```python
import torch

def _softmax(x, axis=-1):
    return torch.softmax(x, dim=axis)

def _gelu(x):
    return torch.nn.functional.gelu(x, approximate='tanh')

def _silu(x):
    return torch.nn.functional.silu(x)

def _sigmoid(x):
    return torch.sigmoid(x)

def _layernorm(x, axis=-1, eps=1e-05):
    m = x.mean(dim=axis, keepdim=True)
    v = x.var(dim=axis, keepdim=True, unbiased=False)
    return (x - m) / torch.sqrt(v + eps)

def _scatter_add(tgt, idx, src, axis=0):
    return tgt.clone().index_add_(axis, idx, src)

def _segment_sum(src, seg, n):
    out = torch.zeros((n,) + src.shape[1:], dtype=src.dtype)
    return out.index_add_(0, seg, src)

def _pad(x, pw):
    flat = tuple((v for pair in reversed(pw) for v in pair))
    return torch.nn.functional.pad(x, flat)
kernel_name = 'parallel_sum__memory_aug_recurrent_mem_tr__dense_activation_silu__prompt'

def setup_inputs():

    _w = lambda a: (lambda t: t.to(torch.bfloat16) if t.is_floating_point() else t)(torch.as_tensor(a))

    def _A_setup():
        B, S, Dm = (1, 2048, 576)
        H, Dh = (32, 128)
        M, seg = (8, 32)
        seg = min(seg, S)
        S = S // seg * seg
        return {'x': _w((lambda *s: torch.randn(*s, dtype=torch.bfloat16) * 0.05)(B, S, Dm)), 'mem0': _w((lambda *s: torch.randn(*s, dtype=torch.bfloat16) * 0.2)(B, M, Dm)), 'Wq': _w((lambda *s: torch.randn(*s, dtype=torch.bfloat16) * 1.6)(Dm, H, Dh) * Dm ** (-0.5)), 'Wk': _w((lambda *s: torch.randn(*s, dtype=torch.bfloat16) * 1.6)(Dm, H, Dh) * Dm ** (-0.5)), 'Wv': _w((lambda *s: torch.randn(*s, dtype=torch.bfloat16) * 0.2)(Dm, H, Dh) * Dm ** (-0.5)), 'Wo': _w((lambda *s: torch.randn(*s, dtype=torch.bfloat16) * 0.2)(H, Dh, Dm) * (H * Dh) ** (-0.5)), 'seg_len': seg}
    _A_in = _A_setup()

    def _B_setup():
        B, S, D, F = (1, 2048, 576, 4608)
        return {'x': _w((lambda *s: torch.randn(*s, dtype=torch.bfloat16) * 0.05)(B, S, D)), 'w1': _w((lambda *s: torch.randn(*s, dtype=torch.bfloat16) * 0.8)(D, F) * D ** (-0.5)), 'w2': _w((lambda *s: torch.randn(*s, dtype=torch.bfloat16) * 0.1)(F, D) * F ** (-0.5))}
    _B_in = _B_setup()
    return {'A_x': _A_in['x'], 'A_mem0': _A_in['mem0'], 'A_Wq': _A_in['Wq'], 'A_Wk': _A_in['Wk'], 'A_Wv': _A_in['Wv'], 'A_Wo': _A_in['Wo'], 'A_seg_len': _A_in['seg_len'], 'B_x': _B_in['x'], 'B_w1': _B_in['w1'], 'B_w2': _B_in['w2']}

def reference(A_x, A_mem0, A_Wq, A_Wk, A_Wv, A_Wo, A_seg_len, B_x, B_w1, B_w2):

    def _A_ref(x, mem0, Wq, Wk, Wv, Wo, seg_len):
        B, S, Dm = x.shape
        H, Dh = (Wq.shape[1], Wq.shape[2])
        M = mem0.shape[1]
        scale = Dh ** (-0.5)
        n_seg = S // seg_len
        L = M + seg_len
        idx = torch.arange(L)
        mask = (idx[:, None] < M) | (idx[:, None] >= idx[None, :])
        mem = mem0
        outs = []
        for s in range(n_seg):
            xs = x[:, s * seg_len:(s + 1) * seg_len, :].clone()
            h = torch.concatenate([mem, xs], axis=1)
            q = torch.einsum('btd,dhe->bhte', h, Wq)
            k = torch.einsum('btd,dhe->bhte', h, Wk)
            v = torch.einsum('btd,dhe->bhte', h, Wv)
            scores = torch.einsum('bhqe,bhke->bhqk', q, k) * scale
            scores = torch.where(mask[None, None], scores, -1000000000.0)
            p = _softmax(scores, axis=-1)
            o = torch.einsum('bhqk,bhke->bhqe', p, v)
            o = torch.einsum('bhte,hed->btd', o, Wo)
            mem = o[:, :M, :].clone()
            outs.append(o[:, M:, :])
        return torch.concatenate(outs, axis=1)

    def _B_ref(x, w1, w2):
        h = torch.einsum('bsd,df->bsf', x, w1)
        h = _silu(h)
        out = torch.einsum('bsf,fd->bsd', h, w2)
        return out
    x = A_x
    xn = _layernorm(x, axis=-1)
    return x + _A_ref(xn, A_mem0, A_Wq, A_Wk, A_Wv, A_Wo, A_seg_len) + _B_ref(xn, B_w1, B_w2)
```

```asm
; @launch grid=(256,1,1) block=(256,1,1) lds=163840
.amdgcn_target "amdgcn-amd-amdhsa--gfx950"
.text
.globl parallel_sum__memory_aug_recurrent_mem_tr__dense_activation_silu__prompt_kernel
.p2align 8
.type parallel_sum__memory_aug_recurrent_mem_tr__dense_activation_silu__prompt_kernel,@function
parallel_sum__memory_aug_recurrent_mem_tr__dense_activation_silu__prompt_kernel:
 s_cmp_ge_u32 s2, 256
 s_cbranch_scc1 L_exit
 s_load_dwordx16 s[52:67], s[0:1], 0
 s_load_dwordx8 s[68:75], s[0:1], 64
 s_load_dwordx2 s[76:77], s[0:1], 96
 s_getreg_b32 s47, hwreg(HW_REG_XCC_ID, 0, 3)
 s_xor_b32 s47, s47, 3
 v_lshrrev_b32 v1, 6, v0
 v_and_b32 v0, 63, v0
 v_readfirstlane_b32 s46, v1
 s_waitcnt lgkmcnt(0)
 s_mov_b64 s[44:45], s[74:75]
 s_mov_b32 s4, s76
 s_and_b32 s5, s77, 0xffff
 s_mov_b32 s6, 268435456
 s_mov_b32 s7, 0x20000
 s_mov_b32 s8, s56
 s_and_b32 s9, s57, 0xffff
 s_mov_b32 s10, 4718592
 s_mov_b32 s11, 0x20000
 s_mov_b32 s12, s58
 s_and_b32 s13, s59, 0xffff
 s_mov_b32 s14, 4718592
 s_mov_b32 s15, 0x20000
 s_mov_b32 s16, s60
 s_and_b32 s17, s61, 0xffff
 s_mov_b32 s18, 4718592
 s_mov_b32 s19, 0x20000
 s_mov_b32 s20, s62
 s_and_b32 s21, s63, 0xffff
 s_mov_b32 s22, 4718592
 s_mov_b32 s23, 0x20000
 s_mov_b32 s24, s52
 s_and_b32 s25, s53, 0xffff
 s_mov_b32 s26, 2359296
 s_mov_b32 s27, 0x20000
 s_mov_b32 s28, s68
 s_and_b32 s29, s69, 0xffff
 s_mov_b32 s30, 5308416
 s_mov_b32 s31, 0x20000
 s_mov_b32 s32, s70
 s_and_b32 s33, s71, 0xffff
 s_mov_b32 s34, 5308416
 s_mov_b32 s35, 0x20000
 s_mov_b32 s36, s72
 s_and_b32 s37, s73, 0xffff
 s_mov_b32 s38, 2359296
 s_mov_b32 s39, 0x20000
 s_mov_b32 s40, s54
 s_and_b32 s41, s55, 0xffff
 s_mov_b32 s42, 9216
 s_mov_b32 s43, 0x20000
 s_getpc_b64 s[52:53]
L_pc_1:
 s_sub_u32 s52, s52, L_pc_1 - parallel_sum__memory_aug_recurrent_mem_tr__dense_activation_silu__prompt_kernel
 s_subb_u32 s53, s53, 0
 s_and_b32 s53, s53, 0xffff
 s_mov_b32 s54, L_codeend - parallel_sum__memory_aug_recurrent_mem_tr__dense_activation_silu__prompt_kernel
 s_mov_b32 s55, 0x20000
 s_lshr_b32 s3, s2, 3
 s_and_b32 s3, s3, 7
 s_lshl_b32 s3, s3, 2
 s_add_u32 s3, s3, s46
 s_lshl_b32 s3, s3, 13
 v_lshlrev_b32 v3, 7, v0
 s_mov_b32 m0, 1024
 s_nop 0
 buffer_load_dword v3, s[52:55], s3 offen lds
 s_cmp_lg_u32 s46, 0
 s_cbranch_scc1 L_tk_2
 s_lshr_b32 s3, s47, 1
 s_lshl_b32 s51, s47, 2
 s_lshl_b32 s3, s3, 6
 s_add_u32 s51, s51, s3
 s_add_u32 s52, s44, s51
 s_addc_u32 s53, s45, 0
 s_mov_b32 s50, 1
 s_atomic_add s50, s[52:53], 0 glc
 s_waitcnt lgkmcnt(0)
 v_mov_b32 v1, s50
 v_mov_b32 v2, 0
 ds_write_b32 v2, v1
 s_waitcnt lgkmcnt(0)
L_tk_2:
 s_barrier
 v_mov_b32 v2, 0
 ds_read_b32 v1, v2
 s_waitcnt lgkmcnt(0)
 v_readfirstlane_b32 s50, v1
 s_barrier
 s_lshl_b32 s48, s47, 5
 s_add_u32 s48, s48, s50
 s_cmp_lt_u32 s50, 32
 s_cbranch_scc1 L_role_3
 v_lshlrev_b32 v1, 2, v0
 s_mov_b32 s60, 0
L_cnt_4:
 global_load_dword v2, v1, s[44:45] sc1
 s_add_u32 s60, s60, 1
 s_cmp_gt_u32 s60, 100000
 s_cbranch_scc1 L_exit
 s_waitcnt vmcnt(0)
 s_mov_b32 s3, 0
 v_readlane_b32 s52, v2, 0
 s_add_u32 s3, s3, s52
 v_readlane_b32 s53, v2, 1
 s_add_u32 s3, s3, s53
 v_readlane_b32 s54, v2, 18
 s_add_u32 s3, s3, s54
 v_readlane_b32 s55, v2, 19
 s_add_u32 s3, s3, s55
 v_readlane_b32 s56, v2, 36
 s_add_u32 s3, s3, s56
 v_readlane_b32 s57, v2, 37
 s_add_u32 s3, s3, s57
 v_readlane_b32 s58, v2, 54
 s_add_u32 s3, s3, s58
 v_readlane_b32 s59, v2, 55
 s_add_u32 s3, s3, s59
 s_cmp_lt_u32 s3, 256
 s_cbranch_scc1 L_cnt_4
 s_mov_b32 s49, 1
 s_cmp_eq_u32 s52, 32
 s_cselect_b32 s49, s49, 0
 s_cmp_eq_u32 s53, 32
 s_cselect_b32 s49, s49, 0
 s_cmp_eq_u32 s54, 32
 s_cselect_b32 s49, s49, 0
 s_cmp_eq_u32 s55, 32
 s_cselect_b32 s49, s49, 0
 s_cmp_eq_u32 s56, 32
 s_cselect_b32 s49, s49, 0
 s_cmp_eq_u32 s57, 32
 s_cselect_b32 s49, s49, 0
 s_cmp_eq_u32 s58, 32
 s_cselect_b32 s49, s49, 0
 s_cmp_eq_u32 s59, 32
 s_cselect_b32 s49, s49, 0
 s_sub_u32 s50, s50, 32
 s_sub_i32 s3, s52, 32
 s_max_i32 s3, s3, 0
 s_cmp_gt_u32 s47, 0
 s_cselect_b32 s3, s3, 0
 s_add_u32 s50, s50, s3
 s_sub_i32 s3, s53, 32
 s_max_i32 s3, s3, 0
 s_cmp_gt_u32 s47, 1
 s_cselect_b32 s3, s3, 0
 s_add_u32 s50, s50, s3
 s_sub_i32 s3, s54, 32
 s_max_i32 s3, s3, 0
 s_cmp_gt_u32 s47, 2
 s_cselect_b32 s3, s3, 0
 s_add_u32 s50, s50, s3
 s_sub_i32 s3, s55, 32
 s_max_i32 s3, s3, 0
 s_cmp_gt_u32 s47, 3
 s_cselect_b32 s3, s3, 0
 s_add_u32 s50, s50, s3
 s_sub_i32 s3, s56, 32
 s_max_i32 s3, s3, 0
 s_cmp_gt_u32 s47, 4
 s_cselect_b32 s3, s3, 0
 s_add_u32 s50, s50, s3
 s_sub_i32 s3, s57, 32
 s_max_i32 s3, s3, 0
 s_cmp_gt_u32 s47, 5
 s_cselect_b32 s3, s3, 0
 s_add_u32 s50, s50, s3
 s_sub_i32 s3, s58, 32
 s_max_i32 s3, s3, 0
 s_cmp_gt_u32 s47, 6
 s_cselect_b32 s3, s3, 0
 s_add_u32 s50, s50, s3
 s_sub_i32 s3, s59, 32
 s_max_i32 s3, s3, 0
 s_cmp_gt_u32 s47, 7
 s_cselect_b32 s3, s3, 0
 s_add_u32 s50, s50, s3
 s_mov_b32 s48, 0
 s_sub_i32 s3, 32, s52
 s_max_i32 s3, s3, 0
 s_add_u32 s61, s52, s50
 s_add_u32 s61, s61, 0
 s_cmp_lt_u32 s50, s3
 s_cselect_b32 s48, s61, s48
 s_sub_u32 s50, s50, s3
 s_sub_i32 s3, 32, s53
 s_max_i32 s3, s3, 0
 s_add_u32 s61, s53, s50
 s_add_u32 s61, s61, 32
 s_cmp_lt_u32 s50, s3
 s_cselect_b32 s48, s61, s48
 s_sub_u32 s50, s50, s3
 s_sub_i32 s3, 32, s54
 s_max_i32 s3, s3, 0
 s_add_u32 s61, s54, s50
 s_add_u32 s61, s61, 64
 s_cmp_lt_u32 s50, s3
 s_cselect_b32 s48, s61, s48
 s_sub_u32 s50, s50, s3
 s_sub_i32 s3, 32, s55
 s_max_i32 s3, s3, 0
 s_add_u32 s61, s55, s50
 s_add_u32 s61, s61, 96
 s_cmp_lt_u32 s50, s3
 s_cselect_b32 s48, s61, s48
 s_sub_u32 s50, s50, s3
 s_sub_i32 s3, 32, s56
 s_max_i32 s3, s3, 0
 s_add_u32 s61, s56, s50
 s_add_u32 s61, s61, 128
 s_cmp_lt_u32 s50, s3
 s_cselect_b32 s48, s61, s48
 s_sub_u32 s50, s50, s3
 s_sub_i32 s3, 32, s57
 s_max_i32 s3, s3, 0
 s_add_u32 s61, s57, s50
 s_add_u32 s61, s61, 160
 s_cmp_lt_u32 s50, s3
 s_cselect_b32 s48, s61, s48
 s_sub_u32 s50, s50, s3
 s_sub_i32 s3, 32, s58
 s_max_i32 s3, s3, 0
 s_add_u32 s61, s58, s50
 s_add_u32 s61, s61, 192
 s_cmp_lt_u32 s50, s3
 s_cselect_b32 s48, s61, s48
 s_sub_u32 s50, s50, s3
 s_sub_i32 s3, 32, s59
 s_max_i32 s3, s3, 0
 s_add_u32 s61, s59, s50
 s_add_u32 s61, s61, 224
 s_cmp_lt_u32 s50, s3
 s_cselect_b32 s48, s61, s48
 s_sub_u32 s50, s50, s3
L_role_3:
 s_mov_b32 s79, 0
 s_cmp_ge_u32 s48, 32
 s_cbranch_scc1 L_notchain
 s_cmp_lg_u32 s46, 1
 s_cbranch_scc1 L_ini_5
 v_mov_b32 v20, 1
 v_mov_b32 v21, 1
 v_mov_b32 v22, 1
 v_mov_b32 v23, 1
 v_mov_b32 v24, 0
 v_lshlrev_b32 v25, 4, v0
 v_lshlrev_b32 v26, 7, v0
 s_mul_i32 s3, s48, 12288
 s_add_u32 s3, s3, 62914560
 buffer_store_dwordx4 v[20:23], v25, s[4:7], s3 offen sc1
 s_add_u32 s3, s3, 1024
 buffer_store_dwordx4 v[20:23], v25, s[4:7], s3 offen sc1
 s_add_u32 s3, s3, 1024
 buffer_store_dwordx4 v[20:23], v25, s[4:7], s3 offen sc1
 s_add_u32 s3, s3, 1024
 buffer_store_dwordx4 v[20:23], v25, s[4:7], s3 offen sc1
 s_add_u32 s3, s3, 1024
 buffer_store_dwordx4 v[20:23], v25, s[4:7], s3 offen sc1
 s_add_u32 s3, s3, 1024
 buffer_store_dwordx4 v[20:23], v25, s[4:7], s3 offen sc1
 s_add_u32 s3, s3, 1024
 buffer_store_dwordx4 v[20:23], v25, s[4:7], s3 offen sc1
 s_add_u32 s3, s3, 1024
 buffer_store_dwordx4 v[20:23], v25, s[4:7], s3 offen sc1
 s_add_u32 s3, s3, 1024
 buffer_store_dwordx4 v[20:23], v25, s[4:7], s3 offen sc1
 s_add_u32 s3, s3, 1024
 buffer_store_dwordx4 v[20:23], v25, s[4:7], s3 offen sc1
 s_add_u32 s3, s3, 1024
 buffer_store_dwordx4 v[20:23], v25, s[4:7], s3 offen sc1
 s_add_u32 s3, s3, 1024
 buffer_store_dwordx4 v[20:23], v25, s[4:7], s3 offen sc1
 s_add_u32 s3, s3, 1024
 s_cmp_lg_u32 s48, 0
 s_cbranch_scc1 L_ini_5
 s_mov_b32 s3, 65011712
 buffer_store_dword v24, v26, s[4:7], s3 offen sc1
 s_mov_b32 s3, 65019904
 buffer_store_dword v24, v26, s[4:7], s3 offen sc1
L_ini_5:
L_chain:
 v_mov_b32 v14, v0
 v_and_b32 v10, 15, v14
 v_lshrrev_b32 v11, 4, v14
 v_mov_b32 v1, 0x44444444
 v_mov_b32 v12, 0xeeeeeeee
 v_cmp_lt_u32 vcc, 7, v10
 s_nop 1
 v_cndmask_b32 v1, v1, v12, vcc
 v_mov_b32 v2, 0
 v_mov_b32 v12, 0xff800000
 v_cmp_gt_u32 vcc, 32, v14
 s_nop 1
 v_cndmask_b32 v2, v2, v12, vcc
 v_lshlrev_b32 v0, 4, v14
 s_lshl_b32 s3, s46, 11
 s_add_u32 s3, s3, 24576
 v_add_u32 v3, s3, v0
 v_and_b32 v12, 7, v14
 v_lshl_add_u32 v12, v11, 3, v12
 v_lshlrev_b32 v4, 4, v12
 v_and_b32 v12, 1, v11
 v_mul_u32_u24 v12, 1088, v12
 v_lshrrev_b32 v13, 1, v11
 v_lshl_add_u32 v13, v13, 4, v10
 s_lshl_b32 s3, s46, 5
 v_add_u32 v13, s3, v13
 v_lshl_add_u32 v5, v13, 3, v12
 v_add_u32 v5, 9216, v5
 v_and_b32 v12, 3, v10
 v_mul_u32_u24 v12, 1088, v12
 v_lshrrev_b32 v13, 1, v11
 v_lshlrev_b32 v13, 4, v13
 v_and_b32 v6, 1, v11
 v_lshl_add_u32 v13, v6, 2, v13
 v_lshrrev_b32 v6, 2, v10
 v_add_u32 v13, v13, v6
 v_lshl_add_u32 v6, v13, 3, v12
 v_add_u32 v6, 9216, v6
 s_lshl_b32 s3, s46, 9
 s_add_u32 s3, s3, 0
 v_mov_b32 v12, s3
 v_mov_b32 v13, 23936
 v_cmp_lt_u32 vcc, 7, v10
 s_nop 1
 v_cndmask_b32 v12, v12, v13, vcc
 v_add_u32 v7, v12, v4
 v_and_b32 v12, 2, v11
 v_lshrrev_b32 v8, 3, v10
 v_add_u32 v12, v12, v8
 v_mul_u32_u24 v12, 4224, v12
 v_and_b32 v13, 1, v11
 v_lshl_add_u32 v12, v13, 3, v12
 v_and_b32 v8, 7, v10
 v_lshl_add_u32 v8, v8, 4, v12
 s_lshl_b32 s3, s48, 7
 s_mul_i32 s72, s46, 16896
 s_add_u32 s3, s3, s72
 s_add_u32 s55, s3, 62914560
 s_add_u32 s56, s55, 67584
 s_add_u32 s57, s55, 135168
 s_add_u32 s58, s55, 202752
 s_add_u32 s59, s55, 236544
 s_lshl_b32 s53, s46, 5
 s_add_u32 s53, s53, s48
 s_cmp_lt_u32 s53, 72
 s_cselect_b32 s54, 1, 0
 s_cmp_eq_u32 s46, 3
 s_cselect_b32 s54, 0, s54
 s_mul_i32 s60, s53, 4224
 s_add_u32 s60, s60, 62914560
 s_lshl_b32 s61, s53, 7
 s_add_u32 s61, s61, 63218688
 s_mov_b32 s24, 63218688
 s_mov_b32 s25, 63222784
 s_mov_b32 s26, 63226880
 s_mov_b32 s62, 0x3e029413
 s_lshl_b32 s52, s48, 13
 s_lshl_b32 s65, s48, 12
 s_add_u32 s3, s46, 1
 s_cmp_eq_u32 s46, 0
 s_cselect_b32 s3, 0, s3
 s_lshl_b32 s3, s3, 10
 s_add_u32 s65, s65, s3
 s_add_u32 s65, s65, 50331648
 s_lshl_b32 s66, s48, 7
 s_add_u32 s66, s66, 65011712
 s_mov_b32 s27, 131072
 s_mov_b32 s71, 1
 s_lshl_b32 s67, s46, 11
 s_mov_b32 s76, 0x3f803f80
 s_mov_b32 s77, 0x3f803f80
 s_mov_b32 s63, s62
 s_lshr_b32 s68, s46, 1
 s_mul_i32 s68, s68, 16777216
 s_and_b32 s3, s46, 1
 s_lshl_b32 s3, s3, 12
 s_add_u32 s68, s68, s3
 v_lshrrev_b32 v20, 4, v14
 v_lshlrev_b32 v21, 2, v20
 v_xor_b32 v21, v21, v14
 v_and_b32 v21, 15, v21
 v_lshlrev_b32 v21, 4, v21
 v_and_b32 v22, 1, v20
 v_lshlrev_b32 v22, 1, v22
 v_lshrrev_b32 v15, 1, v20
 v_add_u32 v22, v22, v15
 v_lshl_add_u32 v15, v22, 13, v21
 v_lshrrev_b32 v22, 1, v20
 v_lshlrev_b32 v22, 4, v22
 v_and_b32 v16, 1, v20
 v_add_u32 v22, v22, v16
 v_mul_u32_u24 v22, 1152, v22
 v_add_u32 v16, v22, v21
 v_lshrrev_b32 v20, 3, v14
 v_bfe_u32 v21, v20, 1, 1
 v_lshlrev_b32 v22, 4, v21
 v_lshlrev_b32 v21, 2, v21
 v_xor_b32 v21, v21, v14
 v_and_b32 v21, 7, v21
 v_lshlrev_b32 v21, 4, v21
 v_and_b32 v17, 1, v20
 v_add_u32 v22, v22, v17
 v_bfe_u32 v17, v20, 2, 1
 v_lshl_add_u32 v22, v17, 1, v22
 v_mul_u32_u24 v22, 1152, v22
 v_add_u32 v17, v22, v21
 v_bfe_u32 v20, v14, 4, 1
 v_bfe_u32 v21, v14, 2, 1
 v_lshl_add_u32 v20, v20, 1, v21
 v_bfe_u32 v21, v14, 5, 1
 v_lshl_add_u32 v21, v21, 3, v20
 v_bfe_u32 v22, v14, 3, 1
 v_lshlrev_b32 v22, 5, v22
 v_and_b32 v18, 3, v14
 v_lshl_add_u32 v22, v18, 3, v22
 v_xor_b32 v18, s46, v20
 v_lshl_add_u32 v18, v18, 6, v22
 v_lshl_add_u32 v18, v21, 8, v18
 v_add_u32 v18, 24576, v18
 v_lshrrev_b32 v20, 1, v20
 s_and_b32 s3, s46, 1
 v_xor_b32 v19, s3, v20
 v_lshl_add_u32 v19, v19, 6, v22
 v_lshl_add_u32 v19, v21, 7, v19
 v_add_u32 v19, 147456, v19
 v_add_u32 v10, 57344, v18
 v_add_u32 v11, 114688, v18
 v_add_u32 v12, 57344, v3
 v_add_u32 v13, 114688, v3
 s_lshl_b32 s69, s48, 8
 s_lshl_b32 s3, s46, 16
 s_add_u32 s69, s69, s3
 s_mul_i32 s70, s48, 147456
 s_mul_i32 s3, s46, 4608
 s_add_u32 s70, s70, s3
 s_lshl_b32 s73, s46, 11
 s_add_u32 s73, s73, 24576
 s_lshl_b32 s74, s46, 10
 s_add_u32 s74, s74, 147456
 v_and_b32 v23, 0xf0, v0
 v_lshlrev_b32 v23, 3, v23
 v_lshrrev_b32 v20, 8, v0
 v_min_u32 v20, 1, v20
 v_lshl_or_b32 v23, v20, 30, v23
 s_lshl_b32 s75, s48, 13
 s_lshl_b32 s3, s46, 11
 s_add_u32 s75, s75, s3
 s_add_u32 s72, s69, 0
 s_add_u32 m0, s73, 40960
 s_nop 0
 buffer_load_dwordx4 v15, s[8:11], s72 offen nt lds
 s_add_u32 s72, s69, 32768
 s_add_u32 m0, s73, 41984
 s_nop 0
 buffer_load_dwordx4 v15, s[8:11], s72 offen nt lds
 s_add_u32 s72, s69, 0
 s_add_u32 m0, s73, 49152
 s_nop 0
 buffer_load_dwordx4 v15, s[12:15], s72 offen nt lds
 s_add_u32 s72, s69, 32768
 s_add_u32 m0, s73, 50176
 s_nop 0
 buffer_load_dwordx4 v15, s[12:15], s72 offen nt lds
 s_add_u32 s72, s69, 262144
 s_add_u32 m0, s73, 57344
 s_nop 0
 buffer_load_dwordx4 v15, s[8:11], s72 offen nt lds
 s_add_u32 s72, s69, 294912
 s_add_u32 m0, s73, 58368
 s_nop 0
 buffer_load_dwordx4 v15, s[8:11], s72 offen nt lds
 s_add_u32 s72, s69, 524288
 s_add_u32 m0, s73, 65536
 s_nop 0
 buffer_load_dwordx4 v15, s[8:11], s72 offen nt lds
 s_add_u32 s72, s69, 557056
 s_add_u32 m0, s73, 66560
 s_nop 0
 buffer_load_dwordx4 v15, s[8:11], s72 offen nt lds
 s_add_u32 s72, s69, 786432
 s_add_u32 m0, s73, 73728
 s_nop 0
 buffer_load_dwordx4 v15, s[8:11], s72 offen nt lds
 s_add_u32 s72, s69, 819200
 s_add_u32 m0, s73, 74752
 s_nop 0
 buffer_load_dwordx4 v15, s[8:11], s72 offen nt lds
 s_add_u32 s72, s69, 1048576
 s_add_u32 m0, s73, 81920
 s_nop 0
 buffer_load_dwordx4 v15, s[8:11], s72 offen nt lds
 s_add_u32 s72, s69, 1081344
 s_add_u32 m0, s73, 82944
 s_nop 0
 buffer_load_dwordx4 v15, s[8:11], s72 offen nt lds
 s_waitcnt vmcnt(8)
 s_cmp_lg_u32 s46, 1
 s_cbranch_scc1 L_inid_8
 s_mov_b32 s3, 1
 s_atomic_add s3, s[44:45], 240
L_inid_8:
L_noinit_7:
 s_barrier
 s_add_u32 s72, s69, 1310720
 s_add_u32 m0, s73, 90112
 s_nop 0
 buffer_load_dwordx4 v15, s[8:11], s72 offen nt lds
 s_add_u32 s72, s69, 1343488
 s_add_u32 m0, s73, 91136
 s_nop 0
 buffer_load_dwordx4 v15, s[8:11], s72 offen nt lds
 s_add_u32 s72, s69, 1310720
 s_add_u32 m0, s73, 98304
 s_nop 0
 buffer_load_dwordx4 v15, s[12:15], s72 offen nt lds
 s_add_u32 s72, s69, 1343488
 s_add_u32 m0, s73, 99328
 s_nop 0
 buffer_load_dwordx4 v15, s[12:15], s72 offen nt lds
 s_add_u32 s72, s69, 1572864
 s_add_u32 m0, s73, 106496
 s_nop 0
 buffer_load_dwordx4 v15, s[8:11], s72 offen nt lds
 s_add_u32 s72, s69, 1605632
 s_add_u32 m0, s73, 107520
 s_nop 0
 buffer_load_dwordx4 v15, s[8:11], s72 offen nt lds
 s_add_u32 s72, s69, 1835008
 s_add_u32 m0, s73, 114688
 s_nop 0
 buffer_load_dwordx4 v15, s[8:11], s72 offen nt lds
 s_add_u32 s72, s69, 1867776
 s_add_u32 m0, s73, 115712
 s_nop 0
 buffer_load_dwordx4 v15, s[8:11], s72 offen nt lds
 s_add_u32 s72, s70, 1024
 s_add_u32 m0, s74, 0
 s_nop 0
 buffer_load_dwordx4 v17, s[20:23], s72 offen lds
 s_add_u32 s72, s70, 37888
 s_add_u32 m0, s74, 4096
 s_nop 0
 buffer_load_dwordx4 v17, s[20:23], s72 offen lds
 s_add_u32 s72, s70, 74752
 s_add_u32 m0, s74, 8192
 s_nop 0
 buffer_load_dwordx4 v17, s[20:23], s72 offen lds
 s_add_u32 s72, s70, 111616
 s_add_u32 m0, s74, 12288
 s_nop 0
 buffer_load_dwordx4 v17, s[20:23], s72 offen lds
 ds_read_b64_tr_b16 v[72:73], v18 offset:40960
 ds_read_b64_tr_b16 v[74:75], v18 offset:41984
 ds_read_b64_tr_b16 v[76:77], v18 offset:45056
 ds_read_b64_tr_b16 v[78:79], v18 offset:46080
 ds_read_b64_tr_b16 v[80:81], v18 offset:49152
 ds_read_b64_tr_b16 v[82:83], v18 offset:50176
 ds_read_b64_tr_b16 v[84:85], v18 offset:53248
 ds_read_b64_tr_b16 v[86:87], v18 offset:54272
 s_waitcnt lgkmcnt(0)
 s_waitcnt vmcnt(16)
 s_barrier
 s_add_u32 s72, s69, 2097152
 s_add_u32 m0, s73, 0
 s_nop 0
 buffer_load_dwordx4 v15, s[8:11], s72 offen nt lds
 s_add_u32 s72, s69, 2129920
 s_add_u32 m0, s73, 1024
 s_nop 0
 buffer_load_dwordx4 v15, s[8:11], s72 offen nt lds
 s_add_u32 s72, s69, 2097152
 s_add_u32 m0, s73, 8192
 s_nop 0
 buffer_load_dwordx4 v15, s[12:15], s72 offen nt lds
 s_add_u32 s72, s69, 2129920
 s_add_u32 m0, s73, 9216
 s_nop 0
 buffer_load_dwordx4 v15, s[12:15], s72 offen nt lds
 s_add_u32 s72, s69, 2359296
 s_add_u32 m0, s73, 16384
 s_nop 0
 buffer_load_dwordx4 v15, s[8:11], s72 offen nt lds
 s_add_u32 s72, s69, 2392064
 s_add_u32 m0, s73, 17408
 s_nop 0
 buffer_load_dwordx4 v15, s[8:11], s72 offen nt lds
 s_add_u32 s72, s69, 2621440
 s_add_u32 m0, s73, 24576
 s_nop 0
 buffer_load_dwordx4 v15, s[8:11], s72 offen nt lds
 s_add_u32 s72, s69, 2654208
 s_add_u32 m0, s73, 25600
 s_nop 0
 buffer_load_dwordx4 v15, s[8:11], s72 offen nt lds
 ds_read_b64_tr_b16 v[88:89], v10 offset:0
 ds_read_b64_tr_b16 v[90:91], v10 offset:1024
 ds_read_b64_tr_b16 v[92:93], v10 offset:4096
 ds_read_b64_tr_b16 v[94:95], v10 offset:5120
 ds_read_b64_tr_b16 v[96:97], v10 offset:8192
 ds_read_b64_tr_b16 v[98:99], v10 offset:9216
 ds_read_b64_tr_b16 v[100:101], v10 offset:12288
 ds_read_b64_tr_b16 v[102:103], v10 offset:13312
 s_waitcnt lgkmcnt(0)
 s_waitcnt vmcnt(20)
 s_barrier
 s_add_u32 s72, s69, 2883584
 s_add_u32 m0, s73, 32768
 s_nop 0
 buffer_load_dwordx4 v15, s[8:11], s72 offen nt lds
 s_add_u32 s72, s69, 2916352
 s_add_u32 m0, s73, 33792
 s_nop 0
 buffer_load_dwordx4 v15, s[8:11], s72 offen nt lds
 s_add_u32 s72, s69, 2883584
 s_add_u32 m0, s73, 40960
 s_nop 0
 buffer_load_dwordx4 v15, s[12:15], s72 offen nt lds
 s_add_u32 s72, s69, 2916352
 s_add_u32 m0, s73, 41984
 s_nop 0
 buffer_load_dwordx4 v15, s[12:15], s72 offen nt lds
 s_add_u32 s72, s69, 3145728
 s_add_u32 m0, s73, 49152
 s_nop 0
 buffer_load_dwordx4 v15, s[8:11], s72 offen nt lds
 s_add_u32 s72, s69, 3178496
 s_add_u32 m0, s73, 50176
 s_nop 0
 buffer_load_dwordx4 v15, s[8:11], s72 offen nt lds
 s_add_u32 s72, s69, 3407872
 s_add_u32 m0, s73, 57344
 s_nop 0
 buffer_load_dwordx4 v15, s[8:11], s72 offen nt lds
 s_add_u32 s72, s69, 3440640
 s_add_u32 m0, s73, 58368
 s_nop 0
 buffer_load_dwordx4 v15, s[8:11], s72 offen nt lds
 ds_read_b64_tr_b16 v[104:105], v10 offset:16384
 ds_read_b64_tr_b16 v[106:107], v10 offset:17408
 ds_read_b64_tr_b16 v[108:109], v10 offset:20480
 ds_read_b64_tr_b16 v[110:111], v10 offset:21504
 ds_read_b64_tr_b16 v[112:113], v10 offset:24576
 ds_read_b64_tr_b16 v[114:115], v10 offset:25600
 ds_read_b64_tr_b16 v[116:117], v10 offset:28672
 ds_read_b64_tr_b16 v[118:119], v10 offset:29696
 s_waitcnt lgkmcnt(0)
 s_waitcnt vmcnt(24)
 s_barrier
 s_add_u32 s72, s69, 3670016
 s_add_u32 m0, s73, 65536
 s_nop 0
 buffer_load_dwordx4 v15, s[8:11], s72 offen nt lds
 s_add_u32 s72, s69, 3702784
 s_add_u32 m0, s73, 66560
 s_nop 0
 buffer_load_dwordx4 v15, s[8:11], s72 offen nt lds
 s_add_u32 s72, s69, 3932160
 s_add_u32 m0, s73, 73728
 s_nop 0
 buffer_load_dwordx4 v15, s[8:11], s72 offen nt lds
 s_add_u32 s72, s69, 3964928
 s_add_u32 m0, s73, 74752
 s_nop 0
 buffer_load_dwordx4 v15, s[8:11], s72 offen nt lds
 s_add_u32 s72, s69, 4194304
 s_add_u32 m0, s73, 81920
 s_nop 0
 buffer_load_dwordx4 v15, s[8:11], s72 offen nt lds
 s_add_u32 s72, s69, 4227072
 s_add_u32 m0, s73, 82944
 s_nop 0
 buffer_load_dwordx4 v15, s[8:11], s72 offen nt lds
 ds_read_b64_tr_b16 v[120:121], v10 offset:32768
 ds_read_b64_tr_b16 v[122:123], v10 offset:33792
 ds_read_b64_tr_b16 v[124:125], v10 offset:36864
 ds_read_b64_tr_b16 v[126:127], v10 offset:37888
 ds_read_b64_tr_b16 v[128:129], v10 offset:40960
 ds_read_b64_tr_b16 v[130:131], v10 offset:41984
 ds_read_b64_tr_b16 v[132:133], v10 offset:45056
 ds_read_b64_tr_b16 v[134:135], v10 offset:46080
 s_waitcnt lgkmcnt(0)
 s_waitcnt vmcnt(26)
 s_barrier
 s_add_u32 s72, s69, 4194304
 s_add_u32 m0, s73, 90112
 s_nop 0
 buffer_load_dwordx4 v15, s[12:15], s72 offen nt lds
 s_add_u32 s72, s69, 4227072
 s_add_u32 m0, s73, 91136
 s_nop 0
 buffer_load_dwordx4 v15, s[12:15], s72 offen nt lds
 s_add_u32 s72, s69, 4456448
 s_add_u32 m0, s73, 98304
 s_nop 0
 buffer_load_dwordx4 v15, s[8:11], s72 offen nt lds
 s_add_u32 s72, s69, 4489216
 s_add_u32 m0, s73, 99328
 s_nop 0
 buffer_load_dwordx4 v15, s[8:11], s72 offen nt lds
 ds_read_b64_tr_b16 v[136:137], v10 offset:49152
 ds_read_b64_tr_b16 v[138:139], v10 offset:50176
 ds_read_b64_tr_b16 v[140:141], v10 offset:53248
 ds_read_b64_tr_b16 v[142:143], v10 offset:54272
 ds_read_b64_tr_b16 v[144:145], v11 offset:0
 ds_read_b64_tr_b16 v[146:147], v11 offset:1024
 ds_read_b64_tr_b16 v[148:149], v11 offset:4096
 ds_read_b64_tr_b16 v[150:151], v11 offset:5120
 s_waitcnt lgkmcnt(0)
 s_waitcnt vmcnt(22)
 s_barrier
 s_add_u32 s72, s69, 4456448
 s_add_u32 m0, s73, 106496
 s_nop 0
 buffer_load_dwordx4 v15, s[12:15], s72 offen nt lds
 s_add_u32 s72, s69, 4489216
 s_add_u32 m0, s73, 107520
 s_nop 0
 buffer_load_dwordx4 v15, s[12:15], s72 offen nt lds
 s_add_u32 s72, s69, 0
 s_add_u32 m0, s73, 114688
 s_nop 0
 buffer_load_dwordx4 v15, s[16:19], s72 offen nt lds
 s_add_u32 s72, s69, 32768
 s_add_u32 m0, s73, 115712
 s_nop 0
 buffer_load_dwordx4 v15, s[16:19], s72 offen nt lds
 ds_read_b64_tr_b16 v[152:153], v18 offset:0
 ds_read_b64_tr_b16 v[154:155], v18 offset:1024
 ds_read_b64_tr_b16 v[156:157], v18 offset:4096
 ds_read_b64_tr_b16 v[158:159], v18 offset:5120
 ds_read_b64_tr_b16 v[160:161], v18 offset:8192
 ds_read_b64_tr_b16 v[162:163], v18 offset:9216
 ds_read_b64_tr_b16 v[164:165], v18 offset:12288
 ds_read_b64_tr_b16 v[166:167], v18 offset:13312
 s_waitcnt lgkmcnt(0)
 s_waitcnt vmcnt(22)
 s_barrier
 s_add_u32 s72, s69, 262144
 s_add_u32 m0, s73, 0
 s_nop 0
 buffer_load_dwordx4 v15, s[16:19], s72 offen nt lds
 s_add_u32 s72, s69, 294912
 s_add_u32 m0, s73, 1024
 s_nop 0
 buffer_load_dwordx4 v15, s[16:19], s72 offen nt lds
 s_add_u32 s72, s69, 524288
 s_add_u32 m0, s73, 8192
 s_nop 0
 buffer_load_dwordx4 v15, s[16:19], s72 offen nt lds
 s_add_u32 s72, s69, 557056
 s_add_u32 m0, s73, 9216
 s_nop 0
 buffer_load_dwordx4 v15, s[16:19], s72 offen nt lds
 ds_read_b64_tr_b16 v[168:169], v18 offset:16384
 ds_read_b64_tr_b16 v[170:171], v18 offset:17408
 ds_read_b64_tr_b16 v[172:173], v18 offset:20480
 ds_read_b64_tr_b16 v[174:175], v18 offset:21504
 ds_read_b64_tr_b16 v[176:177], v18 offset:24576
 ds_read_b64_tr_b16 v[178:179], v18 offset:25600
 ds_read_b64_tr_b16 v[180:181], v18 offset:28672
 ds_read_b64_tr_b16 v[182:183], v18 offset:29696
 s_waitcnt lgkmcnt(0)
 s_waitcnt vmcnt(22)
 s_barrier
 s_add_u32 s72, s69, 786432
 s_add_u32 m0, s73, 16384
 s_nop 0
 buffer_load_dwordx4 v15, s[16:19], s72 offen nt lds
 s_add_u32 s72, s69, 819200
 s_add_u32 m0, s73, 17408
 s_nop 0
 buffer_load_dwordx4 v15, s[16:19], s72 offen nt lds
 s_add_u32 s72, s69, 1048576
 s_add_u32 m0, s73, 24576
 s_nop 0
 buffer_load_dwordx4 v15, s[16:19], s72 offen nt lds
 s_add_u32 s72, s69, 1081344
 s_add_u32 m0, s73, 25600
 s_nop 0
 buffer_load_dwordx4 v15, s[16:19], s72 offen nt lds
 ds_read_b64_tr_b16 v[184:185], v18 offset:32768
 ds_read_b64_tr_b16 v[186:187], v18 offset:33792
 ds_read_b64_tr_b16 v[188:189], v18 offset:36864
 ds_read_b64_tr_b16 v[190:191], v18 offset:37888
 ds_read_b64_tr_b16 v[192:193], v18 offset:40960
 ds_read_b64_tr_b16 v[194:195], v18 offset:41984
 ds_read_b64_tr_b16 v[196:197], v18 offset:45056
 ds_read_b64_tr_b16 v[198:199], v18 offset:46080
 s_waitcnt lgkmcnt(0)
 s_waitcnt vmcnt(22)
 s_barrier
 s_add_u32 s72, s69, 1310720
 s_add_u32 m0, s73, 32768
 s_nop 0
 buffer_load_dwordx4 v15, s[16:19], s72 offen nt lds
 s_add_u32 s72, s69, 1343488
 s_add_u32 m0, s73, 33792
 s_nop 0
 buffer_load_dwordx4 v15, s[16:19], s72 offen nt lds
 s_add_u32 s72, s69, 1572864
 s_add_u32 m0, s73, 40960
 s_nop 0
 buffer_load_dwordx4 v15, s[16:19], s72 offen nt lds
 s_add_u32 s72, s69, 1605632
 s_add_u32 m0, s73, 41984
 s_nop 0
 buffer_load_dwordx4 v15, s[16:19], s72 offen nt lds
 ds_read_b64_tr_b16 v[200:201], v18 offset:49152
 ds_read_b64_tr_b16 v[202:203], v18 offset:50176
 ds_read_b64_tr_b16 v[204:205], v18 offset:53248
 ds_read_b64_tr_b16 v[206:207], v18 offset:54272
 ds_read_b64_tr_b16 v[208:209], v10 offset:0
 ds_read_b64_tr_b16 v[210:211], v10 offset:1024
 ds_read_b64_tr_b16 v[212:213], v10 offset:4096
 ds_read_b64_tr_b16 v[214:215], v10 offset:5120
 s_waitcnt lgkmcnt(0)
 s_waitcnt vmcnt(22)
 s_barrier
 s_add_u32 s72, s69, 1835008
 s_add_u32 m0, s73, 49152
 s_nop 0
 buffer_load_dwordx4 v15, s[16:19], s72 offen nt lds
 s_add_u32 s72, s69, 1867776
 s_add_u32 m0, s73, 50176
 s_nop 0
 buffer_load_dwordx4 v15, s[16:19], s72 offen nt lds
 s_add_u32 s72, s69, 2097152
 s_add_u32 m0, s73, 57344
 s_nop 0
 buffer_load_dwordx4 v15, s[16:19], s72 offen nt lds
 s_add_u32 s72, s69, 2129920
 s_add_u32 m0, s73, 58368
 s_nop 0
 buffer_load_dwordx4 v15, s[16:19], s72 offen nt lds
 ds_read_b64_tr_b16 v[40:41], v19 offset:0
 ds_read_b64_tr_b16 v[42:43], v19 offset:512
 ds_read_b64_tr_b16 v[44:45], v19 offset:2048
 ds_read_b64_tr_b16 v[46:47], v19 offset:2560
 ds_read_b64_tr_b16 v[48:49], v19 offset:4096
 ds_read_b64_tr_b16 v[50:51], v19 offset:4608
 ds_read_b64_tr_b16 v[52:53], v19 offset:6144
 ds_read_b64_tr_b16 v[54:55], v19 offset:6656
 ds_read_b64_tr_b16 v[56:57], v19 offset:8192
 ds_read_b64_tr_b16 v[58:59], v19 offset:8704
 ds_read_b64_tr_b16 v[60:61], v19 offset:10240
 ds_read_b64_tr_b16 v[62:63], v19 offset:10752
 ds_read_b64_tr_b16 v[64:65], v19 offset:12288
 ds_read_b64_tr_b16 v[66:67], v19 offset:12800
 ds_read_b64_tr_b16 v[68:69], v19 offset:14336
 ds_read_b64_tr_b16 v[70:71], v19 offset:14848
 s_waitcnt lgkmcnt(0)
 ds_read_b64_tr_b16 v[216:217], v10 offset:8192
 ds_read_b64_tr_b16 v[218:219], v10 offset:9216
 ds_read_b64_tr_b16 v[220:221], v10 offset:12288
 ds_read_b64_tr_b16 v[222:223], v10 offset:13312
 ds_read_b64_tr_b16 v[224:225], v10 offset:16384
 ds_read_b64_tr_b16 v[226:227], v10 offset:17408
 ds_read_b64_tr_b16 v[228:229], v10 offset:20480
 ds_read_b64_tr_b16 v[230:231], v10 offset:21504
 s_waitcnt lgkmcnt(0)
 s_waitcnt vmcnt(22)
 s_barrier
 s_cmp_lt_u32 s46, 2
 s_cbranch_scc1 L_hb_9
 ds_write_b128 v13, v[40:43] offset:4096
 ds_write_b128 v13, v[44:47] offset:5120
 ds_write_b128 v13, v[48:51] offset:8192
 ds_write_b128 v13, v[52:55] offset:9216
 ds_write_b128 v13, v[56:59] offset:12288
 ds_write_b128 v13, v[60:63] offset:13312
 ds_write_b128 v13, v[64:67] offset:16384
 ds_write_b128 v13, v[68:71] offset:17408
L_hb_9:
 s_add_u32 s72, s69, 2359296
 s_add_u32 m0, s73, 65536
 s_nop 0
 buffer_load_dwordx4 v15, s[16:19], s72 offen nt lds
 s_add_u32 s72, s69, 2392064
 s_add_u32 m0, s73, 66560
 s_nop 0
 buffer_load_dwordx4 v15, s[16:19], s72 offen nt lds
 s_add_u32 s72, s69, 2621440
 s_add_u32 m0, s73, 73728
 s_nop 0
 buffer_load_dwordx4 v15, s[16:19], s72 offen nt lds
 s_add_u32 s72, s69, 2654208
 s_add_u32 m0, s73, 74752
 s_nop 0
 buffer_load_dwordx4 v15, s[16:19], s72 offen nt lds
 ds_read_b64_tr_b16 v[232:233], v10 offset:24576
 ds_read_b64_tr_b16 v[234:235], v10 offset:25600
 ds_read_b64_tr_b16 v[236:237], v10 offset:28672
 ds_read_b64_tr_b16 v[238:239], v10 offset:29696
 ds_read_b64_tr_b16 v[240:241], v10 offset:32768
 ds_read_b64_tr_b16 v[242:243], v10 offset:33792
 ds_read_b64_tr_b16 v[244:245], v10 offset:36864
 ds_read_b64_tr_b16 v[246:247], v10 offset:37888
 s_waitcnt lgkmcnt(0)
 s_waitcnt vmcnt(22)
 s_barrier
 s_add_u32 s72, s69, 2883584
 s_add_u32 m0, s73, 81920
 s_nop 0
 buffer_load_dwordx4 v15, s[16:19], s72 offen nt lds
 s_add_u32 s72, s69, 2916352
 s_add_u32 m0, s73, 82944
 s_nop 0
 buffer_load_dwordx4 v15, s[16:19], s72 offen nt lds
 s_add_u32 s72, s69, 3145728
 s_add_u32 m0, s73, 90112
 s_nop 0
 buffer_load_dwordx4 v15, s[16:19], s72 offen nt lds
 s_add_u32 s72, s69, 3178496
 s_add_u32 m0, s73, 91136
 s_nop 0
 buffer_load_dwordx4 v15, s[16:19], s72 offen nt lds
 s_lshl_b32 s3, s46, 6
 v_lshrrev_b32 v62, 4, v0
 v_add_u32 v62, s3, v62
 v_bfe_u32 v63, v62, 2, 3
 v_mul_u32_u24 v64, 1152, v63
 v_lshrrev_b32 v63, 5, v62
 v_lshl_add_u32 v64, v63, 4, v64
 v_and_b32 v63, 1, v62
 v_lshl_add_u32 v64, v63, 3, v64
 v_bfe_u32 v63, v62, 1, 1
 v_lshl_add_u32 v64, v63, 1, v64
 buffer_load_ushort v44, v64, s[40:43], 0 offen offset:0
 buffer_load_ushort v45, v64, s[40:43], 0 offen offset:4
 buffer_load_ushort v46, v64, s[40:43], 0 offen offset:128
 buffer_load_ushort v47, v64, s[40:43], 0 offen offset:132
 buffer_load_ushort v48, v64, s[40:43], 0 offen offset:256
 buffer_load_ushort v49, v64, s[40:43], 0 offen offset:260
 buffer_load_ushort v50, v64, s[40:43], 0 offen offset:384
 buffer_load_ushort v51, v64, s[40:43], 0 offen offset:388
 buffer_load_ushort v52, v64, s[40:43], 0 offen offset:512
 buffer_load_ushort v53, v64, s[40:43], 0 offen offset:516
 buffer_load_ushort v54, v64, s[40:43], 0 offen offset:640
 buffer_load_ushort v55, v64, s[40:43], 0 offen offset:644
 buffer_load_ushort v56, v64, s[40:43], 0 offen offset:768
 buffer_load_ushort v57, v64, s[40:43], 0 offen offset:772
 buffer_load_ushort v58, v64, s[40:43], 0 offen offset:896
 buffer_load_ushort v59, v64, s[40:43], 0 offen offset:900
 buffer_load_ushort v60, v64, s[40:43], 0 offen offset:1024
 buffer_load_ushort v61, v64, s[40:43], 0 offen offset:1028
 v_lshlrev_b32 v62, 2, v62
 ds_read_b64_tr_b16 v[248:249], v10 offset:40960
 ds_read_b64_tr_b16 v[250:251], v10 offset:41984
 ds_read_b64_tr_b16 v[252:253], v10 offset:45056
 ds_read_b64_tr_b16 v[254:255], v10 offset:46080
 ds_read_b64_tr_b16 a[0:1], v10 offset:49152
 ds_read_b64_tr_b16 a[2:3], v10 offset:50176
 ds_read_b64_tr_b16 a[4:5], v10 offset:53248
 ds_read_b64_tr_b16 a[6:7], v10 offset:54272
 s_waitcnt lgkmcnt(0)
 s_waitcnt vmcnt(40)
 s_barrier
 s_add_u32 s72, s69, 3407872
 s_add_u32 m0, s73, 98304
 s_nop 0
 buffer_load_dwordx4 v15, s[16:19], s72 offen nt lds
 s_add_u32 s72, s69, 3440640
 s_add_u32 m0, s73, 99328
 s_nop 0
 buffer_load_dwordx4 v15, s[16:19], s72 offen nt lds
 s_add_u32 s72, s69, 3670016
 s_add_u32 m0, s73, 106496
 s_nop 0
 buffer_load_dwordx4 v15, s[16:19], s72 offen nt lds
 s_add_u32 s72, s69, 3702784
 s_add_u32 m0, s73, 107520
 s_nop 0
 buffer_load_dwordx4 v15, s[16:19], s72 offen nt lds
 ds_read_b64_tr_b16 a[8:9], v11 offset:0
 ds_read_b64_tr_b16 a[10:11], v11 offset:1024
 ds_read_b64_tr_b16 a[12:13], v11 offset:4096
 ds_read_b64_tr_b16 a[14:15], v11 offset:5120
 ds_read_b64_tr_b16 a[16:17], v18 offset:0
 ds_read_b64_tr_b16 a[18:19], v18 offset:1024
 ds_read_b64_tr_b16 a[20:21], v18 offset:4096
 ds_read_b64_tr_b16 a[22:23], v18 offset:5120
 s_waitcnt lgkmcnt(0)
 s_waitcnt vmcnt(40)
 s_barrier
 s_add_u32 s72, s69, 3932160
 s_add_u32 m0, s73, 114688
 s_nop 0
 buffer_load_dwordx4 v15, s[16:19], s72 offen nt lds
 s_add_u32 s72, s69, 3964928
 s_add_u32 m0, s73, 115712
 s_nop 0
 buffer_load_dwordx4 v15, s[16:19], s72 offen nt lds
 s_add_u32 s72, s69, 4194304
 s_add_u32 m0, s73, 0
 s_nop 0
 buffer_load_dwordx4 v15, s[16:19], s72 offen nt lds
 s_add_u32 s72, s69, 4227072
 s_add_u32 m0, s73, 1024
 s_nop 0
 buffer_load_dwordx4 v15, s[16:19], s72 offen nt lds
 ds_read_b64_tr_b16 a[24:25], v18 offset:8192
 ds_read_b64_tr_b16 a[26:27], v18 offset:9216
 ds_read_b64_tr_b16 a[28:29], v18 offset:12288
 ds_read_b64_tr_b16 a[30:31], v18 offset:13312
 ds_read_b64_tr_b16 a[32:33], v18 offset:16384
 ds_read_b64_tr_b16 a[34:35], v18 offset:17408
 ds_read_b64_tr_b16 a[36:37], v18 offset:20480
 ds_read_b64_tr_b16 a[38:39], v18 offset:21504
 s_waitcnt lgkmcnt(0)
 s_waitcnt vmcnt(40)
 s_barrier
 s_add_u32 s72, s69, 4456448
 s_add_u32 m0, s73, 8192
 s_nop 0
 buffer_load_dwordx4 v15, s[16:19], s72 offen nt lds
 s_add_u32 s72, s69, 4489216
 s_add_u32 m0, s73, 9216
 s_nop 0
 buffer_load_dwordx4 v15, s[16:19], s72 offen nt lds
 s_add_u32 s72, s70, 0
 s_add_u32 m0, s73, 16384
 s_nop 0
 buffer_load_dwordx4 v16, s[20:23], s72 offen nt lds
 s_add_u32 s72, s70, 2304
 s_add_u32 m0, s73, 17408
 s_nop 0
 buffer_load_dwordx4 v16, s[20:23], s72 offen nt lds
 ds_read_b64_tr_b16 a[40:41], v18 offset:24576
 ds_read_b64_tr_b16 a[42:43], v18 offset:25600
 ds_read_b64_tr_b16 a[44:45], v18 offset:28672
 ds_read_b64_tr_b16 a[46:47], v18 offset:29696
 ds_read_b64_tr_b16 a[48:49], v18 offset:32768
 ds_read_b64_tr_b16 a[50:51], v18 offset:33792
 ds_read_b64_tr_b16 a[52:53], v18 offset:36864
 ds_read_b64_tr_b16 a[54:55], v18 offset:37888
 s_waitcnt lgkmcnt(0)
 s_waitcnt vmcnt(40)
 s_barrier
 s_add_u32 s72, s70, 36864
 s_add_u32 m0, s73, 24576
 s_nop 0
 buffer_load_dwordx4 v16, s[20:23], s72 offen nt lds
 s_add_u32 s72, s70, 39168
 s_add_u32 m0, s73, 25600
 s_nop 0
 buffer_load_dwordx4 v16, s[20:23], s72 offen nt lds
 s_add_u32 s72, s70, 73728
 s_add_u32 m0, s73, 32768
 s_nop 0
 buffer_load_dwordx4 v16, s[20:23], s72 offen nt lds
 s_add_u32 s72, s70, 76032
 s_add_u32 m0, s73, 33792
 s_nop 0
 buffer_load_dwordx4 v16, s[20:23], s72 offen nt lds
 v_lshrrev_b32 v40, 2, v0
 global_load_dword v41, v40, s[44:45] sc1
 ds_read_b64_tr_b16 a[56:57], v18 offset:40960
 ds_read_b64_tr_b16 a[58:59], v18 offset:41984
 ds_read_b64_tr_b16 a[60:61], v18 offset:45056
 ds_read_b64_tr_b16 a[62:63], v18 offset:46080
 ds_read_b64_tr_b16 a[64:65], v18 offset:49152
 ds_read_b64_tr_b16 a[66:67], v18 offset:50176
 ds_read_b64_tr_b16 a[68:69], v18 offset:53248
 ds_read_b64_tr_b16 a[70:71], v18 offset:54272
 s_waitcnt lgkmcnt(0)
 s_waitcnt vmcnt(41)
 s_barrier
 s_add_u32 s72, s70, 110592
 s_add_u32 m0, s73, 40960
 s_nop 0
 buffer_load_dwordx4 v16, s[20:23], s72 offen nt lds
 s_add_u32 s72, s70, 112896
 s_add_u32 m0, s73, 41984
 s_nop 0
 buffer_load_dwordx4 v16, s[20:23], s72 offen nt lds
 s_add_u32 s72, s70, 256
 s_add_u32 m0, s73, 49152
 s_nop 0
 buffer_load_dwordx4 v16, s[20:23], s72 offen nt lds
 s_add_u32 s72, s70, 2560
 s_add_u32 m0, s73, 50176
 s_nop 0
 buffer_load_dwordx4 v16, s[20:23], s72 offen nt lds
 ds_read_b64_tr_b16 a[72:73], v10 offset:0
 ds_read_b64_tr_b16 a[74:75], v10 offset:1024
 ds_read_b64_tr_b16 a[76:77], v10 offset:4096
 ds_read_b64_tr_b16 a[78:79], v10 offset:5120
 ds_read_b64_tr_b16 a[80:81], v10 offset:8192
 ds_read_b64_tr_b16 a[82:83], v10 offset:9216
 ds_read_b64_tr_b16 a[84:85], v10 offset:12288
 ds_read_b64_tr_b16 a[86:87], v10 offset:13312
 s_waitcnt lgkmcnt(0)
 s_waitcnt vmcnt(41)
 s_barrier
 s_add_u32 s72, s70, 37120
 s_add_u32 m0, s73, 57344
 s_nop 0
 buffer_load_dwordx4 v16, s[20:23], s72 offen nt lds
 s_add_u32 s72, s70, 39424
 s_add_u32 m0, s73, 58368
 s_nop 0
 buffer_load_dwordx4 v16, s[20:23], s72 offen nt lds
 s_add_u32 s72, s70, 73984
 s_add_u32 m0, s73, 65536
 s_nop 0
 buffer_load_dwordx4 v16, s[20:23], s72 offen nt lds
 s_add_u32 s72, s70, 76288
 s_add_u32 m0, s73, 66560
 s_nop 0
 buffer_load_dwordx4 v16, s[20:23], s72 offen nt lds
 ds_read_b64_tr_b16 a[88:89], v10 offset:16384
 ds_read_b64_tr_b16 a[90:91], v10 offset:17408
 ds_read_b64_tr_b16 a[92:93], v10 offset:20480
 ds_read_b64_tr_b16 a[94:95], v10 offset:21504
 ds_read_b64_tr_b16 a[96:97], v10 offset:24576
 ds_read_b64_tr_b16 a[98:99], v10 offset:25600
 ds_read_b64_tr_b16 a[100:101], v10 offset:28672
 ds_read_b64_tr_b16 a[102:103], v10 offset:29696
 s_waitcnt lgkmcnt(0)
 s_waitcnt vmcnt(23)
 s_barrier
 s_add_u32 s72, s70, 110848
 s_add_u32 m0, s73, 73728
 s_nop 0
 buffer_load_dwordx4 v16, s[20:23], s72 offen nt lds
 s_add_u32 s72, s70, 113152
 s_add_u32 m0, s73, 74752
 s_nop 0
 buffer_load_dwordx4 v16, s[20:23], s72 offen nt lds
 s_add_u32 s72, s70, 512
 s_add_u32 m0, s73, 81920
 s_nop 0
 buffer_load_dwordx4 v16, s[20:23], s72 offen nt lds
 s_add_u32 s72, s70, 2816
 s_add_u32 m0, s73, 82944
 s_nop 0
 buffer_load_dwordx4 v16, s[20:23], s72 offen nt lds
 ds_read_b64_tr_b16 a[104:105], v10 offset:32768
 ds_read_b64_tr_b16 a[106:107], v10 offset:33792
 ds_read_b64_tr_b16 a[108:109], v10 offset:36864
 ds_read_b64_tr_b16 a[110:111], v10 offset:37888
 ds_read_b64_tr_b16 a[112:113], v10 offset:40960
 ds_read_b64_tr_b16 a[114:115], v10 offset:41984
 ds_read_b64_tr_b16 a[116:117], v10 offset:45056
 ds_read_b64_tr_b16 a[118:119], v10 offset:46080
 s_waitcnt lgkmcnt(0)
 s_waitcnt vmcnt(23)
 v_lshl_or_b32 v44, v45, 16, v44
 ds_write_b32 v62, v44 offset:0
 v_lshl_or_b32 v46, v47, 16, v46
 ds_write_b32 v62, v46 offset:1024
 v_lshl_or_b32 v48, v49, 16, v48
 ds_write_b32 v62, v48 offset:2048
 v_lshl_or_b32 v50, v51, 16, v50
 ds_write_b32 v62, v50 offset:3072
 v_lshl_or_b32 v52, v53, 16, v52
 ds_write_b32 v62, v52 offset:4096
 v_lshl_or_b32 v54, v55, 16, v54
 ds_write_b32 v62, v54 offset:5120
 v_lshl_or_b32 v56, v57, 16, v56
 ds_write_b32 v62, v56 offset:6144
 v_lshl_or_b32 v58, v59, 16, v58
 ds_write_b32 v62, v58 offset:7168
 v_lshl_or_b32 v60, v61, 16, v60
 ds_write_b32 v62, v60 offset:8192
 s_barrier
 s_add_u32 s72, s70, 37376
 s_add_u32 m0, s73, 90112
 s_nop 0
 buffer_load_dwordx4 v16, s[20:23], s72 offen nt lds
 s_add_u32 s72, s70, 39680
 s_add_u32 m0, s73, 91136
 s_nop 0
 buffer_load_dwordx4 v16, s[20:23], s72 offen nt lds
 s_add_u32 s72, s70, 111104
 s_add_u32 m0, s73, 98304
 s_nop 0
 buffer_load_dwordx4 v16, s[20:23], s72 offen nt lds
 s_add_u32 s72, s70, 113408
 s_add_u32 m0, s73, 99328
 s_nop 0
 buffer_load_dwordx4 v16, s[20:23], s72 offen nt lds
 ds_read_b64_tr_b16 a[120:121], v10 offset:49152
 ds_read_b64_tr_b16 a[122:123], v10 offset:50176
 ds_read_b64_tr_b16 a[124:125], v10 offset:53248
 ds_read_b64_tr_b16 a[126:127], v10 offset:54272
 ds_read_b64_tr_b16 a[128:129], v11 offset:0
 ds_read_b64_tr_b16 a[130:131], v11 offset:1024
 ds_read_b64_tr_b16 a[132:133], v11 offset:4096
 ds_read_b64_tr_b16 a[134:135], v11 offset:5120
 s_waitcnt lgkmcnt(0)
 s_waitcnt vmcnt(23)
 s_barrier
 s_add_u32 s72, s70, 37632
 s_add_u32 m0, s73, 106496
 s_nop 0
 buffer_load_dwordx4 v16, s[20:23], s72 offen nt lds
 s_add_u32 s72, s70, 39936
 s_add_u32 m0, s73, 107520
 s_nop 0
 buffer_load_dwordx4 v16, s[20:23], s72 offen nt lds
 s_add_u32 s72, s70, 111360
 s_add_u32 m0, s73, 114688
 s_nop 0
 buffer_load_dwordx4 v16, s[20:23], s72 offen nt lds
 s_add_u32 s72, s70, 113664
 s_add_u32 m0, s73, 115712
 s_nop 0
 buffer_load_dwordx4 v16, s[20:23], s72 offen nt lds
 ds_read_b64_tr_b16 a[136:137], v18 offset:0
 ds_read_b64_tr_b16 a[138:139], v18 offset:1024
 ds_read_b64_tr_b16 a[140:141], v18 offset:4096
 ds_read_b64_tr_b16 a[142:143], v18 offset:5120
 ds_read_b64_tr_b16 a[144:145], v18 offset:8192
 ds_read_b64_tr_b16 a[146:147], v18 offset:9216
 ds_read_b64_tr_b16 a[148:149], v18 offset:12288
 ds_read_b64_tr_b16 a[150:151], v18 offset:13312
 s_waitcnt lgkmcnt(0)
 s_waitcnt vmcnt(23)
 s_barrier
 s_add_u32 s72, s69, 262144
 s_add_u32 m0, s73, 0
 s_nop 0
 buffer_load_dwordx4 v15, s[12:15], s72 offen nt lds
 s_add_u32 s72, s69, 294912
 s_add_u32 m0, s73, 1024
 s_nop 0
 buffer_load_dwordx4 v15, s[12:15], s72 offen nt lds
 s_add_u32 s72, s69, 524288
 s_add_u32 m0, s73, 8192
 s_nop 0
 buffer_load_dwordx4 v15, s[12:15], s72 offen nt lds
 s_add_u32 s72, s69, 557056
 s_add_u32 m0, s73, 9216
 s_nop 0
 buffer_load_dwordx4 v15, s[12:15], s72 offen nt lds
 ds_read_b64_tr_b16 a[152:153], v18 offset:16384
 ds_read_b64_tr_b16 a[154:155], v18 offset:17408
 ds_read_b64_tr_b16 a[156:157], v18 offset:20480
 ds_read_b64_tr_b16 a[158:159], v18 offset:21504
 ds_read_b64_tr_b16 a[160:161], v18 offset:24576
 ds_read_b64_tr_b16 a[162:163], v18 offset:25600
 ds_read_b64_tr_b16 a[164:165], v18 offset:28672
 ds_read_b64_tr_b16 a[166:167], v18 offset:29696
 s_waitcnt lgkmcnt(0)
 s_waitcnt vmcnt(22)
 s_barrier
 s_add_u32 s72, s69, 786432
 s_add_u32 m0, s73, 16384
 s_nop 0
 buffer_load_dwordx4 v15, s[12:15], s72 offen nt lds
 s_add_u32 s72, s69, 819200
 s_add_u32 m0, s73, 17408
 s_nop 0
 buffer_load_dwordx4 v15, s[12:15], s72 offen nt lds
 s_add_u32 s72, s69, 1048576
 s_add_u32 m0, s73, 24576
 s_nop 0
 buffer_load_dwordx4 v15, s[12:15], s72 offen nt lds
 s_add_u32 s72, s69, 1081344
 s_add_u32 m0, s73, 25600
 s_nop 0
 buffer_load_dwordx4 v15, s[12:15], s72 offen nt lds
 ds_read_b64_tr_b16 a[168:169], v18 offset:32768
 ds_read_b64_tr_b16 a[170:171], v18 offset:33792
 ds_read_b64_tr_b16 a[172:173], v18 offset:36864
 ds_read_b64_tr_b16 a[174:175], v18 offset:37888
 ds_read_b64_tr_b16 a[176:177], v18 offset:40960
 ds_read_b64_tr_b16 a[178:179], v18 offset:41984
 ds_read_b64_tr_b16 a[180:181], v18 offset:45056
 ds_read_b64_tr_b16 a[182:183], v18 offset:46080
 s_waitcnt lgkmcnt(0)
 s_waitcnt vmcnt(22)
 s_barrier
 s_add_u32 s72, s69, 1572864
 s_add_u32 m0, s73, 32768
 s_nop 0
 buffer_load_dwordx4 v15, s[12:15], s72 offen nt lds
 s_add_u32 s72, s69, 1605632
 s_add_u32 m0, s73, 33792
 s_nop 0
 buffer_load_dwordx4 v15, s[12:15], s72 offen nt lds
 s_add_u32 s72, s69, 1835008
 s_add_u32 m0, s73, 40960
 s_nop 0
 buffer_load_dwordx4 v15, s[12:15], s72 offen nt lds
 s_add_u32 s72, s69, 1867776
 s_add_u32 m0, s73, 41984
 s_nop 0
 buffer_load_dwordx4 v15, s[12:15], s72 offen nt lds
 ds_read_b64_tr_b16 a[184:185], v18 offset:49152
 ds_read_b64_tr_b16 a[186:187], v18 offset:50176
 ds_read_b64_tr_b16 a[188:189], v18 offset:53248
 ds_read_b64_tr_b16 a[190:191], v18 offset:54272
 ds_read_b64_tr_b16 a[192:193], v10 offset:0
 ds_read_b64_tr_b16 a[194:195], v10 offset:1024
 ds_read_b64_tr_b16 a[196:197], v10 offset:4096
 ds_read_b64_tr_b16 a[198:199], v10 offset:5120
 s_waitcnt lgkmcnt(0)
 s_waitcnt vmcnt(22)
 v_readlane_b32 s3, v41, 60
 s_cmp_lt_u32 s3, 32
 s_cbranch_scc1 L_notyet_10
 s_mov_b32 s3, 0
 v_readlane_b32 s80, v41, 0
 s_add_u32 s3, s3, s80
 v_readlane_b32 s81, v41, 1
 s_add_u32 s3, s3, s81
 v_readlane_b32 s82, v41, 18
 s_add_u32 s3, s3, s82
 v_readlane_b32 s83, v41, 19
 s_add_u32 s3, s3, s83
 v_readlane_b32 s84, v41, 36
 s_add_u32 s3, s3, s84
 v_readlane_b32 s85, v41, 37
 s_add_u32 s3, s3, s85
 v_readlane_b32 s86, v41, 54
 s_add_u32 s3, s3, s86
 v_readlane_b32 s87, v41, 55
 s_add_u32 s3, s3, s87
 s_cmp_lt_u32 s3, 256
 s_cbranch_scc1 L_notyet_10
 s_mov_b32 s49, 1
 s_cmp_eq_u32 s80, 32
 s_cselect_b32 s49, s49, 0
 s_cmp_eq_u32 s81, 32
 s_cselect_b32 s49, s49, 0
 s_cmp_eq_u32 s82, 32
 s_cselect_b32 s49, s49, 0
 s_cmp_eq_u32 s83, 32
 s_cselect_b32 s49, s49, 0
 s_cmp_eq_u32 s84, 32
 s_cselect_b32 s49, s49, 0
 s_cmp_eq_u32 s85, 32
 s_cselect_b32 s49, s49, 0
 s_cmp_eq_u32 s86, 32
 s_cselect_b32 s49, s49, 0
 s_cmp_eq_u32 s87, 32
 s_cselect_b32 s49, s49, 0
 s_branch L_ready_11
L_notyet_10:
 s_mov_b32 s88, 0
L_cnt_12:
 global_load_dword v41, v40, s[44:45] sc1
 s_add_u32 s88, s88, 1
 s_cmp_gt_u32 s88, 100000
 s_cbranch_scc1 L_exit
 s_waitcnt vmcnt(0)
 v_readlane_b32 s3, v41, 60
 s_cmp_lt_u32 s3, 32
 s_cbranch_scc1 L_cnt_12
 s_mov_b32 s3, 0
 v_readlane_b32 s80, v41, 0
 s_add_u32 s3, s3, s80
 v_readlane_b32 s81, v41, 1
 s_add_u32 s3, s3, s81
 v_readlane_b32 s82, v41, 18
 s_add_u32 s3, s3, s82
 v_readlane_b32 s83, v41, 19
 s_add_u32 s3, s3, s83
 v_readlane_b32 s84, v41, 36
 s_add_u32 s3, s3, s84
 v_readlane_b32 s85, v41, 37
 s_add_u32 s3, s3, s85
 v_readlane_b32 s86, v41, 54
 s_add_u32 s3, s3, s86
 v_readlane_b32 s87, v41, 55
 s_add_u32 s3, s3, s87
 s_cmp_lt_u32 s3, 256
 s_cbranch_scc1 L_cnt_12
 s_mov_b32 s49, 1
 s_cmp_eq_u32 s80, 32
 s_cselect_b32 s49, s49, 0
 s_cmp_eq_u32 s81, 32
 s_cselect_b32 s49, s49, 0
 s_cmp_eq_u32 s82, 32
 s_cselect_b32 s49, s49, 0
 s_cmp_eq_u32 s83, 32
 s_cselect_b32 s49, s49, 0
 s_cmp_eq_u32 s84, 32
 s_cselect_b32 s49, s49, 0
 s_cmp_eq_u32 s85, 32
 s_cselect_b32 s49, s49, 0
 s_cmp_eq_u32 s86, 32
 s_cselect_b32 s49, s49, 0
 s_cmp_eq_u32 s87, 32
 s_cselect_b32 s49, s49, 0
L_ready_11:
 s_barrier
 s_add_u32 s72, s69, 2359296
 s_add_u32 m0, s73, 49152
 s_nop 0
 buffer_load_dwordx4 v15, s[12:15], s72 offen nt lds
 s_add_u32 s72, s69, 2392064
 s_add_u32 m0, s73, 50176
 s_nop 0
 buffer_load_dwordx4 v15, s[12:15], s72 offen nt lds
 s_add_u32 s72, s69, 2621440
 s_add_u32 m0, s73, 57344
 s_nop 0
 buffer_load_dwordx4 v15, s[12:15], s72 offen nt lds
 s_add_u32 s72, s69, 2654208
 s_add_u32 m0, s73, 58368
 s_nop 0
 buffer_load_dwordx4 v15, s[12:15], s72 offen nt lds
 v_and_b32 v42, 0xf0, v0
 v_min_u32 v42, 16, v42
 v_lshlrev_b32 v42, 3, v42
 s_mov_b32 s72, 65015808
 buffer_load_dword v43, v42, s[4:7], s72 offen sc1
 ds_read_b64_tr_b16 a[200:201], v10 offset:8192
 ds_read_b64_tr_b16 a[202:203], v10 offset:9216
 ds_read_b64_tr_b16 a[204:205], v10 offset:12288
 ds_read_b64_tr_b16 a[206:207], v10 offset:13312
 ds_read_b64_tr_b16 a[208:209], v10 offset:16384
 ds_read_b64_tr_b16 a[210:211], v10 offset:17408
 ds_read_b64_tr_b16 a[212:213], v10 offset:20480
 ds_read_b64_tr_b16 a[214:215], v10 offset:21504
 s_waitcnt lgkmcnt(0)
 s_waitcnt vmcnt(23)
 s_barrier
 s_add_u32 s72, s69, 3145728
 s_add_u32 m0, s73, 65536
 s_nop 0
 buffer_load_dwordx4 v15, s[12:15], s72 offen nt lds
 s_add_u32 s72, s69, 3178496
 s_add_u32 m0, s73, 66560
 s_nop 0
 buffer_load_dwordx4 v15, s[12:15], s72 offen nt lds
 s_add_u32 s72, s69, 3407872
 s_add_u32 m0, s73, 73728
 s_nop 0
 buffer_load_dwordx4 v15, s[12:15], s72 offen nt lds
 s_add_u32 s72, s69, 3440640
 s_add_u32 m0, s73, 74752
 s_nop 0
 buffer_load_dwordx4 v15, s[12:15], s72 offen nt lds
 ds_read_b64_tr_b16 a[216:217], v10 offset:24576
 ds_read_b64_tr_b16 a[218:219], v10 offset:25600
 ds_read_b64_tr_b16 a[220:221], v10 offset:28672
 ds_read_b64_tr_b16 a[222:223], v10 offset:29696
 ds_read_b64_tr_b16 a[224:225], v10 offset:32768
 ds_read_b64_tr_b16 a[226:227], v10 offset:33792
 ds_read_b64_tr_b16 a[228:229], v10 offset:36864
 ds_read_b64_tr_b16 a[230:231], v10 offset:37888
 s_waitcnt lgkmcnt(0)
 s_waitcnt vmcnt(23)
 s_barrier
 s_add_u32 s72, s69, 3670016
 s_add_u32 m0, s73, 81920
 s_nop 0
 buffer_load_dwordx4 v15, s[12:15], s72 offen nt lds
 s_add_u32 s72, s69, 3702784
 s_add_u32 m0, s73, 82944
 s_nop 0
 buffer_load_dwordx4 v15, s[12:15], s72 offen nt lds
 s_add_u32 s72, s69, 3932160
 s_add_u32 m0, s73, 90112
 s_nop 0
 buffer_load_dwordx4 v15, s[12:15], s72 offen nt lds
 s_add_u32 s72, s69, 3964928
 s_add_u32 m0, s73, 91136
 s_nop 0
 buffer_load_dwordx4 v15, s[12:15], s72 offen nt lds
 ds_read_b64_tr_b16 a[232:233], v10 offset:40960
 ds_read_b64_tr_b16 a[234:235], v10 offset:41984
 ds_read_b64_tr_b16 a[236:237], v10 offset:45056
 ds_read_b64_tr_b16 a[238:239], v10 offset:46080
 ds_read_b64_tr_b16 a[240:241], v10 offset:49152
 ds_read_b64_tr_b16 a[242:243], v10 offset:50176
 ds_read_b64_tr_b16 a[244:245], v10 offset:53248
 ds_read_b64_tr_b16 a[246:247], v10 offset:54272
 s_waitcnt lgkmcnt(0)
 s_waitcnt vmcnt(25)
 s_barrier
 s_add_u32 s72, s70, 74240
 s_add_u32 m0, s73, 98304
 s_nop 0
 buffer_load_dwordx4 v16, s[20:23], s72 offen nt lds
 s_add_u32 s72, s70, 76544
 s_add_u32 m0, s73, 99328
 s_nop 0
 buffer_load_dwordx4 v16, s[20:23], s72 offen nt lds
 s_add_u32 s72, s70, 768
 s_add_u32 m0, s73, 106496
 s_nop 0
 buffer_load_dwordx4 v16, s[20:23], s72 offen nt lds
 s_add_u32 s72, s70, 3072
 s_add_u32 m0, s73, 107520
 s_nop 0
 buffer_load_dwordx4 v16, s[20:23], s72 offen nt lds
 ds_read_b64_tr_b16 a[248:249], v11 offset:0
 ds_read_b64_tr_b16 a[250:251], v11 offset:1024
 ds_read_b64_tr_b16 a[252:253], v11 offset:4096
 ds_read_b64_tr_b16 a[254:255], v11 offset:5120
 s_waitcnt lgkmcnt(0)
 s_waitcnt vmcnt(25)
 s_barrier
 s_add_u32 s72, s70, 74496
 s_add_u32 m0, s73, 114688
 s_nop 0
 buffer_load_dwordx4 v16, s[20:23], s72 offen nt lds
 s_add_u32 s72, s70, 76800
 s_add_u32 m0, s73, 115712
 s_nop 0
 buffer_load_dwordx4 v16, s[20:23], s72 offen nt lds
 s_waitcnt lgkmcnt(0)
 ds_read_b64_tr_b16 v[24:25], v18 offset:0
 ds_read_b64_tr_b16 v[26:27], v18 offset:1024
 ds_read_b64_tr_b16 v[28:29], v18 offset:4096
 ds_read_b64_tr_b16 v[30:31], v18 offset:5120
 ds_read_b64_tr_b16 v[32:33], v18 offset:8192
 ds_read_b64_tr_b16 v[34:35], v18 offset:9216
 ds_read_b64_tr_b16 v[36:37], v18 offset:12288
 ds_read_b64_tr_b16 v[38:39], v18 offset:13312
 s_waitcnt lgkmcnt(0)
 s_waitcnt vmcnt(23)
 s_barrier
 ds_write_b128 v3, v[24:27] offset:0
 ds_write_b128 v3, v[28:31] offset:1024
 ds_write_b128 v3, v[32:35] offset:8192
 ds_write_b128 v3, v[36:39] offset:9216
 s_waitcnt lgkmcnt(0)
 ds_read_b64_tr_b16 v[24:25], v18 offset:16384
 ds_read_b64_tr_b16 v[26:27], v18 offset:17408
 ds_read_b64_tr_b16 v[28:29], v18 offset:20480
 ds_read_b64_tr_b16 v[30:31], v18 offset:21504
 ds_read_b64_tr_b16 v[32:33], v18 offset:24576
 ds_read_b64_tr_b16 v[34:35], v18 offset:25600
 ds_read_b64_tr_b16 v[36:37], v18 offset:28672
 ds_read_b64_tr_b16 v[38:39], v18 offset:29696
 s_waitcnt lgkmcnt(0)
 s_waitcnt vmcnt(19)
 s_barrier
 ds_write_b128 v3, v[24:27] offset:16384
 ds_write_b128 v3, v[28:31] offset:17408
 ds_write_b128 v3, v[32:35] offset:24576
 ds_write_b128 v3, v[36:39] offset:25600
 s_waitcnt lgkmcnt(0)
 ds_read_b64_tr_b16 v[24:25], v18 offset:32768
 ds_read_b64_tr_b16 v[26:27], v18 offset:33792
 ds_read_b64_tr_b16 v[28:29], v18 offset:36864
 ds_read_b64_tr_b16 v[30:31], v18 offset:37888
 ds_read_b64_tr_b16 v[32:33], v18 offset:40960
 ds_read_b64_tr_b16 v[34:35], v18 offset:41984
 ds_read_b64_tr_b16 v[36:37], v18 offset:45056
 ds_read_b64_tr_b16 v[38:39], v18 offset:46080
 s_waitcnt lgkmcnt(0)
 s_waitcnt vmcnt(15)
 s_barrier
 ds_write_b128 v3, v[24:27] offset:32768
 ds_write_b128 v3, v[28:31] offset:33792
 ds_write_b128 v3, v[32:35] offset:40960
 ds_write_b128 v3, v[36:39] offset:41984
 s_waitcnt lgkmcnt(0)
 ds_read_b64_tr_b16 v[24:25], v18 offset:49152
 ds_read_b64_tr_b16 v[26:27], v18 offset:50176
 ds_read_b64_tr_b16 v[28:29], v18 offset:53248
 ds_read_b64_tr_b16 v[30:31], v18 offset:54272
 ds_read_b64_tr_b16 v[32:33], v10 offset:0
 ds_read_b64_tr_b16 v[34:35], v10 offset:1024
 ds_read_b64_tr_b16 v[36:37], v10 offset:4096
 ds_read_b64_tr_b16 v[38:39], v10 offset:5120
 s_waitcnt lgkmcnt(0)
 s_waitcnt vmcnt(10)
 v_cmp_gt_u32 vcc, 0x180, v43
 s_cbranch_vccz L_ready_13
 s_mov_b32 s100, 1
 v_and_b32 v42, 0xf0, v0
 v_min_u32 v42, 16, v42
 v_lshlrev_b32 v42, 3, v42
 s_mov_b32 s72, 65015808
 s_mov_b32 s3, 0
L_kvw_14:
 buffer_load_dword v43, v42, s[4:7], s72 offen sc1
 s_add_u32 s3, s3, 1
 s_cmp_gt_u32 s3, 200000
 s_cbranch_scc1 L_exit
 s_waitcnt vmcnt(0)
 v_cmp_gt_u32 vcc, 0x180, v43
 s_cbranch_vccnz L_kvw_14
L_ready_13:
 s_barrier
 ds_write_b128 v3, v[24:27] offset:49152
 ds_write_b128 v3, v[28:31] offset:50176
 ds_write_b128 v12, v[32:35] offset:0
 ds_write_b128 v12, v[36:39] offset:1024
 v_bfe_u32 v71, v0, 8, 2
 v_and_b32 v70, 0x70, v0
 v_lshl_add_u32 v70, v71, 9, v70
 v_and_b32 v71, 0x80, v0
 v_lshl_add_u32 v70, v71, 1, v70
 s_lshl_b32 s3, s46, 11
 s_add_u32 m0, s3, 15744
 s_add_u32 s72, s3, 0
 s_add_u32 s72, s72, s52
 buffer_load_dwordx4 v70, s[4:7], s72 offen sc1 lds
 s_add_u32 m0, s3, 16768
 s_add_u32 s72, s3, 128
 s_add_u32 s72, s72, s52
 buffer_load_dwordx4 v70, s[4:7], s72 offen sc1 lds
 v_lshlrev_b32 v66, 2, v0
 s_add_u32 s72, s52, s68
 s_mov_b32 m0, 23936
 s_nop 0
 buffer_load_dword v66, s[4:7], s72 offen sc1 lds
 s_add_u32 s74, s52, 262144
 s_add_u32 s72, s74, s68
 s_mov_b32 m0, 23936
 s_nop 0
 buffer_load_dword v66, s[4:7], s72 offen sc1 lds
 s_waitcnt lgkmcnt(0)
 ds_read_b64_tr_b16 v[24:25], v10 offset:8192
 ds_read_b64_tr_b16 v[26:27], v10 offset:9216
 ds_read_b64_tr_b16 v[28:29], v10 offset:12288
 ds_read_b64_tr_b16 v[30:31], v10 offset:13312
 ds_read_b64_tr_b16 v[32:33], v10 offset:16384
 ds_read_b64_tr_b16 v[34:35], v10 offset:17408
 ds_read_b64_tr_b16 v[36:37], v10 offset:20480
 ds_read_b64_tr_b16 v[38:39], v10 offset:21504
 s_waitcnt lgkmcnt(0)
 s_waitcnt vmcnt(10)
 s_barrier
 ds_write_b128 v12, v[24:27] offset:8192
 ds_write_b128 v12, v[28:31] offset:9216
 ds_write_b128 v12, v[32:35] offset:16384
 ds_write_b128 v12, v[36:39] offset:17408
 s_waitcnt lgkmcnt(0)
 ds_read_b64_tr_b16 v[24:25], v10 offset:24576
 ds_read_b64_tr_b16 v[26:27], v10 offset:25600
 ds_read_b64_tr_b16 v[28:29], v10 offset:28672
 ds_read_b64_tr_b16 v[30:31], v10 offset:29696
 ds_read_b64_tr_b16 v[32:33], v10 offset:32768
 ds_read_b64_tr_b16 v[34:35], v10 offset:33792
 ds_read_b64_tr_b16 v[36:37], v10 offset:36864
 ds_read_b64_tr_b16 v[38:39], v10 offset:37888
 s_waitcnt lgkmcnt(0)
 s_waitcnt vmcnt(6)
 s_barrier
 ds_write_b128 v12, v[24:27] offset:24576
 ds_write_b128 v12, v[28:31] offset:25600
 ds_write_b128 v12, v[32:35] offset:32768
 ds_write_b128 v12, v[36:39] offset:33792
 s_waitcnt lgkmcnt(0)
 ds_read_b64_tr_b16 v[24:25], v10 offset:40960
 ds_read_b64_tr_b16 v[26:27], v10 offset:41984
 ds_read_b64_tr_b16 v[28:29], v10 offset:45056
 ds_read_b64_tr_b16 v[30:31], v10 offset:46080
 ds_read_b64_tr_b16 v[32:33], v10 offset:49152
 ds_read_b64_tr_b16 v[34:35], v10 offset:50176
 ds_read_b64_tr_b16 v[36:37], v10 offset:53248
 ds_read_b64_tr_b16 v[38:39], v10 offset:54272
 s_waitcnt lgkmcnt(0)
 s_waitcnt vmcnt(4)
 s_barrier
 ds_write_b128 v12, v[24:27] offset:40960
 ds_write_b128 v12, v[28:31] offset:41984
 ds_write_b128 v12, v[32:35] offset:49152
 ds_write_b128 v12, v[36:39] offset:50176
 s_waitcnt lgkmcnt(0)
 ds_read_b64_tr_b16 v[24:25], v11 offset:0
 ds_read_b64_tr_b16 v[26:27], v11 offset:1024
 ds_read_b64_tr_b16 v[28:29], v11 offset:4096
 ds_read_b64_tr_b16 v[30:31], v11 offset:5120
 s_waitcnt lgkmcnt(0)
 s_barrier
 ds_write_b128 v13, v[24:27] offset:0
 ds_write_b128 v13, v[28:31] offset:1024
 s_waitcnt lgkmcnt(0)
 s_cmp_eq_u32 s79, 1
 s_cbranch_scc1 L_chain_far
 s_cmp_eq_u32 s49, 0
 s_cbranch_scc1 L_chain_far
 s_mov_b32 s50, 0
 s_mov_b32 s51, 0
 s_mov_b32 s64, -1
 s_mov_b32 s30, 268501264
 s_mov_b32 s31, 0
 s_mov_b64 s[28:29], 0
 s_cmp_eq_u32 s46, 1
 s_cbranch_scc1 L_wave1_16
 s_cmp_eq_u32 s46, 2
 s_cbranch_scc1 L_wave2_17
 s_cmp_eq_u32 s46, 3
 s_cbranch_scc1 L_wave3_18
L_wave0_15:
 v_mov_b64 v[42:43], 0
 v_mov_b64 v[44:45], 0
 v_mov_b64 v[46:47], 0
 v_mov_b64 v[48:49], 0
 v_mov_b64 v[50:51], 0
 v_mov_b64 v[52:53], 0
 v_and_b32 v70, 0xf0, v0
 v_bfe_u32 v71, v0, 8, 2
 v_lshl_add_u32 v71, v71, 9, s67
 v_add_u32 v70, v70, v71
 v_add_u32 v9, 57344, v3
 ds_read_b128 v[26:29], v3 offset:0
 ds_read_b128 v[30:33], v3 offset:1024
 ds_read_b128 v[62:65], v3 offset:8192
 ds_read_b128 v[66:69], v3 offset:9216
 ds_read_b128 v[34:37], v3 offset:16384
 ds_read_b128 v[38:41], v3 offset:17408
 .p2align 6
L_loop_19:
 s_waitcnt lgkmcnt(0)
 s_barrier
 s_mov_b32 s51, 0
 ds_read_b128 v[10:13], v4 offset:0
 ds_read_b128 v[14:17], v4 offset:512
 s_waitcnt vmcnt(2)
 ds_read_b128 v[18:21], v4 offset:1024
 s_add_u32 s72, s52, 16777216
 buffer_load_dwordx4 v[54:57], v70, s[4:7], s72 offen sc1
 buffer_load_dwordx4 v[58:61], v70, s[4:7], s72 offen offset:256 sc1
 s_waitcnt lgkmcnt(2)
 v_smfmac_f32_16x16x64_bf16 v[50:53], v[10:13], a[8:15], v1
 v_lshlrev_b32 v71, 2, v0
 v_smfmac_f32_16x16x64_bf16 v[42:45], v[10:13], v[72:79], v1
 ds_read_b128 v[22:25], v4 offset:1536
 v_bfe_u32 v70, v0, 5, 1
 v_smfmac_f32_16x16x64_bf16 v[46:49], v[10:13], v[80:87], v1
 v_mul_i32_i24 v70, -1920, v70
 s_waitcnt lgkmcnt(2)
 v_smfmac_f32_16x16x64_bf16 v[50:53], v[14:17], a[16:23], v1
 v_add_u32 v70, v70, v6
 v_smfmac_f32_16x16x64_bf16 v[42:45], v[14:17], v[88:95], v1
 ds_read_b128 v[10:13], v4 offset:2048
 v_smfmac_f32_16x16x64_bf16 v[46:49], v[14:17], v[26:33], v1
 ds_read_b128 v[26:29], v3 offset:24576
 s_add_u32 s73, s52, 524288
 s_min_u32 s73, s73, 16515072
 s_add_u32 s73, s73, s68
 s_waitcnt lgkmcnt(3)
 v_smfmac_f32_16x16x64_bf16 v[50:53], v[18:21], a[24:31], v1
 ds_read_b128 v[30:33], v3 offset:25600
 v_smfmac_f32_16x16x64_bf16 v[42:45], v[18:21], v[96:103], v1
 ds_read_b128 v[14:17], v4 offset:2560
 s_mov_b32 m0, 23936
 s_nop 0
 buffer_load_dword v71, s[4:7], s73 offen sc1 lds
 v_smfmac_f32_16x16x64_bf16 v[46:49], v[18:21], v[62:69], v1
 s_waitcnt vmcnt(3)
 s_waitcnt lgkmcnt(4)
 v_smfmac_f32_16x16x64_bf16 v[50:53], v[22:25], a[32:39], v1
 ds_read_b64_tr_b16 v[62:63], v70 offset:2176
 ds_read_b64_tr_b16 v[64:65], v70 offset:2240
 v_smfmac_f32_16x16x64_bf16 v[42:45], v[22:25], v[104:111], v1
 ds_read_b128 v[18:21], v4 offset:3072
 v_smfmac_f32_16x16x64_bf16 v[46:49], v[22:25], v[34:41], v1
 ds_read_b128 v[34:37], v3 offset:32768
 s_waitcnt lgkmcnt(7)
 v_smfmac_f32_16x16x64_bf16 v[50:53], v[10:13], a[40:47], v1
 ds_read_b128 v[38:41], v3 offset:33792
 ds_read_b64_tr_b16 v[66:67], v70 offset:2688
 ds_read_b64_tr_b16 v[68:69], v70 offset:2752
 v_smfmac_f32_16x16x64_bf16 v[42:45], v[10:13], v[112:119], v1
 ds_read_b128 v[22:25], v4 offset:3584
 s_waitcnt lgkmcnt(9)
 v_smfmac_f32_16x16x64_bf16 v[46:49], v[10:13], v[26:33], v1
 ds_read_b128 v[26:29], v3 offset:40960
 s_waitcnt lgkmcnt(9)
 v_smfmac_f32_16x16x64_bf16 v[50:53], v[14:17], a[48:55], v1
 ds_read_b128 v[30:33], v3 offset:41984
 v_smfmac_f32_16x16x64_bf16 v[42:45], v[14:17], v[120:127], v1
 v_smfmac_f32_16x16x64_bf16 v[46:49], v[14:17], v[128:135], v1
 s_waitcnt lgkmcnt(7)
 v_smfmac_f32_16x16x64_bf16 v[50:53], v[18:21], a[56:63], v1
 s_waitcnt lgkmcnt(3)
 s_barrier
 v_smfmac_f32_16x16x64_bf16 v[42:45], v[18:21], v[136:143], v1
 ds_read_b128 v[10:13], v4 offset:4096
 ds_read_b128 v[14:17], v4 offset:4608
 v_smfmac_f32_16x16x64_bf16 v[46:49], v[18:21], v[34:41], v1
 ds_read_b128 v[34:37], v3 offset:49152
 s_waitcnt lgkmcnt(5)
 v_smfmac_f32_16x16x64_bf16 v[50:53], v[22:25], a[64:71], v1
 ds_read_b128 v[38:41], v3 offset:50176
 v_smfmac_f32_16x16x64_bf16 v[42:45], v[22:25], v[144:151], v1
 ds_read_b128 v[18:21], v4 offset:5120
 buffer_store_dwordx4 v[62:65], v0, s[4:7], s65 offen offset:0 sc1
 s_waitcnt lgkmcnt(5)
 v_smfmac_f32_16x16x64_bf16 v[46:49], v[22:25], v[26:33], v1
 ds_read_b128 v[26:29], v9 offset:0
 s_waitcnt lgkmcnt(5)
 v_smfmac_f32_16x16x64_bf16 v[50:53], v[10:13], a[72:79], v1
 ds_read_b128 v[30:33], v9 offset:1024
 v_smfmac_f32_16x16x64_bf16 v[42:45], v[10:13], v[152:159], v1
 ds_read_b128 v[22:25], v4 offset:5632
 v_smfmac_f32_16x16x64_bf16 v[46:49], v[10:13], v[160:167], v1
 s_waitcnt lgkmcnt(6)
 v_smfmac_f32_16x16x64_bf16 v[50:53], v[14:17], a[80:87], v1
 v_smfmac_f32_16x16x64_bf16 v[42:45], v[14:17], v[168:175], v1
 ds_read_b128 v[10:13], v4 offset:6144
 buffer_store_dwordx4 v[66:69], v0, s[4:7], s65 offen offset:1024 sc1
 s_waitcnt lgkmcnt(5)
 v_smfmac_f32_16x16x64_bf16 v[46:49], v[14:17], v[34:41], v1
 ds_read_b128 v[34:37], v9 offset:8192
 s_waitcnt lgkmcnt(5)
 v_smfmac_f32_16x16x64_bf16 v[50:53], v[18:21], a[88:95], v1
 ds_read_b128 v[38:41], v9 offset:9216
 v_smfmac_f32_16x16x64_bf16 v[42:45], v[18:21], v[176:183], v1
 ds_read_b128 v[14:17], v4 offset:6656
 s_waitcnt lgkmcnt(5)
 v_smfmac_f32_16x16x64_bf16 v[46:49], v[18:21], v[26:33], v1
 ds_read_b128 v[26:29], v9 offset:16384
 s_waitcnt lgkmcnt(5)
 v_smfmac_f32_16x16x64_bf16 v[50:53], v[22:25], a[96:103], v1
 ds_read_b128 v[30:33], v9 offset:17408
 v_smfmac_f32_16x16x64_bf16 v[42:45], v[22:25], v[184:191], v1
 ds_read_b128 v[18:21], v4 offset:7168
 v_smfmac_f32_16x16x64_bf16 v[46:49], v[22:25], v[192:199], v1
 ds_read_b128 v[62:65], v9 offset:24576
 s_waitcnt lgkmcnt(7)
 v_smfmac_f32_16x16x64_bf16 v[42:45], v[10:13], v[200:207], v1
 ds_read_b128 v[66:69], v9 offset:25600
 ds_read_b128 v[22:25], v4 offset:7680
 s_bitcmp1_b64 s[30:31], s50
 s_cbranch_scc1 L_kvs_21
L_kvsb_22:
 s_waitcnt lgkmcnt(7)
 v_smfmac_f32_16x16x64_bf16 v[46:49], v[10:13], v[34:41], v1
 ds_read_b128 v[34:37], v9 offset:32768
 s_waitcnt lgkmcnt(7)
 v_smfmac_f32_16x16x64_bf16 v[42:45], v[14:17], v[208:215], v1
 ds_read_b128 v[38:41], v9 offset:33792
 ds_read_b128 v[10:13], v4 offset:8192
 s_waitcnt lgkmcnt(7)
 v_smfmac_f32_16x16x64_bf16 v[46:49], v[14:17], v[26:33], v1
 s_waitcnt lgkmcnt(6)
 v_smfmac_f32_16x16x64_bf16 v[42:45], v[18:21], v[216:223], v1
 ds_read_b128 v[14:17], v4 offset:8704
 s_waitcnt lgkmcnt(5)
 v_smfmac_f32_16x16x64_bf16 v[46:49], v[18:21], v[62:69], v1
 s_waitcnt lgkmcnt(4)
 v_smfmac_f32_16x16x64_bf16 v[42:45], v[22:25], v[224:231], v1
 ds_read_b128 v[18:21], v4 offset:6144
 s_waitcnt lgkmcnt(3)
 v_smfmac_f32_16x16x64_bf16 v[46:49], v[22:25], v[34:41], v1
 s_waitcnt lgkmcnt(2)
 v_smfmac_f32_16x16x64_bf16 v[42:45], v[10:13], v[232:239], v1
 ds_read_b128 v[22:25], v4 offset:6656
 v_smfmac_f32_16x16x64_bf16 v[46:49], v[10:13], v[240:247], v1
 ds_read_b128 v[26:29], v0 offset:15744
 ds_read_b128 v[30:33], v0 offset:17792
 s_waitcnt lgkmcnt(4)
 v_smfmac_f32_16x16x64_bf16 v[42:45], v[14:17], v[248:255], v1
 ds_read_b128 v[10:13], v4 offset:7168
 v_smfmac_f32_16x16x64_bf16 v[46:49], v[14:17], a[0:7], v1
 ds_read_b128 v[34:37], v0 offset:19840
 ds_read_b128 v[38:41], v0 offset:21888
 ds_read_b128 v[14:17], v4 offset:7680
 s_waitcnt lgkmcnt(7)
 v_smfmac_f32_16x16x64_bf16 v[50:53], v[18:21], a[104:111], v1
 s_nop 1
 s_waitcnt lgkmcnt(6)
 v_smfmac_f32_16x16x64_bf16 v[50:53], v[22:25], a[112:119], v1
 s_nop 2
 v_cvt_pk_bf16_f32 v62, v42, v43
 v_cvt_pk_bf16_f32 v63, v44, v45
 ds_write_b64 v5, v[62:63]
 v_cvt_pk_bf16_f32 v64, v46, v47
 v_cvt_pk_bf16_f32 v65, v48, v49
 ds_write_b64 v5, v[64:65] offset:2176
 ds_read_b128 v[42:45], v4 offset:8192
 ds_read_b128 v[46:49], v4 offset:8704
 s_waitcnt lgkmcnt(7)
 v_smfmac_f32_16x16x64_bf16 v[50:53], v[10:13], a[120:127], v1
 s_waitcnt lgkmcnt(4)
 v_smfmac_f32_16x16x64_bf16 v[50:53], v[14:17], a[128:135], v1
 s_waitcnt lgkmcnt(2)
 s_barrier
 ds_read_b64_tr_b16 v[10:11], v6 offset:0
 ds_read_b64_tr_b16 v[12:13], v6 offset:64
 ds_read_b64_tr_b16 v[14:15], v6 offset:256
 ds_read_b64_tr_b16 v[16:17], v6 offset:320
 s_waitcnt lgkmcnt(5)
 v_smfmac_f32_16x16x64_bf16 v[50:53], v[42:45], a[136:143], v1
 ds_read_b64_tr_b16 v[18:19], v6 offset:512
 ds_read_b64_tr_b16 v[20:21], v6 offset:576
 ds_read_b64_tr_b16 v[22:23], v6 offset:768
 ds_read_b64_tr_b16 v[24:25], v6 offset:832
 s_waitcnt lgkmcnt(8)
 v_smfmac_f32_16x16x64_bf16 v[50:53], v[46:49], a[144:151], v1
 s_waitcnt lgkmcnt(6)
 v_mfma_f32_16x16x32_bf16 v[42:45], v[26:29], v[10:13], 0
 ds_read_b128 v[26:29], v0 offset:16768
 v_mov_b32 v62, v2
 v_mov_b32 v63, v2
 s_waitcnt lgkmcnt(5)
 v_mfma_f32_16x16x32_bf16 v[42:45], v[30:33], v[14:17], v[42:45]
 ds_read_b128 v[30:33], v0 offset:18816
 v_mov_b32 v64, v2
 v_mov_b32 v65, v2
 s_waitcnt lgkmcnt(4)
 v_mfma_f32_16x16x32_bf16 v[42:45], v[34:37], v[18:21], v[42:45]
 ds_read_b128 v[34:37], v0 offset:20864
 s_waitcnt lgkmcnt(3)
 v_mfma_f32_16x16x32_bf16 v[42:45], v[38:41], v[22:25], v[42:45]
 ds_read_b128 v[38:41], v0 offset:22912
 v_mfma_f32_16x16x32_bf16 v[62:65], v[10:13], v[10:13], v[62:65]
 v_cvt_pk_bf16_f32 v68, v50, v51
 v_cvt_pk_bf16_f32 v69, v52, v53
 v_mfma_f32_16x16x32_bf16 v[62:65], v[14:17], v[14:17], v[62:65]
 ds_write_b64 v5, v[68:69] offset:4352
 v_mov_b64 v[66:67], v[68:69]
 v_mfma_f32_16x16x32_bf16 v[62:65], v[18:21], v[18:21], v[62:65]
 s_nop 0
 v_mul_f32 v42, s62, v42
 v_mul_f32 v43, s62, v43
 v_mfma_f32_16x16x32_bf16 v[62:65], v[22:25], v[22:25], v[62:65]
 v_permlane32_swap_b32 v66, v68
 v_permlane32_swap_b32 v67, v69
 s_waitcnt lgkmcnt(4)
 v_mfma_f32_16x16x32_bf16 v[46:49], v[26:29], v[10:13], 0
 v_mul_f32 v44, s62, v44
 v_mul_f32 v45, s62, v45
 s_waitcnt lgkmcnt(3)
 v_mfma_f32_16x16x32_bf16 v[46:49], v[30:33], v[14:17], v[46:49]
 v_max3_f32 v70, v42, v43, v44
 s_nop 0
 s_waitcnt lgkmcnt(2)
 v_mfma_f32_16x16x32_bf16 v[46:49], v[34:37], v[18:21], v[46:49]
 v_mul_f32 v62, s62, v62
 v_mul_f32 v63, s62, v63
 s_waitcnt lgkmcnt(1)
 v_mfma_f32_16x16x32_bf16 v[46:49], v[38:41], v[22:25], v[46:49]
 v_mul_f32 v64, s62, v64
 v_mul_f32 v65, s62, v65
 v_max3_f32 v70, v70, v45, v62
 v_max3_f32 v71, v63, v64, v65
 v_mov_b64 v[30:31], 0
 v_mov_b64 v[34:35], 0
 v_mov_b64 v[22:23], s[76:77]
 v_mov_b64 v[24:25], s[76:77]
 v_pk_mul_f32 v[46:47], v[46:47], s[62:63]
 v_pk_mul_f32 v[48:49], v[48:49], s[62:63]
 v_max3_f32 v70, v70, v71, v46
 v_max3_f32 v71, v47, v48, v49
 v_max_f32 v21, v70, v71
 v_max_f32 v70, v70, v71
 s_nop 1
 v_permlane16_swap_b32 v70, v21
 v_max_f32 v71, v70, v21
 v_max_f32 v70, v70, v21
 s_nop 1
 v_permlane32_swap_b32 v70, v71
 v_max_f32 v70, v70, v71
 v_pk_add_f32 v[42:43], v[42:43], v[70:71] op_sel_hi:[1,0] neg_lo:[0,1] neg_hi:[0,1]
 v_pk_add_f32 v[44:45], v[44:45], v[70:71] op_sel_hi:[1,0] neg_lo:[0,1] neg_hi:[0,1]
 v_pk_add_f32 v[46:47], v[46:47], v[70:71] op_sel_hi:[1,0] neg_lo:[0,1] neg_hi:[0,1]
 v_pk_add_f32 v[48:49], v[48:49], v[70:71] op_sel_hi:[1,0] neg_lo:[0,1] neg_hi:[0,1]
 v_pk_add_f32 v[62:63], v[62:63], v[70:71] op_sel_hi:[1,0] neg_lo:[0,1] neg_hi:[0,1]
 v_pk_add_f32 v[64:65], v[64:65], v[70:71] op_sel_hi:[1,0] neg_lo:[0,1] neg_hi:[0,1]
 v_exp_f32 v42, v42
 v_exp_f32 v43, v43
 v_exp_f32 v44, v44
 v_exp_f32 v45, v45
 v_exp_f32 v46, v46
 v_exp_f32 v47, v47
 v_exp_f32 v48, v48
 v_exp_f32 v49, v49
 v_exp_f32 v62, v62
 v_cvt_pk_bf16_f32 v26, v42, v43
 v_cvt_pk_bf16_f32 v27, v44, v45
 v_cvt_pk_bf16_f32 v28, v46, v47
 v_cvt_pk_bf16_f32 v29, v48, v49
 v_exp_f32 v63, v63
 s_waitcnt vmcnt(3)
 v_mfma_f32_16x16x32_bf16 v[10:13], v[22:25], v[26:29], 0
 v_exp_f32 v64, v64
 v_mfma_f32_16x16x32_bf16 v[14:17], v[54:57], v[26:29], 0
 v_exp_f32 v65, v65
 v_mfma_f32_16x16x32_bf16 v[36:39], v[58:61], v[26:29], 0
 v_cvt_pk_bf16_f32 v32, v62, v63
 v_cvt_pk_bf16_f32 v33, v64, v65
 s_nop 1
 v_mfma_f32_16x16x32_bf16 v[10:13], v[22:25], v[32:35], v[10:13]
 v_mfma_f32_16x16x32_bf16 v[14:17], v[66:69], v[32:35], v[14:17]
 v_mfma_f32_16x16x32_bf16 v[36:39], v[66:69], v[30:33], v[36:39]
 v_add_u32 v9, 98304, v3
 v_mov_b64 v[52:53], 0
 v_mov_b64 v[54:55], 0
 v_mov_b64 v[56:57], 0
 v_mov_b64 v[58:59], 0
 s_nop 0
 v_rcp_f32 v18, v10
 v_mov_b64 v[60:61], 0
 v_pk_mul_f32 v[14:15], v[14:15], v[18:19] op_sel_hi:[1,0]
 v_pk_mul_f32 v[16:17], v[16:17], v[18:19] op_sel_hi:[1,0]
 v_pk_mul_f32 v[36:37], v[36:37], v[18:19] op_sel_hi:[1,0]
 v_pk_mul_f32 v[38:39], v[38:39], v[18:19] op_sel_hi:[1,0]
 v_cvt_pk_bf16_f32 v22, v14, v15
 v_cvt_pk_bf16_f32 v23, v16, v17
 v_cvt_pk_bf16_f32 v24, v36, v37
 v_cvt_pk_bf16_f32 v25, v38, v39
 ds_write_b128 v7, v[22:25]
 s_add_u32 s50, s50, 1
 v_mov_b64 v[62:63], 0
 v_mov_b64 v[64:65], 0
 v_mov_b64 v[66:67], 0
 s_waitcnt lgkmcnt(0)
 s_barrier
 ds_read_b128 v[10:13], v4 offset:0
 ds_read_b128 v[14:17], v4 offset:512
 ds_read_b128 v[18:21], v4 offset:1024
 ds_read_b128 v[22:25], v4 offset:1536
 s_waitcnt lgkmcnt(3)
 v_smfmac_f32_16x16x64_bf16 v[52:55], v[10:13], a[152:159], v1
 s_waitcnt lgkmcnt(2)
 v_smfmac_f32_16x16x64_bf16 v[52:55], v[14:17], a[160:167], v1
 ds_read_b128 v[26:29], v9 offset:0
 ds_read_b128 v[30:33], v9 offset:1024
 s_waitcnt lgkmcnt(3)
 v_smfmac_f32_16x16x64_bf16 v[52:55], v[18:21], a[168:175], v1
 s_waitcnt lgkmcnt(2)
 v_smfmac_f32_16x16x64_bf16 v[52:55], v[22:25], a[176:183], v1
 ds_read_b128 v[34:37], v9 offset:8192
 ds_read_b128 v[38:41], v9 offset:9216
 v_smfmac_f32_16x16x64_bf16 v[56:59], v[10:13], a[184:191], v1
 s_nop 2
 v_smfmac_f32_16x16x64_bf16 v[56:59], v[14:17], a[192:199], v1
 ds_read_b128 v[42:45], v9 offset:16384
 ds_read_b128 v[46:49], v9 offset:17408
 s_nop 0
 v_smfmac_f32_16x16x64_bf16 v[56:59], v[18:21], a[200:207], v1
 v_cvt_pk_bf16_f32 v52, v52, v53
 v_smfmac_f32_16x16x64_bf16 v[56:59], v[22:25], a[208:215], v1
 v_cvt_pk_bf16_f32 v53, v54, v55
 v_smfmac_f32_16x16x64_bf16 v[60:63], v[10:13], a[216:223], v1
 s_nop 1
 v_and_b32 v52, -2, v52
 v_smfmac_f32_16x16x64_bf16 v[60:63], v[14:17], a[224:231], v1
 s_nop 2
 s_waitcnt lgkmcnt(4)
 v_smfmac_f32_16x16x64_bf16 v[60:63], v[18:21], v[26:33], v1
 v_cvt_pk_bf16_f32 v56, v56, v57
 v_smfmac_f32_16x16x64_bf16 v[60:63], v[22:25], a[232:239], v1
 buffer_store_dwordx2 v[52:53], v8, s[4:7], s55 offen
 v_cvt_pk_bf16_f32 v57, v58, v59
 s_waitcnt lgkmcnt(2)
 v_smfmac_f32_16x16x64_bf16 v[64:67], v[10:13], v[34:41], v1
 s_nop 1
 v_and_b32 v56, -2, v56
 v_smfmac_f32_16x16x64_bf16 v[64:67], v[14:17], a[240:247], v1
 s_nop 2
 s_waitcnt lgkmcnt(0)
 v_smfmac_f32_16x16x64_bf16 v[64:67], v[18:21], v[42:49], v1
 v_cvt_pk_bf16_f32 v60, v60, v61
 v_smfmac_f32_16x16x64_bf16 v[64:67], v[22:25], a[248:255], v1
 buffer_store_dwordx2 v[56:57], v8, s[4:7], s56 offen
 v_cvt_pk_bf16_f32 v61, v62, v63
 v_and_b32 v60, -2, v60
 buffer_store_dwordx2 v[60:61], v8, s[4:7], s57 offen
 s_add_u32 s52, s52, 262144
 s_add_u32 s65, s65, s27
 s_mov_b64 s[28:29], -1
 s_sub_i32 s64, s50, s71
 s_mov_b32 s27, 131072
 v_cvt_pk_bf16_f32 v64, v64, v65
 v_cvt_pk_bf16_f32 v65, v66, v67
 v_and_b32 v64, -2, v64
 buffer_store_dwordx2 v[64:65], v8, s[4:7], s58 offen
 s_barrier
 s_nop 15
 s_nop 15
 s_nop 7
 buffer_load_dwordx4 v[10:13], v0, s[4:7], s60 offen offset:0 sc1
 buffer_load_dwordx4 v[14:17], v0, s[4:7], s60 offen offset:1024 sc1
 buffer_load_dwordx4 v[18:21], v0, s[4:7], s60 offen offset:2048 sc1
 buffer_load_dwordx4 v[22:25], v0, s[4:7], s60 offen offset:3072 sc1
 v_and_b32 v34, 16, v0
 v_mov_b32 v30, 0x3f80
 v_lshlrev_b32 v30, v34, v30
 v_bfe_u32 v34, v0, 5, 3
 v_cmp_eq_u32 vcc, 0, v34
 s_nop 1
 v_cndmask_b32 v26, 0, v30, vcc
 v_cmp_eq_u32 vcc, 1, v34
 s_nop 1
 v_cndmask_b32 v27, 0, v30, vcc
 v_cmp_eq_u32 vcc, 2, v34
 s_nop 1
 v_cndmask_b32 v28, 0, v30, vcc
 v_cmp_eq_u32 vcc, 3, v34
 s_nop 1
 v_cndmask_b32 v29, 0, v30, vcc
 v_and_b32 v35, 0xf0, v0
 v_bfe_u32 v34, v0, 8, 2
 v_lshl_add_u32 v35, v34, 2, v35
 v_and_b32 v34, 0x80, v0
 v_lshl_add_u32 v35, v34, 23, v35
 v_mov_b64 v[42:43], 0
 v_mov_b64 v[44:45], 0
 v_mov_b64 v[46:47], 0
 v_mov_b64 v[48:49], 0
 v_mov_b64 v[50:51], 0
 v_mov_b64 v[52:53], 0
 v_and_b32 v70, 0xf0, v0
 v_bfe_u32 v71, v0, 8, 2
 v_lshl_add_u32 v71, v71, 9, s67
 v_add_u32 v70, v70, v71
 v_add_u32 v9, 57344, v3
 s_waitcnt vmcnt(3)
 v_mfma_f32_16x16x32_bf16 v[30:33], v[10:13], v[26:29], 0
 v_bitop3_b32 v34, v10, v12, v12 bitop3:0xfe
 s_waitcnt vmcnt(2)
 v_mfma_f32_16x16x32_bf16 v[30:33], v[14:17], v[26:29], v[30:33]
 v_bitop3_b32 v34, v34, v14, v16 bitop3:0xfe
 s_waitcnt vmcnt(1)
 v_mfma_f32_16x16x32_bf16 v[30:33], v[18:21], v[26:29], v[30:33]
 v_bitop3_b32 v34, v34, v18, v20 bitop3:0xfe
 s_waitcnt vmcnt(0)
 v_mfma_f32_16x16x32_bf16 v[30:33], v[22:25], v[26:29], v[30:33]
 v_bitop3_b32 v34, v34, v22, v24 bitop3:0xfe
 v_and_b32 v34, 1, v34
 v_cmp_ne_u32 vcc, 0, v34
 s_cbranch_vccnz L_rre_23
 s_nop 3
 v_permlane32_swap_b32 v30, v31
 v_permlane32_swap_b32 v32, v33
 v_add_f32 v30, v30, v31
 v_add_f32 v32, v32, v33
 v_cvt_pk_bf16_f32 v30, v30, v32
 v_and_b32 v30, -2, v30
 buffer_store_dword v30, v35, s[4:7], s61 offen
L_rback_24:
 s_barrier
 s_nop 15
 s_nop 11
 buffer_load_dwordx4 v[10:13], v0, s[4:7], s24 offen offset:0 sc1
 buffer_load_dwordx4 v[14:17], v0, s[4:7], s24 offen offset:1024 sc1
 ds_read_b128 v[26:29], v3 offset:0
 ds_read_b128 v[30:33], v3 offset:1024
 ds_read_b128 v[62:65], v3 offset:8192
 ds_read_b128 v[66:69], v3 offset:9216
 ds_read_b128 v[34:37], v3 offset:16384
 ds_read_b128 v[38:41], v3 offset:17408
 s_nop 15
 s_nop 3
 buffer_load_dwordx4 v[18:21], v0, s[4:7], s24 offen offset:0 sc1
 buffer_load_dwordx4 v[22:25], v0, s[4:7], s24 offen offset:1024 sc1
 s_nop 15
 s_nop 11
 buffer_load_dwordx4 v[54:57], v0, s[4:7], s24 offen offset:0 sc1
 buffer_load_dwordx4 v[58:61], v0, s[4:7], s24 offen offset:1024 sc1
 s_waitcnt vmcnt(5)
 v_bitop3_b32 v71, v10, v11, v12 bitop3:0xfe
 v_bitop3_b32 v71, v71, v13, v13 bitop3:0xfe
 s_waitcnt vmcnt(4)
 v_bitop3_b32 v71, v71, v14, v15 bitop3:0xfe
 v_bitop3_b32 v71, v71, v16, v17 bitop3:0xfe
 v_and_b32 v71, 1, v71
 v_cmp_ne_u32 vcc, 0, v71
 s_cbranch_vccnz L_ma_27
 ds_write_b128 v0, v[10:13] offset:0
 ds_write_b128 v0, v[14:17] offset:1024
 s_barrier
L_maok_25:
 s_cmp_eq_u32 s50, 63
 s_cbranch_scc1 L_last_20
 s_waitcnt lgkmcnt(0)
 s_barrier
 s_mov_b32 s51, 0
 ds_read_b128 v[10:13], v4 offset:0
 ds_read_b128 v[14:17], v4 offset:512
 s_waitcnt vmcnt(2)
 ds_read_b128 v[18:21], v4 offset:1024
 s_add_u32 s72, s52, 16777216
 buffer_load_dwordx4 v[54:57], v70, s[4:7], s72 offen sc1
 buffer_load_dwordx4 v[58:61], v70, s[4:7], s72 offen offset:256 sc1
 s_waitcnt lgkmcnt(2)
 v_smfmac_f32_16x16x64_bf16 v[50:53], v[10:13], a[8:15], v1
 v_lshlrev_b32 v71, 2, v0
 v_smfmac_f32_16x16x64_bf16 v[42:45], v[10:13], v[72:79], v1
 ds_read_b128 v[22:25], v4 offset:1536
 v_bfe_u32 v70, v0, 5, 1
 v_smfmac_f32_16x16x64_bf16 v[46:49], v[10:13], v[80:87], v1
 v_mul_i32_i24 v70, -1920, v70
 s_waitcnt lgkmcnt(2)
 v_smfmac_f32_16x16x64_bf16 v[50:53], v[14:17], a[16:23], v1
 v_add_u32 v70, v70, v6
 v_smfmac_f32_16x16x64_bf16 v[42:45], v[14:17], v[88:95], v1
 ds_read_b128 v[10:13], v4 offset:2048
 v_smfmac_f32_16x16x64_bf16 v[46:49], v[14:17], v[26:33], v1
 ds_read_b128 v[26:29], v3 offset:24576
 s_add_u32 s73, s52, 524288
 s_min_u32 s73, s73, 16515072
 s_add_u32 s73, s73, s68
 s_waitcnt lgkmcnt(3)
 v_smfmac_f32_16x16x64_bf16 v[50:53], v[18:21], a[24:31], v1
 ds_read_b128 v[30:33], v3 offset:25600
 v_smfmac_f32_16x16x64_bf16 v[42:45], v[18:21], v[96:103], v1
 ds_read_b128 v[14:17], v4 offset:2560
 s_mov_b32 m0, 23936
 s_nop 0
 buffer_load_dword v71, s[4:7], s73 offen sc1 lds
 v_smfmac_f32_16x16x64_bf16 v[46:49], v[18:21], v[62:69], v1
 s_waitcnt vmcnt(3)
 s_waitcnt lgkmcnt(4)
 v_smfmac_f32_16x16x64_bf16 v[50:53], v[22:25], a[32:39], v1
 ds_read_b64_tr_b16 v[62:63], v70 offset:2176
 ds_read_b64_tr_b16 v[64:65], v70 offset:2240
 v_smfmac_f32_16x16x64_bf16 v[42:45], v[22:25], v[104:111], v1
 ds_read_b128 v[18:21], v4 offset:3072
 v_smfmac_f32_16x16x64_bf16 v[46:49], v[22:25], v[34:41], v1
 ds_read_b128 v[34:37], v3 offset:32768
 s_waitcnt lgkmcnt(7)
 v_smfmac_f32_16x16x64_bf16 v[50:53], v[10:13], a[40:47], v1
 ds_read_b128 v[38:41], v3 offset:33792
 ds_read_b64_tr_b16 v[66:67], v70 offset:2688
 ds_read_b64_tr_b16 v[68:69], v70 offset:2752
 v_smfmac_f32_16x16x64_bf16 v[42:45], v[10:13], v[112:119], v1
 ds_read_b128 v[22:25], v4 offset:3584
 s_waitcnt lgkmcnt(9)
 v_smfmac_f32_16x16x64_bf16 v[46:49], v[10:13], v[26:33], v1
 ds_read_b128 v[26:29], v3 offset:40960
 s_waitcnt lgkmcnt(9)
 v_smfmac_f32_16x16x64_bf16 v[50:53], v[14:17], a[48:55], v1
 ds_read_b128 v[30:33], v3 offset:41984
 v_smfmac_f32_16x16x64_bf16 v[42:45], v[14:17], v[120:127], v1
 v_smfmac_f32_16x16x64_bf16 v[46:49], v[14:17], v[128:135], v1
 s_waitcnt lgkmcnt(7)
 v_smfmac_f32_16x16x64_bf16 v[50:53], v[18:21], a[56:63], v1
 s_waitcnt lgkmcnt(3)
 s_barrier
 v_smfmac_f32_16x16x64_bf16 v[42:45], v[18:21], v[136:143], v1
 ds_read_b128 v[10:13], v4 offset:4096
 ds_read_b128 v[14:17], v4 offset:4608
 v_smfmac_f32_16x16x64_bf16 v[46:49], v[18:21], v[34:41], v1
 ds_read_b128 v[34:37], v3 offset:49152
 s_waitcnt lgkmcnt(5)
 v_smfmac_f32_16x16x64_bf16 v[50:53], v[22:25], a[64:71], v1
 ds_read_b128 v[38:41], v3 offset:50176
 v_smfmac_f32_16x16x64_bf16 v[42:45], v[22:25], v[144:151], v1
 ds_read_b128 v[18:21], v4 offset:5120
 buffer_store_dwordx4 v[62:65], v0, s[4:7], s65 offen offset:0 sc1
 s_waitcnt lgkmcnt(5)
 v_smfmac_f32_16x16x64_bf16 v[46:49], v[22:25], v[26:33], v1
 ds_read_b128 v[26:29], v9 offset:0
 s_waitcnt lgkmcnt(5)
 v_smfmac_f32_16x16x64_bf16 v[50:53], v[10:13], a[72:79], v1
 ds_read_b128 v[30:33], v9 offset:1024
 v_smfmac_f32_16x16x64_bf16 v[42:45], v[10:13], v[152:159], v1
 ds_read_b128 v[22:25], v4 offset:5632
 v_smfmac_f32_16x16x64_bf16 v[46:49], v[10:13], v[160:167], v1
 s_waitcnt lgkmcnt(6)
 v_smfmac_f32_16x16x64_bf16 v[50:53], v[14:17], a[80:87], v1
 v_smfmac_f32_16x16x64_bf16 v[42:45], v[14:17], v[168:175], v1
 ds_read_b128 v[10:13], v4 offset:6144
 buffer_store_dwordx4 v[66:69], v0, s[4:7], s65 offen offset:1024 sc1
 s_waitcnt lgkmcnt(5)
 v_smfmac_f32_16x16x64_bf16 v[46:49], v[14:17], v[34:41], v1
 ds_read_b128 v[34:37], v9 offset:8192
 s_waitcnt lgkmcnt(5)
 v_smfmac_f32_16x16x64_bf16 v[50:53], v[18:21], a[88:95], v1
 ds_read_b128 v[38:41], v9 offset:9216
 v_smfmac_f32_16x16x64_bf16 v[42:45], v[18:21], v[176:183], v1
 ds_read_b128 v[14:17], v4 offset:6656
 s_waitcnt lgkmcnt(5)
 v_smfmac_f32_16x16x64_bf16 v[46:49], v[18:21], v[26:33], v1
 ds_read_b128 v[26:29], v9 offset:16384
 s_waitcnt lgkmcnt(5)
 v_smfmac_f32_16x16x64_bf16 v[50:53], v[22:25], a[96:103], v1
 ds_read_b128 v[30:33], v9 offset:17408
 v_smfmac_f32_16x16x64_bf16 v[42:45], v[22:25], v[184:191], v1
 ds_read_b128 v[18:21], v4 offset:7168
 v_smfmac_f32_16x16x64_bf16 v[46:49], v[22:25], v[192:199], v1
 ds_read_b128 v[62:65], v9 offset:24576
 s_waitcnt lgkmcnt(7)
 v_smfmac_f32_16x16x64_bf16 v[42:45], v[10:13], v[200:207], v1
 ds_read_b128 v[66:69], v9 offset:25600
 ds_read_b128 v[22:25], v4 offset:7680
 s_waitcnt lgkmcnt(7)
 v_smfmac_f32_16x16x64_bf16 v[46:49], v[10:13], v[34:41], v1
 ds_read_b128 v[34:37], v9 offset:32768
 s_waitcnt lgkmcnt(7)
 v_smfmac_f32_16x16x64_bf16 v[42:45], v[14:17], v[208:215], v1
 ds_read_b128 v[38:41], v9 offset:33792
 ds_read_b128 v[10:13], v4 offset:8192
 s_waitcnt lgkmcnt(7)
 v_smfmac_f32_16x16x64_bf16 v[46:49], v[14:17], v[26:33], v1
 s_waitcnt lgkmcnt(6)
 v_smfmac_f32_16x16x64_bf16 v[42:45], v[18:21], v[216:223], v1
 ds_read_b128 v[14:17], v4 offset:8704
 s_waitcnt lgkmcnt(5)
 v_smfmac_f32_16x16x64_bf16 v[46:49], v[18:21], v[62:69], v1
 s_waitcnt lgkmcnt(4)
 v_smfmac_f32_16x16x64_bf16 v[42:45], v[22:25], v[224:231], v1
 ds_read_b128 v[18:21], v4 offset:6144
 s_waitcnt lgkmcnt(3)
 v_smfmac_f32_16x16x64_bf16 v[46:49], v[22:25], v[34:41], v1
 s_waitcnt lgkmcnt(2)
 v_smfmac_f32_16x16x64_bf16 v[42:45], v[10:13], v[232:239], v1
 ds_read_b128 v[22:25], v4 offset:6656
 v_smfmac_f32_16x16x64_bf16 v[46:49], v[10:13], v[240:247], v1
 ds_read_b128 v[26:29], v0 offset:15744
 ds_read_b128 v[30:33], v0 offset:17792
 s_waitcnt lgkmcnt(4)
 v_smfmac_f32_16x16x64_bf16 v[42:45], v[14:17], v[248:255], v1
 ds_read_b128 v[10:13], v4 offset:7168
 v_smfmac_f32_16x16x64_bf16 v[46:49], v[14:17], a[0:7], v1
 ds_read_b128 v[34:37], v0 offset:19840
 ds_read_b128 v[38:41], v0 offset:21888
 ds_read_b128 v[14:17], v4 offset:7680
 s_waitcnt lgkmcnt(7)
 v_smfmac_f32_16x16x64_bf16 v[50:53], v[18:21], a[104:111], v1
 s_nop 1
 s_waitcnt lgkmcnt(6)
 v_smfmac_f32_16x16x64_bf16 v[50:53], v[22:25], a[112:119], v1
 s_nop 2
 v_cvt_pk_bf16_f32 v62, v42, v43
 v_cvt_pk_bf16_f32 v63, v44, v45
 ds_write_b64 v5, v[62:63]
 v_cvt_pk_bf16_f32 v64, v46, v47
 v_cvt_pk_bf16_f32 v65, v48, v49
 ds_write_b64 v5, v[64:65] offset:2176
 ds_read_b128 v[42:45], v4 offset:8192
 ds_read_b128 v[46:49], v4 offset:8704
 s_waitcnt lgkmcnt(7)
 v_smfmac_f32_16x16x64_bf16 v[50:53], v[10:13], a[120:127], v1
 s_waitcnt lgkmcnt(4)
 v_smfmac_f32_16x16x64_bf16 v[50:53], v[14:17], a[128:135], v1
 s_waitcnt lgkmcnt(2)
 s_barrier
 ds_read_b64_tr_b16 v[10:11], v6 offset:0
 ds_read_b64_tr_b16 v[12:13], v6 offset:64
 ds_read_b64_tr_b16 v[14:15], v6 offset:256
 ds_read_b64_tr_b16 v[16:17], v6 offset:320
 s_waitcnt lgkmcnt(5)
 v_smfmac_f32_16x16x64_bf16 v[50:53], v[42:45], a[136:143], v1
 ds_read_b64_tr_b16 v[18:19], v6 offset:512
 ds_read_b64_tr_b16 v[20:21], v6 offset:576
 ds_read_b64_tr_b16 v[22:23], v6 offset:768
 ds_read_b64_tr_b16 v[24:25], v6 offset:832
 s_waitcnt lgkmcnt(8)
 v_smfmac_f32_16x16x64_bf16 v[50:53], v[46:49], a[144:151], v1
 s_waitcnt lgkmcnt(6)
 v_mfma_f32_16x16x32_bf16 v[42:45], v[26:29], v[10:13], 0
 ds_read_b128 v[26:29], v0 offset:16768
 v_mov_b32 v62, v2
 v_mov_b32 v63, v2
 s_waitcnt lgkmcnt(5)
 v_mfma_f32_16x16x32_bf16 v[42:45], v[30:33], v[14:17], v[42:45]
 ds_read_b128 v[30:33], v0 offset:18816
 v_mov_b32 v64, v2
 v_mov_b32 v65, v2
 s_waitcnt lgkmcnt(4)
 v_mfma_f32_16x16x32_bf16 v[42:45], v[34:37], v[18:21], v[42:45]
 ds_read_b128 v[34:37], v0 offset:20864
 s_waitcnt lgkmcnt(3)
 v_mfma_f32_16x16x32_bf16 v[42:45], v[38:41], v[22:25], v[42:45]
 ds_read_b128 v[38:41], v0 offset:22912
 v_mfma_f32_16x16x32_bf16 v[62:65], v[10:13], v[10:13], v[62:65]
 v_cvt_pk_bf16_f32 v68, v50, v51
 v_cvt_pk_bf16_f32 v69, v52, v53
 v_mfma_f32_16x16x32_bf16 v[62:65], v[14:17], v[14:17], v[62:65]
 ds_write_b64 v5, v[68:69] offset:4352
 v_mov_b64 v[66:67], v[68:69]
 v_mfma_f32_16x16x32_bf16 v[62:65], v[18:21], v[18:21], v[62:65]
 s_nop 0
 v_mul_f32 v42, s62, v42
 v_mul_f32 v43, s62, v43
 v_mfma_f32_16x16x32_bf16 v[62:65], v[22:25], v[22:25], v[62:65]
 v_permlane32_swap_b32 v66, v68
 v_permlane32_swap_b32 v67, v69
 s_waitcnt lgkmcnt(4)
 v_mfma_f32_16x16x32_bf16 v[46:49], v[26:29], v[10:13], 0
 v_mul_f32 v44, s62, v44
 v_mul_f32 v45, s62, v45
 s_waitcnt lgkmcnt(3)
 v_mfma_f32_16x16x32_bf16 v[46:49], v[30:33], v[14:17], v[46:49]
 v_max3_f32 v70, v42, v43, v44
 s_nop 0
 s_waitcnt lgkmcnt(2)
 v_mfma_f32_16x16x32_bf16 v[46:49], v[34:37], v[18:21], v[46:49]
 v_mul_f32 v62, s62, v62
 v_mul_f32 v63, s62, v63
 s_waitcnt lgkmcnt(1)
 v_mfma_f32_16x16x32_bf16 v[46:49], v[38:41], v[22:25], v[46:49]
 v_mul_f32 v64, s62, v64
 v_mul_f32 v65, s62, v65
 v_max3_f32 v70, v70, v45, v62
 v_max3_f32 v71, v63, v64, v65
 v_mov_b64 v[30:31], 0
 v_mov_b64 v[34:35], 0
 v_mov_b64 v[22:23], s[76:77]
 v_mov_b64 v[24:25], s[76:77]
 v_pk_mul_f32 v[46:47], v[46:47], s[62:63]
 v_pk_mul_f32 v[48:49], v[48:49], s[62:63]
 v_max3_f32 v70, v70, v71, v46
 v_max3_f32 v71, v47, v48, v49
 v_max_f32 v21, v70, v71
 v_max_f32 v70, v70, v71
 s_nop 1
 v_permlane16_swap_b32 v70, v21
 v_max_f32 v71, v70, v21
 v_max_f32 v70, v70, v21
 s_nop 1
 v_permlane32_swap_b32 v70, v71
 v_max_f32 v70, v70, v71
 v_pk_add_f32 v[42:43], v[42:43], v[70:71] op_sel_hi:[1,0] neg_lo:[0,1] neg_hi:[0,1]
 v_pk_add_f32 v[44:45], v[44:45], v[70:71] op_sel_hi:[1,0] neg_lo:[0,1] neg_hi:[0,1]
 v_pk_add_f32 v[46:47], v[46:47], v[70:71] op_sel_hi:[1,0] neg_lo:[0,1] neg_hi:[0,1]
 v_pk_add_f32 v[48:49], v[48:49], v[70:71] op_sel_hi:[1,0] neg_lo:[0,1] neg_hi:[0,1]
 v_pk_add_f32 v[62:63], v[62:63], v[70:71] op_sel_hi:[1,0] neg_lo:[0,1] neg_hi:[0,1]
 v_pk_add_f32 v[64:65], v[64:65], v[70:71] op_sel_hi:[1,0] neg_lo:[0,1] neg_hi:[0,1]
 v_exp_f32 v42, v42
 v_exp_f32 v43, v43
 v_exp_f32 v44, v44
 v_exp_f32 v45, v45
 v_exp_f32 v46, v46
 v_exp_f32 v47, v47
 v_exp_f32 v48, v48
 v_exp_f32 v49, v49
 v_exp_f32 v62, v62
 v_cvt_pk_bf16_f32 v26, v42, v43
 v_cvt_pk_bf16_f32 v27, v44, v45
 v_cvt_pk_bf16_f32 v28, v46, v47
 v_cvt_pk_bf16_f32 v29, v48, v49
 v_exp_f32 v63, v63
 s_waitcnt vmcnt(3)
 v_mfma_f32_16x16x32_bf16 v[10:13], v[22:25], v[26:29], 0
 v_exp_f32 v64, v64
 v_mfma_f32_16x16x32_bf16 v[14:17], v[54:57], v[26:29], 0
 v_exp_f32 v65, v65
 v_mfma_f32_16x16x32_bf16 v[36:39], v[58:61], v[26:29], 0
 v_cvt_pk_bf16_f32 v32, v62, v63
 v_cvt_pk_bf16_f32 v33, v64, v65
 s_nop 1
 v_mfma_f32_16x16x32_bf16 v[10:13], v[22:25], v[32:35], v[10:13]
 v_mfma_f32_16x16x32_bf16 v[14:17], v[66:69], v[32:35], v[14:17]
 v_mfma_f32_16x16x32_bf16 v[36:39], v[66:69], v[30:33], v[36:39]
 v_add_u32 v9, 98304, v3
 v_mov_b64 v[52:53], 0
 v_mov_b64 v[54:55], 0
 v_mov_b64 v[56:57], 0
 v_mov_b64 v[58:59], 0
 s_nop 0
 v_rcp_f32 v18, v10
 v_mov_b64 v[60:61], 0
 v_pk_mul_f32 v[14:15], v[14:15], v[18:19] op_sel_hi:[1,0]
 v_pk_mul_f32 v[16:17], v[16:17], v[18:19] op_sel_hi:[1,0]
 v_pk_mul_f32 v[36:37], v[36:37], v[18:19] op_sel_hi:[1,0]
 v_pk_mul_f32 v[38:39], v[38:39], v[18:19] op_sel_hi:[1,0]
 v_cvt_pk_bf16_f32 v22, v14, v15
 v_cvt_pk_bf16_f32 v23, v16, v17
 v_cvt_pk_bf16_f32 v24, v36, v37
 v_cvt_pk_bf16_f32 v25, v38, v39
 ds_write_b128 v7, v[22:25]
 s_add_u32 s50, s50, 1
 v_mov_b64 v[62:63], 0
 v_mov_b64 v[64:65], 0
 v_mov_b64 v[66:67], 0
 s_waitcnt lgkmcnt(0)
 s_barrier
 ds_read_b128 v[10:13], v4 offset:0
 ds_read_b128 v[14:17], v4 offset:512
 ds_read_b128 v[18:21], v4 offset:1024
 ds_read_b128 v[22:25], v4 offset:1536
 s_waitcnt lgkmcnt(3)
 v_smfmac_f32_16x16x64_bf16 v[52:55], v[10:13], a[152:159], v1
 s_waitcnt lgkmcnt(2)
 v_smfmac_f32_16x16x64_bf16 v[52:55], v[14:17], a[160:167], v1
 ds_read_b128 v[26:29], v9 offset:0
 ds_read_b128 v[30:33], v9 offset:1024
 s_waitcnt lgkmcnt(3)
 v_smfmac_f32_16x16x64_bf16 v[52:55], v[18:21], a[168:175], v1
 s_waitcnt lgkmcnt(2)
 v_smfmac_f32_16x16x64_bf16 v[52:55], v[22:25], a[176:183], v1
 ds_read_b128 v[34:37], v9 offset:8192
 ds_read_b128 v[38:41], v9 offset:9216
 v_smfmac_f32_16x16x64_bf16 v[56:59], v[10:13], a[184:191], v1
 s_nop 2
 v_smfmac_f32_16x16x64_bf16 v[56:59], v[14:17], a[192:199], v1
 ds_read_b128 v[42:45], v9 offset:16384
 ds_read_b128 v[46:49], v9 offset:17408
 s_nop 0
 v_smfmac_f32_16x16x64_bf16 v[56:59], v[18:21], a[200:207], v1
 v_cvt_pk_bf16_f32 v52, v52, v53
 v_smfmac_f32_16x16x64_bf16 v[56:59], v[22:25], a[208:215], v1
 v_cvt_pk_bf16_f32 v53, v54, v55
 v_smfmac_f32_16x16x64_bf16 v[60:63], v[10:13], a[216:223], v1
 s_nop 1
 v_or_b32 v52, 1, v52
 v_smfmac_f32_16x16x64_bf16 v[60:63], v[14:17], a[224:231], v1
 s_nop 2
 s_waitcnt lgkmcnt(4)
 v_smfmac_f32_16x16x64_bf16 v[60:63], v[18:21], v[26:33], v1
 v_cvt_pk_bf16_f32 v56, v56, v57
 v_smfmac_f32_16x16x64_bf16 v[60:63], v[22:25], a[232:239], v1
 buffer_store_dwordx2 v[52:53], v8, s[4:7], s55 offen
 v_cvt_pk_bf16_f32 v57, v58, v59
 s_waitcnt lgkmcnt(2)
 v_smfmac_f32_16x16x64_bf16 v[64:67], v[10:13], v[34:41], v1
 s_nop 1
 v_or_b32 v56, 1, v56
 v_smfmac_f32_16x16x64_bf16 v[64:67], v[14:17], a[240:247], v1
 s_nop 2
 s_waitcnt lgkmcnt(0)
 v_smfmac_f32_16x16x64_bf16 v[64:67], v[18:21], v[42:49], v1
 v_cvt_pk_bf16_f32 v60, v60, v61
 v_smfmac_f32_16x16x64_bf16 v[64:67], v[22:25], a[248:255], v1
 buffer_store_dwordx2 v[56:57], v8, s[4:7], s56 offen
 v_cvt_pk_bf16_f32 v61, v62, v63
 v_or_b32 v60, 1, v60
 buffer_store_dwordx2 v[60:61], v8, s[4:7], s57 offen
 s_add_u32 s52, s52, 262144
 s_add_u32 s65, s65, s27
 s_mov_b64 s[28:29], -1
 s_sub_i32 s64, s50, s71
 s_mov_b32 s27, 131072
 v_cvt_pk_bf16_f32 v64, v64, v65
 v_cvt_pk_bf16_f32 v65, v66, v67
 v_or_b32 v64, 1, v64
 buffer_store_dwordx2 v[64:65], v8, s[4:7], s58 offen
 s_barrier
 s_nop 15
 s_nop 15
 s_nop 7
 buffer_load_dwordx4 v[10:13], v0, s[4:7], s60 offen offset:0 sc1
 buffer_load_dwordx4 v[14:17], v0, s[4:7], s60 offen offset:1024 sc1
 buffer_load_dwordx4 v[18:21], v0, s[4:7], s60 offen offset:2048 sc1
 buffer_load_dwordx4 v[22:25], v0, s[4:7], s60 offen offset:3072 sc1
 v_and_b32 v34, 16, v0
 v_mov_b32 v30, 0x3f80
 v_lshlrev_b32 v30, v34, v30
 v_bfe_u32 v34, v0, 5, 3
 v_cmp_eq_u32 vcc, 0, v34
 s_nop 1
 v_cndmask_b32 v26, 0, v30, vcc
 v_cmp_eq_u32 vcc, 1, v34
 s_nop 1
 v_cndmask_b32 v27, 0, v30, vcc
 v_cmp_eq_u32 vcc, 2, v34
 s_nop 1
 v_cndmask_b32 v28, 0, v30, vcc
 v_cmp_eq_u32 vcc, 3, v34
 s_nop 1
 v_cndmask_b32 v29, 0, v30, vcc
 v_and_b32 v35, 0xf0, v0
 v_bfe_u32 v34, v0, 8, 2
 v_lshl_add_u32 v35, v34, 2, v35
 v_and_b32 v34, 0x80, v0
 v_lshl_add_u32 v35, v34, 23, v35
 v_mov_b64 v[42:43], 0
 v_mov_b64 v[44:45], 0
 v_mov_b64 v[46:47], 0
 v_mov_b64 v[48:49], 0
 v_mov_b64 v[50:51], 0
 v_mov_b64 v[52:53], 0
 v_and_b32 v70, 0xf0, v0
 v_bfe_u32 v71, v0, 8, 2
 v_lshl_add_u32 v71, v71, 9, s67
 v_add_u32 v70, v70, v71
 v_add_u32 v9, 57344, v3
 s_waitcnt vmcnt(3)
 v_mfma_f32_16x16x32_bf16 v[30:33], v[10:13], v[26:29], 0
 v_bitop3_b32 v34, v10, v12, v12 bitop3:0x80
 s_waitcnt vmcnt(2)
 v_mfma_f32_16x16x32_bf16 v[30:33], v[14:17], v[26:29], v[30:33]
 v_bitop3_b32 v34, v34, v14, v16 bitop3:0x80
 s_waitcnt vmcnt(1)
 v_mfma_f32_16x16x32_bf16 v[30:33], v[18:21], v[26:29], v[30:33]
 v_bitop3_b32 v34, v34, v18, v20 bitop3:0x80
 s_waitcnt vmcnt(0)
 v_mfma_f32_16x16x32_bf16 v[30:33], v[22:25], v[26:29], v[30:33]
 v_bitop3_b32 v34, v34, v22, v24 bitop3:0x80
 v_and_b32 v34, 1, v34
 v_cmp_ne_u32 vcc, 1, v34
 s_cbranch_vccnz L_rre_30
 s_nop 3
 v_permlane32_swap_b32 v30, v31
 v_permlane32_swap_b32 v32, v33
 v_add_f32 v30, v30, v31
 v_add_f32 v32, v32, v33
 v_cvt_pk_bf16_f32 v30, v30, v32
 v_or_b32 v30, 1, v30
 buffer_store_dword v30, v35, s[4:7], s61 offen
L_rback_31:
 s_barrier
 s_nop 15
 s_nop 11
 buffer_load_dwordx4 v[10:13], v0, s[4:7], s24 offen offset:0 sc1
 buffer_load_dwordx4 v[14:17], v0, s[4:7], s24 offen offset:1024 sc1
 ds_read_b128 v[26:29], v3 offset:0
 ds_read_b128 v[30:33], v3 offset:1024
 ds_read_b128 v[62:65], v3 offset:8192
 ds_read_b128 v[66:69], v3 offset:9216
 ds_read_b128 v[34:37], v3 offset:16384
 ds_read_b128 v[38:41], v3 offset:17408
 s_nop 15
 s_nop 3
 buffer_load_dwordx4 v[18:21], v0, s[4:7], s24 offen offset:0 sc1
 buffer_load_dwordx4 v[22:25], v0, s[4:7], s24 offen offset:1024 sc1
 s_nop 15
 s_nop 11
 buffer_load_dwordx4 v[54:57], v0, s[4:7], s24 offen offset:0 sc1
 buffer_load_dwordx4 v[58:61], v0, s[4:7], s24 offen offset:1024 sc1
 s_waitcnt vmcnt(5)
 v_bitop3_b32 v71, v10, v11, v12 bitop3:0x80
 v_bitop3_b32 v71, v71, v13, v13 bitop3:0x80
 s_waitcnt vmcnt(4)
 v_bitop3_b32 v71, v71, v14, v15 bitop3:0x80
 v_bitop3_b32 v71, v71, v16, v17 bitop3:0x80
 v_and_b32 v71, 1, v71
 v_cmp_ne_u32 vcc, 1, v71
 s_cbranch_vccnz L_ma_34
 ds_write_b128 v0, v[10:13] offset:0
 ds_write_b128 v0, v[14:17] offset:1024
 s_barrier
L_maok_32:
 s_branch L_loop_19
L_last_20:
 s_waitcnt lgkmcnt(0)
 s_barrier
 ds_read_b128 v[10:13], v4 offset:0
 ds_read_b128 v[14:17], v4 offset:512
 s_waitcnt vmcnt(2)
 ds_read_b128 v[18:21], v4 offset:1024
 s_waitcnt lgkmcnt(2)
 v_smfmac_f32_16x16x64_bf16 v[50:53], v[10:13], a[8:15], v1
 v_smfmac_f32_16x16x64_bf16 v[42:45], v[10:13], v[72:79], v1
 ds_read_b128 v[22:25], v4 offset:1536
 v_bfe_u32 v70, v0, 5, 1
 v_smfmac_f32_16x16x64_bf16 v[46:49], v[10:13], v[80:87], v1
 v_mul_i32_i24 v70, -1920, v70
 s_waitcnt lgkmcnt(2)
 v_smfmac_f32_16x16x64_bf16 v[50:53], v[14:17], a[16:23], v1
 v_add_u32 v70, v70, v6
 v_smfmac_f32_16x16x64_bf16 v[42:45], v[14:17], v[88:95], v1
 ds_read_b128 v[10:13], v4 offset:2048
 v_smfmac_f32_16x16x64_bf16 v[46:49], v[14:17], v[26:33], v1
 ds_read_b128 v[26:29], v3 offset:24576
 s_waitcnt lgkmcnt(3)
 v_smfmac_f32_16x16x64_bf16 v[50:53], v[18:21], a[24:31], v1
 ds_read_b128 v[30:33], v3 offset:25600
 v_smfmac_f32_16x16x64_bf16 v[42:45], v[18:21], v[96:103], v1
 ds_read_b128 v[14:17], v4 offset:2560
 v_smfmac_f32_16x16x64_bf16 v[46:49], v[18:21], v[62:69], v1
 s_waitcnt vmcnt(0)
 s_waitcnt lgkmcnt(4)
 v_smfmac_f32_16x16x64_bf16 v[50:53], v[22:25], a[32:39], v1
 ds_read_b64_tr_b16 v[62:63], v70 offset:2176
 ds_read_b64_tr_b16 v[64:65], v70 offset:2240
 v_smfmac_f32_16x16x64_bf16 v[42:45], v[22:25], v[104:111], v1
 ds_read_b128 v[18:21], v4 offset:3072
 v_smfmac_f32_16x16x64_bf16 v[46:49], v[22:25], v[34:41], v1
 ds_read_b128 v[34:37], v3 offset:32768
 s_waitcnt lgkmcnt(7)
 v_smfmac_f32_16x16x64_bf16 v[50:53], v[10:13], a[40:47], v1
 ds_read_b128 v[38:41], v3 offset:33792
 ds_read_b64_tr_b16 v[66:67], v70 offset:2688
 ds_read_b64_tr_b16 v[68:69], v70 offset:2752
 v_smfmac_f32_16x16x64_bf16 v[42:45], v[10:13], v[112:119], v1
 ds_read_b128 v[22:25], v4 offset:3584
 s_waitcnt lgkmcnt(9)
 v_smfmac_f32_16x16x64_bf16 v[46:49], v[10:13], v[26:33], v1
 ds_read_b128 v[26:29], v3 offset:40960
 s_waitcnt lgkmcnt(9)
 v_smfmac_f32_16x16x64_bf16 v[50:53], v[14:17], a[48:55], v1
 ds_read_b128 v[30:33], v3 offset:41984
 v_smfmac_f32_16x16x64_bf16 v[42:45], v[14:17], v[120:127], v1
 v_smfmac_f32_16x16x64_bf16 v[46:49], v[14:17], v[128:135], v1
 s_waitcnt lgkmcnt(7)
 v_smfmac_f32_16x16x64_bf16 v[50:53], v[18:21], a[56:63], v1
 s_waitcnt lgkmcnt(3)
 s_barrier
 v_smfmac_f32_16x16x64_bf16 v[42:45], v[18:21], v[136:143], v1
 ds_read_b128 v[10:13], v4 offset:4096
 ds_read_b128 v[14:17], v4 offset:4608
 v_smfmac_f32_16x16x64_bf16 v[46:49], v[18:21], v[34:41], v1
 ds_read_b128 v[34:37], v3 offset:49152
 s_waitcnt lgkmcnt(5)
 v_smfmac_f32_16x16x64_bf16 v[50:53], v[22:25], a[64:71], v1
 ds_read_b128 v[38:41], v3 offset:50176
 v_smfmac_f32_16x16x64_bf16 v[42:45], v[22:25], v[144:151], v1
 ds_read_b128 v[18:21], v4 offset:5120
 buffer_store_dwordx4 v[62:65], v0, s[4:7], s65 offen offset:0 sc1
 s_waitcnt lgkmcnt(5)
 v_smfmac_f32_16x16x64_bf16 v[46:49], v[22:25], v[26:33], v1
 ds_read_b128 v[26:29], v9 offset:0
 s_waitcnt lgkmcnt(5)
 v_smfmac_f32_16x16x64_bf16 v[50:53], v[10:13], a[72:79], v1
 ds_read_b128 v[30:33], v9 offset:1024
 v_smfmac_f32_16x16x64_bf16 v[42:45], v[10:13], v[152:159], v1
 ds_read_b128 v[22:25], v4 offset:5632
 v_smfmac_f32_16x16x64_bf16 v[46:49], v[10:13], v[160:167], v1
 s_waitcnt lgkmcnt(6)
 v_smfmac_f32_16x16x64_bf16 v[50:53], v[14:17], a[80:87], v1
 v_smfmac_f32_16x16x64_bf16 v[42:45], v[14:17], v[168:175], v1
 ds_read_b128 v[10:13], v4 offset:6144
 buffer_store_dwordx4 v[66:69], v0, s[4:7], s65 offen offset:1024 sc1
 s_waitcnt lgkmcnt(5)
 v_smfmac_f32_16x16x64_bf16 v[46:49], v[14:17], v[34:41], v1
 ds_read_b128 v[34:37], v9 offset:8192
 s_waitcnt lgkmcnt(5)
 v_smfmac_f32_16x16x64_bf16 v[50:53], v[18:21], a[88:95], v1
 ds_read_b128 v[38:41], v9 offset:9216
 v_smfmac_f32_16x16x64_bf16 v[42:45], v[18:21], v[176:183], v1
 ds_read_b128 v[14:17], v4 offset:6656
 s_waitcnt lgkmcnt(5)
 v_smfmac_f32_16x16x64_bf16 v[46:49], v[18:21], v[26:33], v1
 ds_read_b128 v[26:29], v9 offset:16384
 s_waitcnt lgkmcnt(5)
 v_smfmac_f32_16x16x64_bf16 v[50:53], v[22:25], a[96:103], v1
 ds_read_b128 v[30:33], v9 offset:17408
 v_smfmac_f32_16x16x64_bf16 v[42:45], v[22:25], v[184:191], v1
 ds_read_b128 v[18:21], v4 offset:7168
 v_smfmac_f32_16x16x64_bf16 v[46:49], v[22:25], v[192:199], v1
 ds_read_b128 v[62:65], v9 offset:24576
 s_waitcnt lgkmcnt(7)
 v_smfmac_f32_16x16x64_bf16 v[42:45], v[10:13], v[200:207], v1
 ds_read_b128 v[66:69], v9 offset:25600
 ds_read_b128 v[22:25], v4 offset:7680
 s_waitcnt lgkmcnt(7)
 v_smfmac_f32_16x16x64_bf16 v[46:49], v[10:13], v[34:41], v1
 ds_read_b128 v[34:37], v9 offset:32768
 s_waitcnt lgkmcnt(7)
 v_smfmac_f32_16x16x64_bf16 v[42:45], v[14:17], v[208:215], v1
 ds_read_b128 v[38:41], v9 offset:33792
 ds_read_b128 v[10:13], v4 offset:8192
 s_waitcnt lgkmcnt(7)
 v_smfmac_f32_16x16x64_bf16 v[46:49], v[14:17], v[26:33], v1
 s_waitcnt lgkmcnt(6)
 v_smfmac_f32_16x16x64_bf16 v[42:45], v[18:21], v[216:223], v1
 ds_read_b128 v[14:17], v4 offset:8704
 s_waitcnt lgkmcnt(5)
 v_smfmac_f32_16x16x64_bf16 v[46:49], v[18:21], v[62:69], v1
 s_waitcnt lgkmcnt(4)
 v_smfmac_f32_16x16x64_bf16 v[42:45], v[22:25], v[224:231], v1
 ds_read_b128 v[18:21], v4 offset:6144
 s_waitcnt lgkmcnt(3)
 v_smfmac_f32_16x16x64_bf16 v[46:49], v[22:25], v[34:41], v1
 s_waitcnt lgkmcnt(2)
 v_smfmac_f32_16x16x64_bf16 v[42:45], v[10:13], v[232:239], v1
 ds_read_b128 v[22:25], v4 offset:6656
 v_smfmac_f32_16x16x64_bf16 v[46:49], v[10:13], v[240:247], v1
 s_waitcnt lgkmcnt(2)
 v_smfmac_f32_16x16x64_bf16 v[42:45], v[14:17], v[248:255], v1
 ds_read_b128 v[10:13], v4 offset:7168
 v_smfmac_f32_16x16x64_bf16 v[46:49], v[14:17], a[0:7], v1
 ds_read_b128 v[14:17], v4 offset:7680
 s_waitcnt lgkmcnt(3)
 v_smfmac_f32_16x16x64_bf16 v[50:53], v[18:21], a[104:111], v1
 s_nop 1
 s_waitcnt lgkmcnt(2)
 v_smfmac_f32_16x16x64_bf16 v[50:53], v[22:25], a[112:119], v1
 s_nop 2
 v_cvt_pk_bf16_f32 v62, v42, v43
 v_cvt_pk_bf16_f32 v63, v44, v45
 ds_write_b64 v5, v[62:63]
 v_cvt_pk_bf16_f32 v64, v46, v47
 v_cvt_pk_bf16_f32 v65, v48, v49
 ds_write_b64 v5, v[64:65] offset:2176
 ds_read_b128 v[42:45], v4 offset:8192
 ds_read_b128 v[46:49], v4 offset:8704
 s_waitcnt lgkmcnt(5)
 v_smfmac_f32_16x16x64_bf16 v[50:53], v[10:13], a[120:127], v1
 s_waitcnt lgkmcnt(4)
 v_smfmac_f32_16x16x64_bf16 v[50:53], v[14:17], a[128:135], v1
 s_waitcnt lgkmcnt(2)
 s_barrier
 s_waitcnt lgkmcnt(1)
 v_smfmac_f32_16x16x64_bf16 v[50:53], v[42:45], a[136:143], v1
 s_waitcnt lgkmcnt(0)
 v_smfmac_f32_16x16x64_bf16 v[50:53], v[46:49], a[144:151], v1
 v_bfe_u32 v70, v0, 5, 1
 v_mul_i32_i24 v70, -1920, v70
 v_add_u32 v70, v70, v6
 s_nop 7
 v_cvt_pk_bf16_f32 v40, v50, v51
 v_cvt_pk_bf16_f32 v41, v52, v53
 ds_write_b64 v5, v[40:41] offset:4352
 s_add_u32 s65, s65, 131072
 s_waitcnt vmcnt(0) lgkmcnt(0)
 s_barrier
 ds_read_b64_tr_b16 v[62:63], v70 offset:2176
 ds_read_b64_tr_b16 v[64:65], v70 offset:2240
 ds_read_b64_tr_b16 v[66:67], v70 offset:2688
 ds_read_b64_tr_b16 v[68:69], v70 offset:2752
 s_waitcnt lgkmcnt(0)
 v_or_b32 v62, 1, v62
 v_or_b32 v63, 1, v63
 v_or_b32 v64, 1, v64
 v_or_b32 v65, 1, v65
 v_or_b32 v66, 1, v66
 v_or_b32 v67, 1, v67
 v_or_b32 v68, 1, v68
 v_or_b32 v69, 1, v69
 buffer_store_dwordx4 v[62:65], v0, s[4:7], s65 offen offset:0 sc1
 buffer_store_dwordx4 v[66:69], v0, s[4:7], s65 offen offset:1024 sc1
 s_branch L_done0
L_kvs_21:
 v_lshlrev_b32 v71, 3, v0
 s_mov_b32 m0, 24448
 s_mov_b32 s72, 65015808
 s_mov_b64 exec, 0x1ffff
 buffer_load_dword v71, s[4:7], s72 offen sc1 lds
 s_mov_b64 exec, -1
 s_branch L_kvsb_22
L_rre_23:
 buffer_load_dwordx4 v[10:13], v0, s[4:7], s60 offen offset:0 sc1
 buffer_load_dwordx4 v[14:17], v0, s[4:7], s60 offen offset:1024 sc1
 buffer_load_dwordx4 v[18:21], v0, s[4:7], s60 offen offset:2048 sc1
 buffer_load_dwordx4 v[22:25], v0, s[4:7], s60 offen offset:3072 sc1
 s_nop 15
 s_nop 7
L_rspin_37:
 buffer_load_dwordx4 v[54:57], v0, s[4:7], s60 offen offset:0 sc1
 buffer_load_dwordx4 v[58:61], v0, s[4:7], s60 offen offset:1024 sc1
 buffer_load_dwordx4 v[62:65], v0, s[4:7], s60 offen offset:2048 sc1
 buffer_load_dwordx4 v[66:69], v0, s[4:7], s60 offen offset:3072 sc1
 s_add_u32 s51, s51, 1
 s_waitcnt vmcnt(7)
 v_mfma_f32_16x16x32_bf16 v[30:33], v[10:13], v[26:29], 0
 v_bitop3_b32 v34, v10, v12, v12 bitop3:0xfe
 s_waitcnt vmcnt(6)
 v_mfma_f32_16x16x32_bf16 v[30:33], v[14:17], v[26:29], v[30:33]
 v_bitop3_b32 v34, v34, v14, v16 bitop3:0xfe
 s_waitcnt vmcnt(5)
 v_mfma_f32_16x16x32_bf16 v[30:33], v[18:21], v[26:29], v[30:33]
 v_bitop3_b32 v34, v34, v18, v20 bitop3:0xfe
 s_waitcnt vmcnt(4)
 v_mfma_f32_16x16x32_bf16 v[30:33], v[22:25], v[26:29], v[30:33]
 v_bitop3_b32 v34, v34, v22, v24 bitop3:0xfe
 v_and_b32 v34, 1, v34
 v_cmp_ne_u32 vcc, 0, v34
 s_cbranch_vccz L_rok_38
 buffer_load_dwordx4 v[10:13], v0, s[4:7], s60 offen offset:0 sc1
 buffer_load_dwordx4 v[14:17], v0, s[4:7], s60 offen offset:1024 sc1
 buffer_load_dwordx4 v[18:21], v0, s[4:7], s60 offen offset:2048 sc1
 buffer_load_dwordx4 v[22:25], v0, s[4:7], s60 offen offset:3072 sc1
 s_add_u32 s51, s51, 1
 s_waitcnt vmcnt(7)
 v_mfma_f32_16x16x32_bf16 v[30:33], v[54:57], v[26:29], 0
 v_bitop3_b32 v34, v54, v56, v56 bitop3:0xfe
 s_waitcnt vmcnt(6)
 v_mfma_f32_16x16x32_bf16 v[30:33], v[58:61], v[26:29], v[30:33]
 v_bitop3_b32 v34, v34, v58, v60 bitop3:0xfe
 s_waitcnt vmcnt(5)
 v_mfma_f32_16x16x32_bf16 v[30:33], v[62:65], v[26:29], v[30:33]
 v_bitop3_b32 v34, v34, v62, v64 bitop3:0xfe
 s_waitcnt vmcnt(4)
 v_mfma_f32_16x16x32_bf16 v[30:33], v[66:69], v[26:29], v[30:33]
 v_bitop3_b32 v34, v34, v66, v68 bitop3:0xfe
 v_and_b32 v34, 1, v34
 v_cmp_ne_u32 vcc, 0, v34
 s_cbranch_vccz L_rok_38
 s_and_b32 s3, s51, 0xffff
 s_cmp_gt_u32 s3, 20000
 s_cbranch_scc0 L_rspin_37
 s_branch L_exit0
L_rok_38:
 s_nop 3
 v_permlane32_swap_b32 v30, v31
 v_permlane32_swap_b32 v32, v33
 v_add_f32 v30, v30, v31
 v_add_f32 v32, v32, v33
 v_cvt_pk_bf16_f32 v30, v30, v32
 v_and_b32 v30, -2, v30
 buffer_store_dword v30, v35, s[4:7], s61 offen
 s_waitcnt vmcnt(1)
 s_branch L_rback_24
L_ma_27:
 s_add_u32 s51, s51, 1
 s_waitcnt vmcnt(3)
 v_bitop3_b32 v71, v18, v19, v20 bitop3:0xfe
 v_bitop3_b32 v71, v71, v21, v21 bitop3:0xfe
 s_waitcnt vmcnt(2)
 v_bitop3_b32 v71, v71, v22, v23 bitop3:0xfe
 v_bitop3_b32 v71, v71, v24, v25 bitop3:0xfe
 v_and_b32 v71, 1, v71
 v_cmp_ne_u32 vcc, 0, v71
 s_cbranch_vccz L_mahit_41
 buffer_load_dwordx4 v[10:13], v0, s[4:7], s24 offen offset:0 sc1
 buffer_load_dwordx4 v[14:17], v0, s[4:7], s24 offen offset:1024 sc1
L_marot_39:
 s_add_u32 s51, s51, 1
 s_waitcnt vmcnt(3)
 v_bitop3_b32 v71, v54, v55, v56 bitop3:0xfe
 v_bitop3_b32 v71, v71, v57, v57 bitop3:0xfe
 s_waitcnt vmcnt(2)
 v_bitop3_b32 v71, v71, v58, v59 bitop3:0xfe
 v_bitop3_b32 v71, v71, v60, v61 bitop3:0xfe
 v_and_b32 v71, 1, v71
 v_cmp_ne_u32 vcc, 0, v71
 s_cbranch_vccz L_mahit_42
 buffer_load_dwordx4 v[18:21], v0, s[4:7], s24 offen offset:0 sc1
 buffer_load_dwordx4 v[22:25], v0, s[4:7], s24 offen offset:1024 sc1
 s_add_u32 s51, s51, 1
 s_waitcnt vmcnt(3)
 v_bitop3_b32 v71, v10, v11, v12 bitop3:0xfe
 v_bitop3_b32 v71, v71, v13, v13 bitop3:0xfe
 s_waitcnt vmcnt(2)
 v_bitop3_b32 v71, v71, v14, v15 bitop3:0xfe
 v_bitop3_b32 v71, v71, v16, v17 bitop3:0xfe
 v_and_b32 v71, 1, v71
 v_cmp_ne_u32 vcc, 0, v71
 s_cbranch_vccz L_mahit_40
 buffer_load_dwordx4 v[54:57], v0, s[4:7], s24 offen offset:0 sc1
 buffer_load_dwordx4 v[58:61], v0, s[4:7], s24 offen offset:1024 sc1
 s_add_u32 s51, s51, 1
 s_waitcnt vmcnt(3)
 v_bitop3_b32 v71, v18, v19, v20 bitop3:0xfe
 v_bitop3_b32 v71, v71, v21, v21 bitop3:0xfe
 s_waitcnt vmcnt(2)
 v_bitop3_b32 v71, v71, v22, v23 bitop3:0xfe
 v_bitop3_b32 v71, v71, v24, v25 bitop3:0xfe
 v_and_b32 v71, 1, v71
 v_cmp_ne_u32 vcc, 0, v71
 s_cbranch_vccz L_mahit_41
 buffer_load_dwordx4 v[10:13], v0, s[4:7], s24 offen offset:0 sc1
 buffer_load_dwordx4 v[14:17], v0, s[4:7], s24 offen offset:1024 sc1
 s_add_u32 s51, s51, 1
 s_and_b32 s3, s51, 0xffff
 s_cmp_gt_u32 s3, 20000
 s_cbranch_scc0 L_marot_39
 s_branch L_exit0
L_mahit_40:
 ds_write_b128 v0, v[10:13] offset:0
 ds_write_b128 v0, v[14:17] offset:1024
 s_barrier
 s_waitcnt vmcnt(0)
 s_branch L_maok_25
L_mahit_41:
 ds_write_b128 v0, v[18:21] offset:0
 ds_write_b128 v0, v[22:25] offset:1024
 s_barrier
 s_branch L_maok_25
L_mahit_42:
 ds_write_b128 v0, v[54:57] offset:0
 ds_write_b128 v0, v[58:61] offset:1024
 s_barrier
 s_waitcnt vmcnt(0)
 s_branch L_maok_25
L_rre_30:
 buffer_load_dwordx4 v[10:13], v0, s[4:7], s60 offen offset:0 sc1
 buffer_load_dwordx4 v[14:17], v0, s[4:7], s60 offen offset:1024 sc1
 buffer_load_dwordx4 v[18:21], v0, s[4:7], s60 offen offset:2048 sc1
 buffer_load_dwordx4 v[22:25], v0, s[4:7], s60 offen offset:3072 sc1
 s_nop 15
 s_nop 7
L_rspin_43:
 buffer_load_dwordx4 v[54:57], v0, s[4:7], s60 offen offset:0 sc1
 buffer_load_dwordx4 v[58:61], v0, s[4:7], s60 offen offset:1024 sc1
 buffer_load_dwordx4 v[62:65], v0, s[4:7], s60 offen offset:2048 sc1
 buffer_load_dwordx4 v[66:69], v0, s[4:7], s60 offen offset:3072 sc1
 s_add_u32 s51, s51, 1
 s_waitcnt vmcnt(7)
 v_mfma_f32_16x16x32_bf16 v[30:33], v[10:13], v[26:29], 0
 v_bitop3_b32 v34, v10, v12, v12 bitop3:0x80
 s_waitcnt vmcnt(6)
 v_mfma_f32_16x16x32_bf16 v[30:33], v[14:17], v[26:29], v[30:33]
 v_bitop3_b32 v34, v34, v14, v16 bitop3:0x80
 s_waitcnt vmcnt(5)
 v_mfma_f32_16x16x32_bf16 v[30:33], v[18:21], v[26:29], v[30:33]
 v_bitop3_b32 v34, v34, v18, v20 bitop3:0x80
 s_waitcnt vmcnt(4)
 v_mfma_f32_16x16x32_bf16 v[30:33], v[22:25], v[26:29], v[30:33]
 v_bitop3_b32 v34, v34, v22, v24 bitop3:0x80
 v_and_b32 v34, 1, v34
 v_cmp_ne_u32 vcc, 1, v34
 s_cbranch_vccz L_rok_44
 buffer_load_dwordx4 v[10:13], v0, s[4:7], s60 offen offset:0 sc1
 buffer_load_dwordx4 v[14:17], v0, s[4:7], s60 offen offset:1024 sc1
 buffer_load_dwordx4 v[18:21], v0, s[4:7], s60 offen offset:2048 sc1
 buffer_load_dwordx4 v[22:25], v0, s[4:7], s60 offen offset:3072 sc1
 s_add_u32 s51, s51, 1
 s_waitcnt vmcnt(7)
 v_mfma_f32_16x16x32_bf16 v[30:33], v[54:57], v[26:29], 0
 v_bitop3_b32 v34, v54, v56, v56 bitop3:0x80
 s_waitcnt vmcnt(6)
 v_mfma_f32_16x16x32_bf16 v[30:33], v[58:61], v[26:29], v[30:33]
 v_bitop3_b32 v34, v34, v58, v60 bitop3:0x80
 s_waitcnt vmcnt(5)
 v_mfma_f32_16x16x32_bf16 v[30:33], v[62:65], v[26:29], v[30:33]
 v_bitop3_b32 v34, v34, v62, v64 bitop3:0x80
 s_waitcnt vmcnt(4)
 v_mfma_f32_16x16x32_bf16 v[30:33], v[66:69], v[26:29], v[30:33]
 v_bitop3_b32 v34, v34, v66, v68 bitop3:0x80
 v_and_b32 v34, 1, v34
 v_cmp_ne_u32 vcc, 1, v34
 s_cbranch_vccz L_rok_44
 s_and_b32 s3, s51, 0xffff
 s_cmp_gt_u32 s3, 20000
 s_cbranch_scc0 L_rspin_43
 s_branch L_exit0
L_rok_44:
 s_nop 3
 v_permlane32_swap_b32 v30, v31
 v_permlane32_swap_b32 v32, v33
 v_add_f32 v30, v30, v31
 v_add_f32 v32, v32, v33
 v_cvt_pk_bf16_f32 v30, v30, v32
 v_or_b32 v30, 1, v30
 buffer_store_dword v30, v35, s[4:7], s61 offen
 s_waitcnt vmcnt(1)
 s_branch L_rback_31
L_ma_34:
 s_add_u32 s51, s51, 1
 s_waitcnt vmcnt(3)
 v_bitop3_b32 v71, v18, v19, v20 bitop3:0x80
 v_bitop3_b32 v71, v71, v21, v21 bitop3:0x80
 s_waitcnt vmcnt(2)
 v_bitop3_b32 v71, v71, v22, v23 bitop3:0x80
 v_bitop3_b32 v71, v71, v24, v25 bitop3:0x80
 v_and_b32 v71, 1, v71
 v_cmp_ne_u32 vcc, 1, v71
 s_cbranch_vccz L_mahit_47
 buffer_load_dwordx4 v[10:13], v0, s[4:7], s24 offen offset:0 sc1
 buffer_load_dwordx4 v[14:17], v0, s[4:7], s24 offen offset:1024 sc1
L_marot_45:
 s_add_u32 s51, s51, 1
 s_waitcnt vmcnt(3)
 v_bitop3_b32 v71, v54, v55, v56 bitop3:0x80
 v_bitop3_b32 v71, v71, v57, v57 bitop3:0x80
 s_waitcnt vmcnt(2)
 v_bitop3_b32 v71, v71, v58, v59 bitop3:0x80
 v_bitop3_b32 v71, v71, v60, v61 bitop3:0x80
 v_and_b32 v71, 1, v71
 v_cmp_ne_u32 vcc, 1, v71
 s_cbranch_vccz L_mahit_48
 buffer_load_dwordx4 v[18:21], v0, s[4:7], s24 offen offset:0 sc1
 buffer_load_dwordx4 v[22:25], v0, s[4:7], s24 offen offset:1024 sc1
 s_add_u32 s51, s51, 1
 s_waitcnt vmcnt(3)
 v_bitop3_b32 v71, v10, v11, v12 bitop3:0x80
 v_bitop3_b32 v71, v71, v13, v13 bitop3:0x80
 s_waitcnt vmcnt(2)
 v_bitop3_b32 v71, v71, v14, v15 bitop3:0x80
 v_bitop3_b32 v71, v71, v16, v17 bitop3:0x80
 v_and_b32 v71, 1, v71
 v_cmp_ne_u32 vcc, 1, v71
 s_cbranch_vccz L_mahit_46
 buffer_load_dwordx4 v[54:57], v0, s[4:7], s24 offen offset:0 sc1
 buffer_load_dwordx4 v[58:61], v0, s[4:7], s24 offen offset:1024 sc1
 s_add_u32 s51, s51, 1
 s_waitcnt vmcnt(3)
 v_bitop3_b32 v71, v18, v19, v20 bitop3:0x80
 v_bitop3_b32 v71, v71, v21, v21 bitop3:0x80
 s_waitcnt vmcnt(2)
 v_bitop3_b32 v71, v71, v22, v23 bitop3:0x80
 v_bitop3_b32 v71, v71, v24, v25 bitop3:0x80
 v_and_b32 v71, 1, v71
 v_cmp_ne_u32 vcc, 1, v71
 s_cbranch_vccz L_mahit_47
 buffer_load_dwordx4 v[10:13], v0, s[4:7], s24 offen offset:0 sc1
 buffer_load_dwordx4 v[14:17], v0, s[4:7], s24 offen offset:1024 sc1
 s_add_u32 s51, s51, 1
 s_and_b32 s3, s51, 0xffff
 s_cmp_gt_u32 s3, 20000
 s_cbranch_scc0 L_marot_45
 s_branch L_exit0
L_mahit_46:
 ds_write_b128 v0, v[10:13] offset:0
 ds_write_b128 v0, v[14:17] offset:1024
 s_barrier
 s_waitcnt vmcnt(0)
 s_branch L_maok_32
L_mahit_47:
 ds_write_b128 v0, v[18:21] offset:0
 ds_write_b128 v0, v[22:25] offset:1024
 s_barrier
 s_branch L_maok_32
L_mahit_48:
 ds_write_b128 v0, v[54:57] offset:0
 ds_write_b128 v0, v[58:61] offset:1024
 s_barrier
 s_waitcnt vmcnt(0)
 s_branch L_maok_32
L_wave1_16:
 v_mov_b64 v[42:43], 0
 v_mov_b64 v[44:45], 0
 v_mov_b64 v[46:47], 0
 v_mov_b64 v[48:49], 0
 v_mov_b64 v[50:51], 0
 v_mov_b64 v[52:53], 0
 v_and_b32 v70, 0xf0, v0
 v_bfe_u32 v71, v0, 8, 2
 v_lshl_add_u32 v71, v71, 9, s67
 v_add_u32 v70, v70, v71
 v_add_u32 v9, 57344, v3
 ds_read_b128 v[26:29], v3 offset:0
 ds_read_b128 v[30:33], v3 offset:1024
 ds_read_b128 v[62:65], v3 offset:8192
 ds_read_b128 v[66:69], v3 offset:9216
 ds_read_b128 v[34:37], v3 offset:16384
 ds_read_b128 v[38:41], v3 offset:17408
 .p2align 6
L_loop_49:
 s_waitcnt lgkmcnt(0)
 s_barrier
 s_mov_b32 s51, 0
 ds_read_b128 v[10:13], v4 offset:0
 ds_read_b128 v[14:17], v4 offset:512
 ds_read_b128 v[18:21], v4 offset:1024
 s_add_u32 s72, s52, 16777216
 buffer_load_dwordx4 v[54:57], v70, s[4:7], s72 offen sc1
 buffer_load_dwordx4 v[58:61], v70, s[4:7], s72 offen offset:256 sc1
 s_waitcnt lgkmcnt(2)
 v_smfmac_f32_16x16x64_bf16 v[50:53], v[10:13], a[8:15], v1
 v_lshlrev_b32 v71, 2, v0
 v_smfmac_f32_16x16x64_bf16 v[42:45], v[10:13], v[72:79], v1
 ds_read_b128 v[22:25], v4 offset:1536
 v_smfmac_f32_16x16x64_bf16 v[46:49], v[10:13], v[80:87], v1
 s_mov_b32 m0, 4096
 s_cmp_eq_u32 s50, 0
 s_cbranch_scc1 L_mb2skip_51
 buffer_load_dwordx4 v0, s[4:7], s25 offen offset:0 sc1 lds
 buffer_load_dwordx4 v0, s[4:7], s25 offen offset:1024 sc1 lds
L_mb2skip_51:
 s_waitcnt lgkmcnt(2)
 v_smfmac_f32_16x16x64_bf16 v[50:53], v[14:17], a[16:23], v1
 v_smfmac_f32_16x16x64_bf16 v[42:45], v[14:17], v[88:95], v1
 ds_read_b128 v[10:13], v4 offset:2048
 v_smfmac_f32_16x16x64_bf16 v[46:49], v[14:17], v[26:33], v1
 ds_read_b128 v[26:29], v3 offset:24576
 s_add_u32 s73, s52, 524288
 s_min_u32 s73, s73, 16515072
 s_add_u32 s73, s73, s68
 s_waitcnt lgkmcnt(3)
 v_smfmac_f32_16x16x64_bf16 v[50:53], v[18:21], a[24:31], v1
 ds_read_b128 v[30:33], v3 offset:25600
 v_smfmac_f32_16x16x64_bf16 v[42:45], v[18:21], v[96:103], v1
 ds_read_b128 v[14:17], v4 offset:2560
 s_mov_b32 m0, 23936
 s_nop 0
 buffer_load_dword v71, s[4:7], s73 offen sc1 lds
 v_smfmac_f32_16x16x64_bf16 v[46:49], v[18:21], v[62:69], v1
 s_waitcnt vmcnt(5)
 ds_read_b128 v[62:65], v0 offset:4096
 ds_read_b128 v[66:69], v0 offset:5120
 s_waitcnt lgkmcnt(6)
 v_smfmac_f32_16x16x64_bf16 v[50:53], v[22:25], a[32:39], v1
 v_smfmac_f32_16x16x64_bf16 v[42:45], v[22:25], v[104:111], v1
 ds_read_b128 v[18:21], v4 offset:3072
 v_smfmac_f32_16x16x64_bf16 v[46:49], v[22:25], v[34:41], v1
 ds_read_b128 v[34:37], v3 offset:32768
 s_waitcnt lgkmcnt(7)
 v_smfmac_f32_16x16x64_bf16 v[50:53], v[10:13], a[40:47], v1
 ds_read_b128 v[38:41], v3 offset:33792
 v_smfmac_f32_16x16x64_bf16 v[42:45], v[10:13], v[112:119], v1
 s_waitcnt lgkmcnt(3)
 ds_read_b128 v[22:25], v4 offset:3584
 v_bitop3_b32 v62, v62, v63, v64 bitop3:0x80
 v_bitop3_b32 v62, v62, v65, v65 bitop3:0x80
 v_smfmac_f32_16x16x64_bf16 v[46:49], v[10:13], v[26:33], v1
 ds_read_b128 v[26:29], v3 offset:40960
 v_bitop3_b32 v62, v62, v66, v67 bitop3:0x80
 v_smfmac_f32_16x16x64_bf16 v[50:53], v[14:17], a[48:55], v1
 ds_read_b128 v[30:33], v3 offset:41984
 v_bitop3_b32 v62, v62, v68, v69 bitop3:0x80
 v_bitop3_b32 v62, v62, v62, s28 bitop3:0xf5
 v_smfmac_f32_16x16x64_bf16 v[42:45], v[14:17], v[120:127], v1
 v_and_b32 v62, 1, v62
 v_smfmac_f32_16x16x64_bf16 v[46:49], v[14:17], v[128:135], v1
 v_cmp_ne_u32 vcc, 1, v62
 s_waitcnt lgkmcnt(5)
 v_smfmac_f32_16x16x64_bf16 v[50:53], v[18:21], a[56:63], v1
 s_cbranch_vccnz L_mbre_53
L_mbok_52:
 s_barrier
 v_smfmac_f32_16x16x64_bf16 v[42:45], v[18:21], v[136:143], v1
 ds_read_b128 v[10:13], v4 offset:4096
 ds_read_b128 v[14:17], v4 offset:4608
 s_waitcnt lgkmcnt(5)
 v_smfmac_f32_16x16x64_bf16 v[46:49], v[18:21], v[34:41], v1
 ds_read_b128 v[34:37], v3 offset:49152
 s_waitcnt lgkmcnt(5)
 v_smfmac_f32_16x16x64_bf16 v[50:53], v[22:25], a[64:71], v1
 ds_read_b128 v[38:41], v3 offset:50176
 v_smfmac_f32_16x16x64_bf16 v[42:45], v[22:25], v[144:151], v1
 ds_read_b128 v[18:21], v4 offset:5120
 s_waitcnt lgkmcnt(5)
 v_smfmac_f32_16x16x64_bf16 v[46:49], v[22:25], v[26:33], v1
 ds_read_b128 v[26:29], v9 offset:0
 s_waitcnt lgkmcnt(5)
 v_smfmac_f32_16x16x64_bf16 v[50:53], v[10:13], a[72:79], v1
 ds_read_b128 v[30:33], v9 offset:1024
 v_smfmac_f32_16x16x64_bf16 v[42:45], v[10:13], v[152:159], v1
 ds_read_b128 v[22:25], v4 offset:5632
 v_smfmac_f32_16x16x64_bf16 v[46:49], v[10:13], v[160:167], v1
 s_waitcnt lgkmcnt(6)
 v_smfmac_f32_16x16x64_bf16 v[50:53], v[14:17], a[80:87], v1
 v_smfmac_f32_16x16x64_bf16 v[42:45], v[14:17], v[168:175], v1
 ds_read_b128 v[10:13], v4 offset:6144
 s_waitcnt lgkmcnt(5)
 v_smfmac_f32_16x16x64_bf16 v[46:49], v[14:17], v[34:41], v1
 ds_read_b128 v[34:37], v9 offset:8192
 s_waitcnt lgkmcnt(5)
 v_smfmac_f32_16x16x64_bf16 v[50:53], v[18:21], a[88:95], v1
 ds_read_b128 v[38:41], v9 offset:9216
 v_smfmac_f32_16x16x64_bf16 v[42:45], v[18:21], v[176:183], v1
 ds_read_b128 v[14:17], v4 offset:6656
 s_waitcnt lgkmcnt(5)
 v_smfmac_f32_16x16x64_bf16 v[46:49], v[18:21], v[26:33], v1
 ds_read_b128 v[26:29], v9 offset:16384
 s_waitcnt lgkmcnt(5)
 v_smfmac_f32_16x16x64_bf16 v[50:53], v[22:25], a[96:103], v1
 ds_read_b128 v[30:33], v9 offset:17408
 v_smfmac_f32_16x16x64_bf16 v[42:45], v[22:25], v[184:191], v1
 ds_read_b128 v[18:21], v4 offset:7168
 v_smfmac_f32_16x16x64_bf16 v[46:49], v[22:25], v[192:199], v1
 ds_read_b128 v[62:65], v9 offset:24576
 s_waitcnt lgkmcnt(7)
 v_smfmac_f32_16x16x64_bf16 v[42:45], v[10:13], v[200:207], v1
 ds_read_b128 v[66:69], v9 offset:25600
 ds_read_b128 v[22:25], v4 offset:7680
 s_waitcnt lgkmcnt(7)
 v_smfmac_f32_16x16x64_bf16 v[46:49], v[10:13], v[34:41], v1
 ds_read_b128 v[34:37], v9 offset:32768
 s_waitcnt lgkmcnt(7)
 v_smfmac_f32_16x16x64_bf16 v[42:45], v[14:17], v[208:215], v1
 ds_read_b128 v[38:41], v9 offset:33792
 ds_read_b128 v[10:13], v4 offset:8192
 s_waitcnt lgkmcnt(7)
 v_smfmac_f32_16x16x64_bf16 v[46:49], v[14:17], v[26:33], v1
 s_waitcnt lgkmcnt(6)
 v_smfmac_f32_16x16x64_bf16 v[42:45], v[18:21], v[216:223], v1
 ds_read_b128 v[14:17], v4 offset:8704
 s_waitcnt lgkmcnt(5)
 v_smfmac_f32_16x16x64_bf16 v[46:49], v[18:21], v[62:69], v1
 s_waitcnt lgkmcnt(4)
 v_smfmac_f32_16x16x64_bf16 v[42:45], v[22:25], v[224:231], v1
 ds_read_b128 v[18:21], v4 offset:6144
 s_waitcnt lgkmcnt(3)
 v_smfmac_f32_16x16x64_bf16 v[46:49], v[22:25], v[34:41], v1
 ds_read_b128 v[66:69], v0 offset:13568
 s_waitcnt lgkmcnt(3)
 v_smfmac_f32_16x16x64_bf16 v[42:45], v[10:13], v[232:239], v1
 ds_read_b128 v[22:25], v4 offset:6656
 v_smfmac_f32_16x16x64_bf16 v[46:49], v[10:13], v[240:247], v1
 ds_read_b128 v[26:29], v0 offset:15744
 ds_read_b128 v[30:33], v0 offset:17792
 s_waitcnt lgkmcnt(5)
 v_smfmac_f32_16x16x64_bf16 v[42:45], v[14:17], v[248:255], v1
 ds_read_b128 v[10:13], v4 offset:7168
 v_smfmac_f32_16x16x64_bf16 v[46:49], v[14:17], a[0:7], v1
 ds_read_b128 v[34:37], v0 offset:19840
 ds_read_b128 v[38:41], v0 offset:21888
 ds_read_b128 v[14:17], v4 offset:7680
 s_waitcnt lgkmcnt(8)
 v_smfmac_f32_16x16x64_bf16 v[50:53], v[18:21], a[104:111], v1
 s_nop 1
 s_waitcnt lgkmcnt(6)
 v_smfmac_f32_16x16x64_bf16 v[50:53], v[22:25], a[112:119], v1
 s_nop 2
 v_cvt_pk_bf16_f32 v62, v42, v43
 v_cvt_pk_bf16_f32 v63, v44, v45
 ds_write_b64 v5, v[62:63]
 v_cvt_pk_bf16_f32 v64, v46, v47
 v_cvt_pk_bf16_f32 v65, v48, v49
 ds_write_b64 v5, v[64:65] offset:2176
 ds_read_b128 v[42:45], v4 offset:8192
 ds_read_b128 v[46:49], v4 offset:8704
 s_waitcnt lgkmcnt(7)
 v_smfmac_f32_16x16x64_bf16 v[50:53], v[10:13], a[120:127], v1
 buffer_store_dwordx4 v[66:69], v0, s[4:7], s65 offen offset:0 sc1
 s_waitcnt lgkmcnt(4)
 v_smfmac_f32_16x16x64_bf16 v[50:53], v[14:17], a[128:135], v1
 s_waitcnt lgkmcnt(2)
 s_barrier
 ds_read_b64_tr_b16 v[10:11], v6 offset:0
 ds_read_b64_tr_b16 v[12:13], v6 offset:64
 ds_read_b64_tr_b16 v[14:15], v6 offset:256
 ds_read_b64_tr_b16 v[16:17], v6 offset:320
 s_waitcnt lgkmcnt(5)
 v_smfmac_f32_16x16x64_bf16 v[50:53], v[42:45], a[136:143], v1
 ds_read_b64_tr_b16 v[18:19], v6 offset:512
 ds_read_b64_tr_b16 v[20:21], v6 offset:576
 ds_read_b64_tr_b16 v[22:23], v6 offset:768
 ds_read_b64_tr_b16 v[24:25], v6 offset:832
 s_waitcnt lgkmcnt(8)
 v_smfmac_f32_16x16x64_bf16 v[50:53], v[46:49], a[144:151], v1
 s_waitcnt lgkmcnt(6)
 v_mfma_f32_16x16x32_bf16 v[42:45], v[26:29], v[10:13], 0
 ds_read_b128 v[26:29], v0 offset:16768
 v_mov_b32 v62, v2
 v_mov_b32 v63, v2
 s_waitcnt lgkmcnt(5)
 v_mfma_f32_16x16x32_bf16 v[42:45], v[30:33], v[14:17], v[42:45]
 ds_read_b128 v[30:33], v0 offset:18816
 v_mov_b32 v64, v2
 v_mov_b32 v65, v2
 s_waitcnt lgkmcnt(4)
 v_mfma_f32_16x16x32_bf16 v[42:45], v[34:37], v[18:21], v[42:45]
 ds_read_b128 v[34:37], v0 offset:20864
 s_waitcnt lgkmcnt(3)
 v_mfma_f32_16x16x32_bf16 v[42:45], v[38:41], v[22:25], v[42:45]
 ds_read_b128 v[38:41], v0 offset:22912
 v_mfma_f32_16x16x32_bf16 v[62:65], v[10:13], v[10:13], v[62:65]
 v_cvt_pk_bf16_f32 v68, v50, v51
 v_cvt_pk_bf16_f32 v69, v52, v53
 v_mfma_f32_16x16x32_bf16 v[62:65], v[14:17], v[14:17], v[62:65]
 ds_write_b64 v5, v[68:69] offset:4352
 v_mov_b64 v[66:67], v[68:69]
 v_mfma_f32_16x16x32_bf16 v[62:65], v[18:21], v[18:21], v[62:65]
 s_nop 0
 v_mul_f32 v42, s62, v42
 v_mul_f32 v43, s62, v43
 v_mfma_f32_16x16x32_bf16 v[62:65], v[22:25], v[22:25], v[62:65]
 v_permlane32_swap_b32 v66, v68
 v_permlane32_swap_b32 v67, v69
 s_waitcnt lgkmcnt(4)
 v_mfma_f32_16x16x32_bf16 v[46:49], v[26:29], v[10:13], 0
 v_mul_f32 v44, s62, v44
 v_mul_f32 v45, s62, v45
 s_waitcnt lgkmcnt(3)
 v_mfma_f32_16x16x32_bf16 v[46:49], v[30:33], v[14:17], v[46:49]
 v_max3_f32 v70, v42, v43, v44
 s_nop 0
 s_waitcnt lgkmcnt(2)
 v_mfma_f32_16x16x32_bf16 v[46:49], v[34:37], v[18:21], v[46:49]
 v_mul_f32 v62, s62, v62
 v_mul_f32 v63, s62, v63
 s_waitcnt lgkmcnt(1)
 v_mfma_f32_16x16x32_bf16 v[46:49], v[38:41], v[22:25], v[46:49]
 v_mul_f32 v64, s62, v64
 v_mul_f32 v65, s62, v65
 v_max3_f32 v70, v70, v45, v62
 v_max3_f32 v71, v63, v64, v65
 v_mov_b64 v[30:31], 0
 v_mov_b64 v[34:35], 0
 v_mov_b64 v[22:23], s[76:77]
 v_mov_b64 v[24:25], s[76:77]
 v_pk_mul_f32 v[46:47], v[46:47], s[62:63]
 v_pk_mul_f32 v[48:49], v[48:49], s[62:63]
 v_max3_f32 v70, v70, v71, v46
 v_max3_f32 v71, v47, v48, v49
 v_max_f32 v21, v70, v71
 v_max_f32 v70, v70, v71
 s_nop 1
 v_permlane16_swap_b32 v70, v21
 v_max_f32 v71, v70, v21
 v_max_f32 v70, v70, v21
 s_nop 1
 v_permlane32_swap_b32 v70, v71
 v_max_f32 v70, v70, v71
 v_pk_add_f32 v[42:43], v[42:43], v[70:71] op_sel_hi:[1,0] neg_lo:[0,1] neg_hi:[0,1]
 v_pk_add_f32 v[44:45], v[44:45], v[70:71] op_sel_hi:[1,0] neg_lo:[0,1] neg_hi:[0,1]
 v_pk_add_f32 v[46:47], v[46:47], v[70:71] op_sel_hi:[1,0] neg_lo:[0,1] neg_hi:[0,1]
 v_pk_add_f32 v[48:49], v[48:49], v[70:71] op_sel_hi:[1,0] neg_lo:[0,1] neg_hi:[0,1]
 v_pk_add_f32 v[62:63], v[62:63], v[70:71] op_sel_hi:[1,0] neg_lo:[0,1] neg_hi:[0,1]
 v_pk_add_f32 v[64:65], v[64:65], v[70:71] op_sel_hi:[1,0] neg_lo:[0,1] neg_hi:[0,1]
 v_exp_f32 v42, v42
 v_exp_f32 v43, v43
 v_exp_f32 v44, v44
 v_exp_f32 v45, v45
 v_exp_f32 v46, v46
 v_exp_f32 v47, v47
 v_exp_f32 v48, v48
 v_exp_f32 v49, v49
 v_exp_f32 v62, v62
 v_cvt_pk_bf16_f32 v26, v42, v43
 v_cvt_pk_bf16_f32 v27, v44, v45
 v_cvt_pk_bf16_f32 v28, v46, v47
 v_cvt_pk_bf16_f32 v29, v48, v49
 v_exp_f32 v63, v63
 s_waitcnt vmcnt(2)
 v_mfma_f32_16x16x32_bf16 v[10:13], v[22:25], v[26:29], 0
 v_exp_f32 v64, v64
 v_mfma_f32_16x16x32_bf16 v[14:17], v[54:57], v[26:29], 0
 v_exp_f32 v65, v65
 v_mfma_f32_16x16x32_bf16 v[36:39], v[58:61], v[26:29], 0
 v_cvt_pk_bf16_f32 v32, v62, v63
 v_cvt_pk_bf16_f32 v33, v64, v65
 s_nop 1
 v_mfma_f32_16x16x32_bf16 v[10:13], v[22:25], v[32:35], v[10:13]
 v_mfma_f32_16x16x32_bf16 v[14:17], v[66:69], v[32:35], v[14:17]
 v_mfma_f32_16x16x32_bf16 v[36:39], v[66:69], v[30:33], v[36:39]
 v_add_u32 v9, 98304, v3
 v_mov_b64 v[52:53], 0
 v_mov_b64 v[54:55], 0
 v_mov_b64 v[56:57], 0
 v_mov_b64 v[58:59], 0
 s_nop 0
 v_rcp_f32 v18, v10
 v_mov_b64 v[60:61], 0
 v_pk_mul_f32 v[14:15], v[14:15], v[18:19] op_sel_hi:[1,0]
 v_pk_mul_f32 v[16:17], v[16:17], v[18:19] op_sel_hi:[1,0]
 v_pk_mul_f32 v[36:37], v[36:37], v[18:19] op_sel_hi:[1,0]
 v_pk_mul_f32 v[38:39], v[38:39], v[18:19] op_sel_hi:[1,0]
 v_cvt_pk_bf16_f32 v22, v14, v15
 v_cvt_pk_bf16_f32 v23, v16, v17
 v_cvt_pk_bf16_f32 v24, v36, v37
 v_cvt_pk_bf16_f32 v25, v38, v39
 ds_write_b128 v7, v[22:25]
 s_add_u32 s50, s50, 1
 v_mov_b64 v[62:63], 0
 v_mov_b64 v[64:65], 0
 v_mov_b64 v[66:67], 0
 s_waitcnt lgkmcnt(0)
 s_barrier
 ds_read_b128 v[10:13], v4 offset:0
 ds_read_b128 v[14:17], v4 offset:512
 ds_read_b128 v[18:21], v4 offset:1024
 ds_read_b128 v[22:25], v4 offset:1536
 s_waitcnt lgkmcnt(3)
 v_smfmac_f32_16x16x64_bf16 v[52:55], v[10:13], a[152:159], v1
 s_waitcnt lgkmcnt(2)
 v_smfmac_f32_16x16x64_bf16 v[52:55], v[14:17], a[160:167], v1
 ds_read_b128 v[26:29], v9 offset:0
 ds_read_b128 v[30:33], v9 offset:1024
 s_waitcnt lgkmcnt(3)
 v_smfmac_f32_16x16x64_bf16 v[52:55], v[18:21], a[168:175], v1
 s_waitcnt lgkmcnt(2)
 v_smfmac_f32_16x16x64_bf16 v[52:55], v[22:25], a[176:183], v1
 ds_read_b128 v[34:37], v9 offset:8192
 ds_read_b128 v[38:41], v9 offset:9216
 v_smfmac_f32_16x16x64_bf16 v[56:59], v[10:13], a[184:191], v1
 s_nop 2
 v_smfmac_f32_16x16x64_bf16 v[56:59], v[14:17], a[192:199], v1
 ds_read_b128 v[42:45], v9 offset:16384
 ds_read_b128 v[46:49], v9 offset:17408
 s_nop 0
 v_smfmac_f32_16x16x64_bf16 v[56:59], v[18:21], a[200:207], v1
 v_cvt_pk_bf16_f32 v52, v52, v53
 v_smfmac_f32_16x16x64_bf16 v[56:59], v[22:25], a[208:215], v1
 v_cvt_pk_bf16_f32 v53, v54, v55
 v_smfmac_f32_16x16x64_bf16 v[60:63], v[10:13], a[216:223], v1
 s_nop 1
 v_and_b32 v52, -2, v52
 v_smfmac_f32_16x16x64_bf16 v[60:63], v[14:17], a[224:231], v1
 s_nop 2
 s_waitcnt lgkmcnt(4)
 v_smfmac_f32_16x16x64_bf16 v[60:63], v[18:21], v[26:33], v1
 v_cvt_pk_bf16_f32 v56, v56, v57
 v_smfmac_f32_16x16x64_bf16 v[60:63], v[22:25], a[232:239], v1
 v_cvt_pk_bf16_f32 v57, v58, v59
 s_waitcnt lgkmcnt(2)
 v_smfmac_f32_16x16x64_bf16 v[64:67], v[10:13], v[34:41], v1
 s_nop 0
 buffer_store_dwordx2 v[52:53], v8, s[4:7], s55 offen
 v_and_b32 v56, -2, v56
 v_smfmac_f32_16x16x64_bf16 v[64:67], v[14:17], a[240:247], v1
 s_nop 2
 s_waitcnt lgkmcnt(0)
 v_smfmac_f32_16x16x64_bf16 v[64:67], v[18:21], v[42:49], v1
 v_cvt_pk_bf16_f32 v60, v60, v61
 v_smfmac_f32_16x16x64_bf16 v[64:67], v[22:25], a[248:255], v1
 v_cvt_pk_bf16_f32 v61, v62, v63
 buffer_store_dwordx2 v[56:57], v8, s[4:7], s56 offen
 v_and_b32 v60, -2, v60
 buffer_store_dwordx2 v[60:61], v8, s[4:7], s57 offen
 s_add_u32 s52, s52, 262144
 s_add_u32 s65, s65, s27
 s_mov_b64 s[28:29], -1
 s_sub_i32 s64, s50, s71
 s_mov_b32 s27, 131072
 v_cvt_pk_bf16_f32 v64, v64, v65
 v_cvt_pk_bf16_f32 v65, v66, v67
 v_and_b32 v64, -2, v64
 buffer_store_dwordx2 v[64:65], v8, s[4:7], s58 offen
 s_barrier
 s_nop 15
 s_nop 15
 s_nop 15
 s_nop 7
 buffer_load_dwordx4 v[10:13], v0, s[4:7], s60 offen offset:0 sc1
 buffer_load_dwordx4 v[14:17], v0, s[4:7], s60 offen offset:1024 sc1
 buffer_load_dwordx4 v[18:21], v0, s[4:7], s60 offen offset:2048 sc1
 buffer_load_dwordx4 v[22:25], v0, s[4:7], s60 offen offset:3072 sc1
 v_and_b32 v34, 16, v0
 v_mov_b32 v30, 0x3f80
 v_lshlrev_b32 v30, v34, v30
 v_bfe_u32 v34, v0, 5, 3
 v_cmp_eq_u32 vcc, 0, v34
 s_nop 1
 v_cndmask_b32 v26, 0, v30, vcc
 v_cmp_eq_u32 vcc, 1, v34
 s_nop 1
 v_cndmask_b32 v27, 0, v30, vcc
 v_cmp_eq_u32 vcc, 2, v34
 s_nop 1
 v_cndmask_b32 v28, 0, v30, vcc
 v_cmp_eq_u32 vcc, 3, v34
 s_nop 1
 v_cndmask_b32 v29, 0, v30, vcc
 v_and_b32 v35, 0xf0, v0
 v_bfe_u32 v34, v0, 8, 2
 v_lshl_add_u32 v35, v34, 2, v35
 v_and_b32 v34, 0x80, v0
 v_lshl_add_u32 v35, v34, 23, v35
 v_mov_b64 v[42:43], 0
 v_mov_b64 v[44:45], 0
 v_mov_b64 v[46:47], 0
 v_mov_b64 v[48:49], 0
 v_mov_b64 v[50:51], 0
 v_mov_b64 v[52:53], 0
 v_and_b32 v70, 0xf0, v0
 v_bfe_u32 v71, v0, 8, 2
 v_lshl_add_u32 v71, v71, 9, s67
 v_add_u32 v70, v70, v71
 v_add_u32 v9, 57344, v3
 s_barrier
 s_waitcnt vmcnt(3)
 v_mfma_f32_16x16x32_bf16 v[30:33], v[10:13], v[26:29], 0
 v_bitop3_b32 v34, v10, v12, v12 bitop3:0xfe
 s_waitcnt vmcnt(2)
 v_mfma_f32_16x16x32_bf16 v[30:33], v[14:17], v[26:29], v[30:33]
 v_bitop3_b32 v34, v34, v14, v16 bitop3:0xfe
 s_waitcnt vmcnt(1)
 v_mfma_f32_16x16x32_bf16 v[30:33], v[18:21], v[26:29], v[30:33]
 v_bitop3_b32 v34, v34, v18, v20 bitop3:0xfe
 s_waitcnt vmcnt(0)
 v_mfma_f32_16x16x32_bf16 v[30:33], v[22:25], v[26:29], v[30:33]
 v_bitop3_b32 v34, v34, v22, v24 bitop3:0xfe
 v_and_b32 v34, 1, v34
 v_cmp_ne_u32 vcc, 0, v34
 s_cbranch_vccnz L_rre_56
 s_nop 3
 v_permlane32_swap_b32 v30, v31
 v_permlane32_swap_b32 v32, v33
 v_add_f32 v30, v30, v31
 v_add_f32 v32, v32, v33
 v_cvt_pk_bf16_f32 v30, v30, v32
 v_and_b32 v30, -2, v30
 buffer_store_dword v30, v35, s[4:7], s61 offen
L_rback_57:
L_redj_55:
 ds_read_b128 v[26:29], v3 offset:0
 ds_read_b128 v[30:33], v3 offset:1024
 ds_read_b128 v[62:65], v3 offset:8192
 ds_read_b128 v[66:69], v3 offset:9216
 ds_read_b128 v[34:37], v3 offset:16384
 ds_read_b128 v[38:41], v3 offset:17408
 s_barrier
 s_mov_b32 m0, 4096
 s_nop 0
 buffer_load_dwordx4 v0, s[4:7], s25 offen offset:0 sc1 lds
 buffer_load_dwordx4 v0, s[4:7], s25 offen offset:1024 sc1 lds
 s_cmp_eq_u32 s50, 63
 s_cbranch_scc1 L_last_50
 s_waitcnt lgkmcnt(0)
 s_barrier
 s_mov_b32 s51, 0
 ds_read_b128 v[10:13], v4 offset:0
 ds_read_b128 v[14:17], v4 offset:512
 ds_read_b128 v[18:21], v4 offset:1024
 s_add_u32 s72, s52, 16777216
 buffer_load_dwordx4 v[54:57], v70, s[4:7], s72 offen sc1
 buffer_load_dwordx4 v[58:61], v70, s[4:7], s72 offen offset:256 sc1
 s_waitcnt lgkmcnt(2)
 v_smfmac_f32_16x16x64_bf16 v[50:53], v[10:13], a[8:15], v1
 v_lshlrev_b32 v71, 2, v0
 v_smfmac_f32_16x16x64_bf16 v[42:45], v[10:13], v[72:79], v1
 ds_read_b128 v[22:25], v4 offset:1536
 v_smfmac_f32_16x16x64_bf16 v[46:49], v[10:13], v[80:87], v1
 s_mov_b32 m0, 4096
 s_cmp_eq_u32 s50, 0
 s_cbranch_scc1 L_mb2skip_58
 buffer_load_dwordx4 v0, s[4:7], s25 offen offset:0 sc1 lds
 buffer_load_dwordx4 v0, s[4:7], s25 offen offset:1024 sc1 lds
L_mb2skip_58:
 s_waitcnt lgkmcnt(2)
 v_smfmac_f32_16x16x64_bf16 v[50:53], v[14:17], a[16:23], v1
 v_smfmac_f32_16x16x64_bf16 v[42:45], v[14:17], v[88:95], v1
 ds_read_b128 v[10:13], v4 offset:2048
 v_smfmac_f32_16x16x64_bf16 v[46:49], v[14:17], v[26:33], v1
 ds_read_b128 v[26:29], v3 offset:24576
 s_add_u32 s73, s52, 524288
 s_min_u32 s73, s73, 16515072
 s_add_u32 s73, s73, s68
 s_waitcnt lgkmcnt(3)
 v_smfmac_f32_16x16x64_bf16 v[50:53], v[18:21], a[24:31], v1
 ds_read_b128 v[30:33], v3 offset:25600
 v_smfmac_f32_16x16x64_bf16 v[42:45], v[18:21], v[96:103], v1
 ds_read_b128 v[14:17], v4 offset:2560
 s_mov_b32 m0, 23936
 s_nop 0
 buffer_load_dword v71, s[4:7], s73 offen sc1 lds
 v_smfmac_f32_16x16x64_bf16 v[46:49], v[18:21], v[62:69], v1
 s_waitcnt vmcnt(5)
 ds_read_b128 v[62:65], v0 offset:4096
 ds_read_b128 v[66:69], v0 offset:5120
 s_waitcnt lgkmcnt(6)
 v_smfmac_f32_16x16x64_bf16 v[50:53], v[22:25], a[32:39], v1
 v_smfmac_f32_16x16x64_bf16 v[42:45], v[22:25], v[104:111], v1
 ds_read_b128 v[18:21], v4 offset:3072
 v_smfmac_f32_16x16x64_bf16 v[46:49], v[22:25], v[34:41], v1
 ds_read_b128 v[34:37], v3 offset:32768
 s_waitcnt lgkmcnt(7)
 v_smfmac_f32_16x16x64_bf16 v[50:53], v[10:13], a[40:47], v1
 ds_read_b128 v[38:41], v3 offset:33792
 v_smfmac_f32_16x16x64_bf16 v[42:45], v[10:13], v[112:119], v1
 s_waitcnt lgkmcnt(3)
 ds_read_b128 v[22:25], v4 offset:3584
 v_bitop3_b32 v62, v62, v63, v64 bitop3:0xfe
 v_bitop3_b32 v62, v62, v65, v65 bitop3:0xfe
 v_smfmac_f32_16x16x64_bf16 v[46:49], v[10:13], v[26:33], v1
 ds_read_b128 v[26:29], v3 offset:40960
 v_bitop3_b32 v62, v62, v66, v67 bitop3:0xfe
 v_smfmac_f32_16x16x64_bf16 v[50:53], v[14:17], a[48:55], v1
 ds_read_b128 v[30:33], v3 offset:41984
 v_bitop3_b32 v62, v62, v68, v69 bitop3:0xfe
 v_bitop3_b32 v62, v62, v62, s28 bitop3:0xa0
 v_smfmac_f32_16x16x64_bf16 v[42:45], v[14:17], v[120:127], v1
 v_and_b32 v62, 1, v62
 v_smfmac_f32_16x16x64_bf16 v[46:49], v[14:17], v[128:135], v1
 v_cmp_ne_u32 vcc, 0, v62
 s_waitcnt lgkmcnt(5)
 v_smfmac_f32_16x16x64_bf16 v[50:53], v[18:21], a[56:63], v1
 s_cbranch_vccnz L_mbre_60
L_mbok_59:
 s_barrier
 v_smfmac_f32_16x16x64_bf16 v[42:45], v[18:21], v[136:143], v1
 ds_read_b128 v[10:13], v4 offset:4096
 ds_read_b128 v[14:17], v4 offset:4608
 s_waitcnt lgkmcnt(5)
 v_smfmac_f32_16x16x64_bf16 v[46:49], v[18:21], v[34:41], v1
 ds_read_b128 v[34:37], v3 offset:49152
 s_waitcnt lgkmcnt(5)
 v_smfmac_f32_16x16x64_bf16 v[50:53], v[22:25], a[64:71], v1
 ds_read_b128 v[38:41], v3 offset:50176
 v_smfmac_f32_16x16x64_bf16 v[42:45], v[22:25], v[144:151], v1
 ds_read_b128 v[18:21], v4 offset:5120
 s_waitcnt lgkmcnt(5)
 v_smfmac_f32_16x16x64_bf16 v[46:49], v[22:25], v[26:33], v1
 ds_read_b128 v[26:29], v9 offset:0
 s_waitcnt lgkmcnt(5)
 v_smfmac_f32_16x16x64_bf16 v[50:53], v[10:13], a[72:79], v1
 ds_read_b128 v[30:33], v9 offset:1024
 v_smfmac_f32_16x16x64_bf16 v[42:45], v[10:13], v[152:159], v1
 ds_read_b128 v[22:25], v4 offset:5632
 v_smfmac_f32_16x16x64_bf16 v[46:49], v[10:13], v[160:167], v1
 s_waitcnt lgkmcnt(6)
 v_smfmac_f32_16x16x64_bf16 v[50:53], v[14:17], a[80:87], v1
 v_smfmac_f32_16x16x64_bf16 v[42:45], v[14:17], v[168:175], v1
 ds_read_b128 v[10:13], v4 offset:6144
 s_waitcnt lgkmcnt(5)
 v_smfmac_f32_16x16x64_bf16 v[46:49], v[14:17], v[34:41], v1
 ds_read_b128 v[34:37], v9 offset:8192
 s_waitcnt lgkmcnt(5)
 v_smfmac_f32_16x16x64_bf16 v[50:53], v[18:21], a[88:95], v1
 ds_read_b128 v[38:41], v9 offset:9216
 v_smfmac_f32_16x16x64_bf16 v[42:45], v[18:21], v[176:183], v1
 ds_read_b128 v[14:17], v4 offset:6656
 s_waitcnt lgkmcnt(5)
 v_smfmac_f32_16x16x64_bf16 v[46:49], v[18:21], v[26:33], v1
 ds_read_b128 v[26:29], v9 offset:16384
 s_waitcnt lgkmcnt(5)
 v_smfmac_f32_16x16x64_bf16 v[50:53], v[22:25], a[96:103], v1
 ds_read_b128 v[30:33], v9 offset:17408
 v_smfmac_f32_16x16x64_bf16 v[42:45], v[22:25], v[184:191], v1
 ds_read_b128 v[18:21], v4 offset:7168
 v_smfmac_f32_16x16x64_bf16 v[46:49], v[22:25], v[192:199], v1
 ds_read_b128 v[62:65], v9 offset:24576
 s_waitcnt lgkmcnt(7)
 v_smfmac_f32_16x16x64_bf16 v[42:45], v[10:13], v[200:207], v1
 ds_read_b128 v[66:69], v9 offset:25600
 ds_read_b128 v[22:25], v4 offset:7680
 s_waitcnt lgkmcnt(7)
 v_smfmac_f32_16x16x64_bf16 v[46:49], v[10:13], v[34:41], v1
 ds_read_b128 v[34:37], v9 offset:32768
 s_waitcnt lgkmcnt(7)
 v_smfmac_f32_16x16x64_bf16 v[42:45], v[14:17], v[208:215], v1
 ds_read_b128 v[38:41], v9 offset:33792
 ds_read_b128 v[10:13], v4 offset:8192
 s_waitcnt lgkmcnt(7)
 v_smfmac_f32_16x16x64_bf16 v[46:49], v[14:17], v[26:33], v1
 s_waitcnt lgkmcnt(6)
 v_smfmac_f32_16x16x64_bf16 v[42:45], v[18:21], v[216:223], v1
 ds_read_b128 v[14:17], v4 offset:8704
 s_waitcnt lgkmcnt(5)
 v_smfmac_f32_16x16x64_bf16 v[46:49], v[18:21], v[62:69], v1
 s_waitcnt lgkmcnt(4)
 v_smfmac_f32_16x16x64_bf16 v[42:45], v[22:25], v[224:231], v1
 ds_read_b128 v[18:21], v4 offset:6144
 s_waitcnt lgkmcnt(3)
 v_smfmac_f32_16x16x64_bf16 v[46:49], v[22:25], v[34:41], v1
 ds_read_b128 v[66:69], v0 offset:13568
 s_waitcnt lgkmcnt(3)
 v_smfmac_f32_16x16x64_bf16 v[42:45], v[10:13], v[232:239], v1
 ds_read_b128 v[22:25], v4 offset:6656
 v_smfmac_f32_16x16x64_bf16 v[46:49], v[10:13], v[240:247], v1
 ds_read_b128 v[26:29], v0 offset:15744
 ds_read_b128 v[30:33], v0 offset:17792
 s_waitcnt lgkmcnt(5)
 v_smfmac_f32_16x16x64_bf16 v[42:45], v[14:17], v[248:255], v1
 ds_read_b128 v[10:13], v4 offset:7168
 v_smfmac_f32_16x16x64_bf16 v[46:49], v[14:17], a[0:7], v1
 ds_read_b128 v[34:37], v0 offset:19840
 ds_read_b128 v[38:41], v0 offset:21888
 ds_read_b128 v[14:17], v4 offset:7680
 s_waitcnt lgkmcnt(8)
 v_smfmac_f32_16x16x64_bf16 v[50:53], v[18:21], a[104:111], v1
 s_nop 1
 s_waitcnt lgkmcnt(6)
 v_smfmac_f32_16x16x64_bf16 v[50:53], v[22:25], a[112:119], v1
 s_nop 2
 v_cvt_pk_bf16_f32 v62, v42, v43
 v_cvt_pk_bf16_f32 v63, v44, v45
 ds_write_b64 v5, v[62:63]
 v_cvt_pk_bf16_f32 v64, v46, v47
 v_cvt_pk_bf16_f32 v65, v48, v49
 ds_write_b64 v5, v[64:65] offset:2176
 ds_read_b128 v[42:45], v4 offset:8192
 ds_read_b128 v[46:49], v4 offset:8704
 s_waitcnt lgkmcnt(7)
 v_smfmac_f32_16x16x64_bf16 v[50:53], v[10:13], a[120:127], v1
 buffer_store_dwordx4 v[66:69], v0, s[4:7], s65 offen offset:0 sc1
 s_waitcnt lgkmcnt(4)
 v_smfmac_f32_16x16x64_bf16 v[50:53], v[14:17], a[128:135], v1
 s_waitcnt lgkmcnt(2)
 s_barrier
 ds_read_b64_tr_b16 v[10:11], v6 offset:0
 ds_read_b64_tr_b16 v[12:13], v6 offset:64
 ds_read_b64_tr_b16 v[14:15], v6 offset:256
 ds_read_b64_tr_b16 v[16:17], v6 offset:320
 s_waitcnt lgkmcnt(5)
 v_smfmac_f32_16x16x64_bf16 v[50:53], v[42:45], a[136:143], v1
 ds_read_b64_tr_b16 v[18:19], v6 offset:512
 ds_read_b64_tr_b16 v[20:21], v6 offset:576
 ds_read_b64_tr_b16 v[22:23], v6 offset:768
 ds_read_b64_tr_b16 v[24:25], v6 offset:832
 s_waitcnt lgkmcnt(8)
 v_smfmac_f32_16x16x64_bf16 v[50:53], v[46:49], a[144:151], v1
 s_waitcnt lgkmcnt(6)
 v_mfma_f32_16x16x32_bf16 v[42:45], v[26:29], v[10:13], 0
 ds_read_b128 v[26:29], v0 offset:16768
 v_mov_b32 v62, v2
 v_mov_b32 v63, v2
 s_waitcnt lgkmcnt(5)
 v_mfma_f32_16x16x32_bf16 v[42:45], v[30:33], v[14:17], v[42:45]
 ds_read_b128 v[30:33], v0 offset:18816
 v_mov_b32 v64, v2
 v_mov_b32 v65, v2
 s_waitcnt lgkmcnt(4)
 v_mfma_f32_16x16x32_bf16 v[42:45], v[34:37], v[18:21], v[42:45]
 ds_read_b128 v[34:37], v0 offset:20864
 s_waitcnt lgkmcnt(3)
 v_mfma_f32_16x16x32_bf16 v[42:45], v[38:41], v[22:25], v[42:45]
 ds_read_b128 v[38:41], v0 offset:22912
 v_mfma_f32_16x16x32_bf16 v[62:65], v[10:13], v[10:13], v[62:65]
 v_cvt_pk_bf16_f32 v68, v50, v51
 v_cvt_pk_bf16_f32 v69, v52, v53
 v_mfma_f32_16x16x32_bf16 v[62:65], v[14:17], v[14:17], v[62:65]
 ds_write_b64 v5, v[68:69] offset:4352
 v_mov_b64 v[66:67], v[68:69]
 v_mfma_f32_16x16x32_bf16 v[62:65], v[18:21], v[18:21], v[62:65]
 s_nop 0
 v_mul_f32 v42, s62, v42
 v_mul_f32 v43, s62, v43
 v_mfma_f32_16x16x32_bf16 v[62:65], v[22:25], v[22:25], v[62:65]
 v_permlane32_swap_b32 v66, v68
 v_permlane32_swap_b32 v67, v69
 s_waitcnt lgkmcnt(4)
 v_mfma_f32_16x16x32_bf16 v[46:49], v[26:29], v[10:13], 0
 v_mul_f32 v44, s62, v44
 v_mul_f32 v45, s62, v45
 s_waitcnt lgkmcnt(3)
 v_mfma_f32_16x16x32_bf16 v[46:49], v[30:33], v[14:17], v[46:49]
 v_max3_f32 v70, v42, v43, v44
 s_nop 0
 s_waitcnt lgkmcnt(2)
 v_mfma_f32_16x16x32_bf16 v[46:49], v[34:37], v[18:21], v[46:49]
 v_mul_f32 v62, s62, v62
 v_mul_f32 v63, s62, v63
 s_waitcnt lgkmcnt(1)
 v_mfma_f32_16x16x32_bf16 v[46:49], v[38:41], v[22:25], v[46:49]
 v_mul_f32 v64, s62, v64
 v_mul_f32 v65, s62, v65
 v_max3_f32 v70, v70, v45, v62
 v_max3_f32 v71, v63, v64, v65
 v_mov_b64 v[30:31], 0
 v_mov_b64 v[34:35], 0
 v_mov_b64 v[22:23], s[76:77]
 v_mov_b64 v[24:25], s[76:77]
 v_pk_mul_f32 v[46:47], v[46:47], s[62:63]
 v_pk_mul_f32 v[48:49], v[48:49], s[62:63]
 v_max3_f32 v70, v70, v71, v46
 v_max3_f32 v71, v47, v48, v49
 v_max_f32 v21, v70, v71
 v_max_f32 v70, v70, v71
 s_nop 1
 v_permlane16_swap_b32 v70, v21
 v_max_f32 v71, v70, v21
 v_max_f32 v70, v70, v21
 s_nop 1
 v_permlane32_swap_b32 v70, v71
 v_max_f32 v70, v70, v71
 v_pk_add_f32 v[42:43], v[42:43], v[70:71] op_sel_hi:[1,0] neg_lo:[0,1] neg_hi:[0,1]
 v_pk_add_f32 v[44:45], v[44:45], v[70:71] op_sel_hi:[1,0] neg_lo:[0,1] neg_hi:[0,1]
 v_pk_add_f32 v[46:47], v[46:47], v[70:71] op_sel_hi:[1,0] neg_lo:[0,1] neg_hi:[0,1]
 v_pk_add_f32 v[48:49], v[48:49], v[70:71] op_sel_hi:[1,0] neg_lo:[0,1] neg_hi:[0,1]
 v_pk_add_f32 v[62:63], v[62:63], v[70:71] op_sel_hi:[1,0] neg_lo:[0,1] neg_hi:[0,1]
 v_pk_add_f32 v[64:65], v[64:65], v[70:71] op_sel_hi:[1,0] neg_lo:[0,1] neg_hi:[0,1]
 v_exp_f32 v42, v42
 v_exp_f32 v43, v43
 v_exp_f32 v44, v44
 v_exp_f32 v45, v45
 v_exp_f32 v46, v46
 v_exp_f32 v47, v47
 v_exp_f32 v48, v48
 v_exp_f32 v49, v49
 v_exp_f32 v62, v62
 v_cvt_pk_bf16_f32 v26, v42, v43
 v_cvt_pk_bf16_f32 v27, v44, v45
 v_cvt_pk_bf16_f32 v28, v46, v47
 v_cvt_pk_bf16_f32 v29, v48, v49
 v_exp_f32 v63, v63
 s_waitcnt vmcnt(2)
 v_mfma_f32_16x16x32_bf16 v[10:13], v[22:25], v[26:29], 0
 v_exp_f32 v64, v64
 v_mfma_f32_16x16x32_bf16 v[14:17], v[54:57], v[26:29], 0
 v_exp_f32 v65, v65
 v_mfma_f32_16x16x32_bf16 v[36:39], v[58:61], v[26:29], 0
 v_cvt_pk_bf16_f32 v32, v62, v63
 v_cvt_pk_bf16_f32 v33, v64, v65
 s_nop 1
 v_mfma_f32_16x16x32_bf16 v[10:13], v[22:25], v[32:35], v[10:13]
 v_mfma_f32_16x16x32_bf16 v[14:17], v[66:69], v[32:35], v[14:17]
 v_mfma_f32_16x16x32_bf16 v[36:39], v[66:69], v[30:33], v[36:39]
 v_add_u32 v9, 98304, v3
 v_mov_b64 v[52:53], 0
 v_mov_b64 v[54:55], 0
 v_mov_b64 v[56:57], 0
 v_mov_b64 v[58:59], 0
 s_nop 0
 v_rcp_f32 v18, v10
 v_mov_b64 v[60:61], 0
 v_pk_mul_f32 v[14:15], v[14:15], v[18:19] op_sel_hi:[1,0]
 v_pk_mul_f32 v[16:17], v[16:17], v[18:19] op_sel_hi:[1,0]
 v_pk_mul_f32 v[36:37], v[36:37], v[18:19] op_sel_hi:[1,0]
 v_pk_mul_f32 v[38:39], v[38:39], v[18:19] op_sel_hi:[1,0]
 v_cvt_pk_bf16_f32 v22, v14, v15
 v_cvt_pk_bf16_f32 v23, v16, v17
 v_cvt_pk_bf16_f32 v24, v36, v37
 v_cvt_pk_bf16_f32 v25, v38, v39
 ds_write_b128 v7, v[22:25]
 s_add_u32 s50, s50, 1
 v_mov_b64 v[62:63], 0
 v_mov_b64 v[64:65], 0
 v_mov_b64 v[66:67], 0
 s_waitcnt lgkmcnt(0)
 s_barrier
 ds_read_b128 v[10:13], v4 offset:0
 ds_read_b128 v[14:17], v4 offset:512
 ds_read_b128 v[18:21], v4 offset:1024
 ds_read_b128 v[22:25], v4 offset:1536
 s_waitcnt lgkmcnt(3)
 v_smfmac_f32_16x16x64_bf16 v[52:55], v[10:13], a[152:159], v1
 s_waitcnt lgkmcnt(2)
 v_smfmac_f32_16x16x64_bf16 v[52:55], v[14:17], a[160:167], v1
 ds_read_b128 v[26:29], v9 offset:0
 ds_read_b128 v[30:33], v9 offset:1024
 s_waitcnt lgkmcnt(3)
 v_smfmac_f32_16x16x64_bf16 v[52:55], v[18:21], a[168:175], v1
 s_waitcnt lgkmcnt(2)
 v_smfmac_f32_16x16x64_bf16 v[52:55], v[22:25], a[176:183], v1
 ds_read_b128 v[34:37], v9 offset:8192
 ds_read_b128 v[38:41], v9 offset:9216
 v_smfmac_f32_16x16x64_bf16 v[56:59], v[10:13], a[184:191], v1
 s_nop 2
 v_smfmac_f32_16x16x64_bf16 v[56:59], v[14:17], a[192:199], v1
 ds_read_b128 v[42:45], v9 offset:16384
 ds_read_b128 v[46:49], v9 offset:17408
 s_nop 0
 v_smfmac_f32_16x16x64_bf16 v[56:59], v[18:21], a[200:207], v1
 v_cvt_pk_bf16_f32 v52, v52, v53
 v_smfmac_f32_16x16x64_bf16 v[56:59], v[22:25], a[208:215], v1
 v_cvt_pk_bf16_f32 v53, v54, v55
 v_smfmac_f32_16x16x64_bf16 v[60:63], v[10:13], a[216:223], v1
 s_nop 1
 v_or_b32 v52, 1, v52
 v_smfmac_f32_16x16x64_bf16 v[60:63], v[14:17], a[224:231], v1
 s_nop 2
 s_waitcnt lgkmcnt(4)
 v_smfmac_f32_16x16x64_bf16 v[60:63], v[18:21], v[26:33], v1
 v_cvt_pk_bf16_f32 v56, v56, v57
 v_smfmac_f32_16x16x64_bf16 v[60:63], v[22:25], a[232:239], v1
 v_cvt_pk_bf16_f32 v57, v58, v59
 s_waitcnt lgkmcnt(2)
 v_smfmac_f32_16x16x64_bf16 v[64:67], v[10:13], v[34:41], v1
 s_nop 0
 buffer_store_dwordx2 v[52:53], v8, s[4:7], s55 offen
 v_or_b32 v56, 1, v56
 v_smfmac_f32_16x16x64_bf16 v[64:67], v[14:17], a[240:247], v1
 s_nop 2
 s_waitcnt lgkmcnt(0)
 v_smfmac_f32_16x16x64_bf16 v[64:67], v[18:21], v[42:49], v1
 v_cvt_pk_bf16_f32 v60, v60, v61
 v_smfmac_f32_16x16x64_bf16 v[64:67], v[22:25], a[248:255], v1
 v_cvt_pk_bf16_f32 v61, v62, v63
 buffer_store_dwordx2 v[56:57], v8, s[4:7], s56 offen
 v_or_b32 v60, 1, v60
 buffer_store_dwordx2 v[60:61], v8, s[4:7], s57 offen
 s_add_u32 s52, s52, 262144
 s_add_u32 s65, s65, s27
 s_mov_b64 s[28:29], -1
 s_sub_i32 s64, s50, s71
 s_mov_b32 s27, 131072
 v_cvt_pk_bf16_f32 v64, v64, v65
 v_cvt_pk_bf16_f32 v65, v66, v67
 v_or_b32 v64, 1, v64
 buffer_store_dwordx2 v[64:65], v8, s[4:7], s58 offen
 s_barrier
 s_nop 15
 s_nop 15
 s_nop 15
 s_nop 7
 buffer_load_dwordx4 v[10:13], v0, s[4:7], s60 offen offset:0 sc1
 buffer_load_dwordx4 v[14:17], v0, s[4:7], s60 offen offset:1024 sc1
 buffer_load_dwordx4 v[18:21], v0, s[4:7], s60 offen offset:2048 sc1
 buffer_load_dwordx4 v[22:25], v0, s[4:7], s60 offen offset:3072 sc1
 v_and_b32 v34, 16, v0
 v_mov_b32 v30, 0x3f80
 v_lshlrev_b32 v30, v34, v30
 v_bfe_u32 v34, v0, 5, 3
 v_cmp_eq_u32 vcc, 0, v34
 s_nop 1
 v_cndmask_b32 v26, 0, v30, vcc
 v_cmp_eq_u32 vcc, 1, v34
 s_nop 1
 v_cndmask_b32 v27, 0, v30, vcc
 v_cmp_eq_u32 vcc, 2, v34
 s_nop 1
 v_cndmask_b32 v28, 0, v30, vcc
 v_cmp_eq_u32 vcc, 3, v34
 s_nop 1
 v_cndmask_b32 v29, 0, v30, vcc
 v_and_b32 v35, 0xf0, v0
 v_bfe_u32 v34, v0, 8, 2
 v_lshl_add_u32 v35, v34, 2, v35
 v_and_b32 v34, 0x80, v0
 v_lshl_add_u32 v35, v34, 23, v35
 v_mov_b64 v[42:43], 0
 v_mov_b64 v[44:45], 0
 v_mov_b64 v[46:47], 0
 v_mov_b64 v[48:49], 0
 v_mov_b64 v[50:51], 0
 v_mov_b64 v[52:53], 0
 v_and_b32 v70, 0xf0, v0
 v_bfe_u32 v71, v0, 8, 2
 v_lshl_add_u32 v71, v71, 9, s67
 v_add_u32 v70, v70, v71
 v_add_u32 v9, 57344, v3
 s_barrier
 s_waitcnt vmcnt(3)
 v_mfma_f32_16x16x32_bf16 v[30:33], v[10:13], v[26:29], 0
 v_bitop3_b32 v34, v10, v12, v12 bitop3:0x80
 s_waitcnt vmcnt(2)
 v_mfma_f32_16x16x32_bf16 v[30:33], v[14:17], v[26:29], v[30:33]
 v_bitop3_b32 v34, v34, v14, v16 bitop3:0x80
 s_waitcnt vmcnt(1)
 v_mfma_f32_16x16x32_bf16 v[30:33], v[18:21], v[26:29], v[30:33]
 v_bitop3_b32 v34, v34, v18, v20 bitop3:0x80
 s_waitcnt vmcnt(0)
 v_mfma_f32_16x16x32_bf16 v[30:33], v[22:25], v[26:29], v[30:33]
 v_bitop3_b32 v34, v34, v22, v24 bitop3:0x80
 v_and_b32 v34, 1, v34
 v_cmp_ne_u32 vcc, 1, v34
 s_cbranch_vccnz L_rre_63
 s_nop 3
 v_permlane32_swap_b32 v30, v31
 v_permlane32_swap_b32 v32, v33
 v_add_f32 v30, v30, v31
 v_add_f32 v32, v32, v33
 v_cvt_pk_bf16_f32 v30, v30, v32
 v_or_b32 v30, 1, v30
 buffer_store_dword v30, v35, s[4:7], s61 offen
L_rback_64:
L_redj_62:
 ds_read_b128 v[26:29], v3 offset:0
 ds_read_b128 v[30:33], v3 offset:1024
 ds_read_b128 v[62:65], v3 offset:8192
 ds_read_b128 v[66:69], v3 offset:9216
 ds_read_b128 v[34:37], v3 offset:16384
 ds_read_b128 v[38:41], v3 offset:17408
 s_barrier
 s_mov_b32 m0, 4096
 s_nop 0
 buffer_load_dwordx4 v0, s[4:7], s25 offen offset:0 sc1 lds
 buffer_load_dwordx4 v0, s[4:7], s25 offen offset:1024 sc1 lds
 s_branch L_loop_49
L_last_50:
 s_waitcnt lgkmcnt(0)
 s_barrier
 ds_read_b128 v[10:13], v4 offset:0
 ds_read_b128 v[14:17], v4 offset:512
 ds_read_b128 v[18:21], v4 offset:1024
 s_waitcnt lgkmcnt(2)
 v_smfmac_f32_16x16x64_bf16 v[50:53], v[10:13], a[8:15], v1
 v_smfmac_f32_16x16x64_bf16 v[42:45], v[10:13], v[72:79], v1
 ds_read_b128 v[22:25], v4 offset:1536
 v_smfmac_f32_16x16x64_bf16 v[46:49], v[10:13], v[80:87], v1
 s_mov_b32 m0, 4096
 s_cmp_eq_u32 s50, 0
 s_cbranch_scc1 L_mb2skip_65
 buffer_load_dwordx4 v0, s[4:7], s25 offen offset:0 sc1 lds
 buffer_load_dwordx4 v0, s[4:7], s25 offen offset:1024 sc1 lds
L_mb2skip_65:
 s_waitcnt lgkmcnt(2)
 v_smfmac_f32_16x16x64_bf16 v[50:53], v[14:17], a[16:23], v1
 v_smfmac_f32_16x16x64_bf16 v[42:45], v[14:17], v[88:95], v1
 ds_read_b128 v[10:13], v4 offset:2048
 v_smfmac_f32_16x16x64_bf16 v[46:49], v[14:17], v[26:33], v1
 ds_read_b128 v[26:29], v3 offset:24576
 s_waitcnt lgkmcnt(3)
 v_smfmac_f32_16x16x64_bf16 v[50:53], v[18:21], a[24:31], v1
 ds_read_b128 v[30:33], v3 offset:25600
 v_smfmac_f32_16x16x64_bf16 v[42:45], v[18:21], v[96:103], v1
 ds_read_b128 v[14:17], v4 offset:2560
 v_smfmac_f32_16x16x64_bf16 v[46:49], v[18:21], v[62:69], v1
 s_waitcnt vmcnt(2)
 ds_read_b128 v[62:65], v0 offset:4096
 ds_read_b128 v[66:69], v0 offset:5120
 s_waitcnt lgkmcnt(6)
 v_smfmac_f32_16x16x64_bf16 v[50:53], v[22:25], a[32:39], v1
 v_smfmac_f32_16x16x64_bf16 v[42:45], v[22:25], v[104:111], v1
 ds_read_b128 v[18:21], v4 offset:3072
 v_smfmac_f32_16x16x64_bf16 v[46:49], v[22:25], v[34:41], v1
 ds_read_b128 v[34:37], v3 offset:32768
 s_waitcnt lgkmcnt(7)
 v_smfmac_f32_16x16x64_bf16 v[50:53], v[10:13], a[40:47], v1
 ds_read_b128 v[38:41], v3 offset:33792
 v_smfmac_f32_16x16x64_bf16 v[42:45], v[10:13], v[112:119], v1
 s_waitcnt lgkmcnt(3)
 ds_read_b128 v[22:25], v4 offset:3584
 v_bitop3_b32 v62, v62, v63, v64 bitop3:0xfe
 v_bitop3_b32 v62, v62, v65, v65 bitop3:0xfe
 v_smfmac_f32_16x16x64_bf16 v[46:49], v[10:13], v[26:33], v1
 ds_read_b128 v[26:29], v3 offset:40960
 v_bitop3_b32 v62, v62, v66, v67 bitop3:0xfe
 v_smfmac_f32_16x16x64_bf16 v[50:53], v[14:17], a[48:55], v1
 ds_read_b128 v[30:33], v3 offset:41984
 v_bitop3_b32 v62, v62, v68, v69 bitop3:0xfe
 v_bitop3_b32 v62, v62, v62, s28 bitop3:0xa0
 v_smfmac_f32_16x16x64_bf16 v[42:45], v[14:17], v[120:127], v1
 v_and_b32 v62, 1, v62
 v_smfmac_f32_16x16x64_bf16 v[46:49], v[14:17], v[128:135], v1
 v_cmp_ne_u32 vcc, 0, v62
 s_waitcnt lgkmcnt(5)
 v_smfmac_f32_16x16x64_bf16 v[50:53], v[18:21], a[56:63], v1
 s_cbranch_vccnz L_mbre_67
L_mbok_66:
 s_barrier
 v_smfmac_f32_16x16x64_bf16 v[42:45], v[18:21], v[136:143], v1
 ds_read_b128 v[10:13], v4 offset:4096
 ds_read_b128 v[14:17], v4 offset:4608
 s_waitcnt lgkmcnt(5)
 v_smfmac_f32_16x16x64_bf16 v[46:49], v[18:21], v[34:41], v1
 ds_read_b128 v[34:37], v3 offset:49152
 s_waitcnt lgkmcnt(5)
 v_smfmac_f32_16x16x64_bf16 v[50:53], v[22:25], a[64:71], v1
 ds_read_b128 v[38:41], v3 offset:50176
 v_smfmac_f32_16x16x64_bf16 v[42:45], v[22:25], v[144:151], v1
 ds_read_b128 v[18:21], v4 offset:5120
 s_waitcnt lgkmcnt(5)
 v_smfmac_f32_16x16x64_bf16 v[46:49], v[22:25], v[26:33], v1
 ds_read_b128 v[26:29], v9 offset:0
 s_waitcnt lgkmcnt(5)
 v_smfmac_f32_16x16x64_bf16 v[50:53], v[10:13], a[72:79], v1
 ds_read_b128 v[30:33], v9 offset:1024
 v_smfmac_f32_16x16x64_bf16 v[42:45], v[10:13], v[152:159], v1
 ds_read_b128 v[22:25], v4 offset:5632
 v_smfmac_f32_16x16x64_bf16 v[46:49], v[10:13], v[160:167], v1
 s_waitcnt lgkmcnt(6)
 v_smfmac_f32_16x16x64_bf16 v[50:53], v[14:17], a[80:87], v1
 v_smfmac_f32_16x16x64_bf16 v[42:45], v[14:17], v[168:175], v1
 ds_read_b128 v[10:13], v4 offset:6144
 s_waitcnt lgkmcnt(5)
 v_smfmac_f32_16x16x64_bf16 v[46:49], v[14:17], v[34:41], v1
 ds_read_b128 v[34:37], v9 offset:8192
 s_waitcnt lgkmcnt(5)
 v_smfmac_f32_16x16x64_bf16 v[50:53], v[18:21], a[88:95], v1
 ds_read_b128 v[38:41], v9 offset:9216
 v_smfmac_f32_16x16x64_bf16 v[42:45], v[18:21], v[176:183], v1
 ds_read_b128 v[14:17], v4 offset:6656
 s_waitcnt lgkmcnt(5)
 v_smfmac_f32_16x16x64_bf16 v[46:49], v[18:21], v[26:33], v1
 ds_read_b128 v[26:29], v9 offset:16384
 s_waitcnt lgkmcnt(5)
 v_smfmac_f32_16x16x64_bf16 v[50:53], v[22:25], a[96:103], v1
 ds_read_b128 v[30:33], v9 offset:17408
 v_smfmac_f32_16x16x64_bf16 v[42:45], v[22:25], v[184:191], v1
 ds_read_b128 v[18:21], v4 offset:7168
 v_smfmac_f32_16x16x64_bf16 v[46:49], v[22:25], v[192:199], v1
 ds_read_b128 v[62:65], v9 offset:24576
 s_waitcnt lgkmcnt(7)
 v_smfmac_f32_16x16x64_bf16 v[42:45], v[10:13], v[200:207], v1
 ds_read_b128 v[66:69], v9 offset:25600
 ds_read_b128 v[22:25], v4 offset:7680
 s_waitcnt lgkmcnt(7)
 v_smfmac_f32_16x16x64_bf16 v[46:49], v[10:13], v[34:41], v1
 ds_read_b128 v[34:37], v9 offset:32768
 s_waitcnt lgkmcnt(7)
 v_smfmac_f32_16x16x64_bf16 v[42:45], v[14:17], v[208:215], v1
 ds_read_b128 v[38:41], v9 offset:33792
 ds_read_b128 v[10:13], v4 offset:8192
 s_waitcnt lgkmcnt(7)
 v_smfmac_f32_16x16x64_bf16 v[46:49], v[14:17], v[26:33], v1
 s_waitcnt lgkmcnt(6)
 v_smfmac_f32_16x16x64_bf16 v[42:45], v[18:21], v[216:223], v1
 ds_read_b128 v[14:17], v4 offset:8704
 s_waitcnt lgkmcnt(5)
 v_smfmac_f32_16x16x64_bf16 v[46:49], v[18:21], v[62:69], v1
 s_waitcnt lgkmcnt(4)
 v_smfmac_f32_16x16x64_bf16 v[42:45], v[22:25], v[224:231], v1
 ds_read_b128 v[18:21], v4 offset:6144
 s_waitcnt lgkmcnt(3)
 v_smfmac_f32_16x16x64_bf16 v[46:49], v[22:25], v[34:41], v1
 ds_read_b128 v[66:69], v0 offset:13568
 s_waitcnt lgkmcnt(3)
 v_smfmac_f32_16x16x64_bf16 v[42:45], v[10:13], v[232:239], v1
 ds_read_b128 v[22:25], v4 offset:6656
 v_smfmac_f32_16x16x64_bf16 v[46:49], v[10:13], v[240:247], v1
 s_waitcnt lgkmcnt(3)
 v_smfmac_f32_16x16x64_bf16 v[42:45], v[14:17], v[248:255], v1
 ds_read_b128 v[10:13], v4 offset:7168
 v_smfmac_f32_16x16x64_bf16 v[46:49], v[14:17], a[0:7], v1
 ds_read_b128 v[14:17], v4 offset:7680
 s_waitcnt lgkmcnt(4)
 v_smfmac_f32_16x16x64_bf16 v[50:53], v[18:21], a[104:111], v1
 s_nop 1
 s_waitcnt lgkmcnt(2)
 v_smfmac_f32_16x16x64_bf16 v[50:53], v[22:25], a[112:119], v1
 s_nop 2
 v_cvt_pk_bf16_f32 v62, v42, v43
 v_cvt_pk_bf16_f32 v63, v44, v45
 ds_write_b64 v5, v[62:63]
 v_cvt_pk_bf16_f32 v64, v46, v47
 v_cvt_pk_bf16_f32 v65, v48, v49
 ds_write_b64 v5, v[64:65] offset:2176
 ds_read_b128 v[42:45], v4 offset:8192
 ds_read_b128 v[46:49], v4 offset:8704
 s_waitcnt lgkmcnt(5)
 v_smfmac_f32_16x16x64_bf16 v[50:53], v[10:13], a[120:127], v1
 buffer_store_dwordx4 v[66:69], v0, s[4:7], s65 offen offset:0 sc1
 s_waitcnt lgkmcnt(4)
 v_smfmac_f32_16x16x64_bf16 v[50:53], v[14:17], a[128:135], v1
 s_waitcnt lgkmcnt(2)
 s_barrier
 s_waitcnt lgkmcnt(1)
 v_smfmac_f32_16x16x64_bf16 v[50:53], v[42:45], a[136:143], v1
 s_waitcnt lgkmcnt(0)
 v_smfmac_f32_16x16x64_bf16 v[50:53], v[46:49], a[144:151], v1
 s_nop 7
 v_cvt_pk_bf16_f32 v40, v50, v51
 v_cvt_pk_bf16_f32 v41, v52, v53
 ds_write_b64 v5, v[40:41] offset:4352
 s_add_u32 s65, s65, 131072
 s_waitcnt vmcnt(0) lgkmcnt(0)
 s_barrier
 ds_read_b128 v[66:69], v0 offset:13568
 s_waitcnt lgkmcnt(0)
 v_or_b32 v66, 1, v66
 v_or_b32 v67, 1, v67
 v_or_b32 v68, 1, v68
 v_or_b32 v69, 1, v69
 buffer_store_dwordx4 v[66:69], v0, s[4:7], s65 offen offset:0 sc1
 s_branch L_done0
L_mbre_53:
 s_mov_b32 m0, 4096
 s_nop 0
 buffer_load_dwordx4 v0, s[4:7], s25 offen offset:0 sc1 lds
 buffer_load_dwordx4 v0, s[4:7], s25 offen offset:1024 sc1 lds
 s_add_u32 s51, s51, 65536
 s_waitcnt vmcnt(3)
 ds_read_b128 v[62:65], v0 offset:4096
 ds_read_b128 v[66:69], v0 offset:5120
 s_waitcnt lgkmcnt(0)
 v_bitop3_b32 v62, v62, v63, v64 bitop3:0x80
 v_bitop3_b32 v62, v62, v65, v65 bitop3:0x80
 v_bitop3_b32 v62, v62, v66, v67 bitop3:0x80
 v_bitop3_b32 v62, v62, v68, v69 bitop3:0x80
 v_bitop3_b32 v62, v62, v62, s28 bitop3:0xf5
 v_and_b32 v62, 1, v62
 v_cmp_ne_u32 vcc, 1, v62
 s_cbranch_vccz L_mbok_52
 s_mov_b32 m0, 4096
 s_nop 0
 buffer_load_dwordx4 v0, s[4:7], s25 offen offset:0 sc1 lds
 buffer_load_dwordx4 v0, s[4:7], s25 offen offset:1024 sc1 lds
 s_nop 15
 s_nop 3
L_mbspin_68:
 s_mov_b32 m0, 4096
 s_nop 0
 buffer_load_dwordx4 v0, s[4:7], s25 offen offset:0 sc1 lds
 buffer_load_dwordx4 v0, s[4:7], s25 offen offset:1024 sc1 lds
 s_add_u32 s51, s51, 65536
 s_cmp_gt_u32 s51, 1310720000
 s_cbranch_scc1 L_exit0
 s_waitcnt vmcnt(4)
 ds_read_b128 v[62:65], v0 offset:4096
 ds_read_b128 v[66:69], v0 offset:5120
 s_waitcnt lgkmcnt(0)
 v_bitop3_b32 v62, v62, v63, v64 bitop3:0x80
 v_bitop3_b32 v62, v62, v65, v65 bitop3:0x80
 v_bitop3_b32 v62, v62, v66, v67 bitop3:0x80
 v_bitop3_b32 v62, v62, v68, v69 bitop3:0x80
 v_bitop3_b32 v62, v62, v62, s28 bitop3:0xf5
 v_and_b32 v62, 1, v62
 v_cmp_ne_u32 vcc, 1, v62
 s_cbranch_vccnz L_mbspin_68
 s_branch L_mbok_52
L_rre_56:
 buffer_load_dwordx4 v[10:13], v0, s[4:7], s60 offen offset:0 sc1
 buffer_load_dwordx4 v[14:17], v0, s[4:7], s60 offen offset:1024 sc1
 buffer_load_dwordx4 v[18:21], v0, s[4:7], s60 offen offset:2048 sc1
 buffer_load_dwordx4 v[22:25], v0, s[4:7], s60 offen offset:3072 sc1
 s_nop 15
 s_nop 7
L_rspin_69:
 buffer_load_dwordx4 v[54:57], v0, s[4:7], s60 offen offset:0 sc1
 buffer_load_dwordx4 v[58:61], v0, s[4:7], s60 offen offset:1024 sc1
 buffer_load_dwordx4 v[62:65], v0, s[4:7], s60 offen offset:2048 sc1
 buffer_load_dwordx4 v[66:69], v0, s[4:7], s60 offen offset:3072 sc1
 s_add_u32 s51, s51, 1
 s_waitcnt vmcnt(7)
 v_mfma_f32_16x16x32_bf16 v[30:33], v[10:13], v[26:29], 0
 v_bitop3_b32 v34, v10, v12, v12 bitop3:0xfe
 s_waitcnt vmcnt(6)
 v_mfma_f32_16x16x32_bf16 v[30:33], v[14:17], v[26:29], v[30:33]
 v_bitop3_b32 v34, v34, v14, v16 bitop3:0xfe
 s_waitcnt vmcnt(5)
 v_mfma_f32_16x16x32_bf16 v[30:33], v[18:21], v[26:29], v[30:33]
 v_bitop3_b32 v34, v34, v18, v20 bitop3:0xfe
 s_waitcnt vmcnt(4)
 v_mfma_f32_16x16x32_bf16 v[30:33], v[22:25], v[26:29], v[30:33]
 v_bitop3_b32 v34, v34, v22, v24 bitop3:0xfe
 v_and_b32 v34, 1, v34
 v_cmp_ne_u32 vcc, 0, v34
 s_cbranch_vccz L_rok_70
 buffer_load_dwordx4 v[10:13], v0, s[4:7], s60 offen offset:0 sc1
 buffer_load_dwordx4 v[14:17], v0, s[4:7], s60 offen offset:1024 sc1
 buffer_load_dwordx4 v[18:21], v0, s[4:7], s60 offen offset:2048 sc1
 buffer_load_dwordx4 v[22:25], v0, s[4:7], s60 offen offset:3072 sc1
 s_add_u32 s51, s51, 1
 s_waitcnt vmcnt(7)
 v_mfma_f32_16x16x32_bf16 v[30:33], v[54:57], v[26:29], 0
 v_bitop3_b32 v34, v54, v56, v56 bitop3:0xfe
 s_waitcnt vmcnt(6)
 v_mfma_f32_16x16x32_bf16 v[30:33], v[58:61], v[26:29], v[30:33]
 v_bitop3_b32 v34, v34, v58, v60 bitop3:0xfe
 s_waitcnt vmcnt(5)
 v_mfma_f32_16x16x32_bf16 v[30:33], v[62:65], v[26:29], v[30:33]
 v_bitop3_b32 v34, v34, v62, v64 bitop3:0xfe
 s_waitcnt vmcnt(4)
 v_mfma_f32_16x16x32_bf16 v[30:33], v[66:69], v[26:29], v[30:33]
 v_bitop3_b32 v34, v34, v66, v68 bitop3:0xfe
 v_and_b32 v34, 1, v34
 v_cmp_ne_u32 vcc, 0, v34
 s_cbranch_vccz L_rok_70
 s_and_b32 s3, s51, 0xffff
 s_cmp_gt_u32 s3, 20000
 s_cbranch_scc0 L_rspin_69
 s_branch L_exit0
L_rok_70:
 s_nop 3
 v_permlane32_swap_b32 v30, v31
 v_permlane32_swap_b32 v32, v33
 v_add_f32 v30, v30, v31
 v_add_f32 v32, v32, v33
 v_cvt_pk_bf16_f32 v30, v30, v32
 v_and_b32 v30, -2, v30
 buffer_store_dword v30, v35, s[4:7], s61 offen
 s_waitcnt vmcnt(1)
 s_branch L_rback_57
L_mbre_60:
 s_mov_b32 m0, 4096
 s_nop 0
 buffer_load_dwordx4 v0, s[4:7], s25 offen offset:0 sc1 lds
 buffer_load_dwordx4 v0, s[4:7], s25 offen offset:1024 sc1 lds
 s_add_u32 s51, s51, 65536
 s_waitcnt vmcnt(3)
 ds_read_b128 v[62:65], v0 offset:4096
 ds_read_b128 v[66:69], v0 offset:5120
 s_waitcnt lgkmcnt(0)
 v_bitop3_b32 v62, v62, v63, v64 bitop3:0xfe
 v_bitop3_b32 v62, v62, v65, v65 bitop3:0xfe
 v_bitop3_b32 v62, v62, v66, v67 bitop3:0xfe
 v_bitop3_b32 v62, v62, v68, v69 bitop3:0xfe
 v_bitop3_b32 v62, v62, v62, s28 bitop3:0xa0
 v_and_b32 v62, 1, v62
 v_cmp_ne_u32 vcc, 0, v62
 s_cbranch_vccz L_mbok_59
 s_mov_b32 m0, 4096
 s_nop 0
 buffer_load_dwordx4 v0, s[4:7], s25 offen offset:0 sc1 lds
 buffer_load_dwordx4 v0, s[4:7], s25 offen offset:1024 sc1 lds
 s_nop 15
 s_nop 3
L_mbspin_71:
 s_mov_b32 m0, 4096
 s_nop 0
 buffer_load_dwordx4 v0, s[4:7], s25 offen offset:0 sc1 lds
 buffer_load_dwordx4 v0, s[4:7], s25 offen offset:1024 sc1 lds
 s_add_u32 s51, s51, 65536
 s_cmp_gt_u32 s51, 1310720000
 s_cbranch_scc1 L_exit0
 s_waitcnt vmcnt(4)
 ds_read_b128 v[62:65], v0 offset:4096
 ds_read_b128 v[66:69], v0 offset:5120
 s_waitcnt lgkmcnt(0)
 v_bitop3_b32 v62, v62, v63, v64 bitop3:0xfe
 v_bitop3_b32 v62, v62, v65, v65 bitop3:0xfe
 v_bitop3_b32 v62, v62, v66, v67 bitop3:0xfe
 v_bitop3_b32 v62, v62, v68, v69 bitop3:0xfe
 v_bitop3_b32 v62, v62, v62, s28 bitop3:0xa0
 v_and_b32 v62, 1, v62
 v_cmp_ne_u32 vcc, 0, v62
 s_cbranch_vccnz L_mbspin_71
 s_branch L_mbok_59
L_rre_63:
 buffer_load_dwordx4 v[10:13], v0, s[4:7], s60 offen offset:0 sc1
 buffer_load_dwordx4 v[14:17], v0, s[4:7], s60 offen offset:1024 sc1
 buffer_load_dwordx4 v[18:21], v0, s[4:7], s60 offen offset:2048 sc1
 buffer_load_dwordx4 v[22:25], v0, s[4:7], s60 offen offset:3072 sc1
 s_nop 15
 s_nop 7
L_rspin_72:
 buffer_load_dwordx4 v[54:57], v0, s[4:7], s60 offen offset:0 sc1
 buffer_load_dwordx4 v[58:61], v0, s[4:7], s60 offen offset:1024 sc1
 buffer_load_dwordx4 v[62:65], v0, s[4:7], s60 offen offset:2048 sc1
 buffer_load_dwordx4 v[66:69], v0, s[4:7], s60 offen offset:3072 sc1
 s_add_u32 s51, s51, 1
 s_waitcnt vmcnt(7)
 v_mfma_f32_16x16x32_bf16 v[30:33], v[10:13], v[26:29], 0
 v_bitop3_b32 v34, v10, v12, v12 bitop3:0x80
 s_waitcnt vmcnt(6)
 v_mfma_f32_16x16x32_bf16 v[30:33], v[14:17], v[26:29], v[30:33]
 v_bitop3_b32 v34, v34, v14, v16 bitop3:0x80
 s_waitcnt vmcnt(5)
 v_mfma_f32_16x16x32_bf16 v[30:33], v[18:21], v[26:29], v[30:33]
 v_bitop3_b32 v34, v34, v18, v20 bitop3:0x80
 s_waitcnt vmcnt(4)
 v_mfma_f32_16x16x32_bf16 v[30:33], v[22:25], v[26:29], v[30:33]
 v_bitop3_b32 v34, v34, v22, v24 bitop3:0x80
 v_and_b32 v34, 1, v34
 v_cmp_ne_u32 vcc, 1, v34
 s_cbranch_vccz L_rok_73
 buffer_load_dwordx4 v[10:13], v0, s[4:7], s60 offen offset:0 sc1
 buffer_load_dwordx4 v[14:17], v0, s[4:7], s60 offen offset:1024 sc1
 buffer_load_dwordx4 v[18:21], v0, s[4:7], s60 offen offset:2048 sc1
 buffer_load_dwordx4 v[22:25], v0, s[4:7], s60 offen offset:3072 sc1
 s_add_u32 s51, s51, 1
 s_waitcnt vmcnt(7)
 v_mfma_f32_16x16x32_bf16 v[30:33], v[54:57], v[26:29], 0
 v_bitop3_b32 v34, v54, v56, v56 bitop3:0x80
 s_waitcnt vmcnt(6)
 v_mfma_f32_16x16x32_bf16 v[30:33], v[58:61], v[26:29], v[30:33]
 v_bitop3_b32 v34, v34, v58, v60 bitop3:0x80
 s_waitcnt vmcnt(5)
 v_mfma_f32_16x16x32_bf16 v[30:33], v[62:65], v[26:29], v[30:33]
 v_bitop3_b32 v34, v34, v62, v64 bitop3:0x80
 s_waitcnt vmcnt(4)
 v_mfma_f32_16x16x32_bf16 v[30:33], v[66:69], v[26:29], v[30:33]
 v_bitop3_b32 v34, v34, v66, v68 bitop3:0x80
 v_and_b32 v34, 1, v34
 v_cmp_ne_u32 vcc, 1, v34
 s_cbranch_vccz L_rok_73
 s_and_b32 s3, s51, 0xffff
 s_cmp_gt_u32 s3, 20000
 s_cbranch_scc0 L_rspin_72
 s_branch L_exit0
L_rok_73:
 s_nop 3
 v_permlane32_swap_b32 v30, v31
 v_permlane32_swap_b32 v32, v33
 v_add_f32 v30, v30, v31
 v_add_f32 v32, v32, v33
 v_cvt_pk_bf16_f32 v30, v30, v32
 v_or_b32 v30, 1, v30
 buffer_store_dword v30, v35, s[4:7], s61 offen
 s_waitcnt vmcnt(1)
 s_branch L_rback_64
L_mbre_67:
 s_mov_b32 m0, 4096
 s_nop 0
 buffer_load_dwordx4 v0, s[4:7], s25 offen offset:0 sc1 lds
 buffer_load_dwordx4 v0, s[4:7], s25 offen offset:1024 sc1 lds
 s_add_u32 s51, s51, 65536
 s_waitcnt vmcnt(2)
 ds_read_b128 v[62:65], v0 offset:4096
 ds_read_b128 v[66:69], v0 offset:5120
 s_waitcnt lgkmcnt(0)
 v_bitop3_b32 v62, v62, v63, v64 bitop3:0xfe
 v_bitop3_b32 v62, v62, v65, v65 bitop3:0xfe
 v_bitop3_b32 v62, v62, v66, v67 bitop3:0xfe
 v_bitop3_b32 v62, v62, v68, v69 bitop3:0xfe
 v_bitop3_b32 v62, v62, v62, s28 bitop3:0xa0
 v_and_b32 v62, 1, v62
 v_cmp_ne_u32 vcc, 0, v62
 s_cbranch_vccz L_mbok_66
 s_mov_b32 m0, 4096
 s_nop 0
 buffer_load_dwordx4 v0, s[4:7], s25 offen offset:0 sc1 lds
 buffer_load_dwordx4 v0, s[4:7], s25 offen offset:1024 sc1 lds
 s_nop 15
 s_nop 3
L_mbspin_74:
 s_mov_b32 m0, 4096
 s_nop 0
 buffer_load_dwordx4 v0, s[4:7], s25 offen offset:0 sc1 lds
 buffer_load_dwordx4 v0, s[4:7], s25 offen offset:1024 sc1 lds
 s_add_u32 s51, s51, 65536
 s_cmp_gt_u32 s51, 1310720000
 s_cbranch_scc1 L_exit0
 s_waitcnt vmcnt(4)
 ds_read_b128 v[62:65], v0 offset:4096
 ds_read_b128 v[66:69], v0 offset:5120
 s_waitcnt lgkmcnt(0)
 v_bitop3_b32 v62, v62, v63, v64 bitop3:0xfe
 v_bitop3_b32 v62, v62, v65, v65 bitop3:0xfe
 v_bitop3_b32 v62, v62, v66, v67 bitop3:0xfe
 v_bitop3_b32 v62, v62, v68, v69 bitop3:0xfe
 v_bitop3_b32 v62, v62, v62, s28 bitop3:0xa0
 v_and_b32 v62, 1, v62
 v_cmp_ne_u32 vcc, 0, v62
 s_cbranch_vccnz L_mbspin_74
 s_branch L_mbok_66
L_wave2_17:
 v_mov_b64 v[42:43], 0
 v_mov_b64 v[44:45], 0
 v_mov_b64 v[46:47], 0
 v_mov_b64 v[48:49], 0
 v_mov_b64 v[50:51], 0
 v_mov_b64 v[52:53], 0
 v_and_b32 v70, 0xf0, v0
 v_bfe_u32 v71, v0, 8, 2
 v_lshl_add_u32 v71, v71, 9, s67
 v_add_u32 v70, v70, v71
 v_add_u32 v9, 57344, v3
 ds_read_b128 v[26:29], v3 offset:0
 ds_read_b128 v[30:33], v3 offset:1024
 ds_read_b128 v[62:65], v3 offset:8192
 ds_read_b128 v[66:69], v3 offset:9216
 ds_read_b128 v[34:37], v3 offset:16384
 ds_read_b128 v[38:41], v3 offset:17408
 .p2align 6
L_loop_75:
 s_waitcnt lgkmcnt(0)
 s_barrier
 s_mov_b32 s51, 0
 ds_read_b128 v[10:13], v4 offset:0
 ds_read_b128 v[14:17], v4 offset:512
 ds_read_b128 v[18:21], v4 offset:1024
 s_add_u32 s72, s52, 16777216
 buffer_load_dwordx4 v[54:57], v70, s[4:7], s72 offen sc1
 buffer_load_dwordx4 v[58:61], v70, s[4:7], s72 offen offset:256 sc1
 s_waitcnt lgkmcnt(2)
 v_smfmac_f32_16x16x64_bf16 v[50:53], v[10:13], a[8:15], v1
 v_lshlrev_b32 v71, 2, v0
 v_smfmac_f32_16x16x64_bf16 v[42:45], v[10:13], v[72:79], v1
 ds_read_b128 v[22:25], v4 offset:1536
 v_smfmac_f32_16x16x64_bf16 v[46:49], v[10:13], v[80:87], v1
 s_mov_b32 m0, 4096
 s_cmp_eq_u32 s50, 0
 s_cbranch_scc1 L_mb2skip_77
 buffer_load_dwordx4 v0, s[4:7], s25 offen offset:2048 sc1 lds
 buffer_load_dwordx4 v0, s[4:7], s25 offen offset:3072 sc1 lds
L_mb2skip_77:
 s_waitcnt lgkmcnt(2)
 v_smfmac_f32_16x16x64_bf16 v[50:53], v[14:17], a[16:23], v1
 v_smfmac_f32_16x16x64_bf16 v[42:45], v[14:17], v[88:95], v1
 ds_read_b128 v[10:13], v4 offset:2048
 v_smfmac_f32_16x16x64_bf16 v[46:49], v[14:17], v[26:33], v1
 ds_read_b128 v[26:29], v3 offset:24576
 s_add_u32 s73, s52, 524288
 s_min_u32 s73, s73, 16515072
 s_add_u32 s73, s73, s68
 s_waitcnt lgkmcnt(3)
 v_smfmac_f32_16x16x64_bf16 v[50:53], v[18:21], a[24:31], v1
 ds_read_b128 v[30:33], v3 offset:25600
 v_smfmac_f32_16x16x64_bf16 v[42:45], v[18:21], v[96:103], v1
 ds_read_b128 v[14:17], v4 offset:2560
 s_mov_b32 m0, 23936
 s_nop 0
 buffer_load_dword v71, s[4:7], s73 offen sc1 lds
 v_smfmac_f32_16x16x64_bf16 v[46:49], v[18:21], v[62:69], v1
 s_waitcnt vmcnt(5)
 ds_read_b128 v[62:65], v0 offset:6144
 ds_read_b128 v[66:69], v0 offset:7168
 s_waitcnt lgkmcnt(6)
 v_smfmac_f32_16x16x64_bf16 v[50:53], v[22:25], a[32:39], v1
 v_smfmac_f32_16x16x64_bf16 v[42:45], v[22:25], v[104:111], v1
 ds_read_b128 v[18:21], v4 offset:3072
 v_smfmac_f32_16x16x64_bf16 v[46:49], v[22:25], v[34:41], v1
 ds_read_b128 v[34:37], v3 offset:32768
 s_waitcnt lgkmcnt(7)
 v_smfmac_f32_16x16x64_bf16 v[50:53], v[10:13], a[40:47], v1
 ds_read_b128 v[38:41], v3 offset:33792
 v_smfmac_f32_16x16x64_bf16 v[42:45], v[10:13], v[112:119], v1
 s_waitcnt lgkmcnt(3)
 ds_read_b128 v[22:25], v4 offset:3584
 v_bitop3_b32 v62, v62, v63, v64 bitop3:0x80
 v_bitop3_b32 v62, v62, v65, v65 bitop3:0x80
 v_smfmac_f32_16x16x64_bf16 v[46:49], v[10:13], v[26:33], v1
 ds_read_b128 v[26:29], v3 offset:40960
 v_bitop3_b32 v62, v62, v66, v67 bitop3:0x80
 v_smfmac_f32_16x16x64_bf16 v[50:53], v[14:17], a[48:55], v1
 ds_read_b128 v[30:33], v3 offset:41984
 v_bitop3_b32 v62, v62, v68, v69 bitop3:0x80
 v_bitop3_b32 v62, v62, v62, s28 bitop3:0xf5
 v_smfmac_f32_16x16x64_bf16 v[42:45], v[14:17], v[120:127], v1
 v_and_b32 v62, 1, v62
 v_smfmac_f32_16x16x64_bf16 v[46:49], v[14:17], v[128:135], v1
 v_cmp_ne_u32 vcc, 1, v62
 s_waitcnt lgkmcnt(5)
 v_smfmac_f32_16x16x64_bf16 v[50:53], v[18:21], a[56:63], v1
 s_cbranch_vccnz L_mbre_79
L_mbok_78:
 s_barrier
 v_smfmac_f32_16x16x64_bf16 v[42:45], v[18:21], v[136:143], v1
 ds_read_b128 v[10:13], v4 offset:4096
 ds_read_b128 v[14:17], v4 offset:4608
 s_waitcnt lgkmcnt(5)
 v_smfmac_f32_16x16x64_bf16 v[46:49], v[18:21], v[34:41], v1
 ds_read_b128 v[34:37], v3 offset:49152
 s_waitcnt lgkmcnt(5)
 v_smfmac_f32_16x16x64_bf16 v[50:53], v[22:25], a[64:71], v1
 ds_read_b128 v[38:41], v3 offset:50176
 v_smfmac_f32_16x16x64_bf16 v[42:45], v[22:25], v[144:151], v1
 ds_read_b128 v[18:21], v4 offset:5120
 s_waitcnt lgkmcnt(5)
 v_smfmac_f32_16x16x64_bf16 v[46:49], v[22:25], v[26:33], v1
 ds_read_b128 v[26:29], v9 offset:0
 s_waitcnt lgkmcnt(5)
 v_smfmac_f32_16x16x64_bf16 v[50:53], v[10:13], a[72:79], v1
 ds_read_b128 v[30:33], v9 offset:1024
 v_smfmac_f32_16x16x64_bf16 v[42:45], v[10:13], v[152:159], v1
 ds_read_b128 v[22:25], v4 offset:5632
 v_smfmac_f32_16x16x64_bf16 v[46:49], v[10:13], v[160:167], v1
 s_waitcnt lgkmcnt(6)
 v_smfmac_f32_16x16x64_bf16 v[50:53], v[14:17], a[80:87], v1
 v_smfmac_f32_16x16x64_bf16 v[42:45], v[14:17], v[168:175], v1
 ds_read_b128 v[10:13], v4 offset:6144
 s_waitcnt lgkmcnt(5)
 v_smfmac_f32_16x16x64_bf16 v[46:49], v[14:17], v[34:41], v1
 ds_read_b128 v[34:37], v9 offset:8192
 s_waitcnt lgkmcnt(5)
 v_smfmac_f32_16x16x64_bf16 v[50:53], v[18:21], a[88:95], v1
 ds_read_b128 v[38:41], v9 offset:9216
 v_smfmac_f32_16x16x64_bf16 v[42:45], v[18:21], v[176:183], v1
 ds_read_b128 v[14:17], v4 offset:6656
 s_waitcnt lgkmcnt(5)
 v_smfmac_f32_16x16x64_bf16 v[46:49], v[18:21], v[26:33], v1
 ds_read_b128 v[26:29], v9 offset:16384
 s_waitcnt lgkmcnt(5)
 v_smfmac_f32_16x16x64_bf16 v[50:53], v[22:25], a[96:103], v1
 ds_read_b128 v[30:33], v9 offset:17408
 v_smfmac_f32_16x16x64_bf16 v[42:45], v[22:25], v[184:191], v1
 ds_read_b128 v[18:21], v4 offset:7168
 v_smfmac_f32_16x16x64_bf16 v[46:49], v[22:25], v[192:199], v1
 ds_read_b128 v[62:65], v9 offset:24576
 s_waitcnt lgkmcnt(7)
 v_smfmac_f32_16x16x64_bf16 v[42:45], v[10:13], v[200:207], v1
 ds_read_b128 v[66:69], v9 offset:25600
 ds_read_b128 v[22:25], v4 offset:7680
 s_waitcnt lgkmcnt(7)
 v_smfmac_f32_16x16x64_bf16 v[46:49], v[10:13], v[34:41], v1
 ds_read_b128 v[34:37], v9 offset:32768
 s_waitcnt lgkmcnt(7)
 v_smfmac_f32_16x16x64_bf16 v[42:45], v[14:17], v[208:215], v1
 ds_read_b128 v[38:41], v9 offset:33792
 ds_read_b128 v[10:13], v4 offset:8192
 s_waitcnt lgkmcnt(7)
 v_smfmac_f32_16x16x64_bf16 v[46:49], v[14:17], v[26:33], v1
 s_waitcnt lgkmcnt(6)
 v_smfmac_f32_16x16x64_bf16 v[42:45], v[18:21], v[216:223], v1
 ds_read_b128 v[14:17], v4 offset:8704
 s_waitcnt lgkmcnt(5)
 v_smfmac_f32_16x16x64_bf16 v[46:49], v[18:21], v[62:69], v1
 s_waitcnt lgkmcnt(4)
 v_smfmac_f32_16x16x64_bf16 v[42:45], v[22:25], v[224:231], v1
 ds_read_b128 v[18:21], v4 offset:6144
 s_waitcnt lgkmcnt(3)
 v_smfmac_f32_16x16x64_bf16 v[46:49], v[22:25], v[34:41], v1
 ds_read_b128 v[66:69], v0 offset:14656
 s_waitcnt lgkmcnt(3)
 v_smfmac_f32_16x16x64_bf16 v[42:45], v[10:13], v[232:239], v1
 ds_read_b128 v[22:25], v4 offset:6656
 v_smfmac_f32_16x16x64_bf16 v[46:49], v[10:13], v[240:247], v1
 ds_read_b128 v[26:29], v0 offset:15744
 ds_read_b128 v[30:33], v0 offset:17792
 s_waitcnt lgkmcnt(5)
 v_smfmac_f32_16x16x64_bf16 v[42:45], v[14:17], v[248:255], v1
 ds_read_b128 v[10:13], v4 offset:7168
 v_smfmac_f32_16x16x64_bf16 v[46:49], v[14:17], a[0:7], v1
 ds_read_b128 v[34:37], v0 offset:19840
 ds_read_b128 v[38:41], v0 offset:21888
 ds_read_b128 v[14:17], v4 offset:7680
 s_waitcnt lgkmcnt(8)
 v_smfmac_f32_16x16x64_bf16 v[50:53], v[18:21], a[104:111], v1
 s_nop 1
 s_waitcnt lgkmcnt(6)
 v_smfmac_f32_16x16x64_bf16 v[50:53], v[22:25], a[112:119], v1
 s_nop 2
 v_cvt_pk_bf16_f32 v62, v42, v43
 v_cvt_pk_bf16_f32 v63, v44, v45
 ds_write_b64 v5, v[62:63]
 v_cvt_pk_bf16_f32 v64, v46, v47
 v_cvt_pk_bf16_f32 v65, v48, v49
 ds_write_b64 v5, v[64:65] offset:2176
 ds_read_b128 v[42:45], v4 offset:8192
 ds_read_b128 v[46:49], v4 offset:8704
 s_waitcnt lgkmcnt(7)
 v_smfmac_f32_16x16x64_bf16 v[50:53], v[10:13], a[120:127], v1
 buffer_store_dwordx4 v[66:69], v0, s[4:7], s65 offen offset:0 sc1
 s_waitcnt lgkmcnt(4)
 v_smfmac_f32_16x16x64_bf16 v[50:53], v[14:17], a[128:135], v1
 s_waitcnt lgkmcnt(2)
 s_barrier
 ds_read_b64_tr_b16 v[10:11], v6 offset:0
 ds_read_b64_tr_b16 v[12:13], v6 offset:64
 ds_read_b64_tr_b16 v[14:15], v6 offset:256
 ds_read_b64_tr_b16 v[16:17], v6 offset:320
 s_waitcnt lgkmcnt(5)
 v_smfmac_f32_16x16x64_bf16 v[50:53], v[42:45], a[136:143], v1
 ds_read_b64_tr_b16 v[18:19], v6 offset:512
 ds_read_b64_tr_b16 v[20:21], v6 offset:576
 ds_read_b64_tr_b16 v[22:23], v6 offset:768
 ds_read_b64_tr_b16 v[24:25], v6 offset:832
 s_waitcnt lgkmcnt(8)
 v_smfmac_f32_16x16x64_bf16 v[50:53], v[46:49], a[144:151], v1
 s_waitcnt lgkmcnt(6)
 v_mfma_f32_16x16x32_bf16 v[42:45], v[26:29], v[10:13], 0
 ds_read_b128 v[26:29], v0 offset:16768
 v_mov_b32 v62, v2
 v_mov_b32 v63, v2
 s_waitcnt lgkmcnt(5)
 v_mfma_f32_16x16x32_bf16 v[42:45], v[30:33], v[14:17], v[42:45]
 ds_read_b128 v[30:33], v0 offset:18816
 v_mov_b32 v64, v2
 v_mov_b32 v65, v2
 s_waitcnt lgkmcnt(4)
 v_mfma_f32_16x16x32_bf16 v[42:45], v[34:37], v[18:21], v[42:45]
 ds_read_b128 v[34:37], v0 offset:20864
 s_waitcnt lgkmcnt(3)
 v_mfma_f32_16x16x32_bf16 v[42:45], v[38:41], v[22:25], v[42:45]
 ds_read_b128 v[38:41], v0 offset:22912
 v_mfma_f32_16x16x32_bf16 v[62:65], v[10:13], v[10:13], v[62:65]
 v_cvt_pk_bf16_f32 v68, v50, v51
 v_cvt_pk_bf16_f32 v69, v52, v53
 v_mfma_f32_16x16x32_bf16 v[62:65], v[14:17], v[14:17], v[62:65]
 ds_write_b64 v5, v[68:69] offset:4352
 v_mov_b64 v[66:67], v[68:69]
 v_mfma_f32_16x16x32_bf16 v[62:65], v[18:21], v[18:21], v[62:65]
 s_nop 0
 v_mul_f32 v42, s62, v42
 v_mul_f32 v43, s62, v43
 v_mfma_f32_16x16x32_bf16 v[62:65], v[22:25], v[22:25], v[62:65]
 v_permlane32_swap_b32 v66, v68
 v_permlane32_swap_b32 v67, v69
 s_waitcnt lgkmcnt(4)
 v_mfma_f32_16x16x32_bf16 v[46:49], v[26:29], v[10:13], 0
 v_mul_f32 v44, s62, v44
 v_mul_f32 v45, s62, v45
 s_waitcnt lgkmcnt(3)
 v_mfma_f32_16x16x32_bf16 v[46:49], v[30:33], v[14:17], v[46:49]
 v_max3_f32 v70, v42, v43, v44
 s_nop 0
 s_waitcnt lgkmcnt(2)
 v_mfma_f32_16x16x32_bf16 v[46:49], v[34:37], v[18:21], v[46:49]
 v_mul_f32 v62, s62, v62
 v_mul_f32 v63, s62, v63
 s_waitcnt lgkmcnt(1)
 v_mfma_f32_16x16x32_bf16 v[46:49], v[38:41], v[22:25], v[46:49]
 v_mul_f32 v64, s62, v64
 v_mul_f32 v65, s62, v65
 v_max3_f32 v70, v70, v45, v62
 v_max3_f32 v71, v63, v64, v65
 v_mov_b64 v[30:31], 0
 v_mov_b64 v[34:35], 0
 v_mov_b64 v[22:23], s[76:77]
 v_mov_b64 v[24:25], s[76:77]
 v_pk_mul_f32 v[46:47], v[46:47], s[62:63]
 v_pk_mul_f32 v[48:49], v[48:49], s[62:63]
 v_max3_f32 v70, v70, v71, v46
 v_max3_f32 v71, v47, v48, v49
 v_max_f32 v21, v70, v71
 v_max_f32 v70, v70, v71
 s_nop 1
 v_permlane16_swap_b32 v70, v21
 v_max_f32 v71, v70, v21
 v_max_f32 v70, v70, v21
 s_nop 1
 v_permlane32_swap_b32 v70, v71
 v_max_f32 v70, v70, v71
 v_pk_add_f32 v[42:43], v[42:43], v[70:71] op_sel_hi:[1,0] neg_lo:[0,1] neg_hi:[0,1]
 v_pk_add_f32 v[44:45], v[44:45], v[70:71] op_sel_hi:[1,0] neg_lo:[0,1] neg_hi:[0,1]
 v_pk_add_f32 v[46:47], v[46:47], v[70:71] op_sel_hi:[1,0] neg_lo:[0,1] neg_hi:[0,1]
 v_pk_add_f32 v[48:49], v[48:49], v[70:71] op_sel_hi:[1,0] neg_lo:[0,1] neg_hi:[0,1]
 v_pk_add_f32 v[62:63], v[62:63], v[70:71] op_sel_hi:[1,0] neg_lo:[0,1] neg_hi:[0,1]
 v_pk_add_f32 v[64:65], v[64:65], v[70:71] op_sel_hi:[1,0] neg_lo:[0,1] neg_hi:[0,1]
 v_exp_f32 v42, v42
 v_exp_f32 v43, v43
 v_exp_f32 v44, v44
 v_exp_f32 v45, v45
 v_exp_f32 v46, v46
 v_exp_f32 v47, v47
 v_exp_f32 v48, v48
 v_exp_f32 v49, v49
 v_exp_f32 v62, v62
 v_cvt_pk_bf16_f32 v26, v42, v43
 v_cvt_pk_bf16_f32 v27, v44, v45
 v_cvt_pk_bf16_f32 v28, v46, v47
 v_cvt_pk_bf16_f32 v29, v48, v49
 v_exp_f32 v63, v63
 s_waitcnt vmcnt(2)
 v_mfma_f32_16x16x32_bf16 v[10:13], v[22:25], v[26:29], 0
 v_exp_f32 v64, v64
 v_mfma_f32_16x16x32_bf16 v[14:17], v[54:57], v[26:29], 0
 v_exp_f32 v65, v65
 v_mfma_f32_16x16x32_bf16 v[36:39], v[58:61], v[26:29], 0
 v_cvt_pk_bf16_f32 v32, v62, v63
 v_cvt_pk_bf16_f32 v33, v64, v65
 s_nop 1
 v_mfma_f32_16x16x32_bf16 v[10:13], v[22:25], v[32:35], v[10:13]
 v_mfma_f32_16x16x32_bf16 v[14:17], v[66:69], v[32:35], v[14:17]
 v_mfma_f32_16x16x32_bf16 v[36:39], v[66:69], v[30:33], v[36:39]
 v_add_u32 v9, 98304, v3
 v_mov_b64 v[52:53], 0
 v_mov_b64 v[54:55], 0
 v_mov_b64 v[56:57], 0
 v_mov_b64 v[58:59], 0
 s_nop 0
 v_rcp_f32 v18, v10
 v_mov_b64 v[60:61], 0
 v_pk_mul_f32 v[14:15], v[14:15], v[18:19] op_sel_hi:[1,0]
 v_pk_mul_f32 v[16:17], v[16:17], v[18:19] op_sel_hi:[1,0]
 v_pk_mul_f32 v[36:37], v[36:37], v[18:19] op_sel_hi:[1,0]
 v_pk_mul_f32 v[38:39], v[38:39], v[18:19] op_sel_hi:[1,0]
 v_cvt_pk_bf16_f32 v22, v14, v15
 v_cvt_pk_bf16_f32 v23, v16, v17
 v_cvt_pk_bf16_f32 v24, v36, v37
 v_cvt_pk_bf16_f32 v25, v38, v39
 ds_write_b128 v7, v[22:25]
 s_add_u32 s50, s50, 1
 v_mov_b64 v[62:63], 0
 v_mov_b64 v[64:65], 0
 v_mov_b64 v[66:67], 0
 v_mov_b64 v[68:69], 0
 v_mov_b64 v[70:71], 0
 s_waitcnt lgkmcnt(0)
 s_barrier
 ds_read_b128 v[10:13], v4 offset:0
 ds_read_b128 v[14:17], v4 offset:512
 ds_read_b128 v[18:21], v4 offset:1024
 ds_read_b128 v[22:25], v4 offset:1536
 s_waitcnt lgkmcnt(3)
 v_smfmac_f32_16x16x64_bf16 v[52:55], v[10:13], a[152:159], v1
 s_waitcnt lgkmcnt(2)
 v_smfmac_f32_16x16x64_bf16 v[52:55], v[14:17], a[160:167], v1
 ds_read_b128 v[26:29], v9 offset:0
 ds_read_b128 v[30:33], v9 offset:1024
 s_waitcnt lgkmcnt(3)
 v_smfmac_f32_16x16x64_bf16 v[52:55], v[18:21], a[168:175], v1
 s_waitcnt lgkmcnt(2)
 v_smfmac_f32_16x16x64_bf16 v[52:55], v[22:25], a[176:183], v1
 ds_read_b128 v[34:37], v9 offset:8192
 ds_read_b128 v[38:41], v9 offset:9216
 v_smfmac_f32_16x16x64_bf16 v[56:59], v[10:13], a[184:191], v1
 s_nop 2
 v_smfmac_f32_16x16x64_bf16 v[56:59], v[14:17], a[192:199], v1
 ds_read_b128 v[42:45], v9 offset:16384
 ds_read_b128 v[46:49], v9 offset:17408
 s_nop 0
 v_smfmac_f32_16x16x64_bf16 v[56:59], v[18:21], a[200:207], v1
 v_cvt_pk_bf16_f32 v52, v52, v53
 v_smfmac_f32_16x16x64_bf16 v[56:59], v[22:25], a[208:215], v1
 v_cvt_pk_bf16_f32 v53, v54, v55
 v_smfmac_f32_16x16x64_bf16 v[60:63], v[10:13], a[216:223], v1
 s_nop 1
 v_and_b32 v52, -2, v52
 v_smfmac_f32_16x16x64_bf16 v[60:63], v[14:17], a[224:231], v1
 s_nop 1
 buffer_store_dwordx2 v[52:53], v8, s[4:7], s55 offen
 s_waitcnt lgkmcnt(4)
 v_smfmac_f32_16x16x64_bf16 v[60:63], v[18:21], v[26:33], v1
 ds_read_b128 v[26:29], v9 offset:20480
 ds_read_b128 v[30:33], v9 offset:21504
 v_cvt_pk_bf16_f32 v56, v56, v57
 v_smfmac_f32_16x16x64_bf16 v[60:63], v[22:25], a[232:239], v1
 v_cvt_pk_bf16_f32 v57, v58, v59
 s_waitcnt lgkmcnt(4)
 v_smfmac_f32_16x16x64_bf16 v[64:67], v[10:13], v[34:41], v1
 ds_read_b128 v[34:37], v9 offset:24576
 ds_read_b128 v[38:41], v9 offset:25600
 v_and_b32 v56, -2, v56
 v_smfmac_f32_16x16x64_bf16 v[64:67], v[14:17], a[240:247], v1
 s_nop 1
 buffer_store_dwordx2 v[56:57], v8, s[4:7], s56 offen
 s_waitcnt lgkmcnt(4)
 v_smfmac_f32_16x16x64_bf16 v[64:67], v[18:21], v[42:49], v1
 ds_read_b128 v[42:45], v9 offset:28672
 ds_read_b128 v[46:49], v9 offset:29696
 v_cvt_pk_bf16_f32 v60, v60, v61
 v_smfmac_f32_16x16x64_bf16 v[64:67], v[22:25], a[248:255], v1
 ds_read_b128 v[52:55], v9 offset:32768
 ds_read_b128 v[56:59], v9 offset:33792
 v_cvt_pk_bf16_f32 v61, v62, v63
 s_waitcnt lgkmcnt(6)
 v_smfmac_f32_16x16x64_bf16 v[68:71], v[10:13], v[26:33], v1
 s_nop 1
 v_and_b32 v60, -2, v60
 s_waitcnt lgkmcnt(4)
 v_smfmac_f32_16x16x64_bf16 v[68:71], v[14:17], v[34:41], v1
 s_nop 1
 buffer_store_dwordx2 v[60:61], v8, s[4:7], s57 offen
 s_waitcnt lgkmcnt(2)
 v_smfmac_f32_16x16x64_bf16 v[68:71], v[18:21], v[42:49], v1
 v_cvt_pk_bf16_f32 v64, v64, v65
 s_waitcnt lgkmcnt(0)
 v_smfmac_f32_16x16x64_bf16 v[68:71], v[22:25], v[52:59], v1
 v_cvt_pk_bf16_f32 v65, v66, v67
 v_and_b32 v64, -2, v64
 buffer_store_dwordx2 v[64:65], v8, s[4:7], s58 offen
 s_add_u32 s52, s52, 262144
 s_add_u32 s65, s65, s27
 s_mov_b64 s[28:29], -1
 s_sub_i32 s64, s50, s71
 s_mov_b32 s27, 131072
 v_cvt_pk_bf16_f32 v68, v68, v69
 v_cvt_pk_bf16_f32 v69, v70, v71
 v_and_b32 v68, -2, v68
 buffer_store_dwordx2 v[68:69], v8, s[4:7], s59 offen
 s_barrier
 s_cmp_ge_u32 s48, 8
 s_cbranch_scc1 L_nored_80
 s_nop 15
 s_nop 15
 s_nop 15
 s_nop 7
 buffer_load_dwordx4 v[10:13], v0, s[4:7], s60 offen offset:0 sc1
 buffer_load_dwordx4 v[14:17], v0, s[4:7], s60 offen offset:1024 sc1
 buffer_load_dwordx4 v[18:21], v0, s[4:7], s60 offen offset:2048 sc1
 buffer_load_dwordx4 v[22:25], v0, s[4:7], s60 offen offset:3072 sc1
 v_and_b32 v34, 16, v0
 v_mov_b32 v30, 0x3f80
 v_lshlrev_b32 v30, v34, v30
 v_bfe_u32 v34, v0, 5, 3
 v_cmp_eq_u32 vcc, 0, v34
 s_nop 1
 v_cndmask_b32 v26, 0, v30, vcc
 v_cmp_eq_u32 vcc, 1, v34
 s_nop 1
 v_cndmask_b32 v27, 0, v30, vcc
 v_cmp_eq_u32 vcc, 2, v34
 s_nop 1
 v_cndmask_b32 v28, 0, v30, vcc
 v_cmp_eq_u32 vcc, 3, v34
 s_nop 1
 v_cndmask_b32 v29, 0, v30, vcc
 v_and_b32 v35, 0xf0, v0
 v_bfe_u32 v34, v0, 8, 2
 v_lshl_add_u32 v35, v34, 2, v35
 v_and_b32 v34, 0x80, v0
 v_lshl_add_u32 v35, v34, 23, v35
 v_mov_b64 v[42:43], 0
 v_mov_b64 v[44:45], 0
 v_mov_b64 v[46:47], 0
 v_mov_b64 v[48:49], 0
 v_mov_b64 v[50:51], 0
 v_mov_b64 v[52:53], 0
 v_and_b32 v70, 0xf0, v0
 v_bfe_u32 v71, v0, 8, 2
 v_lshl_add_u32 v71, v71, 9, s67
 v_add_u32 v70, v70, v71
 v_add_u32 v9, 57344, v3
 s_barrier
 s_waitcnt vmcnt(3)
 v_mfma_f32_16x16x32_bf16 v[30:33], v[10:13], v[26:29], 0
 v_bitop3_b32 v34, v10, v12, v12 bitop3:0xfe
 s_waitcnt vmcnt(2)
 v_mfma_f32_16x16x32_bf16 v[30:33], v[14:17], v[26:29], v[30:33]
 v_bitop3_b32 v34, v34, v14, v16 bitop3:0xfe
 s_waitcnt vmcnt(1)
 v_mfma_f32_16x16x32_bf16 v[30:33], v[18:21], v[26:29], v[30:33]
 v_bitop3_b32 v34, v34, v18, v20 bitop3:0xfe
 s_waitcnt vmcnt(0)
 v_mfma_f32_16x16x32_bf16 v[30:33], v[22:25], v[26:29], v[30:33]
 v_bitop3_b32 v34, v34, v22, v24 bitop3:0xfe
 v_and_b32 v34, 1, v34
 v_cmp_ne_u32 vcc, 0, v34
 s_cbranch_vccnz L_rre_82
 s_nop 3
 v_permlane32_swap_b32 v30, v31
 v_permlane32_swap_b32 v32, v33
 v_add_f32 v30, v30, v31
 v_add_f32 v32, v32, v33
 v_cvt_pk_bf16_f32 v30, v30, v32
 v_and_b32 v30, -2, v30
 buffer_store_dword v30, v35, s[4:7], s61 offen
L_rback_83:
L_redj_81:
 ds_read_b128 v[26:29], v3 offset:0
 ds_read_b128 v[30:33], v3 offset:1024
 ds_read_b128 v[62:65], v3 offset:8192
 ds_read_b128 v[66:69], v3 offset:9216
 ds_read_b128 v[34:37], v3 offset:16384
 ds_read_b128 v[38:41], v3 offset:17408
 s_barrier
 s_mov_b32 m0, 4096
 s_nop 0
 buffer_load_dwordx4 v0, s[4:7], s25 offen offset:2048 sc1 lds
 buffer_load_dwordx4 v0, s[4:7], s25 offen offset:3072 sc1 lds
 s_cmp_eq_u32 s50, 63
 s_cbranch_scc1 L_last_76
 s_waitcnt lgkmcnt(0)
 s_barrier
 s_mov_b32 s51, 0
 ds_read_b128 v[10:13], v4 offset:0
 ds_read_b128 v[14:17], v4 offset:512
 ds_read_b128 v[18:21], v4 offset:1024
 s_add_u32 s72, s52, 16777216
 buffer_load_dwordx4 v[54:57], v70, s[4:7], s72 offen sc1
 buffer_load_dwordx4 v[58:61], v70, s[4:7], s72 offen offset:256 sc1
 s_waitcnt lgkmcnt(2)
 v_smfmac_f32_16x16x64_bf16 v[50:53], v[10:13], a[8:15], v1
 v_lshlrev_b32 v71, 2, v0
 v_smfmac_f32_16x16x64_bf16 v[42:45], v[10:13], v[72:79], v1
 ds_read_b128 v[22:25], v4 offset:1536
 v_smfmac_f32_16x16x64_bf16 v[46:49], v[10:13], v[80:87], v1
 s_mov_b32 m0, 4096
 s_cmp_eq_u32 s50, 0
 s_cbranch_scc1 L_mb2skip_84
 buffer_load_dwordx4 v0, s[4:7], s25 offen offset:2048 sc1 lds
 buffer_load_dwordx4 v0, s[4:7], s25 offen offset:3072 sc1 lds
L_mb2skip_84:
 s_waitcnt lgkmcnt(2)
 v_smfmac_f32_16x16x64_bf16 v[50:53], v[14:17], a[16:23], v1
 v_smfmac_f32_16x16x64_bf16 v[42:45], v[14:17], v[88:95], v1
 ds_read_b128 v[10:13], v4 offset:2048
 v_smfmac_f32_16x16x64_bf16 v[46:49], v[14:17], v[26:33], v1
 ds_read_b128 v[26:29], v3 offset:24576
 s_add_u32 s73, s52, 524288
 s_min_u32 s73, s73, 16515072
 s_add_u32 s73, s73, s68
 s_waitcnt lgkmcnt(3)
 v_smfmac_f32_16x16x64_bf16 v[50:53], v[18:21], a[24:31], v1
 ds_read_b128 v[30:33], v3 offset:25600
 v_smfmac_f32_16x16x64_bf16 v[42:45], v[18:21], v[96:103], v1
 ds_read_b128 v[14:17], v4 offset:2560
 s_mov_b32 m0, 23936
 s_nop 0
 buffer_load_dword v71, s[4:7], s73 offen sc1 lds
 v_smfmac_f32_16x16x64_bf16 v[46:49], v[18:21], v[62:69], v1
 s_waitcnt vmcnt(5)
 ds_read_b128 v[62:65], v0 offset:6144
 ds_read_b128 v[66:69], v0 offset:7168
 s_waitcnt lgkmcnt(6)
 v_smfmac_f32_16x16x64_bf16 v[50:53], v[22:25], a[32:39], v1
 v_smfmac_f32_16x16x64_bf16 v[42:45], v[22:25], v[104:111], v1
 ds_read_b128 v[18:21], v4 offset:3072
 v_smfmac_f32_16x16x64_bf16 v[46:49], v[22:25], v[34:41], v1
 ds_read_b128 v[34:37], v3 offset:32768
 s_waitcnt lgkmcnt(7)
 v_smfmac_f32_16x16x64_bf16 v[50:53], v[10:13], a[40:47], v1
 ds_read_b128 v[38:41], v3 offset:33792
 v_smfmac_f32_16x16x64_bf16 v[42:45], v[10:13], v[112:119], v1
 s_waitcnt lgkmcnt(3)
 ds_read_b128 v[22:25], v4 offset:3584
 v_bitop3_b32 v62, v62, v63, v64 bitop3:0xfe
 v_bitop3_b32 v62, v62, v65, v65 bitop3:0xfe
 v_smfmac_f32_16x16x64_bf16 v[46:49], v[10:13], v[26:33], v1
 ds_read_b128 v[26:29], v3 offset:40960
 v_bitop3_b32 v62, v62, v66, v67 bitop3:0xfe
 v_smfmac_f32_16x16x64_bf16 v[50:53], v[14:17], a[48:55], v1
 ds_read_b128 v[30:33], v3 offset:41984
 v_bitop3_b32 v62, v62, v68, v69 bitop3:0xfe
 v_bitop3_b32 v62, v62, v62, s28 bitop3:0xa0
 v_smfmac_f32_16x16x64_bf16 v[42:45], v[14:17], v[120:127], v1
 v_and_b32 v62, 1, v62
 v_smfmac_f32_16x16x64_bf16 v[46:49], v[14:17], v[128:135], v1
 v_cmp_ne_u32 vcc, 0, v62
 s_waitcnt lgkmcnt(5)
 v_smfmac_f32_16x16x64_bf16 v[50:53], v[18:21], a[56:63], v1
 s_cbranch_vccnz L_mbre_86
L_mbok_85:
 s_barrier
 v_smfmac_f32_16x16x64_bf16 v[42:45], v[18:21], v[136:143], v1
 ds_read_b128 v[10:13], v4 offset:4096
 ds_read_b128 v[14:17], v4 offset:4608
 s_waitcnt lgkmcnt(5)
 v_smfmac_f32_16x16x64_bf16 v[46:49], v[18:21], v[34:41], v1
 ds_read_b128 v[34:37], v3 offset:49152
 s_waitcnt lgkmcnt(5)
 v_smfmac_f32_16x16x64_bf16 v[50:53], v[22:25], a[64:71], v1
 ds_read_b128 v[38:41], v3 offset:50176
 v_smfmac_f32_16x16x64_bf16 v[42:45], v[22:25], v[144:151], v1
 ds_read_b128 v[18:21], v4 offset:5120
 s_waitcnt lgkmcnt(5)
 v_smfmac_f32_16x16x64_bf16 v[46:49], v[22:25], v[26:33], v1
 ds_read_b128 v[26:29], v9 offset:0
 s_waitcnt lgkmcnt(5)
 v_smfmac_f32_16x16x64_bf16 v[50:53], v[10:13], a[72:79], v1
 ds_read_b128 v[30:33], v9 offset:1024
 v_smfmac_f32_16x16x64_bf16 v[42:45], v[10:13], v[152:159], v1
 ds_read_b128 v[22:25], v4 offset:5632
 v_smfmac_f32_16x16x64_bf16 v[46:49], v[10:13], v[160:167], v1
 s_waitcnt lgkmcnt(6)
 v_smfmac_f32_16x16x64_bf16 v[50:53], v[14:17], a[80:87], v1
 v_smfmac_f32_16x16x64_bf16 v[42:45], v[14:17], v[168:175], v1
 ds_read_b128 v[10:13], v4 offset:6144
 s_waitcnt lgkmcnt(5)
 v_smfmac_f32_16x16x64_bf16 v[46:49], v[14:17], v[34:41], v1
 ds_read_b128 v[34:37], v9 offset:8192
 s_waitcnt lgkmcnt(5)
 v_smfmac_f32_16x16x64_bf16 v[50:53], v[18:21], a[88:95], v1
 ds_read_b128 v[38:41], v9 offset:9216
 v_smfmac_f32_16x16x64_bf16 v[42:45], v[18:21], v[176:183], v1
 ds_read_b128 v[14:17], v4 offset:6656
 s_waitcnt lgkmcnt(5)
 v_smfmac_f32_16x16x64_bf16 v[46:49], v[18:21], v[26:33], v1
 ds_read_b128 v[26:29], v9 offset:16384
 s_waitcnt lgkmcnt(5)
 v_smfmac_f32_16x16x64_bf16 v[50:53], v[22:25], a[96:103], v1
 ds_read_b128 v[30:33], v9 offset:17408
 v_smfmac_f32_16x16x64_bf16 v[42:45], v[22:25], v[184:191], v1
 ds_read_b128 v[18:21], v4 offset:7168
 v_smfmac_f32_16x16x64_bf16 v[46:49], v[22:25], v[192:199], v1
 ds_read_b128 v[62:65], v9 offset:24576
 s_waitcnt lgkmcnt(7)
 v_smfmac_f32_16x16x64_bf16 v[42:45], v[10:13], v[200:207], v1
 ds_read_b128 v[66:69], v9 offset:25600
 ds_read_b128 v[22:25], v4 offset:7680
 s_waitcnt lgkmcnt(7)
 v_smfmac_f32_16x16x64_bf16 v[46:49], v[10:13], v[34:41], v1
 ds_read_b128 v[34:37], v9 offset:32768
 s_waitcnt lgkmcnt(7)
 v_smfmac_f32_16x16x64_bf16 v[42:45], v[14:17], v[208:215], v1
 ds_read_b128 v[38:41], v9 offset:33792
 ds_read_b128 v[10:13], v4 offset:8192
 s_waitcnt lgkmcnt(7)
 v_smfmac_f32_16x16x64_bf16 v[46:49], v[14:17], v[26:33], v1
 s_waitcnt lgkmcnt(6)
 v_smfmac_f32_16x16x64_bf16 v[42:45], v[18:21], v[216:223], v1
 ds_read_b128 v[14:17], v4 offset:8704
 s_waitcnt lgkmcnt(5)
 v_smfmac_f32_16x16x64_bf16 v[46:49], v[18:21], v[62:69], v1
 s_waitcnt lgkmcnt(4)
 v_smfmac_f32_16x16x64_bf16 v[42:45], v[22:25], v[224:231], v1
 ds_read_b128 v[18:21], v4 offset:6144
 s_waitcnt lgkmcnt(3)
 v_smfmac_f32_16x16x64_bf16 v[46:49], v[22:25], v[34:41], v1
 ds_read_b128 v[66:69], v0 offset:14656
 s_waitcnt lgkmcnt(3)
 v_smfmac_f32_16x16x64_bf16 v[42:45], v[10:13], v[232:239], v1
 ds_read_b128 v[22:25], v4 offset:6656
 v_smfmac_f32_16x16x64_bf16 v[46:49], v[10:13], v[240:247], v1
 ds_read_b128 v[26:29], v0 offset:15744
 ds_read_b128 v[30:33], v0 offset:17792
 s_waitcnt lgkmcnt(5)
 v_smfmac_f32_16x16x64_bf16 v[42:45], v[14:17], v[248:255], v1
 ds_read_b128 v[10:13], v4 offset:7168
 v_smfmac_f32_16x16x64_bf16 v[46:49], v[14:17], a[0:7], v1
 ds_read_b128 v[34:37], v0 offset:19840
 ds_read_b128 v[38:41], v0 offset:21888
 ds_read_b128 v[14:17], v4 offset:7680
 s_waitcnt lgkmcnt(8)
 v_smfmac_f32_16x16x64_bf16 v[50:53], v[18:21], a[104:111], v1
 s_nop 1
 s_waitcnt lgkmcnt(6)
 v_smfmac_f32_16x16x64_bf16 v[50:53], v[22:25], a[112:119], v1
 s_nop 2
 v_cvt_pk_bf16_f32 v62, v42, v43
 v_cvt_pk_bf16_f32 v63, v44, v45
 ds_write_b64 v5, v[62:63]
 v_cvt_pk_bf16_f32 v64, v46, v47
 v_cvt_pk_bf16_f32 v65, v48, v49
 ds_write_b64 v5, v[64:65] offset:2176
 ds_read_b128 v[42:45], v4 offset:8192
 ds_read_b128 v[46:49], v4 offset:8704
 s_waitcnt lgkmcnt(7)
 v_smfmac_f32_16x16x64_bf16 v[50:53], v[10:13], a[120:127], v1
 buffer_store_dwordx4 v[66:69], v0, s[4:7], s65 offen offset:0 sc1
 s_waitcnt lgkmcnt(4)
 v_smfmac_f32_16x16x64_bf16 v[50:53], v[14:17], a[128:135], v1
 s_waitcnt lgkmcnt(2)
 s_barrier
 ds_read_b64_tr_b16 v[10:11], v6 offset:0
 ds_read_b64_tr_b16 v[12:13], v6 offset:64
 ds_read_b64_tr_b16 v[14:15], v6 offset:256
 ds_read_b64_tr_b16 v[16:17], v6 offset:320
 s_waitcnt lgkmcnt(5)
 v_smfmac_f32_16x16x64_bf16 v[50:53], v[42:45], a[136:143], v1
 ds_read_b64_tr_b16 v[18:19], v6 offset:512
 ds_read_b64_tr_b16 v[20:21], v6 offset:576
 ds_read_b64_tr_b16 v[22:23], v6 offset:768
 ds_read_b64_tr_b16 v[24:25], v6 offset:832
 s_waitcnt lgkmcnt(8)
 v_smfmac_f32_16x16x64_bf16 v[50:53], v[46:49], a[144:151], v1
 s_waitcnt lgkmcnt(6)
 v_mfma_f32_16x16x32_bf16 v[42:45], v[26:29], v[10:13], 0
 ds_read_b128 v[26:29], v0 offset:16768
 v_mov_b32 v62, v2
 v_mov_b32 v63, v2
 s_waitcnt lgkmcnt(5)
 v_mfma_f32_16x16x32_bf16 v[42:45], v[30:33], v[14:17], v[42:45]
 ds_read_b128 v[30:33], v0 offset:18816
 v_mov_b32 v64, v2
 v_mov_b32 v65, v2
 s_waitcnt lgkmcnt(4)
 v_mfma_f32_16x16x32_bf16 v[42:45], v[34:37], v[18:21], v[42:45]
 ds_read_b128 v[34:37], v0 offset:20864
 s_waitcnt lgkmcnt(3)
 v_mfma_f32_16x16x32_bf16 v[42:45], v[38:41], v[22:25], v[42:45]
 ds_read_b128 v[38:41], v0 offset:22912
 v_mfma_f32_16x16x32_bf16 v[62:65], v[10:13], v[10:13], v[62:65]
 v_cvt_pk_bf16_f32 v68, v50, v51
 v_cvt_pk_bf16_f32 v69, v52, v53
 v_mfma_f32_16x16x32_bf16 v[62:65], v[14:17], v[14:17], v[62:65]
 ds_write_b64 v5, v[68:69] offset:4352
 v_mov_b64 v[66:67], v[68:69]
 v_mfma_f32_16x16x32_bf16 v[62:65], v[18:21], v[18:21], v[62:65]
 s_nop 0
 v_mul_f32 v42, s62, v42
 v_mul_f32 v43, s62, v43
 v_mfma_f32_16x16x32_bf16 v[62:65], v[22:25], v[22:25], v[62:65]
 v_permlane32_swap_b32 v66, v68
 v_permlane32_swap_b32 v67, v69
 s_waitcnt lgkmcnt(4)
 v_mfma_f32_16x16x32_bf16 v[46:49], v[26:29], v[10:13], 0
 v_mul_f32 v44, s62, v44
 v_mul_f32 v45, s62, v45
 s_waitcnt lgkmcnt(3)
 v_mfma_f32_16x16x32_bf16 v[46:49], v[30:33], v[14:17], v[46:49]
 v_max3_f32 v70, v42, v43, v44
 s_nop 0
 s_waitcnt lgkmcnt(2)
 v_mfma_f32_16x16x32_bf16 v[46:49], v[34:37], v[18:21], v[46:49]
 v_mul_f32 v62, s62, v62
 v_mul_f32 v63, s62, v63
 s_waitcnt lgkmcnt(1)
 v_mfma_f32_16x16x32_bf16 v[46:49], v[38:41], v[22:25], v[46:49]
 v_mul_f32 v64, s62, v64
 v_mul_f32 v65, s62, v65
 v_max3_f32 v70, v70, v45, v62
 v_max3_f32 v71, v63, v64, v65
 v_mov_b64 v[30:31], 0
 v_mov_b64 v[34:35], 0
 v_mov_b64 v[22:23], s[76:77]
 v_mov_b64 v[24:25], s[76:77]
 v_pk_mul_f32 v[46:47], v[46:47], s[62:63]
 v_pk_mul_f32 v[48:49], v[48:49], s[62:63]
 v_max3_f32 v70, v70, v71, v46
 v_max3_f32 v71, v47, v48, v49
 v_max_f32 v21, v70, v71
 v_max_f32 v70, v70, v71
 s_nop 1
 v_permlane16_swap_b32 v70, v21
 v_max_f32 v71, v70, v21
 v_max_f32 v70, v70, v21
 s_nop 1
 v_permlane32_swap_b32 v70, v71
 v_max_f32 v70, v70, v71
 v_pk_add_f32 v[42:43], v[42:43], v[70:71] op_sel_hi:[1,0] neg_lo:[0,1] neg_hi:[0,1]
 v_pk_add_f32 v[44:45], v[44:45], v[70:71] op_sel_hi:[1,0] neg_lo:[0,1] neg_hi:[0,1]
 v_pk_add_f32 v[46:47], v[46:47], v[70:71] op_sel_hi:[1,0] neg_lo:[0,1] neg_hi:[0,1]
 v_pk_add_f32 v[48:49], v[48:49], v[70:71] op_sel_hi:[1,0] neg_lo:[0,1] neg_hi:[0,1]
 v_pk_add_f32 v[62:63], v[62:63], v[70:71] op_sel_hi:[1,0] neg_lo:[0,1] neg_hi:[0,1]
 v_pk_add_f32 v[64:65], v[64:65], v[70:71] op_sel_hi:[1,0] neg_lo:[0,1] neg_hi:[0,1]
 v_exp_f32 v42, v42
 v_exp_f32 v43, v43
 v_exp_f32 v44, v44
 v_exp_f32 v45, v45
 v_exp_f32 v46, v46
 v_exp_f32 v47, v47
 v_exp_f32 v48, v48
 v_exp_f32 v49, v49
 v_exp_f32 v62, v62
 v_cvt_pk_bf16_f32 v26, v42, v43
 v_cvt_pk_bf16_f32 v27, v44, v45
 v_cvt_pk_bf16_f32 v28, v46, v47
 v_cvt_pk_bf16_f32 v29, v48, v49
 v_exp_f32 v63, v63
 s_waitcnt vmcnt(2)
 v_mfma_f32_16x16x32_bf16 v[10:13], v[22:25], v[26:29], 0
 v_exp_f32 v64, v64
 v_mfma_f32_16x16x32_bf16 v[14:17], v[54:57], v[26:29], 0
 v_exp_f32 v65, v65
 v_mfma_f32_16x16x32_bf16 v[36:39], v[58:61], v[26:29], 0
 v_cvt_pk_bf16_f32 v32, v62, v63
 v_cvt_pk_bf16_f32 v33, v64, v65
 s_nop 1
 v_mfma_f32_16x16x32_bf16 v[10:13], v[22:25], v[32:35], v[10:13]
 v_mfma_f32_16x16x32_bf16 v[14:17], v[66:69], v[32:35], v[14:17]
 v_mfma_f32_16x16x32_bf16 v[36:39], v[66:69], v[30:33], v[36:39]
 v_add_u32 v9, 98304, v3
 v_mov_b64 v[52:53], 0
 v_mov_b64 v[54:55], 0
 v_mov_b64 v[56:57], 0
 v_mov_b64 v[58:59], 0
 s_nop 0
 v_rcp_f32 v18, v10
 v_mov_b64 v[60:61], 0
 v_pk_mul_f32 v[14:15], v[14:15], v[18:19] op_sel_hi:[1,0]
 v_pk_mul_f32 v[16:17], v[16:17], v[18:19] op_sel_hi:[1,0]
 v_pk_mul_f32 v[36:37], v[36:37], v[18:19] op_sel_hi:[1,0]
 v_pk_mul_f32 v[38:39], v[38:39], v[18:19] op_sel_hi:[1,0]
 v_cvt_pk_bf16_f32 v22, v14, v15
 v_cvt_pk_bf16_f32 v23, v16, v17
 v_cvt_pk_bf16_f32 v24, v36, v37
 v_cvt_pk_bf16_f32 v25, v38, v39
 ds_write_b128 v7, v[22:25]
 s_add_u32 s50, s50, 1
 v_mov_b64 v[62:63], 0
 v_mov_b64 v[64:65], 0
 v_mov_b64 v[66:67], 0
 v_mov_b64 v[68:69], 0
 v_mov_b64 v[70:71], 0
 s_waitcnt lgkmcnt(0)
 s_barrier
 ds_read_b128 v[10:13], v4 offset:0
 ds_read_b128 v[14:17], v4 offset:512
 ds_read_b128 v[18:21], v4 offset:1024
 ds_read_b128 v[22:25], v4 offset:1536
 s_waitcnt lgkmcnt(3)
 v_smfmac_f32_16x16x64_bf16 v[52:55], v[10:13], a[152:159], v1
 s_waitcnt lgkmcnt(2)
 v_smfmac_f32_16x16x64_bf16 v[52:55], v[14:17], a[160:167], v1
 ds_read_b128 v[26:29], v9 offset:0
 ds_read_b128 v[30:33], v9 offset:1024
 s_waitcnt lgkmcnt(3)
 v_smfmac_f32_16x16x64_bf16 v[52:55], v[18:21], a[168:175], v1
 s_waitcnt lgkmcnt(2)
 v_smfmac_f32_16x16x64_bf16 v[52:55], v[22:25], a[176:183], v1
 ds_read_b128 v[34:37], v9 offset:8192
 ds_read_b128 v[38:41], v9 offset:9216
 v_smfmac_f32_16x16x64_bf16 v[56:59], v[10:13], a[184:191], v1
 s_nop 2
 v_smfmac_f32_16x16x64_bf16 v[56:59], v[14:17], a[192:199], v1
 ds_read_b128 v[42:45], v9 offset:16384
 ds_read_b128 v[46:49], v9 offset:17408
 s_nop 0
 v_smfmac_f32_16x16x64_bf16 v[56:59], v[18:21], a[200:207], v1
 v_cvt_pk_bf16_f32 v52, v52, v53
 v_smfmac_f32_16x16x64_bf16 v[56:59], v[22:25], a[208:215], v1
 v_cvt_pk_bf16_f32 v53, v54, v55
 v_smfmac_f32_16x16x64_bf16 v[60:63], v[10:13], a[216:223], v1
 s_nop 1
 v_or_b32 v52, 1, v52
 v_smfmac_f32_16x16x64_bf16 v[60:63], v[14:17], a[224:231], v1
 s_nop 1
 buffer_store_dwordx2 v[52:53], v8, s[4:7], s55 offen
 s_waitcnt lgkmcnt(4)
 v_smfmac_f32_16x16x64_bf16 v[60:63], v[18:21], v[26:33], v1
 ds_read_b128 v[26:29], v9 offset:20480
 ds_read_b128 v[30:33], v9 offset:21504
 v_cvt_pk_bf16_f32 v56, v56, v57
 v_smfmac_f32_16x16x64_bf16 v[60:63], v[22:25], a[232:239], v1
 v_cvt_pk_bf16_f32 v57, v58, v59
 s_waitcnt lgkmcnt(4)
 v_smfmac_f32_16x16x64_bf16 v[64:67], v[10:13], v[34:41], v1
 ds_read_b128 v[34:37], v9 offset:24576
 ds_read_b128 v[38:41], v9 offset:25600
 v_or_b32 v56, 1, v56
 v_smfmac_f32_16x16x64_bf16 v[64:67], v[14:17], a[240:247], v1
 s_nop 1
 buffer_store_dwordx2 v[56:57], v8, s[4:7], s56 offen
 s_waitcnt lgkmcnt(4)
 v_smfmac_f32_16x16x64_bf16 v[64:67], v[18:21], v[42:49], v1
 ds_read_b128 v[42:45], v9 offset:28672
 ds_read_b128 v[46:49], v9 offset:29696
 v_cvt_pk_bf16_f32 v60, v60, v61
 v_smfmac_f32_16x16x64_bf16 v[64:67], v[22:25], a[248:255], v1
 ds_read_b128 v[52:55], v9 offset:32768
 ds_read_b128 v[56:59], v9 offset:33792
 v_cvt_pk_bf16_f32 v61, v62, v63
 s_waitcnt lgkmcnt(6)
 v_smfmac_f32_16x16x64_bf16 v[68:71], v[10:13], v[26:33], v1
 s_nop 1
 v_or_b32 v60, 1, v60
 s_waitcnt lgkmcnt(4)
 v_smfmac_f32_16x16x64_bf16 v[68:71], v[14:17], v[34:41], v1
 s_nop 1
 buffer_store_dwordx2 v[60:61], v8, s[4:7], s57 offen
 s_waitcnt lgkmcnt(2)
 v_smfmac_f32_16x16x64_bf16 v[68:71], v[18:21], v[42:49], v1
 v_cvt_pk_bf16_f32 v64, v64, v65
 s_waitcnt lgkmcnt(0)
 v_smfmac_f32_16x16x64_bf16 v[68:71], v[22:25], v[52:59], v1
 v_cvt_pk_bf16_f32 v65, v66, v67
 v_or_b32 v64, 1, v64
 buffer_store_dwordx2 v[64:65], v8, s[4:7], s58 offen
 s_add_u32 s52, s52, 262144
 s_add_u32 s65, s65, s27
 s_mov_b64 s[28:29], -1
 s_sub_i32 s64, s50, s71
 s_mov_b32 s27, 131072
 v_cvt_pk_bf16_f32 v68, v68, v69
 v_cvt_pk_bf16_f32 v69, v70, v71
 v_or_b32 v68, 1, v68
 buffer_store_dwordx2 v[68:69], v8, s[4:7], s59 offen
 s_barrier
 s_cmp_ge_u32 s48, 8
 s_cbranch_scc1 L_nored_87
 s_nop 15
 s_nop 15
 s_nop 15
 s_nop 7
 buffer_load_dwordx4 v[10:13], v0, s[4:7], s60 offen offset:0 sc1
 buffer_load_dwordx4 v[14:17], v0, s[4:7], s60 offen offset:1024 sc1
 buffer_load_dwordx4 v[18:21], v0, s[4:7], s60 offen offset:2048 sc1
 buffer_load_dwordx4 v[22:25], v0, s[4:7], s60 offen offset:3072 sc1
 v_and_b32 v34, 16, v0
 v_mov_b32 v30, 0x3f80
 v_lshlrev_b32 v30, v34, v30
 v_bfe_u32 v34, v0, 5, 3
 v_cmp_eq_u32 vcc, 0, v34
 s_nop 1
 v_cndmask_b32 v26, 0, v30, vcc
 v_cmp_eq_u32 vcc, 1, v34
 s_nop 1
 v_cndmask_b32 v27, 0, v30, vcc
 v_cmp_eq_u32 vcc, 2, v34
 s_nop 1
 v_cndmask_b32 v28, 0, v30, vcc
 v_cmp_eq_u32 vcc, 3, v34
 s_nop 1
 v_cndmask_b32 v29, 0, v30, vcc
 v_and_b32 v35, 0xf0, v0
 v_bfe_u32 v34, v0, 8, 2
 v_lshl_add_u32 v35, v34, 2, v35
 v_and_b32 v34, 0x80, v0
 v_lshl_add_u32 v35, v34, 23, v35
 v_mov_b64 v[42:43], 0
 v_mov_b64 v[44:45], 0
 v_mov_b64 v[46:47], 0
 v_mov_b64 v[48:49], 0
 v_mov_b64 v[50:51], 0
 v_mov_b64 v[52:53], 0
 v_and_b32 v70, 0xf0, v0
 v_bfe_u32 v71, v0, 8, 2
 v_lshl_add_u32 v71, v71, 9, s67
 v_add_u32 v70, v70, v71
 v_add_u32 v9, 57344, v3
 s_barrier
 s_waitcnt vmcnt(3)
 v_mfma_f32_16x16x32_bf16 v[30:33], v[10:13], v[26:29], 0
 v_bitop3_b32 v34, v10, v12, v12 bitop3:0x80
 s_waitcnt vmcnt(2)
 v_mfma_f32_16x16x32_bf16 v[30:33], v[14:17], v[26:29], v[30:33]
 v_bitop3_b32 v34, v34, v14, v16 bitop3:0x80
 s_waitcnt vmcnt(1)
 v_mfma_f32_16x16x32_bf16 v[30:33], v[18:21], v[26:29], v[30:33]
 v_bitop3_b32 v34, v34, v18, v20 bitop3:0x80
 s_waitcnt vmcnt(0)
 v_mfma_f32_16x16x32_bf16 v[30:33], v[22:25], v[26:29], v[30:33]
 v_bitop3_b32 v34, v34, v22, v24 bitop3:0x80
 v_and_b32 v34, 1, v34
 v_cmp_ne_u32 vcc, 1, v34
 s_cbranch_vccnz L_rre_89
 s_nop 3
 v_permlane32_swap_b32 v30, v31
 v_permlane32_swap_b32 v32, v33
 v_add_f32 v30, v30, v31
 v_add_f32 v32, v32, v33
 v_cvt_pk_bf16_f32 v30, v30, v32
 v_or_b32 v30, 1, v30
 buffer_store_dword v30, v35, s[4:7], s61 offen
L_rback_90:
L_redj_88:
 ds_read_b128 v[26:29], v3 offset:0
 ds_read_b128 v[30:33], v3 offset:1024
 ds_read_b128 v[62:65], v3 offset:8192
 ds_read_b128 v[66:69], v3 offset:9216
 ds_read_b128 v[34:37], v3 offset:16384
 ds_read_b128 v[38:41], v3 offset:17408
 s_barrier
 s_mov_b32 m0, 4096
 s_nop 0
 buffer_load_dwordx4 v0, s[4:7], s25 offen offset:2048 sc1 lds
 buffer_load_dwordx4 v0, s[4:7], s25 offen offset:3072 sc1 lds
 s_branch L_loop_75
L_last_76:
 s_waitcnt lgkmcnt(0)
 s_barrier
 ds_read_b128 v[10:13], v4 offset:0
 ds_read_b128 v[14:17], v4 offset:512
 ds_read_b128 v[18:21], v4 offset:1024
 s_waitcnt lgkmcnt(2)
 v_smfmac_f32_16x16x64_bf16 v[50:53], v[10:13], a[8:15], v1
 v_smfmac_f32_16x16x64_bf16 v[42:45], v[10:13], v[72:79], v1
 ds_read_b128 v[22:25], v4 offset:1536
 v_smfmac_f32_16x16x64_bf16 v[46:49], v[10:13], v[80:87], v1
 s_mov_b32 m0, 4096
 s_cmp_eq_u32 s50, 0
 s_cbranch_scc1 L_mb2skip_91
 buffer_load_dwordx4 v0, s[4:7], s25 offen offset:2048 sc1 lds
 buffer_load_dwordx4 v0, s[4:7], s25 offen offset:3072 sc1 lds
L_mb2skip_91:
 s_waitcnt lgkmcnt(2)
 v_smfmac_f32_16x16x64_bf16 v[50:53], v[14:17], a[16:23], v1
 v_smfmac_f32_16x16x64_bf16 v[42:45], v[14:17], v[88:95], v1
 ds_read_b128 v[10:13], v4 offset:2048
 v_smfmac_f32_16x16x64_bf16 v[46:49], v[14:17], v[26:33], v1
 ds_read_b128 v[26:29], v3 offset:24576
 s_waitcnt lgkmcnt(3)
 v_smfmac_f32_16x16x64_bf16 v[50:53], v[18:21], a[24:31], v1
 ds_read_b128 v[30:33], v3 offset:25600
 v_smfmac_f32_16x16x64_bf16 v[42:45], v[18:21], v[96:103], v1
 ds_read_b128 v[14:17], v4 offset:2560
 v_smfmac_f32_16x16x64_bf16 v[46:49], v[18:21], v[62:69], v1
 s_waitcnt vmcnt(2)
 ds_read_b128 v[62:65], v0 offset:6144
 ds_read_b128 v[66:69], v0 offset:7168
 s_waitcnt lgkmcnt(6)
 v_smfmac_f32_16x16x64_bf16 v[50:53], v[22:25], a[32:39], v1
 v_smfmac_f32_16x16x64_bf16 v[42:45], v[22:25], v[104:111], v1
 ds_read_b128 v[18:21], v4 offset:3072
 v_smfmac_f32_16x16x64_bf16 v[46:49], v[22:25], v[34:41], v1
 ds_read_b128 v[34:37], v3 offset:32768
 s_waitcnt lgkmcnt(7)
 v_smfmac_f32_16x16x64_bf16 v[50:53], v[10:13], a[40:47], v1
 ds_read_b128 v[38:41], v3 offset:33792
 v_smfmac_f32_16x16x64_bf16 v[42:45], v[10:13], v[112:119], v1
 s_waitcnt lgkmcnt(3)
 ds_read_b128 v[22:25], v4 offset:3584
 v_bitop3_b32 v62, v62, v63, v64 bitop3:0xfe
 v_bitop3_b32 v62, v62, v65, v65 bitop3:0xfe
 v_smfmac_f32_16x16x64_bf16 v[46:49], v[10:13], v[26:33], v1
 ds_read_b128 v[26:29], v3 offset:40960
 v_bitop3_b32 v62, v62, v66, v67 bitop3:0xfe
 v_smfmac_f32_16x16x64_bf16 v[50:53], v[14:17], a[48:55], v1
 ds_read_b128 v[30:33], v3 offset:41984
 v_bitop3_b32 v62, v62, v68, v69 bitop3:0xfe
 v_bitop3_b32 v62, v62, v62, s28 bitop3:0xa0
 v_smfmac_f32_16x16x64_bf16 v[42:45], v[14:17], v[120:127], v1
 v_and_b32 v62, 1, v62
 v_smfmac_f32_16x16x64_bf16 v[46:49], v[14:17], v[128:135], v1
 v_cmp_ne_u32 vcc, 0, v62
 s_waitcnt lgkmcnt(5)
 v_smfmac_f32_16x16x64_bf16 v[50:53], v[18:21], a[56:63], v1
 s_cbranch_vccnz L_mbre_93
L_mbok_92:
 s_barrier
 v_smfmac_f32_16x16x64_bf16 v[42:45], v[18:21], v[136:143], v1
 ds_read_b128 v[10:13], v4 offset:4096
 ds_read_b128 v[14:17], v4 offset:4608
 s_waitcnt lgkmcnt(5)
 v_smfmac_f32_16x16x64_bf16 v[46:49], v[18:21], v[34:41], v1
 ds_read_b128 v[34:37], v3 offset:49152
 s_waitcnt lgkmcnt(5)
 v_smfmac_f32_16x16x64_bf16 v[50:53], v[22:25], a[64:71], v1
 ds_read_b128 v[38:41], v3 offset:50176
 v_smfmac_f32_16x16x64_bf16 v[42:45], v[22:25], v[144:151], v1
 ds_read_b128 v[18:21], v4 offset:5120
 s_waitcnt lgkmcnt(5)
 v_smfmac_f32_16x16x64_bf16 v[46:49], v[22:25], v[26:33], v1
 ds_read_b128 v[26:29], v9 offset:0
 s_waitcnt lgkmcnt(5)
 v_smfmac_f32_16x16x64_bf16 v[50:53], v[10:13], a[72:79], v1
 ds_read_b128 v[30:33], v9 offset:1024
 v_smfmac_f32_16x16x64_bf16 v[42:45], v[10:13], v[152:159], v1
 ds_read_b128 v[22:25], v4 offset:5632
 v_smfmac_f32_16x16x64_bf16 v[46:49], v[10:13], v[160:167], v1
 s_waitcnt lgkmcnt(6)
 v_smfmac_f32_16x16x64_bf16 v[50:53], v[14:17], a[80:87], v1
 v_smfmac_f32_16x16x64_bf16 v[42:45], v[14:17], v[168:175], v1
 ds_read_b128 v[10:13], v4 offset:6144
 s_waitcnt lgkmcnt(5)
 v_smfmac_f32_16x16x64_bf16 v[46:49], v[14:17], v[34:41], v1
 ds_read_b128 v[34:37], v9 offset:8192
 s_waitcnt lgkmcnt(5)
 v_smfmac_f32_16x16x64_bf16 v[50:53], v[18:21], a[88:95], v1
 ds_read_b128 v[38:41], v9 offset:9216
 v_smfmac_f32_16x16x64_bf16 v[42:45], v[18:21], v[176:183], v1
 ds_read_b128 v[14:17], v4 offset:6656
 s_waitcnt lgkmcnt(5)
 v_smfmac_f32_16x16x64_bf16 v[46:49], v[18:21], v[26:33], v1
 ds_read_b128 v[26:29], v9 offset:16384
 s_waitcnt lgkmcnt(5)
 v_smfmac_f32_16x16x64_bf16 v[50:53], v[22:25], a[96:103], v1
 ds_read_b128 v[30:33], v9 offset:17408
 v_smfmac_f32_16x16x64_bf16 v[42:45], v[22:25], v[184:191], v1
 ds_read_b128 v[18:21], v4 offset:7168
 v_smfmac_f32_16x16x64_bf16 v[46:49], v[22:25], v[192:199], v1
 ds_read_b128 v[62:65], v9 offset:24576
 s_waitcnt lgkmcnt(7)
 v_smfmac_f32_16x16x64_bf16 v[42:45], v[10:13], v[200:207], v1
 ds_read_b128 v[66:69], v9 offset:25600
 ds_read_b128 v[22:25], v4 offset:7680
 s_waitcnt lgkmcnt(7)
 v_smfmac_f32_16x16x64_bf16 v[46:49], v[10:13], v[34:41], v1
 ds_read_b128 v[34:37], v9 offset:32768
 s_waitcnt lgkmcnt(7)
 v_smfmac_f32_16x16x64_bf16 v[42:45], v[14:17], v[208:215], v1
 ds_read_b128 v[38:41], v9 offset:33792
 ds_read_b128 v[10:13], v4 offset:8192
 s_waitcnt lgkmcnt(7)
 v_smfmac_f32_16x16x64_bf16 v[46:49], v[14:17], v[26:33], v1
 s_waitcnt lgkmcnt(6)
 v_smfmac_f32_16x16x64_bf16 v[42:45], v[18:21], v[216:223], v1
 ds_read_b128 v[14:17], v4 offset:8704
 s_waitcnt lgkmcnt(5)
 v_smfmac_f32_16x16x64_bf16 v[46:49], v[18:21], v[62:69], v1
 s_waitcnt lgkmcnt(4)
 v_smfmac_f32_16x16x64_bf16 v[42:45], v[22:25], v[224:231], v1
 ds_read_b128 v[18:21], v4 offset:6144
 s_waitcnt lgkmcnt(3)
 v_smfmac_f32_16x16x64_bf16 v[46:49], v[22:25], v[34:41], v1
 ds_read_b128 v[66:69], v0 offset:14656
 s_waitcnt lgkmcnt(3)
 v_smfmac_f32_16x16x64_bf16 v[42:45], v[10:13], v[232:239], v1
 ds_read_b128 v[22:25], v4 offset:6656
 v_smfmac_f32_16x16x64_bf16 v[46:49], v[10:13], v[240:247], v1
 s_waitcnt lgkmcnt(3)
 v_smfmac_f32_16x16x64_bf16 v[42:45], v[14:17], v[248:255], v1
 ds_read_b128 v[10:13], v4 offset:7168
 v_smfmac_f32_16x16x64_bf16 v[46:49], v[14:17], a[0:7], v1
 ds_read_b128 v[14:17], v4 offset:7680
 s_waitcnt lgkmcnt(4)
 v_smfmac_f32_16x16x64_bf16 v[50:53], v[18:21], a[104:111], v1
 s_nop 1
 s_waitcnt lgkmcnt(2)
 v_smfmac_f32_16x16x64_bf16 v[50:53], v[22:25], a[112:119], v1
 s_nop 2
 v_cvt_pk_bf16_f32 v62, v42, v43
 v_cvt_pk_bf16_f32 v63, v44, v45
 ds_write_b64 v5, v[62:63]
 v_cvt_pk_bf16_f32 v64, v46, v47
 v_cvt_pk_bf16_f32 v65, v48, v49
 ds_write_b64 v5, v[64:65] offset:2176
 ds_read_b128 v[42:45], v4 offset:8192
 ds_read_b128 v[46:49], v4 offset:8704
 s_waitcnt lgkmcnt(5)
 v_smfmac_f32_16x16x64_bf16 v[50:53], v[10:13], a[120:127], v1
 buffer_store_dwordx4 v[66:69], v0, s[4:7], s65 offen offset:0 sc1
 s_waitcnt lgkmcnt(4)
 v_smfmac_f32_16x16x64_bf16 v[50:53], v[14:17], a[128:135], v1
 s_waitcnt lgkmcnt(2)
 s_barrier
 s_waitcnt lgkmcnt(1)
 v_smfmac_f32_16x16x64_bf16 v[50:53], v[42:45], a[136:143], v1
 s_waitcnt lgkmcnt(0)
 v_smfmac_f32_16x16x64_bf16 v[50:53], v[46:49], a[144:151], v1
 s_nop 7
 v_cvt_pk_bf16_f32 v40, v50, v51
 v_cvt_pk_bf16_f32 v41, v52, v53
 ds_write_b64 v5, v[40:41] offset:4352
 s_add_u32 s65, s65, 131072
 s_waitcnt vmcnt(0) lgkmcnt(0)
 s_barrier
 ds_read_b128 v[66:69], v0 offset:14656
 s_waitcnt lgkmcnt(0)
 v_or_b32 v66, 1, v66
 v_or_b32 v67, 1, v67
 v_or_b32 v68, 1, v68
 v_or_b32 v69, 1, v69
 buffer_store_dwordx4 v[66:69], v0, s[4:7], s65 offen offset:0 sc1
 s_branch L_done0
L_mbre_79:
 s_mov_b32 m0, 4096
 s_nop 0
 buffer_load_dwordx4 v0, s[4:7], s25 offen offset:2048 sc1 lds
 buffer_load_dwordx4 v0, s[4:7], s25 offen offset:3072 sc1 lds
 s_add_u32 s51, s51, 65536
 s_waitcnt vmcnt(3)
 ds_read_b128 v[62:65], v0 offset:6144
 ds_read_b128 v[66:69], v0 offset:7168
 s_waitcnt lgkmcnt(0)
 v_bitop3_b32 v62, v62, v63, v64 bitop3:0x80
 v_bitop3_b32 v62, v62, v65, v65 bitop3:0x80
 v_bitop3_b32 v62, v62, v66, v67 bitop3:0x80
 v_bitop3_b32 v62, v62, v68, v69 bitop3:0x80
 v_bitop3_b32 v62, v62, v62, s28 bitop3:0xf5
 v_and_b32 v62, 1, v62
 v_cmp_ne_u32 vcc, 1, v62
 s_cbranch_vccz L_mbok_78
 s_mov_b32 m0, 4096
 s_nop 0
 buffer_load_dwordx4 v0, s[4:7], s25 offen offset:2048 sc1 lds
 buffer_load_dwordx4 v0, s[4:7], s25 offen offset:3072 sc1 lds
 s_nop 15
 s_nop 3
L_mbspin_94:
 s_mov_b32 m0, 4096
 s_nop 0
 buffer_load_dwordx4 v0, s[4:7], s25 offen offset:2048 sc1 lds
 buffer_load_dwordx4 v0, s[4:7], s25 offen offset:3072 sc1 lds
 s_add_u32 s51, s51, 65536
 s_cmp_gt_u32 s51, 1310720000
 s_cbranch_scc1 L_exit0
 s_waitcnt vmcnt(4)
 ds_read_b128 v[62:65], v0 offset:6144
 ds_read_b128 v[66:69], v0 offset:7168
 s_waitcnt lgkmcnt(0)
 v_bitop3_b32 v62, v62, v63, v64 bitop3:0x80
 v_bitop3_b32 v62, v62, v65, v65 bitop3:0x80
 v_bitop3_b32 v62, v62, v66, v67 bitop3:0x80
 v_bitop3_b32 v62, v62, v68, v69 bitop3:0x80
 v_bitop3_b32 v62, v62, v62, s28 bitop3:0xf5
 v_and_b32 v62, 1, v62
 v_cmp_ne_u32 vcc, 1, v62
 s_cbranch_vccnz L_mbspin_94
 s_branch L_mbok_78
L_nored_80:
 v_mov_b64 v[42:43], 0
 v_mov_b64 v[44:45], 0
 v_mov_b64 v[46:47], 0
 v_mov_b64 v[48:49], 0
 v_mov_b64 v[50:51], 0
 v_mov_b64 v[52:53], 0
 v_and_b32 v70, 0xf0, v0
 v_bfe_u32 v71, v0, 8, 2
 v_lshl_add_u32 v71, v71, 9, s67
 v_add_u32 v70, v70, v71
 v_add_u32 v9, 57344, v3
 s_barrier
 s_branch L_redj_81
L_rre_82:
 buffer_load_dwordx4 v[10:13], v0, s[4:7], s60 offen offset:0 sc1
 buffer_load_dwordx4 v[14:17], v0, s[4:7], s60 offen offset:1024 sc1
 buffer_load_dwordx4 v[18:21], v0, s[4:7], s60 offen offset:2048 sc1
 buffer_load_dwordx4 v[22:25], v0, s[4:7], s60 offen offset:3072 sc1
 s_nop 15
 s_nop 7
L_rspin_95:
 buffer_load_dwordx4 v[54:57], v0, s[4:7], s60 offen offset:0 sc1
 buffer_load_dwordx4 v[58:61], v0, s[4:7], s60 offen offset:1024 sc1
 buffer_load_dwordx4 v[62:65], v0, s[4:7], s60 offen offset:2048 sc1
 buffer_load_dwordx4 v[66:69], v0, s[4:7], s60 offen offset:3072 sc1
 s_add_u32 s51, s51, 1
 s_waitcnt vmcnt(7)
 v_mfma_f32_16x16x32_bf16 v[30:33], v[10:13], v[26:29], 0
 v_bitop3_b32 v34, v10, v12, v12 bitop3:0xfe
 s_waitcnt vmcnt(6)
 v_mfma_f32_16x16x32_bf16 v[30:33], v[14:17], v[26:29], v[30:33]
 v_bitop3_b32 v34, v34, v14, v16 bitop3:0xfe
 s_waitcnt vmcnt(5)
 v_mfma_f32_16x16x32_bf16 v[30:33], v[18:21], v[26:29], v[30:33]
 v_bitop3_b32 v34, v34, v18, v20 bitop3:0xfe
 s_waitcnt vmcnt(4)
 v_mfma_f32_16x16x32_bf16 v[30:33], v[22:25], v[26:29], v[30:33]
 v_bitop3_b32 v34, v34, v22, v24 bitop3:0xfe
 v_and_b32 v34, 1, v34
 v_cmp_ne_u32 vcc, 0, v34
 s_cbranch_vccz L_rok_96
 buffer_load_dwordx4 v[10:13], v0, s[4:7], s60 offen offset:0 sc1
 buffer_load_dwordx4 v[14:17], v0, s[4:7], s60 offen offset:1024 sc1
 buffer_load_dwordx4 v[18:21], v0, s[4:7], s60 offen offset:2048 sc1
 buffer_load_dwordx4 v[22:25], v0, s[4:7], s60 offen offset:3072 sc1
 s_add_u32 s51, s51, 1
 s_waitcnt vmcnt(7)
 v_mfma_f32_16x16x32_bf16 v[30:33], v[54:57], v[26:29], 0
 v_bitop3_b32 v34, v54, v56, v56 bitop3:0xfe
 s_waitcnt vmcnt(6)
 v_mfma_f32_16x16x32_bf16 v[30:33], v[58:61], v[26:29], v[30:33]
 v_bitop3_b32 v34, v34, v58, v60 bitop3:0xfe
 s_waitcnt vmcnt(5)
 v_mfma_f32_16x16x32_bf16 v[30:33], v[62:65], v[26:29], v[30:33]
 v_bitop3_b32 v34, v34, v62, v64 bitop3:0xfe
 s_waitcnt vmcnt(4)
 v_mfma_f32_16x16x32_bf16 v[30:33], v[66:69], v[26:29], v[30:33]
 v_bitop3_b32 v34, v34, v66, v68 bitop3:0xfe
 v_and_b32 v34, 1, v34
 v_cmp_ne_u32 vcc, 0, v34
 s_cbranch_vccz L_rok_96
 s_and_b32 s3, s51, 0xffff
 s_cmp_gt_u32 s3, 20000
 s_cbranch_scc0 L_rspin_95
 s_branch L_exit0
L_rok_96:
 s_nop 3
 v_permlane32_swap_b32 v30, v31
 v_permlane32_swap_b32 v32, v33
 v_add_f32 v30, v30, v31
 v_add_f32 v32, v32, v33
 v_cvt_pk_bf16_f32 v30, v30, v32
 v_and_b32 v30, -2, v30
 buffer_store_dword v30, v35, s[4:7], s61 offen
 s_waitcnt vmcnt(1)
 s_branch L_rback_83
L_mbre_86:
 s_mov_b32 m0, 4096
 s_nop 0
 buffer_load_dwordx4 v0, s[4:7], s25 offen offset:2048 sc1 lds
 buffer_load_dwordx4 v0, s[4:7], s25 offen offset:3072 sc1 lds
 s_add_u32 s51, s51, 65536
 s_waitcnt vmcnt(3)
 ds_read_b128 v[62:65], v0 offset:6144
 ds_read_b128 v[66:69], v0 offset:7168
 s_waitcnt lgkmcnt(0)
 v_bitop3_b32 v62, v62, v63, v64 bitop3:0xfe
 v_bitop3_b32 v62, v62, v65, v65 bitop3:0xfe
 v_bitop3_b32 v62, v62, v66, v67 bitop3:0xfe
 v_bitop3_b32 v62, v62, v68, v69 bitop3:0xfe
 v_bitop3_b32 v62, v62, v62, s28 bitop3:0xa0
 v_and_b32 v62, 1, v62
 v_cmp_ne_u32 vcc, 0, v62
 s_cbranch_vccz L_mbok_85
 s_mov_b32 m0, 4096
 s_nop 0
 buffer_load_dwordx4 v0, s[4:7], s25 offen offset:2048 sc1 lds
 buffer_load_dwordx4 v0, s[4:7], s25 offen offset:3072 sc1 lds
 s_nop 15
 s_nop 3
L_mbspin_97:
 s_mov_b32 m0, 4096
 s_nop 0
 buffer_load_dwordx4 v0, s[4:7], s25 offen offset:2048 sc1 lds
 buffer_load_dwordx4 v0, s[4:7], s25 offen offset:3072 sc1 lds
 s_add_u32 s51, s51, 65536
 s_cmp_gt_u32 s51, 1310720000
 s_cbranch_scc1 L_exit0
 s_waitcnt vmcnt(4)
 ds_read_b128 v[62:65], v0 offset:6144
 ds_read_b128 v[66:69], v0 offset:7168
 s_waitcnt lgkmcnt(0)
 v_bitop3_b32 v62, v62, v63, v64 bitop3:0xfe
 v_bitop3_b32 v62, v62, v65, v65 bitop3:0xfe
 v_bitop3_b32 v62, v62, v66, v67 bitop3:0xfe
 v_bitop3_b32 v62, v62, v68, v69 bitop3:0xfe
 v_bitop3_b32 v62, v62, v62, s28 bitop3:0xa0
 v_and_b32 v62, 1, v62
 v_cmp_ne_u32 vcc, 0, v62
 s_cbranch_vccnz L_mbspin_97
 s_branch L_mbok_85
L_nored_87:
 v_mov_b64 v[42:43], 0
 v_mov_b64 v[44:45], 0
 v_mov_b64 v[46:47], 0
 v_mov_b64 v[48:49], 0
 v_mov_b64 v[50:51], 0
 v_mov_b64 v[52:53], 0
 v_and_b32 v70, 0xf0, v0
 v_bfe_u32 v71, v0, 8, 2
 v_lshl_add_u32 v71, v71, 9, s67
 v_add_u32 v70, v70, v71
 v_add_u32 v9, 57344, v3
 s_barrier
 s_branch L_redj_88
L_rre_89:
 buffer_load_dwordx4 v[10:13], v0, s[4:7], s60 offen offset:0 sc1
 buffer_load_dwordx4 v[14:17], v0, s[4:7], s60 offen offset:1024 sc1
 buffer_load_dwordx4 v[18:21], v0, s[4:7], s60 offen offset:2048 sc1
 buffer_load_dwordx4 v[22:25], v0, s[4:7], s60 offen offset:3072 sc1
 s_nop 15
 s_nop 7
L_rspin_98:
 buffer_load_dwordx4 v[54:57], v0, s[4:7], s60 offen offset:0 sc1
 buffer_load_dwordx4 v[58:61], v0, s[4:7], s60 offen offset:1024 sc1
 buffer_load_dwordx4 v[62:65], v0, s[4:7], s60 offen offset:2048 sc1
 buffer_load_dwordx4 v[66:69], v0, s[4:7], s60 offen offset:3072 sc1
 s_add_u32 s51, s51, 1
 s_waitcnt vmcnt(7)
 v_mfma_f32_16x16x32_bf16 v[30:33], v[10:13], v[26:29], 0
 v_bitop3_b32 v34, v10, v12, v12 bitop3:0x80
 s_waitcnt vmcnt(6)
 v_mfma_f32_16x16x32_bf16 v[30:33], v[14:17], v[26:29], v[30:33]
 v_bitop3_b32 v34, v34, v14, v16 bitop3:0x80
 s_waitcnt vmcnt(5)
 v_mfma_f32_16x16x32_bf16 v[30:33], v[18:21], v[26:29], v[30:33]
 v_bitop3_b32 v34, v34, v18, v20 bitop3:0x80
 s_waitcnt vmcnt(4)
 v_mfma_f32_16x16x32_bf16 v[30:33], v[22:25], v[26:29], v[30:33]
 v_bitop3_b32 v34, v34, v22, v24 bitop3:0x80
 v_and_b32 v34, 1, v34
 v_cmp_ne_u32 vcc, 1, v34
 s_cbranch_vccz L_rok_99
 buffer_load_dwordx4 v[10:13], v0, s[4:7], s60 offen offset:0 sc1
 buffer_load_dwordx4 v[14:17], v0, s[4:7], s60 offen offset:1024 sc1
 buffer_load_dwordx4 v[18:21], v0, s[4:7], s60 offen offset:2048 sc1
 buffer_load_dwordx4 v[22:25], v0, s[4:7], s60 offen offset:3072 sc1
 s_add_u32 s51, s51, 1
 s_waitcnt vmcnt(7)
 v_mfma_f32_16x16x32_bf16 v[30:33], v[54:57], v[26:29], 0
 v_bitop3_b32 v34, v54, v56, v56 bitop3:0x80
 s_waitcnt vmcnt(6)
 v_mfma_f32_16x16x32_bf16 v[30:33], v[58:61], v[26:29], v[30:33]
 v_bitop3_b32 v34, v34, v58, v60 bitop3:0x80
 s_waitcnt vmcnt(5)
 v_mfma_f32_16x16x32_bf16 v[30:33], v[62:65], v[26:29], v[30:33]
 v_bitop3_b32 v34, v34, v62, v64 bitop3:0x80
 s_waitcnt vmcnt(4)
 v_mfma_f32_16x16x32_bf16 v[30:33], v[66:69], v[26:29], v[30:33]
 v_bitop3_b32 v34, v34, v66, v68 bitop3:0x80
 v_and_b32 v34, 1, v34
 v_cmp_ne_u32 vcc, 1, v34
 s_cbranch_vccz L_rok_99
 s_and_b32 s3, s51, 0xffff
 s_cmp_gt_u32 s3, 20000
 s_cbranch_scc0 L_rspin_98
 s_branch L_exit0
L_rok_99:
 s_nop 3
 v_permlane32_swap_b32 v30, v31
 v_permlane32_swap_b32 v32, v33
 v_add_f32 v30, v30, v31
 v_add_f32 v32, v32, v33
 v_cvt_pk_bf16_f32 v30, v30, v32
 v_or_b32 v30, 1, v30
 buffer_store_dword v30, v35, s[4:7], s61 offen
 s_waitcnt vmcnt(1)
 s_branch L_rback_90
L_mbre_93:
 s_mov_b32 m0, 4096
 s_nop 0
 buffer_load_dwordx4 v0, s[4:7], s25 offen offset:2048 sc1 lds
 buffer_load_dwordx4 v0, s[4:7], s25 offen offset:3072 sc1 lds
 s_add_u32 s51, s51, 65536
 s_waitcnt vmcnt(2)
 ds_read_b128 v[62:65], v0 offset:6144
 ds_read_b128 v[66:69], v0 offset:7168
 s_waitcnt lgkmcnt(0)
 v_bitop3_b32 v62, v62, v63, v64 bitop3:0xfe
 v_bitop3_b32 v62, v62, v65, v65 bitop3:0xfe
 v_bitop3_b32 v62, v62, v66, v67 bitop3:0xfe
 v_bitop3_b32 v62, v62, v68, v69 bitop3:0xfe
 v_bitop3_b32 v62, v62, v62, s28 bitop3:0xa0
 v_and_b32 v62, 1, v62
 v_cmp_ne_u32 vcc, 0, v62
 s_cbranch_vccz L_mbok_92
 s_mov_b32 m0, 4096
 s_nop 0
 buffer_load_dwordx4 v0, s[4:7], s25 offen offset:2048 sc1 lds
 buffer_load_dwordx4 v0, s[4:7], s25 offen offset:3072 sc1 lds
 s_nop 15
 s_nop 3
L_mbspin_100:
 s_mov_b32 m0, 4096
 s_nop 0
 buffer_load_dwordx4 v0, s[4:7], s25 offen offset:2048 sc1 lds
 buffer_load_dwordx4 v0, s[4:7], s25 offen offset:3072 sc1 lds
 s_add_u32 s51, s51, 65536
 s_cmp_gt_u32 s51, 1310720000
 s_cbranch_scc1 L_exit0
 s_waitcnt vmcnt(4)
 ds_read_b128 v[62:65], v0 offset:6144
 ds_read_b128 v[66:69], v0 offset:7168
 s_waitcnt lgkmcnt(0)
 v_bitop3_b32 v62, v62, v63, v64 bitop3:0xfe
 v_bitop3_b32 v62, v62, v65, v65 bitop3:0xfe
 v_bitop3_b32 v62, v62, v66, v67 bitop3:0xfe
 v_bitop3_b32 v62, v62, v68, v69 bitop3:0xfe
 v_bitop3_b32 v62, v62, v62, s28 bitop3:0xa0
 v_and_b32 v62, 1, v62
 v_cmp_ne_u32 vcc, 0, v62
 s_cbranch_vccnz L_mbspin_100
 s_branch L_mbok_92
L_wave3_18:
 v_mov_b64 v[42:43], 0
 v_mov_b64 v[44:45], 0
 v_mov_b64 v[46:47], 0
 v_mov_b64 v[48:49], 0
 v_mov_b64 v[50:51], 0
 v_mov_b64 v[52:53], 0
 v_and_b32 v70, 0xf0, v0
 v_bfe_u32 v71, v0, 8, 2
 v_lshl_add_u32 v71, v71, 9, s67
 v_add_u32 v70, v70, v71
 v_add_u32 v9, 57344, v3
 ds_read_b128 v[26:29], v3 offset:0
 ds_read_b128 v[30:33], v3 offset:1024
 ds_read_b128 v[62:65], v3 offset:8192
 ds_read_b128 v[66:69], v3 offset:9216
 ds_read_b128 v[34:37], v3 offset:16384
 ds_read_b128 v[38:41], v3 offset:17408
 .p2align 6
L_loop_101:
 s_waitcnt lgkmcnt(0)
 s_barrier
 s_mov_b32 s51, 0
 ds_read_b128 v[10:13], v4 offset:0
 ds_read_b128 v[14:17], v4 offset:512
 s_waitcnt vmcnt(3)
 ds_read_b128 v[18:21], v4 offset:1024
 s_add_u32 s72, s52, 16777216
 buffer_load_dwordx4 v[54:57], v70, s[4:7], s72 offen sc1
 buffer_load_dwordx4 v[58:61], v70, s[4:7], s72 offen offset:256 sc1
 s_waitcnt lgkmcnt(2)
 v_smfmac_f32_16x16x64_bf16 v[50:53], v[10:13], a[8:15], v1
 v_lshlrev_b32 v71, 2, v0
 v_smfmac_f32_16x16x64_bf16 v[42:45], v[10:13], v[72:79], v1
 ds_read_b128 v[22:25], v4 offset:1536
 v_smfmac_f32_16x16x64_bf16 v[46:49], v[10:13], v[80:87], v1
 s_mov_b32 m0, 8192
 s_cmp_eq_u32 s50, 0
 s_cbranch_scc1 L_mb2skip_103
 buffer_load_dwordx4 v0, s[4:7], s26 offen offset:0 sc1 lds
L_mb2skip_103:
 s_waitcnt lgkmcnt(2)
 v_smfmac_f32_16x16x64_bf16 v[50:53], v[14:17], a[16:23], v1
 v_smfmac_f32_16x16x64_bf16 v[42:45], v[14:17], v[88:95], v1
 ds_read_b128 v[10:13], v4 offset:2048
 v_smfmac_f32_16x16x64_bf16 v[46:49], v[14:17], v[26:33], v1
 ds_read_b128 v[26:29], v3 offset:24576
 s_add_u32 s73, s52, 524288
 s_min_u32 s73, s73, 16515072
 s_add_u32 s73, s73, s68
 s_waitcnt lgkmcnt(3)
 v_smfmac_f32_16x16x64_bf16 v[50:53], v[18:21], a[24:31], v1
 ds_read_b128 v[30:33], v3 offset:25600
 v_smfmac_f32_16x16x64_bf16 v[42:45], v[18:21], v[96:103], v1
 ds_read_b128 v[14:17], v4 offset:2560
 s_mov_b32 m0, 23936
 s_nop 0
 buffer_load_dword v71, s[4:7], s73 offen sc1 lds
 v_smfmac_f32_16x16x64_bf16 v[46:49], v[18:21], v[62:69], v1
 s_waitcnt vmcnt(4)
 ds_read_b128 v[62:65], v0 offset:8192
 s_waitcnt lgkmcnt(5)
 v_smfmac_f32_16x16x64_bf16 v[50:53], v[22:25], a[32:39], v1
 v_smfmac_f32_16x16x64_bf16 v[42:45], v[22:25], v[104:111], v1
 ds_read_b128 v[18:21], v4 offset:3072
 v_smfmac_f32_16x16x64_bf16 v[46:49], v[22:25], v[34:41], v1
 ds_read_b128 v[34:37], v3 offset:32768
 s_waitcnt lgkmcnt(6)
 v_smfmac_f32_16x16x64_bf16 v[50:53], v[10:13], a[40:47], v1
 ds_read_b128 v[38:41], v3 offset:33792
 v_smfmac_f32_16x16x64_bf16 v[42:45], v[10:13], v[112:119], v1
 s_waitcnt lgkmcnt(3)
 ds_read_b128 v[22:25], v4 offset:3584
 v_bitop3_b32 v62, v62, v63, v64 bitop3:0x80
 v_bitop3_b32 v62, v62, v65, v65 bitop3:0x80
 v_smfmac_f32_16x16x64_bf16 v[46:49], v[10:13], v[26:33], v1
 ds_read_b128 v[26:29], v3 offset:40960
 v_bitop3_b32 v62, v62, v62, s28 bitop3:0xf5
 v_smfmac_f32_16x16x64_bf16 v[50:53], v[14:17], a[48:55], v1
 ds_read_b128 v[30:33], v3 offset:41984
 v_and_b32 v62, 1, v62
 v_cmp_ne_u32 vcc, 1, v62
 v_smfmac_f32_16x16x64_bf16 v[42:45], v[14:17], v[120:127], v1
 v_smfmac_f32_16x16x64_bf16 v[46:49], v[14:17], v[128:135], v1
 s_waitcnt lgkmcnt(5)
 v_smfmac_f32_16x16x64_bf16 v[50:53], v[18:21], a[56:63], v1
 s_cbranch_vccnz L_mbre_105
L_mbok_104:
 s_barrier
 v_smfmac_f32_16x16x64_bf16 v[42:45], v[18:21], v[136:143], v1
 ds_read_b128 v[10:13], v4 offset:4096
 ds_read_b128 v[14:17], v4 offset:4608
 s_waitcnt lgkmcnt(5)
 v_smfmac_f32_16x16x64_bf16 v[46:49], v[18:21], v[34:41], v1
 ds_read_b128 v[34:37], v3 offset:49152
 s_waitcnt lgkmcnt(5)
 v_smfmac_f32_16x16x64_bf16 v[50:53], v[22:25], a[64:71], v1
 ds_read_b128 v[38:41], v3 offset:50176
 v_mov_b32 v68, s64
 v_smfmac_f32_16x16x64_bf16 v[42:45], v[22:25], v[144:151], v1
 ds_read_b128 v[18:21], v4 offset:5120
 s_mov_b64 exec, 1
 buffer_store_dword v68, v0, s[4:7], s66 offen sc1
 s_mov_b64 exec, -1
 s_waitcnt lgkmcnt(5)
 v_smfmac_f32_16x16x64_bf16 v[46:49], v[22:25], v[26:33], v1
 ds_read_b128 v[26:29], v9 offset:0
 s_waitcnt lgkmcnt(5)
 v_smfmac_f32_16x16x64_bf16 v[50:53], v[10:13], a[72:79], v1
 ds_read_b128 v[30:33], v9 offset:1024
 v_smfmac_f32_16x16x64_bf16 v[42:45], v[10:13], v[152:159], v1
 ds_read_b128 v[22:25], v4 offset:5632
 v_smfmac_f32_16x16x64_bf16 v[46:49], v[10:13], v[160:167], v1
 s_waitcnt lgkmcnt(6)
 v_smfmac_f32_16x16x64_bf16 v[50:53], v[14:17], a[80:87], v1
 v_smfmac_f32_16x16x64_bf16 v[42:45], v[14:17], v[168:175], v1
 ds_read_b128 v[10:13], v4 offset:6144
 s_waitcnt lgkmcnt(5)
 v_smfmac_f32_16x16x64_bf16 v[46:49], v[14:17], v[34:41], v1
 ds_read_b128 v[34:37], v9 offset:8192
 s_waitcnt lgkmcnt(5)
 v_smfmac_f32_16x16x64_bf16 v[50:53], v[18:21], a[88:95], v1
 ds_read_b128 v[38:41], v9 offset:9216
 v_smfmac_f32_16x16x64_bf16 v[42:45], v[18:21], v[176:183], v1
 ds_read_b128 v[14:17], v4 offset:6656
 s_waitcnt lgkmcnt(5)
 v_smfmac_f32_16x16x64_bf16 v[46:49], v[18:21], v[26:33], v1
 ds_read_b128 v[26:29], v9 offset:16384
 s_waitcnt lgkmcnt(5)
 v_smfmac_f32_16x16x64_bf16 v[50:53], v[22:25], a[96:103], v1
 ds_read_b128 v[30:33], v9 offset:17408
 v_smfmac_f32_16x16x64_bf16 v[42:45], v[22:25], v[184:191], v1
 ds_read_b128 v[18:21], v4 offset:7168
 v_smfmac_f32_16x16x64_bf16 v[46:49], v[22:25], v[192:199], v1
 ds_read_b128 v[62:65], v9 offset:24576
 s_waitcnt lgkmcnt(7)
 v_smfmac_f32_16x16x64_bf16 v[42:45], v[10:13], v[200:207], v1
 ds_read_b128 v[66:69], v9 offset:25600
 ds_read_b128 v[22:25], v4 offset:7680
 s_waitcnt lgkmcnt(7)
 v_smfmac_f32_16x16x64_bf16 v[46:49], v[10:13], v[34:41], v1
 ds_read_b128 v[34:37], v9 offset:32768
 s_waitcnt lgkmcnt(7)
 v_smfmac_f32_16x16x64_bf16 v[42:45], v[14:17], v[208:215], v1
 ds_read_b128 v[38:41], v9 offset:33792
 ds_read_b128 v[10:13], v4 offset:8192
 s_waitcnt lgkmcnt(7)
 v_smfmac_f32_16x16x64_bf16 v[46:49], v[14:17], v[26:33], v1
 s_waitcnt lgkmcnt(6)
 v_smfmac_f32_16x16x64_bf16 v[42:45], v[18:21], v[216:223], v1
 ds_read_b128 v[14:17], v4 offset:8704
 s_waitcnt lgkmcnt(5)
 v_smfmac_f32_16x16x64_bf16 v[46:49], v[18:21], v[62:69], v1
 s_waitcnt lgkmcnt(4)
 v_smfmac_f32_16x16x64_bf16 v[42:45], v[22:25], v[224:231], v1
 ds_read_b128 v[18:21], v4 offset:6144
 s_waitcnt lgkmcnt(3)
 v_smfmac_f32_16x16x64_bf16 v[46:49], v[22:25], v[34:41], v1
 s_waitcnt lgkmcnt(2)
 v_smfmac_f32_16x16x64_bf16 v[42:45], v[10:13], v[232:239], v1
 ds_read_b128 v[22:25], v4 offset:6656
 v_smfmac_f32_16x16x64_bf16 v[46:49], v[10:13], v[240:247], v1
 ds_read_b128 v[26:29], v0 offset:15744
 ds_read_b128 v[30:33], v0 offset:17792
 s_waitcnt lgkmcnt(4)
 v_smfmac_f32_16x16x64_bf16 v[42:45], v[14:17], v[248:255], v1
 ds_read_b128 v[10:13], v4 offset:7168
 v_smfmac_f32_16x16x64_bf16 v[46:49], v[14:17], a[0:7], v1
 ds_read_b128 v[34:37], v0 offset:19840
 ds_read_b128 v[38:41], v0 offset:21888
 ds_read_b128 v[14:17], v4 offset:7680
 s_waitcnt lgkmcnt(7)
 v_smfmac_f32_16x16x64_bf16 v[50:53], v[18:21], a[104:111], v1
 s_nop 1
 s_waitcnt lgkmcnt(6)
 v_smfmac_f32_16x16x64_bf16 v[50:53], v[22:25], a[112:119], v1
 s_nop 2
 v_cvt_pk_bf16_f32 v62, v42, v43
 v_cvt_pk_bf16_f32 v63, v44, v45
 ds_write_b64 v5, v[62:63]
 v_cvt_pk_bf16_f32 v64, v46, v47
 v_cvt_pk_bf16_f32 v65, v48, v49
 ds_write_b64 v5, v[64:65] offset:2176
 ds_read_b128 v[42:45], v4 offset:8192
 ds_read_b128 v[46:49], v4 offset:8704
 s_waitcnt lgkmcnt(7)
 v_smfmac_f32_16x16x64_bf16 v[50:53], v[10:13], a[120:127], v1
 s_waitcnt lgkmcnt(4)
 v_smfmac_f32_16x16x64_bf16 v[50:53], v[14:17], a[128:135], v1
 s_waitcnt lgkmcnt(2)
 s_barrier
 ds_read_b64_tr_b16 v[10:11], v6 offset:0
 ds_read_b64_tr_b16 v[12:13], v6 offset:64
 ds_read_b64_tr_b16 v[14:15], v6 offset:256
 ds_read_b64_tr_b16 v[16:17], v6 offset:320
 s_waitcnt lgkmcnt(5)
 v_smfmac_f32_16x16x64_bf16 v[50:53], v[42:45], a[136:143], v1
 ds_read_b64_tr_b16 v[18:19], v6 offset:512
 ds_read_b64_tr_b16 v[20:21], v6 offset:576
 ds_read_b64_tr_b16 v[22:23], v6 offset:768
 ds_read_b64_tr_b16 v[24:25], v6 offset:832
 s_waitcnt lgkmcnt(8)
 v_smfmac_f32_16x16x64_bf16 v[50:53], v[46:49], a[144:151], v1
 s_waitcnt lgkmcnt(6)
 v_mfma_f32_16x16x32_bf16 v[42:45], v[26:29], v[10:13], 0
 ds_read_b128 v[26:29], v0 offset:16768
 v_mov_b32 v62, v2
 v_mov_b32 v63, v2
 s_waitcnt lgkmcnt(5)
 v_mfma_f32_16x16x32_bf16 v[42:45], v[30:33], v[14:17], v[42:45]
 ds_read_b128 v[30:33], v0 offset:18816
 v_mov_b32 v64, v2
 v_mov_b32 v65, v2
 s_waitcnt lgkmcnt(4)
 v_mfma_f32_16x16x32_bf16 v[42:45], v[34:37], v[18:21], v[42:45]
 ds_read_b128 v[34:37], v0 offset:20864
 s_waitcnt lgkmcnt(3)
 v_mfma_f32_16x16x32_bf16 v[42:45], v[38:41], v[22:25], v[42:45]
 ds_read_b128 v[38:41], v0 offset:22912
 v_mfma_f32_16x16x32_bf16 v[62:65], v[10:13], v[10:13], v[62:65]
 v_cvt_pk_bf16_f32 v68, v50, v51
 v_cvt_pk_bf16_f32 v69, v52, v53
 v_mfma_f32_16x16x32_bf16 v[62:65], v[14:17], v[14:17], v[62:65]
 ds_write_b64 v5, v[68:69] offset:4352
 v_mov_b64 v[66:67], v[68:69]
 v_mfma_f32_16x16x32_bf16 v[62:65], v[18:21], v[18:21], v[62:65]
 s_nop 0
 v_mul_f32 v42, s62, v42
 v_mul_f32 v43, s62, v43
 v_mfma_f32_16x16x32_bf16 v[62:65], v[22:25], v[22:25], v[62:65]
 v_permlane32_swap_b32 v66, v68
 v_permlane32_swap_b32 v67, v69
 s_waitcnt lgkmcnt(4)
 v_mfma_f32_16x16x32_bf16 v[46:49], v[26:29], v[10:13], 0
 v_mul_f32 v44, s62, v44
 v_mul_f32 v45, s62, v45
 s_waitcnt lgkmcnt(3)
 v_mfma_f32_16x16x32_bf16 v[46:49], v[30:33], v[14:17], v[46:49]
 v_max3_f32 v70, v42, v43, v44
 s_nop 0
 s_waitcnt lgkmcnt(2)
 v_mfma_f32_16x16x32_bf16 v[46:49], v[34:37], v[18:21], v[46:49]
 v_mul_f32 v62, s62, v62
 v_mul_f32 v63, s62, v63
 s_waitcnt lgkmcnt(1)
 v_mfma_f32_16x16x32_bf16 v[46:49], v[38:41], v[22:25], v[46:49]
 v_mul_f32 v64, s62, v64
 v_mul_f32 v65, s62, v65
 v_max3_f32 v70, v70, v45, v62
 v_max3_f32 v71, v63, v64, v65
 v_mov_b64 v[30:31], 0
 v_mov_b64 v[34:35], 0
 v_mov_b64 v[22:23], s[76:77]
 v_mov_b64 v[24:25], s[76:77]
 v_pk_mul_f32 v[46:47], v[46:47], s[62:63]
 v_pk_mul_f32 v[48:49], v[48:49], s[62:63]
 v_max3_f32 v70, v70, v71, v46
 v_max3_f32 v71, v47, v48, v49
 v_max_f32 v21, v70, v71
 v_max_f32 v70, v70, v71
 s_nop 1
 v_permlane16_swap_b32 v70, v21
 v_max_f32 v71, v70, v21
 v_max_f32 v70, v70, v21
 s_nop 1
 v_permlane32_swap_b32 v70, v71
 v_max_f32 v70, v70, v71
 v_pk_add_f32 v[42:43], v[42:43], v[70:71] op_sel_hi:[1,0] neg_lo:[0,1] neg_hi:[0,1]
 v_pk_add_f32 v[44:45], v[44:45], v[70:71] op_sel_hi:[1,0] neg_lo:[0,1] neg_hi:[0,1]
 v_pk_add_f32 v[46:47], v[46:47], v[70:71] op_sel_hi:[1,0] neg_lo:[0,1] neg_hi:[0,1]
 v_pk_add_f32 v[48:49], v[48:49], v[70:71] op_sel_hi:[1,0] neg_lo:[0,1] neg_hi:[0,1]
 v_pk_add_f32 v[62:63], v[62:63], v[70:71] op_sel_hi:[1,0] neg_lo:[0,1] neg_hi:[0,1]
 v_pk_add_f32 v[64:65], v[64:65], v[70:71] op_sel_hi:[1,0] neg_lo:[0,1] neg_hi:[0,1]
 v_exp_f32 v42, v42
 v_exp_f32 v43, v43
 v_exp_f32 v44, v44
 v_exp_f32 v45, v45
 v_exp_f32 v46, v46
 v_exp_f32 v47, v47
 v_exp_f32 v48, v48
 v_exp_f32 v49, v49
 v_exp_f32 v62, v62
 v_cvt_pk_bf16_f32 v26, v42, v43
 v_cvt_pk_bf16_f32 v27, v44, v45
 v_cvt_pk_bf16_f32 v28, v46, v47
 v_cvt_pk_bf16_f32 v29, v48, v49
 v_exp_f32 v63, v63
 s_waitcnt vmcnt(2)
 v_mfma_f32_16x16x32_bf16 v[10:13], v[22:25], v[26:29], 0
 v_exp_f32 v64, v64
 v_mfma_f32_16x16x32_bf16 v[14:17], v[54:57], v[26:29], 0
 v_exp_f32 v65, v65
 v_mfma_f32_16x16x32_bf16 v[36:39], v[58:61], v[26:29], 0
 v_cvt_pk_bf16_f32 v32, v62, v63
 v_cvt_pk_bf16_f32 v33, v64, v65
 s_nop 1
 v_mfma_f32_16x16x32_bf16 v[10:13], v[22:25], v[32:35], v[10:13]
 v_mfma_f32_16x16x32_bf16 v[14:17], v[66:69], v[32:35], v[14:17]
 v_mfma_f32_16x16x32_bf16 v[36:39], v[66:69], v[30:33], v[36:39]
 v_add_u32 v9, 98304, v3
 v_mov_b64 v[52:53], 0
 v_mov_b64 v[54:55], 0
 v_mov_b64 v[56:57], 0
 v_mov_b64 v[58:59], 0
 s_nop 0
 v_rcp_f32 v18, v10
 v_mov_b64 v[60:61], 0
 v_pk_mul_f32 v[14:15], v[14:15], v[18:19] op_sel_hi:[1,0]
 v_pk_mul_f32 v[16:17], v[16:17], v[18:19] op_sel_hi:[1,0]
 v_pk_mul_f32 v[36:37], v[36:37], v[18:19] op_sel_hi:[1,0]
 v_pk_mul_f32 v[38:39], v[38:39], v[18:19] op_sel_hi:[1,0]
 v_cvt_pk_bf16_f32 v22, v14, v15
 v_cvt_pk_bf16_f32 v23, v16, v17
 v_cvt_pk_bf16_f32 v24, v36, v37
 v_cvt_pk_bf16_f32 v25, v38, v39
 ds_write_b128 v7, v[22:25]
 s_add_u32 s50, s50, 1
 v_mov_b64 v[62:63], 0
 v_mov_b64 v[64:65], 0
 v_mov_b64 v[66:67], 0
 v_mov_b64 v[68:69], 0
 v_mov_b64 v[70:71], 0
 s_waitcnt lgkmcnt(0)
 s_barrier
 ds_read_b128 v[10:13], v4 offset:0
 ds_read_b128 v[14:17], v4 offset:512
 ds_read_b128 v[18:21], v4 offset:1024
 ds_read_b128 v[22:25], v4 offset:1536
 s_waitcnt lgkmcnt(3)
 v_smfmac_f32_16x16x64_bf16 v[52:55], v[10:13], a[152:159], v1
 s_waitcnt lgkmcnt(2)
 v_smfmac_f32_16x16x64_bf16 v[52:55], v[14:17], a[160:167], v1
 ds_read_b128 v[26:29], v9 offset:0
 ds_read_b128 v[30:33], v9 offset:1024
 s_waitcnt lgkmcnt(3)
 v_smfmac_f32_16x16x64_bf16 v[52:55], v[18:21], a[168:175], v1
 s_waitcnt lgkmcnt(2)
 v_smfmac_f32_16x16x64_bf16 v[52:55], v[22:25], a[176:183], v1
 ds_read_b128 v[34:37], v9 offset:8192
 ds_read_b128 v[38:41], v9 offset:9216
 v_smfmac_f32_16x16x64_bf16 v[56:59], v[10:13], a[184:191], v1
 s_nop 2
 v_smfmac_f32_16x16x64_bf16 v[56:59], v[14:17], a[192:199], v1
 ds_read_b128 v[42:45], v9 offset:16384
 ds_read_b128 v[46:49], v9 offset:17408
 s_nop 0
 v_smfmac_f32_16x16x64_bf16 v[56:59], v[18:21], a[200:207], v1
 v_cvt_pk_bf16_f32 v52, v52, v53
 v_smfmac_f32_16x16x64_bf16 v[56:59], v[22:25], a[208:215], v1
 v_cvt_pk_bf16_f32 v53, v54, v55
 v_smfmac_f32_16x16x64_bf16 v[60:63], v[10:13], a[216:223], v1
 s_nop 1
 v_and_b32 v52, -2, v52
 v_smfmac_f32_16x16x64_bf16 v[60:63], v[14:17], a[224:231], v1
 s_nop 2
 s_waitcnt lgkmcnt(4)
 v_smfmac_f32_16x16x64_bf16 v[60:63], v[18:21], v[26:33], v1
 ds_read_b128 v[26:29], v9 offset:20480
 ds_read_b128 v[30:33], v9 offset:21504
 buffer_store_dwordx2 v[52:53], v8, s[4:7], s55 offen
 v_cvt_pk_bf16_f32 v56, v56, v57
 v_smfmac_f32_16x16x64_bf16 v[60:63], v[22:25], a[232:239], v1
 v_cvt_pk_bf16_f32 v57, v58, v59
 s_waitcnt lgkmcnt(4)
 v_smfmac_f32_16x16x64_bf16 v[64:67], v[10:13], v[34:41], v1
 ds_read_b128 v[34:37], v9 offset:24576
 ds_read_b128 v[38:41], v9 offset:25600
 v_and_b32 v56, -2, v56
 v_smfmac_f32_16x16x64_bf16 v[64:67], v[14:17], a[240:247], v1
 s_nop 2
 s_waitcnt lgkmcnt(4)
 v_smfmac_f32_16x16x64_bf16 v[64:67], v[18:21], v[42:49], v1
 ds_read_b128 v[42:45], v9 offset:28672
 ds_read_b128 v[46:49], v9 offset:29696
 buffer_store_dwordx2 v[56:57], v8, s[4:7], s56 offen
 v_cvt_pk_bf16_f32 v60, v60, v61
 v_smfmac_f32_16x16x64_bf16 v[64:67], v[22:25], a[248:255], v1
 ds_read_b128 v[52:55], v9 offset:32768
 ds_read_b128 v[56:59], v9 offset:33792
 v_cvt_pk_bf16_f32 v61, v62, v63
 s_waitcnt lgkmcnt(6)
 v_smfmac_f32_16x16x64_bf16 v[68:71], v[10:13], v[26:33], v1
 s_nop 1
 v_and_b32 v60, -2, v60
 s_waitcnt lgkmcnt(4)
 v_smfmac_f32_16x16x64_bf16 v[68:71], v[14:17], v[34:41], v1
 s_nop 2
 s_waitcnt lgkmcnt(2)
 v_smfmac_f32_16x16x64_bf16 v[68:71], v[18:21], v[42:49], v1
 buffer_store_dwordx2 v[60:61], v8, s[4:7], s57 offen
 v_cvt_pk_bf16_f32 v64, v64, v65
 s_waitcnt lgkmcnt(0)
 v_smfmac_f32_16x16x64_bf16 v[68:71], v[22:25], v[52:59], v1
 v_cvt_pk_bf16_f32 v65, v66, v67
 v_and_b32 v64, -2, v64
 buffer_store_dwordx2 v[64:65], v8, s[4:7], s58 offen
 s_add_u32 s52, s52, 262144
 s_add_u32 s65, s65, s27
 s_mov_b64 s[28:29], -1
 s_sub_i32 s64, s50, s71
 s_mov_b32 s27, 131072
 v_cvt_pk_bf16_f32 v68, v68, v69
 v_cvt_pk_bf16_f32 v69, v70, v71
 v_and_b32 v68, -2, v68
 buffer_store_dwordx2 v[68:69], v8, s[4:7], s59 offen
 s_barrier
 v_mov_b64 v[42:43], 0
 v_mov_b64 v[44:45], 0
 v_mov_b64 v[46:47], 0
 v_mov_b64 v[48:49], 0
 v_mov_b64 v[50:51], 0
 v_mov_b64 v[52:53], 0
 v_and_b32 v70, 0xf0, v0
 v_bfe_u32 v71, v0, 8, 2
 v_lshl_add_u32 v71, v71, 9, s67
 v_add_u32 v70, v70, v71
 v_add_u32 v9, 57344, v3
 v_bfe_u32 v37, v0, 8, 2
 v_and_b32 v36, 0x70, v0
 v_lshl_add_u32 v36, v37, 9, v36
 v_and_b32 v37, 0x80, v0
 v_lshl_add_u32 v36, v37, 1, v36
 s_nop 15
 s_nop 15
 s_nop 7
 s_mov_b32 m0, 15744
 s_add_u32 s72, s52, 0
 buffer_load_dwordx4 v36, s[4:7], s72 offen sc1 lds
 s_mov_b32 m0, 16768
 s_add_u32 s72, s52, 128
 buffer_load_dwordx4 v36, s[4:7], s72 offen sc1 lds
 s_mov_b32 m0, 17792
 s_add_u32 s72, s52, 2048
 buffer_load_dwordx4 v36, s[4:7], s72 offen sc1 lds
 s_mov_b32 m0, 18816
 s_add_u32 s72, s52, 2176
 buffer_load_dwordx4 v36, s[4:7], s72 offen sc1 lds
 s_mov_b32 m0, 19840
 s_add_u32 s72, s52, 4096
 buffer_load_dwordx4 v36, s[4:7], s72 offen sc1 lds
 s_mov_b32 m0, 20864
 s_add_u32 s72, s52, 4224
 buffer_load_dwordx4 v36, s[4:7], s72 offen sc1 lds
 s_mov_b32 m0, 21888
 s_add_u32 s72, s52, 6144
 buffer_load_dwordx4 v36, s[4:7], s72 offen sc1 lds
 s_mov_b32 m0, 22912
 s_add_u32 s72, s52, 6272
 buffer_load_dwordx4 v36, s[4:7], s72 offen sc1 lds
 s_barrier
 s_nop 15
 s_nop 11
 buffer_load_dwordx4 v[10:13], v0, s[4:7], s24 offen offset:2048 sc1
 buffer_load_dwordx4 v[14:17], v0, s[4:7], s24 offen offset:3072 sc1
 ds_read_b128 v[26:29], v3 offset:0
 ds_read_b128 v[30:33], v3 offset:1024
 ds_read_b128 v[62:65], v3 offset:8192
 ds_read_b128 v[66:69], v3 offset:9216
 ds_read_b128 v[34:37], v3 offset:16384
 ds_read_b128 v[38:41], v3 offset:17408
 s_nop 15
 s_nop 3
 buffer_load_dwordx4 v[18:21], v0, s[4:7], s24 offen offset:2048 sc1
 buffer_load_dwordx4 v[22:25], v0, s[4:7], s24 offen offset:3072 sc1
 s_nop 15
 s_nop 11
 buffer_load_dwordx4 v[54:57], v0, s[4:7], s24 offen offset:2048 sc1
 buffer_load_dwordx4 v[58:61], v0, s[4:7], s24 offen offset:3072 sc1
 s_waitcnt vmcnt(5)
 v_bitop3_b32 v71, v10, v11, v12 bitop3:0xfe
 v_bitop3_b32 v71, v71, v13, v13 bitop3:0xfe
 s_waitcnt vmcnt(4)
 v_bitop3_b32 v71, v71, v14, v15 bitop3:0xfe
 v_bitop3_b32 v71, v71, v16, v17 bitop3:0xfe
 v_and_b32 v71, 1, v71
 v_cmp_ne_u32 vcc, 0, v71
 s_cbranch_vccnz L_ma_108
 ds_write_b128 v0, v[10:13] offset:2048
 ds_write_b128 v0, v[14:17] offset:3072
 s_barrier
 s_mov_b32 m0, 8192
 s_nop 0
 buffer_load_dwordx4 v0, s[4:7], s26 offen offset:0 sc1 lds
L_maok_106:
 s_cmp_eq_u32 s50, 63
 s_cbranch_scc1 L_last_102
 s_waitcnt lgkmcnt(0)
 s_barrier
 s_mov_b32 s51, 0
 ds_read_b128 v[10:13], v4 offset:0
 ds_read_b128 v[14:17], v4 offset:512
 s_waitcnt vmcnt(3)
 ds_read_b128 v[18:21], v4 offset:1024
 s_add_u32 s72, s52, 16777216
 buffer_load_dwordx4 v[54:57], v70, s[4:7], s72 offen sc1
 buffer_load_dwordx4 v[58:61], v70, s[4:7], s72 offen offset:256 sc1
 s_waitcnt lgkmcnt(2)
 v_smfmac_f32_16x16x64_bf16 v[50:53], v[10:13], a[8:15], v1
 v_lshlrev_b32 v71, 2, v0
 v_smfmac_f32_16x16x64_bf16 v[42:45], v[10:13], v[72:79], v1
 ds_read_b128 v[22:25], v4 offset:1536
 v_smfmac_f32_16x16x64_bf16 v[46:49], v[10:13], v[80:87], v1
 s_mov_b32 m0, 8192
 s_cmp_eq_u32 s50, 0
 s_cbranch_scc1 L_mb2skip_111
 buffer_load_dwordx4 v0, s[4:7], s26 offen offset:0 sc1 lds
L_mb2skip_111:
 s_waitcnt lgkmcnt(2)
 v_smfmac_f32_16x16x64_bf16 v[50:53], v[14:17], a[16:23], v1
 v_smfmac_f32_16x16x64_bf16 v[42:45], v[14:17], v[88:95], v1
 ds_read_b128 v[10:13], v4 offset:2048
 v_smfmac_f32_16x16x64_bf16 v[46:49], v[14:17], v[26:33], v1
 ds_read_b128 v[26:29], v3 offset:24576
 s_add_u32 s73, s52, 524288
 s_min_u32 s73, s73, 16515072
 s_add_u32 s73, s73, s68
 s_waitcnt lgkmcnt(3)
 v_smfmac_f32_16x16x64_bf16 v[50:53], v[18:21], a[24:31], v1
 ds_read_b128 v[30:33], v3 offset:25600
 v_smfmac_f32_16x16x64_bf16 v[42:45], v[18:21], v[96:103], v1
 ds_read_b128 v[14:17], v4 offset:2560
 s_mov_b32 m0, 23936
 s_nop 0
 buffer_load_dword v71, s[4:7], s73 offen sc1 lds
 v_smfmac_f32_16x16x64_bf16 v[46:49], v[18:21], v[62:69], v1
 s_waitcnt vmcnt(4)
 ds_read_b128 v[62:65], v0 offset:8192
 s_waitcnt lgkmcnt(5)
 v_smfmac_f32_16x16x64_bf16 v[50:53], v[22:25], a[32:39], v1
 v_smfmac_f32_16x16x64_bf16 v[42:45], v[22:25], v[104:111], v1
 ds_read_b128 v[18:21], v4 offset:3072
 v_smfmac_f32_16x16x64_bf16 v[46:49], v[22:25], v[34:41], v1
 ds_read_b128 v[34:37], v3 offset:32768
 s_waitcnt lgkmcnt(6)
 v_smfmac_f32_16x16x64_bf16 v[50:53], v[10:13], a[40:47], v1
 ds_read_b128 v[38:41], v3 offset:33792
 v_smfmac_f32_16x16x64_bf16 v[42:45], v[10:13], v[112:119], v1
 s_waitcnt lgkmcnt(3)
 ds_read_b128 v[22:25], v4 offset:3584
 v_bitop3_b32 v62, v62, v63, v64 bitop3:0xfe
 v_bitop3_b32 v62, v62, v65, v65 bitop3:0xfe
 v_smfmac_f32_16x16x64_bf16 v[46:49], v[10:13], v[26:33], v1
 ds_read_b128 v[26:29], v3 offset:40960
 v_bitop3_b32 v62, v62, v62, s28 bitop3:0xa0
 v_smfmac_f32_16x16x64_bf16 v[50:53], v[14:17], a[48:55], v1
 ds_read_b128 v[30:33], v3 offset:41984
 v_and_b32 v62, 1, v62
 v_cmp_ne_u32 vcc, 0, v62
 v_smfmac_f32_16x16x64_bf16 v[42:45], v[14:17], v[120:127], v1
 v_smfmac_f32_16x16x64_bf16 v[46:49], v[14:17], v[128:135], v1
 s_waitcnt lgkmcnt(5)
 v_smfmac_f32_16x16x64_bf16 v[50:53], v[18:21], a[56:63], v1
 s_cbranch_vccnz L_mbre_113
L_mbok_112:
 s_barrier
 v_smfmac_f32_16x16x64_bf16 v[42:45], v[18:21], v[136:143], v1
 ds_read_b128 v[10:13], v4 offset:4096
 ds_read_b128 v[14:17], v4 offset:4608
 s_waitcnt lgkmcnt(5)
 v_smfmac_f32_16x16x64_bf16 v[46:49], v[18:21], v[34:41], v1
 ds_read_b128 v[34:37], v3 offset:49152
 s_waitcnt lgkmcnt(5)
 v_smfmac_f32_16x16x64_bf16 v[50:53], v[22:25], a[64:71], v1
 ds_read_b128 v[38:41], v3 offset:50176
 v_mov_b32 v68, s64
 v_smfmac_f32_16x16x64_bf16 v[42:45], v[22:25], v[144:151], v1
 ds_read_b128 v[18:21], v4 offset:5120
 s_mov_b64 exec, 1
 buffer_store_dword v68, v0, s[4:7], s66 offen sc1
 s_mov_b64 exec, -1
 s_waitcnt lgkmcnt(5)
 v_smfmac_f32_16x16x64_bf16 v[46:49], v[22:25], v[26:33], v1
 ds_read_b128 v[26:29], v9 offset:0
 s_waitcnt lgkmcnt(5)
 v_smfmac_f32_16x16x64_bf16 v[50:53], v[10:13], a[72:79], v1
 ds_read_b128 v[30:33], v9 offset:1024
 v_smfmac_f32_16x16x64_bf16 v[42:45], v[10:13], v[152:159], v1
 ds_read_b128 v[22:25], v4 offset:5632
 v_smfmac_f32_16x16x64_bf16 v[46:49], v[10:13], v[160:167], v1
 s_waitcnt lgkmcnt(6)
 v_smfmac_f32_16x16x64_bf16 v[50:53], v[14:17], a[80:87], v1
 v_smfmac_f32_16x16x64_bf16 v[42:45], v[14:17], v[168:175], v1
 ds_read_b128 v[10:13], v4 offset:6144
 s_waitcnt lgkmcnt(5)
 v_smfmac_f32_16x16x64_bf16 v[46:49], v[14:17], v[34:41], v1
 ds_read_b128 v[34:37], v9 offset:8192
 s_waitcnt lgkmcnt(5)
 v_smfmac_f32_16x16x64_bf16 v[50:53], v[18:21], a[88:95], v1
 ds_read_b128 v[38:41], v9 offset:9216
 v_smfmac_f32_16x16x64_bf16 v[42:45], v[18:21], v[176:183], v1
 ds_read_b128 v[14:17], v4 offset:6656
 s_waitcnt lgkmcnt(5)
 v_smfmac_f32_16x16x64_bf16 v[46:49], v[18:21], v[26:33], v1
 ds_read_b128 v[26:29], v9 offset:16384
 s_waitcnt lgkmcnt(5)
 v_smfmac_f32_16x16x64_bf16 v[50:53], v[22:25], a[96:103], v1
 ds_read_b128 v[30:33], v9 offset:17408
 v_smfmac_f32_16x16x64_bf16 v[42:45], v[22:25], v[184:191], v1
 ds_read_b128 v[18:21], v4 offset:7168
 v_smfmac_f32_16x16x64_bf16 v[46:49], v[22:25], v[192:199], v1
 ds_read_b128 v[62:65], v9 offset:24576
 s_waitcnt lgkmcnt(7)
 v_smfmac_f32_16x16x64_bf16 v[42:45], v[10:13], v[200:207], v1
 ds_read_b128 v[66:69], v9 offset:25600
 ds_read_b128 v[22:25], v4 offset:7680
 s_waitcnt lgkmcnt(7)
 v_smfmac_f32_16x16x64_bf16 v[46:49], v[10:13], v[34:41], v1
 ds_read_b128 v[34:37], v9 offset:32768
 s_waitcnt lgkmcnt(7)
 v_smfmac_f32_16x16x64_bf16 v[42:45], v[14:17], v[208:215], v1
 ds_read_b128 v[38:41], v9 offset:33792
 ds_read_b128 v[10:13], v4 offset:8192
 s_waitcnt lgkmcnt(7)
 v_smfmac_f32_16x16x64_bf16 v[46:49], v[14:17], v[26:33], v1
 s_waitcnt lgkmcnt(6)
 v_smfmac_f32_16x16x64_bf16 v[42:45], v[18:21], v[216:223], v1
 ds_read_b128 v[14:17], v4 offset:8704
 s_waitcnt lgkmcnt(5)
 v_smfmac_f32_16x16x64_bf16 v[46:49], v[18:21], v[62:69], v1
 s_waitcnt lgkmcnt(4)
 v_smfmac_f32_16x16x64_bf16 v[42:45], v[22:25], v[224:231], v1
 ds_read_b128 v[18:21], v4 offset:6144
 s_waitcnt lgkmcnt(3)
 v_smfmac_f32_16x16x64_bf16 v[46:49], v[22:25], v[34:41], v1
 s_waitcnt lgkmcnt(2)
 v_smfmac_f32_16x16x64_bf16 v[42:45], v[10:13], v[232:239], v1
 ds_read_b128 v[22:25], v4 offset:6656
 v_smfmac_f32_16x16x64_bf16 v[46:49], v[10:13], v[240:247], v1
 ds_read_b128 v[26:29], v0 offset:15744
 ds_read_b128 v[30:33], v0 offset:17792
 s_waitcnt lgkmcnt(4)
 v_smfmac_f32_16x16x64_bf16 v[42:45], v[14:17], v[248:255], v1
 ds_read_b128 v[10:13], v4 offset:7168
 v_smfmac_f32_16x16x64_bf16 v[46:49], v[14:17], a[0:7], v1
 ds_read_b128 v[34:37], v0 offset:19840
 ds_read_b128 v[38:41], v0 offset:21888
 ds_read_b128 v[14:17], v4 offset:7680
 s_waitcnt lgkmcnt(7)
 v_smfmac_f32_16x16x64_bf16 v[50:53], v[18:21], a[104:111], v1
 s_nop 1
 s_waitcnt lgkmcnt(6)
 v_smfmac_f32_16x16x64_bf16 v[50:53], v[22:25], a[112:119], v1
 s_nop 2
 v_cvt_pk_bf16_f32 v62, v42, v43
 v_cvt_pk_bf16_f32 v63, v44, v45
 ds_write_b64 v5, v[62:63]
 v_cvt_pk_bf16_f32 v64, v46, v47
 v_cvt_pk_bf16_f32 v65, v48, v49
 ds_write_b64 v5, v[64:65] offset:2176
 ds_read_b128 v[42:45], v4 offset:8192
 ds_read_b128 v[46:49], v4 offset:8704
 s_waitcnt lgkmcnt(7)
 v_smfmac_f32_16x16x64_bf16 v[50:53], v[10:13], a[120:127], v1
 s_waitcnt lgkmcnt(4)
 v_smfmac_f32_16x16x64_bf16 v[50:53], v[14:17], a[128:135], v1
 s_waitcnt lgkmcnt(2)
 s_barrier
 ds_read_b64_tr_b16 v[10:11], v6 offset:0
 ds_read_b64_tr_b16 v[12:13], v6 offset:64
 ds_read_b64_tr_b16 v[14:15], v6 offset:256
 ds_read_b64_tr_b16 v[16:17], v6 offset:320
 s_waitcnt lgkmcnt(5)
 v_smfmac_f32_16x16x64_bf16 v[50:53], v[42:45], a[136:143], v1
 ds_read_b64_tr_b16 v[18:19], v6 offset:512
 ds_read_b64_tr_b16 v[20:21], v6 offset:576
 ds_read_b64_tr_b16 v[22:23], v6 offset:768
 ds_read_b64_tr_b16 v[24:25], v6 offset:832
 s_waitcnt lgkmcnt(8)
 v_smfmac_f32_16x16x64_bf16 v[50:53], v[46:49], a[144:151], v1
 s_waitcnt lgkmcnt(6)
 v_mfma_f32_16x16x32_bf16 v[42:45], v[26:29], v[10:13], 0
 ds_read_b128 v[26:29], v0 offset:16768
 v_mov_b32 v62, v2
 v_mov_b32 v63, v2
 s_waitcnt lgkmcnt(5)
 v_mfma_f32_16x16x32_bf16 v[42:45], v[30:33], v[14:17], v[42:45]
 ds_read_b128 v[30:33], v0 offset:18816
 v_mov_b32 v64, v2
 v_mov_b32 v65, v2
 s_waitcnt lgkmcnt(4)
 v_mfma_f32_16x16x32_bf16 v[42:45], v[34:37], v[18:21], v[42:45]
 ds_read_b128 v[34:37], v0 offset:20864
 s_waitcnt lgkmcnt(3)
 v_mfma_f32_16x16x32_bf16 v[42:45], v[38:41], v[22:25], v[42:45]
 ds_read_b128 v[38:41], v0 offset:22912
 v_mfma_f32_16x16x32_bf16 v[62:65], v[10:13], v[10:13], v[62:65]
 v_cvt_pk_bf16_f32 v68, v50, v51
 v_cvt_pk_bf16_f32 v69, v52, v53
 v_mfma_f32_16x16x32_bf16 v[62:65], v[14:17], v[14:17], v[62:65]
 ds_write_b64 v5, v[68:69] offset:4352
 v_mov_b64 v[66:67], v[68:69]
 v_mfma_f32_16x16x32_bf16 v[62:65], v[18:21], v[18:21], v[62:65]
 s_nop 0
 v_mul_f32 v42, s62, v42
 v_mul_f32 v43, s62, v43
 v_mfma_f32_16x16x32_bf16 v[62:65], v[22:25], v[22:25], v[62:65]
 v_permlane32_swap_b32 v66, v68
 v_permlane32_swap_b32 v67, v69
 s_waitcnt lgkmcnt(4)
 v_mfma_f32_16x16x32_bf16 v[46:49], v[26:29], v[10:13], 0
 v_mul_f32 v44, s62, v44
 v_mul_f32 v45, s62, v45
 s_waitcnt lgkmcnt(3)
 v_mfma_f32_16x16x32_bf16 v[46:49], v[30:33], v[14:17], v[46:49]
 v_max3_f32 v70, v42, v43, v44
 s_nop 0
 s_waitcnt lgkmcnt(2)
 v_mfma_f32_16x16x32_bf16 v[46:49], v[34:37], v[18:21], v[46:49]
 v_mul_f32 v62, s62, v62
 v_mul_f32 v63, s62, v63
 s_waitcnt lgkmcnt(1)
 v_mfma_f32_16x16x32_bf16 v[46:49], v[38:41], v[22:25], v[46:49]
 v_mul_f32 v64, s62, v64
 v_mul_f32 v65, s62, v65
 v_max3_f32 v70, v70, v45, v62
 v_max3_f32 v71, v63, v64, v65
 v_mov_b64 v[30:31], 0
 v_mov_b64 v[34:35], 0
 v_mov_b64 v[22:23], s[76:77]
 v_mov_b64 v[24:25], s[76:77]
 v_pk_mul_f32 v[46:47], v[46:47], s[62:63]
 v_pk_mul_f32 v[48:49], v[48:49], s[62:63]
 v_max3_f32 v70, v70, v71, v46
 v_max3_f32 v71, v47, v48, v49
 v_max_f32 v21, v70, v71
 v_max_f32 v70, v70, v71
 s_nop 1
 v_permlane16_swap_b32 v70, v21
 v_max_f32 v71, v70, v21
 v_max_f32 v70, v70, v21
 s_nop 1
 v_permlane32_swap_b32 v70, v71
 v_max_f32 v70, v70, v71
 v_pk_add_f32 v[42:43], v[42:43], v[70:71] op_sel_hi:[1,0] neg_lo:[0,1] neg_hi:[0,1]
 v_pk_add_f32 v[44:45], v[44:45], v[70:71] op_sel_hi:[1,0] neg_lo:[0,1] neg_hi:[0,1]
 v_pk_add_f32 v[46:47], v[46:47], v[70:71] op_sel_hi:[1,0] neg_lo:[0,1] neg_hi:[0,1]
 v_pk_add_f32 v[48:49], v[48:49], v[70:71] op_sel_hi:[1,0] neg_lo:[0,1] neg_hi:[0,1]
 v_pk_add_f32 v[62:63], v[62:63], v[70:71] op_sel_hi:[1,0] neg_lo:[0,1] neg_hi:[0,1]
 v_pk_add_f32 v[64:65], v[64:65], v[70:71] op_sel_hi:[1,0] neg_lo:[0,1] neg_hi:[0,1]
 v_exp_f32 v42, v42
 v_exp_f32 v43, v43
 v_exp_f32 v44, v44
 v_exp_f32 v45, v45
 v_exp_f32 v46, v46
 v_exp_f32 v47, v47
 v_exp_f32 v48, v48
 v_exp_f32 v49, v49
 v_exp_f32 v62, v62
 v_cvt_pk_bf16_f32 v26, v42, v43
 v_cvt_pk_bf16_f32 v27, v44, v45
 v_cvt_pk_bf16_f32 v28, v46, v47
 v_cvt_pk_bf16_f32 v29, v48, v49
 v_exp_f32 v63, v63
 s_waitcnt vmcnt(2)
 v_mfma_f32_16x16x32_bf16 v[10:13], v[22:25], v[26:29], 0
 v_exp_f32 v64, v64
 v_mfma_f32_16x16x32_bf16 v[14:17], v[54:57], v[26:29], 0
 v_exp_f32 v65, v65
 v_mfma_f32_16x16x32_bf16 v[36:39], v[58:61], v[26:29], 0
 v_cvt_pk_bf16_f32 v32, v62, v63
 v_cvt_pk_bf16_f32 v33, v64, v65
 s_nop 1
 v_mfma_f32_16x16x32_bf16 v[10:13], v[22:25], v[32:35], v[10:13]
 v_mfma_f32_16x16x32_bf16 v[14:17], v[66:69], v[32:35], v[14:17]
 v_mfma_f32_16x16x32_bf16 v[36:39], v[66:69], v[30:33], v[36:39]
 v_add_u32 v9, 98304, v3
 v_mov_b64 v[52:53], 0
 v_mov_b64 v[54:55], 0
 v_mov_b64 v[56:57], 0
 v_mov_b64 v[58:59], 0
 s_nop 0
 v_rcp_f32 v18, v10
 v_mov_b64 v[60:61], 0
 v_pk_mul_f32 v[14:15], v[14:15], v[18:19] op_sel_hi:[1,0]
 v_pk_mul_f32 v[16:17], v[16:17], v[18:19] op_sel_hi:[1,0]
 v_pk_mul_f32 v[36:37], v[36:37], v[18:19] op_sel_hi:[1,0]
 v_pk_mul_f32 v[38:39], v[38:39], v[18:19] op_sel_hi:[1,0]
 v_cvt_pk_bf16_f32 v22, v14, v15
 v_cvt_pk_bf16_f32 v23, v16, v17
 v_cvt_pk_bf16_f32 v24, v36, v37
 v_cvt_pk_bf16_f32 v25, v38, v39
 ds_write_b128 v7, v[22:25]
 s_add_u32 s50, s50, 1
 v_mov_b64 v[62:63], 0
 v_mov_b64 v[64:65], 0
 v_mov_b64 v[66:67], 0
 v_mov_b64 v[68:69], 0
 v_mov_b64 v[70:71], 0
 s_waitcnt lgkmcnt(0)
 s_barrier
 ds_read_b128 v[10:13], v4 offset:0
 ds_read_b128 v[14:17], v4 offset:512
 ds_read_b128 v[18:21], v4 offset:1024
 ds_read_b128 v[22:25], v4 offset:1536
 s_waitcnt lgkmcnt(3)
 v_smfmac_f32_16x16x64_bf16 v[52:55], v[10:13], a[152:159], v1
 s_waitcnt lgkmcnt(2)
 v_smfmac_f32_16x16x64_bf16 v[52:55], v[14:17], a[160:167], v1
 ds_read_b128 v[26:29], v9 offset:0
 ds_read_b128 v[30:33], v9 offset:1024
 s_waitcnt lgkmcnt(3)
 v_smfmac_f32_16x16x64_bf16 v[52:55], v[18:21], a[168:175], v1
 s_waitcnt lgkmcnt(2)
 v_smfmac_f32_16x16x64_bf16 v[52:55], v[22:25], a[176:183], v1
 ds_read_b128 v[34:37], v9 offset:8192
 ds_read_b128 v[38:41], v9 offset:9216
 v_smfmac_f32_16x16x64_bf16 v[56:59], v[10:13], a[184:191], v1
 s_nop 2
 v_smfmac_f32_16x16x64_bf16 v[56:59], v[14:17], a[192:199], v1
 ds_read_b128 v[42:45], v9 offset:16384
 ds_read_b128 v[46:49], v9 offset:17408
 s_nop 0
 v_smfmac_f32_16x16x64_bf16 v[56:59], v[18:21], a[200:207], v1
 v_cvt_pk_bf16_f32 v52, v52, v53
 v_smfmac_f32_16x16x64_bf16 v[56:59], v[22:25], a[208:215], v1
 v_cvt_pk_bf16_f32 v53, v54, v55
 v_smfmac_f32_16x16x64_bf16 v[60:63], v[10:13], a[216:223], v1
 s_nop 1
 v_or_b32 v52, 1, v52
 v_smfmac_f32_16x16x64_bf16 v[60:63], v[14:17], a[224:231], v1
 s_nop 2
 s_waitcnt lgkmcnt(4)
 v_smfmac_f32_16x16x64_bf16 v[60:63], v[18:21], v[26:33], v1
 ds_read_b128 v[26:29], v9 offset:20480
 ds_read_b128 v[30:33], v9 offset:21504
 buffer_store_dwordx2 v[52:53], v8, s[4:7], s55 offen
 v_cvt_pk_bf16_f32 v56, v56, v57
 v_smfmac_f32_16x16x64_bf16 v[60:63], v[22:25], a[232:239], v1
 v_cvt_pk_bf16_f32 v57, v58, v59
 s_waitcnt lgkmcnt(4)
 v_smfmac_f32_16x16x64_bf16 v[64:67], v[10:13], v[34:41], v1
 ds_read_b128 v[34:37], v9 offset:24576
 ds_read_b128 v[38:41], v9 offset:25600
 v_or_b32 v56, 1, v56
 v_smfmac_f32_16x16x64_bf16 v[64:67], v[14:17], a[240:247], v1
 s_nop 2
 s_waitcnt lgkmcnt(4)
 v_smfmac_f32_16x16x64_bf16 v[64:67], v[18:21], v[42:49], v1
 ds_read_b128 v[42:45], v9 offset:28672
 ds_read_b128 v[46:49], v9 offset:29696
 buffer_store_dwordx2 v[56:57], v8, s[4:7], s56 offen
 v_cvt_pk_bf16_f32 v60, v60, v61
 v_smfmac_f32_16x16x64_bf16 v[64:67], v[22:25], a[248:255], v1
 ds_read_b128 v[52:55], v9 offset:32768
 ds_read_b128 v[56:59], v9 offset:33792
 v_cvt_pk_bf16_f32 v61, v62, v63
 s_waitcnt lgkmcnt(6)
 v_smfmac_f32_16x16x64_bf16 v[68:71], v[10:13], v[26:33], v1
 s_nop 1
 v_or_b32 v60, 1, v60
 s_waitcnt lgkmcnt(4)
 v_smfmac_f32_16x16x64_bf16 v[68:71], v[14:17], v[34:41], v1
 s_nop 2
 s_waitcnt lgkmcnt(2)
 v_smfmac_f32_16x16x64_bf16 v[68:71], v[18:21], v[42:49], v1
 buffer_store_dwordx2 v[60:61], v8, s[4:7], s57 offen
 v_cvt_pk_bf16_f32 v64, v64, v65
 s_waitcnt lgkmcnt(0)
 v_smfmac_f32_16x16x64_bf16 v[68:71], v[22:25], v[52:59], v1
 v_cvt_pk_bf16_f32 v65, v66, v67
 v_or_b32 v64, 1, v64
 buffer_store_dwordx2 v[64:65], v8, s[4:7], s58 offen
 s_add_u32 s52, s52, 262144
 s_add_u32 s65, s65, s27
 s_mov_b64 s[28:29], -1
 s_sub_i32 s64, s50, s71
 s_mov_b32 s27, 131072
 v_cvt_pk_bf16_f32 v68, v68, v69
 v_cvt_pk_bf16_f32 v69, v70, v71
 v_or_b32 v68, 1, v68
 buffer_store_dwordx2 v[68:69], v8, s[4:7], s59 offen
 s_barrier
 v_mov_b64 v[42:43], 0
 v_mov_b64 v[44:45], 0
 v_mov_b64 v[46:47], 0
 v_mov_b64 v[48:49], 0
 v_mov_b64 v[50:51], 0
 v_mov_b64 v[52:53], 0
 v_and_b32 v70, 0xf0, v0
 v_bfe_u32 v71, v0, 8, 2
 v_lshl_add_u32 v71, v71, 9, s67
 v_add_u32 v70, v70, v71
 v_add_u32 v9, 57344, v3
 v_bfe_u32 v37, v0, 8, 2
 v_and_b32 v36, 0x70, v0
 v_lshl_add_u32 v36, v37, 9, v36
 v_and_b32 v37, 0x80, v0
 v_lshl_add_u32 v36, v37, 1, v36
 s_sub_u32 s3, s50, 2
 s_bitcmp1_b64 s[30:31], s3
 s_cbranch_scc1 L_kvgate_114
L_kvback_115:
 s_nop 15
 s_nop 15
 s_nop 7
 s_mov_b32 m0, 15744
 s_add_u32 s72, s52, 0
 buffer_load_dwordx4 v36, s[4:7], s72 offen sc1 lds
 s_mov_b32 m0, 16768
 s_add_u32 s72, s52, 128
 buffer_load_dwordx4 v36, s[4:7], s72 offen sc1 lds
 s_mov_b32 m0, 17792
 s_add_u32 s72, s52, 2048
 buffer_load_dwordx4 v36, s[4:7], s72 offen sc1 lds
 s_mov_b32 m0, 18816
 s_add_u32 s72, s52, 2176
 buffer_load_dwordx4 v36, s[4:7], s72 offen sc1 lds
 s_mov_b32 m0, 19840
 s_add_u32 s72, s52, 4096
 buffer_load_dwordx4 v36, s[4:7], s72 offen sc1 lds
 s_mov_b32 m0, 20864
 s_add_u32 s72, s52, 4224
 buffer_load_dwordx4 v36, s[4:7], s72 offen sc1 lds
 s_mov_b32 m0, 21888
 s_add_u32 s72, s52, 6144
 buffer_load_dwordx4 v36, s[4:7], s72 offen sc1 lds
 s_mov_b32 m0, 22912
 s_add_u32 s72, s52, 6272
 buffer_load_dwordx4 v36, s[4:7], s72 offen sc1 lds
 s_barrier
 s_nop 15
 s_nop 11
 buffer_load_dwordx4 v[10:13], v0, s[4:7], s24 offen offset:2048 sc1
 buffer_load_dwordx4 v[14:17], v0, s[4:7], s24 offen offset:3072 sc1
 ds_read_b128 v[26:29], v3 offset:0
 ds_read_b128 v[30:33], v3 offset:1024
 ds_read_b128 v[62:65], v3 offset:8192
 ds_read_b128 v[66:69], v3 offset:9216
 ds_read_b128 v[34:37], v3 offset:16384
 ds_read_b128 v[38:41], v3 offset:17408
 s_nop 15
 s_nop 3
 buffer_load_dwordx4 v[18:21], v0, s[4:7], s24 offen offset:2048 sc1
 buffer_load_dwordx4 v[22:25], v0, s[4:7], s24 offen offset:3072 sc1
 s_nop 15
 s_nop 11
 buffer_load_dwordx4 v[54:57], v0, s[4:7], s24 offen offset:2048 sc1
 buffer_load_dwordx4 v[58:61], v0, s[4:7], s24 offen offset:3072 sc1
 s_waitcnt vmcnt(5)
 v_bitop3_b32 v71, v10, v11, v12 bitop3:0x80
 v_bitop3_b32 v71, v71, v13, v13 bitop3:0x80
 s_waitcnt vmcnt(4)
 v_bitop3_b32 v71, v71, v14, v15 bitop3:0x80
 v_bitop3_b32 v71, v71, v16, v17 bitop3:0x80
 v_and_b32 v71, 1, v71
 v_cmp_ne_u32 vcc, 1, v71
 s_cbranch_vccnz L_ma_118
 ds_write_b128 v0, v[10:13] offset:2048
 ds_write_b128 v0, v[14:17] offset:3072
 s_barrier
 s_mov_b32 m0, 8192
 s_nop 0
 buffer_load_dwordx4 v0, s[4:7], s26 offen offset:0 sc1 lds
L_maok_116:
 s_branch L_loop_101
L_last_102:
 s_waitcnt lgkmcnt(0)
 s_barrier
 ds_read_b128 v[10:13], v4 offset:0
 ds_read_b128 v[14:17], v4 offset:512
 s_waitcnt vmcnt(3)
 ds_read_b128 v[18:21], v4 offset:1024
 s_waitcnt lgkmcnt(2)
 v_smfmac_f32_16x16x64_bf16 v[50:53], v[10:13], a[8:15], v1
 v_smfmac_f32_16x16x64_bf16 v[42:45], v[10:13], v[72:79], v1
 ds_read_b128 v[22:25], v4 offset:1536
 v_smfmac_f32_16x16x64_bf16 v[46:49], v[10:13], v[80:87], v1
 s_mov_b32 m0, 8192
 s_cmp_eq_u32 s50, 0
 s_cbranch_scc1 L_mb2skip_121
 buffer_load_dwordx4 v0, s[4:7], s26 offen offset:0 sc1 lds
L_mb2skip_121:
 s_waitcnt lgkmcnt(2)
 v_smfmac_f32_16x16x64_bf16 v[50:53], v[14:17], a[16:23], v1
 v_smfmac_f32_16x16x64_bf16 v[42:45], v[14:17], v[88:95], v1
 ds_read_b128 v[10:13], v4 offset:2048
 v_smfmac_f32_16x16x64_bf16 v[46:49], v[14:17], v[26:33], v1
 ds_read_b128 v[26:29], v3 offset:24576
 s_waitcnt lgkmcnt(3)
 v_smfmac_f32_16x16x64_bf16 v[50:53], v[18:21], a[24:31], v1
 ds_read_b128 v[30:33], v3 offset:25600
 v_smfmac_f32_16x16x64_bf16 v[42:45], v[18:21], v[96:103], v1
 ds_read_b128 v[14:17], v4 offset:2560
 v_smfmac_f32_16x16x64_bf16 v[46:49], v[18:21], v[62:69], v1
 s_waitcnt vmcnt(1)
 ds_read_b128 v[62:65], v0 offset:8192
 s_waitcnt lgkmcnt(5)
 v_smfmac_f32_16x16x64_bf16 v[50:53], v[22:25], a[32:39], v1
 v_smfmac_f32_16x16x64_bf16 v[42:45], v[22:25], v[104:111], v1
 ds_read_b128 v[18:21], v4 offset:3072
 v_smfmac_f32_16x16x64_bf16 v[46:49], v[22:25], v[34:41], v1
 ds_read_b128 v[34:37], v3 offset:32768
 s_waitcnt lgkmcnt(6)
 v_smfmac_f32_16x16x64_bf16 v[50:53], v[10:13], a[40:47], v1
 ds_read_b128 v[38:41], v3 offset:33792
 v_smfmac_f32_16x16x64_bf16 v[42:45], v[10:13], v[112:119], v1
 s_waitcnt lgkmcnt(3)
 ds_read_b128 v[22:25], v4 offset:3584
 v_bitop3_b32 v62, v62, v63, v64 bitop3:0xfe
 v_bitop3_b32 v62, v62, v65, v65 bitop3:0xfe
 v_smfmac_f32_16x16x64_bf16 v[46:49], v[10:13], v[26:33], v1
 ds_read_b128 v[26:29], v3 offset:40960
 v_bitop3_b32 v62, v62, v62, s28 bitop3:0xa0
 v_smfmac_f32_16x16x64_bf16 v[50:53], v[14:17], a[48:55], v1
 ds_read_b128 v[30:33], v3 offset:41984
 v_and_b32 v62, 1, v62
 v_cmp_ne_u32 vcc, 0, v62
 v_smfmac_f32_16x16x64_bf16 v[42:45], v[14:17], v[120:127], v1
 v_smfmac_f32_16x16x64_bf16 v[46:49], v[14:17], v[128:135], v1
 s_waitcnt lgkmcnt(5)
 v_smfmac_f32_16x16x64_bf16 v[50:53], v[18:21], a[56:63], v1
 s_cbranch_vccnz L_mbre_123
L_mbok_122:
 s_barrier
 v_smfmac_f32_16x16x64_bf16 v[42:45], v[18:21], v[136:143], v1
 ds_read_b128 v[10:13], v4 offset:4096
 ds_read_b128 v[14:17], v4 offset:4608
 s_waitcnt lgkmcnt(5)
 v_smfmac_f32_16x16x64_bf16 v[46:49], v[18:21], v[34:41], v1
 ds_read_b128 v[34:37], v3 offset:49152
 s_waitcnt lgkmcnt(5)
 v_smfmac_f32_16x16x64_bf16 v[50:53], v[22:25], a[64:71], v1
 ds_read_b128 v[38:41], v3 offset:50176
 v_mov_b32 v68, s64
 v_smfmac_f32_16x16x64_bf16 v[42:45], v[22:25], v[144:151], v1
 ds_read_b128 v[18:21], v4 offset:5120
 s_mov_b64 exec, 1
 buffer_store_dword v68, v0, s[4:7], s66 offen sc1
 s_mov_b64 exec, -1
 s_waitcnt lgkmcnt(5)
 v_smfmac_f32_16x16x64_bf16 v[46:49], v[22:25], v[26:33], v1
 ds_read_b128 v[26:29], v9 offset:0
 s_waitcnt lgkmcnt(5)
 v_smfmac_f32_16x16x64_bf16 v[50:53], v[10:13], a[72:79], v1
 ds_read_b128 v[30:33], v9 offset:1024
 v_smfmac_f32_16x16x64_bf16 v[42:45], v[10:13], v[152:159], v1
 ds_read_b128 v[22:25], v4 offset:5632
 v_smfmac_f32_16x16x64_bf16 v[46:49], v[10:13], v[160:167], v1
 s_waitcnt lgkmcnt(6)
 v_smfmac_f32_16x16x64_bf16 v[50:53], v[14:17], a[80:87], v1
 v_smfmac_f32_16x16x64_bf16 v[42:45], v[14:17], v[168:175], v1
 ds_read_b128 v[10:13], v4 offset:6144
 s_waitcnt lgkmcnt(5)
 v_smfmac_f32_16x16x64_bf16 v[46:49], v[14:17], v[34:41], v1
 ds_read_b128 v[34:37], v9 offset:8192
 s_waitcnt lgkmcnt(5)
 v_smfmac_f32_16x16x64_bf16 v[50:53], v[18:21], a[88:95], v1
 ds_read_b128 v[38:41], v9 offset:9216
 v_smfmac_f32_16x16x64_bf16 v[42:45], v[18:21], v[176:183], v1
 ds_read_b128 v[14:17], v4 offset:6656
 s_waitcnt lgkmcnt(5)
 v_smfmac_f32_16x16x64_bf16 v[46:49], v[18:21], v[26:33], v1
 ds_read_b128 v[26:29], v9 offset:16384
 s_waitcnt lgkmcnt(5)
 v_smfmac_f32_16x16x64_bf16 v[50:53], v[22:25], a[96:103], v1
 ds_read_b128 v[30:33], v9 offset:17408
 v_smfmac_f32_16x16x64_bf16 v[42:45], v[22:25], v[184:191], v1
 ds_read_b128 v[18:21], v4 offset:7168
 v_smfmac_f32_16x16x64_bf16 v[46:49], v[22:25], v[192:199], v1
 ds_read_b128 v[62:65], v9 offset:24576
 s_waitcnt lgkmcnt(7)
 v_smfmac_f32_16x16x64_bf16 v[42:45], v[10:13], v[200:207], v1
 ds_read_b128 v[66:69], v9 offset:25600
 ds_read_b128 v[22:25], v4 offset:7680
 s_waitcnt lgkmcnt(7)
 v_smfmac_f32_16x16x64_bf16 v[46:49], v[10:13], v[34:41], v1
 ds_read_b128 v[34:37], v9 offset:32768
 s_waitcnt lgkmcnt(7)
 v_smfmac_f32_16x16x64_bf16 v[42:45], v[14:17], v[208:215], v1
 ds_read_b128 v[38:41], v9 offset:33792
 ds_read_b128 v[10:13], v4 offset:8192
 s_waitcnt lgkmcnt(7)
 v_smfmac_f32_16x16x64_bf16 v[46:49], v[14:17], v[26:33], v1
 s_waitcnt lgkmcnt(6)
 v_smfmac_f32_16x16x64_bf16 v[42:45], v[18:21], v[216:223], v1
 ds_read_b128 v[14:17], v4 offset:8704
 s_waitcnt lgkmcnt(5)
 v_smfmac_f32_16x16x64_bf16 v[46:49], v[18:21], v[62:69], v1
 s_waitcnt lgkmcnt(4)
 v_smfmac_f32_16x16x64_bf16 v[42:45], v[22:25], v[224:231], v1
 ds_read_b128 v[18:21], v4 offset:6144
 s_waitcnt lgkmcnt(3)
 v_smfmac_f32_16x16x64_bf16 v[46:49], v[22:25], v[34:41], v1
 s_waitcnt lgkmcnt(2)
 v_smfmac_f32_16x16x64_bf16 v[42:45], v[10:13], v[232:239], v1
 ds_read_b128 v[22:25], v4 offset:6656
 v_smfmac_f32_16x16x64_bf16 v[46:49], v[10:13], v[240:247], v1
 s_waitcnt lgkmcnt(2)
 v_smfmac_f32_16x16x64_bf16 v[42:45], v[14:17], v[248:255], v1
 ds_read_b128 v[10:13], v4 offset:7168
 v_smfmac_f32_16x16x64_bf16 v[46:49], v[14:17], a[0:7], v1
 ds_read_b128 v[14:17], v4 offset:7680
 s_waitcnt lgkmcnt(3)
 v_smfmac_f32_16x16x64_bf16 v[50:53], v[18:21], a[104:111], v1
 s_nop 1
 s_waitcnt lgkmcnt(2)
 v_smfmac_f32_16x16x64_bf16 v[50:53], v[22:25], a[112:119], v1
 s_nop 2
 v_cvt_pk_bf16_f32 v62, v42, v43
 v_cvt_pk_bf16_f32 v63, v44, v45
 ds_write_b64 v5, v[62:63]
 v_cvt_pk_bf16_f32 v64, v46, v47
 v_cvt_pk_bf16_f32 v65, v48, v49
 ds_write_b64 v5, v[64:65] offset:2176
 ds_read_b128 v[42:45], v4 offset:8192
 ds_read_b128 v[46:49], v4 offset:8704
 s_waitcnt lgkmcnt(5)
 v_smfmac_f32_16x16x64_bf16 v[50:53], v[10:13], a[120:127], v1
 s_waitcnt lgkmcnt(4)
 v_smfmac_f32_16x16x64_bf16 v[50:53], v[14:17], a[128:135], v1
 s_waitcnt lgkmcnt(2)
 s_barrier
 s_waitcnt lgkmcnt(1)
 v_smfmac_f32_16x16x64_bf16 v[50:53], v[42:45], a[136:143], v1
 s_waitcnt lgkmcnt(0)
 v_smfmac_f32_16x16x64_bf16 v[50:53], v[46:49], a[144:151], v1
 s_nop 7
 v_cvt_pk_bf16_f32 v40, v50, v51
 v_cvt_pk_bf16_f32 v41, v52, v53
 ds_write_b64 v5, v[40:41] offset:4352
 s_add_u32 s65, s65, 131072
 s_waitcnt vmcnt(0) lgkmcnt(0)
 s_barrier
 v_mov_b32 v68, 63
 s_mov_b64 exec, 1
 buffer_store_dword v68, v0, s[4:7], s66 offen sc1
 s_mov_b64 exec, -1
 s_waitcnt lgkmcnt(0)
 s_branch L_done0
L_mbre_105:
 s_mov_b32 m0, 8192
 s_nop 0
 buffer_load_dwordx4 v0, s[4:7], s26 offen offset:0 sc1 lds
 s_add_u32 s51, s51, 65536
 s_waitcnt vmcnt(2)
 ds_read_b128 v[62:65], v0 offset:8192
 s_waitcnt lgkmcnt(0)
 v_bitop3_b32 v62, v62, v63, v64 bitop3:0x80
 v_bitop3_b32 v62, v62, v65, v65 bitop3:0x80
 v_bitop3_b32 v62, v62, v62, s28 bitop3:0xf5
 v_and_b32 v62, 1, v62
 v_cmp_ne_u32 vcc, 1, v62
 s_cbranch_vccz L_mbok_104
 s_mov_b32 m0, 8192
 s_nop 0
 buffer_load_dwordx4 v0, s[4:7], s26 offen offset:0 sc1 lds
 s_nop 15
 s_nop 3
L_mbspin_124:
 s_mov_b32 m0, 8192
 s_nop 0
 buffer_load_dwordx4 v0, s[4:7], s26 offen offset:0 sc1 lds
 s_add_u32 s51, s51, 65536
 s_cmp_gt_u32 s51, 1310720000
 s_cbranch_scc1 L_exit0
 s_waitcnt vmcnt(2)
 ds_read_b128 v[62:65], v0 offset:8192
 s_waitcnt lgkmcnt(0)
 v_bitop3_b32 v62, v62, v63, v64 bitop3:0x80
 v_bitop3_b32 v62, v62, v65, v65 bitop3:0x80
 v_bitop3_b32 v62, v62, v62, s28 bitop3:0xf5
 v_and_b32 v62, 1, v62
 v_cmp_ne_u32 vcc, 1, v62
 s_cbranch_vccnz L_mbspin_124
 s_branch L_mbok_104
L_ma_108:
 s_add_u32 s51, s51, 1
 s_waitcnt vmcnt(3)
 v_bitop3_b32 v71, v18, v19, v20 bitop3:0xfe
 v_bitop3_b32 v71, v71, v21, v21 bitop3:0xfe
 s_waitcnt vmcnt(2)
 v_bitop3_b32 v71, v71, v22, v23 bitop3:0xfe
 v_bitop3_b32 v71, v71, v24, v25 bitop3:0xfe
 v_and_b32 v71, 1, v71
 v_cmp_ne_u32 vcc, 0, v71
 s_cbranch_vccz L_mahit_127
 buffer_load_dwordx4 v[10:13], v0, s[4:7], s24 offen offset:2048 sc1
 buffer_load_dwordx4 v[14:17], v0, s[4:7], s24 offen offset:3072 sc1
L_marot_125:
 s_add_u32 s51, s51, 1
 s_waitcnt vmcnt(3)
 v_bitop3_b32 v71, v54, v55, v56 bitop3:0xfe
 v_bitop3_b32 v71, v71, v57, v57 bitop3:0xfe
 s_waitcnt vmcnt(2)
 v_bitop3_b32 v71, v71, v58, v59 bitop3:0xfe
 v_bitop3_b32 v71, v71, v60, v61 bitop3:0xfe
 v_and_b32 v71, 1, v71
 v_cmp_ne_u32 vcc, 0, v71
 s_cbranch_vccz L_mahit_128
 buffer_load_dwordx4 v[18:21], v0, s[4:7], s24 offen offset:2048 sc1
 buffer_load_dwordx4 v[22:25], v0, s[4:7], s24 offen offset:3072 sc1
 s_add_u32 s51, s51, 1
 s_waitcnt vmcnt(3)
 v_bitop3_b32 v71, v10, v11, v12 bitop3:0xfe
 v_bitop3_b32 v71, v71, v13, v13 bitop3:0xfe
 s_waitcnt vmcnt(2)
 v_bitop3_b32 v71, v71, v14, v15 bitop3:0xfe
 v_bitop3_b32 v71, v71, v16, v17 bitop3:0xfe
 v_and_b32 v71, 1, v71
 v_cmp_ne_u32 vcc, 0, v71
 s_cbranch_vccz L_mahit_126
 buffer_load_dwordx4 v[54:57], v0, s[4:7], s24 offen offset:2048 sc1
 buffer_load_dwordx4 v[58:61], v0, s[4:7], s24 offen offset:3072 sc1
 s_add_u32 s51, s51, 1
 s_waitcnt vmcnt(3)
 v_bitop3_b32 v71, v18, v19, v20 bitop3:0xfe
 v_bitop3_b32 v71, v71, v21, v21 bitop3:0xfe
 s_waitcnt vmcnt(2)
 v_bitop3_b32 v71, v71, v22, v23 bitop3:0xfe
 v_bitop3_b32 v71, v71, v24, v25 bitop3:0xfe
 v_and_b32 v71, 1, v71
 v_cmp_ne_u32 vcc, 0, v71
 s_cbranch_vccz L_mahit_127
 buffer_load_dwordx4 v[10:13], v0, s[4:7], s24 offen offset:2048 sc1
 buffer_load_dwordx4 v[14:17], v0, s[4:7], s24 offen offset:3072 sc1
 s_add_u32 s51, s51, 1
 s_and_b32 s3, s51, 0xffff
 s_cmp_gt_u32 s3, 20000
 s_cbranch_scc0 L_marot_125
 s_branch L_exit0
L_mahit_126:
 ds_write_b128 v0, v[10:13] offset:2048
 ds_write_b128 v0, v[14:17] offset:3072
 s_barrier
 s_mov_b32 m0, 8192
 s_nop 0
 buffer_load_dwordx4 v0, s[4:7], s26 offen offset:0 sc1 lds
 s_waitcnt vmcnt(1)
 s_branch L_maok_106
L_mahit_127:
 ds_write_b128 v0, v[18:21] offset:2048
 ds_write_b128 v0, v[22:25] offset:3072
 s_barrier
 s_mov_b32 m0, 8192
 s_nop 0
 buffer_load_dwordx4 v0, s[4:7], s26 offen offset:0 sc1 lds
 s_branch L_maok_106
L_mahit_128:
 ds_write_b128 v0, v[54:57] offset:2048
 ds_write_b128 v0, v[58:61] offset:3072
 s_barrier
 s_mov_b32 m0, 8192
 s_nop 0
 buffer_load_dwordx4 v0, s[4:7], s26 offen offset:0 sc1 lds
 s_waitcnt vmcnt(1)
 s_branch L_maok_106
L_mbre_113:
 s_mov_b32 m0, 8192
 s_nop 0
 buffer_load_dwordx4 v0, s[4:7], s26 offen offset:0 sc1 lds
 s_add_u32 s51, s51, 65536
 s_waitcnt vmcnt(2)
 ds_read_b128 v[62:65], v0 offset:8192
 s_waitcnt lgkmcnt(0)
 v_bitop3_b32 v62, v62, v63, v64 bitop3:0xfe
 v_bitop3_b32 v62, v62, v65, v65 bitop3:0xfe
 v_bitop3_b32 v62, v62, v62, s28 bitop3:0xa0
 v_and_b32 v62, 1, v62
 v_cmp_ne_u32 vcc, 0, v62
 s_cbranch_vccz L_mbok_112
 s_mov_b32 m0, 8192
 s_nop 0
 buffer_load_dwordx4 v0, s[4:7], s26 offen offset:0 sc1 lds
 s_nop 15
 s_nop 3
L_mbspin_129:
 s_mov_b32 m0, 8192
 s_nop 0
 buffer_load_dwordx4 v0, s[4:7], s26 offen offset:0 sc1 lds
 s_add_u32 s51, s51, 65536
 s_cmp_gt_u32 s51, 1310720000
 s_cbranch_scc1 L_exit0
 s_waitcnt vmcnt(2)
 ds_read_b128 v[62:65], v0 offset:8192
 s_waitcnt lgkmcnt(0)
 v_bitop3_b32 v62, v62, v63, v64 bitop3:0xfe
 v_bitop3_b32 v62, v62, v65, v65 bitop3:0xfe
 v_bitop3_b32 v62, v62, v62, s28 bitop3:0xa0
 v_and_b32 v62, 1, v62
 v_cmp_ne_u32 vcc, 0, v62
 s_cbranch_vccnz L_mbspin_129
 s_branch L_mbok_112
L_kvgate_114:
 s_mov_b32 s73, 64
 s_cmp_eq_u32 s50, 6
 s_cselect_b32 s73, 8, s73
 s_cmp_eq_u32 s50, 10
 s_cselect_b32 s73, 16, s73
 s_cmp_eq_u32 s50, 18
 s_cselect_b32 s73, 28, s73
 v_lshrrev_b32 v10, 2, v0
 v_min_u32 v10, s73, v10
 ds_read_b32 v11, v10 offset:24448
 s_waitcnt lgkmcnt(0)
 v_cmp_gt_u32 vcc, 0x180, v11
 s_cbranch_vccz L_kvback_115
 v_lshlrev_b32 v10, 5, v10
 s_mov_b32 s72, 65015808
 s_mov_b32 s3, 0
L_kvw_130:
 buffer_load_dword v11, v10, s[4:7], s72 offen sc1
 s_add_u32 s3, s3, 1
 s_cmp_gt_u32 s3, 200000
 s_cbranch_scc1 L_exit0
 s_waitcnt vmcnt(0)
 v_cmp_gt_u32 vcc, 0x180, v11
 s_cbranch_vccnz L_kvw_130
 s_branch L_kvback_115
L_ma_118:
 s_add_u32 s51, s51, 1
 s_waitcnt vmcnt(3)
 v_bitop3_b32 v71, v18, v19, v20 bitop3:0x80
 v_bitop3_b32 v71, v71, v21, v21 bitop3:0x80
 s_waitcnt vmcnt(2)
 v_bitop3_b32 v71, v71, v22, v23 bitop3:0x80
 v_bitop3_b32 v71, v71, v24, v25 bitop3:0x80
 v_and_b32 v71, 1, v71
 v_cmp_ne_u32 vcc, 1, v71
 s_cbranch_vccz L_mahit_133
 buffer_load_dwordx4 v[10:13], v0, s[4:7], s24 offen offset:2048 sc1
 buffer_load_dwordx4 v[14:17], v0, s[4:7], s24 offen offset:3072 sc1
L_marot_131:
 s_add_u32 s51, s51, 1
 s_waitcnt vmcnt(3)
 v_bitop3_b32 v71, v54, v55, v56 bitop3:0x80
 v_bitop3_b32 v71, v71, v57, v57 bitop3:0x80
 s_waitcnt vmcnt(2)
 v_bitop3_b32 v71, v71, v58, v59 bitop3:0x80
 v_bitop3_b32 v71, v71, v60, v61 bitop3:0x80
 v_and_b32 v71, 1, v71
 v_cmp_ne_u32 vcc, 1, v71
 s_cbranch_vccz L_mahit_134
 buffer_load_dwordx4 v[18:21], v0, s[4:7], s24 offen offset:2048 sc1
 buffer_load_dwordx4 v[22:25], v0, s[4:7], s24 offen offset:3072 sc1
 s_add_u32 s51, s51, 1
 s_waitcnt vmcnt(3)
 v_bitop3_b32 v71, v10, v11, v12 bitop3:0x80
 v_bitop3_b32 v71, v71, v13, v13 bitop3:0x80
 s_waitcnt vmcnt(2)
 v_bitop3_b32 v71, v71, v14, v15 bitop3:0x80
 v_bitop3_b32 v71, v71, v16, v17 bitop3:0x80
 v_and_b32 v71, 1, v71
 v_cmp_ne_u32 vcc, 1, v71
 s_cbranch_vccz L_mahit_132
 buffer_load_dwordx4 v[54:57], v0, s[4:7], s24 offen offset:2048 sc1
 buffer_load_dwordx4 v[58:61], v0, s[4:7], s24 offen offset:3072 sc1
 s_add_u32 s51, s51, 1
 s_waitcnt vmcnt(3)
 v_bitop3_b32 v71, v18, v19, v20 bitop3:0x80
 v_bitop3_b32 v71, v71, v21, v21 bitop3:0x80
 s_waitcnt vmcnt(2)
 v_bitop3_b32 v71, v71, v22, v23 bitop3:0x80
 v_bitop3_b32 v71, v71, v24, v25 bitop3:0x80
 v_and_b32 v71, 1, v71
 v_cmp_ne_u32 vcc, 1, v71
 s_cbranch_vccz L_mahit_133
 buffer_load_dwordx4 v[10:13], v0, s[4:7], s24 offen offset:2048 sc1
 buffer_load_dwordx4 v[14:17], v0, s[4:7], s24 offen offset:3072 sc1
 s_add_u32 s51, s51, 1
 s_and_b32 s3, s51, 0xffff
 s_cmp_gt_u32 s3, 20000
 s_cbranch_scc0 L_marot_131
 s_branch L_exit0
L_mahit_132:
 ds_write_b128 v0, v[10:13] offset:2048
 ds_write_b128 v0, v[14:17] offset:3072
 s_barrier
 s_mov_b32 m0, 8192
 s_nop 0
 buffer_load_dwordx4 v0, s[4:7], s26 offen offset:0 sc1 lds
 s_waitcnt vmcnt(1)
 s_branch L_maok_116
L_mahit_133:
 ds_write_b128 v0, v[18:21] offset:2048
 ds_write_b128 v0, v[22:25] offset:3072
 s_barrier
 s_mov_b32 m0, 8192
 s_nop 0
 buffer_load_dwordx4 v0, s[4:7], s26 offen offset:0 sc1 lds
 s_branch L_maok_116
L_mahit_134:
 ds_write_b128 v0, v[54:57] offset:2048
 ds_write_b128 v0, v[58:61] offset:3072
 s_barrier
 s_mov_b32 m0, 8192
 s_nop 0
 buffer_load_dwordx4 v0, s[4:7], s26 offen offset:0 sc1 lds
 s_waitcnt vmcnt(1)
 s_branch L_maok_116
L_mbre_123:
 s_mov_b32 m0, 8192
 s_nop 0
 buffer_load_dwordx4 v0, s[4:7], s26 offen offset:0 sc1 lds
 s_add_u32 s51, s51, 65536
 s_waitcnt vmcnt(1)
 ds_read_b128 v[62:65], v0 offset:8192
 s_waitcnt lgkmcnt(0)
 v_bitop3_b32 v62, v62, v63, v64 bitop3:0xfe
 v_bitop3_b32 v62, v62, v65, v65 bitop3:0xfe
 v_bitop3_b32 v62, v62, v62, s28 bitop3:0xa0
 v_and_b32 v62, 1, v62
 v_cmp_ne_u32 vcc, 0, v62
 s_cbranch_vccz L_mbok_122
 s_mov_b32 m0, 8192
 s_nop 0
 buffer_load_dwordx4 v0, s[4:7], s26 offen offset:0 sc1 lds
 s_nop 15
 s_nop 3
L_mbspin_135:
 s_mov_b32 m0, 8192
 s_nop 0
 buffer_load_dwordx4 v0, s[4:7], s26 offen offset:0 sc1 lds
 s_add_u32 s51, s51, 65536
 s_cmp_gt_u32 s51, 1310720000
 s_cbranch_scc1 L_exit0
 s_waitcnt vmcnt(2)
 ds_read_b128 v[62:65], v0 offset:8192
 s_waitcnt lgkmcnt(0)
 v_bitop3_b32 v62, v62, v63, v64 bitop3:0xfe
 v_bitop3_b32 v62, v62, v65, v65 bitop3:0xfe
 v_bitop3_b32 v62, v62, v62, s28 bitop3:0xa0
 v_and_b32 v62, 1, v62
 v_cmp_ne_u32 vcc, 0, v62
 s_cbranch_vccnz L_mbspin_135
 s_branch L_mbok_122
L_exit0:
 s_endpgm
L_done0:
 s_branch L_done1
L_chain_far:
 s_mov_b32 s50, 0
 s_mov_b32 s51, 0
 s_mov_b32 s64, -1
 s_mov_b32 s30, 268501264
 s_mov_b32 s31, 0
 s_mov_b64 s[28:29], 0
 s_cmp_eq_u32 s46, 1
 s_cbranch_scc1 L_wave1_137
 s_cmp_eq_u32 s46, 2
 s_cbranch_scc1 L_wave2_138
 s_cmp_eq_u32 s46, 3
 s_cbranch_scc1 L_wave3_139
L_wave0_136:
 v_mov_b64 v[42:43], 0
 v_mov_b64 v[44:45], 0
 v_mov_b64 v[46:47], 0
 v_mov_b64 v[48:49], 0
 v_mov_b64 v[50:51], 0
 v_mov_b64 v[52:53], 0
 v_and_b32 v70, 0xf0, v0
 v_bfe_u32 v71, v0, 8, 2
 v_lshl_add_u32 v71, v71, 9, s67
 v_add_u32 v70, v70, v71
 v_add_u32 v9, 57344, v3
 ds_read_b128 v[26:29], v3 offset:0
 ds_read_b128 v[30:33], v3 offset:1024
 ds_read_b128 v[62:65], v3 offset:8192
 ds_read_b128 v[66:69], v3 offset:9216
 ds_read_b128 v[34:37], v3 offset:16384
 ds_read_b128 v[38:41], v3 offset:17408
 .p2align 6
L_loop_140:
 s_waitcnt lgkmcnt(0)
 s_barrier
 s_mov_b32 s51, 0
 ds_read_b128 v[10:13], v4 offset:0
 ds_read_b128 v[14:17], v4 offset:512
 s_waitcnt vmcnt(2)
 ds_read_b128 v[18:21], v4 offset:1024
 s_add_u32 s72, s52, 16777216
 buffer_load_dwordx4 v[54:57], v70, s[4:7], s72 offen sc1
 buffer_load_dwordx4 v[58:61], v70, s[4:7], s72 offen offset:256 sc1
 s_waitcnt lgkmcnt(2)
 v_smfmac_f32_16x16x64_bf16 v[50:53], v[10:13], a[8:15], v1
 v_lshlrev_b32 v71, 2, v0
 v_smfmac_f32_16x16x64_bf16 v[42:45], v[10:13], v[72:79], v1
 ds_read_b128 v[22:25], v4 offset:1536
 v_bfe_u32 v70, v0, 5, 1
 v_smfmac_f32_16x16x64_bf16 v[46:49], v[10:13], v[80:87], v1
 v_mul_i32_i24 v70, -1920, v70
 s_waitcnt lgkmcnt(2)
 v_smfmac_f32_16x16x64_bf16 v[50:53], v[14:17], a[16:23], v1
 v_add_u32 v70, v70, v6
 v_smfmac_f32_16x16x64_bf16 v[42:45], v[14:17], v[88:95], v1
 ds_read_b128 v[10:13], v4 offset:2048
 v_smfmac_f32_16x16x64_bf16 v[46:49], v[14:17], v[26:33], v1
 ds_read_b128 v[26:29], v3 offset:24576
 s_add_u32 s73, s52, 524288
 s_min_u32 s73, s73, 16515072
 s_add_u32 s73, s73, s68
 s_waitcnt lgkmcnt(3)
 v_smfmac_f32_16x16x64_bf16 v[50:53], v[18:21], a[24:31], v1
 ds_read_b128 v[30:33], v3 offset:25600
 v_smfmac_f32_16x16x64_bf16 v[42:45], v[18:21], v[96:103], v1
 ds_read_b128 v[14:17], v4 offset:2560
 s_mov_b32 m0, 23936
 s_nop 0
 buffer_load_dword v71, s[4:7], s73 offen sc1 lds
 v_smfmac_f32_16x16x64_bf16 v[46:49], v[18:21], v[62:69], v1
 s_waitcnt vmcnt(3)
 s_waitcnt lgkmcnt(4)
 v_smfmac_f32_16x16x64_bf16 v[50:53], v[22:25], a[32:39], v1
 ds_read_b64_tr_b16 v[62:63], v70 offset:2176
 ds_read_b64_tr_b16 v[64:65], v70 offset:2240
 v_smfmac_f32_16x16x64_bf16 v[42:45], v[22:25], v[104:111], v1
 ds_read_b128 v[18:21], v4 offset:3072
 v_smfmac_f32_16x16x64_bf16 v[46:49], v[22:25], v[34:41], v1
 ds_read_b128 v[34:37], v3 offset:32768
 s_waitcnt lgkmcnt(7)
 v_smfmac_f32_16x16x64_bf16 v[50:53], v[10:13], a[40:47], v1
 ds_read_b128 v[38:41], v3 offset:33792
 ds_read_b64_tr_b16 v[66:67], v70 offset:2688
 ds_read_b64_tr_b16 v[68:69], v70 offset:2752
 v_smfmac_f32_16x16x64_bf16 v[42:45], v[10:13], v[112:119], v1
 ds_read_b128 v[22:25], v4 offset:3584
 s_waitcnt lgkmcnt(9)
 v_smfmac_f32_16x16x64_bf16 v[46:49], v[10:13], v[26:33], v1
 ds_read_b128 v[26:29], v3 offset:40960
 s_waitcnt lgkmcnt(9)
 v_smfmac_f32_16x16x64_bf16 v[50:53], v[14:17], a[48:55], v1
 ds_read_b128 v[30:33], v3 offset:41984
 v_smfmac_f32_16x16x64_bf16 v[42:45], v[14:17], v[120:127], v1
 v_smfmac_f32_16x16x64_bf16 v[46:49], v[14:17], v[128:135], v1
 s_waitcnt lgkmcnt(7)
 v_smfmac_f32_16x16x64_bf16 v[50:53], v[18:21], a[56:63], v1
 s_waitcnt lgkmcnt(3)
 s_barrier
 v_smfmac_f32_16x16x64_bf16 v[42:45], v[18:21], v[136:143], v1
 ds_read_b128 v[10:13], v4 offset:4096
 ds_read_b128 v[14:17], v4 offset:4608
 v_smfmac_f32_16x16x64_bf16 v[46:49], v[18:21], v[34:41], v1
 ds_read_b128 v[34:37], v3 offset:49152
 s_waitcnt lgkmcnt(5)
 v_smfmac_f32_16x16x64_bf16 v[50:53], v[22:25], a[64:71], v1
 ds_read_b128 v[38:41], v3 offset:50176
 v_smfmac_f32_16x16x64_bf16 v[42:45], v[22:25], v[144:151], v1
 ds_read_b128 v[18:21], v4 offset:5120
 buffer_store_dwordx4 v[62:65], v0, s[4:7], s65 offen offset:0 sc1
 s_waitcnt lgkmcnt(5)
 v_smfmac_f32_16x16x64_bf16 v[46:49], v[22:25], v[26:33], v1
 ds_read_b128 v[26:29], v9 offset:0
 s_waitcnt lgkmcnt(5)
 v_smfmac_f32_16x16x64_bf16 v[50:53], v[10:13], a[72:79], v1
 ds_read_b128 v[30:33], v9 offset:1024
 v_smfmac_f32_16x16x64_bf16 v[42:45], v[10:13], v[152:159], v1
 ds_read_b128 v[22:25], v4 offset:5632
 v_smfmac_f32_16x16x64_bf16 v[46:49], v[10:13], v[160:167], v1
 s_waitcnt lgkmcnt(6)
 v_smfmac_f32_16x16x64_bf16 v[50:53], v[14:17], a[80:87], v1
 v_smfmac_f32_16x16x64_bf16 v[42:45], v[14:17], v[168:175], v1
 ds_read_b128 v[10:13], v4 offset:6144
 buffer_store_dwordx4 v[66:69], v0, s[4:7], s65 offen offset:1024 sc1
 s_waitcnt lgkmcnt(5)
 v_smfmac_f32_16x16x64_bf16 v[46:49], v[14:17], v[34:41], v1
 ds_read_b128 v[34:37], v9 offset:8192
 s_waitcnt lgkmcnt(5)
 v_smfmac_f32_16x16x64_bf16 v[50:53], v[18:21], a[88:95], v1
 ds_read_b128 v[38:41], v9 offset:9216
 v_smfmac_f32_16x16x64_bf16 v[42:45], v[18:21], v[176:183], v1
 ds_read_b128 v[14:17], v4 offset:6656
 s_waitcnt lgkmcnt(5)
 v_smfmac_f32_16x16x64_bf16 v[46:49], v[18:21], v[26:33], v1
 ds_read_b128 v[26:29], v9 offset:16384
 s_waitcnt lgkmcnt(5)
 v_smfmac_f32_16x16x64_bf16 v[50:53], v[22:25], a[96:103], v1
 ds_read_b128 v[30:33], v9 offset:17408
 v_smfmac_f32_16x16x64_bf16 v[42:45], v[22:25], v[184:191], v1
 ds_read_b128 v[18:21], v4 offset:7168
 v_smfmac_f32_16x16x64_bf16 v[46:49], v[22:25], v[192:199], v1
 ds_read_b128 v[62:65], v9 offset:24576
 s_waitcnt lgkmcnt(7)
 v_smfmac_f32_16x16x64_bf16 v[42:45], v[10:13], v[200:207], v1
 ds_read_b128 v[66:69], v9 offset:25600
 ds_read_b128 v[22:25], v4 offset:7680
 s_bitcmp1_b64 s[30:31], s50
 s_cbranch_scc1 L_kvs_142
L_kvsb_143:
 s_waitcnt lgkmcnt(7)
 v_smfmac_f32_16x16x64_bf16 v[46:49], v[10:13], v[34:41], v1
 ds_read_b128 v[34:37], v9 offset:32768
 s_waitcnt lgkmcnt(7)
 v_smfmac_f32_16x16x64_bf16 v[42:45], v[14:17], v[208:215], v1
 ds_read_b128 v[38:41], v9 offset:33792
 ds_read_b128 v[10:13], v4 offset:8192
 s_waitcnt lgkmcnt(7)
 v_smfmac_f32_16x16x64_bf16 v[46:49], v[14:17], v[26:33], v1
 s_waitcnt lgkmcnt(6)
 v_smfmac_f32_16x16x64_bf16 v[42:45], v[18:21], v[216:223], v1
 ds_read_b128 v[14:17], v4 offset:8704
 s_waitcnt lgkmcnt(5)
 v_smfmac_f32_16x16x64_bf16 v[46:49], v[18:21], v[62:69], v1
 s_waitcnt lgkmcnt(4)
 v_smfmac_f32_16x16x64_bf16 v[42:45], v[22:25], v[224:231], v1
 ds_read_b128 v[18:21], v4 offset:6144
 s_waitcnt lgkmcnt(3)
 v_smfmac_f32_16x16x64_bf16 v[46:49], v[22:25], v[34:41], v1
 s_waitcnt lgkmcnt(2)
 v_smfmac_f32_16x16x64_bf16 v[42:45], v[10:13], v[232:239], v1
 ds_read_b128 v[22:25], v4 offset:6656
 v_smfmac_f32_16x16x64_bf16 v[46:49], v[10:13], v[240:247], v1
 ds_read_b128 v[26:29], v0 offset:15744
 ds_read_b128 v[30:33], v0 offset:17792
 s_waitcnt lgkmcnt(4)
 v_smfmac_f32_16x16x64_bf16 v[42:45], v[14:17], v[248:255], v1
 ds_read_b128 v[10:13], v4 offset:7168
 v_smfmac_f32_16x16x64_bf16 v[46:49], v[14:17], a[0:7], v1
 ds_read_b128 v[34:37], v0 offset:19840
 ds_read_b128 v[38:41], v0 offset:21888
 ds_read_b128 v[14:17], v4 offset:7680
 s_waitcnt lgkmcnt(7)
 v_smfmac_f32_16x16x64_bf16 v[50:53], v[18:21], a[104:111], v1
 s_nop 1
 s_waitcnt lgkmcnt(6)
 v_smfmac_f32_16x16x64_bf16 v[50:53], v[22:25], a[112:119], v1
 s_nop 2
 v_cvt_pk_bf16_f32 v62, v42, v43
 v_cvt_pk_bf16_f32 v63, v44, v45
 ds_write_b64 v5, v[62:63]
 v_cvt_pk_bf16_f32 v64, v46, v47
 v_cvt_pk_bf16_f32 v65, v48, v49
 ds_write_b64 v5, v[64:65] offset:2176
 ds_read_b128 v[42:45], v4 offset:8192
 ds_read_b128 v[46:49], v4 offset:8704
 s_waitcnt lgkmcnt(7)
 v_smfmac_f32_16x16x64_bf16 v[50:53], v[10:13], a[120:127], v1
 s_waitcnt lgkmcnt(4)
 v_smfmac_f32_16x16x64_bf16 v[50:53], v[14:17], a[128:135], v1
 s_waitcnt lgkmcnt(2)
 s_barrier
 ds_read_b64_tr_b16 v[10:11], v6 offset:0
 ds_read_b64_tr_b16 v[12:13], v6 offset:64
 ds_read_b64_tr_b16 v[14:15], v6 offset:256
 ds_read_b64_tr_b16 v[16:17], v6 offset:320
 s_waitcnt lgkmcnt(5)
 v_smfmac_f32_16x16x64_bf16 v[50:53], v[42:45], a[136:143], v1
 ds_read_b64_tr_b16 v[18:19], v6 offset:512
 ds_read_b64_tr_b16 v[20:21], v6 offset:576
 ds_read_b64_tr_b16 v[22:23], v6 offset:768
 ds_read_b64_tr_b16 v[24:25], v6 offset:832
 s_waitcnt lgkmcnt(8)
 v_smfmac_f32_16x16x64_bf16 v[50:53], v[46:49], a[144:151], v1
 s_waitcnt lgkmcnt(6)
 v_mfma_f32_16x16x32_bf16 v[42:45], v[26:29], v[10:13], 0
 ds_read_b128 v[26:29], v0 offset:16768
 v_mov_b32 v62, v2
 v_mov_b32 v63, v2
 s_waitcnt lgkmcnt(5)
 v_mfma_f32_16x16x32_bf16 v[42:45], v[30:33], v[14:17], v[42:45]
 ds_read_b128 v[30:33], v0 offset:18816
 v_mov_b32 v64, v2
 v_mov_b32 v65, v2
 s_waitcnt lgkmcnt(4)
 v_mfma_f32_16x16x32_bf16 v[42:45], v[34:37], v[18:21], v[42:45]
 ds_read_b128 v[34:37], v0 offset:20864
 s_waitcnt lgkmcnt(3)
 v_mfma_f32_16x16x32_bf16 v[42:45], v[38:41], v[22:25], v[42:45]
 ds_read_b128 v[38:41], v0 offset:22912
 v_mfma_f32_16x16x32_bf16 v[62:65], v[10:13], v[10:13], v[62:65]
 v_cvt_pk_bf16_f32 v68, v50, v51
 v_cvt_pk_bf16_f32 v69, v52, v53
 v_mfma_f32_16x16x32_bf16 v[62:65], v[14:17], v[14:17], v[62:65]
 ds_write_b64 v5, v[68:69] offset:4352
 v_mov_b64 v[66:67], v[68:69]
 v_mfma_f32_16x16x32_bf16 v[62:65], v[18:21], v[18:21], v[62:65]
 s_nop 0
 v_mul_f32 v42, s62, v42
 v_mul_f32 v43, s62, v43
 v_mfma_f32_16x16x32_bf16 v[62:65], v[22:25], v[22:25], v[62:65]
 v_permlane32_swap_b32 v66, v68
 v_permlane32_swap_b32 v67, v69
 s_waitcnt lgkmcnt(4)
 v_mfma_f32_16x16x32_bf16 v[46:49], v[26:29], v[10:13], 0
 v_mul_f32 v44, s62, v44
 v_mul_f32 v45, s62, v45
 s_waitcnt lgkmcnt(3)
 v_mfma_f32_16x16x32_bf16 v[46:49], v[30:33], v[14:17], v[46:49]
 v_max3_f32 v70, v42, v43, v44
 s_nop 0
 s_waitcnt lgkmcnt(2)
 v_mfma_f32_16x16x32_bf16 v[46:49], v[34:37], v[18:21], v[46:49]
 v_mul_f32 v62, s62, v62
 v_mul_f32 v63, s62, v63
 s_waitcnt lgkmcnt(1)
 v_mfma_f32_16x16x32_bf16 v[46:49], v[38:41], v[22:25], v[46:49]
 v_mul_f32 v64, s62, v64
 v_mul_f32 v65, s62, v65
 v_max3_f32 v70, v70, v45, v62
 v_max3_f32 v71, v63, v64, v65
 v_mov_b64 v[30:31], 0
 v_mov_b64 v[34:35], 0
 v_mov_b64 v[22:23], s[76:77]
 v_mov_b64 v[24:25], s[76:77]
 v_pk_mul_f32 v[46:47], v[46:47], s[62:63]
 v_pk_mul_f32 v[48:49], v[48:49], s[62:63]
 v_max3_f32 v70, v70, v71, v46
 v_max3_f32 v71, v47, v48, v49
 v_max_f32 v21, v70, v71
 v_max_f32 v70, v70, v71
 s_nop 1
 v_permlane16_swap_b32 v70, v21
 v_max_f32 v71, v70, v21
 v_max_f32 v70, v70, v21
 s_nop 1
 v_permlane32_swap_b32 v70, v71
 v_max_f32 v70, v70, v71
 v_pk_add_f32 v[42:43], v[42:43], v[70:71] op_sel_hi:[1,0] neg_lo:[0,1] neg_hi:[0,1]
 v_pk_add_f32 v[44:45], v[44:45], v[70:71] op_sel_hi:[1,0] neg_lo:[0,1] neg_hi:[0,1]
 v_pk_add_f32 v[46:47], v[46:47], v[70:71] op_sel_hi:[1,0] neg_lo:[0,1] neg_hi:[0,1]
 v_pk_add_f32 v[48:49], v[48:49], v[70:71] op_sel_hi:[1,0] neg_lo:[0,1] neg_hi:[0,1]
 v_pk_add_f32 v[62:63], v[62:63], v[70:71] op_sel_hi:[1,0] neg_lo:[0,1] neg_hi:[0,1]
 v_pk_add_f32 v[64:65], v[64:65], v[70:71] op_sel_hi:[1,0] neg_lo:[0,1] neg_hi:[0,1]
 v_exp_f32 v42, v42
 v_exp_f32 v43, v43
 v_exp_f32 v44, v44
 v_exp_f32 v45, v45
 v_exp_f32 v46, v46
 v_exp_f32 v47, v47
 v_exp_f32 v48, v48
 v_exp_f32 v49, v49
 v_exp_f32 v62, v62
 v_cvt_pk_bf16_f32 v26, v42, v43
 v_cvt_pk_bf16_f32 v27, v44, v45
 v_cvt_pk_bf16_f32 v28, v46, v47
 v_cvt_pk_bf16_f32 v29, v48, v49
 v_exp_f32 v63, v63
 s_waitcnt vmcnt(3)
 v_mfma_f32_16x16x32_bf16 v[10:13], v[22:25], v[26:29], 0
 v_exp_f32 v64, v64
 v_mfma_f32_16x16x32_bf16 v[14:17], v[54:57], v[26:29], 0
 v_exp_f32 v65, v65
 v_mfma_f32_16x16x32_bf16 v[36:39], v[58:61], v[26:29], 0
 v_cvt_pk_bf16_f32 v32, v62, v63
 v_cvt_pk_bf16_f32 v33, v64, v65
 s_nop 1
 v_mfma_f32_16x16x32_bf16 v[10:13], v[22:25], v[32:35], v[10:13]
 v_mfma_f32_16x16x32_bf16 v[14:17], v[66:69], v[32:35], v[14:17]
 v_mfma_f32_16x16x32_bf16 v[36:39], v[66:69], v[30:33], v[36:39]
 v_add_u32 v9, 98304, v3
 v_mov_b64 v[52:53], 0
 v_mov_b64 v[54:55], 0
 v_mov_b64 v[56:57], 0
 v_mov_b64 v[58:59], 0
 s_nop 0
 v_rcp_f32 v18, v10
 v_mov_b64 v[60:61], 0
 v_pk_mul_f32 v[14:15], v[14:15], v[18:19] op_sel_hi:[1,0]
 v_pk_mul_f32 v[16:17], v[16:17], v[18:19] op_sel_hi:[1,0]
 v_pk_mul_f32 v[36:37], v[36:37], v[18:19] op_sel_hi:[1,0]
 v_pk_mul_f32 v[38:39], v[38:39], v[18:19] op_sel_hi:[1,0]
 v_cvt_pk_bf16_f32 v22, v14, v15
 v_cvt_pk_bf16_f32 v23, v16, v17
 v_cvt_pk_bf16_f32 v24, v36, v37
 v_cvt_pk_bf16_f32 v25, v38, v39
 ds_write_b128 v7, v[22:25]
 s_add_u32 s50, s50, 1
 v_mov_b64 v[62:63], 0
 v_mov_b64 v[64:65], 0
 v_mov_b64 v[66:67], 0
 s_waitcnt lgkmcnt(0)
 s_barrier
 ds_read_b128 v[10:13], v4 offset:0
 ds_read_b128 v[14:17], v4 offset:512
 ds_read_b128 v[18:21], v4 offset:1024
 ds_read_b128 v[22:25], v4 offset:1536
 s_waitcnt lgkmcnt(3)
 v_smfmac_f32_16x16x64_bf16 v[52:55], v[10:13], a[152:159], v1
 s_waitcnt lgkmcnt(2)
 v_smfmac_f32_16x16x64_bf16 v[52:55], v[14:17], a[160:167], v1
 ds_read_b128 v[26:29], v9 offset:0
 ds_read_b128 v[30:33], v9 offset:1024
 s_waitcnt lgkmcnt(3)
 v_smfmac_f32_16x16x64_bf16 v[52:55], v[18:21], a[168:175], v1
 s_waitcnt lgkmcnt(2)
 v_smfmac_f32_16x16x64_bf16 v[52:55], v[22:25], a[176:183], v1
 ds_read_b128 v[34:37], v9 offset:8192
 ds_read_b128 v[38:41], v9 offset:9216
 v_smfmac_f32_16x16x64_bf16 v[56:59], v[10:13], a[184:191], v1
 s_nop 2
 v_smfmac_f32_16x16x64_bf16 v[56:59], v[14:17], a[192:199], v1
 ds_read_b128 v[42:45], v9 offset:16384
 ds_read_b128 v[46:49], v9 offset:17408
 s_nop 0
 v_smfmac_f32_16x16x64_bf16 v[56:59], v[18:21], a[200:207], v1
 v_cvt_pk_bf16_f32 v52, v52, v53
 v_smfmac_f32_16x16x64_bf16 v[56:59], v[22:25], a[208:215], v1
 v_cvt_pk_bf16_f32 v53, v54, v55
 v_smfmac_f32_16x16x64_bf16 v[60:63], v[10:13], a[216:223], v1
 s_nop 1
 v_and_b32 v52, -2, v52
 v_smfmac_f32_16x16x64_bf16 v[60:63], v[14:17], a[224:231], v1
 s_nop 2
 s_waitcnt lgkmcnt(4)
 v_smfmac_f32_16x16x64_bf16 v[60:63], v[18:21], v[26:33], v1
 v_cvt_pk_bf16_f32 v56, v56, v57
 v_smfmac_f32_16x16x64_bf16 v[60:63], v[22:25], a[232:239], v1
 buffer_store_dwordx2 v[52:53], v8, s[4:7], s55 offen sc1
 v_cvt_pk_bf16_f32 v57, v58, v59
 s_waitcnt lgkmcnt(2)
 v_smfmac_f32_16x16x64_bf16 v[64:67], v[10:13], v[34:41], v1
 s_nop 1
 v_and_b32 v56, -2, v56
 v_smfmac_f32_16x16x64_bf16 v[64:67], v[14:17], a[240:247], v1
 s_nop 2
 s_waitcnt lgkmcnt(0)
 v_smfmac_f32_16x16x64_bf16 v[64:67], v[18:21], v[42:49], v1
 v_cvt_pk_bf16_f32 v60, v60, v61
 v_smfmac_f32_16x16x64_bf16 v[64:67], v[22:25], a[248:255], v1
 buffer_store_dwordx2 v[56:57], v8, s[4:7], s56 offen sc1
 v_cvt_pk_bf16_f32 v61, v62, v63
 v_and_b32 v60, -2, v60
 buffer_store_dwordx2 v[60:61], v8, s[4:7], s57 offen sc1
 s_add_u32 s52, s52, 262144
 s_add_u32 s65, s65, s27
 s_mov_b64 s[28:29], -1
 s_sub_i32 s64, s50, s71
 s_mov_b32 s27, 131072
 v_cvt_pk_bf16_f32 v64, v64, v65
 v_cvt_pk_bf16_f32 v65, v66, v67
 v_and_b32 v64, -2, v64
 buffer_store_dwordx2 v[64:65], v8, s[4:7], s58 offen sc1
 s_barrier
 s_nop 15
 s_nop 15
 s_nop 7
 buffer_load_dwordx4 v[10:13], v0, s[4:7], s60 offen offset:0 sc1
 buffer_load_dwordx4 v[14:17], v0, s[4:7], s60 offen offset:1024 sc1
 buffer_load_dwordx4 v[18:21], v0, s[4:7], s60 offen offset:2048 sc1
 buffer_load_dwordx4 v[22:25], v0, s[4:7], s60 offen offset:3072 sc1
 v_and_b32 v34, 16, v0
 v_mov_b32 v30, 0x3f80
 v_lshlrev_b32 v30, v34, v30
 v_bfe_u32 v34, v0, 5, 3
 v_cmp_eq_u32 vcc, 0, v34
 s_nop 1
 v_cndmask_b32 v26, 0, v30, vcc
 v_cmp_eq_u32 vcc, 1, v34
 s_nop 1
 v_cndmask_b32 v27, 0, v30, vcc
 v_cmp_eq_u32 vcc, 2, v34
 s_nop 1
 v_cndmask_b32 v28, 0, v30, vcc
 v_cmp_eq_u32 vcc, 3, v34
 s_nop 1
 v_cndmask_b32 v29, 0, v30, vcc
 v_and_b32 v35, 0xf0, v0
 v_bfe_u32 v34, v0, 8, 2
 v_lshl_add_u32 v35, v34, 2, v35
 v_and_b32 v34, 0x80, v0
 v_lshl_add_u32 v35, v34, 23, v35
 v_mov_b64 v[42:43], 0
 v_mov_b64 v[44:45], 0
 v_mov_b64 v[46:47], 0
 v_mov_b64 v[48:49], 0
 v_mov_b64 v[50:51], 0
 v_mov_b64 v[52:53], 0
 v_and_b32 v70, 0xf0, v0
 v_bfe_u32 v71, v0, 8, 2
 v_lshl_add_u32 v71, v71, 9, s67
 v_add_u32 v70, v70, v71
 v_add_u32 v9, 57344, v3
 s_waitcnt vmcnt(3)
 v_mfma_f32_16x16x32_bf16 v[30:33], v[10:13], v[26:29], 0
 v_bitop3_b32 v34, v10, v12, v12 bitop3:0xfe
 s_waitcnt vmcnt(2)
 v_mfma_f32_16x16x32_bf16 v[30:33], v[14:17], v[26:29], v[30:33]
 v_bitop3_b32 v34, v34, v14, v16 bitop3:0xfe
 s_waitcnt vmcnt(1)
 v_mfma_f32_16x16x32_bf16 v[30:33], v[18:21], v[26:29], v[30:33]
 v_bitop3_b32 v34, v34, v18, v20 bitop3:0xfe
 s_waitcnt vmcnt(0)
 v_mfma_f32_16x16x32_bf16 v[30:33], v[22:25], v[26:29], v[30:33]
 v_bitop3_b32 v34, v34, v22, v24 bitop3:0xfe
 v_and_b32 v34, 1, v34
 v_cmp_ne_u32 vcc, 0, v34
 s_cbranch_vccnz L_rre_144
 s_nop 3
 v_permlane32_swap_b32 v30, v31
 v_permlane32_swap_b32 v32, v33
 v_add_f32 v30, v30, v31
 v_add_f32 v32, v32, v33
 v_cvt_pk_bf16_f32 v30, v30, v32
 v_and_b32 v30, -2, v30
 buffer_store_dword v30, v35, s[4:7], s61 offen sc1
L_rback_145:
 s_barrier
 s_nop 15
 s_nop 11
 buffer_load_dwordx4 v[10:13], v0, s[4:7], s24 offen offset:0 sc1
 buffer_load_dwordx4 v[14:17], v0, s[4:7], s24 offen offset:1024 sc1
 ds_read_b128 v[26:29], v3 offset:0
 ds_read_b128 v[30:33], v3 offset:1024
 ds_read_b128 v[62:65], v3 offset:8192
 ds_read_b128 v[66:69], v3 offset:9216
 ds_read_b128 v[34:37], v3 offset:16384
 ds_read_b128 v[38:41], v3 offset:17408
 s_nop 15
 s_nop 3
 buffer_load_dwordx4 v[18:21], v0, s[4:7], s24 offen offset:0 sc1
 buffer_load_dwordx4 v[22:25], v0, s[4:7], s24 offen offset:1024 sc1
 s_nop 15
 s_nop 11
 buffer_load_dwordx4 v[54:57], v0, s[4:7], s24 offen offset:0 sc1
 buffer_load_dwordx4 v[58:61], v0, s[4:7], s24 offen offset:1024 sc1
 s_waitcnt vmcnt(5)
 v_bitop3_b32 v71, v10, v11, v12 bitop3:0xfe
 v_bitop3_b32 v71, v71, v13, v13 bitop3:0xfe
 s_waitcnt vmcnt(4)
 v_bitop3_b32 v71, v71, v14, v15 bitop3:0xfe
 v_bitop3_b32 v71, v71, v16, v17 bitop3:0xfe
 v_and_b32 v71, 1, v71
 v_cmp_ne_u32 vcc, 0, v71
 s_cbranch_vccnz L_ma_148
 ds_write_b128 v0, v[10:13] offset:0
 ds_write_b128 v0, v[14:17] offset:1024
 s_barrier
L_maok_146:
 s_cmp_eq_u32 s50, 63
 s_cbranch_scc1 L_last_141
 s_waitcnt lgkmcnt(0)
 s_barrier
 s_mov_b32 s51, 0
 ds_read_b128 v[10:13], v4 offset:0
 ds_read_b128 v[14:17], v4 offset:512
 s_waitcnt vmcnt(2)
 ds_read_b128 v[18:21], v4 offset:1024
 s_add_u32 s72, s52, 16777216
 buffer_load_dwordx4 v[54:57], v70, s[4:7], s72 offen sc1
 buffer_load_dwordx4 v[58:61], v70, s[4:7], s72 offen offset:256 sc1
 s_waitcnt lgkmcnt(2)
 v_smfmac_f32_16x16x64_bf16 v[50:53], v[10:13], a[8:15], v1
 v_lshlrev_b32 v71, 2, v0
 v_smfmac_f32_16x16x64_bf16 v[42:45], v[10:13], v[72:79], v1
 ds_read_b128 v[22:25], v4 offset:1536
 v_bfe_u32 v70, v0, 5, 1
 v_smfmac_f32_16x16x64_bf16 v[46:49], v[10:13], v[80:87], v1
 v_mul_i32_i24 v70, -1920, v70
 s_waitcnt lgkmcnt(2)
 v_smfmac_f32_16x16x64_bf16 v[50:53], v[14:17], a[16:23], v1
 v_add_u32 v70, v70, v6
 v_smfmac_f32_16x16x64_bf16 v[42:45], v[14:17], v[88:95], v1
 ds_read_b128 v[10:13], v4 offset:2048
 v_smfmac_f32_16x16x64_bf16 v[46:49], v[14:17], v[26:33], v1
 ds_read_b128 v[26:29], v3 offset:24576
 s_add_u32 s73, s52, 524288
 s_min_u32 s73, s73, 16515072
 s_add_u32 s73, s73, s68
 s_waitcnt lgkmcnt(3)
 v_smfmac_f32_16x16x64_bf16 v[50:53], v[18:21], a[24:31], v1
 ds_read_b128 v[30:33], v3 offset:25600
 v_smfmac_f32_16x16x64_bf16 v[42:45], v[18:21], v[96:103], v1
 ds_read_b128 v[14:17], v4 offset:2560
 s_mov_b32 m0, 23936
 s_nop 0
 buffer_load_dword v71, s[4:7], s73 offen sc1 lds
 v_smfmac_f32_16x16x64_bf16 v[46:49], v[18:21], v[62:69], v1
 s_waitcnt vmcnt(3)
 s_waitcnt lgkmcnt(4)
 v_smfmac_f32_16x16x64_bf16 v[50:53], v[22:25], a[32:39], v1
 ds_read_b64_tr_b16 v[62:63], v70 offset:2176
 ds_read_b64_tr_b16 v[64:65], v70 offset:2240
 v_smfmac_f32_16x16x64_bf16 v[42:45], v[22:25], v[104:111], v1
 ds_read_b128 v[18:21], v4 offset:3072
 v_smfmac_f32_16x16x64_bf16 v[46:49], v[22:25], v[34:41], v1
 ds_read_b128 v[34:37], v3 offset:32768
 s_waitcnt lgkmcnt(7)
 v_smfmac_f32_16x16x64_bf16 v[50:53], v[10:13], a[40:47], v1
 ds_read_b128 v[38:41], v3 offset:33792
 ds_read_b64_tr_b16 v[66:67], v70 offset:2688
 ds_read_b64_tr_b16 v[68:69], v70 offset:2752
 v_smfmac_f32_16x16x64_bf16 v[42:45], v[10:13], v[112:119], v1
 ds_read_b128 v[22:25], v4 offset:3584
 s_waitcnt lgkmcnt(9)
 v_smfmac_f32_16x16x64_bf16 v[46:49], v[10:13], v[26:33], v1
 ds_read_b128 v[26:29], v3 offset:40960
 s_waitcnt lgkmcnt(9)
 v_smfmac_f32_16x16x64_bf16 v[50:53], v[14:17], a[48:55], v1
 ds_read_b128 v[30:33], v3 offset:41984
 v_smfmac_f32_16x16x64_bf16 v[42:45], v[14:17], v[120:127], v1
 v_smfmac_f32_16x16x64_bf16 v[46:49], v[14:17], v[128:135], v1
 s_waitcnt lgkmcnt(7)
 v_smfmac_f32_16x16x64_bf16 v[50:53], v[18:21], a[56:63], v1
 s_waitcnt lgkmcnt(3)
 s_barrier
 v_smfmac_f32_16x16x64_bf16 v[42:45], v[18:21], v[136:143], v1
 ds_read_b128 v[10:13], v4 offset:4096
 ds_read_b128 v[14:17], v4 offset:4608
 v_smfmac_f32_16x16x64_bf16 v[46:49], v[18:21], v[34:41], v1
 ds_read_b128 v[34:37], v3 offset:49152
 s_waitcnt lgkmcnt(5)
 v_smfmac_f32_16x16x64_bf16 v[50:53], v[22:25], a[64:71], v1
 ds_read_b128 v[38:41], v3 offset:50176
 v_smfmac_f32_16x16x64_bf16 v[42:45], v[22:25], v[144:151], v1
 ds_read_b128 v[18:21], v4 offset:5120
 buffer_store_dwordx4 v[62:65], v0, s[4:7], s65 offen offset:0 sc1
 s_waitcnt lgkmcnt(5)
 v_smfmac_f32_16x16x64_bf16 v[46:49], v[22:25], v[26:33], v1
 ds_read_b128 v[26:29], v9 offset:0
 s_waitcnt lgkmcnt(5)
 v_smfmac_f32_16x16x64_bf16 v[50:53], v[10:13], a[72:79], v1
 ds_read_b128 v[30:33], v9 offset:1024
 v_smfmac_f32_16x16x64_bf16 v[42:45], v[10:13], v[152:159], v1
 ds_read_b128 v[22:25], v4 offset:5632
 v_smfmac_f32_16x16x64_bf16 v[46:49], v[10:13], v[160:167], v1
 s_waitcnt lgkmcnt(6)
 v_smfmac_f32_16x16x64_bf16 v[50:53], v[14:17], a[80:87], v1
 v_smfmac_f32_16x16x64_bf16 v[42:45], v[14:17], v[168:175], v1
 ds_read_b128 v[10:13], v4 offset:6144
 buffer_store_dwordx4 v[66:69], v0, s[4:7], s65 offen offset:1024 sc1
 s_waitcnt lgkmcnt(5)
 v_smfmac_f32_16x16x64_bf16 v[46:49], v[14:17], v[34:41], v1
 ds_read_b128 v[34:37], v9 offset:8192
 s_waitcnt lgkmcnt(5)
 v_smfmac_f32_16x16x64_bf16 v[50:53], v[18:21], a[88:95], v1
 ds_read_b128 v[38:41], v9 offset:9216
 v_smfmac_f32_16x16x64_bf16 v[42:45], v[18:21], v[176:183], v1
 ds_read_b128 v[14:17], v4 offset:6656
 s_waitcnt lgkmcnt(5)
 v_smfmac_f32_16x16x64_bf16 v[46:49], v[18:21], v[26:33], v1
 ds_read_b128 v[26:29], v9 offset:16384
 s_waitcnt lgkmcnt(5)
 v_smfmac_f32_16x16x64_bf16 v[50:53], v[22:25], a[96:103], v1
 ds_read_b128 v[30:33], v9 offset:17408
 v_smfmac_f32_16x16x64_bf16 v[42:45], v[22:25], v[184:191], v1
 ds_read_b128 v[18:21], v4 offset:7168
 v_smfmac_f32_16x16x64_bf16 v[46:49], v[22:25], v[192:199], v1
 ds_read_b128 v[62:65], v9 offset:24576
 s_waitcnt lgkmcnt(7)
 v_smfmac_f32_16x16x64_bf16 v[42:45], v[10:13], v[200:207], v1
 ds_read_b128 v[66:69], v9 offset:25600
 ds_read_b128 v[22:25], v4 offset:7680
 s_waitcnt lgkmcnt(7)
 v_smfmac_f32_16x16x64_bf16 v[46:49], v[10:13], v[34:41], v1
 ds_read_b128 v[34:37], v9 offset:32768
 s_waitcnt lgkmcnt(7)
 v_smfmac_f32_16x16x64_bf16 v[42:45], v[14:17], v[208:215], v1
 ds_read_b128 v[38:41], v9 offset:33792
 ds_read_b128 v[10:13], v4 offset:8192
 s_waitcnt lgkmcnt(7)
 v_smfmac_f32_16x16x64_bf16 v[46:49], v[14:17], v[26:33], v1
 s_waitcnt lgkmcnt(6)
 v_smfmac_f32_16x16x64_bf16 v[42:45], v[18:21], v[216:223], v1
 ds_read_b128 v[14:17], v4 offset:8704
 s_waitcnt lgkmcnt(5)
 v_smfmac_f32_16x16x64_bf16 v[46:49], v[18:21], v[62:69], v1
 s_waitcnt lgkmcnt(4)
 v_smfmac_f32_16x16x64_bf16 v[42:45], v[22:25], v[224:231], v1
 ds_read_b128 v[18:21], v4 offset:6144
 s_waitcnt lgkmcnt(3)
 v_smfmac_f32_16x16x64_bf16 v[46:49], v[22:25], v[34:41], v1
 s_waitcnt lgkmcnt(2)
 v_smfmac_f32_16x16x64_bf16 v[42:45], v[10:13], v[232:239], v1
 ds_read_b128 v[22:25], v4 offset:6656
 v_smfmac_f32_16x16x64_bf16 v[46:49], v[10:13], v[240:247], v1
 ds_read_b128 v[26:29], v0 offset:15744
 ds_read_b128 v[30:33], v0 offset:17792
 s_waitcnt lgkmcnt(4)
 v_smfmac_f32_16x16x64_bf16 v[42:45], v[14:17], v[248:255], v1
 ds_read_b128 v[10:13], v4 offset:7168
 v_smfmac_f32_16x16x64_bf16 v[46:49], v[14:17], a[0:7], v1
 ds_read_b128 v[34:37], v0 offset:19840
 ds_read_b128 v[38:41], v0 offset:21888
 ds_read_b128 v[14:17], v4 offset:7680
 s_waitcnt lgkmcnt(7)
 v_smfmac_f32_16x16x64_bf16 v[50:53], v[18:21], a[104:111], v1
 s_nop 1
 s_waitcnt lgkmcnt(6)
 v_smfmac_f32_16x16x64_bf16 v[50:53], v[22:25], a[112:119], v1
 s_nop 2
 v_cvt_pk_bf16_f32 v62, v42, v43
 v_cvt_pk_bf16_f32 v63, v44, v45
 ds_write_b64 v5, v[62:63]
 v_cvt_pk_bf16_f32 v64, v46, v47
 v_cvt_pk_bf16_f32 v65, v48, v49
 ds_write_b64 v5, v[64:65] offset:2176
 ds_read_b128 v[42:45], v4 offset:8192
 ds_read_b128 v[46:49], v4 offset:8704
 s_waitcnt lgkmcnt(7)
 v_smfmac_f32_16x16x64_bf16 v[50:53], v[10:13], a[120:127], v1
 s_waitcnt lgkmcnt(4)
 v_smfmac_f32_16x16x64_bf16 v[50:53], v[14:17], a[128:135], v1
 s_waitcnt lgkmcnt(2)
 s_barrier
 ds_read_b64_tr_b16 v[10:11], v6 offset:0
 ds_read_b64_tr_b16 v[12:13], v6 offset:64
 ds_read_b64_tr_b16 v[14:15], v6 offset:256
 ds_read_b64_tr_b16 v[16:17], v6 offset:320
 s_waitcnt lgkmcnt(5)
 v_smfmac_f32_16x16x64_bf16 v[50:53], v[42:45], a[136:143], v1
 ds_read_b64_tr_b16 v[18:19], v6 offset:512
 ds_read_b64_tr_b16 v[20:21], v6 offset:576
 ds_read_b64_tr_b16 v[22:23], v6 offset:768
 ds_read_b64_tr_b16 v[24:25], v6 offset:832
 s_waitcnt lgkmcnt(8)
 v_smfmac_f32_16x16x64_bf16 v[50:53], v[46:49], a[144:151], v1
 s_waitcnt lgkmcnt(6)
 v_mfma_f32_16x16x32_bf16 v[42:45], v[26:29], v[10:13], 0
 ds_read_b128 v[26:29], v0 offset:16768
 v_mov_b32 v62, v2
 v_mov_b32 v63, v2
 s_waitcnt lgkmcnt(5)
 v_mfma_f32_16x16x32_bf16 v[42:45], v[30:33], v[14:17], v[42:45]
 ds_read_b128 v[30:33], v0 offset:18816
 v_mov_b32 v64, v2
 v_mov_b32 v65, v2
 s_waitcnt lgkmcnt(4)
 v_mfma_f32_16x16x32_bf16 v[42:45], v[34:37], v[18:21], v[42:45]
 ds_read_b128 v[34:37], v0 offset:20864
 s_waitcnt lgkmcnt(3)
 v_mfma_f32_16x16x32_bf16 v[42:45], v[38:41], v[22:25], v[42:45]
 ds_read_b128 v[38:41], v0 offset:22912
 v_mfma_f32_16x16x32_bf16 v[62:65], v[10:13], v[10:13], v[62:65]
 v_cvt_pk_bf16_f32 v68, v50, v51
 v_cvt_pk_bf16_f32 v69, v52, v53
 v_mfma_f32_16x16x32_bf16 v[62:65], v[14:17], v[14:17], v[62:65]
 ds_write_b64 v5, v[68:69] offset:4352
 v_mov_b64 v[66:67], v[68:69]
 v_mfma_f32_16x16x32_bf16 v[62:65], v[18:21], v[18:21], v[62:65]
 s_nop 0
 v_mul_f32 v42, s62, v42
 v_mul_f32 v43, s62, v43
 v_mfma_f32_16x16x32_bf16 v[62:65], v[22:25], v[22:25], v[62:65]
 v_permlane32_swap_b32 v66, v68
 v_permlane32_swap_b32 v67, v69
 s_waitcnt lgkmcnt(4)
 v_mfma_f32_16x16x32_bf16 v[46:49], v[26:29], v[10:13], 0
 v_mul_f32 v44, s62, v44
 v_mul_f32 v45, s62, v45
 s_waitcnt lgkmcnt(3)
 v_mfma_f32_16x16x32_bf16 v[46:49], v[30:33], v[14:17], v[46:49]
 v_max3_f32 v70, v42, v43, v44
 s_nop 0
 s_waitcnt lgkmcnt(2)
 v_mfma_f32_16x16x32_bf16 v[46:49], v[34:37], v[18:21], v[46:49]
 v_mul_f32 v62, s62, v62
 v_mul_f32 v63, s62, v63
 s_waitcnt lgkmcnt(1)
 v_mfma_f32_16x16x32_bf16 v[46:49], v[38:41], v[22:25], v[46:49]
 v_mul_f32 v64, s62, v64
 v_mul_f32 v65, s62, v65
 v_max3_f32 v70, v70, v45, v62
 v_max3_f32 v71, v63, v64, v65
 v_mov_b64 v[30:31], 0
 v_mov_b64 v[34:35], 0
 v_mov_b64 v[22:23], s[76:77]
 v_mov_b64 v[24:25], s[76:77]
 v_pk_mul_f32 v[46:47], v[46:47], s[62:63]
 v_pk_mul_f32 v[48:49], v[48:49], s[62:63]
 v_max3_f32 v70, v70, v71, v46
 v_max3_f32 v71, v47, v48, v49
 v_max_f32 v21, v70, v71
 v_max_f32 v70, v70, v71
 s_nop 1
 v_permlane16_swap_b32 v70, v21
 v_max_f32 v71, v70, v21
 v_max_f32 v70, v70, v21
 s_nop 1
 v_permlane32_swap_b32 v70, v71
 v_max_f32 v70, v70, v71
 v_pk_add_f32 v[42:43], v[42:43], v[70:71] op_sel_hi:[1,0] neg_lo:[0,1] neg_hi:[0,1]
 v_pk_add_f32 v[44:45], v[44:45], v[70:71] op_sel_hi:[1,0] neg_lo:[0,1] neg_hi:[0,1]
 v_pk_add_f32 v[46:47], v[46:47], v[70:71] op_sel_hi:[1,0] neg_lo:[0,1] neg_hi:[0,1]
 v_pk_add_f32 v[48:49], v[48:49], v[70:71] op_sel_hi:[1,0] neg_lo:[0,1] neg_hi:[0,1]
 v_pk_add_f32 v[62:63], v[62:63], v[70:71] op_sel_hi:[1,0] neg_lo:[0,1] neg_hi:[0,1]
 v_pk_add_f32 v[64:65], v[64:65], v[70:71] op_sel_hi:[1,0] neg_lo:[0,1] neg_hi:[0,1]
 v_exp_f32 v42, v42
 v_exp_f32 v43, v43
 v_exp_f32 v44, v44
 v_exp_f32 v45, v45
 v_exp_f32 v46, v46
 v_exp_f32 v47, v47
 v_exp_f32 v48, v48
 v_exp_f32 v49, v49
 v_exp_f32 v62, v62
 v_cvt_pk_bf16_f32 v26, v42, v43
 v_cvt_pk_bf16_f32 v27, v44, v45
 v_cvt_pk_bf16_f32 v28, v46, v47
 v_cvt_pk_bf16_f32 v29, v48, v49
 v_exp_f32 v63, v63
 s_waitcnt vmcnt(3)
 v_mfma_f32_16x16x32_bf16 v[10:13], v[22:25], v[26:29], 0
 v_exp_f32 v64, v64
 v_mfma_f32_16x16x32_bf16 v[14:17], v[54:57], v[26:29], 0
 v_exp_f32 v65, v65
 v_mfma_f32_16x16x32_bf16 v[36:39], v[58:61], v[26:29], 0
 v_cvt_pk_bf16_f32 v32, v62, v63
 v_cvt_pk_bf16_f32 v33, v64, v65
 s_nop 1
 v_mfma_f32_16x16x32_bf16 v[10:13], v[22:25], v[32:35], v[10:13]
 v_mfma_f32_16x16x32_bf16 v[14:17], v[66:69], v[32:35], v[14:17]
 v_mfma_f32_16x16x32_bf16 v[36:39], v[66:69], v[30:33], v[36:39]
 v_add_u32 v9, 98304, v3
 v_mov_b64 v[52:53], 0
 v_mov_b64 v[54:55], 0
 v_mov_b64 v[56:57], 0
 v_mov_b64 v[58:59], 0
 s_nop 0
 v_rcp_f32 v18, v10
 v_mov_b64 v[60:61], 0
 v_pk_mul_f32 v[14:15], v[14:15], v[18:19] op_sel_hi:[1,0]
 v_pk_mul_f32 v[16:17], v[16:17], v[18:19] op_sel_hi:[1,0]
 v_pk_mul_f32 v[36:37], v[36:37], v[18:19] op_sel_hi:[1,0]
 v_pk_mul_f32 v[38:39], v[38:39], v[18:19] op_sel_hi:[1,0]
 v_cvt_pk_bf16_f32 v22, v14, v15
 v_cvt_pk_bf16_f32 v23, v16, v17
 v_cvt_pk_bf16_f32 v24, v36, v37
 v_cvt_pk_bf16_f32 v25, v38, v39
 ds_write_b128 v7, v[22:25]
 s_add_u32 s50, s50, 1
 v_mov_b64 v[62:63], 0
 v_mov_b64 v[64:65], 0
 v_mov_b64 v[66:67], 0
 s_waitcnt lgkmcnt(0)
 s_barrier
 ds_read_b128 v[10:13], v4 offset:0
 ds_read_b128 v[14:17], v4 offset:512
 ds_read_b128 v[18:21], v4 offset:1024
 ds_read_b128 v[22:25], v4 offset:1536
 s_waitcnt lgkmcnt(3)
 v_smfmac_f32_16x16x64_bf16 v[52:55], v[10:13], a[152:159], v1
 s_waitcnt lgkmcnt(2)
 v_smfmac_f32_16x16x64_bf16 v[52:55], v[14:17], a[160:167], v1
 ds_read_b128 v[26:29], v9 offset:0
 ds_read_b128 v[30:33], v9 offset:1024
 s_waitcnt lgkmcnt(3)
 v_smfmac_f32_16x16x64_bf16 v[52:55], v[18:21], a[168:175], v1
 s_waitcnt lgkmcnt(2)
 v_smfmac_f32_16x16x64_bf16 v[52:55], v[22:25], a[176:183], v1
 ds_read_b128 v[34:37], v9 offset:8192
 ds_read_b128 v[38:41], v9 offset:9216
 v_smfmac_f32_16x16x64_bf16 v[56:59], v[10:13], a[184:191], v1
 s_nop 2
 v_smfmac_f32_16x16x64_bf16 v[56:59], v[14:17], a[192:199], v1
 ds_read_b128 v[42:45], v9 offset:16384
 ds_read_b128 v[46:49], v9 offset:17408
 s_nop 0
 v_smfmac_f32_16x16x64_bf16 v[56:59], v[18:21], a[200:207], v1
 v_cvt_pk_bf16_f32 v52, v52, v53
 v_smfmac_f32_16x16x64_bf16 v[56:59], v[22:25], a[208:215], v1
 v_cvt_pk_bf16_f32 v53, v54, v55
 v_smfmac_f32_16x16x64_bf16 v[60:63], v[10:13], a[216:223], v1
 s_nop 1
 v_or_b32 v52, 1, v52
 v_smfmac_f32_16x16x64_bf16 v[60:63], v[14:17], a[224:231], v1
 s_nop 2
 s_waitcnt lgkmcnt(4)
 v_smfmac_f32_16x16x64_bf16 v[60:63], v[18:21], v[26:33], v1
 v_cvt_pk_bf16_f32 v56, v56, v57
 v_smfmac_f32_16x16x64_bf16 v[60:63], v[22:25], a[232:239], v1
 buffer_store_dwordx2 v[52:53], v8, s[4:7], s55 offen sc1
 v_cvt_pk_bf16_f32 v57, v58, v59
 s_waitcnt lgkmcnt(2)
 v_smfmac_f32_16x16x64_bf16 v[64:67], v[10:13], v[34:41], v1
 s_nop 1
 v_or_b32 v56, 1, v56
 v_smfmac_f32_16x16x64_bf16 v[64:67], v[14:17], a[240:247], v1
 s_nop 2
 s_waitcnt lgkmcnt(0)
 v_smfmac_f32_16x16x64_bf16 v[64:67], v[18:21], v[42:49], v1
 v_cvt_pk_bf16_f32 v60, v60, v61
 v_smfmac_f32_16x16x64_bf16 v[64:67], v[22:25], a[248:255], v1
 buffer_store_dwordx2 v[56:57], v8, s[4:7], s56 offen sc1
 v_cvt_pk_bf16_f32 v61, v62, v63
 v_or_b32 v60, 1, v60
 buffer_store_dwordx2 v[60:61], v8, s[4:7], s57 offen sc1
 s_add_u32 s52, s52, 262144
 s_add_u32 s65, s65, s27
 s_mov_b64 s[28:29], -1
 s_sub_i32 s64, s50, s71
 s_mov_b32 s27, 131072
 v_cvt_pk_bf16_f32 v64, v64, v65
 v_cvt_pk_bf16_f32 v65, v66, v67
 v_or_b32 v64, 1, v64
 buffer_store_dwordx2 v[64:65], v8, s[4:7], s58 offen sc1
 s_barrier
 s_nop 15
 s_nop 15
 s_nop 7
 buffer_load_dwordx4 v[10:13], v0, s[4:7], s60 offen offset:0 sc1
 buffer_load_dwordx4 v[14:17], v0, s[4:7], s60 offen offset:1024 sc1
 buffer_load_dwordx4 v[18:21], v0, s[4:7], s60 offen offset:2048 sc1
 buffer_load_dwordx4 v[22:25], v0, s[4:7], s60 offen offset:3072 sc1
 v_and_b32 v34, 16, v0
 v_mov_b32 v30, 0x3f80
 v_lshlrev_b32 v30, v34, v30
 v_bfe_u32 v34, v0, 5, 3
 v_cmp_eq_u32 vcc, 0, v34
 s_nop 1
 v_cndmask_b32 v26, 0, v30, vcc
 v_cmp_eq_u32 vcc, 1, v34
 s_nop 1
 v_cndmask_b32 v27, 0, v30, vcc
 v_cmp_eq_u32 vcc, 2, v34
 s_nop 1
 v_cndmask_b32 v28, 0, v30, vcc
 v_cmp_eq_u32 vcc, 3, v34
 s_nop 1
 v_cndmask_b32 v29, 0, v30, vcc
 v_and_b32 v35, 0xf0, v0
 v_bfe_u32 v34, v0, 8, 2
 v_lshl_add_u32 v35, v34, 2, v35
 v_and_b32 v34, 0x80, v0
 v_lshl_add_u32 v35, v34, 23, v35
 v_mov_b64 v[42:43], 0
 v_mov_b64 v[44:45], 0
 v_mov_b64 v[46:47], 0
 v_mov_b64 v[48:49], 0
 v_mov_b64 v[50:51], 0
 v_mov_b64 v[52:53], 0
 v_and_b32 v70, 0xf0, v0
 v_bfe_u32 v71, v0, 8, 2
 v_lshl_add_u32 v71, v71, 9, s67
 v_add_u32 v70, v70, v71
 v_add_u32 v9, 57344, v3
 s_waitcnt vmcnt(3)
 v_mfma_f32_16x16x32_bf16 v[30:33], v[10:13], v[26:29], 0
 v_bitop3_b32 v34, v10, v12, v12 bitop3:0x80
 s_waitcnt vmcnt(2)
 v_mfma_f32_16x16x32_bf16 v[30:33], v[14:17], v[26:29], v[30:33]
 v_bitop3_b32 v34, v34, v14, v16 bitop3:0x80
 s_waitcnt vmcnt(1)
 v_mfma_f32_16x16x32_bf16 v[30:33], v[18:21], v[26:29], v[30:33]
 v_bitop3_b32 v34, v34, v18, v20 bitop3:0x80
 s_waitcnt vmcnt(0)
 v_mfma_f32_16x16x32_bf16 v[30:33], v[22:25], v[26:29], v[30:33]
 v_bitop3_b32 v34, v34, v22, v24 bitop3:0x80
 v_and_b32 v34, 1, v34
 v_cmp_ne_u32 vcc, 1, v34
 s_cbranch_vccnz L_rre_151
 s_nop 3
 v_permlane32_swap_b32 v30, v31
 v_permlane32_swap_b32 v32, v33
 v_add_f32 v30, v30, v31
 v_add_f32 v32, v32, v33
 v_cvt_pk_bf16_f32 v30, v30, v32
 v_or_b32 v30, 1, v30
 buffer_store_dword v30, v35, s[4:7], s61 offen sc1
L_rback_152:
 s_barrier
 s_nop 15
 s_nop 11
 buffer_load_dwordx4 v[10:13], v0, s[4:7], s24 offen offset:0 sc1
 buffer_load_dwordx4 v[14:17], v0, s[4:7], s24 offen offset:1024 sc1
 ds_read_b128 v[26:29], v3 offset:0
 ds_read_b128 v[30:33], v3 offset:1024
 ds_read_b128 v[62:65], v3 offset:8192
 ds_read_b128 v[66:69], v3 offset:9216
 ds_read_b128 v[34:37], v3 offset:16384
 ds_read_b128 v[38:41], v3 offset:17408
 s_nop 15
 s_nop 3
 buffer_load_dwordx4 v[18:21], v0, s[4:7], s24 offen offset:0 sc1
 buffer_load_dwordx4 v[22:25], v0, s[4:7], s24 offen offset:1024 sc1
 s_nop 15
 s_nop 11
 buffer_load_dwordx4 v[54:57], v0, s[4:7], s24 offen offset:0 sc1
 buffer_load_dwordx4 v[58:61], v0, s[4:7], s24 offen offset:1024 sc1
 s_waitcnt vmcnt(5)
 v_bitop3_b32 v71, v10, v11, v12 bitop3:0x80
 v_bitop3_b32 v71, v71, v13, v13 bitop3:0x80
 s_waitcnt vmcnt(4)
 v_bitop3_b32 v71, v71, v14, v15 bitop3:0x80
 v_bitop3_b32 v71, v71, v16, v17 bitop3:0x80
 v_and_b32 v71, 1, v71
 v_cmp_ne_u32 vcc, 1, v71
 s_cbranch_vccnz L_ma_155
 ds_write_b128 v0, v[10:13] offset:0
 ds_write_b128 v0, v[14:17] offset:1024
 s_barrier
L_maok_153:
 s_branch L_loop_140
L_last_141:
 s_waitcnt lgkmcnt(0)
 s_barrier
 ds_read_b128 v[10:13], v4 offset:0
 ds_read_b128 v[14:17], v4 offset:512
 s_waitcnt vmcnt(2)
 ds_read_b128 v[18:21], v4 offset:1024
 s_waitcnt lgkmcnt(2)
 v_smfmac_f32_16x16x64_bf16 v[50:53], v[10:13], a[8:15], v1
 v_smfmac_f32_16x16x64_bf16 v[42:45], v[10:13], v[72:79], v1
 ds_read_b128 v[22:25], v4 offset:1536
 v_bfe_u32 v70, v0, 5, 1
 v_smfmac_f32_16x16x64_bf16 v[46:49], v[10:13], v[80:87], v1
 v_mul_i32_i24 v70, -1920, v70
 s_waitcnt lgkmcnt(2)
 v_smfmac_f32_16x16x64_bf16 v[50:53], v[14:17], a[16:23], v1
 v_add_u32 v70, v70, v6
 v_smfmac_f32_16x16x64_bf16 v[42:45], v[14:17], v[88:95], v1
 ds_read_b128 v[10:13], v4 offset:2048
 v_smfmac_f32_16x16x64_bf16 v[46:49], v[14:17], v[26:33], v1
 ds_read_b128 v[26:29], v3 offset:24576
 s_waitcnt lgkmcnt(3)
 v_smfmac_f32_16x16x64_bf16 v[50:53], v[18:21], a[24:31], v1
 ds_read_b128 v[30:33], v3 offset:25600
 v_smfmac_f32_16x16x64_bf16 v[42:45], v[18:21], v[96:103], v1
 ds_read_b128 v[14:17], v4 offset:2560
 v_smfmac_f32_16x16x64_bf16 v[46:49], v[18:21], v[62:69], v1
 s_waitcnt vmcnt(0)
 s_waitcnt lgkmcnt(4)
 v_smfmac_f32_16x16x64_bf16 v[50:53], v[22:25], a[32:39], v1
 ds_read_b64_tr_b16 v[62:63], v70 offset:2176
 ds_read_b64_tr_b16 v[64:65], v70 offset:2240
 v_smfmac_f32_16x16x64_bf16 v[42:45], v[22:25], v[104:111], v1
 ds_read_b128 v[18:21], v4 offset:3072
 v_smfmac_f32_16x16x64_bf16 v[46:49], v[22:25], v[34:41], v1
 ds_read_b128 v[34:37], v3 offset:32768
 s_waitcnt lgkmcnt(7)
 v_smfmac_f32_16x16x64_bf16 v[50:53], v[10:13], a[40:47], v1
 ds_read_b128 v[38:41], v3 offset:33792
 ds_read_b64_tr_b16 v[66:67], v70 offset:2688
 ds_read_b64_tr_b16 v[68:69], v70 offset:2752
 v_smfmac_f32_16x16x64_bf16 v[42:45], v[10:13], v[112:119], v1
 ds_read_b128 v[22:25], v4 offset:3584
 s_waitcnt lgkmcnt(9)
 v_smfmac_f32_16x16x64_bf16 v[46:49], v[10:13], v[26:33], v1
 ds_read_b128 v[26:29], v3 offset:40960
 s_waitcnt lgkmcnt(9)
 v_smfmac_f32_16x16x64_bf16 v[50:53], v[14:17], a[48:55], v1
 ds_read_b128 v[30:33], v3 offset:41984
 v_smfmac_f32_16x16x64_bf16 v[42:45], v[14:17], v[120:127], v1
 v_smfmac_f32_16x16x64_bf16 v[46:49], v[14:17], v[128:135], v1
 s_waitcnt lgkmcnt(7)
 v_smfmac_f32_16x16x64_bf16 v[50:53], v[18:21], a[56:63], v1
 s_waitcnt lgkmcnt(3)
 s_barrier
 v_smfmac_f32_16x16x64_bf16 v[42:45], v[18:21], v[136:143], v1
 ds_read_b128 v[10:13], v4 offset:4096
 ds_read_b128 v[14:17], v4 offset:4608
 v_smfmac_f32_16x16x64_bf16 v[46:49], v[18:21], v[34:41], v1
 ds_read_b128 v[34:37], v3 offset:49152
 s_waitcnt lgkmcnt(5)
 v_smfmac_f32_16x16x64_bf16 v[50:53], v[22:25], a[64:71], v1
 ds_read_b128 v[38:41], v3 offset:50176
 v_smfmac_f32_16x16x64_bf16 v[42:45], v[22:25], v[144:151], v1
 ds_read_b128 v[18:21], v4 offset:5120
 buffer_store_dwordx4 v[62:65], v0, s[4:7], s65 offen offset:0 sc1
 s_waitcnt lgkmcnt(5)
 v_smfmac_f32_16x16x64_bf16 v[46:49], v[22:25], v[26:33], v1
 ds_read_b128 v[26:29], v9 offset:0
 s_waitcnt lgkmcnt(5)
 v_smfmac_f32_16x16x64_bf16 v[50:53], v[10:13], a[72:79], v1
 ds_read_b128 v[30:33], v9 offset:1024
 v_smfmac_f32_16x16x64_bf16 v[42:45], v[10:13], v[152:159], v1
 ds_read_b128 v[22:25], v4 offset:5632
 v_smfmac_f32_16x16x64_bf16 v[46:49], v[10:13], v[160:167], v1
 s_waitcnt lgkmcnt(6)
 v_smfmac_f32_16x16x64_bf16 v[50:53], v[14:17], a[80:87], v1
 v_smfmac_f32_16x16x64_bf16 v[42:45], v[14:17], v[168:175], v1
 ds_read_b128 v[10:13], v4 offset:6144
 buffer_store_dwordx4 v[66:69], v0, s[4:7], s65 offen offset:1024 sc1
 s_waitcnt lgkmcnt(5)
 v_smfmac_f32_16x16x64_bf16 v[46:49], v[14:17], v[34:41], v1
 ds_read_b128 v[34:37], v9 offset:8192
 s_waitcnt lgkmcnt(5)
 v_smfmac_f32_16x16x64_bf16 v[50:53], v[18:21], a[88:95], v1
 ds_read_b128 v[38:41], v9 offset:9216
 v_smfmac_f32_16x16x64_bf16 v[42:45], v[18:21], v[176:183], v1
 ds_read_b128 v[14:17], v4 offset:6656
 s_waitcnt lgkmcnt(5)
 v_smfmac_f32_16x16x64_bf16 v[46:49], v[18:21], v[26:33], v1
 ds_read_b128 v[26:29], v9 offset:16384
 s_waitcnt lgkmcnt(5)
 v_smfmac_f32_16x16x64_bf16 v[50:53], v[22:25], a[96:103], v1
 ds_read_b128 v[30:33], v9 offset:17408
 v_smfmac_f32_16x16x64_bf16 v[42:45], v[22:25], v[184:191], v1
 ds_read_b128 v[18:21], v4 offset:7168
 v_smfmac_f32_16x16x64_bf16 v[46:49], v[22:25], v[192:199], v1
 ds_read_b128 v[62:65], v9 offset:24576
 s_waitcnt lgkmcnt(7)
 v_smfmac_f32_16x16x64_bf16 v[42:45], v[10:13], v[200:207], v1
 ds_read_b128 v[66:69], v9 offset:25600
 ds_read_b128 v[22:25], v4 offset:7680
 s_waitcnt lgkmcnt(7)
 v_smfmac_f32_16x16x64_bf16 v[46:49], v[10:13], v[34:41], v1
 ds_read_b128 v[34:37], v9 offset:32768
 s_waitcnt lgkmcnt(7)
 v_smfmac_f32_16x16x64_bf16 v[42:45], v[14:17], v[208:215], v1
 ds_read_b128 v[38:41], v9 offset:33792
 ds_read_b128 v[10:13], v4 offset:8192
 s_waitcnt lgkmcnt(7)
 v_smfmac_f32_16x16x64_bf16 v[46:49], v[14:17], v[26:33], v1
 s_waitcnt lgkmcnt(6)
 v_smfmac_f32_16x16x64_bf16 v[42:45], v[18:21], v[216:223], v1
 ds_read_b128 v[14:17], v4 offset:8704
 s_waitcnt lgkmcnt(5)
 v_smfmac_f32_16x16x64_bf16 v[46:49], v[18:21], v[62:69], v1
 s_waitcnt lgkmcnt(4)
 v_smfmac_f32_16x16x64_bf16 v[42:45], v[22:25], v[224:231], v1
 ds_read_b128 v[18:21], v4 offset:6144
 s_waitcnt lgkmcnt(3)
 v_smfmac_f32_16x16x64_bf16 v[46:49], v[22:25], v[34:41], v1
 s_waitcnt lgkmcnt(2)
 v_smfmac_f32_16x16x64_bf16 v[42:45], v[10:13], v[232:239], v1
 ds_read_b128 v[22:25], v4 offset:6656
 v_smfmac_f32_16x16x64_bf16 v[46:49], v[10:13], v[240:247], v1
 s_waitcnt lgkmcnt(2)
 v_smfmac_f32_16x16x64_bf16 v[42:45], v[14:17], v[248:255], v1
 ds_read_b128 v[10:13], v4 offset:7168
 v_smfmac_f32_16x16x64_bf16 v[46:49], v[14:17], a[0:7], v1
 ds_read_b128 v[14:17], v4 offset:7680
 s_waitcnt lgkmcnt(3)
 v_smfmac_f32_16x16x64_bf16 v[50:53], v[18:21], a[104:111], v1
 s_nop 1
 s_waitcnt lgkmcnt(2)
 v_smfmac_f32_16x16x64_bf16 v[50:53], v[22:25], a[112:119], v1
 s_nop 2
 v_cvt_pk_bf16_f32 v62, v42, v43
 v_cvt_pk_bf16_f32 v63, v44, v45
 ds_write_b64 v5, v[62:63]
 v_cvt_pk_bf16_f32 v64, v46, v47
 v_cvt_pk_bf16_f32 v65, v48, v49
 ds_write_b64 v5, v[64:65] offset:2176
 ds_read_b128 v[42:45], v4 offset:8192
 ds_read_b128 v[46:49], v4 offset:8704
 s_waitcnt lgkmcnt(5)
 v_smfmac_f32_16x16x64_bf16 v[50:53], v[10:13], a[120:127], v1
 s_waitcnt lgkmcnt(4)
 v_smfmac_f32_16x16x64_bf16 v[50:53], v[14:17], a[128:135], v1
 s_waitcnt lgkmcnt(2)
 s_barrier
 s_waitcnt lgkmcnt(1)
 v_smfmac_f32_16x16x64_bf16 v[50:53], v[42:45], a[136:143], v1
 s_waitcnt lgkmcnt(0)
 v_smfmac_f32_16x16x64_bf16 v[50:53], v[46:49], a[144:151], v1
 v_bfe_u32 v70, v0, 5, 1
 v_mul_i32_i24 v70, -1920, v70
 v_add_u32 v70, v70, v6
 s_nop 7
 v_cvt_pk_bf16_f32 v40, v50, v51
 v_cvt_pk_bf16_f32 v41, v52, v53
 ds_write_b64 v5, v[40:41] offset:4352
 s_add_u32 s65, s65, 131072
 s_waitcnt vmcnt(0) lgkmcnt(0)
 s_barrier
 ds_read_b64_tr_b16 v[62:63], v70 offset:2176
 ds_read_b64_tr_b16 v[64:65], v70 offset:2240
 ds_read_b64_tr_b16 v[66:67], v70 offset:2688
 ds_read_b64_tr_b16 v[68:69], v70 offset:2752
 s_waitcnt lgkmcnt(0)
 v_or_b32 v62, 1, v62
 v_or_b32 v63, 1, v63
 v_or_b32 v64, 1, v64
 v_or_b32 v65, 1, v65
 v_or_b32 v66, 1, v66
 v_or_b32 v67, 1, v67
 v_or_b32 v68, 1, v68
 v_or_b32 v69, 1, v69
 buffer_store_dwordx4 v[62:65], v0, s[4:7], s65 offen offset:0 sc1
 buffer_store_dwordx4 v[66:69], v0, s[4:7], s65 offen offset:1024 sc1
 s_branch L_done1
L_kvs_142:
 v_lshlrev_b32 v71, 3, v0
 s_mov_b32 m0, 24448
 s_mov_b32 s72, 65015808
 s_mov_b64 exec, 0x1ffff
 buffer_load_dword v71, s[4:7], s72 offen sc1 lds
 s_mov_b64 exec, -1
 s_branch L_kvsb_143
L_rre_144:
 buffer_load_dwordx4 v[10:13], v0, s[4:7], s60 offen offset:0 sc1
 buffer_load_dwordx4 v[14:17], v0, s[4:7], s60 offen offset:1024 sc1
 buffer_load_dwordx4 v[18:21], v0, s[4:7], s60 offen offset:2048 sc1
 buffer_load_dwordx4 v[22:25], v0, s[4:7], s60 offen offset:3072 sc1
 s_nop 15
 s_nop 7
L_rspin_158:
 buffer_load_dwordx4 v[54:57], v0, s[4:7], s60 offen offset:0 sc1
 buffer_load_dwordx4 v[58:61], v0, s[4:7], s60 offen offset:1024 sc1
 buffer_load_dwordx4 v[62:65], v0, s[4:7], s60 offen offset:2048 sc1
 buffer_load_dwordx4 v[66:69], v0, s[4:7], s60 offen offset:3072 sc1
 s_add_u32 s51, s51, 1
 s_waitcnt vmcnt(7)
 v_mfma_f32_16x16x32_bf16 v[30:33], v[10:13], v[26:29], 0
 v_bitop3_b32 v34, v10, v12, v12 bitop3:0xfe
 s_waitcnt vmcnt(6)
 v_mfma_f32_16x16x32_bf16 v[30:33], v[14:17], v[26:29], v[30:33]
 v_bitop3_b32 v34, v34, v14, v16 bitop3:0xfe
 s_waitcnt vmcnt(5)
 v_mfma_f32_16x16x32_bf16 v[30:33], v[18:21], v[26:29], v[30:33]
 v_bitop3_b32 v34, v34, v18, v20 bitop3:0xfe
 s_waitcnt vmcnt(4)
 v_mfma_f32_16x16x32_bf16 v[30:33], v[22:25], v[26:29], v[30:33]
 v_bitop3_b32 v34, v34, v22, v24 bitop3:0xfe
 v_and_b32 v34, 1, v34
 v_cmp_ne_u32 vcc, 0, v34
 s_cbranch_vccz L_rok_159
 buffer_load_dwordx4 v[10:13], v0, s[4:7], s60 offen offset:0 sc1
 buffer_load_dwordx4 v[14:17], v0, s[4:7], s60 offen offset:1024 sc1
 buffer_load_dwordx4 v[18:21], v0, s[4:7], s60 offen offset:2048 sc1
 buffer_load_dwordx4 v[22:25], v0, s[4:7], s60 offen offset:3072 sc1
 s_add_u32 s51, s51, 1
 s_waitcnt vmcnt(7)
 v_mfma_f32_16x16x32_bf16 v[30:33], v[54:57], v[26:29], 0
 v_bitop3_b32 v34, v54, v56, v56 bitop3:0xfe
 s_waitcnt vmcnt(6)
 v_mfma_f32_16x16x32_bf16 v[30:33], v[58:61], v[26:29], v[30:33]
 v_bitop3_b32 v34, v34, v58, v60 bitop3:0xfe
 s_waitcnt vmcnt(5)
 v_mfma_f32_16x16x32_bf16 v[30:33], v[62:65], v[26:29], v[30:33]
 v_bitop3_b32 v34, v34, v62, v64 bitop3:0xfe
 s_waitcnt vmcnt(4)
 v_mfma_f32_16x16x32_bf16 v[30:33], v[66:69], v[26:29], v[30:33]
 v_bitop3_b32 v34, v34, v66, v68 bitop3:0xfe
 v_and_b32 v34, 1, v34
 v_cmp_ne_u32 vcc, 0, v34
 s_cbranch_vccz L_rok_159
 s_and_b32 s3, s51, 0xffff
 s_cmp_gt_u32 s3, 20000
 s_cbranch_scc0 L_rspin_158
 s_branch L_exit1
L_rok_159:
 s_nop 3
 v_permlane32_swap_b32 v30, v31
 v_permlane32_swap_b32 v32, v33
 v_add_f32 v30, v30, v31
 v_add_f32 v32, v32, v33
 v_cvt_pk_bf16_f32 v30, v30, v32
 v_and_b32 v30, -2, v30
 buffer_store_dword v30, v35, s[4:7], s61 offen sc1
 s_waitcnt vmcnt(1)
 s_branch L_rback_145
L_ma_148:
 s_add_u32 s51, s51, 1
 s_waitcnt vmcnt(3)
 v_bitop3_b32 v71, v18, v19, v20 bitop3:0xfe
 v_bitop3_b32 v71, v71, v21, v21 bitop3:0xfe
 s_waitcnt vmcnt(2)
 v_bitop3_b32 v71, v71, v22, v23 bitop3:0xfe
 v_bitop3_b32 v71, v71, v24, v25 bitop3:0xfe
 v_and_b32 v71, 1, v71
 v_cmp_ne_u32 vcc, 0, v71
 s_cbranch_vccz L_mahit_162
 buffer_load_dwordx4 v[10:13], v0, s[4:7], s24 offen offset:0 sc1
 buffer_load_dwordx4 v[14:17], v0, s[4:7], s24 offen offset:1024 sc1
L_marot_160:
 s_add_u32 s51, s51, 1
 s_waitcnt vmcnt(3)
 v_bitop3_b32 v71, v54, v55, v56 bitop3:0xfe
 v_bitop3_b32 v71, v71, v57, v57 bitop3:0xfe
 s_waitcnt vmcnt(2)
 v_bitop3_b32 v71, v71, v58, v59 bitop3:0xfe
 v_bitop3_b32 v71, v71, v60, v61 bitop3:0xfe
 v_and_b32 v71, 1, v71
 v_cmp_ne_u32 vcc, 0, v71
 s_cbranch_vccz L_mahit_163
 buffer_load_dwordx4 v[18:21], v0, s[4:7], s24 offen offset:0 sc1
 buffer_load_dwordx4 v[22:25], v0, s[4:7], s24 offen offset:1024 sc1
 s_add_u32 s51, s51, 1
 s_waitcnt vmcnt(3)
 v_bitop3_b32 v71, v10, v11, v12 bitop3:0xfe
 v_bitop3_b32 v71, v71, v13, v13 bitop3:0xfe
 s_waitcnt vmcnt(2)
 v_bitop3_b32 v71, v71, v14, v15 bitop3:0xfe
 v_bitop3_b32 v71, v71, v16, v17 bitop3:0xfe
 v_and_b32 v71, 1, v71
 v_cmp_ne_u32 vcc, 0, v71
 s_cbranch_vccz L_mahit_161
 buffer_load_dwordx4 v[54:57], v0, s[4:7], s24 offen offset:0 sc1
 buffer_load_dwordx4 v[58:61], v0, s[4:7], s24 offen offset:1024 sc1
 s_add_u32 s51, s51, 1
 s_waitcnt vmcnt(3)
 v_bitop3_b32 v71, v18, v19, v20 bitop3:0xfe
 v_bitop3_b32 v71, v71, v21, v21 bitop3:0xfe
 s_waitcnt vmcnt(2)
 v_bitop3_b32 v71, v71, v22, v23 bitop3:0xfe
 v_bitop3_b32 v71, v71, v24, v25 bitop3:0xfe
 v_and_b32 v71, 1, v71
 v_cmp_ne_u32 vcc, 0, v71
 s_cbranch_vccz L_mahit_162
 buffer_load_dwordx4 v[10:13], v0, s[4:7], s24 offen offset:0 sc1
 buffer_load_dwordx4 v[14:17], v0, s[4:7], s24 offen offset:1024 sc1
 s_add_u32 s51, s51, 1
 s_and_b32 s3, s51, 0xffff
 s_cmp_gt_u32 s3, 20000
 s_cbranch_scc0 L_marot_160
 s_branch L_exit1
L_mahit_161:
 ds_write_b128 v0, v[10:13] offset:0
 ds_write_b128 v0, v[14:17] offset:1024
 s_barrier
 s_waitcnt vmcnt(0)
 s_branch L_maok_146
L_mahit_162:
 ds_write_b128 v0, v[18:21] offset:0
 ds_write_b128 v0, v[22:25] offset:1024
 s_barrier
 s_branch L_maok_146
L_mahit_163:
 ds_write_b128 v0, v[54:57] offset:0
 ds_write_b128 v0, v[58:61] offset:1024
 s_barrier
 s_waitcnt vmcnt(0)
 s_branch L_maok_146
L_rre_151:
 buffer_load_dwordx4 v[10:13], v0, s[4:7], s60 offen offset:0 sc1
 buffer_load_dwordx4 v[14:17], v0, s[4:7], s60 offen offset:1024 sc1
 buffer_load_dwordx4 v[18:21], v0, s[4:7], s60 offen offset:2048 sc1
 buffer_load_dwordx4 v[22:25], v0, s[4:7], s60 offen offset:3072 sc1
 s_nop 15
 s_nop 7
L_rspin_164:
 buffer_load_dwordx4 v[54:57], v0, s[4:7], s60 offen offset:0 sc1
 buffer_load_dwordx4 v[58:61], v0, s[4:7], s60 offen offset:1024 sc1
 buffer_load_dwordx4 v[62:65], v0, s[4:7], s60 offen offset:2048 sc1
 buffer_load_dwordx4 v[66:69], v0, s[4:7], s60 offen offset:3072 sc1
 s_add_u32 s51, s51, 1
 s_waitcnt vmcnt(7)
 v_mfma_f32_16x16x32_bf16 v[30:33], v[10:13], v[26:29], 0
 v_bitop3_b32 v34, v10, v12, v12 bitop3:0x80
 s_waitcnt vmcnt(6)
 v_mfma_f32_16x16x32_bf16 v[30:33], v[14:17], v[26:29], v[30:33]
 v_bitop3_b32 v34, v34, v14, v16 bitop3:0x80
 s_waitcnt vmcnt(5)
 v_mfma_f32_16x16x32_bf16 v[30:33], v[18:21], v[26:29], v[30:33]
 v_bitop3_b32 v34, v34, v18, v20 bitop3:0x80
 s_waitcnt vmcnt(4)
 v_mfma_f32_16x16x32_bf16 v[30:33], v[22:25], v[26:29], v[30:33]
 v_bitop3_b32 v34, v34, v22, v24 bitop3:0x80
 v_and_b32 v34, 1, v34
 v_cmp_ne_u32 vcc, 1, v34
 s_cbranch_vccz L_rok_165
 buffer_load_dwordx4 v[10:13], v0, s[4:7], s60 offen offset:0 sc1
 buffer_load_dwordx4 v[14:17], v0, s[4:7], s60 offen offset:1024 sc1
 buffer_load_dwordx4 v[18:21], v0, s[4:7], s60 offen offset:2048 sc1
 buffer_load_dwordx4 v[22:25], v0, s[4:7], s60 offen offset:3072 sc1
 s_add_u32 s51, s51, 1
 s_waitcnt vmcnt(7)
 v_mfma_f32_16x16x32_bf16 v[30:33], v[54:57], v[26:29], 0
 v_bitop3_b32 v34, v54, v56, v56 bitop3:0x80
 s_waitcnt vmcnt(6)
 v_mfma_f32_16x16x32_bf16 v[30:33], v[58:61], v[26:29], v[30:33]
 v_bitop3_b32 v34, v34, v58, v60 bitop3:0x80
 s_waitcnt vmcnt(5)
 v_mfma_f32_16x16x32_bf16 v[30:33], v[62:65], v[26:29], v[30:33]
 v_bitop3_b32 v34, v34, v62, v64 bitop3:0x80
 s_waitcnt vmcnt(4)
 v_mfma_f32_16x16x32_bf16 v[30:33], v[66:69], v[26:29], v[30:33]
 v_bitop3_b32 v34, v34, v66, v68 bitop3:0x80
 v_and_b32 v34, 1, v34
 v_cmp_ne_u32 vcc, 1, v34
 s_cbranch_vccz L_rok_165
 s_and_b32 s3, s51, 0xffff
 s_cmp_gt_u32 s3, 20000
 s_cbranch_scc0 L_rspin_164
 s_branch L_exit1
L_rok_165:
 s_nop 3
 v_permlane32_swap_b32 v30, v31
 v_permlane32_swap_b32 v32, v33
 v_add_f32 v30, v30, v31
 v_add_f32 v32, v32, v33
 v_cvt_pk_bf16_f32 v30, v30, v32
 v_or_b32 v30, 1, v30
 buffer_store_dword v30, v35, s[4:7], s61 offen sc1
 s_waitcnt vmcnt(1)
 s_branch L_rback_152
L_ma_155:
 s_add_u32 s51, s51, 1
 s_waitcnt vmcnt(3)
 v_bitop3_b32 v71, v18, v19, v20 bitop3:0x80
 v_bitop3_b32 v71, v71, v21, v21 bitop3:0x80
 s_waitcnt vmcnt(2)
 v_bitop3_b32 v71, v71, v22, v23 bitop3:0x80
 v_bitop3_b32 v71, v71, v24, v25 bitop3:0x80
 v_and_b32 v71, 1, v71
 v_cmp_ne_u32 vcc, 1, v71
 s_cbranch_vccz L_mahit_168
 buffer_load_dwordx4 v[10:13], v0, s[4:7], s24 offen offset:0 sc1
 buffer_load_dwordx4 v[14:17], v0, s[4:7], s24 offen offset:1024 sc1
L_marot_166:
 s_add_u32 s51, s51, 1
 s_waitcnt vmcnt(3)
 v_bitop3_b32 v71, v54, v55, v56 bitop3:0x80
 v_bitop3_b32 v71, v71, v57, v57 bitop3:0x80
 s_waitcnt vmcnt(2)
 v_bitop3_b32 v71, v71, v58, v59 bitop3:0x80
 v_bitop3_b32 v71, v71, v60, v61 bitop3:0x80
 v_and_b32 v71, 1, v71
 v_cmp_ne_u32 vcc, 1, v71
 s_cbranch_vccz L_mahit_169
 buffer_load_dwordx4 v[18:21], v0, s[4:7], s24 offen offset:0 sc1
 buffer_load_dwordx4 v[22:25], v0, s[4:7], s24 offen offset:1024 sc1
 s_add_u32 s51, s51, 1
 s_waitcnt vmcnt(3)
 v_bitop3_b32 v71, v10, v11, v12 bitop3:0x80
 v_bitop3_b32 v71, v71, v13, v13 bitop3:0x80
 s_waitcnt vmcnt(2)
 v_bitop3_b32 v71, v71, v14, v15 bitop3:0x80
 v_bitop3_b32 v71, v71, v16, v17 bitop3:0x80
 v_and_b32 v71, 1, v71
 v_cmp_ne_u32 vcc, 1, v71
 s_cbranch_vccz L_mahit_167
 buffer_load_dwordx4 v[54:57], v0, s[4:7], s24 offen offset:0 sc1
 buffer_load_dwordx4 v[58:61], v0, s[4:7], s24 offen offset:1024 sc1
 s_add_u32 s51, s51, 1
 s_waitcnt vmcnt(3)
 v_bitop3_b32 v71, v18, v19, v20 bitop3:0x80
 v_bitop3_b32 v71, v71, v21, v21 bitop3:0x80
 s_waitcnt vmcnt(2)
 v_bitop3_b32 v71, v71, v22, v23 bitop3:0x80
 v_bitop3_b32 v71, v71, v24, v25 bitop3:0x80
 v_and_b32 v71, 1, v71
 v_cmp_ne_u32 vcc, 1, v71
 s_cbranch_vccz L_mahit_168
 buffer_load_dwordx4 v[10:13], v0, s[4:7], s24 offen offset:0 sc1
 buffer_load_dwordx4 v[14:17], v0, s[4:7], s24 offen offset:1024 sc1
 s_add_u32 s51, s51, 1
 s_and_b32 s3, s51, 0xffff
 s_cmp_gt_u32 s3, 20000
 s_cbranch_scc0 L_marot_166
 s_branch L_exit1
L_mahit_167:
 ds_write_b128 v0, v[10:13] offset:0
 ds_write_b128 v0, v[14:17] offset:1024
 s_barrier
 s_waitcnt vmcnt(0)
 s_branch L_maok_153
L_mahit_168:
 ds_write_b128 v0, v[18:21] offset:0
 ds_write_b128 v0, v[22:25] offset:1024
 s_barrier
 s_branch L_maok_153
L_mahit_169:
 ds_write_b128 v0, v[54:57] offset:0
 ds_write_b128 v0, v[58:61] offset:1024
 s_barrier
 s_waitcnt vmcnt(0)
 s_branch L_maok_153
L_wave1_137:
 v_mov_b64 v[42:43], 0
 v_mov_b64 v[44:45], 0
 v_mov_b64 v[46:47], 0
 v_mov_b64 v[48:49], 0
 v_mov_b64 v[50:51], 0
 v_mov_b64 v[52:53], 0
 v_and_b32 v70, 0xf0, v0
 v_bfe_u32 v71, v0, 8, 2
 v_lshl_add_u32 v71, v71, 9, s67
 v_add_u32 v70, v70, v71
 v_add_u32 v9, 57344, v3
 ds_read_b128 v[26:29], v3 offset:0
 ds_read_b128 v[30:33], v3 offset:1024
 ds_read_b128 v[62:65], v3 offset:8192
 ds_read_b128 v[66:69], v3 offset:9216
 ds_read_b128 v[34:37], v3 offset:16384
 ds_read_b128 v[38:41], v3 offset:17408
 .p2align 6
L_loop_170:
 s_waitcnt lgkmcnt(0)
 s_barrier
 s_mov_b32 s51, 0
 ds_read_b128 v[10:13], v4 offset:0
 ds_read_b128 v[14:17], v4 offset:512
 ds_read_b128 v[18:21], v4 offset:1024
 s_add_u32 s72, s52, 16777216
 buffer_load_dwordx4 v[54:57], v70, s[4:7], s72 offen sc1
 buffer_load_dwordx4 v[58:61], v70, s[4:7], s72 offen offset:256 sc1
 s_waitcnt lgkmcnt(2)
 v_smfmac_f32_16x16x64_bf16 v[50:53], v[10:13], a[8:15], v1
 v_lshlrev_b32 v71, 2, v0
 v_smfmac_f32_16x16x64_bf16 v[42:45], v[10:13], v[72:79], v1
 ds_read_b128 v[22:25], v4 offset:1536
 v_smfmac_f32_16x16x64_bf16 v[46:49], v[10:13], v[80:87], v1
 s_mov_b32 m0, 4096
 s_cmp_eq_u32 s50, 0
 s_cbranch_scc1 L_mb2skip_172
 buffer_load_dwordx4 v0, s[4:7], s25 offen offset:0 sc1 lds
 buffer_load_dwordx4 v0, s[4:7], s25 offen offset:1024 sc1 lds
L_mb2skip_172:
 s_waitcnt lgkmcnt(2)
 v_smfmac_f32_16x16x64_bf16 v[50:53], v[14:17], a[16:23], v1
 v_smfmac_f32_16x16x64_bf16 v[42:45], v[14:17], v[88:95], v1
 ds_read_b128 v[10:13], v4 offset:2048
 v_smfmac_f32_16x16x64_bf16 v[46:49], v[14:17], v[26:33], v1
 ds_read_b128 v[26:29], v3 offset:24576
 s_add_u32 s73, s52, 524288
 s_min_u32 s73, s73, 16515072
 s_add_u32 s73, s73, s68
 s_waitcnt lgkmcnt(3)
 v_smfmac_f32_16x16x64_bf16 v[50:53], v[18:21], a[24:31], v1
 ds_read_b128 v[30:33], v3 offset:25600
 v_smfmac_f32_16x16x64_bf16 v[42:45], v[18:21], v[96:103], v1
 ds_read_b128 v[14:17], v4 offset:2560
 s_mov_b32 m0, 23936
 s_nop 0
 buffer_load_dword v71, s[4:7], s73 offen sc1 lds
 v_smfmac_f32_16x16x64_bf16 v[46:49], v[18:21], v[62:69], v1
 s_waitcnt vmcnt(5)
 ds_read_b128 v[62:65], v0 offset:4096
 ds_read_b128 v[66:69], v0 offset:5120
 s_waitcnt lgkmcnt(6)
 v_smfmac_f32_16x16x64_bf16 v[50:53], v[22:25], a[32:39], v1
 v_smfmac_f32_16x16x64_bf16 v[42:45], v[22:25], v[104:111], v1
 ds_read_b128 v[18:21], v4 offset:3072
 v_smfmac_f32_16x16x64_bf16 v[46:49], v[22:25], v[34:41], v1
 ds_read_b128 v[34:37], v3 offset:32768
 s_waitcnt lgkmcnt(7)
 v_smfmac_f32_16x16x64_bf16 v[50:53], v[10:13], a[40:47], v1
 ds_read_b128 v[38:41], v3 offset:33792
 v_smfmac_f32_16x16x64_bf16 v[42:45], v[10:13], v[112:119], v1
 s_waitcnt lgkmcnt(3)
 ds_read_b128 v[22:25], v4 offset:3584
 v_bitop3_b32 v62, v62, v63, v64 bitop3:0x80
 v_bitop3_b32 v62, v62, v65, v65 bitop3:0x80
 v_smfmac_f32_16x16x64_bf16 v[46:49], v[10:13], v[26:33], v1
 ds_read_b128 v[26:29], v3 offset:40960
 v_bitop3_b32 v62, v62, v66, v67 bitop3:0x80
 v_smfmac_f32_16x16x64_bf16 v[50:53], v[14:17], a[48:55], v1
 ds_read_b128 v[30:33], v3 offset:41984
 v_bitop3_b32 v62, v62, v68, v69 bitop3:0x80
 v_bitop3_b32 v62, v62, v62, s28 bitop3:0xf5
 v_smfmac_f32_16x16x64_bf16 v[42:45], v[14:17], v[120:127], v1
 v_and_b32 v62, 1, v62
 v_smfmac_f32_16x16x64_bf16 v[46:49], v[14:17], v[128:135], v1
 v_cmp_ne_u32 vcc, 1, v62
 s_waitcnt lgkmcnt(5)
 v_smfmac_f32_16x16x64_bf16 v[50:53], v[18:21], a[56:63], v1
 s_cbranch_vccnz L_mbre_174
L_mbok_173:
 s_barrier
 v_smfmac_f32_16x16x64_bf16 v[42:45], v[18:21], v[136:143], v1
 ds_read_b128 v[10:13], v4 offset:4096
 ds_read_b128 v[14:17], v4 offset:4608
 s_waitcnt lgkmcnt(5)
 v_smfmac_f32_16x16x64_bf16 v[46:49], v[18:21], v[34:41], v1
 ds_read_b128 v[34:37], v3 offset:49152
 s_waitcnt lgkmcnt(5)
 v_smfmac_f32_16x16x64_bf16 v[50:53], v[22:25], a[64:71], v1
 ds_read_b128 v[38:41], v3 offset:50176
 v_smfmac_f32_16x16x64_bf16 v[42:45], v[22:25], v[144:151], v1
 ds_read_b128 v[18:21], v4 offset:5120
 s_waitcnt lgkmcnt(5)
 v_smfmac_f32_16x16x64_bf16 v[46:49], v[22:25], v[26:33], v1
 ds_read_b128 v[26:29], v9 offset:0
 s_waitcnt lgkmcnt(5)
 v_smfmac_f32_16x16x64_bf16 v[50:53], v[10:13], a[72:79], v1
 ds_read_b128 v[30:33], v9 offset:1024
 v_smfmac_f32_16x16x64_bf16 v[42:45], v[10:13], v[152:159], v1
 ds_read_b128 v[22:25], v4 offset:5632
 v_smfmac_f32_16x16x64_bf16 v[46:49], v[10:13], v[160:167], v1
 s_waitcnt lgkmcnt(6)
 v_smfmac_f32_16x16x64_bf16 v[50:53], v[14:17], a[80:87], v1
 v_smfmac_f32_16x16x64_bf16 v[42:45], v[14:17], v[168:175], v1
 ds_read_b128 v[10:13], v4 offset:6144
 s_waitcnt lgkmcnt(5)
 v_smfmac_f32_16x16x64_bf16 v[46:49], v[14:17], v[34:41], v1
 ds_read_b128 v[34:37], v9 offset:8192
 s_waitcnt lgkmcnt(5)
 v_smfmac_f32_16x16x64_bf16 v[50:53], v[18:21], a[88:95], v1
 ds_read_b128 v[38:41], v9 offset:9216
 v_smfmac_f32_16x16x64_bf16 v[42:45], v[18:21], v[176:183], v1
 ds_read_b128 v[14:17], v4 offset:6656
 s_waitcnt lgkmcnt(5)
 v_smfmac_f32_16x16x64_bf16 v[46:49], v[18:21], v[26:33], v1
 ds_read_b128 v[26:29], v9 offset:16384
 s_waitcnt lgkmcnt(5)
 v_smfmac_f32_16x16x64_bf16 v[50:53], v[22:25], a[96:103], v1
 ds_read_b128 v[30:33], v9 offset:17408
 v_smfmac_f32_16x16x64_bf16 v[42:45], v[22:25], v[184:191], v1
 ds_read_b128 v[18:21], v4 offset:7168
 v_smfmac_f32_16x16x64_bf16 v[46:49], v[22:25], v[192:199], v1
 ds_read_b128 v[62:65], v9 offset:24576
 s_waitcnt lgkmcnt(7)
 v_smfmac_f32_16x16x64_bf16 v[42:45], v[10:13], v[200:207], v1
 ds_read_b128 v[66:69], v9 offset:25600
 ds_read_b128 v[22:25], v4 offset:7680
 s_waitcnt lgkmcnt(7)
 v_smfmac_f32_16x16x64_bf16 v[46:49], v[10:13], v[34:41], v1
 ds_read_b128 v[34:37], v9 offset:32768
 s_waitcnt lgkmcnt(7)
 v_smfmac_f32_16x16x64_bf16 v[42:45], v[14:17], v[208:215], v1
 ds_read_b128 v[38:41], v9 offset:33792
 ds_read_b128 v[10:13], v4 offset:8192
 s_waitcnt lgkmcnt(7)
 v_smfmac_f32_16x16x64_bf16 v[46:49], v[14:17], v[26:33], v1
 s_waitcnt lgkmcnt(6)
 v_smfmac_f32_16x16x64_bf16 v[42:45], v[18:21], v[216:223], v1
 ds_read_b128 v[14:17], v4 offset:8704
 s_waitcnt lgkmcnt(5)
 v_smfmac_f32_16x16x64_bf16 v[46:49], v[18:21], v[62:69], v1
 s_waitcnt lgkmcnt(4)
 v_smfmac_f32_16x16x64_bf16 v[42:45], v[22:25], v[224:231], v1
 ds_read_b128 v[18:21], v4 offset:6144
 s_waitcnt lgkmcnt(3)
 v_smfmac_f32_16x16x64_bf16 v[46:49], v[22:25], v[34:41], v1
 ds_read_b128 v[66:69], v0 offset:13568
 s_waitcnt lgkmcnt(3)
 v_smfmac_f32_16x16x64_bf16 v[42:45], v[10:13], v[232:239], v1
 ds_read_b128 v[22:25], v4 offset:6656
 v_smfmac_f32_16x16x64_bf16 v[46:49], v[10:13], v[240:247], v1
 ds_read_b128 v[26:29], v0 offset:15744
 ds_read_b128 v[30:33], v0 offset:17792
 s_waitcnt lgkmcnt(5)
 v_smfmac_f32_16x16x64_bf16 v[42:45], v[14:17], v[248:255], v1
 ds_read_b128 v[10:13], v4 offset:7168
 v_smfmac_f32_16x16x64_bf16 v[46:49], v[14:17], a[0:7], v1
 ds_read_b128 v[34:37], v0 offset:19840
 ds_read_b128 v[38:41], v0 offset:21888
 ds_read_b128 v[14:17], v4 offset:7680
 s_waitcnt lgkmcnt(8)
 v_smfmac_f32_16x16x64_bf16 v[50:53], v[18:21], a[104:111], v1
 s_nop 1
 s_waitcnt lgkmcnt(6)
 v_smfmac_f32_16x16x64_bf16 v[50:53], v[22:25], a[112:119], v1
 s_nop 2
 v_cvt_pk_bf16_f32 v62, v42, v43
 v_cvt_pk_bf16_f32 v63, v44, v45
 ds_write_b64 v5, v[62:63]
 v_cvt_pk_bf16_f32 v64, v46, v47
 v_cvt_pk_bf16_f32 v65, v48, v49
 ds_write_b64 v5, v[64:65] offset:2176
 ds_read_b128 v[42:45], v4 offset:8192
 ds_read_b128 v[46:49], v4 offset:8704
 s_waitcnt lgkmcnt(7)
 v_smfmac_f32_16x16x64_bf16 v[50:53], v[10:13], a[120:127], v1
 buffer_store_dwordx4 v[66:69], v0, s[4:7], s65 offen offset:0 sc1
 s_waitcnt lgkmcnt(4)
 v_smfmac_f32_16x16x64_bf16 v[50:53], v[14:17], a[128:135], v1
 s_waitcnt lgkmcnt(2)
 s_barrier
 ds_read_b64_tr_b16 v[10:11], v6 offset:0
 ds_read_b64_tr_b16 v[12:13], v6 offset:64
 ds_read_b64_tr_b16 v[14:15], v6 offset:256
 ds_read_b64_tr_b16 v[16:17], v6 offset:320
 s_waitcnt lgkmcnt(5)
 v_smfmac_f32_16x16x64_bf16 v[50:53], v[42:45], a[136:143], v1
 ds_read_b64_tr_b16 v[18:19], v6 offset:512
 ds_read_b64_tr_b16 v[20:21], v6 offset:576
 ds_read_b64_tr_b16 v[22:23], v6 offset:768
 ds_read_b64_tr_b16 v[24:25], v6 offset:832
 s_waitcnt lgkmcnt(8)
 v_smfmac_f32_16x16x64_bf16 v[50:53], v[46:49], a[144:151], v1
 s_waitcnt lgkmcnt(6)
 v_mfma_f32_16x16x32_bf16 v[42:45], v[26:29], v[10:13], 0
 ds_read_b128 v[26:29], v0 offset:16768
 v_mov_b32 v62, v2
 v_mov_b32 v63, v2
 s_waitcnt lgkmcnt(5)
 v_mfma_f32_16x16x32_bf16 v[42:45], v[30:33], v[14:17], v[42:45]
 ds_read_b128 v[30:33], v0 offset:18816
 v_mov_b32 v64, v2
 v_mov_b32 v65, v2
 s_waitcnt lgkmcnt(4)
 v_mfma_f32_16x16x32_bf16 v[42:45], v[34:37], v[18:21], v[42:45]
 ds_read_b128 v[34:37], v0 offset:20864
 s_waitcnt lgkmcnt(3)
 v_mfma_f32_16x16x32_bf16 v[42:45], v[38:41], v[22:25], v[42:45]
 ds_read_b128 v[38:41], v0 offset:22912
 v_mfma_f32_16x16x32_bf16 v[62:65], v[10:13], v[10:13], v[62:65]
 v_cvt_pk_bf16_f32 v68, v50, v51
 v_cvt_pk_bf16_f32 v69, v52, v53
 v_mfma_f32_16x16x32_bf16 v[62:65], v[14:17], v[14:17], v[62:65]
 ds_write_b64 v5, v[68:69] offset:4352
 v_mov_b64 v[66:67], v[68:69]
 v_mfma_f32_16x16x32_bf16 v[62:65], v[18:21], v[18:21], v[62:65]
 s_nop 0
 v_mul_f32 v42, s62, v42
 v_mul_f32 v43, s62, v43
 v_mfma_f32_16x16x32_bf16 v[62:65], v[22:25], v[22:25], v[62:65]
 v_permlane32_swap_b32 v66, v68
 v_permlane32_swap_b32 v67, v69
 s_waitcnt lgkmcnt(4)
 v_mfma_f32_16x16x32_bf16 v[46:49], v[26:29], v[10:13], 0
 v_mul_f32 v44, s62, v44
 v_mul_f32 v45, s62, v45
 s_waitcnt lgkmcnt(3)
 v_mfma_f32_16x16x32_bf16 v[46:49], v[30:33], v[14:17], v[46:49]
 v_max3_f32 v70, v42, v43, v44
 s_nop 0
 s_waitcnt lgkmcnt(2)
 v_mfma_f32_16x16x32_bf16 v[46:49], v[34:37], v[18:21], v[46:49]
 v_mul_f32 v62, s62, v62
 v_mul_f32 v63, s62, v63
 s_waitcnt lgkmcnt(1)
 v_mfma_f32_16x16x32_bf16 v[46:49], v[38:41], v[22:25], v[46:49]
 v_mul_f32 v64, s62, v64
 v_mul_f32 v65, s62, v65
 v_max3_f32 v70, v70, v45, v62
 v_max3_f32 v71, v63, v64, v65
 v_mov_b64 v[30:31], 0
 v_mov_b64 v[34:35], 0
 v_mov_b64 v[22:23], s[76:77]
 v_mov_b64 v[24:25], s[76:77]
 v_pk_mul_f32 v[46:47], v[46:47], s[62:63]
 v_pk_mul_f32 v[48:49], v[48:49], s[62:63]
 v_max3_f32 v70, v70, v71, v46
 v_max3_f32 v71, v47, v48, v49
 v_max_f32 v21, v70, v71
 v_max_f32 v70, v70, v71
 s_nop 1
 v_permlane16_swap_b32 v70, v21
 v_max_f32 v71, v70, v21
 v_max_f32 v70, v70, v21
 s_nop 1
 v_permlane32_swap_b32 v70, v71
 v_max_f32 v70, v70, v71
 v_pk_add_f32 v[42:43], v[42:43], v[70:71] op_sel_hi:[1,0] neg_lo:[0,1] neg_hi:[0,1]
 v_pk_add_f32 v[44:45], v[44:45], v[70:71] op_sel_hi:[1,0] neg_lo:[0,1] neg_hi:[0,1]
 v_pk_add_f32 v[46:47], v[46:47], v[70:71] op_sel_hi:[1,0] neg_lo:[0,1] neg_hi:[0,1]
 v_pk_add_f32 v[48:49], v[48:49], v[70:71] op_sel_hi:[1,0] neg_lo:[0,1] neg_hi:[0,1]
 v_pk_add_f32 v[62:63], v[62:63], v[70:71] op_sel_hi:[1,0] neg_lo:[0,1] neg_hi:[0,1]
 v_pk_add_f32 v[64:65], v[64:65], v[70:71] op_sel_hi:[1,0] neg_lo:[0,1] neg_hi:[0,1]
 v_exp_f32 v42, v42
 v_exp_f32 v43, v43
 v_exp_f32 v44, v44
 v_exp_f32 v45, v45
 v_exp_f32 v46, v46
 v_exp_f32 v47, v47
 v_exp_f32 v48, v48
 v_exp_f32 v49, v49
 v_exp_f32 v62, v62
 v_cvt_pk_bf16_f32 v26, v42, v43
 v_cvt_pk_bf16_f32 v27, v44, v45
 v_cvt_pk_bf16_f32 v28, v46, v47
 v_cvt_pk_bf16_f32 v29, v48, v49
 v_exp_f32 v63, v63
 s_waitcnt vmcnt(2)
 v_mfma_f32_16x16x32_bf16 v[10:13], v[22:25], v[26:29], 0
 v_exp_f32 v64, v64
 v_mfma_f32_16x16x32_bf16 v[14:17], v[54:57], v[26:29], 0
 v_exp_f32 v65, v65
 v_mfma_f32_16x16x32_bf16 v[36:39], v[58:61], v[26:29], 0
 v_cvt_pk_bf16_f32 v32, v62, v63
 v_cvt_pk_bf16_f32 v33, v64, v65
 s_nop 1
 v_mfma_f32_16x16x32_bf16 v[10:13], v[22:25], v[32:35], v[10:13]
 v_mfma_f32_16x16x32_bf16 v[14:17], v[66:69], v[32:35], v[14:17]
 v_mfma_f32_16x16x32_bf16 v[36:39], v[66:69], v[30:33], v[36:39]
 v_add_u32 v9, 98304, v3
 v_mov_b64 v[52:53], 0
 v_mov_b64 v[54:55], 0
 v_mov_b64 v[56:57], 0
 v_mov_b64 v[58:59], 0
 s_nop 0
 v_rcp_f32 v18, v10
 v_mov_b64 v[60:61], 0
 v_pk_mul_f32 v[14:15], v[14:15], v[18:19] op_sel_hi:[1,0]
 v_pk_mul_f32 v[16:17], v[16:17], v[18:19] op_sel_hi:[1,0]
 v_pk_mul_f32 v[36:37], v[36:37], v[18:19] op_sel_hi:[1,0]
 v_pk_mul_f32 v[38:39], v[38:39], v[18:19] op_sel_hi:[1,0]
 v_cvt_pk_bf16_f32 v22, v14, v15
 v_cvt_pk_bf16_f32 v23, v16, v17
 v_cvt_pk_bf16_f32 v24, v36, v37
 v_cvt_pk_bf16_f32 v25, v38, v39
 ds_write_b128 v7, v[22:25]
 s_add_u32 s50, s50, 1
 v_mov_b64 v[62:63], 0
 v_mov_b64 v[64:65], 0
 v_mov_b64 v[66:67], 0
 s_waitcnt lgkmcnt(0)
 s_barrier
 ds_read_b128 v[10:13], v4 offset:0
 ds_read_b128 v[14:17], v4 offset:512
 ds_read_b128 v[18:21], v4 offset:1024
 ds_read_b128 v[22:25], v4 offset:1536
 s_waitcnt lgkmcnt(3)
 v_smfmac_f32_16x16x64_bf16 v[52:55], v[10:13], a[152:159], v1
 s_waitcnt lgkmcnt(2)
 v_smfmac_f32_16x16x64_bf16 v[52:55], v[14:17], a[160:167], v1
 ds_read_b128 v[26:29], v9 offset:0
 ds_read_b128 v[30:33], v9 offset:1024
 s_waitcnt lgkmcnt(3)
 v_smfmac_f32_16x16x64_bf16 v[52:55], v[18:21], a[168:175], v1
 s_waitcnt lgkmcnt(2)
 v_smfmac_f32_16x16x64_bf16 v[52:55], v[22:25], a[176:183], v1
 ds_read_b128 v[34:37], v9 offset:8192
 ds_read_b128 v[38:41], v9 offset:9216
 v_smfmac_f32_16x16x64_bf16 v[56:59], v[10:13], a[184:191], v1
 s_nop 2
 v_smfmac_f32_16x16x64_bf16 v[56:59], v[14:17], a[192:199], v1
 ds_read_b128 v[42:45], v9 offset:16384
 ds_read_b128 v[46:49], v9 offset:17408
 s_nop 0
 v_smfmac_f32_16x16x64_bf16 v[56:59], v[18:21], a[200:207], v1
 v_cvt_pk_bf16_f32 v52, v52, v53
 v_smfmac_f32_16x16x64_bf16 v[56:59], v[22:25], a[208:215], v1
 v_cvt_pk_bf16_f32 v53, v54, v55
 v_smfmac_f32_16x16x64_bf16 v[60:63], v[10:13], a[216:223], v1
 s_nop 1
 v_and_b32 v52, -2, v52
 v_smfmac_f32_16x16x64_bf16 v[60:63], v[14:17], a[224:231], v1
 s_nop 2
 s_waitcnt lgkmcnt(4)
 v_smfmac_f32_16x16x64_bf16 v[60:63], v[18:21], v[26:33], v1
 v_cvt_pk_bf16_f32 v56, v56, v57
 v_smfmac_f32_16x16x64_bf16 v[60:63], v[22:25], a[232:239], v1
 v_cvt_pk_bf16_f32 v57, v58, v59
 s_waitcnt lgkmcnt(2)
 v_smfmac_f32_16x16x64_bf16 v[64:67], v[10:13], v[34:41], v1
 s_nop 0
 buffer_store_dwordx2 v[52:53], v8, s[4:7], s55 offen sc1
 v_and_b32 v56, -2, v56
 v_smfmac_f32_16x16x64_bf16 v[64:67], v[14:17], a[240:247], v1
 s_nop 2
 s_waitcnt lgkmcnt(0)
 v_smfmac_f32_16x16x64_bf16 v[64:67], v[18:21], v[42:49], v1
 v_cvt_pk_bf16_f32 v60, v60, v61
 v_smfmac_f32_16x16x64_bf16 v[64:67], v[22:25], a[248:255], v1
 v_cvt_pk_bf16_f32 v61, v62, v63
 buffer_store_dwordx2 v[56:57], v8, s[4:7], s56 offen sc1
 v_and_b32 v60, -2, v60
 buffer_store_dwordx2 v[60:61], v8, s[4:7], s57 offen sc1
 s_add_u32 s52, s52, 262144
 s_add_u32 s65, s65, s27
 s_mov_b64 s[28:29], -1
 s_sub_i32 s64, s50, s71
 s_mov_b32 s27, 131072
 v_cvt_pk_bf16_f32 v64, v64, v65
 v_cvt_pk_bf16_f32 v65, v66, v67
 v_and_b32 v64, -2, v64
 buffer_store_dwordx2 v[64:65], v8, s[4:7], s58 offen sc1
 s_barrier
 s_nop 15
 s_nop 15
 s_nop 15
 s_nop 7
 buffer_load_dwordx4 v[10:13], v0, s[4:7], s60 offen offset:0 sc1
 buffer_load_dwordx4 v[14:17], v0, s[4:7], s60 offen offset:1024 sc1
 buffer_load_dwordx4 v[18:21], v0, s[4:7], s60 offen offset:2048 sc1
 buffer_load_dwordx4 v[22:25], v0, s[4:7], s60 offen offset:3072 sc1
 v_and_b32 v34, 16, v0
 v_mov_b32 v30, 0x3f80
 v_lshlrev_b32 v30, v34, v30
 v_bfe_u32 v34, v0, 5, 3
 v_cmp_eq_u32 vcc, 0, v34
 s_nop 1
 v_cndmask_b32 v26, 0, v30, vcc
 v_cmp_eq_u32 vcc, 1, v34
 s_nop 1
 v_cndmask_b32 v27, 0, v30, vcc
 v_cmp_eq_u32 vcc, 2, v34
 s_nop 1
 v_cndmask_b32 v28, 0, v30, vcc
 v_cmp_eq_u32 vcc, 3, v34
 s_nop 1
 v_cndmask_b32 v29, 0, v30, vcc
 v_and_b32 v35, 0xf0, v0
 v_bfe_u32 v34, v0, 8, 2
 v_lshl_add_u32 v35, v34, 2, v35
 v_and_b32 v34, 0x80, v0
 v_lshl_add_u32 v35, v34, 23, v35
 v_mov_b64 v[42:43], 0
 v_mov_b64 v[44:45], 0
 v_mov_b64 v[46:47], 0
 v_mov_b64 v[48:49], 0
 v_mov_b64 v[50:51], 0
 v_mov_b64 v[52:53], 0
 v_and_b32 v70, 0xf0, v0
 v_bfe_u32 v71, v0, 8, 2
 v_lshl_add_u32 v71, v71, 9, s67
 v_add_u32 v70, v70, v71
 v_add_u32 v9, 57344, v3
 s_barrier
 s_waitcnt vmcnt(3)
 v_mfma_f32_16x16x32_bf16 v[30:33], v[10:13], v[26:29], 0
 v_bitop3_b32 v34, v10, v12, v12 bitop3:0xfe
 s_waitcnt vmcnt(2)
 v_mfma_f32_16x16x32_bf16 v[30:33], v[14:17], v[26:29], v[30:33]
 v_bitop3_b32 v34, v34, v14, v16 bitop3:0xfe
 s_waitcnt vmcnt(1)
 v_mfma_f32_16x16x32_bf16 v[30:33], v[18:21], v[26:29], v[30:33]
 v_bitop3_b32 v34, v34, v18, v20 bitop3:0xfe
 s_waitcnt vmcnt(0)
 v_mfma_f32_16x16x32_bf16 v[30:33], v[22:25], v[26:29], v[30:33]
 v_bitop3_b32 v34, v34, v22, v24 bitop3:0xfe
 v_and_b32 v34, 1, v34
 v_cmp_ne_u32 vcc, 0, v34
 s_cbranch_vccnz L_rre_177
 s_nop 3
 v_permlane32_swap_b32 v30, v31
 v_permlane32_swap_b32 v32, v33
 v_add_f32 v30, v30, v31
 v_add_f32 v32, v32, v33
 v_cvt_pk_bf16_f32 v30, v30, v32
 v_and_b32 v30, -2, v30
 buffer_store_dword v30, v35, s[4:7], s61 offen sc1
L_rback_178:
L_redj_176:
 ds_read_b128 v[26:29], v3 offset:0
 ds_read_b128 v[30:33], v3 offset:1024
 ds_read_b128 v[62:65], v3 offset:8192
 ds_read_b128 v[66:69], v3 offset:9216
 ds_read_b128 v[34:37], v3 offset:16384
 ds_read_b128 v[38:41], v3 offset:17408
 s_barrier
 s_mov_b32 m0, 4096
 s_nop 0
 buffer_load_dwordx4 v0, s[4:7], s25 offen offset:0 sc1 lds
 buffer_load_dwordx4 v0, s[4:7], s25 offen offset:1024 sc1 lds
 s_cmp_eq_u32 s50, 63
 s_cbranch_scc1 L_last_171
 s_waitcnt lgkmcnt(0)
 s_barrier
 s_mov_b32 s51, 0
 ds_read_b128 v[10:13], v4 offset:0
 ds_read_b128 v[14:17], v4 offset:512
 ds_read_b128 v[18:21], v4 offset:1024
 s_add_u32 s72, s52, 16777216
 buffer_load_dwordx4 v[54:57], v70, s[4:7], s72 offen sc1
 buffer_load_dwordx4 v[58:61], v70, s[4:7], s72 offen offset:256 sc1
 s_waitcnt lgkmcnt(2)
 v_smfmac_f32_16x16x64_bf16 v[50:53], v[10:13], a[8:15], v1
 v_lshlrev_b32 v71, 2, v0
 v_smfmac_f32_16x16x64_bf16 v[42:45], v[10:13], v[72:79], v1
 ds_read_b128 v[22:25], v4 offset:1536
 v_smfmac_f32_16x16x64_bf16 v[46:49], v[10:13], v[80:87], v1
 s_mov_b32 m0, 4096
 s_cmp_eq_u32 s50, 0
 s_cbranch_scc1 L_mb2skip_179
 buffer_load_dwordx4 v0, s[4:7], s25 offen offset:0 sc1 lds
 buffer_load_dwordx4 v0, s[4:7], s25 offen offset:1024 sc1 lds
L_mb2skip_179:
 s_waitcnt lgkmcnt(2)
 v_smfmac_f32_16x16x64_bf16 v[50:53], v[14:17], a[16:23], v1
 v_smfmac_f32_16x16x64_bf16 v[42:45], v[14:17], v[88:95], v1
 ds_read_b128 v[10:13], v4 offset:2048
 v_smfmac_f32_16x16x64_bf16 v[46:49], v[14:17], v[26:33], v1
 ds_read_b128 v[26:29], v3 offset:24576
 s_add_u32 s73, s52, 524288
 s_min_u32 s73, s73, 16515072
 s_add_u32 s73, s73, s68
 s_waitcnt lgkmcnt(3)
 v_smfmac_f32_16x16x64_bf16 v[50:53], v[18:21], a[24:31], v1
 ds_read_b128 v[30:33], v3 offset:25600
 v_smfmac_f32_16x16x64_bf16 v[42:45], v[18:21], v[96:103], v1
 ds_read_b128 v[14:17], v4 offset:2560
 s_mov_b32 m0, 23936
 s_nop 0
 buffer_load_dword v71, s[4:7], s73 offen sc1 lds
 v_smfmac_f32_16x16x64_bf16 v[46:49], v[18:21], v[62:69], v1
 s_waitcnt vmcnt(5)
 ds_read_b128 v[62:65], v0 offset:4096
 ds_read_b128 v[66:69], v0 offset:5120
 s_waitcnt lgkmcnt(6)
 v_smfmac_f32_16x16x64_bf16 v[50:53], v[22:25], a[32:39], v1
 v_smfmac_f32_16x16x64_bf16 v[42:45], v[22:25], v[104:111], v1
 ds_read_b128 v[18:21], v4 offset:3072
 v_smfmac_f32_16x16x64_bf16 v[46:49], v[22:25], v[34:41], v1
 ds_read_b128 v[34:37], v3 offset:32768
 s_waitcnt lgkmcnt(7)
 v_smfmac_f32_16x16x64_bf16 v[50:53], v[10:13], a[40:47], v1
 ds_read_b128 v[38:41], v3 offset:33792
 v_smfmac_f32_16x16x64_bf16 v[42:45], v[10:13], v[112:119], v1
 s_waitcnt lgkmcnt(3)
 ds_read_b128 v[22:25], v4 offset:3584
 v_bitop3_b32 v62, v62, v63, v64 bitop3:0xfe
 v_bitop3_b32 v62, v62, v65, v65 bitop3:0xfe
 v_smfmac_f32_16x16x64_bf16 v[46:49], v[10:13], v[26:33], v1
 ds_read_b128 v[26:29], v3 offset:40960
 v_bitop3_b32 v62, v62, v66, v67 bitop3:0xfe
 v_smfmac_f32_16x16x64_bf16 v[50:53], v[14:17], a[48:55], v1
 ds_read_b128 v[30:33], v3 offset:41984
 v_bitop3_b32 v62, v62, v68, v69 bitop3:0xfe
 v_bitop3_b32 v62, v62, v62, s28 bitop3:0xa0
 v_smfmac_f32_16x16x64_bf16 v[42:45], v[14:17], v[120:127], v1
 v_and_b32 v62, 1, v62
 v_smfmac_f32_16x16x64_bf16 v[46:49], v[14:17], v[128:135], v1
 v_cmp_ne_u32 vcc, 0, v62
 s_waitcnt lgkmcnt(5)
 v_smfmac_f32_16x16x64_bf16 v[50:53], v[18:21], a[56:63], v1
 s_cbranch_vccnz L_mbre_181
L_mbok_180:
 s_barrier
 v_smfmac_f32_16x16x64_bf16 v[42:45], v[18:21], v[136:143], v1
 ds_read_b128 v[10:13], v4 offset:4096
 ds_read_b128 v[14:17], v4 offset:4608
 s_waitcnt lgkmcnt(5)
 v_smfmac_f32_16x16x64_bf16 v[46:49], v[18:21], v[34:41], v1
 ds_read_b128 v[34:37], v3 offset:49152
 s_waitcnt lgkmcnt(5)
 v_smfmac_f32_16x16x64_bf16 v[50:53], v[22:25], a[64:71], v1
 ds_read_b128 v[38:41], v3 offset:50176
 v_smfmac_f32_16x16x64_bf16 v[42:45], v[22:25], v[144:151], v1
 ds_read_b128 v[18:21], v4 offset:5120
 s_waitcnt lgkmcnt(5)
 v_smfmac_f32_16x16x64_bf16 v[46:49], v[22:25], v[26:33], v1
 ds_read_b128 v[26:29], v9 offset:0
 s_waitcnt lgkmcnt(5)
 v_smfmac_f32_16x16x64_bf16 v[50:53], v[10:13], a[72:79], v1
 ds_read_b128 v[30:33], v9 offset:1024
 v_smfmac_f32_16x16x64_bf16 v[42:45], v[10:13], v[152:159], v1
 ds_read_b128 v[22:25], v4 offset:5632
 v_smfmac_f32_16x16x64_bf16 v[46:49], v[10:13], v[160:167], v1
 s_waitcnt lgkmcnt(6)
 v_smfmac_f32_16x16x64_bf16 v[50:53], v[14:17], a[80:87], v1
 v_smfmac_f32_16x16x64_bf16 v[42:45], v[14:17], v[168:175], v1
 ds_read_b128 v[10:13], v4 offset:6144
 s_waitcnt lgkmcnt(5)
 v_smfmac_f32_16x16x64_bf16 v[46:49], v[14:17], v[34:41], v1
 ds_read_b128 v[34:37], v9 offset:8192
 s_waitcnt lgkmcnt(5)
 v_smfmac_f32_16x16x64_bf16 v[50:53], v[18:21], a[88:95], v1
 ds_read_b128 v[38:41], v9 offset:9216
 v_smfmac_f32_16x16x64_bf16 v[42:45], v[18:21], v[176:183], v1
 ds_read_b128 v[14:17], v4 offset:6656
 s_waitcnt lgkmcnt(5)
 v_smfmac_f32_16x16x64_bf16 v[46:49], v[18:21], v[26:33], v1
 ds_read_b128 v[26:29], v9 offset:16384
 s_waitcnt lgkmcnt(5)
 v_smfmac_f32_16x16x64_bf16 v[50:53], v[22:25], a[96:103], v1
 ds_read_b128 v[30:33], v9 offset:17408
 v_smfmac_f32_16x16x64_bf16 v[42:45], v[22:25], v[184:191], v1
 ds_read_b128 v[18:21], v4 offset:7168
 v_smfmac_f32_16x16x64_bf16 v[46:49], v[22:25], v[192:199], v1
 ds_read_b128 v[62:65], v9 offset:24576
 s_waitcnt lgkmcnt(7)
 v_smfmac_f32_16x16x64_bf16 v[42:45], v[10:13], v[200:207], v1
 ds_read_b128 v[66:69], v9 offset:25600
 ds_read_b128 v[22:25], v4 offset:7680
 s_waitcnt lgkmcnt(7)
 v_smfmac_f32_16x16x64_bf16 v[46:49], v[10:13], v[34:41], v1
 ds_read_b128 v[34:37], v9 offset:32768
 s_waitcnt lgkmcnt(7)
 v_smfmac_f32_16x16x64_bf16 v[42:45], v[14:17], v[208:215], v1
 ds_read_b128 v[38:41], v9 offset:33792
 ds_read_b128 v[10:13], v4 offset:8192
 s_waitcnt lgkmcnt(7)
 v_smfmac_f32_16x16x64_bf16 v[46:49], v[14:17], v[26:33], v1
 s_waitcnt lgkmcnt(6)
 v_smfmac_f32_16x16x64_bf16 v[42:45], v[18:21], v[216:223], v1
 ds_read_b128 v[14:17], v4 offset:8704
 s_waitcnt lgkmcnt(5)
 v_smfmac_f32_16x16x64_bf16 v[46:49], v[18:21], v[62:69], v1
 s_waitcnt lgkmcnt(4)
 v_smfmac_f32_16x16x64_bf16 v[42:45], v[22:25], v[224:231], v1
 ds_read_b128 v[18:21], v4 offset:6144
 s_waitcnt lgkmcnt(3)
 v_smfmac_f32_16x16x64_bf16 v[46:49], v[22:25], v[34:41], v1
 ds_read_b128 v[66:69], v0 offset:13568
 s_waitcnt lgkmcnt(3)
 v_smfmac_f32_16x16x64_bf16 v[42:45], v[10:13], v[232:239], v1
 ds_read_b128 v[22:25], v4 offset:6656
 v_smfmac_f32_16x16x64_bf16 v[46:49], v[10:13], v[240:247], v1
 ds_read_b128 v[26:29], v0 offset:15744
 ds_read_b128 v[30:33], v0 offset:17792
 s_waitcnt lgkmcnt(5)
 v_smfmac_f32_16x16x64_bf16 v[42:45], v[14:17], v[248:255], v1
 ds_read_b128 v[10:13], v4 offset:7168
 v_smfmac_f32_16x16x64_bf16 v[46:49], v[14:17], a[0:7], v1
 ds_read_b128 v[34:37], v0 offset:19840
 ds_read_b128 v[38:41], v0 offset:21888
 ds_read_b128 v[14:17], v4 offset:7680
 s_waitcnt lgkmcnt(8)
 v_smfmac_f32_16x16x64_bf16 v[50:53], v[18:21], a[104:111], v1
 s_nop 1
 s_waitcnt lgkmcnt(6)
 v_smfmac_f32_16x16x64_bf16 v[50:53], v[22:25], a[112:119], v1
 s_nop 2
 v_cvt_pk_bf16_f32 v62, v42, v43
 v_cvt_pk_bf16_f32 v63, v44, v45
 ds_write_b64 v5, v[62:63]
 v_cvt_pk_bf16_f32 v64, v46, v47
 v_cvt_pk_bf16_f32 v65, v48, v49
 ds_write_b64 v5, v[64:65] offset:2176
 ds_read_b128 v[42:45], v4 offset:8192
 ds_read_b128 v[46:49], v4 offset:8704
 s_waitcnt lgkmcnt(7)
 v_smfmac_f32_16x16x64_bf16 v[50:53], v[10:13], a[120:127], v1
 buffer_store_dwordx4 v[66:69], v0, s[4:7], s65 offen offset:0 sc1
 s_waitcnt lgkmcnt(4)
 v_smfmac_f32_16x16x64_bf16 v[50:53], v[14:17], a[128:135], v1
 s_waitcnt lgkmcnt(2)
 s_barrier
 ds_read_b64_tr_b16 v[10:11], v6 offset:0
 ds_read_b64_tr_b16 v[12:13], v6 offset:64
 ds_read_b64_tr_b16 v[14:15], v6 offset:256
 ds_read_b64_tr_b16 v[16:17], v6 offset:320
 s_waitcnt lgkmcnt(5)
 v_smfmac_f32_16x16x64_bf16 v[50:53], v[42:45], a[136:143], v1
 ds_read_b64_tr_b16 v[18:19], v6 offset:512
 ds_read_b64_tr_b16 v[20:21], v6 offset:576
 ds_read_b64_tr_b16 v[22:23], v6 offset:768
 ds_read_b64_tr_b16 v[24:25], v6 offset:832
 s_waitcnt lgkmcnt(8)
 v_smfmac_f32_16x16x64_bf16 v[50:53], v[46:49], a[144:151], v1
 s_waitcnt lgkmcnt(6)
 v_mfma_f32_16x16x32_bf16 v[42:45], v[26:29], v[10:13], 0
 ds_read_b128 v[26:29], v0 offset:16768
 v_mov_b32 v62, v2
 v_mov_b32 v63, v2
 s_waitcnt lgkmcnt(5)
 v_mfma_f32_16x16x32_bf16 v[42:45], v[30:33], v[14:17], v[42:45]
 ds_read_b128 v[30:33], v0 offset:18816
 v_mov_b32 v64, v2
 v_mov_b32 v65, v2
 s_waitcnt lgkmcnt(4)
 v_mfma_f32_16x16x32_bf16 v[42:45], v[34:37], v[18:21], v[42:45]
 ds_read_b128 v[34:37], v0 offset:20864
 s_waitcnt lgkmcnt(3)
 v_mfma_f32_16x16x32_bf16 v[42:45], v[38:41], v[22:25], v[42:45]
 ds_read_b128 v[38:41], v0 offset:22912
 v_mfma_f32_16x16x32_bf16 v[62:65], v[10:13], v[10:13], v[62:65]
 v_cvt_pk_bf16_f32 v68, v50, v51
 v_cvt_pk_bf16_f32 v69, v52, v53
 v_mfma_f32_16x16x32_bf16 v[62:65], v[14:17], v[14:17], v[62:65]
 ds_write_b64 v5, v[68:69] offset:4352
 v_mov_b64 v[66:67], v[68:69]
 v_mfma_f32_16x16x32_bf16 v[62:65], v[18:21], v[18:21], v[62:65]
 s_nop 0
 v_mul_f32 v42, s62, v42
 v_mul_f32 v43, s62, v43
 v_mfma_f32_16x16x32_bf16 v[62:65], v[22:25], v[22:25], v[62:65]
 v_permlane32_swap_b32 v66, v68
 v_permlane32_swap_b32 v67, v69
 s_waitcnt lgkmcnt(4)
 v_mfma_f32_16x16x32_bf16 v[46:49], v[26:29], v[10:13], 0
 v_mul_f32 v44, s62, v44
 v_mul_f32 v45, s62, v45
 s_waitcnt lgkmcnt(3)
 v_mfma_f32_16x16x32_bf16 v[46:49], v[30:33], v[14:17], v[46:49]
 v_max3_f32 v70, v42, v43, v44
 s_nop 0
 s_waitcnt lgkmcnt(2)
 v_mfma_f32_16x16x32_bf16 v[46:49], v[34:37], v[18:21], v[46:49]
 v_mul_f32 v62, s62, v62
 v_mul_f32 v63, s62, v63
 s_waitcnt lgkmcnt(1)
 v_mfma_f32_16x16x32_bf16 v[46:49], v[38:41], v[22:25], v[46:49]
 v_mul_f32 v64, s62, v64
 v_mul_f32 v65, s62, v65
 v_max3_f32 v70, v70, v45, v62
 v_max3_f32 v71, v63, v64, v65
 v_mov_b64 v[30:31], 0
 v_mov_b64 v[34:35], 0
 v_mov_b64 v[22:23], s[76:77]
 v_mov_b64 v[24:25], s[76:77]
 v_pk_mul_f32 v[46:47], v[46:47], s[62:63]
 v_pk_mul_f32 v[48:49], v[48:49], s[62:63]
 v_max3_f32 v70, v70, v71, v46
 v_max3_f32 v71, v47, v48, v49
 v_max_f32 v21, v70, v71
 v_max_f32 v70, v70, v71
 s_nop 1
 v_permlane16_swap_b32 v70, v21
 v_max_f32 v71, v70, v21
 v_max_f32 v70, v70, v21
 s_nop 1
 v_permlane32_swap_b32 v70, v71
 v_max_f32 v70, v70, v71
 v_pk_add_f32 v[42:43], v[42:43], v[70:71] op_sel_hi:[1,0] neg_lo:[0,1] neg_hi:[0,1]
 v_pk_add_f32 v[44:45], v[44:45], v[70:71] op_sel_hi:[1,0] neg_lo:[0,1] neg_hi:[0,1]
 v_pk_add_f32 v[46:47], v[46:47], v[70:71] op_sel_hi:[1,0] neg_lo:[0,1] neg_hi:[0,1]
 v_pk_add_f32 v[48:49], v[48:49], v[70:71] op_sel_hi:[1,0] neg_lo:[0,1] neg_hi:[0,1]
 v_pk_add_f32 v[62:63], v[62:63], v[70:71] op_sel_hi:[1,0] neg_lo:[0,1] neg_hi:[0,1]
 v_pk_add_f32 v[64:65], v[64:65], v[70:71] op_sel_hi:[1,0] neg_lo:[0,1] neg_hi:[0,1]
 v_exp_f32 v42, v42
 v_exp_f32 v43, v43
 v_exp_f32 v44, v44
 v_exp_f32 v45, v45
 v_exp_f32 v46, v46
 v_exp_f32 v47, v47
 v_exp_f32 v48, v48
 v_exp_f32 v49, v49
 v_exp_f32 v62, v62
 v_cvt_pk_bf16_f32 v26, v42, v43
 v_cvt_pk_bf16_f32 v27, v44, v45
 v_cvt_pk_bf16_f32 v28, v46, v47
 v_cvt_pk_bf16_f32 v29, v48, v49
 v_exp_f32 v63, v63
 s_waitcnt vmcnt(2)
 v_mfma_f32_16x16x32_bf16 v[10:13], v[22:25], v[26:29], 0
 v_exp_f32 v64, v64
 v_mfma_f32_16x16x32_bf16 v[14:17], v[54:57], v[26:29], 0
 v_exp_f32 v65, v65
 v_mfma_f32_16x16x32_bf16 v[36:39], v[58:61], v[26:29], 0
 v_cvt_pk_bf16_f32 v32, v62, v63
 v_cvt_pk_bf16_f32 v33, v64, v65
 s_nop 1
 v_mfma_f32_16x16x32_bf16 v[10:13], v[22:25], v[32:35], v[10:13]
 v_mfma_f32_16x16x32_bf16 v[14:17], v[66:69], v[32:35], v[14:17]
 v_mfma_f32_16x16x32_bf16 v[36:39], v[66:69], v[30:33], v[36:39]
 v_add_u32 v9, 98304, v3
 v_mov_b64 v[52:53], 0
 v_mov_b64 v[54:55], 0
 v_mov_b64 v[56:57], 0
 v_mov_b64 v[58:59], 0
 s_nop 0
 v_rcp_f32 v18, v10
 v_mov_b64 v[60:61], 0
 v_pk_mul_f32 v[14:15], v[14:15], v[18:19] op_sel_hi:[1,0]
 v_pk_mul_f32 v[16:17], v[16:17], v[18:19] op_sel_hi:[1,0]
 v_pk_mul_f32 v[36:37], v[36:37], v[18:19] op_sel_hi:[1,0]
 v_pk_mul_f32 v[38:39], v[38:39], v[18:19] op_sel_hi:[1,0]
 v_cvt_pk_bf16_f32 v22, v14, v15
 v_cvt_pk_bf16_f32 v23, v16, v17
 v_cvt_pk_bf16_f32 v24, v36, v37
 v_cvt_pk_bf16_f32 v25, v38, v39
 ds_write_b128 v7, v[22:25]
 s_add_u32 s50, s50, 1
 v_mov_b64 v[62:63], 0
 v_mov_b64 v[64:65], 0
 v_mov_b64 v[66:67], 0
 s_waitcnt lgkmcnt(0)
 s_barrier
 ds_read_b128 v[10:13], v4 offset:0
 ds_read_b128 v[14:17], v4 offset:512
 ds_read_b128 v[18:21], v4 offset:1024
 ds_read_b128 v[22:25], v4 offset:1536
 s_waitcnt lgkmcnt(3)
 v_smfmac_f32_16x16x64_bf16 v[52:55], v[10:13], a[152:159], v1
 s_waitcnt lgkmcnt(2)
 v_smfmac_f32_16x16x64_bf16 v[52:55], v[14:17], a[160:167], v1
 ds_read_b128 v[26:29], v9 offset:0
 ds_read_b128 v[30:33], v9 offset:1024
 s_waitcnt lgkmcnt(3)
 v_smfmac_f32_16x16x64_bf16 v[52:55], v[18:21], a[168:175], v1
 s_waitcnt lgkmcnt(2)
 v_smfmac_f32_16x16x64_bf16 v[52:55], v[22:25], a[176:183], v1
 ds_read_b128 v[34:37], v9 offset:8192
 ds_read_b128 v[38:41], v9 offset:9216
 v_smfmac_f32_16x16x64_bf16 v[56:59], v[10:13], a[184:191], v1
 s_nop 2
 v_smfmac_f32_16x16x64_bf16 v[56:59], v[14:17], a[192:199], v1
 ds_read_b128 v[42:45], v9 offset:16384
 ds_read_b128 v[46:49], v9 offset:17408
 s_nop 0
 v_smfmac_f32_16x16x64_bf16 v[56:59], v[18:21], a[200:207], v1
 v_cvt_pk_bf16_f32 v52, v52, v53
 v_smfmac_f32_16x16x64_bf16 v[56:59], v[22:25], a[208:215], v1
 v_cvt_pk_bf16_f32 v53, v54, v55
 v_smfmac_f32_16x16x64_bf16 v[60:63], v[10:13], a[216:223], v1
 s_nop 1
 v_or_b32 v52, 1, v52
 v_smfmac_f32_16x16x64_bf16 v[60:63], v[14:17], a[224:231], v1
 s_nop 2
 s_waitcnt lgkmcnt(4)
 v_smfmac_f32_16x16x64_bf16 v[60:63], v[18:21], v[26:33], v1
 v_cvt_pk_bf16_f32 v56, v56, v57
 v_smfmac_f32_16x16x64_bf16 v[60:63], v[22:25], a[232:239], v1
 v_cvt_pk_bf16_f32 v57, v58, v59
 s_waitcnt lgkmcnt(2)
 v_smfmac_f32_16x16x64_bf16 v[64:67], v[10:13], v[34:41], v1
 s_nop 0
 buffer_store_dwordx2 v[52:53], v8, s[4:7], s55 offen sc1
 v_or_b32 v56, 1, v56
 v_smfmac_f32_16x16x64_bf16 v[64:67], v[14:17], a[240:247], v1
 s_nop 2
 s_waitcnt lgkmcnt(0)
 v_smfmac_f32_16x16x64_bf16 v[64:67], v[18:21], v[42:49], v1
 v_cvt_pk_bf16_f32 v60, v60, v61
 v_smfmac_f32_16x16x64_bf16 v[64:67], v[22:25], a[248:255], v1
 v_cvt_pk_bf16_f32 v61, v62, v63
 buffer_store_dwordx2 v[56:57], v8, s[4:7], s56 offen sc1
 v_or_b32 v60, 1, v60
 buffer_store_dwordx2 v[60:61], v8, s[4:7], s57 offen sc1
 s_add_u32 s52, s52, 262144
 s_add_u32 s65, s65, s27
 s_mov_b64 s[28:29], -1
 s_sub_i32 s64, s50, s71
 s_mov_b32 s27, 131072
 v_cvt_pk_bf16_f32 v64, v64, v65
 v_cvt_pk_bf16_f32 v65, v66, v67
 v_or_b32 v64, 1, v64
 buffer_store_dwordx2 v[64:65], v8, s[4:7], s58 offen sc1
 s_barrier
 s_nop 15
 s_nop 15
 s_nop 15
 s_nop 7
 buffer_load_dwordx4 v[10:13], v0, s[4:7], s60 offen offset:0 sc1
 buffer_load_dwordx4 v[14:17], v0, s[4:7], s60 offen offset:1024 sc1
 buffer_load_dwordx4 v[18:21], v0, s[4:7], s60 offen offset:2048 sc1
 buffer_load_dwordx4 v[22:25], v0, s[4:7], s60 offen offset:3072 sc1
 v_and_b32 v34, 16, v0
 v_mov_b32 v30, 0x3f80
 v_lshlrev_b32 v30, v34, v30
 v_bfe_u32 v34, v0, 5, 3
 v_cmp_eq_u32 vcc, 0, v34
 s_nop 1
 v_cndmask_b32 v26, 0, v30, vcc
 v_cmp_eq_u32 vcc, 1, v34
 s_nop 1
 v_cndmask_b32 v27, 0, v30, vcc
 v_cmp_eq_u32 vcc, 2, v34
 s_nop 1
 v_cndmask_b32 v28, 0, v30, vcc
 v_cmp_eq_u32 vcc, 3, v34
 s_nop 1
 v_cndmask_b32 v29, 0, v30, vcc
 v_and_b32 v35, 0xf0, v0
 v_bfe_u32 v34, v0, 8, 2
 v_lshl_add_u32 v35, v34, 2, v35
 v_and_b32 v34, 0x80, v0
 v_lshl_add_u32 v35, v34, 23, v35
 v_mov_b64 v[42:43], 0
 v_mov_b64 v[44:45], 0
 v_mov_b64 v[46:47], 0
 v_mov_b64 v[48:49], 0
 v_mov_b64 v[50:51], 0
 v_mov_b64 v[52:53], 0
 v_and_b32 v70, 0xf0, v0
 v_bfe_u32 v71, v0, 8, 2
 v_lshl_add_u32 v71, v71, 9, s67
 v_add_u32 v70, v70, v71
 v_add_u32 v9, 57344, v3
 s_barrier
 s_waitcnt vmcnt(3)
 v_mfma_f32_16x16x32_bf16 v[30:33], v[10:13], v[26:29], 0
 v_bitop3_b32 v34, v10, v12, v12 bitop3:0x80
 s_waitcnt vmcnt(2)
 v_mfma_f32_16x16x32_bf16 v[30:33], v[14:17], v[26:29], v[30:33]
 v_bitop3_b32 v34, v34, v14, v16 bitop3:0x80
 s_waitcnt vmcnt(1)
 v_mfma_f32_16x16x32_bf16 v[30:33], v[18:21], v[26:29], v[30:33]
 v_bitop3_b32 v34, v34, v18, v20 bitop3:0x80
 s_waitcnt vmcnt(0)
 v_mfma_f32_16x16x32_bf16 v[30:33], v[22:25], v[26:29], v[30:33]
 v_bitop3_b32 v34, v34, v22, v24 bitop3:0x80
 v_and_b32 v34, 1, v34
 v_cmp_ne_u32 vcc, 1, v34
 s_cbranch_vccnz L_rre_184
 s_nop 3
 v_permlane32_swap_b32 v30, v31
 v_permlane32_swap_b32 v32, v33
 v_add_f32 v30, v30, v31
 v_add_f32 v32, v32, v33
 v_cvt_pk_bf16_f32 v30, v30, v32
 v_or_b32 v30, 1, v30
 buffer_store_dword v30, v35, s[4:7], s61 offen sc1
L_rback_185:
L_redj_183:
 ds_read_b128 v[26:29], v3 offset:0
 ds_read_b128 v[30:33], v3 offset:1024
 ds_read_b128 v[62:65], v3 offset:8192
 ds_read_b128 v[66:69], v3 offset:9216
 ds_read_b128 v[34:37], v3 offset:16384
 ds_read_b128 v[38:41], v3 offset:17408
 s_barrier
 s_mov_b32 m0, 4096
 s_nop 0
 buffer_load_dwordx4 v0, s[4:7], s25 offen offset:0 sc1 lds
 buffer_load_dwordx4 v0, s[4:7], s25 offen offset:1024 sc1 lds
 s_branch L_loop_170
L_last_171:
 s_waitcnt lgkmcnt(0)
 s_barrier
 ds_read_b128 v[10:13], v4 offset:0
 ds_read_b128 v[14:17], v4 offset:512
 ds_read_b128 v[18:21], v4 offset:1024
 s_waitcnt lgkmcnt(2)
 v_smfmac_f32_16x16x64_bf16 v[50:53], v[10:13], a[8:15], v1
 v_smfmac_f32_16x16x64_bf16 v[42:45], v[10:13], v[72:79], v1
 ds_read_b128 v[22:25], v4 offset:1536
 v_smfmac_f32_16x16x64_bf16 v[46:49], v[10:13], v[80:87], v1
 s_mov_b32 m0, 4096
 s_cmp_eq_u32 s50, 0
 s_cbranch_scc1 L_mb2skip_186
 buffer_load_dwordx4 v0, s[4:7], s25 offen offset:0 sc1 lds
 buffer_load_dwordx4 v0, s[4:7], s25 offen offset:1024 sc1 lds
L_mb2skip_186:
 s_waitcnt lgkmcnt(2)
 v_smfmac_f32_16x16x64_bf16 v[50:53], v[14:17], a[16:23], v1
 v_smfmac_f32_16x16x64_bf16 v[42:45], v[14:17], v[88:95], v1
 ds_read_b128 v[10:13], v4 offset:2048
 v_smfmac_f32_16x16x64_bf16 v[46:49], v[14:17], v[26:33], v1
 ds_read_b128 v[26:29], v3 offset:24576
 s_waitcnt lgkmcnt(3)
 v_smfmac_f32_16x16x64_bf16 v[50:53], v[18:21], a[24:31], v1
 ds_read_b128 v[30:33], v3 offset:25600
 v_smfmac_f32_16x16x64_bf16 v[42:45], v[18:21], v[96:103], v1
 ds_read_b128 v[14:17], v4 offset:2560
 v_smfmac_f32_16x16x64_bf16 v[46:49], v[18:21], v[62:69], v1
 s_waitcnt vmcnt(2)
 ds_read_b128 v[62:65], v0 offset:4096
 ds_read_b128 v[66:69], v0 offset:5120
 s_waitcnt lgkmcnt(6)
 v_smfmac_f32_16x16x64_bf16 v[50:53], v[22:25], a[32:39], v1
 v_smfmac_f32_16x16x64_bf16 v[42:45], v[22:25], v[104:111], v1
 ds_read_b128 v[18:21], v4 offset:3072
 v_smfmac_f32_16x16x64_bf16 v[46:49], v[22:25], v[34:41], v1
 ds_read_b128 v[34:37], v3 offset:32768
 s_waitcnt lgkmcnt(7)
 v_smfmac_f32_16x16x64_bf16 v[50:53], v[10:13], a[40:47], v1
 ds_read_b128 v[38:41], v3 offset:33792
 v_smfmac_f32_16x16x64_bf16 v[42:45], v[10:13], v[112:119], v1
 s_waitcnt lgkmcnt(3)
 ds_read_b128 v[22:25], v4 offset:3584
 v_bitop3_b32 v62, v62, v63, v64 bitop3:0xfe
 v_bitop3_b32 v62, v62, v65, v65 bitop3:0xfe
 v_smfmac_f32_16x16x64_bf16 v[46:49], v[10:13], v[26:33], v1
 ds_read_b128 v[26:29], v3 offset:40960
 v_bitop3_b32 v62, v62, v66, v67 bitop3:0xfe
 v_smfmac_f32_16x16x64_bf16 v[50:53], v[14:17], a[48:55], v1
 ds_read_b128 v[30:33], v3 offset:41984
 v_bitop3_b32 v62, v62, v68, v69 bitop3:0xfe
 v_bitop3_b32 v62, v62, v62, s28 bitop3:0xa0
 v_smfmac_f32_16x16x64_bf16 v[42:45], v[14:17], v[120:127], v1
 v_and_b32 v62, 1, v62
 v_smfmac_f32_16x16x64_bf16 v[46:49], v[14:17], v[128:135], v1
 v_cmp_ne_u32 vcc, 0, v62
 s_waitcnt lgkmcnt(5)
 v_smfmac_f32_16x16x64_bf16 v[50:53], v[18:21], a[56:63], v1
 s_cbranch_vccnz L_mbre_188
L_mbok_187:
 s_barrier
 v_smfmac_f32_16x16x64_bf16 v[42:45], v[18:21], v[136:143], v1
 ds_read_b128 v[10:13], v4 offset:4096
 ds_read_b128 v[14:17], v4 offset:4608
 s_waitcnt lgkmcnt(5)
 v_smfmac_f32_16x16x64_bf16 v[46:49], v[18:21], v[34:41], v1
 ds_read_b128 v[34:37], v3 offset:49152
 s_waitcnt lgkmcnt(5)
 v_smfmac_f32_16x16x64_bf16 v[50:53], v[22:25], a[64:71], v1
 ds_read_b128 v[38:41], v3 offset:50176
 v_smfmac_f32_16x16x64_bf16 v[42:45], v[22:25], v[144:151], v1
 ds_read_b128 v[18:21], v4 offset:5120
 s_waitcnt lgkmcnt(5)
 v_smfmac_f32_16x16x64_bf16 v[46:49], v[22:25], v[26:33], v1
 ds_read_b128 v[26:29], v9 offset:0
 s_waitcnt lgkmcnt(5)
 v_smfmac_f32_16x16x64_bf16 v[50:53], v[10:13], a[72:79], v1
 ds_read_b128 v[30:33], v9 offset:1024
 v_smfmac_f32_16x16x64_bf16 v[42:45], v[10:13], v[152:159], v1
 ds_read_b128 v[22:25], v4 offset:5632
 v_smfmac_f32_16x16x64_bf16 v[46:49], v[10:13], v[160:167], v1
 s_waitcnt lgkmcnt(6)
 v_smfmac_f32_16x16x64_bf16 v[50:53], v[14:17], a[80:87], v1
 v_smfmac_f32_16x16x64_bf16 v[42:45], v[14:17], v[168:175], v1
 ds_read_b128 v[10:13], v4 offset:6144
 s_waitcnt lgkmcnt(5)
 v_smfmac_f32_16x16x64_bf16 v[46:49], v[14:17], v[34:41], v1
 ds_read_b128 v[34:37], v9 offset:8192
 s_waitcnt lgkmcnt(5)
 v_smfmac_f32_16x16x64_bf16 v[50:53], v[18:21], a[88:95], v1
 ds_read_b128 v[38:41], v9 offset:9216
 v_smfmac_f32_16x16x64_bf16 v[42:45], v[18:21], v[176:183], v1
 ds_read_b128 v[14:17], v4 offset:6656
 s_waitcnt lgkmcnt(5)
 v_smfmac_f32_16x16x64_bf16 v[46:49], v[18:21], v[26:33], v1
 ds_read_b128 v[26:29], v9 offset:16384
 s_waitcnt lgkmcnt(5)
 v_smfmac_f32_16x16x64_bf16 v[50:53], v[22:25], a[96:103], v1
 ds_read_b128 v[30:33], v9 offset:17408
 v_smfmac_f32_16x16x64_bf16 v[42:45], v[22:25], v[184:191], v1
 ds_read_b128 v[18:21], v4 offset:7168
 v_smfmac_f32_16x16x64_bf16 v[46:49], v[22:25], v[192:199], v1
 ds_read_b128 v[62:65], v9 offset:24576
 s_waitcnt lgkmcnt(7)
 v_smfmac_f32_16x16x64_bf16 v[42:45], v[10:13], v[200:207], v1
 ds_read_b128 v[66:69], v9 offset:25600
 ds_read_b128 v[22:25], v4 offset:7680
 s_waitcnt lgkmcnt(7)
 v_smfmac_f32_16x16x64_bf16 v[46:49], v[10:13], v[34:41], v1
 ds_read_b128 v[34:37], v9 offset:32768
 s_waitcnt lgkmcnt(7)
 v_smfmac_f32_16x16x64_bf16 v[42:45], v[14:17], v[208:215], v1
 ds_read_b128 v[38:41], v9 offset:33792
 ds_read_b128 v[10:13], v4 offset:8192
 s_waitcnt lgkmcnt(7)
 v_smfmac_f32_16x16x64_bf16 v[46:49], v[14:17], v[26:33], v1
 s_waitcnt lgkmcnt(6)
 v_smfmac_f32_16x16x64_bf16 v[42:45], v[18:21], v[216:223], v1
 ds_read_b128 v[14:17], v4 offset:8704
 s_waitcnt lgkmcnt(5)
 v_smfmac_f32_16x16x64_bf16 v[46:49], v[18:21], v[62:69], v1
 s_waitcnt lgkmcnt(4)
 v_smfmac_f32_16x16x64_bf16 v[42:45], v[22:25], v[224:231], v1
 ds_read_b128 v[18:21], v4 offset:6144
 s_waitcnt lgkmcnt(3)
 v_smfmac_f32_16x16x64_bf16 v[46:49], v[22:25], v[34:41], v1
 ds_read_b128 v[66:69], v0 offset:13568
 s_waitcnt lgkmcnt(3)
 v_smfmac_f32_16x16x64_bf16 v[42:45], v[10:13], v[232:239], v1
 ds_read_b128 v[22:25], v4 offset:6656
 v_smfmac_f32_16x16x64_bf16 v[46:49], v[10:13], v[240:247], v1
 s_waitcnt lgkmcnt(3)
 v_smfmac_f32_16x16x64_bf16 v[42:45], v[14:17], v[248:255], v1
 ds_read_b128 v[10:13], v4 offset:7168
 v_smfmac_f32_16x16x64_bf16 v[46:49], v[14:17], a[0:7], v1
 ds_read_b128 v[14:17], v4 offset:7680
 s_waitcnt lgkmcnt(4)
 v_smfmac_f32_16x16x64_bf16 v[50:53], v[18:21], a[104:111], v1
 s_nop 1
 s_waitcnt lgkmcnt(2)
 v_smfmac_f32_16x16x64_bf16 v[50:53], v[22:25], a[112:119], v1
 s_nop 2
 v_cvt_pk_bf16_f32 v62, v42, v43
 v_cvt_pk_bf16_f32 v63, v44, v45
 ds_write_b64 v5, v[62:63]
 v_cvt_pk_bf16_f32 v64, v46, v47
 v_cvt_pk_bf16_f32 v65, v48, v49
 ds_write_b64 v5, v[64:65] offset:2176
 ds_read_b128 v[42:45], v4 offset:8192
 ds_read_b128 v[46:49], v4 offset:8704
 s_waitcnt lgkmcnt(5)
 v_smfmac_f32_16x16x64_bf16 v[50:53], v[10:13], a[120:127], v1
 buffer_store_dwordx4 v[66:69], v0, s[4:7], s65 offen offset:0 sc1
 s_waitcnt lgkmcnt(4)
 v_smfmac_f32_16x16x64_bf16 v[50:53], v[14:17], a[128:135], v1
 s_waitcnt lgkmcnt(2)
 s_barrier
 s_waitcnt lgkmcnt(1)
 v_smfmac_f32_16x16x64_bf16 v[50:53], v[42:45], a[136:143], v1
 s_waitcnt lgkmcnt(0)
 v_smfmac_f32_16x16x64_bf16 v[50:53], v[46:49], a[144:151], v1
 s_nop 7
 v_cvt_pk_bf16_f32 v40, v50, v51
 v_cvt_pk_bf16_f32 v41, v52, v53
 ds_write_b64 v5, v[40:41] offset:4352
 s_add_u32 s65, s65, 131072
 s_waitcnt vmcnt(0) lgkmcnt(0)
 s_barrier
 ds_read_b128 v[66:69], v0 offset:13568
 s_waitcnt lgkmcnt(0)
 v_or_b32 v66, 1, v66
 v_or_b32 v67, 1, v67
 v_or_b32 v68, 1, v68
 v_or_b32 v69, 1, v69
 buffer_store_dwordx4 v[66:69], v0, s[4:7], s65 offen offset:0 sc1
 s_branch L_done1
L_mbre_174:
 s_mov_b32 m0, 4096
 s_nop 0
 buffer_load_dwordx4 v0, s[4:7], s25 offen offset:0 sc1 lds
 buffer_load_dwordx4 v0, s[4:7], s25 offen offset:1024 sc1 lds
 s_add_u32 s51, s51, 65536
 s_waitcnt vmcnt(3)
 ds_read_b128 v[62:65], v0 offset:4096
 ds_read_b128 v[66:69], v0 offset:5120
 s_waitcnt lgkmcnt(0)
 v_bitop3_b32 v62, v62, v63, v64 bitop3:0x80
 v_bitop3_b32 v62, v62, v65, v65 bitop3:0x80
 v_bitop3_b32 v62, v62, v66, v67 bitop3:0x80
 v_bitop3_b32 v62, v62, v68, v69 bitop3:0x80
 v_bitop3_b32 v62, v62, v62, s28 bitop3:0xf5
 v_and_b32 v62, 1, v62
 v_cmp_ne_u32 vcc, 1, v62
 s_cbranch_vccz L_mbok_173
 s_mov_b32 m0, 4096
 s_nop 0
 buffer_load_dwordx4 v0, s[4:7], s25 offen offset:0 sc1 lds
 buffer_load_dwordx4 v0, s[4:7], s25 offen offset:1024 sc1 lds
 s_nop 15
 s_nop 3
L_mbspin_189:
 s_mov_b32 m0, 4096
 s_nop 0
 buffer_load_dwordx4 v0, s[4:7], s25 offen offset:0 sc1 lds
 buffer_load_dwordx4 v0, s[4:7], s25 offen offset:1024 sc1 lds
 s_add_u32 s51, s51, 65536
 s_cmp_gt_u32 s51, 1310720000
 s_cbranch_scc1 L_exit1
 s_waitcnt vmcnt(4)
 ds_read_b128 v[62:65], v0 offset:4096
 ds_read_b128 v[66:69], v0 offset:5120
 s_waitcnt lgkmcnt(0)
 v_bitop3_b32 v62, v62, v63, v64 bitop3:0x80
 v_bitop3_b32 v62, v62, v65, v65 bitop3:0x80
 v_bitop3_b32 v62, v62, v66, v67 bitop3:0x80
 v_bitop3_b32 v62, v62, v68, v69 bitop3:0x80
 v_bitop3_b32 v62, v62, v62, s28 bitop3:0xf5
 v_and_b32 v62, 1, v62
 v_cmp_ne_u32 vcc, 1, v62
 s_cbranch_vccnz L_mbspin_189
 s_branch L_mbok_173
L_rre_177:
 buffer_load_dwordx4 v[10:13], v0, s[4:7], s60 offen offset:0 sc1
 buffer_load_dwordx4 v[14:17], v0, s[4:7], s60 offen offset:1024 sc1
 buffer_load_dwordx4 v[18:21], v0, s[4:7], s60 offen offset:2048 sc1
 buffer_load_dwordx4 v[22:25], v0, s[4:7], s60 offen offset:3072 sc1
 s_nop 15
 s_nop 7
L_rspin_190:
 buffer_load_dwordx4 v[54:57], v0, s[4:7], s60 offen offset:0 sc1
 buffer_load_dwordx4 v[58:61], v0, s[4:7], s60 offen offset:1024 sc1
 buffer_load_dwordx4 v[62:65], v0, s[4:7], s60 offen offset:2048 sc1
 buffer_load_dwordx4 v[66:69], v0, s[4:7], s60 offen offset:3072 sc1
 s_add_u32 s51, s51, 1
 s_waitcnt vmcnt(7)
 v_mfma_f32_16x16x32_bf16 v[30:33], v[10:13], v[26:29], 0
 v_bitop3_b32 v34, v10, v12, v12 bitop3:0xfe
 s_waitcnt vmcnt(6)
 v_mfma_f32_16x16x32_bf16 v[30:33], v[14:17], v[26:29], v[30:33]
 v_bitop3_b32 v34, v34, v14, v16 bitop3:0xfe
 s_waitcnt vmcnt(5)
 v_mfma_f32_16x16x32_bf16 v[30:33], v[18:21], v[26:29], v[30:33]
 v_bitop3_b32 v34, v34, v18, v20 bitop3:0xfe
 s_waitcnt vmcnt(4)
 v_mfma_f32_16x16x32_bf16 v[30:33], v[22:25], v[26:29], v[30:33]
 v_bitop3_b32 v34, v34, v22, v24 bitop3:0xfe
 v_and_b32 v34, 1, v34
 v_cmp_ne_u32 vcc, 0, v34
 s_cbranch_vccz L_rok_191
 buffer_load_dwordx4 v[10:13], v0, s[4:7], s60 offen offset:0 sc1
 buffer_load_dwordx4 v[14:17], v0, s[4:7], s60 offen offset:1024 sc1
 buffer_load_dwordx4 v[18:21], v0, s[4:7], s60 offen offset:2048 sc1
 buffer_load_dwordx4 v[22:25], v0, s[4:7], s60 offen offset:3072 sc1
 s_add_u32 s51, s51, 1
 s_waitcnt vmcnt(7)
 v_mfma_f32_16x16x32_bf16 v[30:33], v[54:57], v[26:29], 0
 v_bitop3_b32 v34, v54, v56, v56 bitop3:0xfe
 s_waitcnt vmcnt(6)
 v_mfma_f32_16x16x32_bf16 v[30:33], v[58:61], v[26:29], v[30:33]
 v_bitop3_b32 v34, v34, v58, v60 bitop3:0xfe
 s_waitcnt vmcnt(5)
 v_mfma_f32_16x16x32_bf16 v[30:33], v[62:65], v[26:29], v[30:33]
 v_bitop3_b32 v34, v34, v62, v64 bitop3:0xfe
 s_waitcnt vmcnt(4)
 v_mfma_f32_16x16x32_bf16 v[30:33], v[66:69], v[26:29], v[30:33]
 v_bitop3_b32 v34, v34, v66, v68 bitop3:0xfe
 v_and_b32 v34, 1, v34
 v_cmp_ne_u32 vcc, 0, v34
 s_cbranch_vccz L_rok_191
 s_and_b32 s3, s51, 0xffff
 s_cmp_gt_u32 s3, 20000
 s_cbranch_scc0 L_rspin_190
 s_branch L_exit1
L_rok_191:
 s_nop 3
 v_permlane32_swap_b32 v30, v31
 v_permlane32_swap_b32 v32, v33
 v_add_f32 v30, v30, v31
 v_add_f32 v32, v32, v33
 v_cvt_pk_bf16_f32 v30, v30, v32
 v_and_b32 v30, -2, v30
 buffer_store_dword v30, v35, s[4:7], s61 offen sc1
 s_waitcnt vmcnt(1)
 s_branch L_rback_178
L_mbre_181:
 s_mov_b32 m0, 4096
 s_nop 0
 buffer_load_dwordx4 v0, s[4:7], s25 offen offset:0 sc1 lds
 buffer_load_dwordx4 v0, s[4:7], s25 offen offset:1024 sc1 lds
 s_add_u32 s51, s51, 65536
 s_waitcnt vmcnt(3)
 ds_read_b128 v[62:65], v0 offset:4096
 ds_read_b128 v[66:69], v0 offset:5120
 s_waitcnt lgkmcnt(0)
 v_bitop3_b32 v62, v62, v63, v64 bitop3:0xfe
 v_bitop3_b32 v62, v62, v65, v65 bitop3:0xfe
 v_bitop3_b32 v62, v62, v66, v67 bitop3:0xfe
 v_bitop3_b32 v62, v62, v68, v69 bitop3:0xfe
 v_bitop3_b32 v62, v62, v62, s28 bitop3:0xa0
 v_and_b32 v62, 1, v62
 v_cmp_ne_u32 vcc, 0, v62
 s_cbranch_vccz L_mbok_180
 s_mov_b32 m0, 4096
 s_nop 0
 buffer_load_dwordx4 v0, s[4:7], s25 offen offset:0 sc1 lds
 buffer_load_dwordx4 v0, s[4:7], s25 offen offset:1024 sc1 lds
 s_nop 15
 s_nop 3
L_mbspin_192:
 s_mov_b32 m0, 4096
 s_nop 0
 buffer_load_dwordx4 v0, s[4:7], s25 offen offset:0 sc1 lds
 buffer_load_dwordx4 v0, s[4:7], s25 offen offset:1024 sc1 lds
 s_add_u32 s51, s51, 65536
 s_cmp_gt_u32 s51, 1310720000
 s_cbranch_scc1 L_exit1
 s_waitcnt vmcnt(4)
 ds_read_b128 v[62:65], v0 offset:4096
 ds_read_b128 v[66:69], v0 offset:5120
 s_waitcnt lgkmcnt(0)
 v_bitop3_b32 v62, v62, v63, v64 bitop3:0xfe
 v_bitop3_b32 v62, v62, v65, v65 bitop3:0xfe
 v_bitop3_b32 v62, v62, v66, v67 bitop3:0xfe
 v_bitop3_b32 v62, v62, v68, v69 bitop3:0xfe
 v_bitop3_b32 v62, v62, v62, s28 bitop3:0xa0
 v_and_b32 v62, 1, v62
 v_cmp_ne_u32 vcc, 0, v62
 s_cbranch_vccnz L_mbspin_192
 s_branch L_mbok_180
L_rre_184:
 buffer_load_dwordx4 v[10:13], v0, s[4:7], s60 offen offset:0 sc1
 buffer_load_dwordx4 v[14:17], v0, s[4:7], s60 offen offset:1024 sc1
 buffer_load_dwordx4 v[18:21], v0, s[4:7], s60 offen offset:2048 sc1
 buffer_load_dwordx4 v[22:25], v0, s[4:7], s60 offen offset:3072 sc1
 s_nop 15
 s_nop 7
L_rspin_193:
 buffer_load_dwordx4 v[54:57], v0, s[4:7], s60 offen offset:0 sc1
 buffer_load_dwordx4 v[58:61], v0, s[4:7], s60 offen offset:1024 sc1
 buffer_load_dwordx4 v[62:65], v0, s[4:7], s60 offen offset:2048 sc1
 buffer_load_dwordx4 v[66:69], v0, s[4:7], s60 offen offset:3072 sc1
 s_add_u32 s51, s51, 1
 s_waitcnt vmcnt(7)
 v_mfma_f32_16x16x32_bf16 v[30:33], v[10:13], v[26:29], 0
 v_bitop3_b32 v34, v10, v12, v12 bitop3:0x80
 s_waitcnt vmcnt(6)
 v_mfma_f32_16x16x32_bf16 v[30:33], v[14:17], v[26:29], v[30:33]
 v_bitop3_b32 v34, v34, v14, v16 bitop3:0x80
 s_waitcnt vmcnt(5)
 v_mfma_f32_16x16x32_bf16 v[30:33], v[18:21], v[26:29], v[30:33]
 v_bitop3_b32 v34, v34, v18, v20 bitop3:0x80
 s_waitcnt vmcnt(4)
 v_mfma_f32_16x16x32_bf16 v[30:33], v[22:25], v[26:29], v[30:33]
 v_bitop3_b32 v34, v34, v22, v24 bitop3:0x80
 v_and_b32 v34, 1, v34
 v_cmp_ne_u32 vcc, 1, v34
 s_cbranch_vccz L_rok_194
 buffer_load_dwordx4 v[10:13], v0, s[4:7], s60 offen offset:0 sc1
 buffer_load_dwordx4 v[14:17], v0, s[4:7], s60 offen offset:1024 sc1
 buffer_load_dwordx4 v[18:21], v0, s[4:7], s60 offen offset:2048 sc1
 buffer_load_dwordx4 v[22:25], v0, s[4:7], s60 offen offset:3072 sc1
 s_add_u32 s51, s51, 1
 s_waitcnt vmcnt(7)
 v_mfma_f32_16x16x32_bf16 v[30:33], v[54:57], v[26:29], 0
 v_bitop3_b32 v34, v54, v56, v56 bitop3:0x80
 s_waitcnt vmcnt(6)
 v_mfma_f32_16x16x32_bf16 v[30:33], v[58:61], v[26:29], v[30:33]
 v_bitop3_b32 v34, v34, v58, v60 bitop3:0x80
 s_waitcnt vmcnt(5)
 v_mfma_f32_16x16x32_bf16 v[30:33], v[62:65], v[26:29], v[30:33]
 v_bitop3_b32 v34, v34, v62, v64 bitop3:0x80
 s_waitcnt vmcnt(4)
 v_mfma_f32_16x16x32_bf16 v[30:33], v[66:69], v[26:29], v[30:33]
 v_bitop3_b32 v34, v34, v66, v68 bitop3:0x80
 v_and_b32 v34, 1, v34
 v_cmp_ne_u32 vcc, 1, v34
 s_cbranch_vccz L_rok_194
 s_and_b32 s3, s51, 0xffff
 s_cmp_gt_u32 s3, 20000
 s_cbranch_scc0 L_rspin_193
 s_branch L_exit1
L_rok_194:
 s_nop 3
 v_permlane32_swap_b32 v30, v31
 v_permlane32_swap_b32 v32, v33
 v_add_f32 v30, v30, v31
 v_add_f32 v32, v32, v33
 v_cvt_pk_bf16_f32 v30, v30, v32
 v_or_b32 v30, 1, v30
 buffer_store_dword v30, v35, s[4:7], s61 offen sc1
 s_waitcnt vmcnt(1)
 s_branch L_rback_185
L_mbre_188:
 s_mov_b32 m0, 4096
 s_nop 0
 buffer_load_dwordx4 v0, s[4:7], s25 offen offset:0 sc1 lds
 buffer_load_dwordx4 v0, s[4:7], s25 offen offset:1024 sc1 lds
 s_add_u32 s51, s51, 65536
 s_waitcnt vmcnt(2)
 ds_read_b128 v[62:65], v0 offset:4096
 ds_read_b128 v[66:69], v0 offset:5120
 s_waitcnt lgkmcnt(0)
 v_bitop3_b32 v62, v62, v63, v64 bitop3:0xfe
 v_bitop3_b32 v62, v62, v65, v65 bitop3:0xfe
 v_bitop3_b32 v62, v62, v66, v67 bitop3:0xfe
 v_bitop3_b32 v62, v62, v68, v69 bitop3:0xfe
 v_bitop3_b32 v62, v62, v62, s28 bitop3:0xa0
 v_and_b32 v62, 1, v62
 v_cmp_ne_u32 vcc, 0, v62
 s_cbranch_vccz L_mbok_187
 s_mov_b32 m0, 4096
 s_nop 0
 buffer_load_dwordx4 v0, s[4:7], s25 offen offset:0 sc1 lds
 buffer_load_dwordx4 v0, s[4:7], s25 offen offset:1024 sc1 lds
 s_nop 15
 s_nop 3
L_mbspin_195:
 s_mov_b32 m0, 4096
 s_nop 0
 buffer_load_dwordx4 v0, s[4:7], s25 offen offset:0 sc1 lds
 buffer_load_dwordx4 v0, s[4:7], s25 offen offset:1024 sc1 lds
 s_add_u32 s51, s51, 65536
 s_cmp_gt_u32 s51, 1310720000
 s_cbranch_scc1 L_exit1
 s_waitcnt vmcnt(4)
 ds_read_b128 v[62:65], v0 offset:4096
 ds_read_b128 v[66:69], v0 offset:5120
 s_waitcnt lgkmcnt(0)
 v_bitop3_b32 v62, v62, v63, v64 bitop3:0xfe
 v_bitop3_b32 v62, v62, v65, v65 bitop3:0xfe
 v_bitop3_b32 v62, v62, v66, v67 bitop3:0xfe
 v_bitop3_b32 v62, v62, v68, v69 bitop3:0xfe
 v_bitop3_b32 v62, v62, v62, s28 bitop3:0xa0
 v_and_b32 v62, 1, v62
 v_cmp_ne_u32 vcc, 0, v62
 s_cbranch_vccnz L_mbspin_195
 s_branch L_mbok_187
L_wave2_138:
 v_mov_b64 v[42:43], 0
 v_mov_b64 v[44:45], 0
 v_mov_b64 v[46:47], 0
 v_mov_b64 v[48:49], 0
 v_mov_b64 v[50:51], 0
 v_mov_b64 v[52:53], 0
 v_and_b32 v70, 0xf0, v0
 v_bfe_u32 v71, v0, 8, 2
 v_lshl_add_u32 v71, v71, 9, s67
 v_add_u32 v70, v70, v71
 v_add_u32 v9, 57344, v3
 ds_read_b128 v[26:29], v3 offset:0
 ds_read_b128 v[30:33], v3 offset:1024
 ds_read_b128 v[62:65], v3 offset:8192
 ds_read_b128 v[66:69], v3 offset:9216
 ds_read_b128 v[34:37], v3 offset:16384
 ds_read_b128 v[38:41], v3 offset:17408
 .p2align 6
L_loop_196:
 s_waitcnt lgkmcnt(0)
 s_barrier
 s_mov_b32 s51, 0
 ds_read_b128 v[10:13], v4 offset:0
 ds_read_b128 v[14:17], v4 offset:512
 ds_read_b128 v[18:21], v4 offset:1024
 s_add_u32 s72, s52, 16777216
 buffer_load_dwordx4 v[54:57], v70, s[4:7], s72 offen sc1
 buffer_load_dwordx4 v[58:61], v70, s[4:7], s72 offen offset:256 sc1
 s_waitcnt lgkmcnt(2)
 v_smfmac_f32_16x16x64_bf16 v[50:53], v[10:13], a[8:15], v1
 v_lshlrev_b32 v71, 2, v0
 v_smfmac_f32_16x16x64_bf16 v[42:45], v[10:13], v[72:79], v1
 ds_read_b128 v[22:25], v4 offset:1536
 v_smfmac_f32_16x16x64_bf16 v[46:49], v[10:13], v[80:87], v1
 s_mov_b32 m0, 4096
 s_cmp_eq_u32 s50, 0
 s_cbranch_scc1 L_mb2skip_198
 buffer_load_dwordx4 v0, s[4:7], s25 offen offset:2048 sc1 lds
 buffer_load_dwordx4 v0, s[4:7], s25 offen offset:3072 sc1 lds
L_mb2skip_198:
 s_waitcnt lgkmcnt(2)
 v_smfmac_f32_16x16x64_bf16 v[50:53], v[14:17], a[16:23], v1
 v_smfmac_f32_16x16x64_bf16 v[42:45], v[14:17], v[88:95], v1
 ds_read_b128 v[10:13], v4 offset:2048
 v_smfmac_f32_16x16x64_bf16 v[46:49], v[14:17], v[26:33], v1
 ds_read_b128 v[26:29], v3 offset:24576
 s_add_u32 s73, s52, 524288
 s_min_u32 s73, s73, 16515072
 s_add_u32 s73, s73, s68
 s_waitcnt lgkmcnt(3)
 v_smfmac_f32_16x16x64_bf16 v[50:53], v[18:21], a[24:31], v1
 ds_read_b128 v[30:33], v3 offset:25600
 v_smfmac_f32_16x16x64_bf16 v[42:45], v[18:21], v[96:103], v1
 ds_read_b128 v[14:17], v4 offset:2560
 s_mov_b32 m0, 23936
 s_nop 0
 buffer_load_dword v71, s[4:7], s73 offen sc1 lds
 v_smfmac_f32_16x16x64_bf16 v[46:49], v[18:21], v[62:69], v1
 s_waitcnt vmcnt(5)
 ds_read_b128 v[62:65], v0 offset:6144
 ds_read_b128 v[66:69], v0 offset:7168
 s_waitcnt lgkmcnt(6)
 v_smfmac_f32_16x16x64_bf16 v[50:53], v[22:25], a[32:39], v1
 v_smfmac_f32_16x16x64_bf16 v[42:45], v[22:25], v[104:111], v1
 ds_read_b128 v[18:21], v4 offset:3072
 v_smfmac_f32_16x16x64_bf16 v[46:49], v[22:25], v[34:41], v1
 ds_read_b128 v[34:37], v3 offset:32768
 s_waitcnt lgkmcnt(7)
 v_smfmac_f32_16x16x64_bf16 v[50:53], v[10:13], a[40:47], v1
 ds_read_b128 v[38:41], v3 offset:33792
 v_smfmac_f32_16x16x64_bf16 v[42:45], v[10:13], v[112:119], v1
 s_waitcnt lgkmcnt(3)
 ds_read_b128 v[22:25], v4 offset:3584
 v_bitop3_b32 v62, v62, v63, v64 bitop3:0x80
 v_bitop3_b32 v62, v62, v65, v65 bitop3:0x80
 v_smfmac_f32_16x16x64_bf16 v[46:49], v[10:13], v[26:33], v1
 ds_read_b128 v[26:29], v3 offset:40960
 v_bitop3_b32 v62, v62, v66, v67 bitop3:0x80
 v_smfmac_f32_16x16x64_bf16 v[50:53], v[14:17], a[48:55], v1
 ds_read_b128 v[30:33], v3 offset:41984
 v_bitop3_b32 v62, v62, v68, v69 bitop3:0x80
 v_bitop3_b32 v62, v62, v62, s28 bitop3:0xf5
 v_smfmac_f32_16x16x64_bf16 v[42:45], v[14:17], v[120:127], v1
 v_and_b32 v62, 1, v62
 v_smfmac_f32_16x16x64_bf16 v[46:49], v[14:17], v[128:135], v1
 v_cmp_ne_u32 vcc, 1, v62
 s_waitcnt lgkmcnt(5)
 v_smfmac_f32_16x16x64_bf16 v[50:53], v[18:21], a[56:63], v1
 s_cbranch_vccnz L_mbre_200
L_mbok_199:
 s_barrier
 v_smfmac_f32_16x16x64_bf16 v[42:45], v[18:21], v[136:143], v1
 ds_read_b128 v[10:13], v4 offset:4096
 ds_read_b128 v[14:17], v4 offset:4608
 s_waitcnt lgkmcnt(5)
 v_smfmac_f32_16x16x64_bf16 v[46:49], v[18:21], v[34:41], v1
 ds_read_b128 v[34:37], v3 offset:49152
 s_waitcnt lgkmcnt(5)
 v_smfmac_f32_16x16x64_bf16 v[50:53], v[22:25], a[64:71], v1
 ds_read_b128 v[38:41], v3 offset:50176
 v_smfmac_f32_16x16x64_bf16 v[42:45], v[22:25], v[144:151], v1
 ds_read_b128 v[18:21], v4 offset:5120
 s_waitcnt lgkmcnt(5)
 v_smfmac_f32_16x16x64_bf16 v[46:49], v[22:25], v[26:33], v1
 ds_read_b128 v[26:29], v9 offset:0
 s_waitcnt lgkmcnt(5)
 v_smfmac_f32_16x16x64_bf16 v[50:53], v[10:13], a[72:79], v1
 ds_read_b128 v[30:33], v9 offset:1024
 v_smfmac_f32_16x16x64_bf16 v[42:45], v[10:13], v[152:159], v1
 ds_read_b128 v[22:25], v4 offset:5632
 v_smfmac_f32_16x16x64_bf16 v[46:49], v[10:13], v[160:167], v1
 s_waitcnt lgkmcnt(6)
 v_smfmac_f32_16x16x64_bf16 v[50:53], v[14:17], a[80:87], v1
 v_smfmac_f32_16x16x64_bf16 v[42:45], v[14:17], v[168:175], v1
 ds_read_b128 v[10:13], v4 offset:6144
 s_waitcnt lgkmcnt(5)
 v_smfmac_f32_16x16x64_bf16 v[46:49], v[14:17], v[34:41], v1
 ds_read_b128 v[34:37], v9 offset:8192
 s_waitcnt lgkmcnt(5)
 v_smfmac_f32_16x16x64_bf16 v[50:53], v[18:21], a[88:95], v1
 ds_read_b128 v[38:41], v9 offset:9216
 v_smfmac_f32_16x16x64_bf16 v[42:45], v[18:21], v[176:183], v1
 ds_read_b128 v[14:17], v4 offset:6656
 s_waitcnt lgkmcnt(5)
 v_smfmac_f32_16x16x64_bf16 v[46:49], v[18:21], v[26:33], v1
 ds_read_b128 v[26:29], v9 offset:16384
 s_waitcnt lgkmcnt(5)
 v_smfmac_f32_16x16x64_bf16 v[50:53], v[22:25], a[96:103], v1
 ds_read_b128 v[30:33], v9 offset:17408
 v_smfmac_f32_16x16x64_bf16 v[42:45], v[22:25], v[184:191], v1
 ds_read_b128 v[18:21], v4 offset:7168
 v_smfmac_f32_16x16x64_bf16 v[46:49], v[22:25], v[192:199], v1
 ds_read_b128 v[62:65], v9 offset:24576
 s_waitcnt lgkmcnt(7)
 v_smfmac_f32_16x16x64_bf16 v[42:45], v[10:13], v[200:207], v1
 ds_read_b128 v[66:69], v9 offset:25600
 ds_read_b128 v[22:25], v4 offset:7680
 s_waitcnt lgkmcnt(7)
 v_smfmac_f32_16x16x64_bf16 v[46:49], v[10:13], v[34:41], v1
 ds_read_b128 v[34:37], v9 offset:32768
 s_waitcnt lgkmcnt(7)
 v_smfmac_f32_16x16x64_bf16 v[42:45], v[14:17], v[208:215], v1
 ds_read_b128 v[38:41], v9 offset:33792
 ds_read_b128 v[10:13], v4 offset:8192
 s_waitcnt lgkmcnt(7)
 v_smfmac_f32_16x16x64_bf16 v[46:49], v[14:17], v[26:33], v1
 s_waitcnt lgkmcnt(6)
 v_smfmac_f32_16x16x64_bf16 v[42:45], v[18:21], v[216:223], v1
 ds_read_b128 v[14:17], v4 offset:8704
 s_waitcnt lgkmcnt(5)
 v_smfmac_f32_16x16x64_bf16 v[46:49], v[18:21], v[62:69], v1
 s_waitcnt lgkmcnt(4)
 v_smfmac_f32_16x16x64_bf16 v[42:45], v[22:25], v[224:231], v1
 ds_read_b128 v[18:21], v4 offset:6144
 s_waitcnt lgkmcnt(3)
 v_smfmac_f32_16x16x64_bf16 v[46:49], v[22:25], v[34:41], v1
 ds_read_b128 v[66:69], v0 offset:14656
 s_waitcnt lgkmcnt(3)
 v_smfmac_f32_16x16x64_bf16 v[42:45], v[10:13], v[232:239], v1
 ds_read_b128 v[22:25], v4 offset:6656
 v_smfmac_f32_16x16x64_bf16 v[46:49], v[10:13], v[240:247], v1
 ds_read_b128 v[26:29], v0 offset:15744
 ds_read_b128 v[30:33], v0 offset:17792
 s_waitcnt lgkmcnt(5)
 v_smfmac_f32_16x16x64_bf16 v[42:45], v[14:17], v[248:255], v1
 ds_read_b128 v[10:13], v4 offset:7168
 v_smfmac_f32_16x16x64_bf16 v[46:49], v[14:17], a[0:7], v1
 ds_read_b128 v[34:37], v0 offset:19840
 ds_read_b128 v[38:41], v0 offset:21888
 ds_read_b128 v[14:17], v4 offset:7680
 s_waitcnt lgkmcnt(8)
 v_smfmac_f32_16x16x64_bf16 v[50:53], v[18:21], a[104:111], v1
 s_nop 1
 s_waitcnt lgkmcnt(6)
 v_smfmac_f32_16x16x64_bf16 v[50:53], v[22:25], a[112:119], v1
 s_nop 2
 v_cvt_pk_bf16_f32 v62, v42, v43
 v_cvt_pk_bf16_f32 v63, v44, v45
 ds_write_b64 v5, v[62:63]
 v_cvt_pk_bf16_f32 v64, v46, v47
 v_cvt_pk_bf16_f32 v65, v48, v49
 ds_write_b64 v5, v[64:65] offset:2176
 ds_read_b128 v[42:45], v4 offset:8192
 ds_read_b128 v[46:49], v4 offset:8704
 s_waitcnt lgkmcnt(7)
 v_smfmac_f32_16x16x64_bf16 v[50:53], v[10:13], a[120:127], v1
 buffer_store_dwordx4 v[66:69], v0, s[4:7], s65 offen offset:0 sc1
 s_waitcnt lgkmcnt(4)
 v_smfmac_f32_16x16x64_bf16 v[50:53], v[14:17], a[128:135], v1
 s_waitcnt lgkmcnt(2)
 s_barrier
 ds_read_b64_tr_b16 v[10:11], v6 offset:0
 ds_read_b64_tr_b16 v[12:13], v6 offset:64
 ds_read_b64_tr_b16 v[14:15], v6 offset:256
 ds_read_b64_tr_b16 v[16:17], v6 offset:320
 s_waitcnt lgkmcnt(5)
 v_smfmac_f32_16x16x64_bf16 v[50:53], v[42:45], a[136:143], v1
 ds_read_b64_tr_b16 v[18:19], v6 offset:512
 ds_read_b64_tr_b16 v[20:21], v6 offset:576
 ds_read_b64_tr_b16 v[22:23], v6 offset:768
 ds_read_b64_tr_b16 v[24:25], v6 offset:832
 s_waitcnt lgkmcnt(8)
 v_smfmac_f32_16x16x64_bf16 v[50:53], v[46:49], a[144:151], v1
 s_waitcnt lgkmcnt(6)
 v_mfma_f32_16x16x32_bf16 v[42:45], v[26:29], v[10:13], 0
 ds_read_b128 v[26:29], v0 offset:16768
 v_mov_b32 v62, v2
 v_mov_b32 v63, v2
 s_waitcnt lgkmcnt(5)
 v_mfma_f32_16x16x32_bf16 v[42:45], v[30:33], v[14:17], v[42:45]
 ds_read_b128 v[30:33], v0 offset:18816
 v_mov_b32 v64, v2
 v_mov_b32 v65, v2
 s_waitcnt lgkmcnt(4)
 v_mfma_f32_16x16x32_bf16 v[42:45], v[34:37], v[18:21], v[42:45]
 ds_read_b128 v[34:37], v0 offset:20864
 s_waitcnt lgkmcnt(3)
 v_mfma_f32_16x16x32_bf16 v[42:45], v[38:41], v[22:25], v[42:45]
 ds_read_b128 v[38:41], v0 offset:22912
 v_mfma_f32_16x16x32_bf16 v[62:65], v[10:13], v[10:13], v[62:65]
 v_cvt_pk_bf16_f32 v68, v50, v51
 v_cvt_pk_bf16_f32 v69, v52, v53
 v_mfma_f32_16x16x32_bf16 v[62:65], v[14:17], v[14:17], v[62:65]
 ds_write_b64 v5, v[68:69] offset:4352
 v_mov_b64 v[66:67], v[68:69]
 v_mfma_f32_16x16x32_bf16 v[62:65], v[18:21], v[18:21], v[62:65]
 s_nop 0
 v_mul_f32 v42, s62, v42
 v_mul_f32 v43, s62, v43
 v_mfma_f32_16x16x32_bf16 v[62:65], v[22:25], v[22:25], v[62:65]
 v_permlane32_swap_b32 v66, v68
 v_permlane32_swap_b32 v67, v69
 s_waitcnt lgkmcnt(4)
 v_mfma_f32_16x16x32_bf16 v[46:49], v[26:29], v[10:13], 0
 v_mul_f32 v44, s62, v44
 v_mul_f32 v45, s62, v45
 s_waitcnt lgkmcnt(3)
 v_mfma_f32_16x16x32_bf16 v[46:49], v[30:33], v[14:17], v[46:49]
 v_max3_f32 v70, v42, v43, v44
 s_nop 0
 s_waitcnt lgkmcnt(2)
 v_mfma_f32_16x16x32_bf16 v[46:49], v[34:37], v[18:21], v[46:49]
 v_mul_f32 v62, s62, v62
 v_mul_f32 v63, s62, v63
 s_waitcnt lgkmcnt(1)
 v_mfma_f32_16x16x32_bf16 v[46:49], v[38:41], v[22:25], v[46:49]
 v_mul_f32 v64, s62, v64
 v_mul_f32 v65, s62, v65
 v_max3_f32 v70, v70, v45, v62
 v_max3_f32 v71, v63, v64, v65
 v_mov_b64 v[30:31], 0
 v_mov_b64 v[34:35], 0
 v_mov_b64 v[22:23], s[76:77]
 v_mov_b64 v[24:25], s[76:77]
 v_pk_mul_f32 v[46:47], v[46:47], s[62:63]
 v_pk_mul_f32 v[48:49], v[48:49], s[62:63]
 v_max3_f32 v70, v70, v71, v46
 v_max3_f32 v71, v47, v48, v49
 v_max_f32 v21, v70, v71
 v_max_f32 v70, v70, v71
 s_nop 1
 v_permlane16_swap_b32 v70, v21
 v_max_f32 v71, v70, v21
 v_max_f32 v70, v70, v21
 s_nop 1
 v_permlane32_swap_b32 v70, v71
 v_max_f32 v70, v70, v71
 v_pk_add_f32 v[42:43], v[42:43], v[70:71] op_sel_hi:[1,0] neg_lo:[0,1] neg_hi:[0,1]
 v_pk_add_f32 v[44:45], v[44:45], v[70:71] op_sel_hi:[1,0] neg_lo:[0,1] neg_hi:[0,1]
 v_pk_add_f32 v[46:47], v[46:47], v[70:71] op_sel_hi:[1,0] neg_lo:[0,1] neg_hi:[0,1]
 v_pk_add_f32 v[48:49], v[48:49], v[70:71] op_sel_hi:[1,0] neg_lo:[0,1] neg_hi:[0,1]
 v_pk_add_f32 v[62:63], v[62:63], v[70:71] op_sel_hi:[1,0] neg_lo:[0,1] neg_hi:[0,1]
 v_pk_add_f32 v[64:65], v[64:65], v[70:71] op_sel_hi:[1,0] neg_lo:[0,1] neg_hi:[0,1]
 v_exp_f32 v42, v42
 v_exp_f32 v43, v43
 v_exp_f32 v44, v44
 v_exp_f32 v45, v45
 v_exp_f32 v46, v46
 v_exp_f32 v47, v47
 v_exp_f32 v48, v48
 v_exp_f32 v49, v49
 v_exp_f32 v62, v62
 v_cvt_pk_bf16_f32 v26, v42, v43
 v_cvt_pk_bf16_f32 v27, v44, v45
 v_cvt_pk_bf16_f32 v28, v46, v47
 v_cvt_pk_bf16_f32 v29, v48, v49
 v_exp_f32 v63, v63
 s_waitcnt vmcnt(2)
 v_mfma_f32_16x16x32_bf16 v[10:13], v[22:25], v[26:29], 0
 v_exp_f32 v64, v64
 v_mfma_f32_16x16x32_bf16 v[14:17], v[54:57], v[26:29], 0
 v_exp_f32 v65, v65
 v_mfma_f32_16x16x32_bf16 v[36:39], v[58:61], v[26:29], 0
 v_cvt_pk_bf16_f32 v32, v62, v63
 v_cvt_pk_bf16_f32 v33, v64, v65
 s_nop 1
 v_mfma_f32_16x16x32_bf16 v[10:13], v[22:25], v[32:35], v[10:13]
 v_mfma_f32_16x16x32_bf16 v[14:17], v[66:69], v[32:35], v[14:17]
 v_mfma_f32_16x16x32_bf16 v[36:39], v[66:69], v[30:33], v[36:39]
 v_add_u32 v9, 98304, v3
 v_mov_b64 v[52:53], 0
 v_mov_b64 v[54:55], 0
 v_mov_b64 v[56:57], 0
 v_mov_b64 v[58:59], 0
 s_nop 0
 v_rcp_f32 v18, v10
 v_mov_b64 v[60:61], 0
 v_pk_mul_f32 v[14:15], v[14:15], v[18:19] op_sel_hi:[1,0]
 v_pk_mul_f32 v[16:17], v[16:17], v[18:19] op_sel_hi:[1,0]
 v_pk_mul_f32 v[36:37], v[36:37], v[18:19] op_sel_hi:[1,0]
 v_pk_mul_f32 v[38:39], v[38:39], v[18:19] op_sel_hi:[1,0]
 v_cvt_pk_bf16_f32 v22, v14, v15
 v_cvt_pk_bf16_f32 v23, v16, v17
 v_cvt_pk_bf16_f32 v24, v36, v37
 v_cvt_pk_bf16_f32 v25, v38, v39
 ds_write_b128 v7, v[22:25]
 s_add_u32 s50, s50, 1
 v_mov_b64 v[62:63], 0
 v_mov_b64 v[64:65], 0
 v_mov_b64 v[66:67], 0
 v_mov_b64 v[68:69], 0
 v_mov_b64 v[70:71], 0
 s_waitcnt lgkmcnt(0)
 s_barrier
 ds_read_b128 v[10:13], v4 offset:0
 ds_read_b128 v[14:17], v4 offset:512
 ds_read_b128 v[18:21], v4 offset:1024
 ds_read_b128 v[22:25], v4 offset:1536
 s_waitcnt lgkmcnt(3)
 v_smfmac_f32_16x16x64_bf16 v[52:55], v[10:13], a[152:159], v1
 s_waitcnt lgkmcnt(2)
 v_smfmac_f32_16x16x64_bf16 v[52:55], v[14:17], a[160:167], v1
 ds_read_b128 v[26:29], v9 offset:0
 ds_read_b128 v[30:33], v9 offset:1024
 s_waitcnt lgkmcnt(3)
 v_smfmac_f32_16x16x64_bf16 v[52:55], v[18:21], a[168:175], v1
 s_waitcnt lgkmcnt(2)
 v_smfmac_f32_16x16x64_bf16 v[52:55], v[22:25], a[176:183], v1
 ds_read_b128 v[34:37], v9 offset:8192
 ds_read_b128 v[38:41], v9 offset:9216
 v_smfmac_f32_16x16x64_bf16 v[56:59], v[10:13], a[184:191], v1
 s_nop 2
 v_smfmac_f32_16x16x64_bf16 v[56:59], v[14:17], a[192:199], v1
 ds_read_b128 v[42:45], v9 offset:16384
 ds_read_b128 v[46:49], v9 offset:17408
 s_nop 0
 v_smfmac_f32_16x16x64_bf16 v[56:59], v[18:21], a[200:207], v1
 v_cvt_pk_bf16_f32 v52, v52, v53
 v_smfmac_f32_16x16x64_bf16 v[56:59], v[22:25], a[208:215], v1
 v_cvt_pk_bf16_f32 v53, v54, v55
 v_smfmac_f32_16x16x64_bf16 v[60:63], v[10:13], a[216:223], v1
 s_nop 1
 v_and_b32 v52, -2, v52
 v_smfmac_f32_16x16x64_bf16 v[60:63], v[14:17], a[224:231], v1
 s_nop 1
 buffer_store_dwordx2 v[52:53], v8, s[4:7], s55 offen sc1
 s_waitcnt lgkmcnt(4)
 v_smfmac_f32_16x16x64_bf16 v[60:63], v[18:21], v[26:33], v1
 ds_read_b128 v[26:29], v9 offset:20480
 ds_read_b128 v[30:33], v9 offset:21504
 v_cvt_pk_bf16_f32 v56, v56, v57
 v_smfmac_f32_16x16x64_bf16 v[60:63], v[22:25], a[232:239], v1
 v_cvt_pk_bf16_f32 v57, v58, v59
 s_waitcnt lgkmcnt(4)
 v_smfmac_f32_16x16x64_bf16 v[64:67], v[10:13], v[34:41], v1
 ds_read_b128 v[34:37], v9 offset:24576
 ds_read_b128 v[38:41], v9 offset:25600
 v_and_b32 v56, -2, v56
 v_smfmac_f32_16x16x64_bf16 v[64:67], v[14:17], a[240:247], v1
 s_nop 1
 buffer_store_dwordx2 v[56:57], v8, s[4:7], s56 offen sc1
 s_waitcnt lgkmcnt(4)
 v_smfmac_f32_16x16x64_bf16 v[64:67], v[18:21], v[42:49], v1
 ds_read_b128 v[42:45], v9 offset:28672
 ds_read_b128 v[46:49], v9 offset:29696
 v_cvt_pk_bf16_f32 v60, v60, v61
 v_smfmac_f32_16x16x64_bf16 v[64:67], v[22:25], a[248:255], v1
 ds_read_b128 v[52:55], v9 offset:32768
 ds_read_b128 v[56:59], v9 offset:33792
 v_cvt_pk_bf16_f32 v61, v62, v63
 s_waitcnt lgkmcnt(6)
 v_smfmac_f32_16x16x64_bf16 v[68:71], v[10:13], v[26:33], v1
 s_nop 1
 v_and_b32 v60, -2, v60
 s_waitcnt lgkmcnt(4)
 v_smfmac_f32_16x16x64_bf16 v[68:71], v[14:17], v[34:41], v1
 s_nop 1
 buffer_store_dwordx2 v[60:61], v8, s[4:7], s57 offen sc1
 s_waitcnt lgkmcnt(2)
 v_smfmac_f32_16x16x64_bf16 v[68:71], v[18:21], v[42:49], v1
 v_cvt_pk_bf16_f32 v64, v64, v65
 s_waitcnt lgkmcnt(0)
 v_smfmac_f32_16x16x64_bf16 v[68:71], v[22:25], v[52:59], v1
 v_cvt_pk_bf16_f32 v65, v66, v67
 v_and_b32 v64, -2, v64
 buffer_store_dwordx2 v[64:65], v8, s[4:7], s58 offen sc1
 s_add_u32 s52, s52, 262144
 s_add_u32 s65, s65, s27
 s_mov_b64 s[28:29], -1
 s_sub_i32 s64, s50, s71
 s_mov_b32 s27, 131072
 v_cvt_pk_bf16_f32 v68, v68, v69
 v_cvt_pk_bf16_f32 v69, v70, v71
 v_and_b32 v68, -2, v68
 buffer_store_dwordx2 v[68:69], v8, s[4:7], s59 offen sc1
 s_barrier
 s_cmp_ge_u32 s48, 8
 s_cbranch_scc1 L_nored_201
 s_nop 15
 s_nop 15
 s_nop 15
 s_nop 7
 buffer_load_dwordx4 v[10:13], v0, s[4:7], s60 offen offset:0 sc1
 buffer_load_dwordx4 v[14:17], v0, s[4:7], s60 offen offset:1024 sc1
 buffer_load_dwordx4 v[18:21], v0, s[4:7], s60 offen offset:2048 sc1
 buffer_load_dwordx4 v[22:25], v0, s[4:7], s60 offen offset:3072 sc1
 v_and_b32 v34, 16, v0
 v_mov_b32 v30, 0x3f80
 v_lshlrev_b32 v30, v34, v30
 v_bfe_u32 v34, v0, 5, 3
 v_cmp_eq_u32 vcc, 0, v34
 s_nop 1
 v_cndmask_b32 v26, 0, v30, vcc
 v_cmp_eq_u32 vcc, 1, v34
 s_nop 1
 v_cndmask_b32 v27, 0, v30, vcc
 v_cmp_eq_u32 vcc, 2, v34
 s_nop 1
 v_cndmask_b32 v28, 0, v30, vcc
 v_cmp_eq_u32 vcc, 3, v34
 s_nop 1
 v_cndmask_b32 v29, 0, v30, vcc
 v_and_b32 v35, 0xf0, v0
 v_bfe_u32 v34, v0, 8, 2
 v_lshl_add_u32 v35, v34, 2, v35
 v_and_b32 v34, 0x80, v0
 v_lshl_add_u32 v35, v34, 23, v35
 v_mov_b64 v[42:43], 0
 v_mov_b64 v[44:45], 0
 v_mov_b64 v[46:47], 0
 v_mov_b64 v[48:49], 0
 v_mov_b64 v[50:51], 0
 v_mov_b64 v[52:53], 0
 v_and_b32 v70, 0xf0, v0
 v_bfe_u32 v71, v0, 8, 2
 v_lshl_add_u32 v71, v71, 9, s67
 v_add_u32 v70, v70, v71
 v_add_u32 v9, 57344, v3
 s_barrier
 s_waitcnt vmcnt(3)
 v_mfma_f32_16x16x32_bf16 v[30:33], v[10:13], v[26:29], 0
 v_bitop3_b32 v34, v10, v12, v12 bitop3:0xfe
 s_waitcnt vmcnt(2)
 v_mfma_f32_16x16x32_bf16 v[30:33], v[14:17], v[26:29], v[30:33]
 v_bitop3_b32 v34, v34, v14, v16 bitop3:0xfe
 s_waitcnt vmcnt(1)
 v_mfma_f32_16x16x32_bf16 v[30:33], v[18:21], v[26:29], v[30:33]
 v_bitop3_b32 v34, v34, v18, v20 bitop3:0xfe
 s_waitcnt vmcnt(0)
 v_mfma_f32_16x16x32_bf16 v[30:33], v[22:25], v[26:29], v[30:33]
 v_bitop3_b32 v34, v34, v22, v24 bitop3:0xfe
 v_and_b32 v34, 1, v34
 v_cmp_ne_u32 vcc, 0, v34
 s_cbranch_vccnz L_rre_203
 s_nop 3
 v_permlane32_swap_b32 v30, v31
 v_permlane32_swap_b32 v32, v33
 v_add_f32 v30, v30, v31
 v_add_f32 v32, v32, v33
 v_cvt_pk_bf16_f32 v30, v30, v32
 v_and_b32 v30, -2, v30
 buffer_store_dword v30, v35, s[4:7], s61 offen sc1
L_rback_204:
L_redj_202:
 ds_read_b128 v[26:29], v3 offset:0
 ds_read_b128 v[30:33], v3 offset:1024
 ds_read_b128 v[62:65], v3 offset:8192
 ds_read_b128 v[66:69], v3 offset:9216
 ds_read_b128 v[34:37], v3 offset:16384
 ds_read_b128 v[38:41], v3 offset:17408
 s_barrier
 s_mov_b32 m0, 4096
 s_nop 0
 buffer_load_dwordx4 v0, s[4:7], s25 offen offset:2048 sc1 lds
 buffer_load_dwordx4 v0, s[4:7], s25 offen offset:3072 sc1 lds
 s_cmp_eq_u32 s50, 63
 s_cbranch_scc1 L_last_197
 s_waitcnt lgkmcnt(0)
 s_barrier
 s_mov_b32 s51, 0
 ds_read_b128 v[10:13], v4 offset:0
 ds_read_b128 v[14:17], v4 offset:512
 ds_read_b128 v[18:21], v4 offset:1024
 s_add_u32 s72, s52, 16777216
 buffer_load_dwordx4 v[54:57], v70, s[4:7], s72 offen sc1
 buffer_load_dwordx4 v[58:61], v70, s[4:7], s72 offen offset:256 sc1
 s_waitcnt lgkmcnt(2)
 v_smfmac_f32_16x16x64_bf16 v[50:53], v[10:13], a[8:15], v1
 v_lshlrev_b32 v71, 2, v0
 v_smfmac_f32_16x16x64_bf16 v[42:45], v[10:13], v[72:79], v1
 ds_read_b128 v[22:25], v4 offset:1536
 v_smfmac_f32_16x16x64_bf16 v[46:49], v[10:13], v[80:87], v1
 s_mov_b32 m0, 4096
 s_cmp_eq_u32 s50, 0
 s_cbranch_scc1 L_mb2skip_205
 buffer_load_dwordx4 v0, s[4:7], s25 offen offset:2048 sc1 lds
 buffer_load_dwordx4 v0, s[4:7], s25 offen offset:3072 sc1 lds
L_mb2skip_205:
 s_waitcnt lgkmcnt(2)
 v_smfmac_f32_16x16x64_bf16 v[50:53], v[14:17], a[16:23], v1
 v_smfmac_f32_16x16x64_bf16 v[42:45], v[14:17], v[88:95], v1
 ds_read_b128 v[10:13], v4 offset:2048
 v_smfmac_f32_16x16x64_bf16 v[46:49], v[14:17], v[26:33], v1
 ds_read_b128 v[26:29], v3 offset:24576
 s_add_u32 s73, s52, 524288
 s_min_u32 s73, s73, 16515072
 s_add_u32 s73, s73, s68
 s_waitcnt lgkmcnt(3)
 v_smfmac_f32_16x16x64_bf16 v[50:53], v[18:21], a[24:31], v1
 ds_read_b128 v[30:33], v3 offset:25600
 v_smfmac_f32_16x16x64_bf16 v[42:45], v[18:21], v[96:103], v1
 ds_read_b128 v[14:17], v4 offset:2560
 s_mov_b32 m0, 23936
 s_nop 0
 buffer_load_dword v71, s[4:7], s73 offen sc1 lds
 v_smfmac_f32_16x16x64_bf16 v[46:49], v[18:21], v[62:69], v1
 s_waitcnt vmcnt(5)
 ds_read_b128 v[62:65], v0 offset:6144
 ds_read_b128 v[66:69], v0 offset:7168
 s_waitcnt lgkmcnt(6)
 v_smfmac_f32_16x16x64_bf16 v[50:53], v[22:25], a[32:39], v1
 v_smfmac_f32_16x16x64_bf16 v[42:45], v[22:25], v[104:111], v1
 ds_read_b128 v[18:21], v4 offset:3072
 v_smfmac_f32_16x16x64_bf16 v[46:49], v[22:25], v[34:41], v1
 ds_read_b128 v[34:37], v3 offset:32768
 s_waitcnt lgkmcnt(7)
 v_smfmac_f32_16x16x64_bf16 v[50:53], v[10:13], a[40:47], v1
 ds_read_b128 v[38:41], v3 offset:33792
 v_smfmac_f32_16x16x64_bf16 v[42:45], v[10:13], v[112:119], v1
 s_waitcnt lgkmcnt(3)
 ds_read_b128 v[22:25], v4 offset:3584
 v_bitop3_b32 v62, v62, v63, v64 bitop3:0xfe
 v_bitop3_b32 v62, v62, v65, v65 bitop3:0xfe
 v_smfmac_f32_16x16x64_bf16 v[46:49], v[10:13], v[26:33], v1
 ds_read_b128 v[26:29], v3 offset:40960
 v_bitop3_b32 v62, v62, v66, v67 bitop3:0xfe
 v_smfmac_f32_16x16x64_bf16 v[50:53], v[14:17], a[48:55], v1
 ds_read_b128 v[30:33], v3 offset:41984
 v_bitop3_b32 v62, v62, v68, v69 bitop3:0xfe
 v_bitop3_b32 v62, v62, v62, s28 bitop3:0xa0
 v_smfmac_f32_16x16x64_bf16 v[42:45], v[14:17], v[120:127], v1
 v_and_b32 v62, 1, v62
 v_smfmac_f32_16x16x64_bf16 v[46:49], v[14:17], v[128:135], v1
 v_cmp_ne_u32 vcc, 0, v62
 s_waitcnt lgkmcnt(5)
 v_smfmac_f32_16x16x64_bf16 v[50:53], v[18:21], a[56:63], v1
 s_cbranch_vccnz L_mbre_207
L_mbok_206:
 s_barrier
 v_smfmac_f32_16x16x64_bf16 v[42:45], v[18:21], v[136:143], v1
 ds_read_b128 v[10:13], v4 offset:4096
 ds_read_b128 v[14:17], v4 offset:4608
 s_waitcnt lgkmcnt(5)
 v_smfmac_f32_16x16x64_bf16 v[46:49], v[18:21], v[34:41], v1
 ds_read_b128 v[34:37], v3 offset:49152
 s_waitcnt lgkmcnt(5)
 v_smfmac_f32_16x16x64_bf16 v[50:53], v[22:25], a[64:71], v1
 ds_read_b128 v[38:41], v3 offset:50176
 v_smfmac_f32_16x16x64_bf16 v[42:45], v[22:25], v[144:151], v1
 ds_read_b128 v[18:21], v4 offset:5120
 s_waitcnt lgkmcnt(5)
 v_smfmac_f32_16x16x64_bf16 v[46:49], v[22:25], v[26:33], v1
 ds_read_b128 v[26:29], v9 offset:0
 s_waitcnt lgkmcnt(5)
 v_smfmac_f32_16x16x64_bf16 v[50:53], v[10:13], a[72:79], v1
 ds_read_b128 v[30:33], v9 offset:1024
 v_smfmac_f32_16x16x64_bf16 v[42:45], v[10:13], v[152:159], v1
 ds_read_b128 v[22:25], v4 offset:5632
 v_smfmac_f32_16x16x64_bf16 v[46:49], v[10:13], v[160:167], v1
 s_waitcnt lgkmcnt(6)
 v_smfmac_f32_16x16x64_bf16 v[50:53], v[14:17], a[80:87], v1
 v_smfmac_f32_16x16x64_bf16 v[42:45], v[14:17], v[168:175], v1
 ds_read_b128 v[10:13], v4 offset:6144
 s_waitcnt lgkmcnt(5)
 v_smfmac_f32_16x16x64_bf16 v[46:49], v[14:17], v[34:41], v1
 ds_read_b128 v[34:37], v9 offset:8192
 s_waitcnt lgkmcnt(5)
 v_smfmac_f32_16x16x64_bf16 v[50:53], v[18:21], a[88:95], v1
 ds_read_b128 v[38:41], v9 offset:9216
 v_smfmac_f32_16x16x64_bf16 v[42:45], v[18:21], v[176:183], v1
 ds_read_b128 v[14:17], v4 offset:6656
 s_waitcnt lgkmcnt(5)
 v_smfmac_f32_16x16x64_bf16 v[46:49], v[18:21], v[26:33], v1
 ds_read_b128 v[26:29], v9 offset:16384
 s_waitcnt lgkmcnt(5)
 v_smfmac_f32_16x16x64_bf16 v[50:53], v[22:25], a[96:103], v1
 ds_read_b128 v[30:33], v9 offset:17408
 v_smfmac_f32_16x16x64_bf16 v[42:45], v[22:25], v[184:191], v1
 ds_read_b128 v[18:21], v4 offset:7168
 v_smfmac_f32_16x16x64_bf16 v[46:49], v[22:25], v[192:199], v1
 ds_read_b128 v[62:65], v9 offset:24576
 s_waitcnt lgkmcnt(7)
 v_smfmac_f32_16x16x64_bf16 v[42:45], v[10:13], v[200:207], v1
 ds_read_b128 v[66:69], v9 offset:25600
 ds_read_b128 v[22:25], v4 offset:7680
 s_waitcnt lgkmcnt(7)
 v_smfmac_f32_16x16x64_bf16 v[46:49], v[10:13], v[34:41], v1
 ds_read_b128 v[34:37], v9 offset:32768
 s_waitcnt lgkmcnt(7)
 v_smfmac_f32_16x16x64_bf16 v[42:45], v[14:17], v[208:215], v1
 ds_read_b128 v[38:41], v9 offset:33792
 ds_read_b128 v[10:13], v4 offset:8192
 s_waitcnt lgkmcnt(7)
 v_smfmac_f32_16x16x64_bf16 v[46:49], v[14:17], v[26:33], v1
 s_waitcnt lgkmcnt(6)
 v_smfmac_f32_16x16x64_bf16 v[42:45], v[18:21], v[216:223], v1
 ds_read_b128 v[14:17], v4 offset:8704
 s_waitcnt lgkmcnt(5)
 v_smfmac_f32_16x16x64_bf16 v[46:49], v[18:21], v[62:69], v1
 s_waitcnt lgkmcnt(4)
 v_smfmac_f32_16x16x64_bf16 v[42:45], v[22:25], v[224:231], v1
 ds_read_b128 v[18:21], v4 offset:6144
 s_waitcnt lgkmcnt(3)
 v_smfmac_f32_16x16x64_bf16 v[46:49], v[22:25], v[34:41], v1
 ds_read_b128 v[66:69], v0 offset:14656
 s_waitcnt lgkmcnt(3)
 v_smfmac_f32_16x16x64_bf16 v[42:45], v[10:13], v[232:239], v1
 ds_read_b128 v[22:25], v4 offset:6656
 v_smfmac_f32_16x16x64_bf16 v[46:49], v[10:13], v[240:247], v1
 ds_read_b128 v[26:29], v0 offset:15744
 ds_read_b128 v[30:33], v0 offset:17792
 s_waitcnt lgkmcnt(5)
 v_smfmac_f32_16x16x64_bf16 v[42:45], v[14:17], v[248:255], v1
 ds_read_b128 v[10:13], v4 offset:7168
 v_smfmac_f32_16x16x64_bf16 v[46:49], v[14:17], a[0:7], v1
 ds_read_b128 v[34:37], v0 offset:19840
 ds_read_b128 v[38:41], v0 offset:21888
 ds_read_b128 v[14:17], v4 offset:7680
 s_waitcnt lgkmcnt(8)
 v_smfmac_f32_16x16x64_bf16 v[50:53], v[18:21], a[104:111], v1
 s_nop 1
 s_waitcnt lgkmcnt(6)
 v_smfmac_f32_16x16x64_bf16 v[50:53], v[22:25], a[112:119], v1
 s_nop 2
 v_cvt_pk_bf16_f32 v62, v42, v43
 v_cvt_pk_bf16_f32 v63, v44, v45
 ds_write_b64 v5, v[62:63]
 v_cvt_pk_bf16_f32 v64, v46, v47
 v_cvt_pk_bf16_f32 v65, v48, v49
 ds_write_b64 v5, v[64:65] offset:2176
 ds_read_b128 v[42:45], v4 offset:8192
 ds_read_b128 v[46:49], v4 offset:8704
 s_waitcnt lgkmcnt(7)
 v_smfmac_f32_16x16x64_bf16 v[50:53], v[10:13], a[120:127], v1
 buffer_store_dwordx4 v[66:69], v0, s[4:7], s65 offen offset:0 sc1
 s_waitcnt lgkmcnt(4)
 v_smfmac_f32_16x16x64_bf16 v[50:53], v[14:17], a[128:135], v1
 s_waitcnt lgkmcnt(2)
 s_barrier
 ds_read_b64_tr_b16 v[10:11], v6 offset:0
 ds_read_b64_tr_b16 v[12:13], v6 offset:64
 ds_read_b64_tr_b16 v[14:15], v6 offset:256
 ds_read_b64_tr_b16 v[16:17], v6 offset:320
 s_waitcnt lgkmcnt(5)
 v_smfmac_f32_16x16x64_bf16 v[50:53], v[42:45], a[136:143], v1
 ds_read_b64_tr_b16 v[18:19], v6 offset:512
 ds_read_b64_tr_b16 v[20:21], v6 offset:576
 ds_read_b64_tr_b16 v[22:23], v6 offset:768
 ds_read_b64_tr_b16 v[24:25], v6 offset:832
 s_waitcnt lgkmcnt(8)
 v_smfmac_f32_16x16x64_bf16 v[50:53], v[46:49], a[144:151], v1
 s_waitcnt lgkmcnt(6)
 v_mfma_f32_16x16x32_bf16 v[42:45], v[26:29], v[10:13], 0
 ds_read_b128 v[26:29], v0 offset:16768
 v_mov_b32 v62, v2
 v_mov_b32 v63, v2
 s_waitcnt lgkmcnt(5)
 v_mfma_f32_16x16x32_bf16 v[42:45], v[30:33], v[14:17], v[42:45]
 ds_read_b128 v[30:33], v0 offset:18816
 v_mov_b32 v64, v2
 v_mov_b32 v65, v2
 s_waitcnt lgkmcnt(4)
 v_mfma_f32_16x16x32_bf16 v[42:45], v[34:37], v[18:21], v[42:45]
 ds_read_b128 v[34:37], v0 offset:20864
 s_waitcnt lgkmcnt(3)
 v_mfma_f32_16x16x32_bf16 v[42:45], v[38:41], v[22:25], v[42:45]
 ds_read_b128 v[38:41], v0 offset:22912
 v_mfma_f32_16x16x32_bf16 v[62:65], v[10:13], v[10:13], v[62:65]
 v_cvt_pk_bf16_f32 v68, v50, v51
 v_cvt_pk_bf16_f32 v69, v52, v53
 v_mfma_f32_16x16x32_bf16 v[62:65], v[14:17], v[14:17], v[62:65]
 ds_write_b64 v5, v[68:69] offset:4352
 v_mov_b64 v[66:67], v[68:69]
 v_mfma_f32_16x16x32_bf16 v[62:65], v[18:21], v[18:21], v[62:65]
 s_nop 0
 v_mul_f32 v42, s62, v42
 v_mul_f32 v43, s62, v43
 v_mfma_f32_16x16x32_bf16 v[62:65], v[22:25], v[22:25], v[62:65]
 v_permlane32_swap_b32 v66, v68
 v_permlane32_swap_b32 v67, v69
 s_waitcnt lgkmcnt(4)
 v_mfma_f32_16x16x32_bf16 v[46:49], v[26:29], v[10:13], 0
 v_mul_f32 v44, s62, v44
 v_mul_f32 v45, s62, v45
 s_waitcnt lgkmcnt(3)
 v_mfma_f32_16x16x32_bf16 v[46:49], v[30:33], v[14:17], v[46:49]
 v_max3_f32 v70, v42, v43, v44
 s_nop 0
 s_waitcnt lgkmcnt(2)
 v_mfma_f32_16x16x32_bf16 v[46:49], v[34:37], v[18:21], v[46:49]
 v_mul_f32 v62, s62, v62
 v_mul_f32 v63, s62, v63
 s_waitcnt lgkmcnt(1)
 v_mfma_f32_16x16x32_bf16 v[46:49], v[38:41], v[22:25], v[46:49]
 v_mul_f32 v64, s62, v64
 v_mul_f32 v65, s62, v65
 v_max3_f32 v70, v70, v45, v62
 v_max3_f32 v71, v63, v64, v65
 v_mov_b64 v[30:31], 0
 v_mov_b64 v[34:35], 0
 v_mov_b64 v[22:23], s[76:77]
 v_mov_b64 v[24:25], s[76:77]
 v_pk_mul_f32 v[46:47], v[46:47], s[62:63]
 v_pk_mul_f32 v[48:49], v[48:49], s[62:63]
 v_max3_f32 v70, v70, v71, v46
 v_max3_f32 v71, v47, v48, v49
 v_max_f32 v21, v70, v71
 v_max_f32 v70, v70, v71
 s_nop 1
 v_permlane16_swap_b32 v70, v21
 v_max_f32 v71, v70, v21
 v_max_f32 v70, v70, v21
 s_nop 1
 v_permlane32_swap_b32 v70, v71
 v_max_f32 v70, v70, v71
 v_pk_add_f32 v[42:43], v[42:43], v[70:71] op_sel_hi:[1,0] neg_lo:[0,1] neg_hi:[0,1]
 v_pk_add_f32 v[44:45], v[44:45], v[70:71] op_sel_hi:[1,0] neg_lo:[0,1] neg_hi:[0,1]
 v_pk_add_f32 v[46:47], v[46:47], v[70:71] op_sel_hi:[1,0] neg_lo:[0,1] neg_hi:[0,1]
 v_pk_add_f32 v[48:49], v[48:49], v[70:71] op_sel_hi:[1,0] neg_lo:[0,1] neg_hi:[0,1]
 v_pk_add_f32 v[62:63], v[62:63], v[70:71] op_sel_hi:[1,0] neg_lo:[0,1] neg_hi:[0,1]
 v_pk_add_f32 v[64:65], v[64:65], v[70:71] op_sel_hi:[1,0] neg_lo:[0,1] neg_hi:[0,1]
 v_exp_f32 v42, v42
 v_exp_f32 v43, v43
 v_exp_f32 v44, v44
 v_exp_f32 v45, v45
 v_exp_f32 v46, v46
 v_exp_f32 v47, v47
 v_exp_f32 v48, v48
 v_exp_f32 v49, v49
 v_exp_f32 v62, v62
 v_cvt_pk_bf16_f32 v26, v42, v43
 v_cvt_pk_bf16_f32 v27, v44, v45
 v_cvt_pk_bf16_f32 v28, v46, v47
 v_cvt_pk_bf16_f32 v29, v48, v49
 v_exp_f32 v63, v63
 s_waitcnt vmcnt(2)
 v_mfma_f32_16x16x32_bf16 v[10:13], v[22:25], v[26:29], 0
 v_exp_f32 v64, v64
 v_mfma_f32_16x16x32_bf16 v[14:17], v[54:57], v[26:29], 0
 v_exp_f32 v65, v65
 v_mfma_f32_16x16x32_bf16 v[36:39], v[58:61], v[26:29], 0
 v_cvt_pk_bf16_f32 v32, v62, v63
 v_cvt_pk_bf16_f32 v33, v64, v65
 s_nop 1
 v_mfma_f32_16x16x32_bf16 v[10:13], v[22:25], v[32:35], v[10:13]
 v_mfma_f32_16x16x32_bf16 v[14:17], v[66:69], v[32:35], v[14:17]
 v_mfma_f32_16x16x32_bf16 v[36:39], v[66:69], v[30:33], v[36:39]
 v_add_u32 v9, 98304, v3
 v_mov_b64 v[52:53], 0
 v_mov_b64 v[54:55], 0
 v_mov_b64 v[56:57], 0
 v_mov_b64 v[58:59], 0
 s_nop 0
 v_rcp_f32 v18, v10
 v_mov_b64 v[60:61], 0
 v_pk_mul_f32 v[14:15], v[14:15], v[18:19] op_sel_hi:[1,0]
 v_pk_mul_f32 v[16:17], v[16:17], v[18:19] op_sel_hi:[1,0]
 v_pk_mul_f32 v[36:37], v[36:37], v[18:19] op_sel_hi:[1,0]
 v_pk_mul_f32 v[38:39], v[38:39], v[18:19] op_sel_hi:[1,0]
 v_cvt_pk_bf16_f32 v22, v14, v15
 v_cvt_pk_bf16_f32 v23, v16, v17
 v_cvt_pk_bf16_f32 v24, v36, v37
 v_cvt_pk_bf16_f32 v25, v38, v39
 ds_write_b128 v7, v[22:25]
 s_add_u32 s50, s50, 1
 v_mov_b64 v[62:63], 0
 v_mov_b64 v[64:65], 0
 v_mov_b64 v[66:67], 0
 v_mov_b64 v[68:69], 0
 v_mov_b64 v[70:71], 0
 s_waitcnt lgkmcnt(0)
 s_barrier
 ds_read_b128 v[10:13], v4 offset:0
 ds_read_b128 v[14:17], v4 offset:512
 ds_read_b128 v[18:21], v4 offset:1024
 ds_read_b128 v[22:25], v4 offset:1536
 s_waitcnt lgkmcnt(3)
 v_smfmac_f32_16x16x64_bf16 v[52:55], v[10:13], a[152:159], v1
 s_waitcnt lgkmcnt(2)
 v_smfmac_f32_16x16x64_bf16 v[52:55], v[14:17], a[160:167], v1
 ds_read_b128 v[26:29], v9 offset:0
 ds_read_b128 v[30:33], v9 offset:1024
 s_waitcnt lgkmcnt(3)
 v_smfmac_f32_16x16x64_bf16 v[52:55], v[18:21], a[168:175], v1
 s_waitcnt lgkmcnt(2)
 v_smfmac_f32_16x16x64_bf16 v[52:55], v[22:25], a[176:183], v1
 ds_read_b128 v[34:37], v9 offset:8192
 ds_read_b128 v[38:41], v9 offset:9216
 v_smfmac_f32_16x16x64_bf16 v[56:59], v[10:13], a[184:191], v1
 s_nop 2
 v_smfmac_f32_16x16x64_bf16 v[56:59], v[14:17], a[192:199], v1
 ds_read_b128 v[42:45], v9 offset:16384
 ds_read_b128 v[46:49], v9 offset:17408
 s_nop 0
 v_smfmac_f32_16x16x64_bf16 v[56:59], v[18:21], a[200:207], v1
 v_cvt_pk_bf16_f32 v52, v52, v53
 v_smfmac_f32_16x16x64_bf16 v[56:59], v[22:25], a[208:215], v1
 v_cvt_pk_bf16_f32 v53, v54, v55
 v_smfmac_f32_16x16x64_bf16 v[60:63], v[10:13], a[216:223], v1
 s_nop 1
 v_or_b32 v52, 1, v52
 v_smfmac_f32_16x16x64_bf16 v[60:63], v[14:17], a[224:231], v1
 s_nop 1
 buffer_store_dwordx2 v[52:53], v8, s[4:7], s55 offen sc1
 s_waitcnt lgkmcnt(4)
 v_smfmac_f32_16x16x64_bf16 v[60:63], v[18:21], v[26:33], v1
 ds_read_b128 v[26:29], v9 offset:20480
 ds_read_b128 v[30:33], v9 offset:21504
 v_cvt_pk_bf16_f32 v56, v56, v57
 v_smfmac_f32_16x16x64_bf16 v[60:63], v[22:25], a[232:239], v1
 v_cvt_pk_bf16_f32 v57, v58, v59
 s_waitcnt lgkmcnt(4)
 v_smfmac_f32_16x16x64_bf16 v[64:67], v[10:13], v[34:41], v1
 ds_read_b128 v[34:37], v9 offset:24576
 ds_read_b128 v[38:41], v9 offset:25600
 v_or_b32 v56, 1, v56
 v_smfmac_f32_16x16x64_bf16 v[64:67], v[14:17], a[240:247], v1
 s_nop 1
 buffer_store_dwordx2 v[56:57], v8, s[4:7], s56 offen sc1
 s_waitcnt lgkmcnt(4)
 v_smfmac_f32_16x16x64_bf16 v[64:67], v[18:21], v[42:49], v1
 ds_read_b128 v[42:45], v9 offset:28672
 ds_read_b128 v[46:49], v9 offset:29696
 v_cvt_pk_bf16_f32 v60, v60, v61
 v_smfmac_f32_16x16x64_bf16 v[64:67], v[22:25], a[248:255], v1
 ds_read_b128 v[52:55], v9 offset:32768
 ds_read_b128 v[56:59], v9 offset:33792
 v_cvt_pk_bf16_f32 v61, v62, v63
 s_waitcnt lgkmcnt(6)
 v_smfmac_f32_16x16x64_bf16 v[68:71], v[10:13], v[26:33], v1
 s_nop 1
 v_or_b32 v60, 1, v60
 s_waitcnt lgkmcnt(4)
 v_smfmac_f32_16x16x64_bf16 v[68:71], v[14:17], v[34:41], v1
 s_nop 1
 buffer_store_dwordx2 v[60:61], v8, s[4:7], s57 offen sc1
 s_waitcnt lgkmcnt(2)
 v_smfmac_f32_16x16x64_bf16 v[68:71], v[18:21], v[42:49], v1
 v_cvt_pk_bf16_f32 v64, v64, v65
 s_waitcnt lgkmcnt(0)
 v_smfmac_f32_16x16x64_bf16 v[68:71], v[22:25], v[52:59], v1
 v_cvt_pk_bf16_f32 v65, v66, v67
 v_or_b32 v64, 1, v64
 buffer_store_dwordx2 v[64:65], v8, s[4:7], s58 offen sc1
 s_add_u32 s52, s52, 262144
 s_add_u32 s65, s65, s27
 s_mov_b64 s[28:29], -1
 s_sub_i32 s64, s50, s71
 s_mov_b32 s27, 131072
 v_cvt_pk_bf16_f32 v68, v68, v69
 v_cvt_pk_bf16_f32 v69, v70, v71
 v_or_b32 v68, 1, v68
 buffer_store_dwordx2 v[68:69], v8, s[4:7], s59 offen sc1
 s_barrier
 s_cmp_ge_u32 s48, 8
 s_cbranch_scc1 L_nored_208
 s_nop 15
 s_nop 15
 s_nop 15
 s_nop 7
 buffer_load_dwordx4 v[10:13], v0, s[4:7], s60 offen offset:0 sc1
 buffer_load_dwordx4 v[14:17], v0, s[4:7], s60 offen offset:1024 sc1
 buffer_load_dwordx4 v[18:21], v0, s[4:7], s60 offen offset:2048 sc1
 buffer_load_dwordx4 v[22:25], v0, s[4:7], s60 offen offset:3072 sc1
 v_and_b32 v34, 16, v0
 v_mov_b32 v30, 0x3f80
 v_lshlrev_b32 v30, v34, v30
 v_bfe_u32 v34, v0, 5, 3
 v_cmp_eq_u32 vcc, 0, v34
 s_nop 1
 v_cndmask_b32 v26, 0, v30, vcc
 v_cmp_eq_u32 vcc, 1, v34
 s_nop 1
 v_cndmask_b32 v27, 0, v30, vcc
 v_cmp_eq_u32 vcc, 2, v34
 s_nop 1
 v_cndmask_b32 v28, 0, v30, vcc
 v_cmp_eq_u32 vcc, 3, v34
 s_nop 1
 v_cndmask_b32 v29, 0, v30, vcc
 v_and_b32 v35, 0xf0, v0
 v_bfe_u32 v34, v0, 8, 2
 v_lshl_add_u32 v35, v34, 2, v35
 v_and_b32 v34, 0x80, v0
 v_lshl_add_u32 v35, v34, 23, v35
 v_mov_b64 v[42:43], 0
 v_mov_b64 v[44:45], 0
 v_mov_b64 v[46:47], 0
 v_mov_b64 v[48:49], 0
 v_mov_b64 v[50:51], 0
 v_mov_b64 v[52:53], 0
 v_and_b32 v70, 0xf0, v0
 v_bfe_u32 v71, v0, 8, 2
 v_lshl_add_u32 v71, v71, 9, s67
 v_add_u32 v70, v70, v71
 v_add_u32 v9, 57344, v3
 s_barrier
 s_waitcnt vmcnt(3)
 v_mfma_f32_16x16x32_bf16 v[30:33], v[10:13], v[26:29], 0
 v_bitop3_b32 v34, v10, v12, v12 bitop3:0x80
 s_waitcnt vmcnt(2)
 v_mfma_f32_16x16x32_bf16 v[30:33], v[14:17], v[26:29], v[30:33]
 v_bitop3_b32 v34, v34, v14, v16 bitop3:0x80
 s_waitcnt vmcnt(1)
 v_mfma_f32_16x16x32_bf16 v[30:33], v[18:21], v[26:29], v[30:33]
 v_bitop3_b32 v34, v34, v18, v20 bitop3:0x80
 s_waitcnt vmcnt(0)
 v_mfma_f32_16x16x32_bf16 v[30:33], v[22:25], v[26:29], v[30:33]
 v_bitop3_b32 v34, v34, v22, v24 bitop3:0x80
 v_and_b32 v34, 1, v34
 v_cmp_ne_u32 vcc, 1, v34
 s_cbranch_vccnz L_rre_210
 s_nop 3
 v_permlane32_swap_b32 v30, v31
 v_permlane32_swap_b32 v32, v33
 v_add_f32 v30, v30, v31
 v_add_f32 v32, v32, v33
 v_cvt_pk_bf16_f32 v30, v30, v32
 v_or_b32 v30, 1, v30
 buffer_store_dword v30, v35, s[4:7], s61 offen sc1
L_rback_211:
L_redj_209:
 ds_read_b128 v[26:29], v3 offset:0
 ds_read_b128 v[30:33], v3 offset:1024
 ds_read_b128 v[62:65], v3 offset:8192
 ds_read_b128 v[66:69], v3 offset:9216
 ds_read_b128 v[34:37], v3 offset:16384
 ds_read_b128 v[38:41], v3 offset:17408
 s_barrier
 s_mov_b32 m0, 4096
 s_nop 0
 buffer_load_dwordx4 v0, s[4:7], s25 offen offset:2048 sc1 lds
 buffer_load_dwordx4 v0, s[4:7], s25 offen offset:3072 sc1 lds
 s_branch L_loop_196
L_last_197:
 s_waitcnt lgkmcnt(0)
 s_barrier
 ds_read_b128 v[10:13], v4 offset:0
 ds_read_b128 v[14:17], v4 offset:512
 ds_read_b128 v[18:21], v4 offset:1024
 s_waitcnt lgkmcnt(2)
 v_smfmac_f32_16x16x64_bf16 v[50:53], v[10:13], a[8:15], v1
 v_smfmac_f32_16x16x64_bf16 v[42:45], v[10:13], v[72:79], v1
 ds_read_b128 v[22:25], v4 offset:1536
 v_smfmac_f32_16x16x64_bf16 v[46:49], v[10:13], v[80:87], v1
 s_mov_b32 m0, 4096
 s_cmp_eq_u32 s50, 0
 s_cbranch_scc1 L_mb2skip_212
 buffer_load_dwordx4 v0, s[4:7], s25 offen offset:2048 sc1 lds
 buffer_load_dwordx4 v0, s[4:7], s25 offen offset:3072 sc1 lds
L_mb2skip_212:
 s_waitcnt lgkmcnt(2)
 v_smfmac_f32_16x16x64_bf16 v[50:53], v[14:17], a[16:23], v1
 v_smfmac_f32_16x16x64_bf16 v[42:45], v[14:17], v[88:95], v1
 ds_read_b128 v[10:13], v4 offset:2048
 v_smfmac_f32_16x16x64_bf16 v[46:49], v[14:17], v[26:33], v1
 ds_read_b128 v[26:29], v3 offset:24576
 s_waitcnt lgkmcnt(3)
 v_smfmac_f32_16x16x64_bf16 v[50:53], v[18:21], a[24:31], v1
 ds_read_b128 v[30:33], v3 offset:25600
 v_smfmac_f32_16x16x64_bf16 v[42:45], v[18:21], v[96:103], v1
 ds_read_b128 v[14:17], v4 offset:2560
 v_smfmac_f32_16x16x64_bf16 v[46:49], v[18:21], v[62:69], v1
 s_waitcnt vmcnt(2)
 ds_read_b128 v[62:65], v0 offset:6144
 ds_read_b128 v[66:69], v0 offset:7168
 s_waitcnt lgkmcnt(6)
 v_smfmac_f32_16x16x64_bf16 v[50:53], v[22:25], a[32:39], v1
 v_smfmac_f32_16x16x64_bf16 v[42:45], v[22:25], v[104:111], v1
 ds_read_b128 v[18:21], v4 offset:3072
 v_smfmac_f32_16x16x64_bf16 v[46:49], v[22:25], v[34:41], v1
 ds_read_b128 v[34:37], v3 offset:32768
 s_waitcnt lgkmcnt(7)
 v_smfmac_f32_16x16x64_bf16 v[50:53], v[10:13], a[40:47], v1
 ds_read_b128 v[38:41], v3 offset:33792
 v_smfmac_f32_16x16x64_bf16 v[42:45], v[10:13], v[112:119], v1
 s_waitcnt lgkmcnt(3)
 ds_read_b128 v[22:25], v4 offset:3584
 v_bitop3_b32 v62, v62, v63, v64 bitop3:0xfe
 v_bitop3_b32 v62, v62, v65, v65 bitop3:0xfe
 v_smfmac_f32_16x16x64_bf16 v[46:49], v[10:13], v[26:33], v1
 ds_read_b128 v[26:29], v3 offset:40960
 v_bitop3_b32 v62, v62, v66, v67 bitop3:0xfe
 v_smfmac_f32_16x16x64_bf16 v[50:53], v[14:17], a[48:55], v1
 ds_read_b128 v[30:33], v3 offset:41984
 v_bitop3_b32 v62, v62, v68, v69 bitop3:0xfe
 v_bitop3_b32 v62, v62, v62, s28 bitop3:0xa0
 v_smfmac_f32_16x16x64_bf16 v[42:45], v[14:17], v[120:127], v1
 v_and_b32 v62, 1, v62
 v_smfmac_f32_16x16x64_bf16 v[46:49], v[14:17], v[128:135], v1
 v_cmp_ne_u32 vcc, 0, v62
 s_waitcnt lgkmcnt(5)
 v_smfmac_f32_16x16x64_bf16 v[50:53], v[18:21], a[56:63], v1
 s_cbranch_vccnz L_mbre_214
L_mbok_213:
 s_barrier
 v_smfmac_f32_16x16x64_bf16 v[42:45], v[18:21], v[136:143], v1
 ds_read_b128 v[10:13], v4 offset:4096
 ds_read_b128 v[14:17], v4 offset:4608
 s_waitcnt lgkmcnt(5)
 v_smfmac_f32_16x16x64_bf16 v[46:49], v[18:21], v[34:41], v1
 ds_read_b128 v[34:37], v3 offset:49152
 s_waitcnt lgkmcnt(5)
 v_smfmac_f32_16x16x64_bf16 v[50:53], v[22:25], a[64:71], v1
 ds_read_b128 v[38:41], v3 offset:50176
 v_smfmac_f32_16x16x64_bf16 v[42:45], v[22:25], v[144:151], v1
 ds_read_b128 v[18:21], v4 offset:5120
 s_waitcnt lgkmcnt(5)
 v_smfmac_f32_16x16x64_bf16 v[46:49], v[22:25], v[26:33], v1
 ds_read_b128 v[26:29], v9 offset:0
 s_waitcnt lgkmcnt(5)
 v_smfmac_f32_16x16x64_bf16 v[50:53], v[10:13], a[72:79], v1
 ds_read_b128 v[30:33], v9 offset:1024
 v_smfmac_f32_16x16x64_bf16 v[42:45], v[10:13], v[152:159], v1
 ds_read_b128 v[22:25], v4 offset:5632
 v_smfmac_f32_16x16x64_bf16 v[46:49], v[10:13], v[160:167], v1
 s_waitcnt lgkmcnt(6)
 v_smfmac_f32_16x16x64_bf16 v[50:53], v[14:17], a[80:87], v1
 v_smfmac_f32_16x16x64_bf16 v[42:45], v[14:17], v[168:175], v1
 ds_read_b128 v[10:13], v4 offset:6144
 s_waitcnt lgkmcnt(5)
 v_smfmac_f32_16x16x64_bf16 v[46:49], v[14:17], v[34:41], v1
 ds_read_b128 v[34:37], v9 offset:8192
 s_waitcnt lgkmcnt(5)
 v_smfmac_f32_16x16x64_bf16 v[50:53], v[18:21], a[88:95], v1
 ds_read_b128 v[38:41], v9 offset:9216
 v_smfmac_f32_16x16x64_bf16 v[42:45], v[18:21], v[176:183], v1
 ds_read_b128 v[14:17], v4 offset:6656
 s_waitcnt lgkmcnt(5)
 v_smfmac_f32_16x16x64_bf16 v[46:49], v[18:21], v[26:33], v1
 ds_read_b128 v[26:29], v9 offset:16384
 s_waitcnt lgkmcnt(5)
 v_smfmac_f32_16x16x64_bf16 v[50:53], v[22:25], a[96:103], v1
 ds_read_b128 v[30:33], v9 offset:17408
 v_smfmac_f32_16x16x64_bf16 v[42:45], v[22:25], v[184:191], v1
 ds_read_b128 v[18:21], v4 offset:7168
 v_smfmac_f32_16x16x64_bf16 v[46:49], v[22:25], v[192:199], v1
 ds_read_b128 v[62:65], v9 offset:24576
 s_waitcnt lgkmcnt(7)
 v_smfmac_f32_16x16x64_bf16 v[42:45], v[10:13], v[200:207], v1
 ds_read_b128 v[66:69], v9 offset:25600
 ds_read_b128 v[22:25], v4 offset:7680
 s_waitcnt lgkmcnt(7)
 v_smfmac_f32_16x16x64_bf16 v[46:49], v[10:13], v[34:41], v1
 ds_read_b128 v[34:37], v9 offset:32768
 s_waitcnt lgkmcnt(7)
 v_smfmac_f32_16x16x64_bf16 v[42:45], v[14:17], v[208:215], v1
 ds_read_b128 v[38:41], v9 offset:33792
 ds_read_b128 v[10:13], v4 offset:8192
 s_waitcnt lgkmcnt(7)
 v_smfmac_f32_16x16x64_bf16 v[46:49], v[14:17], v[26:33], v1
 s_waitcnt lgkmcnt(6)
 v_smfmac_f32_16x16x64_bf16 v[42:45], v[18:21], v[216:223], v1
 ds_read_b128 v[14:17], v4 offset:8704
 s_waitcnt lgkmcnt(5)
 v_smfmac_f32_16x16x64_bf16 v[46:49], v[18:21], v[62:69], v1
 s_waitcnt lgkmcnt(4)
 v_smfmac_f32_16x16x64_bf16 v[42:45], v[22:25], v[224:231], v1
 ds_read_b128 v[18:21], v4 offset:6144
 s_waitcnt lgkmcnt(3)
 v_smfmac_f32_16x16x64_bf16 v[46:49], v[22:25], v[34:41], v1
 ds_read_b128 v[66:69], v0 offset:14656
 s_waitcnt lgkmcnt(3)
 v_smfmac_f32_16x16x64_bf16 v[42:45], v[10:13], v[232:239], v1
 ds_read_b128 v[22:25], v4 offset:6656
 v_smfmac_f32_16x16x64_bf16 v[46:49], v[10:13], v[240:247], v1
 s_waitcnt lgkmcnt(3)
 v_smfmac_f32_16x16x64_bf16 v[42:45], v[14:17], v[248:255], v1
 ds_read_b128 v[10:13], v4 offset:7168
 v_smfmac_f32_16x16x64_bf16 v[46:49], v[14:17], a[0:7], v1
 ds_read_b128 v[14:17], v4 offset:7680
 s_waitcnt lgkmcnt(4)
 v_smfmac_f32_16x16x64_bf16 v[50:53], v[18:21], a[104:111], v1
 s_nop 1
 s_waitcnt lgkmcnt(2)
 v_smfmac_f32_16x16x64_bf16 v[50:53], v[22:25], a[112:119], v1
 s_nop 2
 v_cvt_pk_bf16_f32 v62, v42, v43
 v_cvt_pk_bf16_f32 v63, v44, v45
 ds_write_b64 v5, v[62:63]
 v_cvt_pk_bf16_f32 v64, v46, v47
 v_cvt_pk_bf16_f32 v65, v48, v49
 ds_write_b64 v5, v[64:65] offset:2176
 ds_read_b128 v[42:45], v4 offset:8192
 ds_read_b128 v[46:49], v4 offset:8704
 s_waitcnt lgkmcnt(5)
 v_smfmac_f32_16x16x64_bf16 v[50:53], v[10:13], a[120:127], v1
 buffer_store_dwordx4 v[66:69], v0, s[4:7], s65 offen offset:0 sc1
 s_waitcnt lgkmcnt(4)
 v_smfmac_f32_16x16x64_bf16 v[50:53], v[14:17], a[128:135], v1
 s_waitcnt lgkmcnt(2)
 s_barrier
 s_waitcnt lgkmcnt(1)
 v_smfmac_f32_16x16x64_bf16 v[50:53], v[42:45], a[136:143], v1
 s_waitcnt lgkmcnt(0)
 v_smfmac_f32_16x16x64_bf16 v[50:53], v[46:49], a[144:151], v1
 s_nop 7
 v_cvt_pk_bf16_f32 v40, v50, v51
 v_cvt_pk_bf16_f32 v41, v52, v53
 ds_write_b64 v5, v[40:41] offset:4352
 s_add_u32 s65, s65, 131072
 s_waitcnt vmcnt(0) lgkmcnt(0)
 s_barrier
 ds_read_b128 v[66:69], v0 offset:14656
 s_waitcnt lgkmcnt(0)
 v_or_b32 v66, 1, v66
 v_or_b32 v67, 1, v67
 v_or_b32 v68, 1, v68
 v_or_b32 v69, 1, v69
 buffer_store_dwordx4 v[66:69], v0, s[4:7], s65 offen offset:0 sc1
 s_branch L_done1
L_mbre_200:
 s_mov_b32 m0, 4096
 s_nop 0
 buffer_load_dwordx4 v0, s[4:7], s25 offen offset:2048 sc1 lds
 buffer_load_dwordx4 v0, s[4:7], s25 offen offset:3072 sc1 lds
 s_add_u32 s51, s51, 65536
 s_waitcnt vmcnt(3)
 ds_read_b128 v[62:65], v0 offset:6144
 ds_read_b128 v[66:69], v0 offset:7168
 s_waitcnt lgkmcnt(0)
 v_bitop3_b32 v62, v62, v63, v64 bitop3:0x80
 v_bitop3_b32 v62, v62, v65, v65 bitop3:0x80
 v_bitop3_b32 v62, v62, v66, v67 bitop3:0x80
 v_bitop3_b32 v62, v62, v68, v69 bitop3:0x80
 v_bitop3_b32 v62, v62, v62, s28 bitop3:0xf5
 v_and_b32 v62, 1, v62
 v_cmp_ne_u32 vcc, 1, v62
 s_cbranch_vccz L_mbok_199
 s_mov_b32 m0, 4096
 s_nop 0
 buffer_load_dwordx4 v0, s[4:7], s25 offen offset:2048 sc1 lds
 buffer_load_dwordx4 v0, s[4:7], s25 offen offset:3072 sc1 lds
 s_nop 15
 s_nop 3
L_mbspin_215:
 s_mov_b32 m0, 4096
 s_nop 0
 buffer_load_dwordx4 v0, s[4:7], s25 offen offset:2048 sc1 lds
 buffer_load_dwordx4 v0, s[4:7], s25 offen offset:3072 sc1 lds
 s_add_u32 s51, s51, 65536
 s_cmp_gt_u32 s51, 1310720000
 s_cbranch_scc1 L_exit1
 s_waitcnt vmcnt(4)
 ds_read_b128 v[62:65], v0 offset:6144
 ds_read_b128 v[66:69], v0 offset:7168
 s_waitcnt lgkmcnt(0)
 v_bitop3_b32 v62, v62, v63, v64 bitop3:0x80
 v_bitop3_b32 v62, v62, v65, v65 bitop3:0x80
 v_bitop3_b32 v62, v62, v66, v67 bitop3:0x80
 v_bitop3_b32 v62, v62, v68, v69 bitop3:0x80
 v_bitop3_b32 v62, v62, v62, s28 bitop3:0xf5
 v_and_b32 v62, 1, v62
 v_cmp_ne_u32 vcc, 1, v62
 s_cbranch_vccnz L_mbspin_215
 s_branch L_mbok_199
L_nored_201:
 v_mov_b64 v[42:43], 0
 v_mov_b64 v[44:45], 0
 v_mov_b64 v[46:47], 0
 v_mov_b64 v[48:49], 0
 v_mov_b64 v[50:51], 0
 v_mov_b64 v[52:53], 0
 v_and_b32 v70, 0xf0, v0
 v_bfe_u32 v71, v0, 8, 2
 v_lshl_add_u32 v71, v71, 9, s67
 v_add_u32 v70, v70, v71
 v_add_u32 v9, 57344, v3
 s_barrier
 s_branch L_redj_202
L_rre_203:
 buffer_load_dwordx4 v[10:13], v0, s[4:7], s60 offen offset:0 sc1
 buffer_load_dwordx4 v[14:17], v0, s[4:7], s60 offen offset:1024 sc1
 buffer_load_dwordx4 v[18:21], v0, s[4:7], s60 offen offset:2048 sc1
 buffer_load_dwordx4 v[22:25], v0, s[4:7], s60 offen offset:3072 sc1
 s_nop 15
 s_nop 7
L_rspin_216:
 buffer_load_dwordx4 v[54:57], v0, s[4:7], s60 offen offset:0 sc1
 buffer_load_dwordx4 v[58:61], v0, s[4:7], s60 offen offset:1024 sc1
 buffer_load_dwordx4 v[62:65], v0, s[4:7], s60 offen offset:2048 sc1
 buffer_load_dwordx4 v[66:69], v0, s[4:7], s60 offen offset:3072 sc1
 s_add_u32 s51, s51, 1
 s_waitcnt vmcnt(7)
 v_mfma_f32_16x16x32_bf16 v[30:33], v[10:13], v[26:29], 0
 v_bitop3_b32 v34, v10, v12, v12 bitop3:0xfe
 s_waitcnt vmcnt(6)
 v_mfma_f32_16x16x32_bf16 v[30:33], v[14:17], v[26:29], v[30:33]
 v_bitop3_b32 v34, v34, v14, v16 bitop3:0xfe
 s_waitcnt vmcnt(5)
 v_mfma_f32_16x16x32_bf16 v[30:33], v[18:21], v[26:29], v[30:33]
 v_bitop3_b32 v34, v34, v18, v20 bitop3:0xfe
 s_waitcnt vmcnt(4)
 v_mfma_f32_16x16x32_bf16 v[30:33], v[22:25], v[26:29], v[30:33]
 v_bitop3_b32 v34, v34, v22, v24 bitop3:0xfe
 v_and_b32 v34, 1, v34
 v_cmp_ne_u32 vcc, 0, v34
 s_cbranch_vccz L_rok_217
 buffer_load_dwordx4 v[10:13], v0, s[4:7], s60 offen offset:0 sc1
 buffer_load_dwordx4 v[14:17], v0, s[4:7], s60 offen offset:1024 sc1
 buffer_load_dwordx4 v[18:21], v0, s[4:7], s60 offen offset:2048 sc1
 buffer_load_dwordx4 v[22:25], v0, s[4:7], s60 offen offset:3072 sc1
 s_add_u32 s51, s51, 1
 s_waitcnt vmcnt(7)
 v_mfma_f32_16x16x32_bf16 v[30:33], v[54:57], v[26:29], 0
 v_bitop3_b32 v34, v54, v56, v56 bitop3:0xfe
 s_waitcnt vmcnt(6)
 v_mfma_f32_16x16x32_bf16 v[30:33], v[58:61], v[26:29], v[30:33]
 v_bitop3_b32 v34, v34, v58, v60 bitop3:0xfe
 s_waitcnt vmcnt(5)
 v_mfma_f32_16x16x32_bf16 v[30:33], v[62:65], v[26:29], v[30:33]
 v_bitop3_b32 v34, v34, v62, v64 bitop3:0xfe
 s_waitcnt vmcnt(4)
 v_mfma_f32_16x16x32_bf16 v[30:33], v[66:69], v[26:29], v[30:33]
 v_bitop3_b32 v34, v34, v66, v68 bitop3:0xfe
 v_and_b32 v34, 1, v34
 v_cmp_ne_u32 vcc, 0, v34
 s_cbranch_vccz L_rok_217
 s_and_b32 s3, s51, 0xffff
 s_cmp_gt_u32 s3, 20000
 s_cbranch_scc0 L_rspin_216
 s_branch L_exit1
L_rok_217:
 s_nop 3
 v_permlane32_swap_b32 v30, v31
 v_permlane32_swap_b32 v32, v33
 v_add_f32 v30, v30, v31
 v_add_f32 v32, v32, v33
 v_cvt_pk_bf16_f32 v30, v30, v32
 v_and_b32 v30, -2, v30
 buffer_store_dword v30, v35, s[4:7], s61 offen sc1
 s_waitcnt vmcnt(1)
 s_branch L_rback_204
L_mbre_207:
 s_mov_b32 m0, 4096
 s_nop 0
 buffer_load_dwordx4 v0, s[4:7], s25 offen offset:2048 sc1 lds
 buffer_load_dwordx4 v0, s[4:7], s25 offen offset:3072 sc1 lds
 s_add_u32 s51, s51, 65536
 s_waitcnt vmcnt(3)
 ds_read_b128 v[62:65], v0 offset:6144
 ds_read_b128 v[66:69], v0 offset:7168
 s_waitcnt lgkmcnt(0)
 v_bitop3_b32 v62, v62, v63, v64 bitop3:0xfe
 v_bitop3_b32 v62, v62, v65, v65 bitop3:0xfe
 v_bitop3_b32 v62, v62, v66, v67 bitop3:0xfe
 v_bitop3_b32 v62, v62, v68, v69 bitop3:0xfe
 v_bitop3_b32 v62, v62, v62, s28 bitop3:0xa0
 v_and_b32 v62, 1, v62
 v_cmp_ne_u32 vcc, 0, v62
 s_cbranch_vccz L_mbok_206
 s_mov_b32 m0, 4096
 s_nop 0
 buffer_load_dwordx4 v0, s[4:7], s25 offen offset:2048 sc1 lds
 buffer_load_dwordx4 v0, s[4:7], s25 offen offset:3072 sc1 lds
 s_nop 15
 s_nop 3
L_mbspin_218:
 s_mov_b32 m0, 4096
 s_nop 0
 buffer_load_dwordx4 v0, s[4:7], s25 offen offset:2048 sc1 lds
 buffer_load_dwordx4 v0, s[4:7], s25 offen offset:3072 sc1 lds
 s_add_u32 s51, s51, 65536
 s_cmp_gt_u32 s51, 1310720000
 s_cbranch_scc1 L_exit1
 s_waitcnt vmcnt(4)
 ds_read_b128 v[62:65], v0 offset:6144
 ds_read_b128 v[66:69], v0 offset:7168
 s_waitcnt lgkmcnt(0)
 v_bitop3_b32 v62, v62, v63, v64 bitop3:0xfe
 v_bitop3_b32 v62, v62, v65, v65 bitop3:0xfe
 v_bitop3_b32 v62, v62, v66, v67 bitop3:0xfe
 v_bitop3_b32 v62, v62, v68, v69 bitop3:0xfe
 v_bitop3_b32 v62, v62, v62, s28 bitop3:0xa0
 v_and_b32 v62, 1, v62
 v_cmp_ne_u32 vcc, 0, v62
 s_cbranch_vccnz L_mbspin_218
 s_branch L_mbok_206
L_nored_208:
 v_mov_b64 v[42:43], 0
 v_mov_b64 v[44:45], 0
 v_mov_b64 v[46:47], 0
 v_mov_b64 v[48:49], 0
 v_mov_b64 v[50:51], 0
 v_mov_b64 v[52:53], 0
 v_and_b32 v70, 0xf0, v0
 v_bfe_u32 v71, v0, 8, 2
 v_lshl_add_u32 v71, v71, 9, s67
 v_add_u32 v70, v70, v71
 v_add_u32 v9, 57344, v3
 s_barrier
 s_branch L_redj_209
L_rre_210:
 buffer_load_dwordx4 v[10:13], v0, s[4:7], s60 offen offset:0 sc1
 buffer_load_dwordx4 v[14:17], v0, s[4:7], s60 offen offset:1024 sc1
 buffer_load_dwordx4 v[18:21], v0, s[4:7], s60 offen offset:2048 sc1
 buffer_load_dwordx4 v[22:25], v0, s[4:7], s60 offen offset:3072 sc1
 s_nop 15
 s_nop 7
L_rspin_219:
 buffer_load_dwordx4 v[54:57], v0, s[4:7], s60 offen offset:0 sc1
 buffer_load_dwordx4 v[58:61], v0, s[4:7], s60 offen offset:1024 sc1
 buffer_load_dwordx4 v[62:65], v0, s[4:7], s60 offen offset:2048 sc1
 buffer_load_dwordx4 v[66:69], v0, s[4:7], s60 offen offset:3072 sc1
 s_add_u32 s51, s51, 1
 s_waitcnt vmcnt(7)
 v_mfma_f32_16x16x32_bf16 v[30:33], v[10:13], v[26:29], 0
 v_bitop3_b32 v34, v10, v12, v12 bitop3:0x80
 s_waitcnt vmcnt(6)
 v_mfma_f32_16x16x32_bf16 v[30:33], v[14:17], v[26:29], v[30:33]
 v_bitop3_b32 v34, v34, v14, v16 bitop3:0x80
 s_waitcnt vmcnt(5)
 v_mfma_f32_16x16x32_bf16 v[30:33], v[18:21], v[26:29], v[30:33]
 v_bitop3_b32 v34, v34, v18, v20 bitop3:0x80
 s_waitcnt vmcnt(4)
 v_mfma_f32_16x16x32_bf16 v[30:33], v[22:25], v[26:29], v[30:33]
 v_bitop3_b32 v34, v34, v22, v24 bitop3:0x80
 v_and_b32 v34, 1, v34
 v_cmp_ne_u32 vcc, 1, v34
 s_cbranch_vccz L_rok_220
 buffer_load_dwordx4 v[10:13], v0, s[4:7], s60 offen offset:0 sc1
 buffer_load_dwordx4 v[14:17], v0, s[4:7], s60 offen offset:1024 sc1
 buffer_load_dwordx4 v[18:21], v0, s[4:7], s60 offen offset:2048 sc1
 buffer_load_dwordx4 v[22:25], v0, s[4:7], s60 offen offset:3072 sc1
 s_add_u32 s51, s51, 1
 s_waitcnt vmcnt(7)
 v_mfma_f32_16x16x32_bf16 v[30:33], v[54:57], v[26:29], 0
 v_bitop3_b32 v34, v54, v56, v56 bitop3:0x80
 s_waitcnt vmcnt(6)
 v_mfma_f32_16x16x32_bf16 v[30:33], v[58:61], v[26:29], v[30:33]
 v_bitop3_b32 v34, v34, v58, v60 bitop3:0x80
 s_waitcnt vmcnt(5)
 v_mfma_f32_16x16x32_bf16 v[30:33], v[62:65], v[26:29], v[30:33]
 v_bitop3_b32 v34, v34, v62, v64 bitop3:0x80
 s_waitcnt vmcnt(4)
 v_mfma_f32_16x16x32_bf16 v[30:33], v[66:69], v[26:29], v[30:33]
 v_bitop3_b32 v34, v34, v66, v68 bitop3:0x80
 v_and_b32 v34, 1, v34
 v_cmp_ne_u32 vcc, 1, v34
 s_cbranch_vccz L_rok_220
 s_and_b32 s3, s51, 0xffff
 s_cmp_gt_u32 s3, 20000
 s_cbranch_scc0 L_rspin_219
 s_branch L_exit1
L_rok_220:
 s_nop 3
 v_permlane32_swap_b32 v30, v31
 v_permlane32_swap_b32 v32, v33
 v_add_f32 v30, v30, v31
 v_add_f32 v32, v32, v33
 v_cvt_pk_bf16_f32 v30, v30, v32
 v_or_b32 v30, 1, v30
 buffer_store_dword v30, v35, s[4:7], s61 offen sc1
 s_waitcnt vmcnt(1)
 s_branch L_rback_211
L_mbre_214:
 s_mov_b32 m0, 4096
 s_nop 0
 buffer_load_dwordx4 v0, s[4:7], s25 offen offset:2048 sc1 lds
 buffer_load_dwordx4 v0, s[4:7], s25 offen offset:3072 sc1 lds
 s_add_u32 s51, s51, 65536
 s_waitcnt vmcnt(2)
 ds_read_b128 v[62:65], v0 offset:6144
 ds_read_b128 v[66:69], v0 offset:7168
 s_waitcnt lgkmcnt(0)
 v_bitop3_b32 v62, v62, v63, v64 bitop3:0xfe
 v_bitop3_b32 v62, v62, v65, v65 bitop3:0xfe
 v_bitop3_b32 v62, v62, v66, v67 bitop3:0xfe
 v_bitop3_b32 v62, v62, v68, v69 bitop3:0xfe
 v_bitop3_b32 v62, v62, v62, s28 bitop3:0xa0
 v_and_b32 v62, 1, v62
 v_cmp_ne_u32 vcc, 0, v62
 s_cbranch_vccz L_mbok_213
 s_mov_b32 m0, 4096
 s_nop 0
 buffer_load_dwordx4 v0, s[4:7], s25 offen offset:2048 sc1 lds
 buffer_load_dwordx4 v0, s[4:7], s25 offen offset:3072 sc1 lds
 s_nop 15
 s_nop 3
L_mbspin_221:
 s_mov_b32 m0, 4096
 s_nop 0
 buffer_load_dwordx4 v0, s[4:7], s25 offen offset:2048 sc1 lds
 buffer_load_dwordx4 v0, s[4:7], s25 offen offset:3072 sc1 lds
 s_add_u32 s51, s51, 65536
 s_cmp_gt_u32 s51, 1310720000
 s_cbranch_scc1 L_exit1
 s_waitcnt vmcnt(4)
 ds_read_b128 v[62:65], v0 offset:6144
 ds_read_b128 v[66:69], v0 offset:7168
 s_waitcnt lgkmcnt(0)
 v_bitop3_b32 v62, v62, v63, v64 bitop3:0xfe
 v_bitop3_b32 v62, v62, v65, v65 bitop3:0xfe
 v_bitop3_b32 v62, v62, v66, v67 bitop3:0xfe
 v_bitop3_b32 v62, v62, v68, v69 bitop3:0xfe
 v_bitop3_b32 v62, v62, v62, s28 bitop3:0xa0
 v_and_b32 v62, 1, v62
 v_cmp_ne_u32 vcc, 0, v62
 s_cbranch_vccnz L_mbspin_221
 s_branch L_mbok_213
L_wave3_139:
 v_mov_b64 v[42:43], 0
 v_mov_b64 v[44:45], 0
 v_mov_b64 v[46:47], 0
 v_mov_b64 v[48:49], 0
 v_mov_b64 v[50:51], 0
 v_mov_b64 v[52:53], 0
 v_and_b32 v70, 0xf0, v0
 v_bfe_u32 v71, v0, 8, 2
 v_lshl_add_u32 v71, v71, 9, s67
 v_add_u32 v70, v70, v71
 v_add_u32 v9, 57344, v3
 ds_read_b128 v[26:29], v3 offset:0
 ds_read_b128 v[30:33], v3 offset:1024
 ds_read_b128 v[62:65], v3 offset:8192
 ds_read_b128 v[66:69], v3 offset:9216
 ds_read_b128 v[34:37], v3 offset:16384
 ds_read_b128 v[38:41], v3 offset:17408
 .p2align 6
L_loop_222:
 s_waitcnt lgkmcnt(0)
 s_barrier
 s_mov_b32 s51, 0
 ds_read_b128 v[10:13], v4 offset:0
 ds_read_b128 v[14:17], v4 offset:512
 s_waitcnt vmcnt(3)
 ds_read_b128 v[18:21], v4 offset:1024
 s_add_u32 s72, s52, 16777216
 buffer_load_dwordx4 v[54:57], v70, s[4:7], s72 offen sc1
 buffer_load_dwordx4 v[58:61], v70, s[4:7], s72 offen offset:256 sc1
 s_waitcnt lgkmcnt(2)
 v_smfmac_f32_16x16x64_bf16 v[50:53], v[10:13], a[8:15], v1
 v_lshlrev_b32 v71, 2, v0
 v_smfmac_f32_16x16x64_bf16 v[42:45], v[10:13], v[72:79], v1
 ds_read_b128 v[22:25], v4 offset:1536
 v_smfmac_f32_16x16x64_bf16 v[46:49], v[10:13], v[80:87], v1
 s_mov_b32 m0, 8192
 s_cmp_eq_u32 s50, 0
 s_cbranch_scc1 L_mb2skip_224
 buffer_load_dwordx4 v0, s[4:7], s26 offen offset:0 sc1 lds
L_mb2skip_224:
 s_waitcnt lgkmcnt(2)
 v_smfmac_f32_16x16x64_bf16 v[50:53], v[14:17], a[16:23], v1
 v_smfmac_f32_16x16x64_bf16 v[42:45], v[14:17], v[88:95], v1
 ds_read_b128 v[10:13], v4 offset:2048
 v_smfmac_f32_16x16x64_bf16 v[46:49], v[14:17], v[26:33], v1
 ds_read_b128 v[26:29], v3 offset:24576
 s_add_u32 s73, s52, 524288
 s_min_u32 s73, s73, 16515072
 s_add_u32 s73, s73, s68
 s_waitcnt lgkmcnt(3)
 v_smfmac_f32_16x16x64_bf16 v[50:53], v[18:21], a[24:31], v1
 ds_read_b128 v[30:33], v3 offset:25600
 v_smfmac_f32_16x16x64_bf16 v[42:45], v[18:21], v[96:103], v1
 ds_read_b128 v[14:17], v4 offset:2560
 s_mov_b32 m0, 23936
 s_nop 0
 buffer_load_dword v71, s[4:7], s73 offen sc1 lds
 v_smfmac_f32_16x16x64_bf16 v[46:49], v[18:21], v[62:69], v1
 s_waitcnt vmcnt(4)
 ds_read_b128 v[62:65], v0 offset:8192
 s_waitcnt lgkmcnt(5)
 v_smfmac_f32_16x16x64_bf16 v[50:53], v[22:25], a[32:39], v1
 v_smfmac_f32_16x16x64_bf16 v[42:45], v[22:25], v[104:111], v1
 ds_read_b128 v[18:21], v4 offset:3072
 v_smfmac_f32_16x16x64_bf16 v[46:49], v[22:25], v[34:41], v1
 ds_read_b128 v[34:37], v3 offset:32768
 s_waitcnt lgkmcnt(6)
 v_smfmac_f32_16x16x64_bf16 v[50:53], v[10:13], a[40:47], v1
 ds_read_b128 v[38:41], v3 offset:33792
 v_smfmac_f32_16x16x64_bf16 v[42:45], v[10:13], v[112:119], v1
 s_waitcnt lgkmcnt(3)
 ds_read_b128 v[22:25], v4 offset:3584
 v_bitop3_b32 v62, v62, v63, v64 bitop3:0x80
 v_bitop3_b32 v62, v62, v65, v65 bitop3:0x80
 v_smfmac_f32_16x16x64_bf16 v[46:49], v[10:13], v[26:33], v1
 ds_read_b128 v[26:29], v3 offset:40960
 v_bitop3_b32 v62, v62, v62, s28 bitop3:0xf5
 v_smfmac_f32_16x16x64_bf16 v[50:53], v[14:17], a[48:55], v1
 ds_read_b128 v[30:33], v3 offset:41984
 v_and_b32 v62, 1, v62
 v_cmp_ne_u32 vcc, 1, v62
 v_smfmac_f32_16x16x64_bf16 v[42:45], v[14:17], v[120:127], v1
 v_smfmac_f32_16x16x64_bf16 v[46:49], v[14:17], v[128:135], v1
 s_waitcnt lgkmcnt(5)
 v_smfmac_f32_16x16x64_bf16 v[50:53], v[18:21], a[56:63], v1
 s_cbranch_vccnz L_mbre_226
L_mbok_225:
 s_barrier
 v_smfmac_f32_16x16x64_bf16 v[42:45], v[18:21], v[136:143], v1
 ds_read_b128 v[10:13], v4 offset:4096
 ds_read_b128 v[14:17], v4 offset:4608
 s_waitcnt lgkmcnt(5)
 v_smfmac_f32_16x16x64_bf16 v[46:49], v[18:21], v[34:41], v1
 ds_read_b128 v[34:37], v3 offset:49152
 s_waitcnt lgkmcnt(5)
 v_smfmac_f32_16x16x64_bf16 v[50:53], v[22:25], a[64:71], v1
 ds_read_b128 v[38:41], v3 offset:50176
 v_mov_b32 v68, s64
 v_smfmac_f32_16x16x64_bf16 v[42:45], v[22:25], v[144:151], v1
 ds_read_b128 v[18:21], v4 offset:5120
 s_mov_b64 exec, 1
 buffer_store_dword v68, v0, s[4:7], s66 offen sc1
 s_mov_b64 exec, -1
 s_waitcnt lgkmcnt(5)
 v_smfmac_f32_16x16x64_bf16 v[46:49], v[22:25], v[26:33], v1
 ds_read_b128 v[26:29], v9 offset:0
 s_waitcnt lgkmcnt(5)
 v_smfmac_f32_16x16x64_bf16 v[50:53], v[10:13], a[72:79], v1
 ds_read_b128 v[30:33], v9 offset:1024
 v_smfmac_f32_16x16x64_bf16 v[42:45], v[10:13], v[152:159], v1
 ds_read_b128 v[22:25], v4 offset:5632
 v_smfmac_f32_16x16x64_bf16 v[46:49], v[10:13], v[160:167], v1
 s_waitcnt lgkmcnt(6)
 v_smfmac_f32_16x16x64_bf16 v[50:53], v[14:17], a[80:87], v1
 v_smfmac_f32_16x16x64_bf16 v[42:45], v[14:17], v[168:175], v1
 ds_read_b128 v[10:13], v4 offset:6144
 s_waitcnt lgkmcnt(5)
 v_smfmac_f32_16x16x64_bf16 v[46:49], v[14:17], v[34:41], v1
 ds_read_b128 v[34:37], v9 offset:8192
 s_waitcnt lgkmcnt(5)
 v_smfmac_f32_16x16x64_bf16 v[50:53], v[18:21], a[88:95], v1
 ds_read_b128 v[38:41], v9 offset:9216
 v_smfmac_f32_16x16x64_bf16 v[42:45], v[18:21], v[176:183], v1
 ds_read_b128 v[14:17], v4 offset:6656
 s_waitcnt lgkmcnt(5)
 v_smfmac_f32_16x16x64_bf16 v[46:49], v[18:21], v[26:33], v1
 ds_read_b128 v[26:29], v9 offset:16384
 s_waitcnt lgkmcnt(5)
 v_smfmac_f32_16x16x64_bf16 v[50:53], v[22:25], a[96:103], v1
 ds_read_b128 v[30:33], v9 offset:17408
 v_smfmac_f32_16x16x64_bf16 v[42:45], v[22:25], v[184:191], v1
 ds_read_b128 v[18:21], v4 offset:7168
 v_smfmac_f32_16x16x64_bf16 v[46:49], v[22:25], v[192:199], v1
 ds_read_b128 v[62:65], v9 offset:24576
 s_waitcnt lgkmcnt(7)
 v_smfmac_f32_16x16x64_bf16 v[42:45], v[10:13], v[200:207], v1
 ds_read_b128 v[66:69], v9 offset:25600
 ds_read_b128 v[22:25], v4 offset:7680
 s_waitcnt lgkmcnt(7)
 v_smfmac_f32_16x16x64_bf16 v[46:49], v[10:13], v[34:41], v1
 ds_read_b128 v[34:37], v9 offset:32768
 s_waitcnt lgkmcnt(7)
 v_smfmac_f32_16x16x64_bf16 v[42:45], v[14:17], v[208:215], v1
 ds_read_b128 v[38:41], v9 offset:33792
 ds_read_b128 v[10:13], v4 offset:8192
 s_waitcnt lgkmcnt(7)
 v_smfmac_f32_16x16x64_bf16 v[46:49], v[14:17], v[26:33], v1
 s_waitcnt lgkmcnt(6)
 v_smfmac_f32_16x16x64_bf16 v[42:45], v[18:21], v[216:223], v1
 ds_read_b128 v[14:17], v4 offset:8704
 s_waitcnt lgkmcnt(5)
 v_smfmac_f32_16x16x64_bf16 v[46:49], v[18:21], v[62:69], v1
 s_waitcnt lgkmcnt(4)
 v_smfmac_f32_16x16x64_bf16 v[42:45], v[22:25], v[224:231], v1
 ds_read_b128 v[18:21], v4 offset:6144
 s_waitcnt lgkmcnt(3)
 v_smfmac_f32_16x16x64_bf16 v[46:49], v[22:25], v[34:41], v1
 s_waitcnt lgkmcnt(2)
 v_smfmac_f32_16x16x64_bf16 v[42:45], v[10:13], v[232:239], v1
 ds_read_b128 v[22:25], v4 offset:6656
 v_smfmac_f32_16x16x64_bf16 v[46:49], v[10:13], v[240:247], v1
 ds_read_b128 v[26:29], v0 offset:15744
 ds_read_b128 v[30:33], v0 offset:17792
 s_waitcnt lgkmcnt(4)
 v_smfmac_f32_16x16x64_bf16 v[42:45], v[14:17], v[248:255], v1
 ds_read_b128 v[10:13], v4 offset:7168
 v_smfmac_f32_16x16x64_bf16 v[46:49], v[14:17], a[0:7], v1
 ds_read_b128 v[34:37], v0 offset:19840
 ds_read_b128 v[38:41], v0 offset:21888
 ds_read_b128 v[14:17], v4 offset:7680
 s_waitcnt lgkmcnt(7)
 v_smfmac_f32_16x16x64_bf16 v[50:53], v[18:21], a[104:111], v1
 s_nop 1
 s_waitcnt lgkmcnt(6)
 v_smfmac_f32_16x16x64_bf16 v[50:53], v[22:25], a[112:119], v1
 s_nop 2
 v_cvt_pk_bf16_f32 v62, v42, v43
 v_cvt_pk_bf16_f32 v63, v44, v45
 ds_write_b64 v5, v[62:63]
 v_cvt_pk_bf16_f32 v64, v46, v47
 v_cvt_pk_bf16_f32 v65, v48, v49
 ds_write_b64 v5, v[64:65] offset:2176
 ds_read_b128 v[42:45], v4 offset:8192
 ds_read_b128 v[46:49], v4 offset:8704
 s_waitcnt lgkmcnt(7)
 v_smfmac_f32_16x16x64_bf16 v[50:53], v[10:13], a[120:127], v1
 s_waitcnt lgkmcnt(4)
 v_smfmac_f32_16x16x64_bf16 v[50:53], v[14:17], a[128:135], v1
 s_waitcnt lgkmcnt(2)
 s_barrier
 ds_read_b64_tr_b16 v[10:11], v6 offset:0
 ds_read_b64_tr_b16 v[12:13], v6 offset:64
 ds_read_b64_tr_b16 v[14:15], v6 offset:256
 ds_read_b64_tr_b16 v[16:17], v6 offset:320
 s_waitcnt lgkmcnt(5)
 v_smfmac_f32_16x16x64_bf16 v[50:53], v[42:45], a[136:143], v1
 ds_read_b64_tr_b16 v[18:19], v6 offset:512
 ds_read_b64_tr_b16 v[20:21], v6 offset:576
 ds_read_b64_tr_b16 v[22:23], v6 offset:768
 ds_read_b64_tr_b16 v[24:25], v6 offset:832
 s_waitcnt lgkmcnt(8)
 v_smfmac_f32_16x16x64_bf16 v[50:53], v[46:49], a[144:151], v1
 s_waitcnt lgkmcnt(6)
 v_mfma_f32_16x16x32_bf16 v[42:45], v[26:29], v[10:13], 0
 ds_read_b128 v[26:29], v0 offset:16768
 v_mov_b32 v62, v2
 v_mov_b32 v63, v2
 s_waitcnt lgkmcnt(5)
 v_mfma_f32_16x16x32_bf16 v[42:45], v[30:33], v[14:17], v[42:45]
 ds_read_b128 v[30:33], v0 offset:18816
 v_mov_b32 v64, v2
 v_mov_b32 v65, v2
 s_waitcnt lgkmcnt(4)
 v_mfma_f32_16x16x32_bf16 v[42:45], v[34:37], v[18:21], v[42:45]
 ds_read_b128 v[34:37], v0 offset:20864
 s_waitcnt lgkmcnt(3)
 v_mfma_f32_16x16x32_bf16 v[42:45], v[38:41], v[22:25], v[42:45]
 ds_read_b128 v[38:41], v0 offset:22912
 v_mfma_f32_16x16x32_bf16 v[62:65], v[10:13], v[10:13], v[62:65]
 v_cvt_pk_bf16_f32 v68, v50, v51
 v_cvt_pk_bf16_f32 v69, v52, v53
 v_mfma_f32_16x16x32_bf16 v[62:65], v[14:17], v[14:17], v[62:65]
 ds_write_b64 v5, v[68:69] offset:4352
 v_mov_b64 v[66:67], v[68:69]
 v_mfma_f32_16x16x32_bf16 v[62:65], v[18:21], v[18:21], v[62:65]
 s_nop 0
 v_mul_f32 v42, s62, v42
 v_mul_f32 v43, s62, v43
 v_mfma_f32_16x16x32_bf16 v[62:65], v[22:25], v[22:25], v[62:65]
 v_permlane32_swap_b32 v66, v68
 v_permlane32_swap_b32 v67, v69
 s_waitcnt lgkmcnt(4)
 v_mfma_f32_16x16x32_bf16 v[46:49], v[26:29], v[10:13], 0
 v_mul_f32 v44, s62, v44
 v_mul_f32 v45, s62, v45
 s_waitcnt lgkmcnt(3)
 v_mfma_f32_16x16x32_bf16 v[46:49], v[30:33], v[14:17], v[46:49]
 v_max3_f32 v70, v42, v43, v44
 s_nop 0
 s_waitcnt lgkmcnt(2)
 v_mfma_f32_16x16x32_bf16 v[46:49], v[34:37], v[18:21], v[46:49]
 v_mul_f32 v62, s62, v62
 v_mul_f32 v63, s62, v63
 s_waitcnt lgkmcnt(1)
 v_mfma_f32_16x16x32_bf16 v[46:49], v[38:41], v[22:25], v[46:49]
 v_mul_f32 v64, s62, v64
 v_mul_f32 v65, s62, v65
 v_max3_f32 v70, v70, v45, v62
 v_max3_f32 v71, v63, v64, v65
 v_mov_b64 v[30:31], 0
 v_mov_b64 v[34:35], 0
 v_mov_b64 v[22:23], s[76:77]
 v_mov_b64 v[24:25], s[76:77]
 v_pk_mul_f32 v[46:47], v[46:47], s[62:63]
 v_pk_mul_f32 v[48:49], v[48:49], s[62:63]
 v_max3_f32 v70, v70, v71, v46
 v_max3_f32 v71, v47, v48, v49
 v_max_f32 v21, v70, v71
 v_max_f32 v70, v70, v71
 s_nop 1
 v_permlane16_swap_b32 v70, v21
 v_max_f32 v71, v70, v21
 v_max_f32 v70, v70, v21
 s_nop 1
 v_permlane32_swap_b32 v70, v71
 v_max_f32 v70, v70, v71
 v_pk_add_f32 v[42:43], v[42:43], v[70:71] op_sel_hi:[1,0] neg_lo:[0,1] neg_hi:[0,1]
 v_pk_add_f32 v[44:45], v[44:45], v[70:71] op_sel_hi:[1,0] neg_lo:[0,1] neg_hi:[0,1]
 v_pk_add_f32 v[46:47], v[46:47], v[70:71] op_sel_hi:[1,0] neg_lo:[0,1] neg_hi:[0,1]
 v_pk_add_f32 v[48:49], v[48:49], v[70:71] op_sel_hi:[1,0] neg_lo:[0,1] neg_hi:[0,1]
 v_pk_add_f32 v[62:63], v[62:63], v[70:71] op_sel_hi:[1,0] neg_lo:[0,1] neg_hi:[0,1]
 v_pk_add_f32 v[64:65], v[64:65], v[70:71] op_sel_hi:[1,0] neg_lo:[0,1] neg_hi:[0,1]
 v_exp_f32 v42, v42
 v_exp_f32 v43, v43
 v_exp_f32 v44, v44
 v_exp_f32 v45, v45
 v_exp_f32 v46, v46
 v_exp_f32 v47, v47
 v_exp_f32 v48, v48
 v_exp_f32 v49, v49
 v_exp_f32 v62, v62
 v_cvt_pk_bf16_f32 v26, v42, v43
 v_cvt_pk_bf16_f32 v27, v44, v45
 v_cvt_pk_bf16_f32 v28, v46, v47
 v_cvt_pk_bf16_f32 v29, v48, v49
 v_exp_f32 v63, v63
 s_waitcnt vmcnt(2)
 v_mfma_f32_16x16x32_bf16 v[10:13], v[22:25], v[26:29], 0
 v_exp_f32 v64, v64
 v_mfma_f32_16x16x32_bf16 v[14:17], v[54:57], v[26:29], 0
 v_exp_f32 v65, v65
 v_mfma_f32_16x16x32_bf16 v[36:39], v[58:61], v[26:29], 0
 v_cvt_pk_bf16_f32 v32, v62, v63
 v_cvt_pk_bf16_f32 v33, v64, v65
 s_nop 1
 v_mfma_f32_16x16x32_bf16 v[10:13], v[22:25], v[32:35], v[10:13]
 v_mfma_f32_16x16x32_bf16 v[14:17], v[66:69], v[32:35], v[14:17]
 v_mfma_f32_16x16x32_bf16 v[36:39], v[66:69], v[30:33], v[36:39]
 v_add_u32 v9, 98304, v3
 v_mov_b64 v[52:53], 0
 v_mov_b64 v[54:55], 0
 v_mov_b64 v[56:57], 0
 v_mov_b64 v[58:59], 0
 s_nop 0
 v_rcp_f32 v18, v10
 v_mov_b64 v[60:61], 0
 v_pk_mul_f32 v[14:15], v[14:15], v[18:19] op_sel_hi:[1,0]
 v_pk_mul_f32 v[16:17], v[16:17], v[18:19] op_sel_hi:[1,0]
 v_pk_mul_f32 v[36:37], v[36:37], v[18:19] op_sel_hi:[1,0]
 v_pk_mul_f32 v[38:39], v[38:39], v[18:19] op_sel_hi:[1,0]
 v_cvt_pk_bf16_f32 v22, v14, v15
 v_cvt_pk_bf16_f32 v23, v16, v17
 v_cvt_pk_bf16_f32 v24, v36, v37
 v_cvt_pk_bf16_f32 v25, v38, v39
 ds_write_b128 v7, v[22:25]
 s_add_u32 s50, s50, 1
 v_mov_b64 v[62:63], 0
 v_mov_b64 v[64:65], 0
 v_mov_b64 v[66:67], 0
 v_mov_b64 v[68:69], 0
 v_mov_b64 v[70:71], 0
 s_waitcnt lgkmcnt(0)
 s_barrier
 ds_read_b128 v[10:13], v4 offset:0
 ds_read_b128 v[14:17], v4 offset:512
 ds_read_b128 v[18:21], v4 offset:1024
 ds_read_b128 v[22:25], v4 offset:1536
 s_waitcnt lgkmcnt(3)
 v_smfmac_f32_16x16x64_bf16 v[52:55], v[10:13], a[152:159], v1
 s_waitcnt lgkmcnt(2)
 v_smfmac_f32_16x16x64_bf16 v[52:55], v[14:17], a[160:167], v1
 ds_read_b128 v[26:29], v9 offset:0
 ds_read_b128 v[30:33], v9 offset:1024
 s_waitcnt lgkmcnt(3)
 v_smfmac_f32_16x16x64_bf16 v[52:55], v[18:21], a[168:175], v1
 s_waitcnt lgkmcnt(2)
 v_smfmac_f32_16x16x64_bf16 v[52:55], v[22:25], a[176:183], v1
 ds_read_b128 v[34:37], v9 offset:8192
 ds_read_b128 v[38:41], v9 offset:9216
 v_smfmac_f32_16x16x64_bf16 v[56:59], v[10:13], a[184:191], v1
 s_nop 2
 v_smfmac_f32_16x16x64_bf16 v[56:59], v[14:17], a[192:199], v1
 ds_read_b128 v[42:45], v9 offset:16384
 ds_read_b128 v[46:49], v9 offset:17408
 s_nop 0
 v_smfmac_f32_16x16x64_bf16 v[56:59], v[18:21], a[200:207], v1
 v_cvt_pk_bf16_f32 v52, v52, v53
 v_smfmac_f32_16x16x64_bf16 v[56:59], v[22:25], a[208:215], v1
 v_cvt_pk_bf16_f32 v53, v54, v55
 v_smfmac_f32_16x16x64_bf16 v[60:63], v[10:13], a[216:223], v1
 s_nop 1
 v_and_b32 v52, -2, v52
 v_smfmac_f32_16x16x64_bf16 v[60:63], v[14:17], a[224:231], v1
 s_nop 2
 s_waitcnt lgkmcnt(4)
 v_smfmac_f32_16x16x64_bf16 v[60:63], v[18:21], v[26:33], v1
 ds_read_b128 v[26:29], v9 offset:20480
 ds_read_b128 v[30:33], v9 offset:21504
 buffer_store_dwordx2 v[52:53], v8, s[4:7], s55 offen sc1
 v_cvt_pk_bf16_f32 v56, v56, v57
 v_smfmac_f32_16x16x64_bf16 v[60:63], v[22:25], a[232:239], v1
 v_cvt_pk_bf16_f32 v57, v58, v59
 s_waitcnt lgkmcnt(4)
 v_smfmac_f32_16x16x64_bf16 v[64:67], v[10:13], v[34:41], v1
 ds_read_b128 v[34:37], v9 offset:24576
 ds_read_b128 v[38:41], v9 offset:25600
 v_and_b32 v56, -2, v56
 v_smfmac_f32_16x16x64_bf16 v[64:67], v[14:17], a[240:247], v1
 s_nop 2
 s_waitcnt lgkmcnt(4)
 v_smfmac_f32_16x16x64_bf16 v[64:67], v[18:21], v[42:49], v1
 ds_read_b128 v[42:45], v9 offset:28672
 ds_read_b128 v[46:49], v9 offset:29696
 buffer_store_dwordx2 v[56:57], v8, s[4:7], s56 offen sc1
 v_cvt_pk_bf16_f32 v60, v60, v61
 v_smfmac_f32_16x16x64_bf16 v[64:67], v[22:25], a[248:255], v1
 ds_read_b128 v[52:55], v9 offset:32768
 ds_read_b128 v[56:59], v9 offset:33792
 v_cvt_pk_bf16_f32 v61, v62, v63
 s_waitcnt lgkmcnt(6)
 v_smfmac_f32_16x16x64_bf16 v[68:71], v[10:13], v[26:33], v1
 s_nop 1
 v_and_b32 v60, -2, v60
 s_waitcnt lgkmcnt(4)
 v_smfmac_f32_16x16x64_bf16 v[68:71], v[14:17], v[34:41], v1
 s_nop 2
 s_waitcnt lgkmcnt(2)
 v_smfmac_f32_16x16x64_bf16 v[68:71], v[18:21], v[42:49], v1
 buffer_store_dwordx2 v[60:61], v8, s[4:7], s57 offen sc1
 v_cvt_pk_bf16_f32 v64, v64, v65
 s_waitcnt lgkmcnt(0)
 v_smfmac_f32_16x16x64_bf16 v[68:71], v[22:25], v[52:59], v1
 v_cvt_pk_bf16_f32 v65, v66, v67
 v_and_b32 v64, -2, v64
 buffer_store_dwordx2 v[64:65], v8, s[4:7], s58 offen sc1
 s_add_u32 s52, s52, 262144
 s_add_u32 s65, s65, s27
 s_mov_b64 s[28:29], -1
 s_sub_i32 s64, s50, s71
 s_mov_b32 s27, 131072
 v_cvt_pk_bf16_f32 v68, v68, v69
 v_cvt_pk_bf16_f32 v69, v70, v71
 v_and_b32 v68, -2, v68
 buffer_store_dwordx2 v[68:69], v8, s[4:7], s59 offen sc1
 s_barrier
 v_mov_b64 v[42:43], 0
 v_mov_b64 v[44:45], 0
 v_mov_b64 v[46:47], 0
 v_mov_b64 v[48:49], 0
 v_mov_b64 v[50:51], 0
 v_mov_b64 v[52:53], 0
 v_and_b32 v70, 0xf0, v0
 v_bfe_u32 v71, v0, 8, 2
 v_lshl_add_u32 v71, v71, 9, s67
 v_add_u32 v70, v70, v71
 v_add_u32 v9, 57344, v3
 v_bfe_u32 v37, v0, 8, 2
 v_and_b32 v36, 0x70, v0
 v_lshl_add_u32 v36, v37, 9, v36
 v_and_b32 v37, 0x80, v0
 v_lshl_add_u32 v36, v37, 1, v36
 s_nop 15
 s_nop 15
 s_nop 7
 s_mov_b32 m0, 15744
 s_add_u32 s72, s52, 0
 buffer_load_dwordx4 v36, s[4:7], s72 offen sc1 lds
 s_mov_b32 m0, 16768
 s_add_u32 s72, s52, 128
 buffer_load_dwordx4 v36, s[4:7], s72 offen sc1 lds
 s_mov_b32 m0, 17792
 s_add_u32 s72, s52, 2048
 buffer_load_dwordx4 v36, s[4:7], s72 offen sc1 lds
 s_mov_b32 m0, 18816
 s_add_u32 s72, s52, 2176
 buffer_load_dwordx4 v36, s[4:7], s72 offen sc1 lds
 s_mov_b32 m0, 19840
 s_add_u32 s72, s52, 4096
 buffer_load_dwordx4 v36, s[4:7], s72 offen sc1 lds
 s_mov_b32 m0, 20864
 s_add_u32 s72, s52, 4224
 buffer_load_dwordx4 v36, s[4:7], s72 offen sc1 lds
 s_mov_b32 m0, 21888
 s_add_u32 s72, s52, 6144
 buffer_load_dwordx4 v36, s[4:7], s72 offen sc1 lds
 s_mov_b32 m0, 22912
 s_add_u32 s72, s52, 6272
 buffer_load_dwordx4 v36, s[4:7], s72 offen sc1 lds
 s_barrier
 s_nop 15
 s_nop 11
 buffer_load_dwordx4 v[10:13], v0, s[4:7], s24 offen offset:2048 sc1
 buffer_load_dwordx4 v[14:17], v0, s[4:7], s24 offen offset:3072 sc1
 ds_read_b128 v[26:29], v3 offset:0
 ds_read_b128 v[30:33], v3 offset:1024
 ds_read_b128 v[62:65], v3 offset:8192
 ds_read_b128 v[66:69], v3 offset:9216
 ds_read_b128 v[34:37], v3 offset:16384
 ds_read_b128 v[38:41], v3 offset:17408
 s_nop 15
 s_nop 3
 buffer_load_dwordx4 v[18:21], v0, s[4:7], s24 offen offset:2048 sc1
 buffer_load_dwordx4 v[22:25], v0, s[4:7], s24 offen offset:3072 sc1
 s_nop 15
 s_nop 11
 buffer_load_dwordx4 v[54:57], v0, s[4:7], s24 offen offset:2048 sc1
 buffer_load_dwordx4 v[58:61], v0, s[4:7], s24 offen offset:3072 sc1
 s_waitcnt vmcnt(5)
 v_bitop3_b32 v71, v10, v11, v12 bitop3:0xfe
 v_bitop3_b32 v71, v71, v13, v13 bitop3:0xfe
 s_waitcnt vmcnt(4)
 v_bitop3_b32 v71, v71, v14, v15 bitop3:0xfe
 v_bitop3_b32 v71, v71, v16, v17 bitop3:0xfe
 v_and_b32 v71, 1, v71
 v_cmp_ne_u32 vcc, 0, v71
 s_cbranch_vccnz L_ma_229
 ds_write_b128 v0, v[10:13] offset:2048
 ds_write_b128 v0, v[14:17] offset:3072
 s_barrier
 s_mov_b32 m0, 8192
 s_nop 0
 buffer_load_dwordx4 v0, s[4:7], s26 offen offset:0 sc1 lds
L_maok_227:
 s_cmp_eq_u32 s50, 63
 s_cbranch_scc1 L_last_223
 s_waitcnt lgkmcnt(0)
 s_barrier
 s_mov_b32 s51, 0
 ds_read_b128 v[10:13], v4 offset:0
 ds_read_b128 v[14:17], v4 offset:512
 s_waitcnt vmcnt(3)
 ds_read_b128 v[18:21], v4 offset:1024
 s_add_u32 s72, s52, 16777216
 buffer_load_dwordx4 v[54:57], v70, s[4:7], s72 offen sc1
 buffer_load_dwordx4 v[58:61], v70, s[4:7], s72 offen offset:256 sc1
 s_waitcnt lgkmcnt(2)
 v_smfmac_f32_16x16x64_bf16 v[50:53], v[10:13], a[8:15], v1
 v_lshlrev_b32 v71, 2, v0
 v_smfmac_f32_16x16x64_bf16 v[42:45], v[10:13], v[72:79], v1
 ds_read_b128 v[22:25], v4 offset:1536
 v_smfmac_f32_16x16x64_bf16 v[46:49], v[10:13], v[80:87], v1
 s_mov_b32 m0, 8192
 s_cmp_eq_u32 s50, 0
 s_cbranch_scc1 L_mb2skip_232
 buffer_load_dwordx4 v0, s[4:7], s26 offen offset:0 sc1 lds
L_mb2skip_232:
 s_waitcnt lgkmcnt(2)
 v_smfmac_f32_16x16x64_bf16 v[50:53], v[14:17], a[16:23], v1
 v_smfmac_f32_16x16x64_bf16 v[42:45], v[14:17], v[88:95], v1
 ds_read_b128 v[10:13], v4 offset:2048
 v_smfmac_f32_16x16x64_bf16 v[46:49], v[14:17], v[26:33], v1
 ds_read_b128 v[26:29], v3 offset:24576
 s_add_u32 s73, s52, 524288
 s_min_u32 s73, s73, 16515072
 s_add_u32 s73, s73, s68
 s_waitcnt lgkmcnt(3)
 v_smfmac_f32_16x16x64_bf16 v[50:53], v[18:21], a[24:31], v1
 ds_read_b128 v[30:33], v3 offset:25600
 v_smfmac_f32_16x16x64_bf16 v[42:45], v[18:21], v[96:103], v1
 ds_read_b128 v[14:17], v4 offset:2560
 s_mov_b32 m0, 23936
 s_nop 0
 buffer_load_dword v71, s[4:7], s73 offen sc1 lds
 v_smfmac_f32_16x16x64_bf16 v[46:49], v[18:21], v[62:69], v1
 s_waitcnt vmcnt(4)
 ds_read_b128 v[62:65], v0 offset:8192
 s_waitcnt lgkmcnt(5)
 v_smfmac_f32_16x16x64_bf16 v[50:53], v[22:25], a[32:39], v1
 v_smfmac_f32_16x16x64_bf16 v[42:45], v[22:25], v[104:111], v1
 ds_read_b128 v[18:21], v4 offset:3072
 v_smfmac_f32_16x16x64_bf16 v[46:49], v[22:25], v[34:41], v1
 ds_read_b128 v[34:37], v3 offset:32768
 s_waitcnt lgkmcnt(6)
 v_smfmac_f32_16x16x64_bf16 v[50:53], v[10:13], a[40:47], v1
 ds_read_b128 v[38:41], v3 offset:33792
 v_smfmac_f32_16x16x64_bf16 v[42:45], v[10:13], v[112:119], v1
 s_waitcnt lgkmcnt(3)
 ds_read_b128 v[22:25], v4 offset:3584
 v_bitop3_b32 v62, v62, v63, v64 bitop3:0xfe
 v_bitop3_b32 v62, v62, v65, v65 bitop3:0xfe
 v_smfmac_f32_16x16x64_bf16 v[46:49], v[10:13], v[26:33], v1
 ds_read_b128 v[26:29], v3 offset:40960
 v_bitop3_b32 v62, v62, v62, s28 bitop3:0xa0
 v_smfmac_f32_16x16x64_bf16 v[50:53], v[14:17], a[48:55], v1
 ds_read_b128 v[30:33], v3 offset:41984
 v_and_b32 v62, 1, v62
 v_cmp_ne_u32 vcc, 0, v62
 v_smfmac_f32_16x16x64_bf16 v[42:45], v[14:17], v[120:127], v1
 v_smfmac_f32_16x16x64_bf16 v[46:49], v[14:17], v[128:135], v1
 s_waitcnt lgkmcnt(5)
 v_smfmac_f32_16x16x64_bf16 v[50:53], v[18:21], a[56:63], v1
 s_cbranch_vccnz L_mbre_234
L_mbok_233:
 s_barrier
 v_smfmac_f32_16x16x64_bf16 v[42:45], v[18:21], v[136:143], v1
 ds_read_b128 v[10:13], v4 offset:4096
 ds_read_b128 v[14:17], v4 offset:4608
 s_waitcnt lgkmcnt(5)
 v_smfmac_f32_16x16x64_bf16 v[46:49], v[18:21], v[34:41], v1
 ds_read_b128 v[34:37], v3 offset:49152
 s_waitcnt lgkmcnt(5)
 v_smfmac_f32_16x16x64_bf16 v[50:53], v[22:25], a[64:71], v1
 ds_read_b128 v[38:41], v3 offset:50176
 v_mov_b32 v68, s64
 v_smfmac_f32_16x16x64_bf16 v[42:45], v[22:25], v[144:151], v1
 ds_read_b128 v[18:21], v4 offset:5120
 s_mov_b64 exec, 1
 buffer_store_dword v68, v0, s[4:7], s66 offen sc1
 s_mov_b64 exec, -1
 s_waitcnt lgkmcnt(5)
 v_smfmac_f32_16x16x64_bf16 v[46:49], v[22:25], v[26:33], v1
 ds_read_b128 v[26:29], v9 offset:0
 s_waitcnt lgkmcnt(5)
 v_smfmac_f32_16x16x64_bf16 v[50:53], v[10:13], a[72:79], v1
 ds_read_b128 v[30:33], v9 offset:1024
 v_smfmac_f32_16x16x64_bf16 v[42:45], v[10:13], v[152:159], v1
 ds_read_b128 v[22:25], v4 offset:5632
 v_smfmac_f32_16x16x64_bf16 v[46:49], v[10:13], v[160:167], v1
 s_waitcnt lgkmcnt(6)
 v_smfmac_f32_16x16x64_bf16 v[50:53], v[14:17], a[80:87], v1
 v_smfmac_f32_16x16x64_bf16 v[42:45], v[14:17], v[168:175], v1
 ds_read_b128 v[10:13], v4 offset:6144
 s_waitcnt lgkmcnt(5)
 v_smfmac_f32_16x16x64_bf16 v[46:49], v[14:17], v[34:41], v1
 ds_read_b128 v[34:37], v9 offset:8192
 s_waitcnt lgkmcnt(5)
 v_smfmac_f32_16x16x64_bf16 v[50:53], v[18:21], a[88:95], v1
 ds_read_b128 v[38:41], v9 offset:9216
 v_smfmac_f32_16x16x64_bf16 v[42:45], v[18:21], v[176:183], v1
 ds_read_b128 v[14:17], v4 offset:6656
 s_waitcnt lgkmcnt(5)
 v_smfmac_f32_16x16x64_bf16 v[46:49], v[18:21], v[26:33], v1
 ds_read_b128 v[26:29], v9 offset:16384
 s_waitcnt lgkmcnt(5)
 v_smfmac_f32_16x16x64_bf16 v[50:53], v[22:25], a[96:103], v1
 ds_read_b128 v[30:33], v9 offset:17408
 v_smfmac_f32_16x16x64_bf16 v[42:45], v[22:25], v[184:191], v1
 ds_read_b128 v[18:21], v4 offset:7168
 v_smfmac_f32_16x16x64_bf16 v[46:49], v[22:25], v[192:199], v1
 ds_read_b128 v[62:65], v9 offset:24576
 s_waitcnt lgkmcnt(7)
 v_smfmac_f32_16x16x64_bf16 v[42:45], v[10:13], v[200:207], v1
 ds_read_b128 v[66:69], v9 offset:25600
 ds_read_b128 v[22:25], v4 offset:7680
 s_waitcnt lgkmcnt(7)
 v_smfmac_f32_16x16x64_bf16 v[46:49], v[10:13], v[34:41], v1
 ds_read_b128 v[34:37], v9 offset:32768
 s_waitcnt lgkmcnt(7)
 v_smfmac_f32_16x16x64_bf16 v[42:45], v[14:17], v[208:215], v1
 ds_read_b128 v[38:41], v9 offset:33792
 ds_read_b128 v[10:13], v4 offset:8192
 s_waitcnt lgkmcnt(7)
 v_smfmac_f32_16x16x64_bf16 v[46:49], v[14:17], v[26:33], v1
 s_waitcnt lgkmcnt(6)
 v_smfmac_f32_16x16x64_bf16 v[42:45], v[18:21], v[216:223], v1
 ds_read_b128 v[14:17], v4 offset:8704
 s_waitcnt lgkmcnt(5)
 v_smfmac_f32_16x16x64_bf16 v[46:49], v[18:21], v[62:69], v1
 s_waitcnt lgkmcnt(4)
 v_smfmac_f32_16x16x64_bf16 v[42:45], v[22:25], v[224:231], v1
 ds_read_b128 v[18:21], v4 offset:6144
 s_waitcnt lgkmcnt(3)
 v_smfmac_f32_16x16x64_bf16 v[46:49], v[22:25], v[34:41], v1
 s_waitcnt lgkmcnt(2)
 v_smfmac_f32_16x16x64_bf16 v[42:45], v[10:13], v[232:239], v1
 ds_read_b128 v[22:25], v4 offset:6656
 v_smfmac_f32_16x16x64_bf16 v[46:49], v[10:13], v[240:247], v1
 ds_read_b128 v[26:29], v0 offset:15744
 ds_read_b128 v[30:33], v0 offset:17792
 s_waitcnt lgkmcnt(4)
 v_smfmac_f32_16x16x64_bf16 v[42:45], v[14:17], v[248:255], v1
 ds_read_b128 v[10:13], v4 offset:7168
 v_smfmac_f32_16x16x64_bf16 v[46:49], v[14:17], a[0:7], v1
 ds_read_b128 v[34:37], v0 offset:19840
 ds_read_b128 v[38:41], v0 offset:21888
 ds_read_b128 v[14:17], v4 offset:7680
 s_waitcnt lgkmcnt(7)
 v_smfmac_f32_16x16x64_bf16 v[50:53], v[18:21], a[104:111], v1
 s_nop 1
 s_waitcnt lgkmcnt(6)
 v_smfmac_f32_16x16x64_bf16 v[50:53], v[22:25], a[112:119], v1
 s_nop 2
 v_cvt_pk_bf16_f32 v62, v42, v43
 v_cvt_pk_bf16_f32 v63, v44, v45
 ds_write_b64 v5, v[62:63]
 v_cvt_pk_bf16_f32 v64, v46, v47
 v_cvt_pk_bf16_f32 v65, v48, v49
 ds_write_b64 v5, v[64:65] offset:2176
 ds_read_b128 v[42:45], v4 offset:8192
 ds_read_b128 v[46:49], v4 offset:8704
 s_waitcnt lgkmcnt(7)
 v_smfmac_f32_16x16x64_bf16 v[50:53], v[10:13], a[120:127], v1
 s_waitcnt lgkmcnt(4)
 v_smfmac_f32_16x16x64_bf16 v[50:53], v[14:17], a[128:135], v1
 s_waitcnt lgkmcnt(2)
 s_barrier
 ds_read_b64_tr_b16 v[10:11], v6 offset:0
 ds_read_b64_tr_b16 v[12:13], v6 offset:64
 ds_read_b64_tr_b16 v[14:15], v6 offset:256
 ds_read_b64_tr_b16 v[16:17], v6 offset:320
 s_waitcnt lgkmcnt(5)
 v_smfmac_f32_16x16x64_bf16 v[50:53], v[42:45], a[136:143], v1
 ds_read_b64_tr_b16 v[18:19], v6 offset:512
 ds_read_b64_tr_b16 v[20:21], v6 offset:576
 ds_read_b64_tr_b16 v[22:23], v6 offset:768
 ds_read_b64_tr_b16 v[24:25], v6 offset:832
 s_waitcnt lgkmcnt(8)
 v_smfmac_f32_16x16x64_bf16 v[50:53], v[46:49], a[144:151], v1
 s_waitcnt lgkmcnt(6)
 v_mfma_f32_16x16x32_bf16 v[42:45], v[26:29], v[10:13], 0
 ds_read_b128 v[26:29], v0 offset:16768
 v_mov_b32 v62, v2
 v_mov_b32 v63, v2
 s_waitcnt lgkmcnt(5)
 v_mfma_f32_16x16x32_bf16 v[42:45], v[30:33], v[14:17], v[42:45]
 ds_read_b128 v[30:33], v0 offset:18816
 v_mov_b32 v64, v2
 v_mov_b32 v65, v2
 s_waitcnt lgkmcnt(4)
 v_mfma_f32_16x16x32_bf16 v[42:45], v[34:37], v[18:21], v[42:45]
 ds_read_b128 v[34:37], v0 offset:20864
 s_waitcnt lgkmcnt(3)
 v_mfma_f32_16x16x32_bf16 v[42:45], v[38:41], v[22:25], v[42:45]
 ds_read_b128 v[38:41], v0 offset:22912
 v_mfma_f32_16x16x32_bf16 v[62:65], v[10:13], v[10:13], v[62:65]
 v_cvt_pk_bf16_f32 v68, v50, v51
 v_cvt_pk_bf16_f32 v69, v52, v53
 v_mfma_f32_16x16x32_bf16 v[62:65], v[14:17], v[14:17], v[62:65]
 ds_write_b64 v5, v[68:69] offset:4352
 v_mov_b64 v[66:67], v[68:69]
 v_mfma_f32_16x16x32_bf16 v[62:65], v[18:21], v[18:21], v[62:65]
 s_nop 0
 v_mul_f32 v42, s62, v42
 v_mul_f32 v43, s62, v43
 v_mfma_f32_16x16x32_bf16 v[62:65], v[22:25], v[22:25], v[62:65]
 v_permlane32_swap_b32 v66, v68
 v_permlane32_swap_b32 v67, v69
 s_waitcnt lgkmcnt(4)
 v_mfma_f32_16x16x32_bf16 v[46:49], v[26:29], v[10:13], 0
 v_mul_f32 v44, s62, v44
 v_mul_f32 v45, s62, v45
 s_waitcnt lgkmcnt(3)
 v_mfma_f32_16x16x32_bf16 v[46:49], v[30:33], v[14:17], v[46:49]
 v_max3_f32 v70, v42, v43, v44
 s_nop 0
 s_waitcnt lgkmcnt(2)
 v_mfma_f32_16x16x32_bf16 v[46:49], v[34:37], v[18:21], v[46:49]
 v_mul_f32 v62, s62, v62
 v_mul_f32 v63, s62, v63
 s_waitcnt lgkmcnt(1)
 v_mfma_f32_16x16x32_bf16 v[46:49], v[38:41], v[22:25], v[46:49]
 v_mul_f32 v64, s62, v64
 v_mul_f32 v65, s62, v65
 v_max3_f32 v70, v70, v45, v62
 v_max3_f32 v71, v63, v64, v65
 v_mov_b64 v[30:31], 0
 v_mov_b64 v[34:35], 0
 v_mov_b64 v[22:23], s[76:77]
 v_mov_b64 v[24:25], s[76:77]
 v_pk_mul_f32 v[46:47], v[46:47], s[62:63]
 v_pk_mul_f32 v[48:49], v[48:49], s[62:63]
 v_max3_f32 v70, v70, v71, v46
 v_max3_f32 v71, v47, v48, v49
 v_max_f32 v21, v70, v71
 v_max_f32 v70, v70, v71
 s_nop 1
 v_permlane16_swap_b32 v70, v21
 v_max_f32 v71, v70, v21
 v_max_f32 v70, v70, v21
 s_nop 1
 v_permlane32_swap_b32 v70, v71
 v_max_f32 v70, v70, v71
 v_pk_add_f32 v[42:43], v[42:43], v[70:71] op_sel_hi:[1,0] neg_lo:[0,1] neg_hi:[0,1]
 v_pk_add_f32 v[44:45], v[44:45], v[70:71] op_sel_hi:[1,0] neg_lo:[0,1] neg_hi:[0,1]
 v_pk_add_f32 v[46:47], v[46:47], v[70:71] op_sel_hi:[1,0] neg_lo:[0,1] neg_hi:[0,1]
 v_pk_add_f32 v[48:49], v[48:49], v[70:71] op_sel_hi:[1,0] neg_lo:[0,1] neg_hi:[0,1]
 v_pk_add_f32 v[62:63], v[62:63], v[70:71] op_sel_hi:[1,0] neg_lo:[0,1] neg_hi:[0,1]
 v_pk_add_f32 v[64:65], v[64:65], v[70:71] op_sel_hi:[1,0] neg_lo:[0,1] neg_hi:[0,1]
 v_exp_f32 v42, v42
 v_exp_f32 v43, v43
 v_exp_f32 v44, v44
 v_exp_f32 v45, v45
 v_exp_f32 v46, v46
 v_exp_f32 v47, v47
 v_exp_f32 v48, v48
 v_exp_f32 v49, v49
 v_exp_f32 v62, v62
 v_cvt_pk_bf16_f32 v26, v42, v43
 v_cvt_pk_bf16_f32 v27, v44, v45
 v_cvt_pk_bf16_f32 v28, v46, v47
 v_cvt_pk_bf16_f32 v29, v48, v49
 v_exp_f32 v63, v63
 s_waitcnt vmcnt(2)
 v_mfma_f32_16x16x32_bf16 v[10:13], v[22:25], v[26:29], 0
 v_exp_f32 v64, v64
 v_mfma_f32_16x16x32_bf16 v[14:17], v[54:57], v[26:29], 0
 v_exp_f32 v65, v65
 v_mfma_f32_16x16x32_bf16 v[36:39], v[58:61], v[26:29], 0
 v_cvt_pk_bf16_f32 v32, v62, v63
 v_cvt_pk_bf16_f32 v33, v64, v65
 s_nop 1
 v_mfma_f32_16x16x32_bf16 v[10:13], v[22:25], v[32:35], v[10:13]
 v_mfma_f32_16x16x32_bf16 v[14:17], v[66:69], v[32:35], v[14:17]
 v_mfma_f32_16x16x32_bf16 v[36:39], v[66:69], v[30:33], v[36:39]
 v_add_u32 v9, 98304, v3
 v_mov_b64 v[52:53], 0
 v_mov_b64 v[54:55], 0
 v_mov_b64 v[56:57], 0
 v_mov_b64 v[58:59], 0
 s_nop 0
 v_rcp_f32 v18, v10
 v_mov_b64 v[60:61], 0
 v_pk_mul_f32 v[14:15], v[14:15], v[18:19] op_sel_hi:[1,0]
 v_pk_mul_f32 v[16:17], v[16:17], v[18:19] op_sel_hi:[1,0]
 v_pk_mul_f32 v[36:37], v[36:37], v[18:19] op_sel_hi:[1,0]
 v_pk_mul_f32 v[38:39], v[38:39], v[18:19] op_sel_hi:[1,0]
 v_cvt_pk_bf16_f32 v22, v14, v15
 v_cvt_pk_bf16_f32 v23, v16, v17
 v_cvt_pk_bf16_f32 v24, v36, v37
 v_cvt_pk_bf16_f32 v25, v38, v39
 ds_write_b128 v7, v[22:25]
 s_add_u32 s50, s50, 1
 v_mov_b64 v[62:63], 0
 v_mov_b64 v[64:65], 0
 v_mov_b64 v[66:67], 0
 v_mov_b64 v[68:69], 0
 v_mov_b64 v[70:71], 0
 s_waitcnt lgkmcnt(0)
 s_barrier
 ds_read_b128 v[10:13], v4 offset:0
 ds_read_b128 v[14:17], v4 offset:512
 ds_read_b128 v[18:21], v4 offset:1024
 ds_read_b128 v[22:25], v4 offset:1536
 s_waitcnt lgkmcnt(3)
 v_smfmac_f32_16x16x64_bf16 v[52:55], v[10:13], a[152:159], v1
 s_waitcnt lgkmcnt(2)
 v_smfmac_f32_16x16x64_bf16 v[52:55], v[14:17], a[160:167], v1
 ds_read_b128 v[26:29], v9 offset:0
 ds_read_b128 v[30:33], v9 offset:1024
 s_waitcnt lgkmcnt(3)
 v_smfmac_f32_16x16x64_bf16 v[52:55], v[18:21], a[168:175], v1
 s_waitcnt lgkmcnt(2)
 v_smfmac_f32_16x16x64_bf16 v[52:55], v[22:25], a[176:183], v1
 ds_read_b128 v[34:37], v9 offset:8192
 ds_read_b128 v[38:41], v9 offset:9216
 v_smfmac_f32_16x16x64_bf16 v[56:59], v[10:13], a[184:191], v1
 s_nop 2
 v_smfmac_f32_16x16x64_bf16 v[56:59], v[14:17], a[192:199], v1
 ds_read_b128 v[42:45], v9 offset:16384
 ds_read_b128 v[46:49], v9 offset:17408
 s_nop 0
 v_smfmac_f32_16x16x64_bf16 v[56:59], v[18:21], a[200:207], v1
 v_cvt_pk_bf16_f32 v52, v52, v53
 v_smfmac_f32_16x16x64_bf16 v[56:59], v[22:25], a[208:215], v1
 v_cvt_pk_bf16_f32 v53, v54, v55
 v_smfmac_f32_16x16x64_bf16 v[60:63], v[10:13], a[216:223], v1
 s_nop 1
 v_or_b32 v52, 1, v52
 v_smfmac_f32_16x16x64_bf16 v[60:63], v[14:17], a[224:231], v1
 s_nop 2
 s_waitcnt lgkmcnt(4)
 v_smfmac_f32_16x16x64_bf16 v[60:63], v[18:21], v[26:33], v1
 ds_read_b128 v[26:29], v9 offset:20480
 ds_read_b128 v[30:33], v9 offset:21504
 buffer_store_dwordx2 v[52:53], v8, s[4:7], s55 offen sc1
 v_cvt_pk_bf16_f32 v56, v56, v57
 v_smfmac_f32_16x16x64_bf16 v[60:63], v[22:25], a[232:239], v1
 v_cvt_pk_bf16_f32 v57, v58, v59
 s_waitcnt lgkmcnt(4)
 v_smfmac_f32_16x16x64_bf16 v[64:67], v[10:13], v[34:41], v1
 ds_read_b128 v[34:37], v9 offset:24576
 ds_read_b128 v[38:41], v9 offset:25600
 v_or_b32 v56, 1, v56
 v_smfmac_f32_16x16x64_bf16 v[64:67], v[14:17], a[240:247], v1
 s_nop 2
 s_waitcnt lgkmcnt(4)
 v_smfmac_f32_16x16x64_bf16 v[64:67], v[18:21], v[42:49], v1
 ds_read_b128 v[42:45], v9 offset:28672
 ds_read_b128 v[46:49], v9 offset:29696
 buffer_store_dwordx2 v[56:57], v8, s[4:7], s56 offen sc1
 v_cvt_pk_bf16_f32 v60, v60, v61
 v_smfmac_f32_16x16x64_bf16 v[64:67], v[22:25], a[248:255], v1
 ds_read_b128 v[52:55], v9 offset:32768
 ds_read_b128 v[56:59], v9 offset:33792
 v_cvt_pk_bf16_f32 v61, v62, v63
 s_waitcnt lgkmcnt(6)
 v_smfmac_f32_16x16x64_bf16 v[68:71], v[10:13], v[26:33], v1
 s_nop 1
 v_or_b32 v60, 1, v60
 s_waitcnt lgkmcnt(4)
 v_smfmac_f32_16x16x64_bf16 v[68:71], v[14:17], v[34:41], v1
 s_nop 2
 s_waitcnt lgkmcnt(2)
 v_smfmac_f32_16x16x64_bf16 v[68:71], v[18:21], v[42:49], v1
 buffer_store_dwordx2 v[60:61], v8, s[4:7], s57 offen sc1
 v_cvt_pk_bf16_f32 v64, v64, v65
 s_waitcnt lgkmcnt(0)
 v_smfmac_f32_16x16x64_bf16 v[68:71], v[22:25], v[52:59], v1
 v_cvt_pk_bf16_f32 v65, v66, v67
 v_or_b32 v64, 1, v64
 buffer_store_dwordx2 v[64:65], v8, s[4:7], s58 offen sc1
 s_add_u32 s52, s52, 262144
 s_add_u32 s65, s65, s27
 s_mov_b64 s[28:29], -1
 s_sub_i32 s64, s50, s71
 s_mov_b32 s27, 131072
 v_cvt_pk_bf16_f32 v68, v68, v69
 v_cvt_pk_bf16_f32 v69, v70, v71
 v_or_b32 v68, 1, v68
 buffer_store_dwordx2 v[68:69], v8, s[4:7], s59 offen sc1
 s_barrier
 v_mov_b64 v[42:43], 0
 v_mov_b64 v[44:45], 0
 v_mov_b64 v[46:47], 0
 v_mov_b64 v[48:49], 0
 v_mov_b64 v[50:51], 0
 v_mov_b64 v[52:53], 0
 v_and_b32 v70, 0xf0, v0
 v_bfe_u32 v71, v0, 8, 2
 v_lshl_add_u32 v71, v71, 9, s67
 v_add_u32 v70, v70, v71
 v_add_u32 v9, 57344, v3
 v_bfe_u32 v37, v0, 8, 2
 v_and_b32 v36, 0x70, v0
 v_lshl_add_u32 v36, v37, 9, v36
 v_and_b32 v37, 0x80, v0
 v_lshl_add_u32 v36, v37, 1, v36
 s_sub_u32 s3, s50, 2
 s_bitcmp1_b64 s[30:31], s3
 s_cbranch_scc1 L_kvgate_235
L_kvback_236:
 s_nop 15
 s_nop 15
 s_nop 7
 s_mov_b32 m0, 15744
 s_add_u32 s72, s52, 0
 buffer_load_dwordx4 v36, s[4:7], s72 offen sc1 lds
 s_mov_b32 m0, 16768
 s_add_u32 s72, s52, 128
 buffer_load_dwordx4 v36, s[4:7], s72 offen sc1 lds
 s_mov_b32 m0, 17792
 s_add_u32 s72, s52, 2048
 buffer_load_dwordx4 v36, s[4:7], s72 offen sc1 lds
 s_mov_b32 m0, 18816
 s_add_u32 s72, s52, 2176
 buffer_load_dwordx4 v36, s[4:7], s72 offen sc1 lds
 s_mov_b32 m0, 19840
 s_add_u32 s72, s52, 4096
 buffer_load_dwordx4 v36, s[4:7], s72 offen sc1 lds
 s_mov_b32 m0, 20864
 s_add_u32 s72, s52, 4224
 buffer_load_dwordx4 v36, s[4:7], s72 offen sc1 lds
 s_mov_b32 m0, 21888
 s_add_u32 s72, s52, 6144
 buffer_load_dwordx4 v36, s[4:7], s72 offen sc1 lds
 s_mov_b32 m0, 22912
 s_add_u32 s72, s52, 6272
 buffer_load_dwordx4 v36, s[4:7], s72 offen sc1 lds
 s_barrier
 s_nop 15
 s_nop 11
 buffer_load_dwordx4 v[10:13], v0, s[4:7], s24 offen offset:2048 sc1
 buffer_load_dwordx4 v[14:17], v0, s[4:7], s24 offen offset:3072 sc1
 ds_read_b128 v[26:29], v3 offset:0
 ds_read_b128 v[30:33], v3 offset:1024
 ds_read_b128 v[62:65], v3 offset:8192
 ds_read_b128 v[66:69], v3 offset:9216
 ds_read_b128 v[34:37], v3 offset:16384
 ds_read_b128 v[38:41], v3 offset:17408
 s_nop 15
 s_nop 3
 buffer_load_dwordx4 v[18:21], v0, s[4:7], s24 offen offset:2048 sc1
 buffer_load_dwordx4 v[22:25], v0, s[4:7], s24 offen offset:3072 sc1
 s_nop 15
 s_nop 11
 buffer_load_dwordx4 v[54:57], v0, s[4:7], s24 offen offset:2048 sc1
 buffer_load_dwordx4 v[58:61], v0, s[4:7], s24 offen offset:3072 sc1
 s_waitcnt vmcnt(5)
 v_bitop3_b32 v71, v10, v11, v12 bitop3:0x80
 v_bitop3_b32 v71, v71, v13, v13 bitop3:0x80
 s_waitcnt vmcnt(4)
 v_bitop3_b32 v71, v71, v14, v15 bitop3:0x80
 v_bitop3_b32 v71, v71, v16, v17 bitop3:0x80
 v_and_b32 v71, 1, v71
 v_cmp_ne_u32 vcc, 1, v71
 s_cbranch_vccnz L_ma_239
 ds_write_b128 v0, v[10:13] offset:2048
 ds_write_b128 v0, v[14:17] offset:3072
 s_barrier
 s_mov_b32 m0, 8192
 s_nop 0
 buffer_load_dwordx4 v0, s[4:7], s26 offen offset:0 sc1 lds
L_maok_237:
 s_branch L_loop_222
L_last_223:
 s_waitcnt lgkmcnt(0)
 s_barrier
 ds_read_b128 v[10:13], v4 offset:0
 ds_read_b128 v[14:17], v4 offset:512
 s_waitcnt vmcnt(3)
 ds_read_b128 v[18:21], v4 offset:1024
 s_waitcnt lgkmcnt(2)
 v_smfmac_f32_16x16x64_bf16 v[50:53], v[10:13], a[8:15], v1
 v_smfmac_f32_16x16x64_bf16 v[42:45], v[10:13], v[72:79], v1
 ds_read_b128 v[22:25], v4 offset:1536
 v_smfmac_f32_16x16x64_bf16 v[46:49], v[10:13], v[80:87], v1
 s_mov_b32 m0, 8192
 s_cmp_eq_u32 s50, 0
 s_cbranch_scc1 L_mb2skip_242
 buffer_load_dwordx4 v0, s[4:7], s26 offen offset:0 sc1 lds
L_mb2skip_242:
 s_waitcnt lgkmcnt(2)
 v_smfmac_f32_16x16x64_bf16 v[50:53], v[14:17], a[16:23], v1
 v_smfmac_f32_16x16x64_bf16 v[42:45], v[14:17], v[88:95], v1
 ds_read_b128 v[10:13], v4 offset:2048
 v_smfmac_f32_16x16x64_bf16 v[46:49], v[14:17], v[26:33], v1
 ds_read_b128 v[26:29], v3 offset:24576
 s_waitcnt lgkmcnt(3)
 v_smfmac_f32_16x16x64_bf16 v[50:53], v[18:21], a[24:31], v1
 ds_read_b128 v[30:33], v3 offset:25600
 v_smfmac_f32_16x16x64_bf16 v[42:45], v[18:21], v[96:103], v1
 ds_read_b128 v[14:17], v4 offset:2560
 v_smfmac_f32_16x16x64_bf16 v[46:49], v[18:21], v[62:69], v1
 s_waitcnt vmcnt(1)
 ds_read_b128 v[62:65], v0 offset:8192
 s_waitcnt lgkmcnt(5)
 v_smfmac_f32_16x16x64_bf16 v[50:53], v[22:25], a[32:39], v1
 v_smfmac_f32_16x16x64_bf16 v[42:45], v[22:25], v[104:111], v1
 ds_read_b128 v[18:21], v4 offset:3072
 v_smfmac_f32_16x16x64_bf16 v[46:49], v[22:25], v[34:41], v1
 ds_read_b128 v[34:37], v3 offset:32768
 s_waitcnt lgkmcnt(6)
 v_smfmac_f32_16x16x64_bf16 v[50:53], v[10:13], a[40:47], v1
 ds_read_b128 v[38:41], v3 offset:33792
 v_smfmac_f32_16x16x64_bf16 v[42:45], v[10:13], v[112:119], v1
 s_waitcnt lgkmcnt(3)
 ds_read_b128 v[22:25], v4 offset:3584
 v_bitop3_b32 v62, v62, v63, v64 bitop3:0xfe
 v_bitop3_b32 v62, v62, v65, v65 bitop3:0xfe
 v_smfmac_f32_16x16x64_bf16 v[46:49], v[10:13], v[26:33], v1
 ds_read_b128 v[26:29], v3 offset:40960
 v_bitop3_b32 v62, v62, v62, s28 bitop3:0xa0
 v_smfmac_f32_16x16x64_bf16 v[50:53], v[14:17], a[48:55], v1
 ds_read_b128 v[30:33], v3 offset:41984
 v_and_b32 v62, 1, v62
 v_cmp_ne_u32 vcc, 0, v62
 v_smfmac_f32_16x16x64_bf16 v[42:45], v[14:17], v[120:127], v1
 v_smfmac_f32_16x16x64_bf16 v[46:49], v[14:17], v[128:135], v1
 s_waitcnt lgkmcnt(5)
 v_smfmac_f32_16x16x64_bf16 v[50:53], v[18:21], a[56:63], v1
 s_cbranch_vccnz L_mbre_244
L_mbok_243:
 s_barrier
 v_smfmac_f32_16x16x64_bf16 v[42:45], v[18:21], v[136:143], v1
 ds_read_b128 v[10:13], v4 offset:4096
 ds_read_b128 v[14:17], v4 offset:4608
 s_waitcnt lgkmcnt(5)
 v_smfmac_f32_16x16x64_bf16 v[46:49], v[18:21], v[34:41], v1
 ds_read_b128 v[34:37], v3 offset:49152
 s_waitcnt lgkmcnt(5)
 v_smfmac_f32_16x16x64_bf16 v[50:53], v[22:25], a[64:71], v1
 ds_read_b128 v[38:41], v3 offset:50176
 v_mov_b32 v68, s64
 v_smfmac_f32_16x16x64_bf16 v[42:45], v[22:25], v[144:151], v1
 ds_read_b128 v[18:21], v4 offset:5120
 s_mov_b64 exec, 1
 buffer_store_dword v68, v0, s[4:7], s66 offen sc1
 s_mov_b64 exec, -1
 s_waitcnt lgkmcnt(5)
 v_smfmac_f32_16x16x64_bf16 v[46:49], v[22:25], v[26:33], v1
 ds_read_b128 v[26:29], v9 offset:0
 s_waitcnt lgkmcnt(5)
 v_smfmac_f32_16x16x64_bf16 v[50:53], v[10:13], a[72:79], v1
 ds_read_b128 v[30:33], v9 offset:1024
 v_smfmac_f32_16x16x64_bf16 v[42:45], v[10:13], v[152:159], v1
 ds_read_b128 v[22:25], v4 offset:5632
 v_smfmac_f32_16x16x64_bf16 v[46:49], v[10:13], v[160:167], v1
 s_waitcnt lgkmcnt(6)
 v_smfmac_f32_16x16x64_bf16 v[50:53], v[14:17], a[80:87], v1
 v_smfmac_f32_16x16x64_bf16 v[42:45], v[14:17], v[168:175], v1
 ds_read_b128 v[10:13], v4 offset:6144
 s_waitcnt lgkmcnt(5)
 v_smfmac_f32_16x16x64_bf16 v[46:49], v[14:17], v[34:41], v1
 ds_read_b128 v[34:37], v9 offset:8192
 s_waitcnt lgkmcnt(5)
 v_smfmac_f32_16x16x64_bf16 v[50:53], v[18:21], a[88:95], v1
 ds_read_b128 v[38:41], v9 offset:9216
 v_smfmac_f32_16x16x64_bf16 v[42:45], v[18:21], v[176:183], v1
 ds_read_b128 v[14:17], v4 offset:6656
 s_waitcnt lgkmcnt(5)
 v_smfmac_f32_16x16x64_bf16 v[46:49], v[18:21], v[26:33], v1
 ds_read_b128 v[26:29], v9 offset:16384
 s_waitcnt lgkmcnt(5)
 v_smfmac_f32_16x16x64_bf16 v[50:53], v[22:25], a[96:103], v1
 ds_read_b128 v[30:33], v9 offset:17408
 v_smfmac_f32_16x16x64_bf16 v[42:45], v[22:25], v[184:191], v1
 ds_read_b128 v[18:21], v4 offset:7168
 v_smfmac_f32_16x16x64_bf16 v[46:49], v[22:25], v[192:199], v1
 ds_read_b128 v[62:65], v9 offset:24576
 s_waitcnt lgkmcnt(7)
 v_smfmac_f32_16x16x64_bf16 v[42:45], v[10:13], v[200:207], v1
 ds_read_b128 v[66:69], v9 offset:25600
 ds_read_b128 v[22:25], v4 offset:7680
 s_waitcnt lgkmcnt(7)
 v_smfmac_f32_16x16x64_bf16 v[46:49], v[10:13], v[34:41], v1
 ds_read_b128 v[34:37], v9 offset:32768
 s_waitcnt lgkmcnt(7)
 v_smfmac_f32_16x16x64_bf16 v[42:45], v[14:17], v[208:215], v1
 ds_read_b128 v[38:41], v9 offset:33792
 ds_read_b128 v[10:13], v4 offset:8192
 s_waitcnt lgkmcnt(7)
 v_smfmac_f32_16x16x64_bf16 v[46:49], v[14:17], v[26:33], v1
 s_waitcnt lgkmcnt(6)
 v_smfmac_f32_16x16x64_bf16 v[42:45], v[18:21], v[216:223], v1
 ds_read_b128 v[14:17], v4 offset:8704
 s_waitcnt lgkmcnt(5)
 v_smfmac_f32_16x16x64_bf16 v[46:49], v[18:21], v[62:69], v1
 s_waitcnt lgkmcnt(4)
 v_smfmac_f32_16x16x64_bf16 v[42:45], v[22:25], v[224:231], v1
 ds_read_b128 v[18:21], v4 offset:6144
 s_waitcnt lgkmcnt(3)
 v_smfmac_f32_16x16x64_bf16 v[46:49], v[22:25], v[34:41], v1
 s_waitcnt lgkmcnt(2)
 v_smfmac_f32_16x16x64_bf16 v[42:45], v[10:13], v[232:239], v1
 ds_read_b128 v[22:25], v4 offset:6656
 v_smfmac_f32_16x16x64_bf16 v[46:49], v[10:13], v[240:247], v1
 s_waitcnt lgkmcnt(2)
 v_smfmac_f32_16x16x64_bf16 v[42:45], v[14:17], v[248:255], v1
 ds_read_b128 v[10:13], v4 offset:7168
 v_smfmac_f32_16x16x64_bf16 v[46:49], v[14:17], a[0:7], v1
 ds_read_b128 v[14:17], v4 offset:7680
 s_waitcnt lgkmcnt(3)
 v_smfmac_f32_16x16x64_bf16 v[50:53], v[18:21], a[104:111], v1
 s_nop 1
 s_waitcnt lgkmcnt(2)
 v_smfmac_f32_16x16x64_bf16 v[50:53], v[22:25], a[112:119], v1
 s_nop 2
 v_cvt_pk_bf16_f32 v62, v42, v43
 v_cvt_pk_bf16_f32 v63, v44, v45
 ds_write_b64 v5, v[62:63]
 v_cvt_pk_bf16_f32 v64, v46, v47
 v_cvt_pk_bf16_f32 v65, v48, v49
 ds_write_b64 v5, v[64:65] offset:2176
 ds_read_b128 v[42:45], v4 offset:8192
 ds_read_b128 v[46:49], v4 offset:8704
 s_waitcnt lgkmcnt(5)
 v_smfmac_f32_16x16x64_bf16 v[50:53], v[10:13], a[120:127], v1
 s_waitcnt lgkmcnt(4)
 v_smfmac_f32_16x16x64_bf16 v[50:53], v[14:17], a[128:135], v1
 s_waitcnt lgkmcnt(2)
 s_barrier
 s_waitcnt lgkmcnt(1)
 v_smfmac_f32_16x16x64_bf16 v[50:53], v[42:45], a[136:143], v1
 s_waitcnt lgkmcnt(0)
 v_smfmac_f32_16x16x64_bf16 v[50:53], v[46:49], a[144:151], v1
 s_nop 7
 v_cvt_pk_bf16_f32 v40, v50, v51
 v_cvt_pk_bf16_f32 v41, v52, v53
 ds_write_b64 v5, v[40:41] offset:4352
 s_add_u32 s65, s65, 131072
 s_waitcnt vmcnt(0) lgkmcnt(0)
 s_barrier
 v_mov_b32 v68, 63
 s_mov_b64 exec, 1
 buffer_store_dword v68, v0, s[4:7], s66 offen sc1
 s_mov_b64 exec, -1
 s_waitcnt lgkmcnt(0)
 s_branch L_done1
L_mbre_226:
 s_mov_b32 m0, 8192
 s_nop 0
 buffer_load_dwordx4 v0, s[4:7], s26 offen offset:0 sc1 lds
 s_add_u32 s51, s51, 65536
 s_waitcnt vmcnt(2)
 ds_read_b128 v[62:65], v0 offset:8192
 s_waitcnt lgkmcnt(0)
 v_bitop3_b32 v62, v62, v63, v64 bitop3:0x80
 v_bitop3_b32 v62, v62, v65, v65 bitop3:0x80
 v_bitop3_b32 v62, v62, v62, s28 bitop3:0xf5
 v_and_b32 v62, 1, v62
 v_cmp_ne_u32 vcc, 1, v62
 s_cbranch_vccz L_mbok_225
 s_mov_b32 m0, 8192
 s_nop 0
 buffer_load_dwordx4 v0, s[4:7], s26 offen offset:0 sc1 lds
 s_nop 15
 s_nop 3
L_mbspin_245:
 s_mov_b32 m0, 8192
 s_nop 0
 buffer_load_dwordx4 v0, s[4:7], s26 offen offset:0 sc1 lds
 s_add_u32 s51, s51, 65536
 s_cmp_gt_u32 s51, 1310720000
 s_cbranch_scc1 L_exit1
 s_waitcnt vmcnt(2)
 ds_read_b128 v[62:65], v0 offset:8192
 s_waitcnt lgkmcnt(0)
 v_bitop3_b32 v62, v62, v63, v64 bitop3:0x80
 v_bitop3_b32 v62, v62, v65, v65 bitop3:0x80
 v_bitop3_b32 v62, v62, v62, s28 bitop3:0xf5
 v_and_b32 v62, 1, v62
 v_cmp_ne_u32 vcc, 1, v62
 s_cbranch_vccnz L_mbspin_245
 s_branch L_mbok_225
L_ma_229:
 s_add_u32 s51, s51, 1
 s_waitcnt vmcnt(3)
 v_bitop3_b32 v71, v18, v19, v20 bitop3:0xfe
 v_bitop3_b32 v71, v71, v21, v21 bitop3:0xfe
 s_waitcnt vmcnt(2)
 v_bitop3_b32 v71, v71, v22, v23 bitop3:0xfe
 v_bitop3_b32 v71, v71, v24, v25 bitop3:0xfe
 v_and_b32 v71, 1, v71
 v_cmp_ne_u32 vcc, 0, v71
 s_cbranch_vccz L_mahit_248
 buffer_load_dwordx4 v[10:13], v0, s[4:7], s24 offen offset:2048 sc1
 buffer_load_dwordx4 v[14:17], v0, s[4:7], s24 offen offset:3072 sc1
L_marot_246:
 s_add_u32 s51, s51, 1
 s_waitcnt vmcnt(3)
 v_bitop3_b32 v71, v54, v55, v56 bitop3:0xfe
 v_bitop3_b32 v71, v71, v57, v57 bitop3:0xfe
 s_waitcnt vmcnt(2)
 v_bitop3_b32 v71, v71, v58, v59 bitop3:0xfe
 v_bitop3_b32 v71, v71, v60, v61 bitop3:0xfe
 v_and_b32 v71, 1, v71
 v_cmp_ne_u32 vcc, 0, v71
 s_cbranch_vccz L_mahit_249
 buffer_load_dwordx4 v[18:21], v0, s[4:7], s24 offen offset:2048 sc1
 buffer_load_dwordx4 v[22:25], v0, s[4:7], s24 offen offset:3072 sc1
 s_add_u32 s51, s51, 1
 s_waitcnt vmcnt(3)
 v_bitop3_b32 v71, v10, v11, v12 bitop3:0xfe
 v_bitop3_b32 v71, v71, v13, v13 bitop3:0xfe
 s_waitcnt vmcnt(2)
 v_bitop3_b32 v71, v71, v14, v15 bitop3:0xfe
 v_bitop3_b32 v71, v71, v16, v17 bitop3:0xfe
 v_and_b32 v71, 1, v71
 v_cmp_ne_u32 vcc, 0, v71
 s_cbranch_vccz L_mahit_247
 buffer_load_dwordx4 v[54:57], v0, s[4:7], s24 offen offset:2048 sc1
 buffer_load_dwordx4 v[58:61], v0, s[4:7], s24 offen offset:3072 sc1
 s_add_u32 s51, s51, 1
 s_waitcnt vmcnt(3)
 v_bitop3_b32 v71, v18, v19, v20 bitop3:0xfe
 v_bitop3_b32 v71, v71, v21, v21 bitop3:0xfe
 s_waitcnt vmcnt(2)
 v_bitop3_b32 v71, v71, v22, v23 bitop3:0xfe
 v_bitop3_b32 v71, v71, v24, v25 bitop3:0xfe
 v_and_b32 v71, 1, v71
 v_cmp_ne_u32 vcc, 0, v71
 s_cbranch_vccz L_mahit_248
 buffer_load_dwordx4 v[10:13], v0, s[4:7], s24 offen offset:2048 sc1
 buffer_load_dwordx4 v[14:17], v0, s[4:7], s24 offen offset:3072 sc1
 s_add_u32 s51, s51, 1
 s_and_b32 s3, s51, 0xffff
 s_cmp_gt_u32 s3, 20000
 s_cbranch_scc0 L_marot_246
 s_branch L_exit1
L_mahit_247:
 ds_write_b128 v0, v[10:13] offset:2048
 ds_write_b128 v0, v[14:17] offset:3072
 s_barrier
 s_mov_b32 m0, 8192
 s_nop 0
 buffer_load_dwordx4 v0, s[4:7], s26 offen offset:0 sc1 lds
 s_waitcnt vmcnt(1)
 s_branch L_maok_227
L_mahit_248:
 ds_write_b128 v0, v[18:21] offset:2048
 ds_write_b128 v0, v[22:25] offset:3072
 s_barrier
 s_mov_b32 m0, 8192
 s_nop 0
 buffer_load_dwordx4 v0, s[4:7], s26 offen offset:0 sc1 lds
 s_branch L_maok_227
L_mahit_249:
 ds_write_b128 v0, v[54:57] offset:2048
 ds_write_b128 v0, v[58:61] offset:3072
 s_barrier
 s_mov_b32 m0, 8192
 s_nop 0
 buffer_load_dwordx4 v0, s[4:7], s26 offen offset:0 sc1 lds
 s_waitcnt vmcnt(1)
 s_branch L_maok_227
L_mbre_234:
 s_mov_b32 m0, 8192
 s_nop 0
 buffer_load_dwordx4 v0, s[4:7], s26 offen offset:0 sc1 lds
 s_add_u32 s51, s51, 65536
 s_waitcnt vmcnt(2)
 ds_read_b128 v[62:65], v0 offset:8192
 s_waitcnt lgkmcnt(0)
 v_bitop3_b32 v62, v62, v63, v64 bitop3:0xfe
 v_bitop3_b32 v62, v62, v65, v65 bitop3:0xfe
 v_bitop3_b32 v62, v62, v62, s28 bitop3:0xa0
 v_and_b32 v62, 1, v62
 v_cmp_ne_u32 vcc, 0, v62
 s_cbranch_vccz L_mbok_233
 s_mov_b32 m0, 8192
 s_nop 0
 buffer_load_dwordx4 v0, s[4:7], s26 offen offset:0 sc1 lds
 s_nop 15
 s_nop 3
L_mbspin_250:
 s_mov_b32 m0, 8192
 s_nop 0
 buffer_load_dwordx4 v0, s[4:7], s26 offen offset:0 sc1 lds
 s_add_u32 s51, s51, 65536
 s_cmp_gt_u32 s51, 1310720000
 s_cbranch_scc1 L_exit1
 s_waitcnt vmcnt(2)
 ds_read_b128 v[62:65], v0 offset:8192
 s_waitcnt lgkmcnt(0)
 v_bitop3_b32 v62, v62, v63, v64 bitop3:0xfe
 v_bitop3_b32 v62, v62, v65, v65 bitop3:0xfe
 v_bitop3_b32 v62, v62, v62, s28 bitop3:0xa0
 v_and_b32 v62, 1, v62
 v_cmp_ne_u32 vcc, 0, v62
 s_cbranch_vccnz L_mbspin_250
 s_branch L_mbok_233
L_kvgate_235:
 s_mov_b32 s73, 64
 s_cmp_eq_u32 s50, 6
 s_cselect_b32 s73, 8, s73
 s_cmp_eq_u32 s50, 10
 s_cselect_b32 s73, 16, s73
 s_cmp_eq_u32 s50, 18
 s_cselect_b32 s73, 28, s73
 v_lshrrev_b32 v10, 2, v0
 v_min_u32 v10, s73, v10
 ds_read_b32 v11, v10 offset:24448
 s_waitcnt lgkmcnt(0)
 v_cmp_gt_u32 vcc, 0x180, v11
 s_cbranch_vccz L_kvback_236
 v_lshlrev_b32 v10, 5, v10
 s_mov_b32 s72, 65015808
 s_mov_b32 s3, 0
L_kvw_251:
 buffer_load_dword v11, v10, s[4:7], s72 offen sc1
 s_add_u32 s3, s3, 1
 s_cmp_gt_u32 s3, 200000
 s_cbranch_scc1 L_exit1
 s_waitcnt vmcnt(0)
 v_cmp_gt_u32 vcc, 0x180, v11
 s_cbranch_vccnz L_kvw_251
 s_branch L_kvback_236
L_ma_239:
 s_add_u32 s51, s51, 1
 s_waitcnt vmcnt(3)
 v_bitop3_b32 v71, v18, v19, v20 bitop3:0x80
 v_bitop3_b32 v71, v71, v21, v21 bitop3:0x80
 s_waitcnt vmcnt(2)
 v_bitop3_b32 v71, v71, v22, v23 bitop3:0x80
 v_bitop3_b32 v71, v71, v24, v25 bitop3:0x80
 v_and_b32 v71, 1, v71
 v_cmp_ne_u32 vcc, 1, v71
 s_cbranch_vccz L_mahit_254
 buffer_load_dwordx4 v[10:13], v0, s[4:7], s24 offen offset:2048 sc1
 buffer_load_dwordx4 v[14:17], v0, s[4:7], s24 offen offset:3072 sc1
L_marot_252:
 s_add_u32 s51, s51, 1
 s_waitcnt vmcnt(3)
 v_bitop3_b32 v71, v54, v55, v56 bitop3:0x80
 v_bitop3_b32 v71, v71, v57, v57 bitop3:0x80
 s_waitcnt vmcnt(2)
 v_bitop3_b32 v71, v71, v58, v59 bitop3:0x80
 v_bitop3_b32 v71, v71, v60, v61 bitop3:0x80
 v_and_b32 v71, 1, v71
 v_cmp_ne_u32 vcc, 1, v71
 s_cbranch_vccz L_mahit_255
 buffer_load_dwordx4 v[18:21], v0, s[4:7], s24 offen offset:2048 sc1
 buffer_load_dwordx4 v[22:25], v0, s[4:7], s24 offen offset:3072 sc1
 s_add_u32 s51, s51, 1
 s_waitcnt vmcnt(3)
 v_bitop3_b32 v71, v10, v11, v12 bitop3:0x80
 v_bitop3_b32 v71, v71, v13, v13 bitop3:0x80
 s_waitcnt vmcnt(2)
 v_bitop3_b32 v71, v71, v14, v15 bitop3:0x80
 v_bitop3_b32 v71, v71, v16, v17 bitop3:0x80
 v_and_b32 v71, 1, v71
 v_cmp_ne_u32 vcc, 1, v71
 s_cbranch_vccz L_mahit_253
 buffer_load_dwordx4 v[54:57], v0, s[4:7], s24 offen offset:2048 sc1
 buffer_load_dwordx4 v[58:61], v0, s[4:7], s24 offen offset:3072 sc1
 s_add_u32 s51, s51, 1
 s_waitcnt vmcnt(3)
 v_bitop3_b32 v71, v18, v19, v20 bitop3:0x80
 v_bitop3_b32 v71, v71, v21, v21 bitop3:0x80
 s_waitcnt vmcnt(2)
 v_bitop3_b32 v71, v71, v22, v23 bitop3:0x80
 v_bitop3_b32 v71, v71, v24, v25 bitop3:0x80
 v_and_b32 v71, 1, v71
 v_cmp_ne_u32 vcc, 1, v71
 s_cbranch_vccz L_mahit_254
 buffer_load_dwordx4 v[10:13], v0, s[4:7], s24 offen offset:2048 sc1
 buffer_load_dwordx4 v[14:17], v0, s[4:7], s24 offen offset:3072 sc1
 s_add_u32 s51, s51, 1
 s_and_b32 s3, s51, 0xffff
 s_cmp_gt_u32 s3, 20000
 s_cbranch_scc0 L_marot_252
 s_branch L_exit1
L_mahit_253:
 ds_write_b128 v0, v[10:13] offset:2048
 ds_write_b128 v0, v[14:17] offset:3072
 s_barrier
 s_mov_b32 m0, 8192
 s_nop 0
 buffer_load_dwordx4 v0, s[4:7], s26 offen offset:0 sc1 lds
 s_waitcnt vmcnt(1)
 s_branch L_maok_237
L_mahit_254:
 ds_write_b128 v0, v[18:21] offset:2048
 ds_write_b128 v0, v[22:25] offset:3072
 s_barrier
 s_mov_b32 m0, 8192
 s_nop 0
 buffer_load_dwordx4 v0, s[4:7], s26 offen offset:0 sc1 lds
 s_branch L_maok_237
L_mahit_255:
 ds_write_b128 v0, v[54:57] offset:2048
 ds_write_b128 v0, v[58:61] offset:3072
 s_barrier
 s_mov_b32 m0, 8192
 s_nop 0
 buffer_load_dwordx4 v0, s[4:7], s26 offen offset:0 sc1 lds
 s_waitcnt vmcnt(1)
 s_branch L_maok_237
L_mbre_244:
 s_mov_b32 m0, 8192
 s_nop 0
 buffer_load_dwordx4 v0, s[4:7], s26 offen offset:0 sc1 lds
 s_add_u32 s51, s51, 65536
 s_waitcnt vmcnt(1)
 ds_read_b128 v[62:65], v0 offset:8192
 s_waitcnt lgkmcnt(0)
 v_bitop3_b32 v62, v62, v63, v64 bitop3:0xfe
 v_bitop3_b32 v62, v62, v65, v65 bitop3:0xfe
 v_bitop3_b32 v62, v62, v62, s28 bitop3:0xa0
 v_and_b32 v62, 1, v62
 v_cmp_ne_u32 vcc, 0, v62
 s_cbranch_vccz L_mbok_243
 s_mov_b32 m0, 8192
 s_nop 0
 buffer_load_dwordx4 v0, s[4:7], s26 offen offset:0 sc1 lds
 s_nop 15
 s_nop 3
L_mbspin_256:
 s_mov_b32 m0, 8192
 s_nop 0
 buffer_load_dwordx4 v0, s[4:7], s26 offen offset:0 sc1 lds
 s_add_u32 s51, s51, 65536
 s_cmp_gt_u32 s51, 1310720000
 s_cbranch_scc1 L_exit1
 s_waitcnt vmcnt(2)
 ds_read_b128 v[62:65], v0 offset:8192
 s_waitcnt lgkmcnt(0)
 v_bitop3_b32 v62, v62, v63, v64 bitop3:0xfe
 v_bitop3_b32 v62, v62, v65, v65 bitop3:0xfe
 v_bitop3_b32 v62, v62, v62, s28 bitop3:0xa0
 v_and_b32 v62, 1, v62
 v_cmp_ne_u32 vcc, 0, v62
 s_cbranch_vccnz L_mbspin_256
 s_branch L_mbok_243
L_exit:
L_exit1:
 s_endpgm
L_done1:
 s_branch L_done
L_notchain:
L_bulk:
 s_sub_u32 s48, s48, 32
 s_and_b32 s50, s48, 15
 s_lshr_b32 s51, s48, 4
 s_sub_u32 s51, s51, 2
 s_cmp_eq_u32 s51, 0
 s_mov_b32 s72, 83888896
 s_mov_b32 s73, 1536
 s_cmp_eq_u32 s51, 1
 s_cselect_b32 s72, 84216587, s72
 s_cselect_b32 s73, 1542, s73
 s_cmp_eq_u32 s51, 2
 s_cselect_b32 s72, 84544278, s72
 s_cselect_b32 s73, 1548, s73
 s_cmp_eq_u32 s51, 3
 s_cselect_b32 s72, 84871969, s72
 s_cselect_b32 s73, 1554, s73
 s_cmp_eq_u32 s51, 4
 s_cselect_b32 s72, 85199660, s72
 s_cselect_b32 s73, 1560, s73
 s_cmp_eq_u32 s51, 5
 s_cselect_b32 s72, 85527351, s72
 s_cselect_b32 s73, 1566, s73
 s_cmp_eq_u32 s51, 6
 s_cselect_b32 s72, 85855042, s72
 s_cselect_b32 s73, 1572, s73
 s_cmp_eq_u32 s51, 7
 s_cselect_b32 s72, 86182733, s72
 s_cselect_b32 s73, 1578, s73
 s_cmp_eq_u32 s51, 8
 s_cselect_b32 s72, 103287384, s72
 s_cselect_b32 s73, 1584, s73
 s_cmp_eq_u32 s51, 9
 s_cselect_b32 s72, 103680610, s72
 s_cselect_b32 s73, 1590, s73
 s_cmp_eq_u32 s51, 10
 s_cselect_b32 s72, 104073836, s72
 s_cselect_b32 s73, 1596, s73
 s_cmp_eq_u32 s51, 11
 s_cselect_b32 s72, 104467062, s72
 s_cselect_b32 s73, 1602, s73
 s_and_b32 s59, s72, 255
 s_bfe_u32 s60, s72, 0x80008
 s_bfe_u32 s61, s72, 0x80010
 s_lshr_b32 s62, s72, 24
 s_and_b32 s63, s73, 255
 s_lshr_b32 s64, s73, 8
 s_lshl_b32 s58, s50, 2
 s_add_u32 s58, s58, s46
 s_mov_b32 s68, 0xbfb8aa3b
 v_mov_b32 v246, v0
 v_lshrrev_b32 v247, 3, v246
 v_bfe_u32 v248, v246, 4, 1
 v_lshlrev_b32 v248, 2, v248
 v_xor_b32 v248, v248, v246
 v_and_b32 v248, 7, v248
 v_lshlrev_b32 v248, 4, v248
 v_lshl_add_u32 v244, v247, 13, v248
 v_mul_u32_u24 v251, 9216, v247
 v_add_u32 v251, v251, v248
 v_bfe_u32 v249, v246, 5, 1
 v_and_b32 v247, 3, v247
 v_lshl_add_u32 v247, v249, 3, v247
 v_mul_u32_u24 v245, 1152, v247
 v_add_u32 v245, v245, v248
 v_bfe_u32 v247, v246, 2, 2
 v_bfe_u32 v248, v246, 5, 1
 v_lshl_add_u32 v247, v248, 3, v247
 v_lshlrev_b32 v240, 7, v247
 v_bfe_u32 v248, v246, 3, 1
 v_lshl_add_u32 v240, v248, 6, v240
 v_bfe_u32 v248, v246, 4, 1
 v_lshl_add_u32 v240, v248, 5, v240
 v_and_b32 v248, 3, v246
 v_lshl_add_u32 v240, v248, 3, v240
 v_xor_b32 v242, 64, v240
 v_add_u32 v241, 36864, v240
 v_add_u32 v243, 36864, v242
 v_lshlrev_b32 v246, 4, v246
 s_lshl_b32 s57, s46, 10
 v_add_u32 v240, 73728, v240
 v_add_u32 v241, 73728, v241
 v_add_u32 v242, 73728, v242
 v_add_u32 v243, 73728, v243
 s_cmp_ge_u32 s50, 8
 s_cselect_b32 s89, 1, 0
 s_cmp_lt_u32 s48, 32
 s_cselect_b32 s89, 0, s89
 s_cmp_ge_u32 s48, 32
 s_cbranch_scc1 L_notg0_260
 s_lshl_b32 s59, s48, 2
 s_mov_b32 s60, 4
 s_mov_b32 s62, 0
 s_mov_b32 s69, -2
 s_add_u32 s58, s46, 8
 s_branch L_nop0_258
L_notg0_260:
 s_mov_b32 s69, s60
 s_mov_b32 s70, s50
 s_mov_b32 s71, s51
 s_cmp_lt_u32 s50, 3
 s_cselect_b32 s60, 0, s60
 s_cselect_b32 s69, -2, s69
 s_cmp_lt_u32 s50, 2
 s_cbranch_scc1 L_own_259
 s_sub_u32 s3, s50, 3
 s_cmp_lt_u32 s3, 2
 s_cbranch_scc1 L_nop0_258
 s_sub_u32 s3, s50, 4
 s_cmp_eq_u32 s50, 2
 s_cselect_b32 s3, 0, s3
 s_cmp_ge_u32 s3, 9
 s_cbranch_scc1 L_nop0_258
 s_mul_i32 s71, s51, 9
 s_add_u32 s3, s3, s71
 s_cmp_ge_u32 s3, 104
 s_cbranch_scc1 L_nop0_258
 s_and_b32 s70, s3, 1
 s_lshr_b32 s71, s3, 1
 s_add_u32 s71, s71, 12
L_own_259:
 s_mov_b32 s90, s59
 s_mov_b32 s91, s60
 s_lshl_b32 s59, s71, 1
 s_mov_b32 s60, 2
 s_lshl_b32 s58, s70, 2
 s_add_u32 s58, s58, s46
 v_bfe_u32 v247, v246, 4, 5
 s_lshl_b32 s3, s58, 5
 v_add_u32 v247, s3, v247
 v_mul_u32_u24 v247, 1152, v247
 v_bfe_u32 v248, v246, 9, 1
 v_lshl_add_u32 v247, v248, 4, v247
 buffer_load_dwordx4 v[0:3], v247, s[24:27], 0 offen offset:0
 buffer_load_dwordx4 v[4:7], v247, s[24:27], 0 offen offset:32
 buffer_load_dwordx4 v[8:11], v247, s[24:27], 0 offen offset:64
 buffer_load_dwordx4 v[12:15], v247, s[24:27], 0 offen offset:96
 buffer_load_dwordx4 v[16:19], v247, s[24:27], 0 offen offset:128
 buffer_load_dwordx4 v[20:23], v247, s[24:27], 0 offen offset:160
 buffer_load_dwordx4 v[24:27], v247, s[24:27], 0 offen offset:192
 buffer_load_dwordx4 v[28:31], v247, s[24:27], 0 offen offset:224
 buffer_load_dwordx4 v[32:35], v247, s[24:27], 0 offen offset:256
 buffer_load_dwordx4 v[36:39], v247, s[24:27], 0 offen offset:288
 buffer_load_dwordx4 v[40:43], v247, s[24:27], 0 offen offset:320
 buffer_load_dwordx4 v[44:47], v247, s[24:27], 0 offen offset:352
 buffer_load_dwordx4 v[48:51], v247, s[24:27], 0 offen offset:384
 buffer_load_dwordx4 v[52:55], v247, s[24:27], 0 offen offset:416
 buffer_load_dwordx4 v[56:59], v247, s[24:27], 0 offen offset:448
 buffer_load_dwordx4 v[60:63], v247, s[24:27], 0 offen offset:480
 buffer_load_dwordx4 v[64:67], v247, s[24:27], 0 offen offset:512
 buffer_load_dwordx4 v[68:71], v247, s[24:27], 0 offen offset:544
 buffer_load_dwordx4 v[72:75], v247, s[24:27], 0 offen offset:576
 buffer_load_dwordx4 v[76:79], v247, s[24:27], 0 offen offset:608
 buffer_load_dwordx4 v[80:83], v247, s[24:27], 0 offen offset:640
 buffer_load_dwordx4 v[84:87], v247, s[24:27], 0 offen offset:672
 buffer_load_dwordx4 v[88:91], v247, s[24:27], 0 offen offset:704
 buffer_load_dwordx4 v[92:95], v247, s[24:27], 0 offen offset:736
 buffer_load_dwordx4 v[96:99], v247, s[24:27], 0 offen offset:768
 buffer_load_dwordx4 v[100:103], v247, s[24:27], 0 offen offset:800
 buffer_load_dwordx4 v[104:107], v247, s[24:27], 0 offen offset:832
 buffer_load_dwordx4 v[108:111], v247, s[24:27], 0 offen offset:864
 buffer_load_dwordx4 v[112:115], v247, s[24:27], 0 offen offset:896
 buffer_load_dwordx4 v[116:119], v247, s[24:27], 0 offen offset:928
 buffer_load_dwordx4 v[120:123], v247, s[24:27], 0 offen offset:960
 buffer_load_dwordx4 v[124:127], v247, s[24:27], 0 offen offset:992
 buffer_load_dwordx4 v[128:131], v247, s[24:27], 0 offen offset:1024
 buffer_load_dwordx4 v[132:135], v247, s[24:27], 0 offen offset:1056
 buffer_load_dwordx4 v[136:139], v247, s[24:27], 0 offen offset:1088
 buffer_load_dwordx4 v[140:143], v247, s[24:27], 0 offen offset:1120
 s_mov_b32 s52, 0
 s_cmp_ge_u32 s52, s60
 s_cbranch_scc1 L_pq_261
 s_add_u32 s72, s59, s52
 s_cmp_ge_u32 s72, 64
 s_cbranch_scc1 L_pv_262
 s_mov_b32 s40, s12
 s_mov_b32 s41, s13
 s_mov_b32 s42, s14
 s_mov_b32 s43, s15
 s_mov_b32 s73, 0
 s_mov_b32 s66, 0
 s_branch L_pe_263
L_pv_262:
 s_sub_u32 s72, s72, 64
 s_mov_b32 s40, s16
 s_mov_b32 s41, s17
 s_mov_b32 s42, s18
 s_mov_b32 s43, s19
 s_mov_b32 s73, 16777216
 s_mov_b32 s66, 1
 s_branch L_pe_263
L_pq_261:
 s_sub_u32 s72, s52, s60
 s_add_u32 s72, s72, s61
 s_mov_b32 s40, s8
 s_mov_b32 s41, s9
 s_mov_b32 s42, s10
 s_mov_b32 s43, s11
 s_mov_b32 s73, 33554432
 s_mov_b32 s66, 0
L_pe_263:
 s_lshl_b32 s54, s72, 7
 s_lshl_b32 s3, s46, 16
 s_add_u32 s54, s54, s3
 s_lshl_b32 s74, s72, 12
 s_lshl_b32 s3, s58, 18
 s_add_u32 s74, s74, s3
 s_add_u32 s74, s74, s73
 s_mov_b32 s67, 262144
 v_mov_b32 v144, 0
 v_mov_b32 v145, 0
 v_mov_b32 v146, 0
 v_mov_b32 v147, 0
 v_mov_b32 v148, 0
 v_mov_b32 v149, 0
 v_mov_b32 v150, 0
 v_mov_b32 v151, 0
 v_mov_b32 v152, 0x3f803f80
 s_waitcnt vmcnt(32)
 v_dot2c_f32_bf16 v144, v0, v152
 v_dot2c_f32_bf16 v148, v0, v0
 v_dot2c_f32_bf16 v145, v1, v152
 v_dot2c_f32_bf16 v149, v1, v1
 v_dot2c_f32_bf16 v146, v2, v152
 v_dot2c_f32_bf16 v150, v2, v2
 v_dot2c_f32_bf16 v147, v3, v152
 v_dot2c_f32_bf16 v151, v3, v3
 v_dot2c_f32_bf16 v144, v4, v152
 v_dot2c_f32_bf16 v148, v4, v4
 v_dot2c_f32_bf16 v145, v5, v152
 v_dot2c_f32_bf16 v149, v5, v5
 v_dot2c_f32_bf16 v146, v6, v152
 v_dot2c_f32_bf16 v150, v6, v6
 v_dot2c_f32_bf16 v147, v7, v152
 v_dot2c_f32_bf16 v151, v7, v7
 v_dot2c_f32_bf16 v144, v8, v152
 v_dot2c_f32_bf16 v148, v8, v8
 v_dot2c_f32_bf16 v145, v9, v152
 v_dot2c_f32_bf16 v149, v9, v9
 v_dot2c_f32_bf16 v146, v10, v152
 v_dot2c_f32_bf16 v150, v10, v10
 v_dot2c_f32_bf16 v147, v11, v152
 v_dot2c_f32_bf16 v151, v11, v11
 v_dot2c_f32_bf16 v144, v12, v152
 v_dot2c_f32_bf16 v148, v12, v12
 v_dot2c_f32_bf16 v145, v13, v152
 v_dot2c_f32_bf16 v149, v13, v13
 v_dot2c_f32_bf16 v146, v14, v152
 v_dot2c_f32_bf16 v150, v14, v14
 v_dot2c_f32_bf16 v147, v15, v152
 v_dot2c_f32_bf16 v151, v15, v15
 s_waitcnt vmcnt(28)
 v_dot2c_f32_bf16 v144, v16, v152
 v_dot2c_f32_bf16 v148, v16, v16
 v_dot2c_f32_bf16 v145, v17, v152
 v_dot2c_f32_bf16 v149, v17, v17
 v_dot2c_f32_bf16 v146, v18, v152
 v_dot2c_f32_bf16 v150, v18, v18
 v_dot2c_f32_bf16 v147, v19, v152
 v_dot2c_f32_bf16 v151, v19, v19
 v_dot2c_f32_bf16 v144, v20, v152
 v_dot2c_f32_bf16 v148, v20, v20
 v_dot2c_f32_bf16 v145, v21, v152
 v_dot2c_f32_bf16 v149, v21, v21
 v_dot2c_f32_bf16 v146, v22, v152
 v_dot2c_f32_bf16 v150, v22, v22
 v_dot2c_f32_bf16 v147, v23, v152
 v_dot2c_f32_bf16 v151, v23, v23
 v_dot2c_f32_bf16 v144, v24, v152
 v_dot2c_f32_bf16 v148, v24, v24
 v_dot2c_f32_bf16 v145, v25, v152
 v_dot2c_f32_bf16 v149, v25, v25
 v_dot2c_f32_bf16 v146, v26, v152
 v_dot2c_f32_bf16 v150, v26, v26
 v_dot2c_f32_bf16 v147, v27, v152
 v_dot2c_f32_bf16 v151, v27, v27
 v_dot2c_f32_bf16 v144, v28, v152
 v_dot2c_f32_bf16 v148, v28, v28
 v_dot2c_f32_bf16 v145, v29, v152
 v_dot2c_f32_bf16 v149, v29, v29
 v_dot2c_f32_bf16 v146, v30, v152
 v_dot2c_f32_bf16 v150, v30, v30
 v_dot2c_f32_bf16 v147, v31, v152
 v_dot2c_f32_bf16 v151, v31, v31
 s_waitcnt vmcnt(24)
 v_dot2c_f32_bf16 v144, v32, v152
 v_dot2c_f32_bf16 v148, v32, v32
 v_dot2c_f32_bf16 v145, v33, v152
 v_dot2c_f32_bf16 v149, v33, v33
 v_dot2c_f32_bf16 v146, v34, v152
 v_dot2c_f32_bf16 v150, v34, v34
 v_dot2c_f32_bf16 v147, v35, v152
 v_dot2c_f32_bf16 v151, v35, v35
 v_dot2c_f32_bf16 v144, v36, v152
 v_dot2c_f32_bf16 v148, v36, v36
 v_dot2c_f32_bf16 v145, v37, v152
 v_dot2c_f32_bf16 v149, v37, v37
 v_dot2c_f32_bf16 v146, v38, v152
 v_dot2c_f32_bf16 v150, v38, v38
 v_dot2c_f32_bf16 v147, v39, v152
 v_dot2c_f32_bf16 v151, v39, v39
 v_dot2c_f32_bf16 v144, v40, v152
 v_dot2c_f32_bf16 v148, v40, v40
 v_dot2c_f32_bf16 v145, v41, v152
 v_dot2c_f32_bf16 v149, v41, v41
 v_dot2c_f32_bf16 v146, v42, v152
 v_dot2c_f32_bf16 v150, v42, v42
 v_dot2c_f32_bf16 v147, v43, v152
 v_dot2c_f32_bf16 v151, v43, v43
 v_dot2c_f32_bf16 v144, v44, v152
 v_dot2c_f32_bf16 v148, v44, v44
 v_dot2c_f32_bf16 v145, v45, v152
 v_dot2c_f32_bf16 v149, v45, v45
 v_dot2c_f32_bf16 v146, v46, v152
 v_dot2c_f32_bf16 v150, v46, v46
 v_dot2c_f32_bf16 v147, v47, v152
 v_dot2c_f32_bf16 v151, v47, v47
 s_waitcnt vmcnt(20)
 v_dot2c_f32_bf16 v144, v48, v152
 v_dot2c_f32_bf16 v148, v48, v48
 v_dot2c_f32_bf16 v145, v49, v152
 v_dot2c_f32_bf16 v149, v49, v49
 v_dot2c_f32_bf16 v146, v50, v152
 v_dot2c_f32_bf16 v150, v50, v50
 v_dot2c_f32_bf16 v147, v51, v152
 v_dot2c_f32_bf16 v151, v51, v51
 v_dot2c_f32_bf16 v144, v52, v152
 v_dot2c_f32_bf16 v148, v52, v52
 v_dot2c_f32_bf16 v145, v53, v152
 v_dot2c_f32_bf16 v149, v53, v53
 v_dot2c_f32_bf16 v146, v54, v152
 v_dot2c_f32_bf16 v150, v54, v54
 v_dot2c_f32_bf16 v147, v55, v152
 v_dot2c_f32_bf16 v151, v55, v55
 v_dot2c_f32_bf16 v144, v56, v152
 v_dot2c_f32_bf16 v148, v56, v56
 v_dot2c_f32_bf16 v145, v57, v152
 v_dot2c_f32_bf16 v149, v57, v57
 v_dot2c_f32_bf16 v146, v58, v152
 v_dot2c_f32_bf16 v150, v58, v58
 v_dot2c_f32_bf16 v147, v59, v152
 v_dot2c_f32_bf16 v151, v59, v59
 v_dot2c_f32_bf16 v144, v60, v152
 v_dot2c_f32_bf16 v148, v60, v60
 v_dot2c_f32_bf16 v145, v61, v152
 v_dot2c_f32_bf16 v149, v61, v61
 v_dot2c_f32_bf16 v146, v62, v152
 v_dot2c_f32_bf16 v150, v62, v62
 v_dot2c_f32_bf16 v147, v63, v152
 v_dot2c_f32_bf16 v151, v63, v63
 s_waitcnt vmcnt(16)
 v_dot2c_f32_bf16 v144, v64, v152
 v_dot2c_f32_bf16 v148, v64, v64
 v_dot2c_f32_bf16 v145, v65, v152
 v_dot2c_f32_bf16 v149, v65, v65
 v_dot2c_f32_bf16 v146, v66, v152
 v_dot2c_f32_bf16 v150, v66, v66
 v_dot2c_f32_bf16 v147, v67, v152
 v_dot2c_f32_bf16 v151, v67, v67
 v_dot2c_f32_bf16 v144, v68, v152
 v_dot2c_f32_bf16 v148, v68, v68
 v_dot2c_f32_bf16 v145, v69, v152
 v_dot2c_f32_bf16 v149, v69, v69
 v_dot2c_f32_bf16 v146, v70, v152
 v_dot2c_f32_bf16 v150, v70, v70
 v_dot2c_f32_bf16 v147, v71, v152
 v_dot2c_f32_bf16 v151, v71, v71
 v_dot2c_f32_bf16 v144, v72, v152
 v_dot2c_f32_bf16 v148, v72, v72
 v_dot2c_f32_bf16 v145, v73, v152
 v_dot2c_f32_bf16 v149, v73, v73
 v_dot2c_f32_bf16 v146, v74, v152
 v_dot2c_f32_bf16 v150, v74, v74
 v_dot2c_f32_bf16 v147, v75, v152
 v_dot2c_f32_bf16 v151, v75, v75
 v_dot2c_f32_bf16 v144, v76, v152
 v_dot2c_f32_bf16 v148, v76, v76
 v_dot2c_f32_bf16 v145, v77, v152
 v_dot2c_f32_bf16 v149, v77, v77
 v_dot2c_f32_bf16 v146, v78, v152
 v_dot2c_f32_bf16 v150, v78, v78
 v_dot2c_f32_bf16 v147, v79, v152
 v_dot2c_f32_bf16 v151, v79, v79
 s_waitcnt vmcnt(12)
 v_dot2c_f32_bf16 v144, v80, v152
 v_dot2c_f32_bf16 v148, v80, v80
 v_dot2c_f32_bf16 v145, v81, v152
 v_dot2c_f32_bf16 v149, v81, v81
 v_dot2c_f32_bf16 v146, v82, v152
 v_dot2c_f32_bf16 v150, v82, v82
 v_dot2c_f32_bf16 v147, v83, v152
 v_dot2c_f32_bf16 v151, v83, v83
 v_dot2c_f32_bf16 v144, v84, v152
 v_dot2c_f32_bf16 v148, v84, v84
 v_dot2c_f32_bf16 v145, v85, v152
 v_dot2c_f32_bf16 v149, v85, v85
 v_dot2c_f32_bf16 v146, v86, v152
 v_dot2c_f32_bf16 v150, v86, v86
 v_dot2c_f32_bf16 v147, v87, v152
 v_dot2c_f32_bf16 v151, v87, v87
 v_dot2c_f32_bf16 v144, v88, v152
 v_dot2c_f32_bf16 v148, v88, v88
 v_dot2c_f32_bf16 v145, v89, v152
 v_dot2c_f32_bf16 v149, v89, v89
 v_dot2c_f32_bf16 v146, v90, v152
 v_dot2c_f32_bf16 v150, v90, v90
 v_dot2c_f32_bf16 v147, v91, v152
 v_dot2c_f32_bf16 v151, v91, v91
 v_dot2c_f32_bf16 v144, v92, v152
 v_dot2c_f32_bf16 v148, v92, v92
 v_dot2c_f32_bf16 v145, v93, v152
 v_dot2c_f32_bf16 v149, v93, v93
 v_dot2c_f32_bf16 v146, v94, v152
 v_dot2c_f32_bf16 v150, v94, v94
 v_dot2c_f32_bf16 v147, v95, v152
 v_dot2c_f32_bf16 v151, v95, v95
 s_waitcnt vmcnt(8)
 v_dot2c_f32_bf16 v144, v96, v152
 v_dot2c_f32_bf16 v148, v96, v96
 v_dot2c_f32_bf16 v145, v97, v152
 v_dot2c_f32_bf16 v149, v97, v97
 v_dot2c_f32_bf16 v146, v98, v152
 v_dot2c_f32_bf16 v150, v98, v98
 v_dot2c_f32_bf16 v147, v99, v152
 v_dot2c_f32_bf16 v151, v99, v99
 v_dot2c_f32_bf16 v144, v100, v152
 v_dot2c_f32_bf16 v148, v100, v100
 v_dot2c_f32_bf16 v145, v101, v152
 v_dot2c_f32_bf16 v149, v101, v101
 v_dot2c_f32_bf16 v146, v102, v152
 v_dot2c_f32_bf16 v150, v102, v102
 v_dot2c_f32_bf16 v147, v103, v152
 v_dot2c_f32_bf16 v151, v103, v103
 v_dot2c_f32_bf16 v144, v104, v152
 v_dot2c_f32_bf16 v148, v104, v104
 v_dot2c_f32_bf16 v145, v105, v152
 v_dot2c_f32_bf16 v149, v105, v105
 v_dot2c_f32_bf16 v146, v106, v152
 v_dot2c_f32_bf16 v150, v106, v106
 v_dot2c_f32_bf16 v147, v107, v152
 v_dot2c_f32_bf16 v151, v107, v107
 v_dot2c_f32_bf16 v144, v108, v152
 v_dot2c_f32_bf16 v148, v108, v108
 v_dot2c_f32_bf16 v145, v109, v152
 v_dot2c_f32_bf16 v149, v109, v109
 v_dot2c_f32_bf16 v146, v110, v152
 v_dot2c_f32_bf16 v150, v110, v110
 v_dot2c_f32_bf16 v147, v111, v152
 v_dot2c_f32_bf16 v151, v111, v111
 s_waitcnt vmcnt(4)
 v_dot2c_f32_bf16 v144, v112, v152
 v_dot2c_f32_bf16 v148, v112, v112
 v_dot2c_f32_bf16 v145, v113, v152
 v_dot2c_f32_bf16 v149, v113, v113
 v_dot2c_f32_bf16 v146, v114, v152
 v_dot2c_f32_bf16 v150, v114, v114
 v_dot2c_f32_bf16 v147, v115, v152
 v_dot2c_f32_bf16 v151, v115, v115
 v_dot2c_f32_bf16 v144, v116, v152
 v_dot2c_f32_bf16 v148, v116, v116
 v_dot2c_f32_bf16 v145, v117, v152
 v_dot2c_f32_bf16 v149, v117, v117
 v_dot2c_f32_bf16 v146, v118, v152
 v_dot2c_f32_bf16 v150, v118, v118
 v_dot2c_f32_bf16 v147, v119, v152
 v_dot2c_f32_bf16 v151, v119, v119
 v_dot2c_f32_bf16 v144, v120, v152
 v_dot2c_f32_bf16 v148, v120, v120
 v_dot2c_f32_bf16 v145, v121, v152
 v_dot2c_f32_bf16 v149, v121, v121
 v_dot2c_f32_bf16 v146, v122, v152
 v_dot2c_f32_bf16 v150, v122, v122
 v_dot2c_f32_bf16 v147, v123, v152
 v_dot2c_f32_bf16 v151, v123, v123
 v_dot2c_f32_bf16 v144, v124, v152
 v_dot2c_f32_bf16 v148, v124, v124
 v_dot2c_f32_bf16 v145, v125, v152
 v_dot2c_f32_bf16 v149, v125, v125
 v_dot2c_f32_bf16 v146, v126, v152
 v_dot2c_f32_bf16 v150, v126, v126
 v_dot2c_f32_bf16 v147, v127, v152
 v_dot2c_f32_bf16 v151, v127, v127
 s_waitcnt vmcnt(0)
 v_dot2c_f32_bf16 v144, v128, v152
 v_dot2c_f32_bf16 v148, v128, v128
 v_dot2c_f32_bf16 v145, v129, v152
 v_dot2c_f32_bf16 v149, v129, v129
 v_dot2c_f32_bf16 v146, v130, v152
 v_dot2c_f32_bf16 v150, v130, v130
 v_dot2c_f32_bf16 v147, v131, v152
 v_dot2c_f32_bf16 v151, v131, v131
 v_dot2c_f32_bf16 v144, v132, v152
 v_dot2c_f32_bf16 v148, v132, v132
 v_dot2c_f32_bf16 v145, v133, v152
 v_dot2c_f32_bf16 v149, v133, v133
 v_dot2c_f32_bf16 v146, v134, v152
 v_dot2c_f32_bf16 v150, v134, v134
 v_dot2c_f32_bf16 v147, v135, v152
 v_dot2c_f32_bf16 v151, v135, v135
 v_dot2c_f32_bf16 v144, v136, v152
 v_dot2c_f32_bf16 v148, v136, v136
 v_dot2c_f32_bf16 v145, v137, v152
 v_dot2c_f32_bf16 v149, v137, v137
 v_dot2c_f32_bf16 v146, v138, v152
 v_dot2c_f32_bf16 v150, v138, v138
 v_dot2c_f32_bf16 v147, v139, v152
 v_dot2c_f32_bf16 v151, v139, v139
 v_dot2c_f32_bf16 v144, v140, v152
 v_dot2c_f32_bf16 v148, v140, v140
 v_dot2c_f32_bf16 v145, v141, v152
 v_dot2c_f32_bf16 v149, v141, v141
 v_dot2c_f32_bf16 v146, v142, v152
 v_dot2c_f32_bf16 v150, v142, v142
 v_dot2c_f32_bf16 v147, v143, v152
 v_dot2c_f32_bf16 v151, v143, v143
 s_nop 2
 v_add_f32 v144, v144, v145
 v_add_f32 v146, v146, v147
 v_add_f32 v144, v144, v146
 v_mov_b32 v145, v144
 v_add_f32 v148, v148, v149
 v_add_f32 v150, v150, v151
 v_add_f32 v148, v148, v150
 v_mov_b32 v149, v148
 s_nop 1
 v_permlane32_swap_b32 v144, v145
 v_permlane32_swap_b32 v148, v149
 v_add_f32 v144, v144, v145
 v_add_f32 v148, v148, v149
 v_mul_f32 v144, 0x3ae38e39, v144
 v_mul_f32 v148, 0x3ae38e39, v148
 v_fma_f32 v148, -v144, v144, v148
 v_max_f32 v148, 0, v148
 v_cvt_pk_bf16_f32 v145, v148, v144
 v_lshlrev_b32 v148, 16, v145
 v_and_b32 v144, 0xffff0000, v145
 v_add_f32 v148, 0x3727c5ac, v148
 v_cvt_pk_bf16_f32 v148, v148, v148
 v_lshlrev_b32 v148, 16, v148
 v_sqrt_f32 v148, v148
 s_nop 0
 v_cvt_pk_bf16_f32 v148, v148, v148
 v_lshlrev_b32 v148, 16, v148
 v_rcp_f32 v148, v148
 s_nop 0
 v_mul_f32 v144, v144, v148
 s_mov_b32 s78, 0xffff0000
 v_lshlrev_b32 v160, 16, v0
 v_and_b32 v161, s78, v0
 v_pk_fma_f32 v[160:161], v[160:161], v[148:149], v[144:145] op_sel_hi:[1,0,0] neg_lo:[0,0,1] neg_hi:[0,0,1]
 v_cvt_pk_bf16_f32 v0, v160, v161
 s_add_u32 m0, s57, 0
 s_nop 0
 buffer_load_dwordx4 v244, s[40:43], s54 offen  lds
 s_add_u32 s54, s54, s67
 v_lshlrev_b32 v162, 16, v1
 v_and_b32 v163, s78, v1
 v_pk_fma_f32 v[162:163], v[162:163], v[148:149], v[144:145] op_sel_hi:[1,0,0] neg_lo:[0,0,1] neg_hi:[0,0,1]
 v_cvt_pk_bf16_f32 v1, v162, v163
 v_lshlrev_b32 v164, 16, v2
 v_and_b32 v165, s78, v2
 v_pk_fma_f32 v[164:165], v[164:165], v[148:149], v[144:145] op_sel_hi:[1,0,0] neg_lo:[0,0,1] neg_hi:[0,0,1]
 v_cvt_pk_bf16_f32 v2, v164, v165
 v_lshlrev_b32 v166, 16, v3
 v_and_b32 v167, s78, v3
 v_pk_fma_f32 v[166:167], v[166:167], v[148:149], v[144:145] op_sel_hi:[1,0,0] neg_lo:[0,0,1] neg_hi:[0,0,1]
 v_cvt_pk_bf16_f32 v3, v166, v167
 v_lshlrev_b32 v160, 16, v4
 v_and_b32 v161, s78, v4
 v_pk_fma_f32 v[160:161], v[160:161], v[148:149], v[144:145] op_sel_hi:[1,0,0] neg_lo:[0,0,1] neg_hi:[0,0,1]
 v_cvt_pk_bf16_f32 v4, v160, v161
 s_add_u32 m0, s57, 4096
 s_nop 0
 buffer_load_dwordx4 v244, s[40:43], s54 offen  lds
 s_add_u32 s54, s54, s67
 v_lshlrev_b32 v162, 16, v5
 v_and_b32 v163, s78, v5
 v_pk_fma_f32 v[162:163], v[162:163], v[148:149], v[144:145] op_sel_hi:[1,0,0] neg_lo:[0,0,1] neg_hi:[0,0,1]
 v_cvt_pk_bf16_f32 v5, v162, v163
 v_lshlrev_b32 v164, 16, v6
 v_and_b32 v165, s78, v6
 v_pk_fma_f32 v[164:165], v[164:165], v[148:149], v[144:145] op_sel_hi:[1,0,0] neg_lo:[0,0,1] neg_hi:[0,0,1]
 v_cvt_pk_bf16_f32 v6, v164, v165
 v_lshlrev_b32 v166, 16, v7
 v_and_b32 v167, s78, v7
 v_pk_fma_f32 v[166:167], v[166:167], v[148:149], v[144:145] op_sel_hi:[1,0,0] neg_lo:[0,0,1] neg_hi:[0,0,1]
 v_cvt_pk_bf16_f32 v7, v166, v167
 v_lshlrev_b32 v160, 16, v8
 v_and_b32 v161, s78, v8
 v_pk_fma_f32 v[160:161], v[160:161], v[148:149], v[144:145] op_sel_hi:[1,0,0] neg_lo:[0,0,1] neg_hi:[0,0,1]
 v_cvt_pk_bf16_f32 v8, v160, v161
 s_add_u32 m0, s57, 8192
 s_nop 0
 buffer_load_dwordx4 v244, s[40:43], s54 offen  lds
 s_add_u32 s54, s54, s67
 v_lshlrev_b32 v162, 16, v9
 v_and_b32 v163, s78, v9
 v_pk_fma_f32 v[162:163], v[162:163], v[148:149], v[144:145] op_sel_hi:[1,0,0] neg_lo:[0,0,1] neg_hi:[0,0,1]
 v_cvt_pk_bf16_f32 v9, v162, v163
 v_lshlrev_b32 v164, 16, v10
 v_and_b32 v165, s78, v10
 v_pk_fma_f32 v[164:165], v[164:165], v[148:149], v[144:145] op_sel_hi:[1,0,0] neg_lo:[0,0,1] neg_hi:[0,0,1]
 v_cvt_pk_bf16_f32 v10, v164, v165
 v_lshlrev_b32 v166, 16, v11
 v_and_b32 v167, s78, v11
 v_pk_fma_f32 v[166:167], v[166:167], v[148:149], v[144:145] op_sel_hi:[1,0,0] neg_lo:[0,0,1] neg_hi:[0,0,1]
 v_cvt_pk_bf16_f32 v11, v166, v167
 v_lshlrev_b32 v160, 16, v12
 v_and_b32 v161, s78, v12
 v_pk_fma_f32 v[160:161], v[160:161], v[148:149], v[144:145] op_sel_hi:[1,0,0] neg_lo:[0,0,1] neg_hi:[0,0,1]
 v_cvt_pk_bf16_f32 v12, v160, v161
 s_add_u32 m0, s57, 12288
 s_nop 0
 buffer_load_dwordx4 v244, s[40:43], s54 offen  lds
 s_add_u32 s54, s54, s67
 v_lshlrev_b32 v162, 16, v13
 v_and_b32 v163, s78, v13
 v_pk_fma_f32 v[162:163], v[162:163], v[148:149], v[144:145] op_sel_hi:[1,0,0] neg_lo:[0,0,1] neg_hi:[0,0,1]
 v_cvt_pk_bf16_f32 v13, v162, v163
 v_lshlrev_b32 v164, 16, v14
 v_and_b32 v165, s78, v14
 v_pk_fma_f32 v[164:165], v[164:165], v[148:149], v[144:145] op_sel_hi:[1,0,0] neg_lo:[0,0,1] neg_hi:[0,0,1]
 v_cvt_pk_bf16_f32 v14, v164, v165
 v_lshlrev_b32 v166, 16, v15
 v_and_b32 v167, s78, v15
 v_pk_fma_f32 v[166:167], v[166:167], v[148:149], v[144:145] op_sel_hi:[1,0,0] neg_lo:[0,0,1] neg_hi:[0,0,1]
 v_cvt_pk_bf16_f32 v15, v166, v167
 v_lshlrev_b32 v160, 16, v16
 v_and_b32 v161, s78, v16
 v_pk_fma_f32 v[160:161], v[160:161], v[148:149], v[144:145] op_sel_hi:[1,0,0] neg_lo:[0,0,1] neg_hi:[0,0,1]
 v_cvt_pk_bf16_f32 v16, v160, v161
 s_add_u32 m0, s57, 16384
 s_nop 0
 buffer_load_dwordx4 v244, s[40:43], s54 offen  lds
 s_add_u32 s54, s54, s67
 v_lshlrev_b32 v162, 16, v17
 v_and_b32 v163, s78, v17
 v_pk_fma_f32 v[162:163], v[162:163], v[148:149], v[144:145] op_sel_hi:[1,0,0] neg_lo:[0,0,1] neg_hi:[0,0,1]
 v_cvt_pk_bf16_f32 v17, v162, v163
 v_lshlrev_b32 v164, 16, v18
 v_and_b32 v165, s78, v18
 v_pk_fma_f32 v[164:165], v[164:165], v[148:149], v[144:145] op_sel_hi:[1,0,0] neg_lo:[0,0,1] neg_hi:[0,0,1]
 v_cvt_pk_bf16_f32 v18, v164, v165
 v_lshlrev_b32 v166, 16, v19
 v_and_b32 v167, s78, v19
 v_pk_fma_f32 v[166:167], v[166:167], v[148:149], v[144:145] op_sel_hi:[1,0,0] neg_lo:[0,0,1] neg_hi:[0,0,1]
 v_cvt_pk_bf16_f32 v19, v166, v167
 v_lshlrev_b32 v160, 16, v20
 v_and_b32 v161, s78, v20
 v_pk_fma_f32 v[160:161], v[160:161], v[148:149], v[144:145] op_sel_hi:[1,0,0] neg_lo:[0,0,1] neg_hi:[0,0,1]
 v_cvt_pk_bf16_f32 v20, v160, v161
 s_add_u32 m0, s57, 20480
 s_nop 0
 buffer_load_dwordx4 v244, s[40:43], s54 offen  lds
 s_add_u32 s54, s54, s67
 v_lshlrev_b32 v162, 16, v21
 v_and_b32 v163, s78, v21
 v_pk_fma_f32 v[162:163], v[162:163], v[148:149], v[144:145] op_sel_hi:[1,0,0] neg_lo:[0,0,1] neg_hi:[0,0,1]
 v_cvt_pk_bf16_f32 v21, v162, v163
 v_lshlrev_b32 v164, 16, v22
 v_and_b32 v165, s78, v22
 v_pk_fma_f32 v[164:165], v[164:165], v[148:149], v[144:145] op_sel_hi:[1,0,0] neg_lo:[0,0,1] neg_hi:[0,0,1]
 v_cvt_pk_bf16_f32 v22, v164, v165
 v_lshlrev_b32 v166, 16, v23
 v_and_b32 v167, s78, v23
 v_pk_fma_f32 v[166:167], v[166:167], v[148:149], v[144:145] op_sel_hi:[1,0,0] neg_lo:[0,0,1] neg_hi:[0,0,1]
 v_cvt_pk_bf16_f32 v23, v166, v167
 v_lshlrev_b32 v160, 16, v24
 v_and_b32 v161, s78, v24
 v_pk_fma_f32 v[160:161], v[160:161], v[148:149], v[144:145] op_sel_hi:[1,0,0] neg_lo:[0,0,1] neg_hi:[0,0,1]
 v_cvt_pk_bf16_f32 v24, v160, v161
 s_add_u32 m0, s57, 24576
 s_nop 0
 buffer_load_dwordx4 v244, s[40:43], s54 offen  lds
 s_add_u32 s54, s54, s67
 v_lshlrev_b32 v162, 16, v25
 v_and_b32 v163, s78, v25
 v_pk_fma_f32 v[162:163], v[162:163], v[148:149], v[144:145] op_sel_hi:[1,0,0] neg_lo:[0,0,1] neg_hi:[0,0,1]
 v_cvt_pk_bf16_f32 v25, v162, v163
 v_lshlrev_b32 v164, 16, v26
 v_and_b32 v165, s78, v26
 v_pk_fma_f32 v[164:165], v[164:165], v[148:149], v[144:145] op_sel_hi:[1,0,0] neg_lo:[0,0,1] neg_hi:[0,0,1]
 v_cvt_pk_bf16_f32 v26, v164, v165
 v_lshlrev_b32 v166, 16, v27
 v_and_b32 v167, s78, v27
 v_pk_fma_f32 v[166:167], v[166:167], v[148:149], v[144:145] op_sel_hi:[1,0,0] neg_lo:[0,0,1] neg_hi:[0,0,1]
 v_cvt_pk_bf16_f32 v27, v166, v167
 v_lshlrev_b32 v160, 16, v28
 v_and_b32 v161, s78, v28
 v_pk_fma_f32 v[160:161], v[160:161], v[148:149], v[144:145] op_sel_hi:[1,0,0] neg_lo:[0,0,1] neg_hi:[0,0,1]
 v_cvt_pk_bf16_f32 v28, v160, v161
 s_add_u32 m0, s57, 28672
 s_nop 0
 buffer_load_dwordx4 v244, s[40:43], s54 offen  lds
 s_add_u32 s54, s54, s67
 v_lshlrev_b32 v162, 16, v29
 v_and_b32 v163, s78, v29
 v_pk_fma_f32 v[162:163], v[162:163], v[148:149], v[144:145] op_sel_hi:[1,0,0] neg_lo:[0,0,1] neg_hi:[0,0,1]
 v_cvt_pk_bf16_f32 v29, v162, v163
 v_lshlrev_b32 v164, 16, v30
 v_and_b32 v165, s78, v30
 v_pk_fma_f32 v[164:165], v[164:165], v[148:149], v[144:145] op_sel_hi:[1,0,0] neg_lo:[0,0,1] neg_hi:[0,0,1]
 v_cvt_pk_bf16_f32 v30, v164, v165
 v_lshlrev_b32 v166, 16, v31
 v_and_b32 v167, s78, v31
 v_pk_fma_f32 v[166:167], v[166:167], v[148:149], v[144:145] op_sel_hi:[1,0,0] neg_lo:[0,0,1] neg_hi:[0,0,1]
 v_cvt_pk_bf16_f32 v31, v166, v167
 v_lshlrev_b32 v160, 16, v32
 v_and_b32 v161, s78, v32
 v_pk_fma_f32 v[160:161], v[160:161], v[148:149], v[144:145] op_sel_hi:[1,0,0] neg_lo:[0,0,1] neg_hi:[0,0,1]
 v_cvt_pk_bf16_f32 v32, v160, v161
 s_add_u32 m0, s57, 32768
 s_nop 0
 buffer_load_dwordx4 v244, s[40:43], s54 offen  lds
 s_add_u32 s54, s54, s67
 v_lshlrev_b32 v162, 16, v33
 v_and_b32 v163, s78, v33
 v_pk_fma_f32 v[162:163], v[162:163], v[148:149], v[144:145] op_sel_hi:[1,0,0] neg_lo:[0,0,1] neg_hi:[0,0,1]
 v_cvt_pk_bf16_f32 v33, v162, v163
 v_lshlrev_b32 v164, 16, v34
 v_and_b32 v165, s78, v34
 v_pk_fma_f32 v[164:165], v[164:165], v[148:149], v[144:145] op_sel_hi:[1,0,0] neg_lo:[0,0,1] neg_hi:[0,0,1]
 v_cvt_pk_bf16_f32 v34, v164, v165
 v_lshlrev_b32 v166, 16, v35
 v_and_b32 v167, s78, v35
 v_pk_fma_f32 v[166:167], v[166:167], v[148:149], v[144:145] op_sel_hi:[1,0,0] neg_lo:[0,0,1] neg_hi:[0,0,1]
 v_cvt_pk_bf16_f32 v35, v166, v167
 v_lshlrev_b32 v160, 16, v36
 v_and_b32 v161, s78, v36
 v_pk_fma_f32 v[160:161], v[160:161], v[148:149], v[144:145] op_sel_hi:[1,0,0] neg_lo:[0,0,1] neg_hi:[0,0,1]
 v_cvt_pk_bf16_f32 v36, v160, v161
 s_add_u32 m0, s57, 36864
 s_nop 0
 buffer_load_dwordx4 v244, s[40:43], s54 offen  lds
 s_add_u32 s54, s54, s67
 v_lshlrev_b32 v162, 16, v37
 v_and_b32 v163, s78, v37
 v_pk_fma_f32 v[162:163], v[162:163], v[148:149], v[144:145] op_sel_hi:[1,0,0] neg_lo:[0,0,1] neg_hi:[0,0,1]
 v_cvt_pk_bf16_f32 v37, v162, v163
 v_lshlrev_b32 v164, 16, v38
 v_and_b32 v165, s78, v38
 v_pk_fma_f32 v[164:165], v[164:165], v[148:149], v[144:145] op_sel_hi:[1,0,0] neg_lo:[0,0,1] neg_hi:[0,0,1]
 v_cvt_pk_bf16_f32 v38, v164, v165
 v_lshlrev_b32 v166, 16, v39
 v_and_b32 v167, s78, v39
 v_pk_fma_f32 v[166:167], v[166:167], v[148:149], v[144:145] op_sel_hi:[1,0,0] neg_lo:[0,0,1] neg_hi:[0,0,1]
 v_cvt_pk_bf16_f32 v39, v166, v167
 v_lshlrev_b32 v160, 16, v40
 v_and_b32 v161, s78, v40
 v_pk_fma_f32 v[160:161], v[160:161], v[148:149], v[144:145] op_sel_hi:[1,0,0] neg_lo:[0,0,1] neg_hi:[0,0,1]
 v_cvt_pk_bf16_f32 v40, v160, v161
 s_add_u32 m0, s57, 40960
 s_nop 0
 buffer_load_dwordx4 v244, s[40:43], s54 offen  lds
 s_add_u32 s54, s54, s67
 v_lshlrev_b32 v162, 16, v41
 v_and_b32 v163, s78, v41
 v_pk_fma_f32 v[162:163], v[162:163], v[148:149], v[144:145] op_sel_hi:[1,0,0] neg_lo:[0,0,1] neg_hi:[0,0,1]
 v_cvt_pk_bf16_f32 v41, v162, v163
 v_lshlrev_b32 v164, 16, v42
 v_and_b32 v165, s78, v42
 v_pk_fma_f32 v[164:165], v[164:165], v[148:149], v[144:145] op_sel_hi:[1,0,0] neg_lo:[0,0,1] neg_hi:[0,0,1]
 v_cvt_pk_bf16_f32 v42, v164, v165
 v_lshlrev_b32 v166, 16, v43
 v_and_b32 v167, s78, v43
 v_pk_fma_f32 v[166:167], v[166:167], v[148:149], v[144:145] op_sel_hi:[1,0,0] neg_lo:[0,0,1] neg_hi:[0,0,1]
 v_cvt_pk_bf16_f32 v43, v166, v167
 v_lshlrev_b32 v160, 16, v44
 v_and_b32 v161, s78, v44
 v_pk_fma_f32 v[160:161], v[160:161], v[148:149], v[144:145] op_sel_hi:[1,0,0] neg_lo:[0,0,1] neg_hi:[0,0,1]
 v_cvt_pk_bf16_f32 v44, v160, v161
 s_add_u32 m0, s57, 45056
 s_nop 0
 buffer_load_dwordx4 v244, s[40:43], s54 offen  lds
 s_add_u32 s54, s54, s67
 v_lshlrev_b32 v162, 16, v45
 v_and_b32 v163, s78, v45
 v_pk_fma_f32 v[162:163], v[162:163], v[148:149], v[144:145] op_sel_hi:[1,0,0] neg_lo:[0,0,1] neg_hi:[0,0,1]
 v_cvt_pk_bf16_f32 v45, v162, v163
 v_lshlrev_b32 v164, 16, v46
 v_and_b32 v165, s78, v46
 v_pk_fma_f32 v[164:165], v[164:165], v[148:149], v[144:145] op_sel_hi:[1,0,0] neg_lo:[0,0,1] neg_hi:[0,0,1]
 v_cvt_pk_bf16_f32 v46, v164, v165
 v_lshlrev_b32 v166, 16, v47
 v_and_b32 v167, s78, v47
 v_pk_fma_f32 v[166:167], v[166:167], v[148:149], v[144:145] op_sel_hi:[1,0,0] neg_lo:[0,0,1] neg_hi:[0,0,1]
 v_cvt_pk_bf16_f32 v47, v166, v167
 v_lshlrev_b32 v160, 16, v48
 v_and_b32 v161, s78, v48
 v_pk_fma_f32 v[160:161], v[160:161], v[148:149], v[144:145] op_sel_hi:[1,0,0] neg_lo:[0,0,1] neg_hi:[0,0,1]
 v_cvt_pk_bf16_f32 v48, v160, v161
 s_add_u32 m0, s57, 49152
 s_nop 0
 buffer_load_dwordx4 v244, s[40:43], s54 offen  lds
 s_add_u32 s54, s54, s67
 v_lshlrev_b32 v162, 16, v49
 v_and_b32 v163, s78, v49
 v_pk_fma_f32 v[162:163], v[162:163], v[148:149], v[144:145] op_sel_hi:[1,0,0] neg_lo:[0,0,1] neg_hi:[0,0,1]
 v_cvt_pk_bf16_f32 v49, v162, v163
 v_lshlrev_b32 v164, 16, v50
 v_and_b32 v165, s78, v50
 v_pk_fma_f32 v[164:165], v[164:165], v[148:149], v[144:145] op_sel_hi:[1,0,0] neg_lo:[0,0,1] neg_hi:[0,0,1]
 v_cvt_pk_bf16_f32 v50, v164, v165
 v_lshlrev_b32 v166, 16, v51
 v_and_b32 v167, s78, v51
 v_pk_fma_f32 v[166:167], v[166:167], v[148:149], v[144:145] op_sel_hi:[1,0,0] neg_lo:[0,0,1] neg_hi:[0,0,1]
 v_cvt_pk_bf16_f32 v51, v166, v167
 v_lshlrev_b32 v160, 16, v52
 v_and_b32 v161, s78, v52
 v_pk_fma_f32 v[160:161], v[160:161], v[148:149], v[144:145] op_sel_hi:[1,0,0] neg_lo:[0,0,1] neg_hi:[0,0,1]
 v_cvt_pk_bf16_f32 v52, v160, v161
 s_add_u32 m0, s57, 53248
 s_nop 0
 buffer_load_dwordx4 v244, s[40:43], s54 offen  lds
 s_add_u32 s54, s54, s67
 v_lshlrev_b32 v162, 16, v53
 v_and_b32 v163, s78, v53
 v_pk_fma_f32 v[162:163], v[162:163], v[148:149], v[144:145] op_sel_hi:[1,0,0] neg_lo:[0,0,1] neg_hi:[0,0,1]
 v_cvt_pk_bf16_f32 v53, v162, v163
 v_lshlrev_b32 v164, 16, v54
 v_and_b32 v165, s78, v54
 v_pk_fma_f32 v[164:165], v[164:165], v[148:149], v[144:145] op_sel_hi:[1,0,0] neg_lo:[0,0,1] neg_hi:[0,0,1]
 v_cvt_pk_bf16_f32 v54, v164, v165
 v_lshlrev_b32 v166, 16, v55
 v_and_b32 v167, s78, v55
 v_pk_fma_f32 v[166:167], v[166:167], v[148:149], v[144:145] op_sel_hi:[1,0,0] neg_lo:[0,0,1] neg_hi:[0,0,1]
 v_cvt_pk_bf16_f32 v55, v166, v167
 v_lshlrev_b32 v160, 16, v56
 v_and_b32 v161, s78, v56
 v_pk_fma_f32 v[160:161], v[160:161], v[148:149], v[144:145] op_sel_hi:[1,0,0] neg_lo:[0,0,1] neg_hi:[0,0,1]
 v_cvt_pk_bf16_f32 v56, v160, v161
 s_add_u32 m0, s57, 57344
 s_nop 0
 buffer_load_dwordx4 v244, s[40:43], s54 offen  lds
 s_add_u32 s54, s54, s67
 v_lshlrev_b32 v162, 16, v57
 v_and_b32 v163, s78, v57
 v_pk_fma_f32 v[162:163], v[162:163], v[148:149], v[144:145] op_sel_hi:[1,0,0] neg_lo:[0,0,1] neg_hi:[0,0,1]
 v_cvt_pk_bf16_f32 v57, v162, v163
 v_lshlrev_b32 v164, 16, v58
 v_and_b32 v165, s78, v58
 v_pk_fma_f32 v[164:165], v[164:165], v[148:149], v[144:145] op_sel_hi:[1,0,0] neg_lo:[0,0,1] neg_hi:[0,0,1]
 v_cvt_pk_bf16_f32 v58, v164, v165
 v_lshlrev_b32 v166, 16, v59
 v_and_b32 v167, s78, v59
 v_pk_fma_f32 v[166:167], v[166:167], v[148:149], v[144:145] op_sel_hi:[1,0,0] neg_lo:[0,0,1] neg_hi:[0,0,1]
 v_cvt_pk_bf16_f32 v59, v166, v167
 v_lshlrev_b32 v160, 16, v60
 v_and_b32 v161, s78, v60
 v_pk_fma_f32 v[160:161], v[160:161], v[148:149], v[144:145] op_sel_hi:[1,0,0] neg_lo:[0,0,1] neg_hi:[0,0,1]
 v_cvt_pk_bf16_f32 v60, v160, v161
 s_add_u32 m0, s57, 61440
 s_nop 0
 buffer_load_dwordx4 v244, s[40:43], s54 offen  lds
 s_add_u32 s54, s54, s67
 v_lshlrev_b32 v162, 16, v61
 v_and_b32 v163, s78, v61
 v_pk_fma_f32 v[162:163], v[162:163], v[148:149], v[144:145] op_sel_hi:[1,0,0] neg_lo:[0,0,1] neg_hi:[0,0,1]
 v_cvt_pk_bf16_f32 v61, v162, v163
 v_lshlrev_b32 v164, 16, v62
 v_and_b32 v165, s78, v62
 v_pk_fma_f32 v[164:165], v[164:165], v[148:149], v[144:145] op_sel_hi:[1,0,0] neg_lo:[0,0,1] neg_hi:[0,0,1]
 v_cvt_pk_bf16_f32 v62, v164, v165
 v_lshlrev_b32 v166, 16, v63
 v_and_b32 v167, s78, v63
 v_pk_fma_f32 v[166:167], v[166:167], v[148:149], v[144:145] op_sel_hi:[1,0,0] neg_lo:[0,0,1] neg_hi:[0,0,1]
 v_cvt_pk_bf16_f32 v63, v166, v167
 v_lshlrev_b32 v160, 16, v64
 v_and_b32 v161, s78, v64
 v_pk_fma_f32 v[160:161], v[160:161], v[148:149], v[144:145] op_sel_hi:[1,0,0] neg_lo:[0,0,1] neg_hi:[0,0,1]
 v_cvt_pk_bf16_f32 v64, v160, v161
 s_add_u32 m0, s57, 65536
 s_nop 0
 buffer_load_dwordx4 v244, s[40:43], s54 offen  lds
 s_add_u32 s54, s54, s67
 v_lshlrev_b32 v162, 16, v65
 v_and_b32 v163, s78, v65
 v_pk_fma_f32 v[162:163], v[162:163], v[148:149], v[144:145] op_sel_hi:[1,0,0] neg_lo:[0,0,1] neg_hi:[0,0,1]
 v_cvt_pk_bf16_f32 v65, v162, v163
 v_lshlrev_b32 v164, 16, v66
 v_and_b32 v165, s78, v66
 v_pk_fma_f32 v[164:165], v[164:165], v[148:149], v[144:145] op_sel_hi:[1,0,0] neg_lo:[0,0,1] neg_hi:[0,0,1]
 v_cvt_pk_bf16_f32 v66, v164, v165
 v_lshlrev_b32 v166, 16, v67
 v_and_b32 v167, s78, v67
 v_pk_fma_f32 v[166:167], v[166:167], v[148:149], v[144:145] op_sel_hi:[1,0,0] neg_lo:[0,0,1] neg_hi:[0,0,1]
 v_cvt_pk_bf16_f32 v67, v166, v167
 v_lshlrev_b32 v160, 16, v68
 v_and_b32 v161, s78, v68
 v_pk_fma_f32 v[160:161], v[160:161], v[148:149], v[144:145] op_sel_hi:[1,0,0] neg_lo:[0,0,1] neg_hi:[0,0,1]
 v_cvt_pk_bf16_f32 v68, v160, v161
 s_add_u32 m0, s57, 69632
 s_nop 0
 buffer_load_dwordx4 v244, s[40:43], s54 offen  lds
 s_add_u32 s54, s54, s67
 v_lshlrev_b32 v162, 16, v69
 v_and_b32 v163, s78, v69
 v_pk_fma_f32 v[162:163], v[162:163], v[148:149], v[144:145] op_sel_hi:[1,0,0] neg_lo:[0,0,1] neg_hi:[0,0,1]
 v_cvt_pk_bf16_f32 v69, v162, v163
 v_lshlrev_b32 v164, 16, v70
 v_and_b32 v165, s78, v70
 v_pk_fma_f32 v[164:165], v[164:165], v[148:149], v[144:145] op_sel_hi:[1,0,0] neg_lo:[0,0,1] neg_hi:[0,0,1]
 v_cvt_pk_bf16_f32 v70, v164, v165
 v_lshlrev_b32 v166, 16, v71
 v_and_b32 v167, s78, v71
 v_pk_fma_f32 v[166:167], v[166:167], v[148:149], v[144:145] op_sel_hi:[1,0,0] neg_lo:[0,0,1] neg_hi:[0,0,1]
 v_cvt_pk_bf16_f32 v71, v166, v167
 v_lshlrev_b32 v160, 16, v72
 v_and_b32 v161, s78, v72
 v_pk_fma_f32 v[160:161], v[160:161], v[148:149], v[144:145] op_sel_hi:[1,0,0] neg_lo:[0,0,1] neg_hi:[0,0,1]
 v_cvt_pk_bf16_f32 v72, v160, v161
 v_lshlrev_b32 v162, 16, v73
 v_and_b32 v163, s78, v73
 v_pk_fma_f32 v[162:163], v[162:163], v[148:149], v[144:145] op_sel_hi:[1,0,0] neg_lo:[0,0,1] neg_hi:[0,0,1]
 v_cvt_pk_bf16_f32 v73, v162, v163
 v_lshlrev_b32 v164, 16, v74
 v_and_b32 v165, s78, v74
 v_pk_fma_f32 v[164:165], v[164:165], v[148:149], v[144:145] op_sel_hi:[1,0,0] neg_lo:[0,0,1] neg_hi:[0,0,1]
 v_cvt_pk_bf16_f32 v74, v164, v165
 v_lshlrev_b32 v166, 16, v75
 v_and_b32 v167, s78, v75
 v_pk_fma_f32 v[166:167], v[166:167], v[148:149], v[144:145] op_sel_hi:[1,0,0] neg_lo:[0,0,1] neg_hi:[0,0,1]
 v_cvt_pk_bf16_f32 v75, v166, v167
 v_lshlrev_b32 v160, 16, v76
 v_and_b32 v161, s78, v76
 v_pk_fma_f32 v[160:161], v[160:161], v[148:149], v[144:145] op_sel_hi:[1,0,0] neg_lo:[0,0,1] neg_hi:[0,0,1]
 v_cvt_pk_bf16_f32 v76, v160, v161
 v_lshlrev_b32 v162, 16, v77
 v_and_b32 v163, s78, v77
 v_pk_fma_f32 v[162:163], v[162:163], v[148:149], v[144:145] op_sel_hi:[1,0,0] neg_lo:[0,0,1] neg_hi:[0,0,1]
 v_cvt_pk_bf16_f32 v77, v162, v163
 v_lshlrev_b32 v164, 16, v78
 v_and_b32 v165, s78, v78
 v_pk_fma_f32 v[164:165], v[164:165], v[148:149], v[144:145] op_sel_hi:[1,0,0] neg_lo:[0,0,1] neg_hi:[0,0,1]
 v_cvt_pk_bf16_f32 v78, v164, v165
 v_lshlrev_b32 v166, 16, v79
 v_and_b32 v167, s78, v79
 v_pk_fma_f32 v[166:167], v[166:167], v[148:149], v[144:145] op_sel_hi:[1,0,0] neg_lo:[0,0,1] neg_hi:[0,0,1]
 v_cvt_pk_bf16_f32 v79, v166, v167
 v_lshlrev_b32 v160, 16, v80
 v_and_b32 v161, s78, v80
 v_pk_fma_f32 v[160:161], v[160:161], v[148:149], v[144:145] op_sel_hi:[1,0,0] neg_lo:[0,0,1] neg_hi:[0,0,1]
 v_cvt_pk_bf16_f32 v80, v160, v161
 v_lshlrev_b32 v162, 16, v81
 v_and_b32 v163, s78, v81
 v_pk_fma_f32 v[162:163], v[162:163], v[148:149], v[144:145] op_sel_hi:[1,0,0] neg_lo:[0,0,1] neg_hi:[0,0,1]
 v_cvt_pk_bf16_f32 v81, v162, v163
 v_lshlrev_b32 v164, 16, v82
 v_and_b32 v165, s78, v82
 v_pk_fma_f32 v[164:165], v[164:165], v[148:149], v[144:145] op_sel_hi:[1,0,0] neg_lo:[0,0,1] neg_hi:[0,0,1]
 v_cvt_pk_bf16_f32 v82, v164, v165
 v_lshlrev_b32 v166, 16, v83
 v_and_b32 v167, s78, v83
 v_pk_fma_f32 v[166:167], v[166:167], v[148:149], v[144:145] op_sel_hi:[1,0,0] neg_lo:[0,0,1] neg_hi:[0,0,1]
 v_cvt_pk_bf16_f32 v83, v166, v167
 v_lshlrev_b32 v160, 16, v84
 v_and_b32 v161, s78, v84
 v_pk_fma_f32 v[160:161], v[160:161], v[148:149], v[144:145] op_sel_hi:[1,0,0] neg_lo:[0,0,1] neg_hi:[0,0,1]
 v_cvt_pk_bf16_f32 v84, v160, v161
 v_lshlrev_b32 v162, 16, v85
 v_and_b32 v163, s78, v85
 v_pk_fma_f32 v[162:163], v[162:163], v[148:149], v[144:145] op_sel_hi:[1,0,0] neg_lo:[0,0,1] neg_hi:[0,0,1]
 v_cvt_pk_bf16_f32 v85, v162, v163
 v_lshlrev_b32 v164, 16, v86
 v_and_b32 v165, s78, v86
 v_pk_fma_f32 v[164:165], v[164:165], v[148:149], v[144:145] op_sel_hi:[1,0,0] neg_lo:[0,0,1] neg_hi:[0,0,1]
 v_cvt_pk_bf16_f32 v86, v164, v165
 v_lshlrev_b32 v166, 16, v87
 v_and_b32 v167, s78, v87
 v_pk_fma_f32 v[166:167], v[166:167], v[148:149], v[144:145] op_sel_hi:[1,0,0] neg_lo:[0,0,1] neg_hi:[0,0,1]
 v_cvt_pk_bf16_f32 v87, v166, v167
 v_lshlrev_b32 v160, 16, v88
 v_and_b32 v161, s78, v88
 v_pk_fma_f32 v[160:161], v[160:161], v[148:149], v[144:145] op_sel_hi:[1,0,0] neg_lo:[0,0,1] neg_hi:[0,0,1]
 v_cvt_pk_bf16_f32 v88, v160, v161
 v_lshlrev_b32 v162, 16, v89
 v_and_b32 v163, s78, v89
 v_pk_fma_f32 v[162:163], v[162:163], v[148:149], v[144:145] op_sel_hi:[1,0,0] neg_lo:[0,0,1] neg_hi:[0,0,1]
 v_cvt_pk_bf16_f32 v89, v162, v163
 v_lshlrev_b32 v164, 16, v90
 v_and_b32 v165, s78, v90
 v_pk_fma_f32 v[164:165], v[164:165], v[148:149], v[144:145] op_sel_hi:[1,0,0] neg_lo:[0,0,1] neg_hi:[0,0,1]
 v_cvt_pk_bf16_f32 v90, v164, v165
 v_lshlrev_b32 v166, 16, v91
 v_and_b32 v167, s78, v91
 v_pk_fma_f32 v[166:167], v[166:167], v[148:149], v[144:145] op_sel_hi:[1,0,0] neg_lo:[0,0,1] neg_hi:[0,0,1]
 v_cvt_pk_bf16_f32 v91, v166, v167
 v_lshlrev_b32 v160, 16, v92
 v_and_b32 v161, s78, v92
 v_pk_fma_f32 v[160:161], v[160:161], v[148:149], v[144:145] op_sel_hi:[1,0,0] neg_lo:[0,0,1] neg_hi:[0,0,1]
 v_cvt_pk_bf16_f32 v92, v160, v161
 v_lshlrev_b32 v162, 16, v93
 v_and_b32 v163, s78, v93
 v_pk_fma_f32 v[162:163], v[162:163], v[148:149], v[144:145] op_sel_hi:[1,0,0] neg_lo:[0,0,1] neg_hi:[0,0,1]
 v_cvt_pk_bf16_f32 v93, v162, v163
 v_lshlrev_b32 v164, 16, v94
 v_and_b32 v165, s78, v94
 v_pk_fma_f32 v[164:165], v[164:165], v[148:149], v[144:145] op_sel_hi:[1,0,0] neg_lo:[0,0,1] neg_hi:[0,0,1]
 v_cvt_pk_bf16_f32 v94, v164, v165
 v_lshlrev_b32 v166, 16, v95
 v_and_b32 v167, s78, v95
 v_pk_fma_f32 v[166:167], v[166:167], v[148:149], v[144:145] op_sel_hi:[1,0,0] neg_lo:[0,0,1] neg_hi:[0,0,1]
 v_cvt_pk_bf16_f32 v95, v166, v167
 v_lshlrev_b32 v160, 16, v96
 v_and_b32 v161, s78, v96
 v_pk_fma_f32 v[160:161], v[160:161], v[148:149], v[144:145] op_sel_hi:[1,0,0] neg_lo:[0,0,1] neg_hi:[0,0,1]
 v_cvt_pk_bf16_f32 v96, v160, v161
 v_lshlrev_b32 v162, 16, v97
 v_and_b32 v163, s78, v97
 v_pk_fma_f32 v[162:163], v[162:163], v[148:149], v[144:145] op_sel_hi:[1,0,0] neg_lo:[0,0,1] neg_hi:[0,0,1]
 v_cvt_pk_bf16_f32 v97, v162, v163
 v_lshlrev_b32 v164, 16, v98
 v_and_b32 v165, s78, v98
 v_pk_fma_f32 v[164:165], v[164:165], v[148:149], v[144:145] op_sel_hi:[1,0,0] neg_lo:[0,0,1] neg_hi:[0,0,1]
 v_cvt_pk_bf16_f32 v98, v164, v165
 v_lshlrev_b32 v166, 16, v99
 v_and_b32 v167, s78, v99
 v_pk_fma_f32 v[166:167], v[166:167], v[148:149], v[144:145] op_sel_hi:[1,0,0] neg_lo:[0,0,1] neg_hi:[0,0,1]
 v_cvt_pk_bf16_f32 v99, v166, v167
 v_lshlrev_b32 v160, 16, v100
 v_and_b32 v161, s78, v100
 v_pk_fma_f32 v[160:161], v[160:161], v[148:149], v[144:145] op_sel_hi:[1,0,0] neg_lo:[0,0,1] neg_hi:[0,0,1]
 v_cvt_pk_bf16_f32 v100, v160, v161
 v_lshlrev_b32 v162, 16, v101
 v_and_b32 v163, s78, v101
 v_pk_fma_f32 v[162:163], v[162:163], v[148:149], v[144:145] op_sel_hi:[1,0,0] neg_lo:[0,0,1] neg_hi:[0,0,1]
 v_cvt_pk_bf16_f32 v101, v162, v163
 v_lshlrev_b32 v164, 16, v102
 v_and_b32 v165, s78, v102
 v_pk_fma_f32 v[164:165], v[164:165], v[148:149], v[144:145] op_sel_hi:[1,0,0] neg_lo:[0,0,1] neg_hi:[0,0,1]
 v_cvt_pk_bf16_f32 v102, v164, v165
 v_lshlrev_b32 v166, 16, v103
 v_and_b32 v167, s78, v103
 v_pk_fma_f32 v[166:167], v[166:167], v[148:149], v[144:145] op_sel_hi:[1,0,0] neg_lo:[0,0,1] neg_hi:[0,0,1]
 v_cvt_pk_bf16_f32 v103, v166, v167
 v_lshlrev_b32 v160, 16, v104
 v_and_b32 v161, s78, v104
 v_pk_fma_f32 v[160:161], v[160:161], v[148:149], v[144:145] op_sel_hi:[1,0,0] neg_lo:[0,0,1] neg_hi:[0,0,1]
 v_cvt_pk_bf16_f32 v104, v160, v161
 v_lshlrev_b32 v162, 16, v105
 v_and_b32 v163, s78, v105
 v_pk_fma_f32 v[162:163], v[162:163], v[148:149], v[144:145] op_sel_hi:[1,0,0] neg_lo:[0,0,1] neg_hi:[0,0,1]
 v_cvt_pk_bf16_f32 v105, v162, v163
 v_lshlrev_b32 v164, 16, v106
 v_and_b32 v165, s78, v106
 v_pk_fma_f32 v[164:165], v[164:165], v[148:149], v[144:145] op_sel_hi:[1,0,0] neg_lo:[0,0,1] neg_hi:[0,0,1]
 v_cvt_pk_bf16_f32 v106, v164, v165
 v_lshlrev_b32 v166, 16, v107
 v_and_b32 v167, s78, v107
 v_pk_fma_f32 v[166:167], v[166:167], v[148:149], v[144:145] op_sel_hi:[1,0,0] neg_lo:[0,0,1] neg_hi:[0,0,1]
 v_cvt_pk_bf16_f32 v107, v166, v167
 v_lshlrev_b32 v160, 16, v108
 v_and_b32 v161, s78, v108
 v_pk_fma_f32 v[160:161], v[160:161], v[148:149], v[144:145] op_sel_hi:[1,0,0] neg_lo:[0,0,1] neg_hi:[0,0,1]
 v_cvt_pk_bf16_f32 v108, v160, v161
 v_lshlrev_b32 v162, 16, v109
 v_and_b32 v163, s78, v109
 v_pk_fma_f32 v[162:163], v[162:163], v[148:149], v[144:145] op_sel_hi:[1,0,0] neg_lo:[0,0,1] neg_hi:[0,0,1]
 v_cvt_pk_bf16_f32 v109, v162, v163
 v_lshlrev_b32 v164, 16, v110
 v_and_b32 v165, s78, v110
 v_pk_fma_f32 v[164:165], v[164:165], v[148:149], v[144:145] op_sel_hi:[1,0,0] neg_lo:[0,0,1] neg_hi:[0,0,1]
 v_cvt_pk_bf16_f32 v110, v164, v165
 v_lshlrev_b32 v166, 16, v111
 v_and_b32 v167, s78, v111
 v_pk_fma_f32 v[166:167], v[166:167], v[148:149], v[144:145] op_sel_hi:[1,0,0] neg_lo:[0,0,1] neg_hi:[0,0,1]
 v_cvt_pk_bf16_f32 v111, v166, v167
 v_lshlrev_b32 v160, 16, v112
 v_and_b32 v161, s78, v112
 v_pk_fma_f32 v[160:161], v[160:161], v[148:149], v[144:145] op_sel_hi:[1,0,0] neg_lo:[0,0,1] neg_hi:[0,0,1]
 v_cvt_pk_bf16_f32 v112, v160, v161
 v_lshlrev_b32 v162, 16, v113
 v_and_b32 v163, s78, v113
 v_pk_fma_f32 v[162:163], v[162:163], v[148:149], v[144:145] op_sel_hi:[1,0,0] neg_lo:[0,0,1] neg_hi:[0,0,1]
 v_cvt_pk_bf16_f32 v113, v162, v163
 v_lshlrev_b32 v164, 16, v114
 v_and_b32 v165, s78, v114
 v_pk_fma_f32 v[164:165], v[164:165], v[148:149], v[144:145] op_sel_hi:[1,0,0] neg_lo:[0,0,1] neg_hi:[0,0,1]
 v_cvt_pk_bf16_f32 v114, v164, v165
 v_lshlrev_b32 v166, 16, v115
 v_and_b32 v167, s78, v115
 v_pk_fma_f32 v[166:167], v[166:167], v[148:149], v[144:145] op_sel_hi:[1,0,0] neg_lo:[0,0,1] neg_hi:[0,0,1]
 v_cvt_pk_bf16_f32 v115, v166, v167
 v_lshlrev_b32 v160, 16, v116
 v_and_b32 v161, s78, v116
 v_pk_fma_f32 v[160:161], v[160:161], v[148:149], v[144:145] op_sel_hi:[1,0,0] neg_lo:[0,0,1] neg_hi:[0,0,1]
 v_cvt_pk_bf16_f32 v116, v160, v161
 v_lshlrev_b32 v162, 16, v117
 v_and_b32 v163, s78, v117
 v_pk_fma_f32 v[162:163], v[162:163], v[148:149], v[144:145] op_sel_hi:[1,0,0] neg_lo:[0,0,1] neg_hi:[0,0,1]
 v_cvt_pk_bf16_f32 v117, v162, v163
 v_lshlrev_b32 v164, 16, v118
 v_and_b32 v165, s78, v118
 v_pk_fma_f32 v[164:165], v[164:165], v[148:149], v[144:145] op_sel_hi:[1,0,0] neg_lo:[0,0,1] neg_hi:[0,0,1]
 v_cvt_pk_bf16_f32 v118, v164, v165
 v_lshlrev_b32 v166, 16, v119
 v_and_b32 v167, s78, v119
 v_pk_fma_f32 v[166:167], v[166:167], v[148:149], v[144:145] op_sel_hi:[1,0,0] neg_lo:[0,0,1] neg_hi:[0,0,1]
 v_cvt_pk_bf16_f32 v119, v166, v167
 v_lshlrev_b32 v160, 16, v120
 v_and_b32 v161, s78, v120
 v_pk_fma_f32 v[160:161], v[160:161], v[148:149], v[144:145] op_sel_hi:[1,0,0] neg_lo:[0,0,1] neg_hi:[0,0,1]
 v_cvt_pk_bf16_f32 v120, v160, v161
 v_lshlrev_b32 v162, 16, v121
 v_and_b32 v163, s78, v121
 v_pk_fma_f32 v[162:163], v[162:163], v[148:149], v[144:145] op_sel_hi:[1,0,0] neg_lo:[0,0,1] neg_hi:[0,0,1]
 v_cvt_pk_bf16_f32 v121, v162, v163
 v_lshlrev_b32 v164, 16, v122
 v_and_b32 v165, s78, v122
 v_pk_fma_f32 v[164:165], v[164:165], v[148:149], v[144:145] op_sel_hi:[1,0,0] neg_lo:[0,0,1] neg_hi:[0,0,1]
 v_cvt_pk_bf16_f32 v122, v164, v165
 v_lshlrev_b32 v166, 16, v123
 v_and_b32 v167, s78, v123
 v_pk_fma_f32 v[166:167], v[166:167], v[148:149], v[144:145] op_sel_hi:[1,0,0] neg_lo:[0,0,1] neg_hi:[0,0,1]
 v_cvt_pk_bf16_f32 v123, v166, v167
 v_lshlrev_b32 v160, 16, v124
 v_and_b32 v161, s78, v124
 v_pk_fma_f32 v[160:161], v[160:161], v[148:149], v[144:145] op_sel_hi:[1,0,0] neg_lo:[0,0,1] neg_hi:[0,0,1]
 v_cvt_pk_bf16_f32 v124, v160, v161
 v_lshlrev_b32 v162, 16, v125
 v_and_b32 v163, s78, v125
 v_pk_fma_f32 v[162:163], v[162:163], v[148:149], v[144:145] op_sel_hi:[1,0,0] neg_lo:[0,0,1] neg_hi:[0,0,1]
 v_cvt_pk_bf16_f32 v125, v162, v163
 v_lshlrev_b32 v164, 16, v126
 v_and_b32 v165, s78, v126
 v_pk_fma_f32 v[164:165], v[164:165], v[148:149], v[144:145] op_sel_hi:[1,0,0] neg_lo:[0,0,1] neg_hi:[0,0,1]
 v_cvt_pk_bf16_f32 v126, v164, v165
 v_lshlrev_b32 v166, 16, v127
 v_and_b32 v167, s78, v127
 v_pk_fma_f32 v[166:167], v[166:167], v[148:149], v[144:145] op_sel_hi:[1,0,0] neg_lo:[0,0,1] neg_hi:[0,0,1]
 v_cvt_pk_bf16_f32 v127, v166, v167
 v_lshlrev_b32 v160, 16, v128
 v_and_b32 v161, s78, v128
 v_pk_fma_f32 v[160:161], v[160:161], v[148:149], v[144:145] op_sel_hi:[1,0,0] neg_lo:[0,0,1] neg_hi:[0,0,1]
 v_cvt_pk_bf16_f32 v128, v160, v161
 v_lshlrev_b32 v162, 16, v129
 v_and_b32 v163, s78, v129
 v_pk_fma_f32 v[162:163], v[162:163], v[148:149], v[144:145] op_sel_hi:[1,0,0] neg_lo:[0,0,1] neg_hi:[0,0,1]
 v_cvt_pk_bf16_f32 v129, v162, v163
 v_lshlrev_b32 v164, 16, v130
 v_and_b32 v165, s78, v130
 v_pk_fma_f32 v[164:165], v[164:165], v[148:149], v[144:145] op_sel_hi:[1,0,0] neg_lo:[0,0,1] neg_hi:[0,0,1]
 v_cvt_pk_bf16_f32 v130, v164, v165
 v_lshlrev_b32 v166, 16, v131
 v_and_b32 v167, s78, v131
 v_pk_fma_f32 v[166:167], v[166:167], v[148:149], v[144:145] op_sel_hi:[1,0,0] neg_lo:[0,0,1] neg_hi:[0,0,1]
 v_cvt_pk_bf16_f32 v131, v166, v167
 v_lshlrev_b32 v160, 16, v132
 v_and_b32 v161, s78, v132
 v_pk_fma_f32 v[160:161], v[160:161], v[148:149], v[144:145] op_sel_hi:[1,0,0] neg_lo:[0,0,1] neg_hi:[0,0,1]
 v_cvt_pk_bf16_f32 v132, v160, v161
 v_lshlrev_b32 v162, 16, v133
 v_and_b32 v163, s78, v133
 v_pk_fma_f32 v[162:163], v[162:163], v[148:149], v[144:145] op_sel_hi:[1,0,0] neg_lo:[0,0,1] neg_hi:[0,0,1]
 v_cvt_pk_bf16_f32 v133, v162, v163
 v_lshlrev_b32 v164, 16, v134
 v_and_b32 v165, s78, v134
 v_pk_fma_f32 v[164:165], v[164:165], v[148:149], v[144:145] op_sel_hi:[1,0,0] neg_lo:[0,0,1] neg_hi:[0,0,1]
 v_cvt_pk_bf16_f32 v134, v164, v165
 v_lshlrev_b32 v166, 16, v135
 v_and_b32 v167, s78, v135
 v_pk_fma_f32 v[166:167], v[166:167], v[148:149], v[144:145] op_sel_hi:[1,0,0] neg_lo:[0,0,1] neg_hi:[0,0,1]
 v_cvt_pk_bf16_f32 v135, v166, v167
 v_lshlrev_b32 v160, 16, v136
 v_and_b32 v161, s78, v136
 v_pk_fma_f32 v[160:161], v[160:161], v[148:149], v[144:145] op_sel_hi:[1,0,0] neg_lo:[0,0,1] neg_hi:[0,0,1]
 v_cvt_pk_bf16_f32 v136, v160, v161
 v_lshlrev_b32 v162, 16, v137
 v_and_b32 v163, s78, v137
 v_pk_fma_f32 v[162:163], v[162:163], v[148:149], v[144:145] op_sel_hi:[1,0,0] neg_lo:[0,0,1] neg_hi:[0,0,1]
 v_cvt_pk_bf16_f32 v137, v162, v163
 v_lshlrev_b32 v164, 16, v138
 v_and_b32 v165, s78, v138
 v_pk_fma_f32 v[164:165], v[164:165], v[148:149], v[144:145] op_sel_hi:[1,0,0] neg_lo:[0,0,1] neg_hi:[0,0,1]
 v_cvt_pk_bf16_f32 v138, v164, v165
 v_lshlrev_b32 v166, 16, v139
 v_and_b32 v167, s78, v139
 v_pk_fma_f32 v[166:167], v[166:167], v[148:149], v[144:145] op_sel_hi:[1,0,0] neg_lo:[0,0,1] neg_hi:[0,0,1]
 v_cvt_pk_bf16_f32 v139, v166, v167
 v_lshlrev_b32 v160, 16, v140
 v_and_b32 v161, s78, v140
 v_pk_fma_f32 v[160:161], v[160:161], v[148:149], v[144:145] op_sel_hi:[1,0,0] neg_lo:[0,0,1] neg_hi:[0,0,1]
 v_cvt_pk_bf16_f32 v140, v160, v161
 v_lshlrev_b32 v162, 16, v141
 v_and_b32 v163, s78, v141
 v_pk_fma_f32 v[162:163], v[162:163], v[148:149], v[144:145] op_sel_hi:[1,0,0] neg_lo:[0,0,1] neg_hi:[0,0,1]
 v_cvt_pk_bf16_f32 v141, v162, v163
 v_lshlrev_b32 v164, 16, v142
 v_and_b32 v165, s78, v142
 v_pk_fma_f32 v[164:165], v[164:165], v[148:149], v[144:145] op_sel_hi:[1,0,0] neg_lo:[0,0,1] neg_hi:[0,0,1]
 v_cvt_pk_bf16_f32 v142, v164, v165
 v_lshlrev_b32 v166, 16, v143
 v_and_b32 v167, s78, v143
 v_pk_fma_f32 v[166:167], v[166:167], v[148:149], v[144:145] op_sel_hi:[1,0,0] neg_lo:[0,0,1] neg_hi:[0,0,1]
 v_cvt_pk_bf16_f32 v143, v166, v167
 s_waitcnt vmcnt(0) lgkmcnt(0)
 s_barrier
 s_lshl_b32 s3, s46, 10
 s_sub_u32 s76, s57, s3
 s_sub_u32 s77, 73728, s76
 s_add_u32 s57, s77, s3
 s_sub_u32 s76, s76, s77
 v_add_u32 v240, s76, v240
 v_add_u32 v241, s76, v241
 v_add_u32 v242, s76, v242
 v_add_u32 v243, s76, v243
 s_mov_b32 s55, s74
 s_mov_b32 s65, s66
 s_mov_b32 s52, 1
 s_cmp_ge_u32 s52, s60
 s_cbranch_scc1 L_pq_264
 s_add_u32 s72, s59, s52
 s_cmp_ge_u32 s72, 64
 s_cbranch_scc1 L_pv_265
 s_mov_b32 s40, s12
 s_mov_b32 s41, s13
 s_mov_b32 s42, s14
 s_mov_b32 s43, s15
 s_mov_b32 s73, 0
 s_mov_b32 s66, 0
 s_branch L_pe_266
L_pv_265:
 s_sub_u32 s72, s72, 64
 s_mov_b32 s40, s16
 s_mov_b32 s41, s17
 s_mov_b32 s42, s18
 s_mov_b32 s43, s19
 s_mov_b32 s73, 16777216
 s_mov_b32 s66, 1
 s_branch L_pe_266
L_pq_264:
 s_sub_u32 s72, s52, s60
 s_add_u32 s72, s72, s61
 s_mov_b32 s40, s8
 s_mov_b32 s41, s9
 s_mov_b32 s42, s10
 s_mov_b32 s43, s11
 s_mov_b32 s73, 33554432
 s_mov_b32 s66, 0
L_pe_266:
 s_lshl_b32 s54, s72, 7
 s_lshl_b32 s3, s46, 16
 s_add_u32 s54, s54, s3
 s_lshl_b32 s74, s72, 12
 s_lshl_b32 s3, s58, 18
 s_add_u32 s74, s74, s3
 s_add_u32 s74, s74, s73
 s_mov_b32 s67, 262144
 s_cmp_eq_u32 s65, 1
 s_cbranch_scc1 L_projv_267
 ds_read_b64_tr_b16 v[176:177], v240 offset:0
 ds_read_b64_tr_b16 v[178:179], v240 offset:512
 ds_read_b64_tr_b16 v[180:181], v240 offset:2048
 ds_read_b64_tr_b16 v[182:183], v240 offset:2560
 ds_read_b64_tr_b16 v[184:185], v240 offset:4096
 ds_read_b64_tr_b16 v[186:187], v240 offset:4608
 s_waitcnt lgkmcnt(4)
 v_mfma_f32_32x32x16_bf16 v[144:159], v[176:179], v[0:3], 0
 ds_read_b64_tr_b16 v[188:189], v240 offset:6144
 ds_read_b64_tr_b16 v[190:191], v240 offset:6656
 s_add_u32 m0, s57, 0
 s_nop 0
 buffer_load_dwordx4 v244, s[40:43], s54 offen  lds
 s_add_u32 s54, s54, s67
 s_waitcnt lgkmcnt(4)
 v_mfma_f32_32x32x16_bf16 v[144:159], v[180:183], v[4:7], v[144:159]
 ds_read_b64_tr_b16 v[176:177], v240 offset:8192
 ds_read_b64_tr_b16 v[178:179], v240 offset:8704
 s_add_u32 m0, s57, 4096
 s_nop 0
 buffer_load_dwordx4 v244, s[40:43], s54 offen  lds
 s_add_u32 s54, s54, s67
 s_waitcnt lgkmcnt(4)
 v_mfma_f32_32x32x16_bf16 v[144:159], v[184:187], v[8:11], v[144:159]
 ds_read_b64_tr_b16 v[180:181], v240 offset:10240
 ds_read_b64_tr_b16 v[182:183], v240 offset:10752
 s_add_u32 m0, s57, 8192
 s_nop 0
 buffer_load_dwordx4 v244, s[40:43], s54 offen  lds
 s_add_u32 s54, s54, s67
 s_waitcnt lgkmcnt(4)
 v_mfma_f32_32x32x16_bf16 v[144:159], v[188:191], v[12:15], v[144:159]
 ds_read_b64_tr_b16 v[184:185], v240 offset:12288
 ds_read_b64_tr_b16 v[186:187], v240 offset:12800
 s_add_u32 m0, s57, 12288
 s_nop 0
 buffer_load_dwordx4 v244, s[40:43], s54 offen  lds
 s_add_u32 s54, s54, s67
 s_waitcnt lgkmcnt(4)
 v_mfma_f32_32x32x16_bf16 v[144:159], v[176:179], v[16:19], v[144:159]
 ds_read_b64_tr_b16 v[188:189], v240 offset:14336
 ds_read_b64_tr_b16 v[190:191], v240 offset:14848
 s_add_u32 m0, s57, 16384
 s_nop 0
 buffer_load_dwordx4 v244, s[40:43], s54 offen  lds
 s_add_u32 s54, s54, s67
 s_waitcnt lgkmcnt(4)
 v_mfma_f32_32x32x16_bf16 v[144:159], v[180:183], v[20:23], v[144:159]
 ds_read_b64_tr_b16 v[176:177], v240 offset:16384
 ds_read_b64_tr_b16 v[178:179], v240 offset:16896
 s_add_u32 m0, s57, 20480
 s_nop 0
 buffer_load_dwordx4 v244, s[40:43], s54 offen  lds
 s_add_u32 s54, s54, s67
 s_waitcnt lgkmcnt(4)
 v_mfma_f32_32x32x16_bf16 v[144:159], v[184:187], v[24:27], v[144:159]
 ds_read_b64_tr_b16 v[180:181], v240 offset:18432
 ds_read_b64_tr_b16 v[182:183], v240 offset:18944
 s_add_u32 m0, s57, 24576
 s_nop 0
 buffer_load_dwordx4 v244, s[40:43], s54 offen  lds
 s_add_u32 s54, s54, s67
 s_waitcnt lgkmcnt(4)
 v_mfma_f32_32x32x16_bf16 v[144:159], v[188:191], v[28:31], v[144:159]
 ds_read_b64_tr_b16 v[184:185], v240 offset:20480
 ds_read_b64_tr_b16 v[186:187], v240 offset:20992
 s_add_u32 m0, s57, 28672
 s_nop 0
 buffer_load_dwordx4 v244, s[40:43], s54 offen  lds
 s_add_u32 s54, s54, s67
 s_waitcnt lgkmcnt(4)
 v_mfma_f32_32x32x16_bf16 v[144:159], v[176:179], v[32:35], v[144:159]
 ds_read_b64_tr_b16 v[188:189], v240 offset:22528
 ds_read_b64_tr_b16 v[190:191], v240 offset:23040
 s_add_u32 m0, s57, 32768
 s_nop 0
 buffer_load_dwordx4 v244, s[40:43], s54 offen  lds
 s_add_u32 s54, s54, s67
 s_waitcnt lgkmcnt(4)
 v_mfma_f32_32x32x16_bf16 v[144:159], v[180:183], v[36:39], v[144:159]
 ds_read_b64_tr_b16 v[176:177], v240 offset:24576
 ds_read_b64_tr_b16 v[178:179], v240 offset:25088
 s_add_u32 m0, s57, 36864
 s_nop 0
 buffer_load_dwordx4 v244, s[40:43], s54 offen  lds
 s_add_u32 s54, s54, s67
 s_waitcnt lgkmcnt(4)
 v_mfma_f32_32x32x16_bf16 v[144:159], v[184:187], v[40:43], v[144:159]
 ds_read_b64_tr_b16 v[180:181], v240 offset:26624
 ds_read_b64_tr_b16 v[182:183], v240 offset:27136
 s_add_u32 m0, s57, 40960
 s_nop 0
 buffer_load_dwordx4 v244, s[40:43], s54 offen  lds
 s_add_u32 s54, s54, s67
 s_waitcnt lgkmcnt(4)
 v_mfma_f32_32x32x16_bf16 v[144:159], v[188:191], v[44:47], v[144:159]
 ds_read_b64_tr_b16 v[184:185], v240 offset:28672
 ds_read_b64_tr_b16 v[186:187], v240 offset:29184
 s_add_u32 m0, s57, 45056
 s_nop 0
 buffer_load_dwordx4 v244, s[40:43], s54 offen  lds
 s_add_u32 s54, s54, s67
 s_waitcnt lgkmcnt(4)
 v_mfma_f32_32x32x16_bf16 v[144:159], v[176:179], v[48:51], v[144:159]
 ds_read_b64_tr_b16 v[188:189], v240 offset:30720
 ds_read_b64_tr_b16 v[190:191], v240 offset:31232
 s_add_u32 m0, s57, 49152
 s_nop 0
 buffer_load_dwordx4 v244, s[40:43], s54 offen  lds
 s_add_u32 s54, s54, s67
 s_waitcnt lgkmcnt(4)
 v_mfma_f32_32x32x16_bf16 v[144:159], v[180:183], v[52:55], v[144:159]
 ds_read_b64_tr_b16 v[176:177], v240 offset:32768
 ds_read_b64_tr_b16 v[178:179], v240 offset:33280
 s_add_u32 m0, s57, 53248
 s_nop 0
 buffer_load_dwordx4 v244, s[40:43], s54 offen  lds
 s_add_u32 s54, s54, s67
 s_waitcnt lgkmcnt(4)
 v_mfma_f32_32x32x16_bf16 v[144:159], v[184:187], v[56:59], v[144:159]
 ds_read_b64_tr_b16 v[180:181], v240 offset:34816
 ds_read_b64_tr_b16 v[182:183], v240 offset:35328
 s_add_u32 m0, s57, 57344
 s_nop 0
 buffer_load_dwordx4 v244, s[40:43], s54 offen  lds
 s_add_u32 s54, s54, s67
 s_waitcnt lgkmcnt(4)
 v_mfma_f32_32x32x16_bf16 v[144:159], v[188:191], v[60:63], v[144:159]
 ds_read_b64_tr_b16 v[184:185], v241 offset:0
 ds_read_b64_tr_b16 v[186:187], v241 offset:512
 s_add_u32 m0, s57, 61440
 s_nop 0
 buffer_load_dwordx4 v244, s[40:43], s54 offen  lds
 s_add_u32 s54, s54, s67
 s_waitcnt lgkmcnt(4)
 v_mfma_f32_32x32x16_bf16 v[144:159], v[176:179], v[64:67], v[144:159]
 ds_read_b64_tr_b16 v[188:189], v241 offset:2048
 ds_read_b64_tr_b16 v[190:191], v241 offset:2560
 s_add_u32 m0, s57, 65536
 s_nop 0
 buffer_load_dwordx4 v244, s[40:43], s54 offen  lds
 s_add_u32 s54, s54, s67
 s_waitcnt lgkmcnt(4)
 v_mfma_f32_32x32x16_bf16 v[144:159], v[180:183], v[68:71], v[144:159]
 ds_read_b64_tr_b16 v[176:177], v241 offset:4096
 ds_read_b64_tr_b16 v[178:179], v241 offset:4608
 s_add_u32 m0, s57, 69632
 s_nop 0
 buffer_load_dwordx4 v244, s[40:43], s54 offen  lds
 s_add_u32 s54, s54, s67
 s_waitcnt lgkmcnt(4)
 v_mfma_f32_32x32x16_bf16 v[144:159], v[184:187], v[72:75], v[144:159]
 ds_read_b64_tr_b16 v[180:181], v241 offset:6144
 ds_read_b64_tr_b16 v[182:183], v241 offset:6656
 s_waitcnt lgkmcnt(4)
 v_mfma_f32_32x32x16_bf16 v[144:159], v[188:191], v[76:79], v[144:159]
 ds_read_b64_tr_b16 v[184:185], v241 offset:8192
 ds_read_b64_tr_b16 v[186:187], v241 offset:8704
 s_waitcnt lgkmcnt(4)
 v_mfma_f32_32x32x16_bf16 v[144:159], v[176:179], v[80:83], v[144:159]
 ds_read_b64_tr_b16 v[188:189], v241 offset:10240
 ds_read_b64_tr_b16 v[190:191], v241 offset:10752
 s_waitcnt lgkmcnt(4)
 v_mfma_f32_32x32x16_bf16 v[144:159], v[180:183], v[84:87], v[144:159]
 ds_read_b64_tr_b16 v[176:177], v241 offset:12288
 ds_read_b64_tr_b16 v[178:179], v241 offset:12800
 s_waitcnt lgkmcnt(4)
 v_mfma_f32_32x32x16_bf16 v[144:159], v[184:187], v[88:91], v[144:159]
 ds_read_b64_tr_b16 v[180:181], v241 offset:14336
 ds_read_b64_tr_b16 v[182:183], v241 offset:14848
 s_waitcnt lgkmcnt(4)
 v_mfma_f32_32x32x16_bf16 v[144:159], v[188:191], v[92:95], v[144:159]
 ds_read_b64_tr_b16 v[184:185], v241 offset:16384
 ds_read_b64_tr_b16 v[186:187], v241 offset:16896
 s_waitcnt lgkmcnt(4)
 v_mfma_f32_32x32x16_bf16 v[144:159], v[176:179], v[96:99], v[144:159]
 ds_read_b64_tr_b16 v[188:189], v241 offset:18432
 ds_read_b64_tr_b16 v[190:191], v241 offset:18944
 s_waitcnt lgkmcnt(4)
 v_mfma_f32_32x32x16_bf16 v[144:159], v[180:183], v[100:103], v[144:159]
 ds_read_b64_tr_b16 v[176:177], v241 offset:20480
 ds_read_b64_tr_b16 v[178:179], v241 offset:20992
 s_waitcnt lgkmcnt(4)
 v_mfma_f32_32x32x16_bf16 v[144:159], v[184:187], v[104:107], v[144:159]
 ds_read_b64_tr_b16 v[180:181], v241 offset:22528
 ds_read_b64_tr_b16 v[182:183], v241 offset:23040
 s_waitcnt lgkmcnt(4)
 v_mfma_f32_32x32x16_bf16 v[144:159], v[188:191], v[108:111], v[144:159]
 ds_read_b64_tr_b16 v[184:185], v241 offset:24576
 ds_read_b64_tr_b16 v[186:187], v241 offset:25088
 s_waitcnt lgkmcnt(4)
 v_mfma_f32_32x32x16_bf16 v[144:159], v[176:179], v[112:115], v[144:159]
 ds_read_b64_tr_b16 v[188:189], v241 offset:26624
 ds_read_b64_tr_b16 v[190:191], v241 offset:27136
 s_waitcnt lgkmcnt(4)
 v_mfma_f32_32x32x16_bf16 v[144:159], v[180:183], v[116:119], v[144:159]
 ds_read_b64_tr_b16 v[176:177], v241 offset:28672
 ds_read_b64_tr_b16 v[178:179], v241 offset:29184
 s_waitcnt lgkmcnt(4)
 v_mfma_f32_32x32x16_bf16 v[144:159], v[184:187], v[120:123], v[144:159]
 ds_read_b64_tr_b16 v[180:181], v241 offset:30720
 ds_read_b64_tr_b16 v[182:183], v241 offset:31232
 s_waitcnt lgkmcnt(4)
 v_mfma_f32_32x32x16_bf16 v[144:159], v[188:191], v[124:127], v[144:159]
 ds_read_b64_tr_b16 v[184:185], v241 offset:32768
 ds_read_b64_tr_b16 v[186:187], v241 offset:33280
 s_waitcnt lgkmcnt(4)
 v_mfma_f32_32x32x16_bf16 v[144:159], v[176:179], v[128:131], v[144:159]
 ds_read_b64_tr_b16 v[188:189], v241 offset:34816
 ds_read_b64_tr_b16 v[190:191], v241 offset:35328
 s_waitcnt lgkmcnt(4)
 v_mfma_f32_32x32x16_bf16 v[144:159], v[180:183], v[132:135], v[144:159]
 ds_read_b64_tr_b16 v[176:177], v242 offset:0
 ds_read_b64_tr_b16 v[178:179], v242 offset:512
 s_waitcnt lgkmcnt(4)
 v_mfma_f32_32x32x16_bf16 v[144:159], v[184:187], v[136:139], v[144:159]
 ds_read_b64_tr_b16 v[180:181], v242 offset:2048
 ds_read_b64_tr_b16 v[182:183], v242 offset:2560
 s_waitcnt lgkmcnt(4)
 v_mfma_f32_32x32x16_bf16 v[144:159], v[188:191], v[140:143], v[144:159]
 ds_read_b64_tr_b16 v[184:185], v242 offset:4096
 ds_read_b64_tr_b16 v[186:187], v242 offset:4608
 s_waitcnt lgkmcnt(4)
 v_mfma_f32_32x32x16_bf16 v[160:175], v[176:179], v[0:3], 0
 ds_read_b64_tr_b16 v[188:189], v242 offset:6144
 ds_read_b64_tr_b16 v[190:191], v242 offset:6656
 s_waitcnt lgkmcnt(4)
 v_mfma_f32_32x32x16_bf16 v[160:175], v[180:183], v[4:7], v[160:175]
 ds_read_b64_tr_b16 v[176:177], v242 offset:8192
 ds_read_b64_tr_b16 v[178:179], v242 offset:8704
 s_waitcnt lgkmcnt(4)
 v_mfma_f32_32x32x16_bf16 v[160:175], v[184:187], v[8:11], v[160:175]
 ds_read_b64_tr_b16 v[180:181], v242 offset:10240
 ds_read_b64_tr_b16 v[182:183], v242 offset:10752
 s_waitcnt lgkmcnt(4)
 v_mfma_f32_32x32x16_bf16 v[160:175], v[188:191], v[12:15], v[160:175]
 ds_read_b64_tr_b16 v[184:185], v242 offset:12288
 ds_read_b64_tr_b16 v[186:187], v242 offset:12800
 s_waitcnt lgkmcnt(4)
 v_mfma_f32_32x32x16_bf16 v[160:175], v[176:179], v[16:19], v[160:175]
 ds_read_b64_tr_b16 v[188:189], v242 offset:14336
 ds_read_b64_tr_b16 v[190:191], v242 offset:14848
 v_cvt_pk_bf16_f32 v200, v144, v145
 v_cvt_pk_bf16_f32 v201, v146, v147
 s_waitcnt lgkmcnt(4)
 v_mfma_f32_32x32x16_bf16 v[160:175], v[180:183], v[20:23], v[160:175]
 ds_read_b64_tr_b16 v[176:177], v242 offset:16384
 ds_read_b64_tr_b16 v[178:179], v242 offset:16896
 v_cvt_pk_bf16_f32 v202, v148, v149
 v_cvt_pk_bf16_f32 v203, v150, v151
 s_waitcnt lgkmcnt(4)
 v_mfma_f32_32x32x16_bf16 v[160:175], v[184:187], v[24:27], v[160:175]
 ds_read_b64_tr_b16 v[180:181], v242 offset:18432
 ds_read_b64_tr_b16 v[182:183], v242 offset:18944
 buffer_store_dwordx4 v[200:203], v246, s[4:7], s55 offen offset:0 sc1
 v_cvt_pk_bf16_f32 v204, v152, v153
 s_waitcnt lgkmcnt(4)
 v_mfma_f32_32x32x16_bf16 v[160:175], v[188:191], v[28:31], v[160:175]
 ds_read_b64_tr_b16 v[184:185], v242 offset:20480
 ds_read_b64_tr_b16 v[186:187], v242 offset:20992
 v_cvt_pk_bf16_f32 v205, v154, v155
 v_cvt_pk_bf16_f32 v206, v156, v157
 s_waitcnt lgkmcnt(4)
 v_mfma_f32_32x32x16_bf16 v[160:175], v[176:179], v[32:35], v[160:175]
 ds_read_b64_tr_b16 v[188:189], v242 offset:22528
 ds_read_b64_tr_b16 v[190:191], v242 offset:23040
 v_cvt_pk_bf16_f32 v207, v158, v159
 buffer_store_dwordx4 v[204:207], v246, s[4:7], s55 offen offset:1024 sc1
 s_waitcnt lgkmcnt(4)
 v_mfma_f32_32x32x16_bf16 v[160:175], v[180:183], v[36:39], v[160:175]
 ds_read_b64_tr_b16 v[176:177], v242 offset:24576
 ds_read_b64_tr_b16 v[178:179], v242 offset:25088
 s_waitcnt lgkmcnt(4)
 v_mfma_f32_32x32x16_bf16 v[160:175], v[184:187], v[40:43], v[160:175]
 ds_read_b64_tr_b16 v[180:181], v242 offset:26624
 ds_read_b64_tr_b16 v[182:183], v242 offset:27136
 s_waitcnt lgkmcnt(4)
 v_mfma_f32_32x32x16_bf16 v[160:175], v[188:191], v[44:47], v[160:175]
 ds_read_b64_tr_b16 v[184:185], v242 offset:28672
 ds_read_b64_tr_b16 v[186:187], v242 offset:29184
 s_waitcnt lgkmcnt(4)
 v_mfma_f32_32x32x16_bf16 v[160:175], v[176:179], v[48:51], v[160:175]
 ds_read_b64_tr_b16 v[188:189], v242 offset:30720
 ds_read_b64_tr_b16 v[190:191], v242 offset:31232
 s_waitcnt lgkmcnt(4)
 v_mfma_f32_32x32x16_bf16 v[160:175], v[180:183], v[52:55], v[160:175]
 ds_read_b64_tr_b16 v[176:177], v242 offset:32768
 ds_read_b64_tr_b16 v[178:179], v242 offset:33280
 s_waitcnt lgkmcnt(4)
 v_mfma_f32_32x32x16_bf16 v[160:175], v[184:187], v[56:59], v[160:175]
 ds_read_b64_tr_b16 v[180:181], v242 offset:34816
 ds_read_b64_tr_b16 v[182:183], v242 offset:35328
 s_waitcnt lgkmcnt(4)
 v_mfma_f32_32x32x16_bf16 v[160:175], v[188:191], v[60:63], v[160:175]
 ds_read_b64_tr_b16 v[184:185], v243 offset:0
 ds_read_b64_tr_b16 v[186:187], v243 offset:512
 s_waitcnt lgkmcnt(4)
 v_mfma_f32_32x32x16_bf16 v[160:175], v[176:179], v[64:67], v[160:175]
 ds_read_b64_tr_b16 v[188:189], v243 offset:2048
 ds_read_b64_tr_b16 v[190:191], v243 offset:2560
 s_waitcnt lgkmcnt(4)
 v_mfma_f32_32x32x16_bf16 v[160:175], v[180:183], v[68:71], v[160:175]
 ds_read_b64_tr_b16 v[176:177], v243 offset:4096
 ds_read_b64_tr_b16 v[178:179], v243 offset:4608
 s_waitcnt lgkmcnt(4)
 v_mfma_f32_32x32x16_bf16 v[160:175], v[184:187], v[72:75], v[160:175]
 ds_read_b64_tr_b16 v[180:181], v243 offset:6144
 ds_read_b64_tr_b16 v[182:183], v243 offset:6656
 s_waitcnt lgkmcnt(4)
 v_mfma_f32_32x32x16_bf16 v[160:175], v[188:191], v[76:79], v[160:175]
 ds_read_b64_tr_b16 v[184:185], v243 offset:8192
 ds_read_b64_tr_b16 v[186:187], v243 offset:8704
 s_waitcnt lgkmcnt(4)
 v_mfma_f32_32x32x16_bf16 v[160:175], v[176:179], v[80:83], v[160:175]
 ds_read_b64_tr_b16 v[188:189], v243 offset:10240
 ds_read_b64_tr_b16 v[190:191], v243 offset:10752
 s_waitcnt lgkmcnt(4)
 v_mfma_f32_32x32x16_bf16 v[160:175], v[180:183], v[84:87], v[160:175]
 ds_read_b64_tr_b16 v[176:177], v243 offset:12288
 ds_read_b64_tr_b16 v[178:179], v243 offset:12800
 s_waitcnt lgkmcnt(4)
 v_mfma_f32_32x32x16_bf16 v[160:175], v[184:187], v[88:91], v[160:175]
 ds_read_b64_tr_b16 v[180:181], v243 offset:14336
 ds_read_b64_tr_b16 v[182:183], v243 offset:14848
 s_waitcnt lgkmcnt(4)
 v_mfma_f32_32x32x16_bf16 v[160:175], v[188:191], v[92:95], v[160:175]
 ds_read_b64_tr_b16 v[184:185], v243 offset:16384
 ds_read_b64_tr_b16 v[186:187], v243 offset:16896
 s_waitcnt lgkmcnt(4)
 v_mfma_f32_32x32x16_bf16 v[160:175], v[176:179], v[96:99], v[160:175]
 ds_read_b64_tr_b16 v[188:189], v243 offset:18432
 ds_read_b64_tr_b16 v[190:191], v243 offset:18944
 s_waitcnt lgkmcnt(4)
 v_mfma_f32_32x32x16_bf16 v[160:175], v[180:183], v[100:103], v[160:175]
 ds_read_b64_tr_b16 v[176:177], v243 offset:20480
 ds_read_b64_tr_b16 v[178:179], v243 offset:20992
 s_waitcnt lgkmcnt(4)
 v_mfma_f32_32x32x16_bf16 v[160:175], v[184:187], v[104:107], v[160:175]
 ds_read_b64_tr_b16 v[180:181], v243 offset:22528
 ds_read_b64_tr_b16 v[182:183], v243 offset:23040
 s_waitcnt lgkmcnt(4)
 v_mfma_f32_32x32x16_bf16 v[160:175], v[188:191], v[108:111], v[160:175]
 ds_read_b64_tr_b16 v[184:185], v243 offset:24576
 ds_read_b64_tr_b16 v[186:187], v243 offset:25088
 s_waitcnt lgkmcnt(4)
 v_mfma_f32_32x32x16_bf16 v[160:175], v[176:179], v[112:115], v[160:175]
 ds_read_b64_tr_b16 v[188:189], v243 offset:26624
 ds_read_b64_tr_b16 v[190:191], v243 offset:27136
 s_waitcnt lgkmcnt(4)
 v_mfma_f32_32x32x16_bf16 v[160:175], v[180:183], v[116:119], v[160:175]
 ds_read_b64_tr_b16 v[176:177], v243 offset:28672
 ds_read_b64_tr_b16 v[178:179], v243 offset:29184
 s_waitcnt lgkmcnt(4)
 v_mfma_f32_32x32x16_bf16 v[160:175], v[184:187], v[120:123], v[160:175]
 ds_read_b64_tr_b16 v[180:181], v243 offset:30720
 ds_read_b64_tr_b16 v[182:183], v243 offset:31232
 s_waitcnt lgkmcnt(4)
 v_mfma_f32_32x32x16_bf16 v[160:175], v[188:191], v[124:127], v[160:175]
 ds_read_b64_tr_b16 v[184:185], v243 offset:32768
 ds_read_b64_tr_b16 v[186:187], v243 offset:33280
 s_waitcnt lgkmcnt(4)
 v_mfma_f32_32x32x16_bf16 v[160:175], v[176:179], v[128:131], v[160:175]
 ds_read_b64_tr_b16 v[188:189], v243 offset:34816
 ds_read_b64_tr_b16 v[190:191], v243 offset:35328
 s_waitcnt lgkmcnt(4)
 v_mfma_f32_32x32x16_bf16 v[160:175], v[180:183], v[132:135], v[160:175]
 s_waitcnt lgkmcnt(2)
 v_mfma_f32_32x32x16_bf16 v[160:175], v[184:187], v[136:139], v[160:175]
 s_waitcnt lgkmcnt(0)
 v_mfma_f32_32x32x16_bf16 v[160:175], v[188:191], v[140:143], v[160:175]
 s_branch L_projj_268
L_projv_267:
 ds_read_b64_tr_b16 v[176:177], v240 offset:0
 ds_read_b64_tr_b16 v[178:179], v240 offset:512
 ds_read_b64_tr_b16 v[180:181], v240 offset:2048
 ds_read_b64_tr_b16 v[182:183], v240 offset:2560
 ds_read_b64_tr_b16 v[184:185], v240 offset:4096
 ds_read_b64_tr_b16 v[186:187], v240 offset:4608
 s_waitcnt lgkmcnt(4)
 v_mfma_f32_32x32x16_bf16 v[144:159], v[0:3], v[176:179], 0
 ds_read_b64_tr_b16 v[188:189], v240 offset:6144
 ds_read_b64_tr_b16 v[190:191], v240 offset:6656
 s_add_u32 m0, s57, 0
 s_nop 0
 buffer_load_dwordx4 v244, s[40:43], s54 offen  lds
 s_add_u32 s54, s54, s67
 s_waitcnt lgkmcnt(4)
 v_mfma_f32_32x32x16_bf16 v[144:159], v[4:7], v[180:183], v[144:159]
 ds_read_b64_tr_b16 v[176:177], v240 offset:8192
 ds_read_b64_tr_b16 v[178:179], v240 offset:8704
 s_add_u32 m0, s57, 4096
 s_nop 0
 buffer_load_dwordx4 v244, s[40:43], s54 offen  lds
 s_add_u32 s54, s54, s67
 s_waitcnt lgkmcnt(4)
 v_mfma_f32_32x32x16_bf16 v[144:159], v[8:11], v[184:187], v[144:159]
 ds_read_b64_tr_b16 v[180:181], v240 offset:10240
 ds_read_b64_tr_b16 v[182:183], v240 offset:10752
 s_add_u32 m0, s57, 8192
 s_nop 0
 buffer_load_dwordx4 v244, s[40:43], s54 offen  lds
 s_add_u32 s54, s54, s67
 s_waitcnt lgkmcnt(4)
 v_mfma_f32_32x32x16_bf16 v[144:159], v[12:15], v[188:191], v[144:159]
 ds_read_b64_tr_b16 v[184:185], v240 offset:12288
 ds_read_b64_tr_b16 v[186:187], v240 offset:12800
 s_add_u32 m0, s57, 12288
 s_nop 0
 buffer_load_dwordx4 v244, s[40:43], s54 offen  lds
 s_add_u32 s54, s54, s67
 s_waitcnt lgkmcnt(4)
 v_mfma_f32_32x32x16_bf16 v[144:159], v[16:19], v[176:179], v[144:159]
 ds_read_b64_tr_b16 v[188:189], v240 offset:14336
 ds_read_b64_tr_b16 v[190:191], v240 offset:14848
 s_add_u32 m0, s57, 16384
 s_nop 0
 buffer_load_dwordx4 v244, s[40:43], s54 offen  lds
 s_add_u32 s54, s54, s67
 s_waitcnt lgkmcnt(4)
 v_mfma_f32_32x32x16_bf16 v[144:159], v[20:23], v[180:183], v[144:159]
 ds_read_b64_tr_b16 v[176:177], v240 offset:16384
 ds_read_b64_tr_b16 v[178:179], v240 offset:16896
 s_add_u32 m0, s57, 20480
 s_nop 0
 buffer_load_dwordx4 v244, s[40:43], s54 offen  lds
 s_add_u32 s54, s54, s67
 s_waitcnt lgkmcnt(4)
 v_mfma_f32_32x32x16_bf16 v[144:159], v[24:27], v[184:187], v[144:159]
 ds_read_b64_tr_b16 v[180:181], v240 offset:18432
 ds_read_b64_tr_b16 v[182:183], v240 offset:18944
 s_add_u32 m0, s57, 24576
 s_nop 0
 buffer_load_dwordx4 v244, s[40:43], s54 offen  lds
 s_add_u32 s54, s54, s67
 s_waitcnt lgkmcnt(4)
 v_mfma_f32_32x32x16_bf16 v[144:159], v[28:31], v[188:191], v[144:159]
 ds_read_b64_tr_b16 v[184:185], v240 offset:20480
 ds_read_b64_tr_b16 v[186:187], v240 offset:20992
 s_add_u32 m0, s57, 28672
 s_nop 0
 buffer_load_dwordx4 v244, s[40:43], s54 offen  lds
 s_add_u32 s54, s54, s67
 s_waitcnt lgkmcnt(4)
 v_mfma_f32_32x32x16_bf16 v[144:159], v[32:35], v[176:179], v[144:159]
 ds_read_b64_tr_b16 v[188:189], v240 offset:22528
 ds_read_b64_tr_b16 v[190:191], v240 offset:23040
 s_add_u32 m0, s57, 32768
 s_nop 0
 buffer_load_dwordx4 v244, s[40:43], s54 offen  lds
 s_add_u32 s54, s54, s67
 s_waitcnt lgkmcnt(4)
 v_mfma_f32_32x32x16_bf16 v[144:159], v[36:39], v[180:183], v[144:159]
 ds_read_b64_tr_b16 v[176:177], v240 offset:24576
 ds_read_b64_tr_b16 v[178:179], v240 offset:25088
 s_add_u32 m0, s57, 36864
 s_nop 0
 buffer_load_dwordx4 v244, s[40:43], s54 offen  lds
 s_add_u32 s54, s54, s67
 s_waitcnt lgkmcnt(4)
 v_mfma_f32_32x32x16_bf16 v[144:159], v[40:43], v[184:187], v[144:159]
 ds_read_b64_tr_b16 v[180:181], v240 offset:26624
 ds_read_b64_tr_b16 v[182:183], v240 offset:27136
 s_add_u32 m0, s57, 40960
 s_nop 0
 buffer_load_dwordx4 v244, s[40:43], s54 offen  lds
 s_add_u32 s54, s54, s67
 s_waitcnt lgkmcnt(4)
 v_mfma_f32_32x32x16_bf16 v[144:159], v[44:47], v[188:191], v[144:159]
 ds_read_b64_tr_b16 v[184:185], v240 offset:28672
 ds_read_b64_tr_b16 v[186:187], v240 offset:29184
 s_add_u32 m0, s57, 45056
 s_nop 0
 buffer_load_dwordx4 v244, s[40:43], s54 offen  lds
 s_add_u32 s54, s54, s67
 s_waitcnt lgkmcnt(4)
 v_mfma_f32_32x32x16_bf16 v[144:159], v[48:51], v[176:179], v[144:159]
 ds_read_b64_tr_b16 v[188:189], v240 offset:30720
 ds_read_b64_tr_b16 v[190:191], v240 offset:31232
 s_add_u32 m0, s57, 49152
 s_nop 0
 buffer_load_dwordx4 v244, s[40:43], s54 offen  lds
 s_add_u32 s54, s54, s67
 s_waitcnt lgkmcnt(4)
 v_mfma_f32_32x32x16_bf16 v[144:159], v[52:55], v[180:183], v[144:159]
 ds_read_b64_tr_b16 v[176:177], v240 offset:32768
 ds_read_b64_tr_b16 v[178:179], v240 offset:33280
 s_add_u32 m0, s57, 53248
 s_nop 0
 buffer_load_dwordx4 v244, s[40:43], s54 offen  lds
 s_add_u32 s54, s54, s67
 s_waitcnt lgkmcnt(4)
 v_mfma_f32_32x32x16_bf16 v[144:159], v[56:59], v[184:187], v[144:159]
 ds_read_b64_tr_b16 v[180:181], v240 offset:34816
 ds_read_b64_tr_b16 v[182:183], v240 offset:35328
 s_add_u32 m0, s57, 57344
 s_nop 0
 buffer_load_dwordx4 v244, s[40:43], s54 offen  lds
 s_add_u32 s54, s54, s67
 s_waitcnt lgkmcnt(4)
 v_mfma_f32_32x32x16_bf16 v[144:159], v[60:63], v[188:191], v[144:159]
 ds_read_b64_tr_b16 v[184:185], v241 offset:0
 ds_read_b64_tr_b16 v[186:187], v241 offset:512
 s_add_u32 m0, s57, 61440
 s_nop 0
 buffer_load_dwordx4 v244, s[40:43], s54 offen  lds
 s_add_u32 s54, s54, s67
 s_waitcnt lgkmcnt(4)
 v_mfma_f32_32x32x16_bf16 v[144:159], v[64:67], v[176:179], v[144:159]
 ds_read_b64_tr_b16 v[188:189], v241 offset:2048
 ds_read_b64_tr_b16 v[190:191], v241 offset:2560
 s_add_u32 m0, s57, 65536
 s_nop 0
 buffer_load_dwordx4 v244, s[40:43], s54 offen  lds
 s_add_u32 s54, s54, s67
 s_waitcnt lgkmcnt(4)
 v_mfma_f32_32x32x16_bf16 v[144:159], v[68:71], v[180:183], v[144:159]
 ds_read_b64_tr_b16 v[176:177], v241 offset:4096
 ds_read_b64_tr_b16 v[178:179], v241 offset:4608
 s_add_u32 m0, s57, 69632
 s_nop 0
 buffer_load_dwordx4 v244, s[40:43], s54 offen  lds
 s_add_u32 s54, s54, s67
 s_waitcnt lgkmcnt(4)
 v_mfma_f32_32x32x16_bf16 v[144:159], v[72:75], v[184:187], v[144:159]
 ds_read_b64_tr_b16 v[180:181], v241 offset:6144
 ds_read_b64_tr_b16 v[182:183], v241 offset:6656
 s_waitcnt lgkmcnt(4)
 v_mfma_f32_32x32x16_bf16 v[144:159], v[76:79], v[188:191], v[144:159]
 ds_read_b64_tr_b16 v[184:185], v241 offset:8192
 ds_read_b64_tr_b16 v[186:187], v241 offset:8704
 s_waitcnt lgkmcnt(4)
 v_mfma_f32_32x32x16_bf16 v[144:159], v[80:83], v[176:179], v[144:159]
 ds_read_b64_tr_b16 v[188:189], v241 offset:10240
 ds_read_b64_tr_b16 v[190:191], v241 offset:10752
 s_waitcnt lgkmcnt(4)
 v_mfma_f32_32x32x16_bf16 v[144:159], v[84:87], v[180:183], v[144:159]
 ds_read_b64_tr_b16 v[176:177], v241 offset:12288
 ds_read_b64_tr_b16 v[178:179], v241 offset:12800
 s_waitcnt lgkmcnt(4)
 v_mfma_f32_32x32x16_bf16 v[144:159], v[88:91], v[184:187], v[144:159]
 ds_read_b64_tr_b16 v[180:181], v241 offset:14336
 ds_read_b64_tr_b16 v[182:183], v241 offset:14848
 s_waitcnt lgkmcnt(4)
 v_mfma_f32_32x32x16_bf16 v[144:159], v[92:95], v[188:191], v[144:159]
 ds_read_b64_tr_b16 v[184:185], v241 offset:16384
 ds_read_b64_tr_b16 v[186:187], v241 offset:16896
 s_waitcnt lgkmcnt(4)
 v_mfma_f32_32x32x16_bf16 v[144:159], v[96:99], v[176:179], v[144:159]
 ds_read_b64_tr_b16 v[188:189], v241 offset:18432
 ds_read_b64_tr_b16 v[190:191], v241 offset:18944
 s_waitcnt lgkmcnt(4)
 v_mfma_f32_32x32x16_bf16 v[144:159], v[100:103], v[180:183], v[144:159]
 ds_read_b64_tr_b16 v[176:177], v241 offset:20480
 ds_read_b64_tr_b16 v[178:179], v241 offset:20992
 s_waitcnt lgkmcnt(4)
 v_mfma_f32_32x32x16_bf16 v[144:159], v[104:107], v[184:187], v[144:159]
 ds_read_b64_tr_b16 v[180:181], v241 offset:22528
 ds_read_b64_tr_b16 v[182:183], v241 offset:23040
 s_waitcnt lgkmcnt(4)
 v_mfma_f32_32x32x16_bf16 v[144:159], v[108:111], v[188:191], v[144:159]
 ds_read_b64_tr_b16 v[184:185], v241 offset:24576
 ds_read_b64_tr_b16 v[186:187], v241 offset:25088
 s_waitcnt lgkmcnt(4)
 v_mfma_f32_32x32x16_bf16 v[144:159], v[112:115], v[176:179], v[144:159]
 ds_read_b64_tr_b16 v[188:189], v241 offset:26624
 ds_read_b64_tr_b16 v[190:191], v241 offset:27136
 s_waitcnt lgkmcnt(4)
 v_mfma_f32_32x32x16_bf16 v[144:159], v[116:119], v[180:183], v[144:159]
 ds_read_b64_tr_b16 v[176:177], v241 offset:28672
 ds_read_b64_tr_b16 v[178:179], v241 offset:29184
 s_waitcnt lgkmcnt(4)
 v_mfma_f32_32x32x16_bf16 v[144:159], v[120:123], v[184:187], v[144:159]
 ds_read_b64_tr_b16 v[180:181], v241 offset:30720
 ds_read_b64_tr_b16 v[182:183], v241 offset:31232
 s_waitcnt lgkmcnt(4)
 v_mfma_f32_32x32x16_bf16 v[144:159], v[124:127], v[188:191], v[144:159]
 ds_read_b64_tr_b16 v[184:185], v241 offset:32768
 ds_read_b64_tr_b16 v[186:187], v241 offset:33280
 s_waitcnt lgkmcnt(4)
 v_mfma_f32_32x32x16_bf16 v[144:159], v[128:131], v[176:179], v[144:159]
 ds_read_b64_tr_b16 v[188:189], v241 offset:34816
 ds_read_b64_tr_b16 v[190:191], v241 offset:35328
 s_waitcnt lgkmcnt(4)
 v_mfma_f32_32x32x16_bf16 v[144:159], v[132:135], v[180:183], v[144:159]
 ds_read_b64_tr_b16 v[176:177], v242 offset:0
 ds_read_b64_tr_b16 v[178:179], v242 offset:512
 s_waitcnt lgkmcnt(4)
 v_mfma_f32_32x32x16_bf16 v[144:159], v[136:139], v[184:187], v[144:159]
 ds_read_b64_tr_b16 v[180:181], v242 offset:2048
 ds_read_b64_tr_b16 v[182:183], v242 offset:2560
 s_waitcnt lgkmcnt(4)
 v_mfma_f32_32x32x16_bf16 v[144:159], v[140:143], v[188:191], v[144:159]
 ds_read_b64_tr_b16 v[184:185], v242 offset:4096
 ds_read_b64_tr_b16 v[186:187], v242 offset:4608
 s_waitcnt lgkmcnt(4)
 v_mfma_f32_32x32x16_bf16 v[160:175], v[0:3], v[176:179], 0
 ds_read_b64_tr_b16 v[188:189], v242 offset:6144
 ds_read_b64_tr_b16 v[190:191], v242 offset:6656
 s_waitcnt lgkmcnt(4)
 v_mfma_f32_32x32x16_bf16 v[160:175], v[4:7], v[180:183], v[160:175]
 ds_read_b64_tr_b16 v[176:177], v242 offset:8192
 ds_read_b64_tr_b16 v[178:179], v242 offset:8704
 s_waitcnt lgkmcnt(4)
 v_mfma_f32_32x32x16_bf16 v[160:175], v[8:11], v[184:187], v[160:175]
 ds_read_b64_tr_b16 v[180:181], v242 offset:10240
 ds_read_b64_tr_b16 v[182:183], v242 offset:10752
 s_waitcnt lgkmcnt(4)
 v_mfma_f32_32x32x16_bf16 v[160:175], v[12:15], v[188:191], v[160:175]
 ds_read_b64_tr_b16 v[184:185], v242 offset:12288
 ds_read_b64_tr_b16 v[186:187], v242 offset:12800
 s_waitcnt lgkmcnt(4)
 v_mfma_f32_32x32x16_bf16 v[160:175], v[16:19], v[176:179], v[160:175]
 ds_read_b64_tr_b16 v[188:189], v242 offset:14336
 ds_read_b64_tr_b16 v[190:191], v242 offset:14848
 v_cvt_pk_bf16_f32 v200, v144, v145
 v_cvt_pk_bf16_f32 v201, v146, v147
 s_waitcnt lgkmcnt(4)
 v_mfma_f32_32x32x16_bf16 v[160:175], v[20:23], v[180:183], v[160:175]
 ds_read_b64_tr_b16 v[176:177], v242 offset:16384
 ds_read_b64_tr_b16 v[178:179], v242 offset:16896
 v_cvt_pk_bf16_f32 v202, v148, v149
 v_cvt_pk_bf16_f32 v203, v150, v151
 s_waitcnt lgkmcnt(4)
 v_mfma_f32_32x32x16_bf16 v[160:175], v[24:27], v[184:187], v[160:175]
 ds_read_b64_tr_b16 v[180:181], v242 offset:18432
 ds_read_b64_tr_b16 v[182:183], v242 offset:18944
 buffer_store_dwordx4 v[200:203], v246, s[4:7], s55 offen offset:0 sc1
 v_cvt_pk_bf16_f32 v204, v152, v153
 s_waitcnt lgkmcnt(4)
 v_mfma_f32_32x32x16_bf16 v[160:175], v[28:31], v[188:191], v[160:175]
 ds_read_b64_tr_b16 v[184:185], v242 offset:20480
 ds_read_b64_tr_b16 v[186:187], v242 offset:20992
 v_cvt_pk_bf16_f32 v205, v154, v155
 v_cvt_pk_bf16_f32 v206, v156, v157
 s_waitcnt lgkmcnt(4)
 v_mfma_f32_32x32x16_bf16 v[160:175], v[32:35], v[176:179], v[160:175]
 ds_read_b64_tr_b16 v[188:189], v242 offset:22528
 ds_read_b64_tr_b16 v[190:191], v242 offset:23040
 v_cvt_pk_bf16_f32 v207, v158, v159
 buffer_store_dwordx4 v[204:207], v246, s[4:7], s55 offen offset:1024 sc1
 s_waitcnt lgkmcnt(4)
 v_mfma_f32_32x32x16_bf16 v[160:175], v[36:39], v[180:183], v[160:175]
 ds_read_b64_tr_b16 v[176:177], v242 offset:24576
 ds_read_b64_tr_b16 v[178:179], v242 offset:25088
 s_waitcnt lgkmcnt(4)
 v_mfma_f32_32x32x16_bf16 v[160:175], v[40:43], v[184:187], v[160:175]
 ds_read_b64_tr_b16 v[180:181], v242 offset:26624
 ds_read_b64_tr_b16 v[182:183], v242 offset:27136
 s_waitcnt lgkmcnt(4)
 v_mfma_f32_32x32x16_bf16 v[160:175], v[44:47], v[188:191], v[160:175]
 ds_read_b64_tr_b16 v[184:185], v242 offset:28672
 ds_read_b64_tr_b16 v[186:187], v242 offset:29184
 s_waitcnt lgkmcnt(4)
 v_mfma_f32_32x32x16_bf16 v[160:175], v[48:51], v[176:179], v[160:175]
 ds_read_b64_tr_b16 v[188:189], v242 offset:30720
 ds_read_b64_tr_b16 v[190:191], v242 offset:31232
 s_waitcnt lgkmcnt(4)
 v_mfma_f32_32x32x16_bf16 v[160:175], v[52:55], v[180:183], v[160:175]
 ds_read_b64_tr_b16 v[176:177], v242 offset:32768
 ds_read_b64_tr_b16 v[178:179], v242 offset:33280
 s_waitcnt lgkmcnt(4)
 v_mfma_f32_32x32x16_bf16 v[160:175], v[56:59], v[184:187], v[160:175]
 ds_read_b64_tr_b16 v[180:181], v242 offset:34816
 ds_read_b64_tr_b16 v[182:183], v242 offset:35328
 s_waitcnt lgkmcnt(4)
 v_mfma_f32_32x32x16_bf16 v[160:175], v[60:63], v[188:191], v[160:175]
 ds_read_b64_tr_b16 v[184:185], v243 offset:0
 ds_read_b64_tr_b16 v[186:187], v243 offset:512
 s_waitcnt lgkmcnt(4)
 v_mfma_f32_32x32x16_bf16 v[160:175], v[64:67], v[176:179], v[160:175]
 ds_read_b64_tr_b16 v[188:189], v243 offset:2048
 ds_read_b64_tr_b16 v[190:191], v243 offset:2560
 s_waitcnt lgkmcnt(4)
 v_mfma_f32_32x32x16_bf16 v[160:175], v[68:71], v[180:183], v[160:175]
 ds_read_b64_tr_b16 v[176:177], v243 offset:4096
 ds_read_b64_tr_b16 v[178:179], v243 offset:4608
 s_waitcnt lgkmcnt(4)
 v_mfma_f32_32x32x16_bf16 v[160:175], v[72:75], v[184:187], v[160:175]
 ds_read_b64_tr_b16 v[180:181], v243 offset:6144
 ds_read_b64_tr_b16 v[182:183], v243 offset:6656
 s_waitcnt lgkmcnt(4)
 v_mfma_f32_32x32x16_bf16 v[160:175], v[76:79], v[188:191], v[160:175]
 ds_read_b64_tr_b16 v[184:185], v243 offset:8192
 ds_read_b64_tr_b16 v[186:187], v243 offset:8704
 s_waitcnt lgkmcnt(4)
 v_mfma_f32_32x32x16_bf16 v[160:175], v[80:83], v[176:179], v[160:175]
 ds_read_b64_tr_b16 v[188:189], v243 offset:10240
 ds_read_b64_tr_b16 v[190:191], v243 offset:10752
 s_waitcnt lgkmcnt(4)
 v_mfma_f32_32x32x16_bf16 v[160:175], v[84:87], v[180:183], v[160:175]
 ds_read_b64_tr_b16 v[176:177], v243 offset:12288
 ds_read_b64_tr_b16 v[178:179], v243 offset:12800
 s_waitcnt lgkmcnt(4)
 v_mfma_f32_32x32x16_bf16 v[160:175], v[88:91], v[184:187], v[160:175]
 ds_read_b64_tr_b16 v[180:181], v243 offset:14336
 ds_read_b64_tr_b16 v[182:183], v243 offset:14848
 s_waitcnt lgkmcnt(4)
 v_mfma_f32_32x32x16_bf16 v[160:175], v[92:95], v[188:191], v[160:175]
 ds_read_b64_tr_b16 v[184:185], v243 offset:16384
 ds_read_b64_tr_b16 v[186:187], v243 offset:16896
 s_waitcnt lgkmcnt(4)
 v_mfma_f32_32x32x16_bf16 v[160:175], v[96:99], v[176:179], v[160:175]
 ds_read_b64_tr_b16 v[188:189], v243 offset:18432
 ds_read_b64_tr_b16 v[190:191], v243 offset:18944
 s_waitcnt lgkmcnt(4)
 v_mfma_f32_32x32x16_bf16 v[160:175], v[100:103], v[180:183], v[160:175]
 ds_read_b64_tr_b16 v[176:177], v243 offset:20480
 ds_read_b64_tr_b16 v[178:179], v243 offset:20992
 s_waitcnt lgkmcnt(4)
 v_mfma_f32_32x32x16_bf16 v[160:175], v[104:107], v[184:187], v[160:175]
 ds_read_b64_tr_b16 v[180:181], v243 offset:22528
 ds_read_b64_tr_b16 v[182:183], v243 offset:23040
 s_waitcnt lgkmcnt(4)
 v_mfma_f32_32x32x16_bf16 v[160:175], v[108:111], v[188:191], v[160:175]
 ds_read_b64_tr_b16 v[184:185], v243 offset:24576
 ds_read_b64_tr_b16 v[186:187], v243 offset:25088
 s_waitcnt lgkmcnt(4)
 v_mfma_f32_32x32x16_bf16 v[160:175], v[112:115], v[176:179], v[160:175]
 ds_read_b64_tr_b16 v[188:189], v243 offset:26624
 ds_read_b64_tr_b16 v[190:191], v243 offset:27136
 s_waitcnt lgkmcnt(4)
 v_mfma_f32_32x32x16_bf16 v[160:175], v[116:119], v[180:183], v[160:175]
 ds_read_b64_tr_b16 v[176:177], v243 offset:28672
 ds_read_b64_tr_b16 v[178:179], v243 offset:29184
 s_waitcnt lgkmcnt(4)
 v_mfma_f32_32x32x16_bf16 v[160:175], v[120:123], v[184:187], v[160:175]
 ds_read_b64_tr_b16 v[180:181], v243 offset:30720
 ds_read_b64_tr_b16 v[182:183], v243 offset:31232
 s_waitcnt lgkmcnt(4)
 v_mfma_f32_32x32x16_bf16 v[160:175], v[124:127], v[188:191], v[160:175]
 ds_read_b64_tr_b16 v[184:185], v243 offset:32768
 ds_read_b64_tr_b16 v[186:187], v243 offset:33280
 s_waitcnt lgkmcnt(4)
 v_mfma_f32_32x32x16_bf16 v[160:175], v[128:131], v[176:179], v[160:175]
 ds_read_b64_tr_b16 v[188:189], v243 offset:34816
 ds_read_b64_tr_b16 v[190:191], v243 offset:35328
 s_waitcnt lgkmcnt(4)
 v_mfma_f32_32x32x16_bf16 v[160:175], v[132:135], v[180:183], v[160:175]
 s_waitcnt lgkmcnt(2)
 v_mfma_f32_32x32x16_bf16 v[160:175], v[136:139], v[184:187], v[160:175]
 s_waitcnt lgkmcnt(0)
 v_mfma_f32_32x32x16_bf16 v[160:175], v[140:143], v[188:191], v[160:175]
L_projj_268:
 s_mov_b32 s56, s55
 s_waitcnt vmcnt(2) lgkmcnt(0)
 s_barrier
 s_lshl_b32 s3, s46, 10
 s_sub_u32 s76, s57, s3
 s_sub_u32 s77, 73728, s76
 s_add_u32 s57, s77, s3
 s_sub_u32 s76, s76, s77
 v_add_u32 v240, s76, v240
 v_add_u32 v241, s76, v241
 v_add_u32 v242, s76, v242
 v_add_u32 v243, s76, v243
 s_mov_b32 s55, s74
 s_mov_b32 s59, s90
 s_mov_b32 s60, s91
 s_lshl_b32 s58, s50, 2
 s_add_u32 s58, s58, s46
 s_mov_b32 s52, 0
 s_cmp_eq_u32 s89, 1
 s_cbranch_scc1 L_fs_269
 s_cmp_ge_u32 s52, s60
 s_cbranch_scc1 L_pq_271
 s_add_u32 s72, s59, s52
 s_cmp_ge_u32 s72, 64
 s_cbranch_scc1 L_pv_272
 s_mov_b32 s40, s12
 s_mov_b32 s41, s13
 s_mov_b32 s42, s14
 s_mov_b32 s43, s15
 s_mov_b32 s73, 0
 s_mov_b32 s66, 0
 s_branch L_pe_273
L_pv_272:
 s_sub_u32 s72, s72, 64
 s_mov_b32 s40, s16
 s_mov_b32 s41, s17
 s_mov_b32 s42, s18
 s_mov_b32 s43, s19
 s_mov_b32 s73, 16777216
 s_mov_b32 s66, 1
 s_branch L_pe_273
L_pq_271:
 s_sub_u32 s72, s52, s60
 s_add_u32 s72, s72, s61
 s_mov_b32 s40, s8
 s_mov_b32 s41, s9
 s_mov_b32 s42, s10
 s_mov_b32 s43, s11
 s_mov_b32 s73, 33554432
 s_mov_b32 s66, 0
L_pe_273:
 s_lshl_b32 s54, s72, 7
 s_lshl_b32 s3, s46, 16
 s_add_u32 s54, s54, s3
 s_lshl_b32 s74, s72, 12
 s_lshl_b32 s3, s58, 18
 s_add_u32 s74, s74, s3
 s_add_u32 s74, s74, s73
 s_mov_b32 s67, 262144
 v_mov_b32 v252, v244
 s_branch L_fs2_270
L_fs_269:
 s_mov_b32 s40, s28
 s_mov_b32 s41, s29
 s_mov_b32 s42, s30
 s_mov_b32 s43, s31
 s_lshl_b32 s54, s63, 7
 s_mul_i32 s3, s46, 73728
 s_add_u32 s54, s54, s3
 s_mov_b32 s67, 294912
 v_mov_b32 v252, v251
L_fs2_270:
 s_cmp_eq_u32 s65, 1
 s_cbranch_scc1 L_projv_274
 ds_read_b64_tr_b16 v[176:177], v240 offset:0
 ds_read_b64_tr_b16 v[178:179], v240 offset:512
 ds_read_b64_tr_b16 v[180:181], v240 offset:2048
 ds_read_b64_tr_b16 v[182:183], v240 offset:2560
 ds_read_b64_tr_b16 v[184:185], v240 offset:4096
 ds_read_b64_tr_b16 v[186:187], v240 offset:4608
 s_waitcnt lgkmcnt(4)
 v_mfma_f32_32x32x16_bf16 v[144:159], v[176:179], v[0:3], 0
 ds_read_b64_tr_b16 v[188:189], v240 offset:6144
 ds_read_b64_tr_b16 v[190:191], v240 offset:6656
 s_add_u32 m0, s57, 0
 s_nop 0
 buffer_load_dwordx4 v252, s[40:43], s54 offen  lds
 s_add_u32 s54, s54, s67
 s_waitcnt lgkmcnt(4)
 v_mfma_f32_32x32x16_bf16 v[144:159], v[180:183], v[4:7], v[144:159]
 ds_read_b64_tr_b16 v[176:177], v240 offset:8192
 ds_read_b64_tr_b16 v[178:179], v240 offset:8704
 s_add_u32 m0, s57, 4096
 s_nop 0
 buffer_load_dwordx4 v252, s[40:43], s54 offen  lds
 s_add_u32 s54, s54, s67
 s_waitcnt lgkmcnt(4)
 v_mfma_f32_32x32x16_bf16 v[144:159], v[184:187], v[8:11], v[144:159]
 ds_read_b64_tr_b16 v[180:181], v240 offset:10240
 ds_read_b64_tr_b16 v[182:183], v240 offset:10752
 s_add_u32 m0, s57, 8192
 s_nop 0
 buffer_load_dwordx4 v252, s[40:43], s54 offen  lds
 s_add_u32 s54, s54, s67
 s_waitcnt lgkmcnt(4)
 v_mfma_f32_32x32x16_bf16 v[144:159], v[188:191], v[12:15], v[144:159]
 ds_read_b64_tr_b16 v[184:185], v240 offset:12288
 ds_read_b64_tr_b16 v[186:187], v240 offset:12800
 s_add_u32 m0, s57, 12288
 s_nop 0
 buffer_load_dwordx4 v252, s[40:43], s54 offen  lds
 s_add_u32 s54, s54, s67
 s_waitcnt lgkmcnt(4)
 v_mfma_f32_32x32x16_bf16 v[144:159], v[176:179], v[16:19], v[144:159]
 ds_read_b64_tr_b16 v[188:189], v240 offset:14336
 ds_read_b64_tr_b16 v[190:191], v240 offset:14848
 s_add_u32 m0, s57, 16384
 s_nop 0
 buffer_load_dwordx4 v252, s[40:43], s54 offen  lds
 s_add_u32 s54, s54, s67
 s_waitcnt lgkmcnt(4)
 v_mfma_f32_32x32x16_bf16 v[144:159], v[180:183], v[20:23], v[144:159]
 ds_read_b64_tr_b16 v[176:177], v240 offset:16384
 ds_read_b64_tr_b16 v[178:179], v240 offset:16896
 s_add_u32 m0, s57, 20480
 s_nop 0
 buffer_load_dwordx4 v252, s[40:43], s54 offen  lds
 s_add_u32 s54, s54, s67
 s_waitcnt lgkmcnt(4)
 v_mfma_f32_32x32x16_bf16 v[144:159], v[184:187], v[24:27], v[144:159]
 ds_read_b64_tr_b16 v[180:181], v240 offset:18432
 ds_read_b64_tr_b16 v[182:183], v240 offset:18944
 s_add_u32 m0, s57, 24576
 s_nop 0
 buffer_load_dwordx4 v252, s[40:43], s54 offen  lds
 s_add_u32 s54, s54, s67
 s_waitcnt lgkmcnt(4)
 v_mfma_f32_32x32x16_bf16 v[144:159], v[188:191], v[28:31], v[144:159]
 ds_read_b64_tr_b16 v[184:185], v240 offset:20480
 ds_read_b64_tr_b16 v[186:187], v240 offset:20992
 s_add_u32 m0, s57, 28672
 s_nop 0
 buffer_load_dwordx4 v252, s[40:43], s54 offen  lds
 s_add_u32 s54, s54, s67
 s_waitcnt lgkmcnt(4)
 v_mfma_f32_32x32x16_bf16 v[144:159], v[176:179], v[32:35], v[144:159]
 ds_read_b64_tr_b16 v[188:189], v240 offset:22528
 ds_read_b64_tr_b16 v[190:191], v240 offset:23040
 s_add_u32 m0, s57, 32768
 s_nop 0
 buffer_load_dwordx4 v252, s[40:43], s54 offen  lds
 s_add_u32 s54, s54, s67
 s_waitcnt lgkmcnt(4)
 v_mfma_f32_32x32x16_bf16 v[144:159], v[180:183], v[36:39], v[144:159]
 ds_read_b64_tr_b16 v[176:177], v240 offset:24576
 ds_read_b64_tr_b16 v[178:179], v240 offset:25088
 s_add_u32 m0, s57, 36864
 s_nop 0
 buffer_load_dwordx4 v252, s[40:43], s54 offen  lds
 s_add_u32 s54, s54, s67
 s_waitcnt lgkmcnt(4)
 v_mfma_f32_32x32x16_bf16 v[144:159], v[184:187], v[40:43], v[144:159]
 ds_read_b64_tr_b16 v[180:181], v240 offset:26624
 ds_read_b64_tr_b16 v[182:183], v240 offset:27136
 s_add_u32 m0, s57, 40960
 s_nop 0
 buffer_load_dwordx4 v252, s[40:43], s54 offen  lds
 s_add_u32 s54, s54, s67
 s_waitcnt lgkmcnt(4)
 v_mfma_f32_32x32x16_bf16 v[144:159], v[188:191], v[44:47], v[144:159]
 ds_read_b64_tr_b16 v[184:185], v240 offset:28672
 ds_read_b64_tr_b16 v[186:187], v240 offset:29184
 s_add_u32 m0, s57, 45056
 s_nop 0
 buffer_load_dwordx4 v252, s[40:43], s54 offen  lds
 s_add_u32 s54, s54, s67
 s_waitcnt lgkmcnt(4)
 v_mfma_f32_32x32x16_bf16 v[144:159], v[176:179], v[48:51], v[144:159]
 ds_read_b64_tr_b16 v[188:189], v240 offset:30720
 ds_read_b64_tr_b16 v[190:191], v240 offset:31232
 s_add_u32 m0, s57, 49152
 s_nop 0
 buffer_load_dwordx4 v252, s[40:43], s54 offen  lds
 s_add_u32 s54, s54, s67
 s_waitcnt lgkmcnt(4)
 v_mfma_f32_32x32x16_bf16 v[144:159], v[180:183], v[52:55], v[144:159]
 ds_read_b64_tr_b16 v[176:177], v240 offset:32768
 ds_read_b64_tr_b16 v[178:179], v240 offset:33280
 s_add_u32 m0, s57, 53248
 s_nop 0
 buffer_load_dwordx4 v252, s[40:43], s54 offen  lds
 s_add_u32 s54, s54, s67
 s_waitcnt lgkmcnt(4)
 v_mfma_f32_32x32x16_bf16 v[144:159], v[184:187], v[56:59], v[144:159]
 ds_read_b64_tr_b16 v[180:181], v240 offset:34816
 ds_read_b64_tr_b16 v[182:183], v240 offset:35328
 s_add_u32 m0, s57, 57344
 s_nop 0
 buffer_load_dwordx4 v252, s[40:43], s54 offen  lds
 s_add_u32 s54, s54, s67
 s_waitcnt lgkmcnt(4)
 v_mfma_f32_32x32x16_bf16 v[144:159], v[188:191], v[60:63], v[144:159]
 ds_read_b64_tr_b16 v[184:185], v241 offset:0
 ds_read_b64_tr_b16 v[186:187], v241 offset:512
 s_add_u32 m0, s57, 61440
 s_nop 0
 buffer_load_dwordx4 v252, s[40:43], s54 offen  lds
 s_add_u32 s54, s54, s67
 s_waitcnt lgkmcnt(4)
 v_mfma_f32_32x32x16_bf16 v[144:159], v[176:179], v[64:67], v[144:159]
 ds_read_b64_tr_b16 v[188:189], v241 offset:2048
 ds_read_b64_tr_b16 v[190:191], v241 offset:2560
 s_add_u32 m0, s57, 65536
 s_nop 0
 buffer_load_dwordx4 v252, s[40:43], s54 offen  lds
 s_add_u32 s54, s54, s67
 s_waitcnt lgkmcnt(4)
 v_mfma_f32_32x32x16_bf16 v[144:159], v[180:183], v[68:71], v[144:159]
 ds_read_b64_tr_b16 v[176:177], v241 offset:4096
 ds_read_b64_tr_b16 v[178:179], v241 offset:4608
 s_add_u32 m0, s57, 69632
 s_nop 0
 buffer_load_dwordx4 v252, s[40:43], s54 offen  lds
 s_add_u32 s54, s54, s67
 s_waitcnt lgkmcnt(4)
 v_mfma_f32_32x32x16_bf16 v[144:159], v[184:187], v[72:75], v[144:159]
 ds_read_b64_tr_b16 v[180:181], v241 offset:6144
 ds_read_b64_tr_b16 v[182:183], v241 offset:6656
 s_waitcnt lgkmcnt(4)
 v_mfma_f32_32x32x16_bf16 v[144:159], v[188:191], v[76:79], v[144:159]
 ds_read_b64_tr_b16 v[184:185], v241 offset:8192
 ds_read_b64_tr_b16 v[186:187], v241 offset:8704
 s_waitcnt lgkmcnt(4)
 v_mfma_f32_32x32x16_bf16 v[144:159], v[176:179], v[80:83], v[144:159]
 ds_read_b64_tr_b16 v[188:189], v241 offset:10240
 ds_read_b64_tr_b16 v[190:191], v241 offset:10752
 s_waitcnt lgkmcnt(4)
 v_mfma_f32_32x32x16_bf16 v[144:159], v[180:183], v[84:87], v[144:159]
 ds_read_b64_tr_b16 v[176:177], v241 offset:12288
 ds_read_b64_tr_b16 v[178:179], v241 offset:12800
 s_waitcnt lgkmcnt(4)
 v_mfma_f32_32x32x16_bf16 v[144:159], v[184:187], v[88:91], v[144:159]
 ds_read_b64_tr_b16 v[180:181], v241 offset:14336
 ds_read_b64_tr_b16 v[182:183], v241 offset:14848
 s_waitcnt lgkmcnt(4)
 v_mfma_f32_32x32x16_bf16 v[144:159], v[188:191], v[92:95], v[144:159]
 ds_read_b64_tr_b16 v[184:185], v241 offset:16384
 ds_read_b64_tr_b16 v[186:187], v241 offset:16896
 s_waitcnt lgkmcnt(4)
 v_mfma_f32_32x32x16_bf16 v[144:159], v[176:179], v[96:99], v[144:159]
 ds_read_b64_tr_b16 v[188:189], v241 offset:18432
 ds_read_b64_tr_b16 v[190:191], v241 offset:18944
 s_waitcnt lgkmcnt(4)
 v_mfma_f32_32x32x16_bf16 v[144:159], v[180:183], v[100:103], v[144:159]
 ds_read_b64_tr_b16 v[176:177], v241 offset:20480
 ds_read_b64_tr_b16 v[178:179], v241 offset:20992
 s_waitcnt lgkmcnt(4)
 v_mfma_f32_32x32x16_bf16 v[144:159], v[184:187], v[104:107], v[144:159]
 ds_read_b64_tr_b16 v[180:181], v241 offset:22528
 ds_read_b64_tr_b16 v[182:183], v241 offset:23040
 s_waitcnt lgkmcnt(4)
 v_mfma_f32_32x32x16_bf16 v[144:159], v[188:191], v[108:111], v[144:159]
 ds_read_b64_tr_b16 v[184:185], v241 offset:24576
 ds_read_b64_tr_b16 v[186:187], v241 offset:25088
 s_waitcnt lgkmcnt(4)
 v_mfma_f32_32x32x16_bf16 v[144:159], v[176:179], v[112:115], v[144:159]
 ds_read_b64_tr_b16 v[188:189], v241 offset:26624
 ds_read_b64_tr_b16 v[190:191], v241 offset:27136
 s_waitcnt lgkmcnt(4)
 v_mfma_f32_32x32x16_bf16 v[144:159], v[180:183], v[116:119], v[144:159]
 ds_read_b64_tr_b16 v[176:177], v241 offset:28672
 ds_read_b64_tr_b16 v[178:179], v241 offset:29184
 s_waitcnt lgkmcnt(4)
 v_mfma_f32_32x32x16_bf16 v[144:159], v[184:187], v[120:123], v[144:159]
 ds_read_b64_tr_b16 v[180:181], v241 offset:30720
 ds_read_b64_tr_b16 v[182:183], v241 offset:31232
 v_cvt_pk_bf16_f32 v192, v160, v161
 v_cvt_pk_bf16_f32 v193, v162, v163
 s_waitcnt lgkmcnt(4)
 v_mfma_f32_32x32x16_bf16 v[144:159], v[188:191], v[124:127], v[144:159]
 ds_read_b64_tr_b16 v[184:185], v241 offset:32768
 ds_read_b64_tr_b16 v[186:187], v241 offset:33280
 v_cvt_pk_bf16_f32 v194, v164, v165
 v_cvt_pk_bf16_f32 v195, v166, v167
 s_waitcnt lgkmcnt(4)
 v_mfma_f32_32x32x16_bf16 v[144:159], v[176:179], v[128:131], v[144:159]
 ds_read_b64_tr_b16 v[188:189], v241 offset:34816
 ds_read_b64_tr_b16 v[190:191], v241 offset:35328
 buffer_store_dwordx4 v[192:195], v246, s[4:7], s56 offen offset:2048 sc1
 v_cvt_pk_bf16_f32 v196, v168, v169
 s_waitcnt lgkmcnt(4)
 v_mfma_f32_32x32x16_bf16 v[144:159], v[180:183], v[132:135], v[144:159]
 ds_read_b64_tr_b16 v[176:177], v242 offset:0
 ds_read_b64_tr_b16 v[178:179], v242 offset:512
 v_cvt_pk_bf16_f32 v197, v170, v171
 v_cvt_pk_bf16_f32 v198, v172, v173
 s_waitcnt lgkmcnt(4)
 v_mfma_f32_32x32x16_bf16 v[144:159], v[184:187], v[136:139], v[144:159]
 ds_read_b64_tr_b16 v[180:181], v242 offset:2048
 ds_read_b64_tr_b16 v[182:183], v242 offset:2560
 v_cvt_pk_bf16_f32 v199, v174, v175
 buffer_store_dwordx4 v[196:199], v246, s[4:7], s56 offen offset:3072 sc1
 s_waitcnt lgkmcnt(4)
 v_mfma_f32_32x32x16_bf16 v[144:159], v[188:191], v[140:143], v[144:159]
 ds_read_b64_tr_b16 v[184:185], v242 offset:4096
 ds_read_b64_tr_b16 v[186:187], v242 offset:4608
 s_waitcnt lgkmcnt(4)
 v_mfma_f32_32x32x16_bf16 v[160:175], v[176:179], v[0:3], 0
 ds_read_b64_tr_b16 v[188:189], v242 offset:6144
 ds_read_b64_tr_b16 v[190:191], v242 offset:6656
 s_waitcnt lgkmcnt(4)
 v_mfma_f32_32x32x16_bf16 v[160:175], v[180:183], v[4:7], v[160:175]
 ds_read_b64_tr_b16 v[176:177], v242 offset:8192
 ds_read_b64_tr_b16 v[178:179], v242 offset:8704
 s_waitcnt lgkmcnt(4)
 v_mfma_f32_32x32x16_bf16 v[160:175], v[184:187], v[8:11], v[160:175]
 ds_read_b64_tr_b16 v[180:181], v242 offset:10240
 ds_read_b64_tr_b16 v[182:183], v242 offset:10752
 s_waitcnt lgkmcnt(4)
 v_mfma_f32_32x32x16_bf16 v[160:175], v[188:191], v[12:15], v[160:175]
 ds_read_b64_tr_b16 v[184:185], v242 offset:12288
 ds_read_b64_tr_b16 v[186:187], v242 offset:12800
 s_waitcnt lgkmcnt(4)
 v_mfma_f32_32x32x16_bf16 v[160:175], v[176:179], v[16:19], v[160:175]
 ds_read_b64_tr_b16 v[188:189], v242 offset:14336
 ds_read_b64_tr_b16 v[190:191], v242 offset:14848
 v_cvt_pk_bf16_f32 v200, v144, v145
 v_cvt_pk_bf16_f32 v201, v146, v147
 s_waitcnt lgkmcnt(4)
 v_mfma_f32_32x32x16_bf16 v[160:175], v[180:183], v[20:23], v[160:175]
 ds_read_b64_tr_b16 v[176:177], v242 offset:16384
 ds_read_b64_tr_b16 v[178:179], v242 offset:16896
 v_cvt_pk_bf16_f32 v202, v148, v149
 v_cvt_pk_bf16_f32 v203, v150, v151
 s_waitcnt lgkmcnt(4)
 v_mfma_f32_32x32x16_bf16 v[160:175], v[184:187], v[24:27], v[160:175]
 ds_read_b64_tr_b16 v[180:181], v242 offset:18432
 ds_read_b64_tr_b16 v[182:183], v242 offset:18944
 buffer_store_dwordx4 v[200:203], v246, s[4:7], s55 offen offset:0 sc1
 v_cvt_pk_bf16_f32 v204, v152, v153
 s_waitcnt lgkmcnt(4)
 v_mfma_f32_32x32x16_bf16 v[160:175], v[188:191], v[28:31], v[160:175]
 ds_read_b64_tr_b16 v[184:185], v242 offset:20480
 ds_read_b64_tr_b16 v[186:187], v242 offset:20992
 v_cvt_pk_bf16_f32 v205, v154, v155
 v_cvt_pk_bf16_f32 v206, v156, v157
 s_waitcnt lgkmcnt(4)
 v_mfma_f32_32x32x16_bf16 v[160:175], v[176:179], v[32:35], v[160:175]
 ds_read_b64_tr_b16 v[188:189], v242 offset:22528
 ds_read_b64_tr_b16 v[190:191], v242 offset:23040
 v_cvt_pk_bf16_f32 v207, v158, v159
 buffer_store_dwordx4 v[204:207], v246, s[4:7], s55 offen offset:1024 sc1
 s_waitcnt lgkmcnt(4)
 v_mfma_f32_32x32x16_bf16 v[160:175], v[180:183], v[36:39], v[160:175]
 ds_read_b64_tr_b16 v[176:177], v242 offset:24576
 ds_read_b64_tr_b16 v[178:179], v242 offset:25088
 s_waitcnt lgkmcnt(4)
 v_mfma_f32_32x32x16_bf16 v[160:175], v[184:187], v[40:43], v[160:175]
 ds_read_b64_tr_b16 v[180:181], v242 offset:26624
 ds_read_b64_tr_b16 v[182:183], v242 offset:27136
 s_waitcnt lgkmcnt(4)
 v_mfma_f32_32x32x16_bf16 v[160:175], v[188:191], v[44:47], v[160:175]
 ds_read_b64_tr_b16 v[184:185], v242 offset:28672
 ds_read_b64_tr_b16 v[186:187], v242 offset:29184
 s_waitcnt lgkmcnt(4)
 v_mfma_f32_32x32x16_bf16 v[160:175], v[176:179], v[48:51], v[160:175]
 ds_read_b64_tr_b16 v[188:189], v242 offset:30720
 ds_read_b64_tr_b16 v[190:191], v242 offset:31232
 s_waitcnt lgkmcnt(4)
 v_mfma_f32_32x32x16_bf16 v[160:175], v[180:183], v[52:55], v[160:175]
 ds_read_b64_tr_b16 v[176:177], v242 offset:32768
 ds_read_b64_tr_b16 v[178:179], v242 offset:33280
 s_waitcnt lgkmcnt(4)
 v_mfma_f32_32x32x16_bf16 v[160:175], v[184:187], v[56:59], v[160:175]
 ds_read_b64_tr_b16 v[180:181], v242 offset:34816
 ds_read_b64_tr_b16 v[182:183], v242 offset:35328
 s_waitcnt lgkmcnt(4)
 v_mfma_f32_32x32x16_bf16 v[160:175], v[188:191], v[60:63], v[160:175]
 ds_read_b64_tr_b16 v[184:185], v243 offset:0
 ds_read_b64_tr_b16 v[186:187], v243 offset:512
 s_waitcnt lgkmcnt(4)
 v_mfma_f32_32x32x16_bf16 v[160:175], v[176:179], v[64:67], v[160:175]
 ds_read_b64_tr_b16 v[188:189], v243 offset:2048
 ds_read_b64_tr_b16 v[190:191], v243 offset:2560
 s_waitcnt lgkmcnt(4)
 v_mfma_f32_32x32x16_bf16 v[160:175], v[180:183], v[68:71], v[160:175]
 ds_read_b64_tr_b16 v[176:177], v243 offset:4096
 ds_read_b64_tr_b16 v[178:179], v243 offset:4608
 s_waitcnt lgkmcnt(4)
 v_mfma_f32_32x32x16_bf16 v[160:175], v[184:187], v[72:75], v[160:175]
 ds_read_b64_tr_b16 v[180:181], v243 offset:6144
 ds_read_b64_tr_b16 v[182:183], v243 offset:6656
 s_waitcnt lgkmcnt(4)
 v_mfma_f32_32x32x16_bf16 v[160:175], v[188:191], v[76:79], v[160:175]
 ds_read_b64_tr_b16 v[184:185], v243 offset:8192
 ds_read_b64_tr_b16 v[186:187], v243 offset:8704
 s_waitcnt lgkmcnt(4)
 v_mfma_f32_32x32x16_bf16 v[160:175], v[176:179], v[80:83], v[160:175]
 ds_read_b64_tr_b16 v[188:189], v243 offset:10240
 ds_read_b64_tr_b16 v[190:191], v243 offset:10752
 s_waitcnt lgkmcnt(4)
 v_mfma_f32_32x32x16_bf16 v[160:175], v[180:183], v[84:87], v[160:175]
 ds_read_b64_tr_b16 v[176:177], v243 offset:12288
 ds_read_b64_tr_b16 v[178:179], v243 offset:12800
 s_waitcnt lgkmcnt(4)
 v_mfma_f32_32x32x16_bf16 v[160:175], v[184:187], v[88:91], v[160:175]
 ds_read_b64_tr_b16 v[180:181], v243 offset:14336
 ds_read_b64_tr_b16 v[182:183], v243 offset:14848
 s_waitcnt lgkmcnt(4)
 v_mfma_f32_32x32x16_bf16 v[160:175], v[188:191], v[92:95], v[160:175]
 ds_read_b64_tr_b16 v[184:185], v243 offset:16384
 ds_read_b64_tr_b16 v[186:187], v243 offset:16896
 s_waitcnt lgkmcnt(4)
 v_mfma_f32_32x32x16_bf16 v[160:175], v[176:179], v[96:99], v[160:175]
 ds_read_b64_tr_b16 v[188:189], v243 offset:18432
 ds_read_b64_tr_b16 v[190:191], v243 offset:18944
 s_waitcnt lgkmcnt(4)
 v_mfma_f32_32x32x16_bf16 v[160:175], v[180:183], v[100:103], v[160:175]
 ds_read_b64_tr_b16 v[176:177], v243 offset:20480
 ds_read_b64_tr_b16 v[178:179], v243 offset:20992
 s_waitcnt lgkmcnt(4)
 v_mfma_f32_32x32x16_bf16 v[160:175], v[184:187], v[104:107], v[160:175]
 ds_read_b64_tr_b16 v[180:181], v243 offset:22528
 ds_read_b64_tr_b16 v[182:183], v243 offset:23040
 s_waitcnt lgkmcnt(4)
 v_mfma_f32_32x32x16_bf16 v[160:175], v[188:191], v[108:111], v[160:175]
 ds_read_b64_tr_b16 v[184:185], v243 offset:24576
 ds_read_b64_tr_b16 v[186:187], v243 offset:25088
 s_waitcnt lgkmcnt(4)
 v_mfma_f32_32x32x16_bf16 v[160:175], v[176:179], v[112:115], v[160:175]
 ds_read_b64_tr_b16 v[188:189], v243 offset:26624
 ds_read_b64_tr_b16 v[190:191], v243 offset:27136
 s_waitcnt lgkmcnt(4)
 v_mfma_f32_32x32x16_bf16 v[160:175], v[180:183], v[116:119], v[160:175]
 ds_read_b64_tr_b16 v[176:177], v243 offset:28672
 ds_read_b64_tr_b16 v[178:179], v243 offset:29184
 s_waitcnt lgkmcnt(4)
 v_mfma_f32_32x32x16_bf16 v[160:175], v[184:187], v[120:123], v[160:175]
 ds_read_b64_tr_b16 v[180:181], v243 offset:30720
 ds_read_b64_tr_b16 v[182:183], v243 offset:31232
 s_waitcnt lgkmcnt(4)
 v_mfma_f32_32x32x16_bf16 v[160:175], v[188:191], v[124:127], v[160:175]
 ds_read_b64_tr_b16 v[184:185], v243 offset:32768
 ds_read_b64_tr_b16 v[186:187], v243 offset:33280
 s_waitcnt lgkmcnt(4)
 v_mfma_f32_32x32x16_bf16 v[160:175], v[176:179], v[128:131], v[160:175]
 ds_read_b64_tr_b16 v[188:189], v243 offset:34816
 ds_read_b64_tr_b16 v[190:191], v243 offset:35328
 s_waitcnt lgkmcnt(4)
 v_mfma_f32_32x32x16_bf16 v[160:175], v[180:183], v[132:135], v[160:175]
 s_waitcnt lgkmcnt(2)
 v_mfma_f32_32x32x16_bf16 v[160:175], v[184:187], v[136:139], v[160:175]
 s_waitcnt lgkmcnt(0)
 v_mfma_f32_32x32x16_bf16 v[160:175], v[188:191], v[140:143], v[160:175]
 s_branch L_projj_275
L_projv_274:
 ds_read_b64_tr_b16 v[176:177], v240 offset:0
 ds_read_b64_tr_b16 v[178:179], v240 offset:512
 ds_read_b64_tr_b16 v[180:181], v240 offset:2048
 ds_read_b64_tr_b16 v[182:183], v240 offset:2560
 ds_read_b64_tr_b16 v[184:185], v240 offset:4096
 ds_read_b64_tr_b16 v[186:187], v240 offset:4608
 s_waitcnt lgkmcnt(4)
 v_mfma_f32_32x32x16_bf16 v[144:159], v[0:3], v[176:179], 0
 ds_read_b64_tr_b16 v[188:189], v240 offset:6144
 ds_read_b64_tr_b16 v[190:191], v240 offset:6656
 s_add_u32 m0, s57, 0
 s_nop 0
 buffer_load_dwordx4 v252, s[40:43], s54 offen  lds
 s_add_u32 s54, s54, s67
 s_waitcnt lgkmcnt(4)
 v_mfma_f32_32x32x16_bf16 v[144:159], v[4:7], v[180:183], v[144:159]
 ds_read_b64_tr_b16 v[176:177], v240 offset:8192
 ds_read_b64_tr_b16 v[178:179], v240 offset:8704
 s_add_u32 m0, s57, 4096
 s_nop 0
 buffer_load_dwordx4 v252, s[40:43], s54 offen  lds
 s_add_u32 s54, s54, s67
 s_waitcnt lgkmcnt(4)
 v_mfma_f32_32x32x16_bf16 v[144:159], v[8:11], v[184:187], v[144:159]
 ds_read_b64_tr_b16 v[180:181], v240 offset:10240
 ds_read_b64_tr_b16 v[182:183], v240 offset:10752
 s_add_u32 m0, s57, 8192
 s_nop 0
 buffer_load_dwordx4 v252, s[40:43], s54 offen  lds
 s_add_u32 s54, s54, s67
 s_waitcnt lgkmcnt(4)
 v_mfma_f32_32x32x16_bf16 v[144:159], v[12:15], v[188:191], v[144:159]
 ds_read_b64_tr_b16 v[184:185], v240 offset:12288
 ds_read_b64_tr_b16 v[186:187], v240 offset:12800
 s_add_u32 m0, s57, 12288
 s_nop 0
 buffer_load_dwordx4 v252, s[40:43], s54 offen  lds
 s_add_u32 s54, s54, s67
 s_waitcnt lgkmcnt(4)
 v_mfma_f32_32x32x16_bf16 v[144:159], v[16:19], v[176:179], v[144:159]
 ds_read_b64_tr_b16 v[188:189], v240 offset:14336
 ds_read_b64_tr_b16 v[190:191], v240 offset:14848
 s_add_u32 m0, s57, 16384
 s_nop 0
 buffer_load_dwordx4 v252, s[40:43], s54 offen  lds
 s_add_u32 s54, s54, s67
 s_waitcnt lgkmcnt(4)
 v_mfma_f32_32x32x16_bf16 v[144:159], v[20:23], v[180:183], v[144:159]
 ds_read_b64_tr_b16 v[176:177], v240 offset:16384
 ds_read_b64_tr_b16 v[178:179], v240 offset:16896
 s_add_u32 m0, s57, 20480
 s_nop 0
 buffer_load_dwordx4 v252, s[40:43], s54 offen  lds
 s_add_u32 s54, s54, s67
 s_waitcnt lgkmcnt(4)
 v_mfma_f32_32x32x16_bf16 v[144:159], v[24:27], v[184:187], v[144:159]
 ds_read_b64_tr_b16 v[180:181], v240 offset:18432
 ds_read_b64_tr_b16 v[182:183], v240 offset:18944
 s_add_u32 m0, s57, 24576
 s_nop 0
 buffer_load_dwordx4 v252, s[40:43], s54 offen  lds
 s_add_u32 s54, s54, s67
 s_waitcnt lgkmcnt(4)
 v_mfma_f32_32x32x16_bf16 v[144:159], v[28:31], v[188:191], v[144:159]
 ds_read_b64_tr_b16 v[184:185], v240 offset:20480
 ds_read_b64_tr_b16 v[186:187], v240 offset:20992
 s_add_u32 m0, s57, 28672
 s_nop 0
 buffer_load_dwordx4 v252, s[40:43], s54 offen  lds
 s_add_u32 s54, s54, s67
 s_waitcnt lgkmcnt(4)
 v_mfma_f32_32x32x16_bf16 v[144:159], v[32:35], v[176:179], v[144:159]
 ds_read_b64_tr_b16 v[188:189], v240 offset:22528
 ds_read_b64_tr_b16 v[190:191], v240 offset:23040
 s_add_u32 m0, s57, 32768
 s_nop 0
 buffer_load_dwordx4 v252, s[40:43], s54 offen  lds
 s_add_u32 s54, s54, s67
 s_waitcnt lgkmcnt(4)
 v_mfma_f32_32x32x16_bf16 v[144:159], v[36:39], v[180:183], v[144:159]
 ds_read_b64_tr_b16 v[176:177], v240 offset:24576
 ds_read_b64_tr_b16 v[178:179], v240 offset:25088
 s_add_u32 m0, s57, 36864
 s_nop 0
 buffer_load_dwordx4 v252, s[40:43], s54 offen  lds
 s_add_u32 s54, s54, s67
 s_waitcnt lgkmcnt(4)
 v_mfma_f32_32x32x16_bf16 v[144:159], v[40:43], v[184:187], v[144:159]
 ds_read_b64_tr_b16 v[180:181], v240 offset:26624
 ds_read_b64_tr_b16 v[182:183], v240 offset:27136
 s_add_u32 m0, s57, 40960
 s_nop 0
 buffer_load_dwordx4 v252, s[40:43], s54 offen  lds
 s_add_u32 s54, s54, s67
 s_waitcnt lgkmcnt(4)
 v_mfma_f32_32x32x16_bf16 v[144:159], v[44:47], v[188:191], v[144:159]
 ds_read_b64_tr_b16 v[184:185], v240 offset:28672
 ds_read_b64_tr_b16 v[186:187], v240 offset:29184
 s_add_u32 m0, s57, 45056
 s_nop 0
 buffer_load_dwordx4 v252, s[40:43], s54 offen  lds
 s_add_u32 s54, s54, s67
 s_waitcnt lgkmcnt(4)
 v_mfma_f32_32x32x16_bf16 v[144:159], v[48:51], v[176:179], v[144:159]
 ds_read_b64_tr_b16 v[188:189], v240 offset:30720
 ds_read_b64_tr_b16 v[190:191], v240 offset:31232
 s_add_u32 m0, s57, 49152
 s_nop 0
 buffer_load_dwordx4 v252, s[40:43], s54 offen  lds
 s_add_u32 s54, s54, s67
 s_waitcnt lgkmcnt(4)
 v_mfma_f32_32x32x16_bf16 v[144:159], v[52:55], v[180:183], v[144:159]
 ds_read_b64_tr_b16 v[176:177], v240 offset:32768
 ds_read_b64_tr_b16 v[178:179], v240 offset:33280
 s_add_u32 m0, s57, 53248
 s_nop 0
 buffer_load_dwordx4 v252, s[40:43], s54 offen  lds
 s_add_u32 s54, s54, s67
 s_waitcnt lgkmcnt(4)
 v_mfma_f32_32x32x16_bf16 v[144:159], v[56:59], v[184:187], v[144:159]
 ds_read_b64_tr_b16 v[180:181], v240 offset:34816
 ds_read_b64_tr_b16 v[182:183], v240 offset:35328
 s_add_u32 m0, s57, 57344
 s_nop 0
 buffer_load_dwordx4 v252, s[40:43], s54 offen  lds
 s_add_u32 s54, s54, s67
 s_waitcnt lgkmcnt(4)
 v_mfma_f32_32x32x16_bf16 v[144:159], v[60:63], v[188:191], v[144:159]
 ds_read_b64_tr_b16 v[184:185], v241 offset:0
 ds_read_b64_tr_b16 v[186:187], v241 offset:512
 s_add_u32 m0, s57, 61440
 s_nop 0
 buffer_load_dwordx4 v252, s[40:43], s54 offen  lds
 s_add_u32 s54, s54, s67
 s_waitcnt lgkmcnt(4)
 v_mfma_f32_32x32x16_bf16 v[144:159], v[64:67], v[176:179], v[144:159]
 ds_read_b64_tr_b16 v[188:189], v241 offset:2048
 ds_read_b64_tr_b16 v[190:191], v241 offset:2560
 s_add_u32 m0, s57, 65536
 s_nop 0
 buffer_load_dwordx4 v252, s[40:43], s54 offen  lds
 s_add_u32 s54, s54, s67
 s_waitcnt lgkmcnt(4)
 v_mfma_f32_32x32x16_bf16 v[144:159], v[68:71], v[180:183], v[144:159]
 ds_read_b64_tr_b16 v[176:177], v241 offset:4096
 ds_read_b64_tr_b16 v[178:179], v241 offset:4608
 s_add_u32 m0, s57, 69632
 s_nop 0
 buffer_load_dwordx4 v252, s[40:43], s54 offen  lds
 s_add_u32 s54, s54, s67
 s_waitcnt lgkmcnt(4)
 v_mfma_f32_32x32x16_bf16 v[144:159], v[72:75], v[184:187], v[144:159]
 ds_read_b64_tr_b16 v[180:181], v241 offset:6144
 ds_read_b64_tr_b16 v[182:183], v241 offset:6656
 s_waitcnt lgkmcnt(4)
 v_mfma_f32_32x32x16_bf16 v[144:159], v[76:79], v[188:191], v[144:159]
 ds_read_b64_tr_b16 v[184:185], v241 offset:8192
 ds_read_b64_tr_b16 v[186:187], v241 offset:8704
 s_waitcnt lgkmcnt(4)
 v_mfma_f32_32x32x16_bf16 v[144:159], v[80:83], v[176:179], v[144:159]
 ds_read_b64_tr_b16 v[188:189], v241 offset:10240
 ds_read_b64_tr_b16 v[190:191], v241 offset:10752
 s_waitcnt lgkmcnt(4)
 v_mfma_f32_32x32x16_bf16 v[144:159], v[84:87], v[180:183], v[144:159]
 ds_read_b64_tr_b16 v[176:177], v241 offset:12288
 ds_read_b64_tr_b16 v[178:179], v241 offset:12800
 s_waitcnt lgkmcnt(4)
 v_mfma_f32_32x32x16_bf16 v[144:159], v[88:91], v[184:187], v[144:159]
 ds_read_b64_tr_b16 v[180:181], v241 offset:14336
 ds_read_b64_tr_b16 v[182:183], v241 offset:14848
 s_waitcnt lgkmcnt(4)
 v_mfma_f32_32x32x16_bf16 v[144:159], v[92:95], v[188:191], v[144:159]
 ds_read_b64_tr_b16 v[184:185], v241 offset:16384
 ds_read_b64_tr_b16 v[186:187], v241 offset:16896
 s_waitcnt lgkmcnt(4)
 v_mfma_f32_32x32x16_bf16 v[144:159], v[96:99], v[176:179], v[144:159]
 ds_read_b64_tr_b16 v[188:189], v241 offset:18432
 ds_read_b64_tr_b16 v[190:191], v241 offset:18944
 s_waitcnt lgkmcnt(4)
 v_mfma_f32_32x32x16_bf16 v[144:159], v[100:103], v[180:183], v[144:159]
 ds_read_b64_tr_b16 v[176:177], v241 offset:20480
 ds_read_b64_tr_b16 v[178:179], v241 offset:20992
 s_waitcnt lgkmcnt(4)
 v_mfma_f32_32x32x16_bf16 v[144:159], v[104:107], v[184:187], v[144:159]
 ds_read_b64_tr_b16 v[180:181], v241 offset:22528
 ds_read_b64_tr_b16 v[182:183], v241 offset:23040
 s_waitcnt lgkmcnt(4)
 v_mfma_f32_32x32x16_bf16 v[144:159], v[108:111], v[188:191], v[144:159]
 ds_read_b64_tr_b16 v[184:185], v241 offset:24576
 ds_read_b64_tr_b16 v[186:187], v241 offset:25088
 s_waitcnt lgkmcnt(4)
 v_mfma_f32_32x32x16_bf16 v[144:159], v[112:115], v[176:179], v[144:159]
 ds_read_b64_tr_b16 v[188:189], v241 offset:26624
 ds_read_b64_tr_b16 v[190:191], v241 offset:27136
 s_waitcnt lgkmcnt(4)
 v_mfma_f32_32x32x16_bf16 v[144:159], v[116:119], v[180:183], v[144:159]
 ds_read_b64_tr_b16 v[176:177], v241 offset:28672
 ds_read_b64_tr_b16 v[178:179], v241 offset:29184
 s_waitcnt lgkmcnt(4)
 v_mfma_f32_32x32x16_bf16 v[144:159], v[120:123], v[184:187], v[144:159]
 ds_read_b64_tr_b16 v[180:181], v241 offset:30720
 ds_read_b64_tr_b16 v[182:183], v241 offset:31232
 v_cvt_pk_bf16_f32 v192, v160, v161
 v_cvt_pk_bf16_f32 v193, v162, v163
 s_waitcnt lgkmcnt(4)
 v_mfma_f32_32x32x16_bf16 v[144:159], v[124:127], v[188:191], v[144:159]
 ds_read_b64_tr_b16 v[184:185], v241 offset:32768
 ds_read_b64_tr_b16 v[186:187], v241 offset:33280
 v_cvt_pk_bf16_f32 v194, v164, v165
 v_cvt_pk_bf16_f32 v195, v166, v167
 s_waitcnt lgkmcnt(4)
 v_mfma_f32_32x32x16_bf16 v[144:159], v[128:131], v[176:179], v[144:159]
 ds_read_b64_tr_b16 v[188:189], v241 offset:34816
 ds_read_b64_tr_b16 v[190:191], v241 offset:35328
 buffer_store_dwordx4 v[192:195], v246, s[4:7], s56 offen offset:2048 sc1
 v_cvt_pk_bf16_f32 v196, v168, v169
 s_waitcnt lgkmcnt(4)
 v_mfma_f32_32x32x16_bf16 v[144:159], v[132:135], v[180:183], v[144:159]
 ds_read_b64_tr_b16 v[176:177], v242 offset:0
 ds_read_b64_tr_b16 v[178:179], v242 offset:512
 v_cvt_pk_bf16_f32 v197, v170, v171
 v_cvt_pk_bf16_f32 v198, v172, v173
 s_waitcnt lgkmcnt(4)
 v_mfma_f32_32x32x16_bf16 v[144:159], v[136:139], v[184:187], v[144:159]
 ds_read_b64_tr_b16 v[180:181], v242 offset:2048
 ds_read_b64_tr_b16 v[182:183], v242 offset:2560
 v_cvt_pk_bf16_f32 v199, v174, v175
 buffer_store_dwordx4 v[196:199], v246, s[4:7], s56 offen offset:3072 sc1
 s_waitcnt lgkmcnt(4)
 v_mfma_f32_32x32x16_bf16 v[144:159], v[140:143], v[188:191], v[144:159]
 ds_read_b64_tr_b16 v[184:185], v242 offset:4096
 ds_read_b64_tr_b16 v[186:187], v242 offset:4608
 s_waitcnt lgkmcnt(4)
 v_mfma_f32_32x32x16_bf16 v[160:175], v[0:3], v[176:179], 0
 ds_read_b64_tr_b16 v[188:189], v242 offset:6144
 ds_read_b64_tr_b16 v[190:191], v242 offset:6656
 s_waitcnt lgkmcnt(4)
 v_mfma_f32_32x32x16_bf16 v[160:175], v[4:7], v[180:183], v[160:175]
 ds_read_b64_tr_b16 v[176:177], v242 offset:8192
 ds_read_b64_tr_b16 v[178:179], v242 offset:8704
 s_waitcnt lgkmcnt(4)
 v_mfma_f32_32x32x16_bf16 v[160:175], v[8:11], v[184:187], v[160:175]
 ds_read_b64_tr_b16 v[180:181], v242 offset:10240
 ds_read_b64_tr_b16 v[182:183], v242 offset:10752
 s_waitcnt lgkmcnt(4)
 v_mfma_f32_32x32x16_bf16 v[160:175], v[12:15], v[188:191], v[160:175]
 ds_read_b64_tr_b16 v[184:185], v242 offset:12288
 ds_read_b64_tr_b16 v[186:187], v242 offset:12800
 s_waitcnt lgkmcnt(4)
 v_mfma_f32_32x32x16_bf16 v[160:175], v[16:19], v[176:179], v[160:175]
 ds_read_b64_tr_b16 v[188:189], v242 offset:14336
 ds_read_b64_tr_b16 v[190:191], v242 offset:14848
 v_cvt_pk_bf16_f32 v200, v144, v145
 v_cvt_pk_bf16_f32 v201, v146, v147
 s_waitcnt lgkmcnt(4)
 v_mfma_f32_32x32x16_bf16 v[160:175], v[20:23], v[180:183], v[160:175]
 ds_read_b64_tr_b16 v[176:177], v242 offset:16384
 ds_read_b64_tr_b16 v[178:179], v242 offset:16896
 v_cvt_pk_bf16_f32 v202, v148, v149
 v_cvt_pk_bf16_f32 v203, v150, v151
 s_waitcnt lgkmcnt(4)
 v_mfma_f32_32x32x16_bf16 v[160:175], v[24:27], v[184:187], v[160:175]
 ds_read_b64_tr_b16 v[180:181], v242 offset:18432
 ds_read_b64_tr_b16 v[182:183], v242 offset:18944
 buffer_store_dwordx4 v[200:203], v246, s[4:7], s55 offen offset:0 sc1
 v_cvt_pk_bf16_f32 v204, v152, v153
 s_waitcnt lgkmcnt(4)
 v_mfma_f32_32x32x16_bf16 v[160:175], v[28:31], v[188:191], v[160:175]
 ds_read_b64_tr_b16 v[184:185], v242 offset:20480
 ds_read_b64_tr_b16 v[186:187], v242 offset:20992
 v_cvt_pk_bf16_f32 v205, v154, v155
 v_cvt_pk_bf16_f32 v206, v156, v157
 s_waitcnt lgkmcnt(4)
 v_mfma_f32_32x32x16_bf16 v[160:175], v[32:35], v[176:179], v[160:175]
 ds_read_b64_tr_b16 v[188:189], v242 offset:22528
 ds_read_b64_tr_b16 v[190:191], v242 offset:23040
 v_cvt_pk_bf16_f32 v207, v158, v159
 buffer_store_dwordx4 v[204:207], v246, s[4:7], s55 offen offset:1024 sc1
 s_waitcnt lgkmcnt(4)
 v_mfma_f32_32x32x16_bf16 v[160:175], v[36:39], v[180:183], v[160:175]
 ds_read_b64_tr_b16 v[176:177], v242 offset:24576
 ds_read_b64_tr_b16 v[178:179], v242 offset:25088
 s_waitcnt lgkmcnt(4)
 v_mfma_f32_32x32x16_bf16 v[160:175], v[40:43], v[184:187], v[160:175]
 ds_read_b64_tr_b16 v[180:181], v242 offset:26624
 ds_read_b64_tr_b16 v[182:183], v242 offset:27136
 s_waitcnt lgkmcnt(4)
 v_mfma_f32_32x32x16_bf16 v[160:175], v[44:47], v[188:191], v[160:175]
 ds_read_b64_tr_b16 v[184:185], v242 offset:28672
 ds_read_b64_tr_b16 v[186:187], v242 offset:29184
 s_waitcnt lgkmcnt(4)
 v_mfma_f32_32x32x16_bf16 v[160:175], v[48:51], v[176:179], v[160:175]
 ds_read_b64_tr_b16 v[188:189], v242 offset:30720
 ds_read_b64_tr_b16 v[190:191], v242 offset:31232
 s_waitcnt lgkmcnt(4)
 v_mfma_f32_32x32x16_bf16 v[160:175], v[52:55], v[180:183], v[160:175]
 ds_read_b64_tr_b16 v[176:177], v242 offset:32768
 ds_read_b64_tr_b16 v[178:179], v242 offset:33280
 s_waitcnt lgkmcnt(4)
 v_mfma_f32_32x32x16_bf16 v[160:175], v[56:59], v[184:187], v[160:175]
 ds_read_b64_tr_b16 v[180:181], v242 offset:34816
 ds_read_b64_tr_b16 v[182:183], v242 offset:35328
 s_waitcnt lgkmcnt(4)
 v_mfma_f32_32x32x16_bf16 v[160:175], v[60:63], v[188:191], v[160:175]
 ds_read_b64_tr_b16 v[184:185], v243 offset:0
 ds_read_b64_tr_b16 v[186:187], v243 offset:512
 s_waitcnt lgkmcnt(4)
 v_mfma_f32_32x32x16_bf16 v[160:175], v[64:67], v[176:179], v[160:175]
 ds_read_b64_tr_b16 v[188:189], v243 offset:2048
 ds_read_b64_tr_b16 v[190:191], v243 offset:2560
 s_waitcnt lgkmcnt(4)
 v_mfma_f32_32x32x16_bf16 v[160:175], v[68:71], v[180:183], v[160:175]
 ds_read_b64_tr_b16 v[176:177], v243 offset:4096
 ds_read_b64_tr_b16 v[178:179], v243 offset:4608
 s_waitcnt lgkmcnt(4)
 v_mfma_f32_32x32x16_bf16 v[160:175], v[72:75], v[184:187], v[160:175]
 ds_read_b64_tr_b16 v[180:181], v243 offset:6144
 ds_read_b64_tr_b16 v[182:183], v243 offset:6656
 s_waitcnt lgkmcnt(4)
 v_mfma_f32_32x32x16_bf16 v[160:175], v[76:79], v[188:191], v[160:175]
 ds_read_b64_tr_b16 v[184:185], v243 offset:8192
 ds_read_b64_tr_b16 v[186:187], v243 offset:8704
 s_waitcnt lgkmcnt(4)
 v_mfma_f32_32x32x16_bf16 v[160:175], v[80:83], v[176:179], v[160:175]
 ds_read_b64_tr_b16 v[188:189], v243 offset:10240
 ds_read_b64_tr_b16 v[190:191], v243 offset:10752
 s_waitcnt lgkmcnt(4)
 v_mfma_f32_32x32x16_bf16 v[160:175], v[84:87], v[180:183], v[160:175]
 ds_read_b64_tr_b16 v[176:177], v243 offset:12288
 ds_read_b64_tr_b16 v[178:179], v243 offset:12800
 s_waitcnt lgkmcnt(4)
 v_mfma_f32_32x32x16_bf16 v[160:175], v[88:91], v[184:187], v[160:175]
 ds_read_b64_tr_b16 v[180:181], v243 offset:14336
 ds_read_b64_tr_b16 v[182:183], v243 offset:14848
 s_waitcnt lgkmcnt(4)
 v_mfma_f32_32x32x16_bf16 v[160:175], v[92:95], v[188:191], v[160:175]
 ds_read_b64_tr_b16 v[184:185], v243 offset:16384
 ds_read_b64_tr_b16 v[186:187], v243 offset:16896
 s_waitcnt lgkmcnt(4)
 v_mfma_f32_32x32x16_bf16 v[160:175], v[96:99], v[176:179], v[160:175]
 ds_read_b64_tr_b16 v[188:189], v243 offset:18432
 ds_read_b64_tr_b16 v[190:191], v243 offset:18944
 s_waitcnt lgkmcnt(4)
 v_mfma_f32_32x32x16_bf16 v[160:175], v[100:103], v[180:183], v[160:175]
 ds_read_b64_tr_b16 v[176:177], v243 offset:20480
 ds_read_b64_tr_b16 v[178:179], v243 offset:20992
 s_waitcnt lgkmcnt(4)
 v_mfma_f32_32x32x16_bf16 v[160:175], v[104:107], v[184:187], v[160:175]
 ds_read_b64_tr_b16 v[180:181], v243 offset:22528
 ds_read_b64_tr_b16 v[182:183], v243 offset:23040
 s_waitcnt lgkmcnt(4)
 v_mfma_f32_32x32x16_bf16 v[160:175], v[108:111], v[188:191], v[160:175]
 ds_read_b64_tr_b16 v[184:185], v243 offset:24576
 ds_read_b64_tr_b16 v[186:187], v243 offset:25088
 s_waitcnt lgkmcnt(4)
 v_mfma_f32_32x32x16_bf16 v[160:175], v[112:115], v[176:179], v[160:175]
 ds_read_b64_tr_b16 v[188:189], v243 offset:26624
 ds_read_b64_tr_b16 v[190:191], v243 offset:27136
 s_waitcnt lgkmcnt(4)
 v_mfma_f32_32x32x16_bf16 v[160:175], v[116:119], v[180:183], v[160:175]
 ds_read_b64_tr_b16 v[176:177], v243 offset:28672
 ds_read_b64_tr_b16 v[178:179], v243 offset:29184
 s_waitcnt lgkmcnt(4)
 v_mfma_f32_32x32x16_bf16 v[160:175], v[120:123], v[184:187], v[160:175]
 ds_read_b64_tr_b16 v[180:181], v243 offset:30720
 ds_read_b64_tr_b16 v[182:183], v243 offset:31232
 s_waitcnt lgkmcnt(4)
 v_mfma_f32_32x32x16_bf16 v[160:175], v[124:127], v[188:191], v[160:175]
 ds_read_b64_tr_b16 v[184:185], v243 offset:32768
 ds_read_b64_tr_b16 v[186:187], v243 offset:33280
 s_waitcnt lgkmcnt(4)
 v_mfma_f32_32x32x16_bf16 v[160:175], v[128:131], v[176:179], v[160:175]
 ds_read_b64_tr_b16 v[188:189], v243 offset:34816
 ds_read_b64_tr_b16 v[190:191], v243 offset:35328
 s_waitcnt lgkmcnt(4)
 v_mfma_f32_32x32x16_bf16 v[160:175], v[132:135], v[180:183], v[160:175]
 s_waitcnt lgkmcnt(2)
 v_mfma_f32_32x32x16_bf16 v[160:175], v[136:139], v[184:187], v[160:175]
 s_waitcnt lgkmcnt(0)
 v_mfma_f32_32x32x16_bf16 v[160:175], v[140:143], v[188:191], v[160:175]
L_projj_275:
 s_nop 7
 s_nop 3
 v_cvt_pk_bf16_f32 v192, v160, v161
 v_cvt_pk_bf16_f32 v193, v162, v163
 v_cvt_pk_bf16_f32 v194, v164, v165
 v_cvt_pk_bf16_f32 v195, v166, v167
 buffer_store_dwordx4 v[192:195], v246, s[4:7], s55 offen offset:2048 sc1
 v_cvt_pk_bf16_f32 v196, v168, v169
 v_cvt_pk_bf16_f32 v197, v170, v171
 v_cvt_pk_bf16_f32 v198, v172, v173
 v_cvt_pk_bf16_f32 v199, v174, v175
 buffer_store_dwordx4 v[196:199], v246, s[4:7], s55 offen offset:3072 sc1
 v_lshrrev_b32 v247, 2, v246
 s_mov_b32 s88, 0
L_cnt_276:
 global_load_dword v248, v247, s[44:45] sc1
 s_add_u32 s88, s88, 1
 s_cmp_gt_u32 s88, 100000
 s_cbranch_scc1 L_exit2
 s_waitcnt vmcnt(0)
 v_readlane_b32 s3, v248, 60
 s_cmp_lt_u32 s3, 32
 s_cbranch_scc1 L_cnt_276
 s_mov_b32 s3, 0
 v_readlane_b32 s80, v248, 0
 s_add_u32 s3, s3, s80
 v_readlane_b32 s81, v248, 1
 s_add_u32 s3, s3, s81
 v_readlane_b32 s82, v248, 18
 s_add_u32 s3, s3, s82
 v_readlane_b32 s83, v248, 19
 s_add_u32 s3, s3, s83
 v_readlane_b32 s84, v248, 36
 s_add_u32 s3, s3, s84
 v_readlane_b32 s85, v248, 37
 s_add_u32 s3, s3, s85
 v_readlane_b32 s86, v248, 54
 s_add_u32 s3, s3, s86
 v_readlane_b32 s87, v248, 55
 s_add_u32 s3, s3, s87
 s_cmp_lt_u32 s3, 256
 s_cbranch_scc1 L_cnt_276
 s_mov_b32 s49, 1
 s_cmp_eq_u32 s80, 32
 s_cselect_b32 s49, s49, 0
 s_cmp_eq_u32 s81, 32
 s_cselect_b32 s49, s49, 0
 s_cmp_eq_u32 s82, 32
 s_cselect_b32 s49, s49, 0
 s_cmp_eq_u32 s83, 32
 s_cselect_b32 s49, s49, 0
 s_cmp_eq_u32 s84, 32
 s_cselect_b32 s49, s49, 0
 s_cmp_eq_u32 s85, 32
 s_cselect_b32 s49, s49, 0
 s_cmp_eq_u32 s86, 32
 s_cselect_b32 s49, s49, 0
 s_cmp_eq_u32 s87, 32
 s_cselect_b32 s49, s49, 0
 s_barrier
 s_lshl_b32 s72, s70, 7
 s_add_u32 s72, s72, 65015808
 s_cmp_lg_u32 s46, 0
 s_cbranch_scc1 L_sig_277
 v_mov_b32 v247, 6
 v_mov_b32 v248, 0
 s_mov_b64 exec, 1
 buffer_atomic_add v247, v248, s[4:7], s72 offen
 s_mov_b64 exec, -1
L_sig_277:
 s_cmp_lt_u32 s50, 2
 s_cbranch_scc1 L_main_257
 v_bfe_u32 v247, v246, 4, 5
 s_lshl_b32 s3, s58, 5
 v_add_u32 v247, s3, v247
 v_mul_u32_u24 v247, 1152, v247
 v_bfe_u32 v248, v246, 9, 1
 v_lshl_add_u32 v247, v248, 4, v247
 buffer_load_dwordx4 v[0:3], v247, s[24:27], 0 offen offset:0
 buffer_load_dwordx4 v[4:7], v247, s[24:27], 0 offen offset:32
 buffer_load_dwordx4 v[8:11], v247, s[24:27], 0 offen offset:64
 buffer_load_dwordx4 v[12:15], v247, s[24:27], 0 offen offset:96
 buffer_load_dwordx4 v[16:19], v247, s[24:27], 0 offen offset:128
 buffer_load_dwordx4 v[20:23], v247, s[24:27], 0 offen offset:160
 buffer_load_dwordx4 v[24:27], v247, s[24:27], 0 offen offset:192
 buffer_load_dwordx4 v[28:31], v247, s[24:27], 0 offen offset:224
 buffer_load_dwordx4 v[32:35], v247, s[24:27], 0 offen offset:256
 buffer_load_dwordx4 v[36:39], v247, s[24:27], 0 offen offset:288
 buffer_load_dwordx4 v[40:43], v247, s[24:27], 0 offen offset:320
 buffer_load_dwordx4 v[44:47], v247, s[24:27], 0 offen offset:352
 buffer_load_dwordx4 v[48:51], v247, s[24:27], 0 offen offset:384
 buffer_load_dwordx4 v[52:55], v247, s[24:27], 0 offen offset:416
 buffer_load_dwordx4 v[56:59], v247, s[24:27], 0 offen offset:448
 buffer_load_dwordx4 v[60:63], v247, s[24:27], 0 offen offset:480
 buffer_load_dwordx4 v[64:67], v247, s[24:27], 0 offen offset:512
 buffer_load_dwordx4 v[68:71], v247, s[24:27], 0 offen offset:544
 buffer_load_dwordx4 v[72:75], v247, s[24:27], 0 offen offset:576
 buffer_load_dwordx4 v[76:79], v247, s[24:27], 0 offen offset:608
 buffer_load_dwordx4 v[80:83], v247, s[24:27], 0 offen offset:640
 buffer_load_dwordx4 v[84:87], v247, s[24:27], 0 offen offset:672
 buffer_load_dwordx4 v[88:91], v247, s[24:27], 0 offen offset:704
 buffer_load_dwordx4 v[92:95], v247, s[24:27], 0 offen offset:736
 buffer_load_dwordx4 v[96:99], v247, s[24:27], 0 offen offset:768
 buffer_load_dwordx4 v[100:103], v247, s[24:27], 0 offen offset:800
 buffer_load_dwordx4 v[104:107], v247, s[24:27], 0 offen offset:832
 buffer_load_dwordx4 v[108:111], v247, s[24:27], 0 offen offset:864
 buffer_load_dwordx4 v[112:115], v247, s[24:27], 0 offen offset:896
 buffer_load_dwordx4 v[116:119], v247, s[24:27], 0 offen offset:928
 buffer_load_dwordx4 v[120:123], v247, s[24:27], 0 offen offset:960
 buffer_load_dwordx4 v[124:127], v247, s[24:27], 0 offen offset:992
 buffer_load_dwordx4 v[128:131], v247, s[24:27], 0 offen offset:1024
 buffer_load_dwordx4 v[132:135], v247, s[24:27], 0 offen offset:1056
 buffer_load_dwordx4 v[136:139], v247, s[24:27], 0 offen offset:1088
 buffer_load_dwordx4 v[140:143], v247, s[24:27], 0 offen offset:1120
 v_mov_b32 v144, 0
 v_mov_b32 v145, 0
 v_mov_b32 v146, 0
 v_mov_b32 v147, 0
 v_mov_b32 v148, 0
 v_mov_b32 v149, 0
 v_mov_b32 v150, 0
 v_mov_b32 v151, 0
 v_mov_b32 v152, 0x3f803f80
 s_waitcnt vmcnt(32)
 v_dot2c_f32_bf16 v144, v0, v152
 v_dot2c_f32_bf16 v148, v0, v0
 v_dot2c_f32_bf16 v145, v1, v152
 v_dot2c_f32_bf16 v149, v1, v1
 v_dot2c_f32_bf16 v146, v2, v152
 v_dot2c_f32_bf16 v150, v2, v2
 v_dot2c_f32_bf16 v147, v3, v152
 v_dot2c_f32_bf16 v151, v3, v3
 v_dot2c_f32_bf16 v144, v4, v152
 v_dot2c_f32_bf16 v148, v4, v4
 v_dot2c_f32_bf16 v145, v5, v152
 v_dot2c_f32_bf16 v149, v5, v5
 v_dot2c_f32_bf16 v146, v6, v152
 v_dot2c_f32_bf16 v150, v6, v6
 v_dot2c_f32_bf16 v147, v7, v152
 v_dot2c_f32_bf16 v151, v7, v7
 v_dot2c_f32_bf16 v144, v8, v152
 v_dot2c_f32_bf16 v148, v8, v8
 v_dot2c_f32_bf16 v145, v9, v152
 v_dot2c_f32_bf16 v149, v9, v9
 v_dot2c_f32_bf16 v146, v10, v152
 v_dot2c_f32_bf16 v150, v10, v10
 v_dot2c_f32_bf16 v147, v11, v152
 v_dot2c_f32_bf16 v151, v11, v11
 v_dot2c_f32_bf16 v144, v12, v152
 v_dot2c_f32_bf16 v148, v12, v12
 v_dot2c_f32_bf16 v145, v13, v152
 v_dot2c_f32_bf16 v149, v13, v13
 v_dot2c_f32_bf16 v146, v14, v152
 v_dot2c_f32_bf16 v150, v14, v14
 v_dot2c_f32_bf16 v147, v15, v152
 v_dot2c_f32_bf16 v151, v15, v15
 s_waitcnt vmcnt(28)
 v_dot2c_f32_bf16 v144, v16, v152
 v_dot2c_f32_bf16 v148, v16, v16
 v_dot2c_f32_bf16 v145, v17, v152
 v_dot2c_f32_bf16 v149, v17, v17
 v_dot2c_f32_bf16 v146, v18, v152
 v_dot2c_f32_bf16 v150, v18, v18
 v_dot2c_f32_bf16 v147, v19, v152
 v_dot2c_f32_bf16 v151, v19, v19
 v_dot2c_f32_bf16 v144, v20, v152
 v_dot2c_f32_bf16 v148, v20, v20
 v_dot2c_f32_bf16 v145, v21, v152
 v_dot2c_f32_bf16 v149, v21, v21
 v_dot2c_f32_bf16 v146, v22, v152
 v_dot2c_f32_bf16 v150, v22, v22
 v_dot2c_f32_bf16 v147, v23, v152
 v_dot2c_f32_bf16 v151, v23, v23
 v_dot2c_f32_bf16 v144, v24, v152
 v_dot2c_f32_bf16 v148, v24, v24
 v_dot2c_f32_bf16 v145, v25, v152
 v_dot2c_f32_bf16 v149, v25, v25
 v_dot2c_f32_bf16 v146, v26, v152
 v_dot2c_f32_bf16 v150, v26, v26
 v_dot2c_f32_bf16 v147, v27, v152
 v_dot2c_f32_bf16 v151, v27, v27
 v_dot2c_f32_bf16 v144, v28, v152
 v_dot2c_f32_bf16 v148, v28, v28
 v_dot2c_f32_bf16 v145, v29, v152
 v_dot2c_f32_bf16 v149, v29, v29
 v_dot2c_f32_bf16 v146, v30, v152
 v_dot2c_f32_bf16 v150, v30, v30
 v_dot2c_f32_bf16 v147, v31, v152
 v_dot2c_f32_bf16 v151, v31, v31
 s_waitcnt vmcnt(24)
 v_dot2c_f32_bf16 v144, v32, v152
 v_dot2c_f32_bf16 v148, v32, v32
 v_dot2c_f32_bf16 v145, v33, v152
 v_dot2c_f32_bf16 v149, v33, v33
 v_dot2c_f32_bf16 v146, v34, v152
 v_dot2c_f32_bf16 v150, v34, v34
 v_dot2c_f32_bf16 v147, v35, v152
 v_dot2c_f32_bf16 v151, v35, v35
 v_dot2c_f32_bf16 v144, v36, v152
 v_dot2c_f32_bf16 v148, v36, v36
 v_dot2c_f32_bf16 v145, v37, v152
 v_dot2c_f32_bf16 v149, v37, v37
 v_dot2c_f32_bf16 v146, v38, v152
 v_dot2c_f32_bf16 v150, v38, v38
 v_dot2c_f32_bf16 v147, v39, v152
 v_dot2c_f32_bf16 v151, v39, v39
 v_dot2c_f32_bf16 v144, v40, v152
 v_dot2c_f32_bf16 v148, v40, v40
 v_dot2c_f32_bf16 v145, v41, v152
 v_dot2c_f32_bf16 v149, v41, v41
 v_dot2c_f32_bf16 v146, v42, v152
 v_dot2c_f32_bf16 v150, v42, v42
 v_dot2c_f32_bf16 v147, v43, v152
 v_dot2c_f32_bf16 v151, v43, v43
 v_dot2c_f32_bf16 v144, v44, v152
 v_dot2c_f32_bf16 v148, v44, v44
 v_dot2c_f32_bf16 v145, v45, v152
 v_dot2c_f32_bf16 v149, v45, v45
 v_dot2c_f32_bf16 v146, v46, v152
 v_dot2c_f32_bf16 v150, v46, v46
 v_dot2c_f32_bf16 v147, v47, v152
 v_dot2c_f32_bf16 v151, v47, v47
 s_waitcnt vmcnt(20)
 v_dot2c_f32_bf16 v144, v48, v152
 v_dot2c_f32_bf16 v148, v48, v48
 v_dot2c_f32_bf16 v145, v49, v152
 v_dot2c_f32_bf16 v149, v49, v49
 v_dot2c_f32_bf16 v146, v50, v152
 v_dot2c_f32_bf16 v150, v50, v50
 v_dot2c_f32_bf16 v147, v51, v152
 v_dot2c_f32_bf16 v151, v51, v51
 v_dot2c_f32_bf16 v144, v52, v152
 v_dot2c_f32_bf16 v148, v52, v52
 v_dot2c_f32_bf16 v145, v53, v152
 v_dot2c_f32_bf16 v149, v53, v53
 v_dot2c_f32_bf16 v146, v54, v152
 v_dot2c_f32_bf16 v150, v54, v54
 v_dot2c_f32_bf16 v147, v55, v152
 v_dot2c_f32_bf16 v151, v55, v55
 v_dot2c_f32_bf16 v144, v56, v152
 v_dot2c_f32_bf16 v148, v56, v56
 v_dot2c_f32_bf16 v145, v57, v152
 v_dot2c_f32_bf16 v149, v57, v57
 v_dot2c_f32_bf16 v146, v58, v152
 v_dot2c_f32_bf16 v150, v58, v58
 v_dot2c_f32_bf16 v147, v59, v152
 v_dot2c_f32_bf16 v151, v59, v59
 v_dot2c_f32_bf16 v144, v60, v152
 v_dot2c_f32_bf16 v148, v60, v60
 v_dot2c_f32_bf16 v145, v61, v152
 v_dot2c_f32_bf16 v149, v61, v61
 v_dot2c_f32_bf16 v146, v62, v152
 v_dot2c_f32_bf16 v150, v62, v62
 v_dot2c_f32_bf16 v147, v63, v152
 v_dot2c_f32_bf16 v151, v63, v63
 s_waitcnt vmcnt(16)
 v_dot2c_f32_bf16 v144, v64, v152
 v_dot2c_f32_bf16 v148, v64, v64
 v_dot2c_f32_bf16 v145, v65, v152
 v_dot2c_f32_bf16 v149, v65, v65
 v_dot2c_f32_bf16 v146, v66, v152
 v_dot2c_f32_bf16 v150, v66, v66
 v_dot2c_f32_bf16 v147, v67, v152
 v_dot2c_f32_bf16 v151, v67, v67
 v_dot2c_f32_bf16 v144, v68, v152
 v_dot2c_f32_bf16 v148, v68, v68
 v_dot2c_f32_bf16 v145, v69, v152
 v_dot2c_f32_bf16 v149, v69, v69
 v_dot2c_f32_bf16 v146, v70, v152
 v_dot2c_f32_bf16 v150, v70, v70
 v_dot2c_f32_bf16 v147, v71, v152
 v_dot2c_f32_bf16 v151, v71, v71
 v_dot2c_f32_bf16 v144, v72, v152
 v_dot2c_f32_bf16 v148, v72, v72
 v_dot2c_f32_bf16 v145, v73, v152
 v_dot2c_f32_bf16 v149, v73, v73
 v_dot2c_f32_bf16 v146, v74, v152
 v_dot2c_f32_bf16 v150, v74, v74
 v_dot2c_f32_bf16 v147, v75, v152
 v_dot2c_f32_bf16 v151, v75, v75
 v_dot2c_f32_bf16 v144, v76, v152
 v_dot2c_f32_bf16 v148, v76, v76
 v_dot2c_f32_bf16 v145, v77, v152
 v_dot2c_f32_bf16 v149, v77, v77
 v_dot2c_f32_bf16 v146, v78, v152
 v_dot2c_f32_bf16 v150, v78, v78
 v_dot2c_f32_bf16 v147, v79, v152
 v_dot2c_f32_bf16 v151, v79, v79
 s_waitcnt vmcnt(12)
 v_dot2c_f32_bf16 v144, v80, v152
 v_dot2c_f32_bf16 v148, v80, v80
 v_dot2c_f32_bf16 v145, v81, v152
 v_dot2c_f32_bf16 v149, v81, v81
 v_dot2c_f32_bf16 v146, v82, v152
 v_dot2c_f32_bf16 v150, v82, v82
 v_dot2c_f32_bf16 v147, v83, v152
 v_dot2c_f32_bf16 v151, v83, v83
 v_dot2c_f32_bf16 v144, v84, v152
 v_dot2c_f32_bf16 v148, v84, v84
 v_dot2c_f32_bf16 v145, v85, v152
 v_dot2c_f32_bf16 v149, v85, v85
 v_dot2c_f32_bf16 v146, v86, v152
 v_dot2c_f32_bf16 v150, v86, v86
 v_dot2c_f32_bf16 v147, v87, v152
 v_dot2c_f32_bf16 v151, v87, v87
 v_dot2c_f32_bf16 v144, v88, v152
 v_dot2c_f32_bf16 v148, v88, v88
 v_dot2c_f32_bf16 v145, v89, v152
 v_dot2c_f32_bf16 v149, v89, v89
 v_dot2c_f32_bf16 v146, v90, v152
 v_dot2c_f32_bf16 v150, v90, v90
 v_dot2c_f32_bf16 v147, v91, v152
 v_dot2c_f32_bf16 v151, v91, v91
 v_dot2c_f32_bf16 v144, v92, v152
 v_dot2c_f32_bf16 v148, v92, v92
 v_dot2c_f32_bf16 v145, v93, v152
 v_dot2c_f32_bf16 v149, v93, v93
 v_dot2c_f32_bf16 v146, v94, v152
 v_dot2c_f32_bf16 v150, v94, v94
 v_dot2c_f32_bf16 v147, v95, v152
 v_dot2c_f32_bf16 v151, v95, v95
 s_waitcnt vmcnt(8)
 v_dot2c_f32_bf16 v144, v96, v152
 v_dot2c_f32_bf16 v148, v96, v96
 v_dot2c_f32_bf16 v145, v97, v152
 v_dot2c_f32_bf16 v149, v97, v97
 v_dot2c_f32_bf16 v146, v98, v152
 v_dot2c_f32_bf16 v150, v98, v98
 v_dot2c_f32_bf16 v147, v99, v152
 v_dot2c_f32_bf16 v151, v99, v99
 v_dot2c_f32_bf16 v144, v100, v152
 v_dot2c_f32_bf16 v148, v100, v100
 v_dot2c_f32_bf16 v145, v101, v152
 v_dot2c_f32_bf16 v149, v101, v101
 v_dot2c_f32_bf16 v146, v102, v152
 v_dot2c_f32_bf16 v150, v102, v102
 v_dot2c_f32_bf16 v147, v103, v152
 v_dot2c_f32_bf16 v151, v103, v103
 v_dot2c_f32_bf16 v144, v104, v152
 v_dot2c_f32_bf16 v148, v104, v104
 v_dot2c_f32_bf16 v145, v105, v152
 v_dot2c_f32_bf16 v149, v105, v105
 v_dot2c_f32_bf16 v146, v106, v152
 v_dot2c_f32_bf16 v150, v106, v106
 v_dot2c_f32_bf16 v147, v107, v152
 v_dot2c_f32_bf16 v151, v107, v107
 v_dot2c_f32_bf16 v144, v108, v152
 v_dot2c_f32_bf16 v148, v108, v108
 v_dot2c_f32_bf16 v145, v109, v152
 v_dot2c_f32_bf16 v149, v109, v109
 v_dot2c_f32_bf16 v146, v110, v152
 v_dot2c_f32_bf16 v150, v110, v110
 v_dot2c_f32_bf16 v147, v111, v152
 v_dot2c_f32_bf16 v151, v111, v111
 s_waitcnt vmcnt(4)
 v_dot2c_f32_bf16 v144, v112, v152
 v_dot2c_f32_bf16 v148, v112, v112
 v_dot2c_f32_bf16 v145, v113, v152
 v_dot2c_f32_bf16 v149, v113, v113
 v_dot2c_f32_bf16 v146, v114, v152
 v_dot2c_f32_bf16 v150, v114, v114
 v_dot2c_f32_bf16 v147, v115, v152
 v_dot2c_f32_bf16 v151, v115, v115
 v_dot2c_f32_bf16 v144, v116, v152
 v_dot2c_f32_bf16 v148, v116, v116
 v_dot2c_f32_bf16 v145, v117, v152
 v_dot2c_f32_bf16 v149, v117, v117
 v_dot2c_f32_bf16 v146, v118, v152
 v_dot2c_f32_bf16 v150, v118, v118
 v_dot2c_f32_bf16 v147, v119, v152
 v_dot2c_f32_bf16 v151, v119, v119
 v_dot2c_f32_bf16 v144, v120, v152
 v_dot2c_f32_bf16 v148, v120, v120
 v_dot2c_f32_bf16 v145, v121, v152
 v_dot2c_f32_bf16 v149, v121, v121
 v_dot2c_f32_bf16 v146, v122, v152
 v_dot2c_f32_bf16 v150, v122, v122
 v_dot2c_f32_bf16 v147, v123, v152
 v_dot2c_f32_bf16 v151, v123, v123
 v_dot2c_f32_bf16 v144, v124, v152
 v_dot2c_f32_bf16 v148, v124, v124
 v_dot2c_f32_bf16 v145, v125, v152
 v_dot2c_f32_bf16 v149, v125, v125
 v_dot2c_f32_bf16 v146, v126, v152
 v_dot2c_f32_bf16 v150, v126, v126
 v_dot2c_f32_bf16 v147, v127, v152
 v_dot2c_f32_bf16 v151, v127, v127
 s_waitcnt vmcnt(0)
 v_dot2c_f32_bf16 v144, v128, v152
 v_dot2c_f32_bf16 v148, v128, v128
 v_dot2c_f32_bf16 v145, v129, v152
 v_dot2c_f32_bf16 v149, v129, v129
 v_dot2c_f32_bf16 v146, v130, v152
 v_dot2c_f32_bf16 v150, v130, v130
 v_dot2c_f32_bf16 v147, v131, v152
 v_dot2c_f32_bf16 v151, v131, v131
 v_dot2c_f32_bf16 v144, v132, v152
 v_dot2c_f32_bf16 v148, v132, v132
 v_dot2c_f32_bf16 v145, v133, v152
 v_dot2c_f32_bf16 v149, v133, v133
 v_dot2c_f32_bf16 v146, v134, v152
 v_dot2c_f32_bf16 v150, v134, v134
 v_dot2c_f32_bf16 v147, v135, v152
 v_dot2c_f32_bf16 v151, v135, v135
 v_dot2c_f32_bf16 v144, v136, v152
 v_dot2c_f32_bf16 v148, v136, v136
 v_dot2c_f32_bf16 v145, v137, v152
 v_dot2c_f32_bf16 v149, v137, v137
 v_dot2c_f32_bf16 v146, v138, v152
 v_dot2c_f32_bf16 v150, v138, v138
 v_dot2c_f32_bf16 v147, v139, v152
 v_dot2c_f32_bf16 v151, v139, v139
 v_dot2c_f32_bf16 v144, v140, v152
 v_dot2c_f32_bf16 v148, v140, v140
 v_dot2c_f32_bf16 v145, v141, v152
 v_dot2c_f32_bf16 v149, v141, v141
 v_dot2c_f32_bf16 v146, v142, v152
 v_dot2c_f32_bf16 v150, v142, v142
 v_dot2c_f32_bf16 v147, v143, v152
 v_dot2c_f32_bf16 v151, v143, v143
 s_nop 2
 v_add_f32 v144, v144, v145
 v_add_f32 v146, v146, v147
 v_add_f32 v144, v144, v146
 v_mov_b32 v145, v144
 v_add_f32 v148, v148, v149
 v_add_f32 v150, v150, v151
 v_add_f32 v148, v148, v150
 v_mov_b32 v149, v148
 s_nop 1
 v_permlane32_swap_b32 v144, v145
 v_permlane32_swap_b32 v148, v149
 v_add_f32 v144, v144, v145
 v_add_f32 v148, v148, v149
 v_mul_f32 v144, 0x3ae38e39, v144
 v_mul_f32 v148, 0x3ae38e39, v148
 v_fma_f32 v148, -v144, v144, v148
 v_max_f32 v148, 0, v148
 v_cvt_pk_bf16_f32 v145, v148, v144
 v_lshlrev_b32 v148, 16, v145
 v_and_b32 v144, 0xffff0000, v145
 v_add_f32 v148, 0x3727c5ac, v148
 v_cvt_pk_bf16_f32 v148, v148, v148
 v_lshlrev_b32 v148, 16, v148
 v_sqrt_f32 v148, v148
 s_nop 0
 v_cvt_pk_bf16_f32 v148, v148, v148
 v_lshlrev_b32 v148, 16, v148
 v_rcp_f32 v148, v148
 s_nop 0
 v_mul_f32 v144, v144, v148
 s_mov_b32 s78, 0xffff0000
 v_lshlrev_b32 v160, 16, v0
 v_and_b32 v161, s78, v0
 v_pk_fma_f32 v[160:161], v[160:161], v[148:149], v[144:145] op_sel_hi:[1,0,0] neg_lo:[0,0,1] neg_hi:[0,0,1]
 v_cvt_pk_bf16_f32 v0, v160, v161
 v_lshlrev_b32 v162, 16, v1
 v_and_b32 v163, s78, v1
 v_pk_fma_f32 v[162:163], v[162:163], v[148:149], v[144:145] op_sel_hi:[1,0,0] neg_lo:[0,0,1] neg_hi:[0,0,1]
 v_cvt_pk_bf16_f32 v1, v162, v163
 v_lshlrev_b32 v164, 16, v2
 v_and_b32 v165, s78, v2
 v_pk_fma_f32 v[164:165], v[164:165], v[148:149], v[144:145] op_sel_hi:[1,0,0] neg_lo:[0,0,1] neg_hi:[0,0,1]
 v_cvt_pk_bf16_f32 v2, v164, v165
 v_lshlrev_b32 v166, 16, v3
 v_and_b32 v167, s78, v3
 v_pk_fma_f32 v[166:167], v[166:167], v[148:149], v[144:145] op_sel_hi:[1,0,0] neg_lo:[0,0,1] neg_hi:[0,0,1]
 v_cvt_pk_bf16_f32 v3, v166, v167
 v_lshlrev_b32 v160, 16, v4
 v_and_b32 v161, s78, v4
 v_pk_fma_f32 v[160:161], v[160:161], v[148:149], v[144:145] op_sel_hi:[1,0,0] neg_lo:[0,0,1] neg_hi:[0,0,1]
 v_cvt_pk_bf16_f32 v4, v160, v161
 v_lshlrev_b32 v162, 16, v5
 v_and_b32 v163, s78, v5
 v_pk_fma_f32 v[162:163], v[162:163], v[148:149], v[144:145] op_sel_hi:[1,0,0] neg_lo:[0,0,1] neg_hi:[0,0,1]
 v_cvt_pk_bf16_f32 v5, v162, v163
 v_lshlrev_b32 v164, 16, v6
 v_and_b32 v165, s78, v6
 v_pk_fma_f32 v[164:165], v[164:165], v[148:149], v[144:145] op_sel_hi:[1,0,0] neg_lo:[0,0,1] neg_hi:[0,0,1]
 v_cvt_pk_bf16_f32 v6, v164, v165
 v_lshlrev_b32 v166, 16, v7
 v_and_b32 v167, s78, v7
 v_pk_fma_f32 v[166:167], v[166:167], v[148:149], v[144:145] op_sel_hi:[1,0,0] neg_lo:[0,0,1] neg_hi:[0,0,1]
 v_cvt_pk_bf16_f32 v7, v166, v167
 v_lshlrev_b32 v160, 16, v8
 v_and_b32 v161, s78, v8
 v_pk_fma_f32 v[160:161], v[160:161], v[148:149], v[144:145] op_sel_hi:[1,0,0] neg_lo:[0,0,1] neg_hi:[0,0,1]
 v_cvt_pk_bf16_f32 v8, v160, v161
 v_lshlrev_b32 v162, 16, v9
 v_and_b32 v163, s78, v9
 v_pk_fma_f32 v[162:163], v[162:163], v[148:149], v[144:145] op_sel_hi:[1,0,0] neg_lo:[0,0,1] neg_hi:[0,0,1]
 v_cvt_pk_bf16_f32 v9, v162, v163
 v_lshlrev_b32 v164, 16, v10
 v_and_b32 v165, s78, v10
 v_pk_fma_f32 v[164:165], v[164:165], v[148:149], v[144:145] op_sel_hi:[1,0,0] neg_lo:[0,0,1] neg_hi:[0,0,1]
 v_cvt_pk_bf16_f32 v10, v164, v165
 v_lshlrev_b32 v166, 16, v11
 v_and_b32 v167, s78, v11
 v_pk_fma_f32 v[166:167], v[166:167], v[148:149], v[144:145] op_sel_hi:[1,0,0] neg_lo:[0,0,1] neg_hi:[0,0,1]
 v_cvt_pk_bf16_f32 v11, v166, v167
 v_lshlrev_b32 v160, 16, v12
 v_and_b32 v161, s78, v12
 v_pk_fma_f32 v[160:161], v[160:161], v[148:149], v[144:145] op_sel_hi:[1,0,0] neg_lo:[0,0,1] neg_hi:[0,0,1]
 v_cvt_pk_bf16_f32 v12, v160, v161
 v_lshlrev_b32 v162, 16, v13
 v_and_b32 v163, s78, v13
 v_pk_fma_f32 v[162:163], v[162:163], v[148:149], v[144:145] op_sel_hi:[1,0,0] neg_lo:[0,0,1] neg_hi:[0,0,1]
 v_cvt_pk_bf16_f32 v13, v162, v163
 v_lshlrev_b32 v164, 16, v14
 v_and_b32 v165, s78, v14
 v_pk_fma_f32 v[164:165], v[164:165], v[148:149], v[144:145] op_sel_hi:[1,0,0] neg_lo:[0,0,1] neg_hi:[0,0,1]
 v_cvt_pk_bf16_f32 v14, v164, v165
 v_lshlrev_b32 v166, 16, v15
 v_and_b32 v167, s78, v15
 v_pk_fma_f32 v[166:167], v[166:167], v[148:149], v[144:145] op_sel_hi:[1,0,0] neg_lo:[0,0,1] neg_hi:[0,0,1]
 v_cvt_pk_bf16_f32 v15, v166, v167
 v_lshlrev_b32 v160, 16, v16
 v_and_b32 v161, s78, v16
 v_pk_fma_f32 v[160:161], v[160:161], v[148:149], v[144:145] op_sel_hi:[1,0,0] neg_lo:[0,0,1] neg_hi:[0,0,1]
 v_cvt_pk_bf16_f32 v16, v160, v161
 v_lshlrev_b32 v162, 16, v17
 v_and_b32 v163, s78, v17
 v_pk_fma_f32 v[162:163], v[162:163], v[148:149], v[144:145] op_sel_hi:[1,0,0] neg_lo:[0,0,1] neg_hi:[0,0,1]
 v_cvt_pk_bf16_f32 v17, v162, v163
 v_lshlrev_b32 v164, 16, v18
 v_and_b32 v165, s78, v18
 v_pk_fma_f32 v[164:165], v[164:165], v[148:149], v[144:145] op_sel_hi:[1,0,0] neg_lo:[0,0,1] neg_hi:[0,0,1]
 v_cvt_pk_bf16_f32 v18, v164, v165
 v_lshlrev_b32 v166, 16, v19
 v_and_b32 v167, s78, v19
 v_pk_fma_f32 v[166:167], v[166:167], v[148:149], v[144:145] op_sel_hi:[1,0,0] neg_lo:[0,0,1] neg_hi:[0,0,1]
 v_cvt_pk_bf16_f32 v19, v166, v167
 v_lshlrev_b32 v160, 16, v20
 v_and_b32 v161, s78, v20
 v_pk_fma_f32 v[160:161], v[160:161], v[148:149], v[144:145] op_sel_hi:[1,0,0] neg_lo:[0,0,1] neg_hi:[0,0,1]
 v_cvt_pk_bf16_f32 v20, v160, v161
 v_lshlrev_b32 v162, 16, v21
 v_and_b32 v163, s78, v21
 v_pk_fma_f32 v[162:163], v[162:163], v[148:149], v[144:145] op_sel_hi:[1,0,0] neg_lo:[0,0,1] neg_hi:[0,0,1]
 v_cvt_pk_bf16_f32 v21, v162, v163
 v_lshlrev_b32 v164, 16, v22
 v_and_b32 v165, s78, v22
 v_pk_fma_f32 v[164:165], v[164:165], v[148:149], v[144:145] op_sel_hi:[1,0,0] neg_lo:[0,0,1] neg_hi:[0,0,1]
 v_cvt_pk_bf16_f32 v22, v164, v165
 v_lshlrev_b32 v166, 16, v23
 v_and_b32 v167, s78, v23
 v_pk_fma_f32 v[166:167], v[166:167], v[148:149], v[144:145] op_sel_hi:[1,0,0] neg_lo:[0,0,1] neg_hi:[0,0,1]
 v_cvt_pk_bf16_f32 v23, v166, v167
 v_lshlrev_b32 v160, 16, v24
 v_and_b32 v161, s78, v24
 v_pk_fma_f32 v[160:161], v[160:161], v[148:149], v[144:145] op_sel_hi:[1,0,0] neg_lo:[0,0,1] neg_hi:[0,0,1]
 v_cvt_pk_bf16_f32 v24, v160, v161
 v_lshlrev_b32 v162, 16, v25
 v_and_b32 v163, s78, v25
 v_pk_fma_f32 v[162:163], v[162:163], v[148:149], v[144:145] op_sel_hi:[1,0,0] neg_lo:[0,0,1] neg_hi:[0,0,1]
 v_cvt_pk_bf16_f32 v25, v162, v163
 v_lshlrev_b32 v164, 16, v26
 v_and_b32 v165, s78, v26
 v_pk_fma_f32 v[164:165], v[164:165], v[148:149], v[144:145] op_sel_hi:[1,0,0] neg_lo:[0,0,1] neg_hi:[0,0,1]
 v_cvt_pk_bf16_f32 v26, v164, v165
 v_lshlrev_b32 v166, 16, v27
 v_and_b32 v167, s78, v27
 v_pk_fma_f32 v[166:167], v[166:167], v[148:149], v[144:145] op_sel_hi:[1,0,0] neg_lo:[0,0,1] neg_hi:[0,0,1]
 v_cvt_pk_bf16_f32 v27, v166, v167
 v_lshlrev_b32 v160, 16, v28
 v_and_b32 v161, s78, v28
 v_pk_fma_f32 v[160:161], v[160:161], v[148:149], v[144:145] op_sel_hi:[1,0,0] neg_lo:[0,0,1] neg_hi:[0,0,1]
 v_cvt_pk_bf16_f32 v28, v160, v161
 v_lshlrev_b32 v162, 16, v29
 v_and_b32 v163, s78, v29
 v_pk_fma_f32 v[162:163], v[162:163], v[148:149], v[144:145] op_sel_hi:[1,0,0] neg_lo:[0,0,1] neg_hi:[0,0,1]
 v_cvt_pk_bf16_f32 v29, v162, v163
 v_lshlrev_b32 v164, 16, v30
 v_and_b32 v165, s78, v30
 v_pk_fma_f32 v[164:165], v[164:165], v[148:149], v[144:145] op_sel_hi:[1,0,0] neg_lo:[0,0,1] neg_hi:[0,0,1]
 v_cvt_pk_bf16_f32 v30, v164, v165
 v_lshlrev_b32 v166, 16, v31
 v_and_b32 v167, s78, v31
 v_pk_fma_f32 v[166:167], v[166:167], v[148:149], v[144:145] op_sel_hi:[1,0,0] neg_lo:[0,0,1] neg_hi:[0,0,1]
 v_cvt_pk_bf16_f32 v31, v166, v167
 v_lshlrev_b32 v160, 16, v32
 v_and_b32 v161, s78, v32
 v_pk_fma_f32 v[160:161], v[160:161], v[148:149], v[144:145] op_sel_hi:[1,0,0] neg_lo:[0,0,1] neg_hi:[0,0,1]
 v_cvt_pk_bf16_f32 v32, v160, v161
 v_lshlrev_b32 v162, 16, v33
 v_and_b32 v163, s78, v33
 v_pk_fma_f32 v[162:163], v[162:163], v[148:149], v[144:145] op_sel_hi:[1,0,0] neg_lo:[0,0,1] neg_hi:[0,0,1]
 v_cvt_pk_bf16_f32 v33, v162, v163
 v_lshlrev_b32 v164, 16, v34
 v_and_b32 v165, s78, v34
 v_pk_fma_f32 v[164:165], v[164:165], v[148:149], v[144:145] op_sel_hi:[1,0,0] neg_lo:[0,0,1] neg_hi:[0,0,1]
 v_cvt_pk_bf16_f32 v34, v164, v165
 v_lshlrev_b32 v166, 16, v35
 v_and_b32 v167, s78, v35
 v_pk_fma_f32 v[166:167], v[166:167], v[148:149], v[144:145] op_sel_hi:[1,0,0] neg_lo:[0,0,1] neg_hi:[0,0,1]
 v_cvt_pk_bf16_f32 v35, v166, v167
 v_lshlrev_b32 v160, 16, v36
 v_and_b32 v161, s78, v36
 v_pk_fma_f32 v[160:161], v[160:161], v[148:149], v[144:145] op_sel_hi:[1,0,0] neg_lo:[0,0,1] neg_hi:[0,0,1]
 v_cvt_pk_bf16_f32 v36, v160, v161
 v_lshlrev_b32 v162, 16, v37
 v_and_b32 v163, s78, v37
 v_pk_fma_f32 v[162:163], v[162:163], v[148:149], v[144:145] op_sel_hi:[1,0,0] neg_lo:[0,0,1] neg_hi:[0,0,1]
 v_cvt_pk_bf16_f32 v37, v162, v163
 v_lshlrev_b32 v164, 16, v38
 v_and_b32 v165, s78, v38
 v_pk_fma_f32 v[164:165], v[164:165], v[148:149], v[144:145] op_sel_hi:[1,0,0] neg_lo:[0,0,1] neg_hi:[0,0,1]
 v_cvt_pk_bf16_f32 v38, v164, v165
 v_lshlrev_b32 v166, 16, v39
 v_and_b32 v167, s78, v39
 v_pk_fma_f32 v[166:167], v[166:167], v[148:149], v[144:145] op_sel_hi:[1,0,0] neg_lo:[0,0,1] neg_hi:[0,0,1]
 v_cvt_pk_bf16_f32 v39, v166, v167
 v_lshlrev_b32 v160, 16, v40
 v_and_b32 v161, s78, v40
 v_pk_fma_f32 v[160:161], v[160:161], v[148:149], v[144:145] op_sel_hi:[1,0,0] neg_lo:[0,0,1] neg_hi:[0,0,1]
 v_cvt_pk_bf16_f32 v40, v160, v161
 v_lshlrev_b32 v162, 16, v41
 v_and_b32 v163, s78, v41
 v_pk_fma_f32 v[162:163], v[162:163], v[148:149], v[144:145] op_sel_hi:[1,0,0] neg_lo:[0,0,1] neg_hi:[0,0,1]
 v_cvt_pk_bf16_f32 v41, v162, v163
 v_lshlrev_b32 v164, 16, v42
 v_and_b32 v165, s78, v42
 v_pk_fma_f32 v[164:165], v[164:165], v[148:149], v[144:145] op_sel_hi:[1,0,0] neg_lo:[0,0,1] neg_hi:[0,0,1]
 v_cvt_pk_bf16_f32 v42, v164, v165
 v_lshlrev_b32 v166, 16, v43
 v_and_b32 v167, s78, v43
 v_pk_fma_f32 v[166:167], v[166:167], v[148:149], v[144:145] op_sel_hi:[1,0,0] neg_lo:[0,0,1] neg_hi:[0,0,1]
 v_cvt_pk_bf16_f32 v43, v166, v167
 v_lshlrev_b32 v160, 16, v44
 v_and_b32 v161, s78, v44
 v_pk_fma_f32 v[160:161], v[160:161], v[148:149], v[144:145] op_sel_hi:[1,0,0] neg_lo:[0,0,1] neg_hi:[0,0,1]
 v_cvt_pk_bf16_f32 v44, v160, v161
 v_lshlrev_b32 v162, 16, v45
 v_and_b32 v163, s78, v45
 v_pk_fma_f32 v[162:163], v[162:163], v[148:149], v[144:145] op_sel_hi:[1,0,0] neg_lo:[0,0,1] neg_hi:[0,0,1]
 v_cvt_pk_bf16_f32 v45, v162, v163
 v_lshlrev_b32 v164, 16, v46
 v_and_b32 v165, s78, v46
 v_pk_fma_f32 v[164:165], v[164:165], v[148:149], v[144:145] op_sel_hi:[1,0,0] neg_lo:[0,0,1] neg_hi:[0,0,1]
 v_cvt_pk_bf16_f32 v46, v164, v165
 v_lshlrev_b32 v166, 16, v47
 v_and_b32 v167, s78, v47
 v_pk_fma_f32 v[166:167], v[166:167], v[148:149], v[144:145] op_sel_hi:[1,0,0] neg_lo:[0,0,1] neg_hi:[0,0,1]
 v_cvt_pk_bf16_f32 v47, v166, v167
 v_lshlrev_b32 v160, 16, v48
 v_and_b32 v161, s78, v48
 v_pk_fma_f32 v[160:161], v[160:161], v[148:149], v[144:145] op_sel_hi:[1,0,0] neg_lo:[0,0,1] neg_hi:[0,0,1]
 v_cvt_pk_bf16_f32 v48, v160, v161
 v_lshlrev_b32 v162, 16, v49
 v_and_b32 v163, s78, v49
 v_pk_fma_f32 v[162:163], v[162:163], v[148:149], v[144:145] op_sel_hi:[1,0,0] neg_lo:[0,0,1] neg_hi:[0,0,1]
 v_cvt_pk_bf16_f32 v49, v162, v163
 v_lshlrev_b32 v164, 16, v50
 v_and_b32 v165, s78, v50
 v_pk_fma_f32 v[164:165], v[164:165], v[148:149], v[144:145] op_sel_hi:[1,0,0] neg_lo:[0,0,1] neg_hi:[0,0,1]
 v_cvt_pk_bf16_f32 v50, v164, v165
 v_lshlrev_b32 v166, 16, v51
 v_and_b32 v167, s78, v51
 v_pk_fma_f32 v[166:167], v[166:167], v[148:149], v[144:145] op_sel_hi:[1,0,0] neg_lo:[0,0,1] neg_hi:[0,0,1]
 v_cvt_pk_bf16_f32 v51, v166, v167
 v_lshlrev_b32 v160, 16, v52
 v_and_b32 v161, s78, v52
 v_pk_fma_f32 v[160:161], v[160:161], v[148:149], v[144:145] op_sel_hi:[1,0,0] neg_lo:[0,0,1] neg_hi:[0,0,1]
 v_cvt_pk_bf16_f32 v52, v160, v161
 v_lshlrev_b32 v162, 16, v53
 v_and_b32 v163, s78, v53
 v_pk_fma_f32 v[162:163], v[162:163], v[148:149], v[144:145] op_sel_hi:[1,0,0] neg_lo:[0,0,1] neg_hi:[0,0,1]
 v_cvt_pk_bf16_f32 v53, v162, v163
 v_lshlrev_b32 v164, 16, v54
 v_and_b32 v165, s78, v54
 v_pk_fma_f32 v[164:165], v[164:165], v[148:149], v[144:145] op_sel_hi:[1,0,0] neg_lo:[0,0,1] neg_hi:[0,0,1]
 v_cvt_pk_bf16_f32 v54, v164, v165
 v_lshlrev_b32 v166, 16, v55
 v_and_b32 v167, s78, v55
 v_pk_fma_f32 v[166:167], v[166:167], v[148:149], v[144:145] op_sel_hi:[1,0,0] neg_lo:[0,0,1] neg_hi:[0,0,1]
 v_cvt_pk_bf16_f32 v55, v166, v167
 v_lshlrev_b32 v160, 16, v56
 v_and_b32 v161, s78, v56
 v_pk_fma_f32 v[160:161], v[160:161], v[148:149], v[144:145] op_sel_hi:[1,0,0] neg_lo:[0,0,1] neg_hi:[0,0,1]
 v_cvt_pk_bf16_f32 v56, v160, v161
 v_lshlrev_b32 v162, 16, v57
 v_and_b32 v163, s78, v57
 v_pk_fma_f32 v[162:163], v[162:163], v[148:149], v[144:145] op_sel_hi:[1,0,0] neg_lo:[0,0,1] neg_hi:[0,0,1]
 v_cvt_pk_bf16_f32 v57, v162, v163
 v_lshlrev_b32 v164, 16, v58
 v_and_b32 v165, s78, v58
 v_pk_fma_f32 v[164:165], v[164:165], v[148:149], v[144:145] op_sel_hi:[1,0,0] neg_lo:[0,0,1] neg_hi:[0,0,1]
 v_cvt_pk_bf16_f32 v58, v164, v165
 v_lshlrev_b32 v166, 16, v59
 v_and_b32 v167, s78, v59
 v_pk_fma_f32 v[166:167], v[166:167], v[148:149], v[144:145] op_sel_hi:[1,0,0] neg_lo:[0,0,1] neg_hi:[0,0,1]
 v_cvt_pk_bf16_f32 v59, v166, v167
 v_lshlrev_b32 v160, 16, v60
 v_and_b32 v161, s78, v60
 v_pk_fma_f32 v[160:161], v[160:161], v[148:149], v[144:145] op_sel_hi:[1,0,0] neg_lo:[0,0,1] neg_hi:[0,0,1]
 v_cvt_pk_bf16_f32 v60, v160, v161
 v_lshlrev_b32 v162, 16, v61
 v_and_b32 v163, s78, v61
 v_pk_fma_f32 v[162:163], v[162:163], v[148:149], v[144:145] op_sel_hi:[1,0,0] neg_lo:[0,0,1] neg_hi:[0,0,1]
 v_cvt_pk_bf16_f32 v61, v162, v163
 v_lshlrev_b32 v164, 16, v62
 v_and_b32 v165, s78, v62
 v_pk_fma_f32 v[164:165], v[164:165], v[148:149], v[144:145] op_sel_hi:[1,0,0] neg_lo:[0,0,1] neg_hi:[0,0,1]
 v_cvt_pk_bf16_f32 v62, v164, v165
 v_lshlrev_b32 v166, 16, v63
 v_and_b32 v167, s78, v63
 v_pk_fma_f32 v[166:167], v[166:167], v[148:149], v[144:145] op_sel_hi:[1,0,0] neg_lo:[0,0,1] neg_hi:[0,0,1]
 v_cvt_pk_bf16_f32 v63, v166, v167
 v_lshlrev_b32 v160, 16, v64
 v_and_b32 v161, s78, v64
 v_pk_fma_f32 v[160:161], v[160:161], v[148:149], v[144:145] op_sel_hi:[1,0,0] neg_lo:[0,0,1] neg_hi:[0,0,1]
 v_cvt_pk_bf16_f32 v64, v160, v161
 v_lshlrev_b32 v162, 16, v65
 v_and_b32 v163, s78, v65
 v_pk_fma_f32 v[162:163], v[162:163], v[148:149], v[144:145] op_sel_hi:[1,0,0] neg_lo:[0,0,1] neg_hi:[0,0,1]
 v_cvt_pk_bf16_f32 v65, v162, v163
 v_lshlrev_b32 v164, 16, v66
 v_and_b32 v165, s78, v66
 v_pk_fma_f32 v[164:165], v[164:165], v[148:149], v[144:145] op_sel_hi:[1,0,0] neg_lo:[0,0,1] neg_hi:[0,0,1]
 v_cvt_pk_bf16_f32 v66, v164, v165
 v_lshlrev_b32 v166, 16, v67
 v_and_b32 v167, s78, v67
 v_pk_fma_f32 v[166:167], v[166:167], v[148:149], v[144:145] op_sel_hi:[1,0,0] neg_lo:[0,0,1] neg_hi:[0,0,1]
 v_cvt_pk_bf16_f32 v67, v166, v167
 v_lshlrev_b32 v160, 16, v68
 v_and_b32 v161, s78, v68
 v_pk_fma_f32 v[160:161], v[160:161], v[148:149], v[144:145] op_sel_hi:[1,0,0] neg_lo:[0,0,1] neg_hi:[0,0,1]
 v_cvt_pk_bf16_f32 v68, v160, v161
 v_lshlrev_b32 v162, 16, v69
 v_and_b32 v163, s78, v69
 v_pk_fma_f32 v[162:163], v[162:163], v[148:149], v[144:145] op_sel_hi:[1,0,0] neg_lo:[0,0,1] neg_hi:[0,0,1]
 v_cvt_pk_bf16_f32 v69, v162, v163
 v_lshlrev_b32 v164, 16, v70
 v_and_b32 v165, s78, v70
 v_pk_fma_f32 v[164:165], v[164:165], v[148:149], v[144:145] op_sel_hi:[1,0,0] neg_lo:[0,0,1] neg_hi:[0,0,1]
 v_cvt_pk_bf16_f32 v70, v164, v165
 v_lshlrev_b32 v166, 16, v71
 v_and_b32 v167, s78, v71
 v_pk_fma_f32 v[166:167], v[166:167], v[148:149], v[144:145] op_sel_hi:[1,0,0] neg_lo:[0,0,1] neg_hi:[0,0,1]
 v_cvt_pk_bf16_f32 v71, v166, v167
 v_lshlrev_b32 v160, 16, v72
 v_and_b32 v161, s78, v72
 v_pk_fma_f32 v[160:161], v[160:161], v[148:149], v[144:145] op_sel_hi:[1,0,0] neg_lo:[0,0,1] neg_hi:[0,0,1]
 v_cvt_pk_bf16_f32 v72, v160, v161
 v_lshlrev_b32 v162, 16, v73
 v_and_b32 v163, s78, v73
 v_pk_fma_f32 v[162:163], v[162:163], v[148:149], v[144:145] op_sel_hi:[1,0,0] neg_lo:[0,0,1] neg_hi:[0,0,1]
 v_cvt_pk_bf16_f32 v73, v162, v163
 v_lshlrev_b32 v164, 16, v74
 v_and_b32 v165, s78, v74
 v_pk_fma_f32 v[164:165], v[164:165], v[148:149], v[144:145] op_sel_hi:[1,0,0] neg_lo:[0,0,1] neg_hi:[0,0,1]
 v_cvt_pk_bf16_f32 v74, v164, v165
 v_lshlrev_b32 v166, 16, v75
 v_and_b32 v167, s78, v75
 v_pk_fma_f32 v[166:167], v[166:167], v[148:149], v[144:145] op_sel_hi:[1,0,0] neg_lo:[0,0,1] neg_hi:[0,0,1]
 v_cvt_pk_bf16_f32 v75, v166, v167
 v_lshlrev_b32 v160, 16, v76
 v_and_b32 v161, s78, v76
 v_pk_fma_f32 v[160:161], v[160:161], v[148:149], v[144:145] op_sel_hi:[1,0,0] neg_lo:[0,0,1] neg_hi:[0,0,1]
 v_cvt_pk_bf16_f32 v76, v160, v161
 v_lshlrev_b32 v162, 16, v77
 v_and_b32 v163, s78, v77
 v_pk_fma_f32 v[162:163], v[162:163], v[148:149], v[144:145] op_sel_hi:[1,0,0] neg_lo:[0,0,1] neg_hi:[0,0,1]
 v_cvt_pk_bf16_f32 v77, v162, v163
 v_lshlrev_b32 v164, 16, v78
 v_and_b32 v165, s78, v78
 v_pk_fma_f32 v[164:165], v[164:165], v[148:149], v[144:145] op_sel_hi:[1,0,0] neg_lo:[0,0,1] neg_hi:[0,0,1]
 v_cvt_pk_bf16_f32 v78, v164, v165
 v_lshlrev_b32 v166, 16, v79
 v_and_b32 v167, s78, v79
 v_pk_fma_f32 v[166:167], v[166:167], v[148:149], v[144:145] op_sel_hi:[1,0,0] neg_lo:[0,0,1] neg_hi:[0,0,1]
 v_cvt_pk_bf16_f32 v79, v166, v167
 v_lshlrev_b32 v160, 16, v80
 v_and_b32 v161, s78, v80
 v_pk_fma_f32 v[160:161], v[160:161], v[148:149], v[144:145] op_sel_hi:[1,0,0] neg_lo:[0,0,1] neg_hi:[0,0,1]
 v_cvt_pk_bf16_f32 v80, v160, v161
 v_lshlrev_b32 v162, 16, v81
 v_and_b32 v163, s78, v81
 v_pk_fma_f32 v[162:163], v[162:163], v[148:149], v[144:145] op_sel_hi:[1,0,0] neg_lo:[0,0,1] neg_hi:[0,0,1]
 v_cvt_pk_bf16_f32 v81, v162, v163
 v_lshlrev_b32 v164, 16, v82
 v_and_b32 v165, s78, v82
 v_pk_fma_f32 v[164:165], v[164:165], v[148:149], v[144:145] op_sel_hi:[1,0,0] neg_lo:[0,0,1] neg_hi:[0,0,1]
 v_cvt_pk_bf16_f32 v82, v164, v165
 v_lshlrev_b32 v166, 16, v83
 v_and_b32 v167, s78, v83
 v_pk_fma_f32 v[166:167], v[166:167], v[148:149], v[144:145] op_sel_hi:[1,0,0] neg_lo:[0,0,1] neg_hi:[0,0,1]
 v_cvt_pk_bf16_f32 v83, v166, v167
 v_lshlrev_b32 v160, 16, v84
 v_and_b32 v161, s78, v84
 v_pk_fma_f32 v[160:161], v[160:161], v[148:149], v[144:145] op_sel_hi:[1,0,0] neg_lo:[0,0,1] neg_hi:[0,0,1]
 v_cvt_pk_bf16_f32 v84, v160, v161
 v_lshlrev_b32 v162, 16, v85
 v_and_b32 v163, s78, v85
 v_pk_fma_f32 v[162:163], v[162:163], v[148:149], v[144:145] op_sel_hi:[1,0,0] neg_lo:[0,0,1] neg_hi:[0,0,1]
 v_cvt_pk_bf16_f32 v85, v162, v163
 v_lshlrev_b32 v164, 16, v86
 v_and_b32 v165, s78, v86
 v_pk_fma_f32 v[164:165], v[164:165], v[148:149], v[144:145] op_sel_hi:[1,0,0] neg_lo:[0,0,1] neg_hi:[0,0,1]
 v_cvt_pk_bf16_f32 v86, v164, v165
 v_lshlrev_b32 v166, 16, v87
 v_and_b32 v167, s78, v87
 v_pk_fma_f32 v[166:167], v[166:167], v[148:149], v[144:145] op_sel_hi:[1,0,0] neg_lo:[0,0,1] neg_hi:[0,0,1]
 v_cvt_pk_bf16_f32 v87, v166, v167
 v_lshlrev_b32 v160, 16, v88
 v_and_b32 v161, s78, v88
 v_pk_fma_f32 v[160:161], v[160:161], v[148:149], v[144:145] op_sel_hi:[1,0,0] neg_lo:[0,0,1] neg_hi:[0,0,1]
 v_cvt_pk_bf16_f32 v88, v160, v161
 v_lshlrev_b32 v162, 16, v89
 v_and_b32 v163, s78, v89
 v_pk_fma_f32 v[162:163], v[162:163], v[148:149], v[144:145] op_sel_hi:[1,0,0] neg_lo:[0,0,1] neg_hi:[0,0,1]
 v_cvt_pk_bf16_f32 v89, v162, v163
 v_lshlrev_b32 v164, 16, v90
 v_and_b32 v165, s78, v90
 v_pk_fma_f32 v[164:165], v[164:165], v[148:149], v[144:145] op_sel_hi:[1,0,0] neg_lo:[0,0,1] neg_hi:[0,0,1]
 v_cvt_pk_bf16_f32 v90, v164, v165
 v_lshlrev_b32 v166, 16, v91
 v_and_b32 v167, s78, v91
 v_pk_fma_f32 v[166:167], v[166:167], v[148:149], v[144:145] op_sel_hi:[1,0,0] neg_lo:[0,0,1] neg_hi:[0,0,1]
 v_cvt_pk_bf16_f32 v91, v166, v167
 v_lshlrev_b32 v160, 16, v92
 v_and_b32 v161, s78, v92
 v_pk_fma_f32 v[160:161], v[160:161], v[148:149], v[144:145] op_sel_hi:[1,0,0] neg_lo:[0,0,1] neg_hi:[0,0,1]
 v_cvt_pk_bf16_f32 v92, v160, v161
 v_lshlrev_b32 v162, 16, v93
 v_and_b32 v163, s78, v93
 v_pk_fma_f32 v[162:163], v[162:163], v[148:149], v[144:145] op_sel_hi:[1,0,0] neg_lo:[0,0,1] neg_hi:[0,0,1]
 v_cvt_pk_bf16_f32 v93, v162, v163
 v_lshlrev_b32 v164, 16, v94
 v_and_b32 v165, s78, v94
 v_pk_fma_f32 v[164:165], v[164:165], v[148:149], v[144:145] op_sel_hi:[1,0,0] neg_lo:[0,0,1] neg_hi:[0,0,1]
 v_cvt_pk_bf16_f32 v94, v164, v165
 v_lshlrev_b32 v166, 16, v95
 v_and_b32 v167, s78, v95
 v_pk_fma_f32 v[166:167], v[166:167], v[148:149], v[144:145] op_sel_hi:[1,0,0] neg_lo:[0,0,1] neg_hi:[0,0,1]
 v_cvt_pk_bf16_f32 v95, v166, v167
 v_lshlrev_b32 v160, 16, v96
 v_and_b32 v161, s78, v96
 v_pk_fma_f32 v[160:161], v[160:161], v[148:149], v[144:145] op_sel_hi:[1,0,0] neg_lo:[0,0,1] neg_hi:[0,0,1]
 v_cvt_pk_bf16_f32 v96, v160, v161
 v_lshlrev_b32 v162, 16, v97
 v_and_b32 v163, s78, v97
 v_pk_fma_f32 v[162:163], v[162:163], v[148:149], v[144:145] op_sel_hi:[1,0,0] neg_lo:[0,0,1] neg_hi:[0,0,1]
 v_cvt_pk_bf16_f32 v97, v162, v163
 v_lshlrev_b32 v164, 16, v98
 v_and_b32 v165, s78, v98
 v_pk_fma_f32 v[164:165], v[164:165], v[148:149], v[144:145] op_sel_hi:[1,0,0] neg_lo:[0,0,1] neg_hi:[0,0,1]
 v_cvt_pk_bf16_f32 v98, v164, v165
 v_lshlrev_b32 v166, 16, v99
 v_and_b32 v167, s78, v99
 v_pk_fma_f32 v[166:167], v[166:167], v[148:149], v[144:145] op_sel_hi:[1,0,0] neg_lo:[0,0,1] neg_hi:[0,0,1]
 v_cvt_pk_bf16_f32 v99, v166, v167
 v_lshlrev_b32 v160, 16, v100
 v_and_b32 v161, s78, v100
 v_pk_fma_f32 v[160:161], v[160:161], v[148:149], v[144:145] op_sel_hi:[1,0,0] neg_lo:[0,0,1] neg_hi:[0,0,1]
 v_cvt_pk_bf16_f32 v100, v160, v161
 v_lshlrev_b32 v162, 16, v101
 v_and_b32 v163, s78, v101
 v_pk_fma_f32 v[162:163], v[162:163], v[148:149], v[144:145] op_sel_hi:[1,0,0] neg_lo:[0,0,1] neg_hi:[0,0,1]
 v_cvt_pk_bf16_f32 v101, v162, v163
 v_lshlrev_b32 v164, 16, v102
 v_and_b32 v165, s78, v102
 v_pk_fma_f32 v[164:165], v[164:165], v[148:149], v[144:145] op_sel_hi:[1,0,0] neg_lo:[0,0,1] neg_hi:[0,0,1]
 v_cvt_pk_bf16_f32 v102, v164, v165
 v_lshlrev_b32 v166, 16, v103
 v_and_b32 v167, s78, v103
 v_pk_fma_f32 v[166:167], v[166:167], v[148:149], v[144:145] op_sel_hi:[1,0,0] neg_lo:[0,0,1] neg_hi:[0,0,1]
 v_cvt_pk_bf16_f32 v103, v166, v167
 v_lshlrev_b32 v160, 16, v104
 v_and_b32 v161, s78, v104
 v_pk_fma_f32 v[160:161], v[160:161], v[148:149], v[144:145] op_sel_hi:[1,0,0] neg_lo:[0,0,1] neg_hi:[0,0,1]
 v_cvt_pk_bf16_f32 v104, v160, v161
 v_lshlrev_b32 v162, 16, v105
 v_and_b32 v163, s78, v105
 v_pk_fma_f32 v[162:163], v[162:163], v[148:149], v[144:145] op_sel_hi:[1,0,0] neg_lo:[0,0,1] neg_hi:[0,0,1]
 v_cvt_pk_bf16_f32 v105, v162, v163
 v_lshlrev_b32 v164, 16, v106
 v_and_b32 v165, s78, v106
 v_pk_fma_f32 v[164:165], v[164:165], v[148:149], v[144:145] op_sel_hi:[1,0,0] neg_lo:[0,0,1] neg_hi:[0,0,1]
 v_cvt_pk_bf16_f32 v106, v164, v165
 v_lshlrev_b32 v166, 16, v107
 v_and_b32 v167, s78, v107
 v_pk_fma_f32 v[166:167], v[166:167], v[148:149], v[144:145] op_sel_hi:[1,0,0] neg_lo:[0,0,1] neg_hi:[0,0,1]
 v_cvt_pk_bf16_f32 v107, v166, v167
 v_lshlrev_b32 v160, 16, v108
 v_and_b32 v161, s78, v108
 v_pk_fma_f32 v[160:161], v[160:161], v[148:149], v[144:145] op_sel_hi:[1,0,0] neg_lo:[0,0,1] neg_hi:[0,0,1]
 v_cvt_pk_bf16_f32 v108, v160, v161
 v_lshlrev_b32 v162, 16, v109
 v_and_b32 v163, s78, v109
 v_pk_fma_f32 v[162:163], v[162:163], v[148:149], v[144:145] op_sel_hi:[1,0,0] neg_lo:[0,0,1] neg_hi:[0,0,1]
 v_cvt_pk_bf16_f32 v109, v162, v163
 v_lshlrev_b32 v164, 16, v110
 v_and_b32 v165, s78, v110
 v_pk_fma_f32 v[164:165], v[164:165], v[148:149], v[144:145] op_sel_hi:[1,0,0] neg_lo:[0,0,1] neg_hi:[0,0,1]
 v_cvt_pk_bf16_f32 v110, v164, v165
 v_lshlrev_b32 v166, 16, v111
 v_and_b32 v167, s78, v111
 v_pk_fma_f32 v[166:167], v[166:167], v[148:149], v[144:145] op_sel_hi:[1,0,0] neg_lo:[0,0,1] neg_hi:[0,0,1]
 v_cvt_pk_bf16_f32 v111, v166, v167
 v_lshlrev_b32 v160, 16, v112
 v_and_b32 v161, s78, v112
 v_pk_fma_f32 v[160:161], v[160:161], v[148:149], v[144:145] op_sel_hi:[1,0,0] neg_lo:[0,0,1] neg_hi:[0,0,1]
 v_cvt_pk_bf16_f32 v112, v160, v161
 v_lshlrev_b32 v162, 16, v113
 v_and_b32 v163, s78, v113
 v_pk_fma_f32 v[162:163], v[162:163], v[148:149], v[144:145] op_sel_hi:[1,0,0] neg_lo:[0,0,1] neg_hi:[0,0,1]
 v_cvt_pk_bf16_f32 v113, v162, v163
 v_lshlrev_b32 v164, 16, v114
 v_and_b32 v165, s78, v114
 v_pk_fma_f32 v[164:165], v[164:165], v[148:149], v[144:145] op_sel_hi:[1,0,0] neg_lo:[0,0,1] neg_hi:[0,0,1]
 v_cvt_pk_bf16_f32 v114, v164, v165
 v_lshlrev_b32 v166, 16, v115
 v_and_b32 v167, s78, v115
 v_pk_fma_f32 v[166:167], v[166:167], v[148:149], v[144:145] op_sel_hi:[1,0,0] neg_lo:[0,0,1] neg_hi:[0,0,1]
 v_cvt_pk_bf16_f32 v115, v166, v167
 v_lshlrev_b32 v160, 16, v116
 v_and_b32 v161, s78, v116
 v_pk_fma_f32 v[160:161], v[160:161], v[148:149], v[144:145] op_sel_hi:[1,0,0] neg_lo:[0,0,1] neg_hi:[0,0,1]
 v_cvt_pk_bf16_f32 v116, v160, v161
 v_lshlrev_b32 v162, 16, v117
 v_and_b32 v163, s78, v117
 v_pk_fma_f32 v[162:163], v[162:163], v[148:149], v[144:145] op_sel_hi:[1,0,0] neg_lo:[0,0,1] neg_hi:[0,0,1]
 v_cvt_pk_bf16_f32 v117, v162, v163
 v_lshlrev_b32 v164, 16, v118
 v_and_b32 v165, s78, v118
 v_pk_fma_f32 v[164:165], v[164:165], v[148:149], v[144:145] op_sel_hi:[1,0,0] neg_lo:[0,0,1] neg_hi:[0,0,1]
 v_cvt_pk_bf16_f32 v118, v164, v165
 v_lshlrev_b32 v166, 16, v119
 v_and_b32 v167, s78, v119
 v_pk_fma_f32 v[166:167], v[166:167], v[148:149], v[144:145] op_sel_hi:[1,0,0] neg_lo:[0,0,1] neg_hi:[0,0,1]
 v_cvt_pk_bf16_f32 v119, v166, v167
 v_lshlrev_b32 v160, 16, v120
 v_and_b32 v161, s78, v120
 v_pk_fma_f32 v[160:161], v[160:161], v[148:149], v[144:145] op_sel_hi:[1,0,0] neg_lo:[0,0,1] neg_hi:[0,0,1]
 v_cvt_pk_bf16_f32 v120, v160, v161
 v_lshlrev_b32 v162, 16, v121
 v_and_b32 v163, s78, v121
 v_pk_fma_f32 v[162:163], v[162:163], v[148:149], v[144:145] op_sel_hi:[1,0,0] neg_lo:[0,0,1] neg_hi:[0,0,1]
 v_cvt_pk_bf16_f32 v121, v162, v163
 v_lshlrev_b32 v164, 16, v122
 v_and_b32 v165, s78, v122
 v_pk_fma_f32 v[164:165], v[164:165], v[148:149], v[144:145] op_sel_hi:[1,0,0] neg_lo:[0,0,1] neg_hi:[0,0,1]
 v_cvt_pk_bf16_f32 v122, v164, v165
 v_lshlrev_b32 v166, 16, v123
 v_and_b32 v167, s78, v123
 v_pk_fma_f32 v[166:167], v[166:167], v[148:149], v[144:145] op_sel_hi:[1,0,0] neg_lo:[0,0,1] neg_hi:[0,0,1]
 v_cvt_pk_bf16_f32 v123, v166, v167
 v_lshlrev_b32 v160, 16, v124
 v_and_b32 v161, s78, v124
 v_pk_fma_f32 v[160:161], v[160:161], v[148:149], v[144:145] op_sel_hi:[1,0,0] neg_lo:[0,0,1] neg_hi:[0,0,1]
 v_cvt_pk_bf16_f32 v124, v160, v161
 v_lshlrev_b32 v162, 16, v125
 v_and_b32 v163, s78, v125
 v_pk_fma_f32 v[162:163], v[162:163], v[148:149], v[144:145] op_sel_hi:[1,0,0] neg_lo:[0,0,1] neg_hi:[0,0,1]
 v_cvt_pk_bf16_f32 v125, v162, v163
 v_lshlrev_b32 v164, 16, v126
 v_and_b32 v165, s78, v126
 v_pk_fma_f32 v[164:165], v[164:165], v[148:149], v[144:145] op_sel_hi:[1,0,0] neg_lo:[0,0,1] neg_hi:[0,0,1]
 v_cvt_pk_bf16_f32 v126, v164, v165
 v_lshlrev_b32 v166, 16, v127
 v_and_b32 v167, s78, v127
 v_pk_fma_f32 v[166:167], v[166:167], v[148:149], v[144:145] op_sel_hi:[1,0,0] neg_lo:[0,0,1] neg_hi:[0,0,1]
 v_cvt_pk_bf16_f32 v127, v166, v167
 v_lshlrev_b32 v160, 16, v128
 v_and_b32 v161, s78, v128
 v_pk_fma_f32 v[160:161], v[160:161], v[148:149], v[144:145] op_sel_hi:[1,0,0] neg_lo:[0,0,1] neg_hi:[0,0,1]
 v_cvt_pk_bf16_f32 v128, v160, v161
 v_lshlrev_b32 v162, 16, v129
 v_and_b32 v163, s78, v129
 v_pk_fma_f32 v[162:163], v[162:163], v[148:149], v[144:145] op_sel_hi:[1,0,0] neg_lo:[0,0,1] neg_hi:[0,0,1]
 v_cvt_pk_bf16_f32 v129, v162, v163
 v_lshlrev_b32 v164, 16, v130
 v_and_b32 v165, s78, v130
 v_pk_fma_f32 v[164:165], v[164:165], v[148:149], v[144:145] op_sel_hi:[1,0,0] neg_lo:[0,0,1] neg_hi:[0,0,1]
 v_cvt_pk_bf16_f32 v130, v164, v165
 v_lshlrev_b32 v166, 16, v131
 v_and_b32 v167, s78, v131
 v_pk_fma_f32 v[166:167], v[166:167], v[148:149], v[144:145] op_sel_hi:[1,0,0] neg_lo:[0,0,1] neg_hi:[0,0,1]
 v_cvt_pk_bf16_f32 v131, v166, v167
 v_lshlrev_b32 v160, 16, v132
 v_and_b32 v161, s78, v132
 v_pk_fma_f32 v[160:161], v[160:161], v[148:149], v[144:145] op_sel_hi:[1,0,0] neg_lo:[0,0,1] neg_hi:[0,0,1]
 v_cvt_pk_bf16_f32 v132, v160, v161
 v_lshlrev_b32 v162, 16, v133
 v_and_b32 v163, s78, v133
 v_pk_fma_f32 v[162:163], v[162:163], v[148:149], v[144:145] op_sel_hi:[1,0,0] neg_lo:[0,0,1] neg_hi:[0,0,1]
 v_cvt_pk_bf16_f32 v133, v162, v163
 v_lshlrev_b32 v164, 16, v134
 v_and_b32 v165, s78, v134
 v_pk_fma_f32 v[164:165], v[164:165], v[148:149], v[144:145] op_sel_hi:[1,0,0] neg_lo:[0,0,1] neg_hi:[0,0,1]
 v_cvt_pk_bf16_f32 v134, v164, v165
 v_lshlrev_b32 v166, 16, v135
 v_and_b32 v167, s78, v135
 v_pk_fma_f32 v[166:167], v[166:167], v[148:149], v[144:145] op_sel_hi:[1,0,0] neg_lo:[0,0,1] neg_hi:[0,0,1]
 v_cvt_pk_bf16_f32 v135, v166, v167
 v_lshlrev_b32 v160, 16, v136
 v_and_b32 v161, s78, v136
 v_pk_fma_f32 v[160:161], v[160:161], v[148:149], v[144:145] op_sel_hi:[1,0,0] neg_lo:[0,0,1] neg_hi:[0,0,1]
 v_cvt_pk_bf16_f32 v136, v160, v161
 v_lshlrev_b32 v162, 16, v137
 v_and_b32 v163, s78, v137
 v_pk_fma_f32 v[162:163], v[162:163], v[148:149], v[144:145] op_sel_hi:[1,0,0] neg_lo:[0,0,1] neg_hi:[0,0,1]
 v_cvt_pk_bf16_f32 v137, v162, v163
 v_lshlrev_b32 v164, 16, v138
 v_and_b32 v165, s78, v138
 v_pk_fma_f32 v[164:165], v[164:165], v[148:149], v[144:145] op_sel_hi:[1,0,0] neg_lo:[0,0,1] neg_hi:[0,0,1]
 v_cvt_pk_bf16_f32 v138, v164, v165
 v_lshlrev_b32 v166, 16, v139
 v_and_b32 v167, s78, v139
 v_pk_fma_f32 v[166:167], v[166:167], v[148:149], v[144:145] op_sel_hi:[1,0,0] neg_lo:[0,0,1] neg_hi:[0,0,1]
 v_cvt_pk_bf16_f32 v139, v166, v167
 v_lshlrev_b32 v160, 16, v140
 v_and_b32 v161, s78, v140
 v_pk_fma_f32 v[160:161], v[160:161], v[148:149], v[144:145] op_sel_hi:[1,0,0] neg_lo:[0,0,1] neg_hi:[0,0,1]
 v_cvt_pk_bf16_f32 v140, v160, v161
 v_lshlrev_b32 v162, 16, v141
 v_and_b32 v163, s78, v141
 v_pk_fma_f32 v[162:163], v[162:163], v[148:149], v[144:145] op_sel_hi:[1,0,0] neg_lo:[0,0,1] neg_hi:[0,0,1]
 v_cvt_pk_bf16_f32 v141, v162, v163
 v_lshlrev_b32 v164, 16, v142
 v_and_b32 v165, s78, v142
 v_pk_fma_f32 v[164:165], v[164:165], v[148:149], v[144:145] op_sel_hi:[1,0,0] neg_lo:[0,0,1] neg_hi:[0,0,1]
 v_cvt_pk_bf16_f32 v142, v164, v165
 v_lshlrev_b32 v166, 16, v143
 v_and_b32 v167, s78, v143
 v_pk_fma_f32 v[166:167], v[166:167], v[148:149], v[144:145] op_sel_hi:[1,0,0] neg_lo:[0,0,1] neg_hi:[0,0,1]
 v_cvt_pk_bf16_f32 v143, v166, v167
 s_branch L_main_257
L_nop0_258:
 v_bfe_u32 v247, v246, 4, 5
 s_lshl_b32 s3, s58, 5
 v_add_u32 v247, s3, v247
 v_mul_u32_u24 v247, 1152, v247
 v_bfe_u32 v248, v246, 9, 1
 v_lshl_add_u32 v247, v248, 4, v247
 buffer_load_dwordx4 v[0:3], v247, s[24:27], 0 offen offset:0
 buffer_load_dwordx4 v[4:7], v247, s[24:27], 0 offen offset:32
 buffer_load_dwordx4 v[8:11], v247, s[24:27], 0 offen offset:64
 buffer_load_dwordx4 v[12:15], v247, s[24:27], 0 offen offset:96
 buffer_load_dwordx4 v[16:19], v247, s[24:27], 0 offen offset:128
 buffer_load_dwordx4 v[20:23], v247, s[24:27], 0 offen offset:160
 buffer_load_dwordx4 v[24:27], v247, s[24:27], 0 offen offset:192
 buffer_load_dwordx4 v[28:31], v247, s[24:27], 0 offen offset:224
 buffer_load_dwordx4 v[32:35], v247, s[24:27], 0 offen offset:256
 buffer_load_dwordx4 v[36:39], v247, s[24:27], 0 offen offset:288
 buffer_load_dwordx4 v[40:43], v247, s[24:27], 0 offen offset:320
 buffer_load_dwordx4 v[44:47], v247, s[24:27], 0 offen offset:352
 buffer_load_dwordx4 v[48:51], v247, s[24:27], 0 offen offset:384
 buffer_load_dwordx4 v[52:55], v247, s[24:27], 0 offen offset:416
 buffer_load_dwordx4 v[56:59], v247, s[24:27], 0 offen offset:448
 buffer_load_dwordx4 v[60:63], v247, s[24:27], 0 offen offset:480
 buffer_load_dwordx4 v[64:67], v247, s[24:27], 0 offen offset:512
 buffer_load_dwordx4 v[68:71], v247, s[24:27], 0 offen offset:544
 buffer_load_dwordx4 v[72:75], v247, s[24:27], 0 offen offset:576
 buffer_load_dwordx4 v[76:79], v247, s[24:27], 0 offen offset:608
 buffer_load_dwordx4 v[80:83], v247, s[24:27], 0 offen offset:640
 buffer_load_dwordx4 v[84:87], v247, s[24:27], 0 offen offset:672
 buffer_load_dwordx4 v[88:91], v247, s[24:27], 0 offen offset:704
 buffer_load_dwordx4 v[92:95], v247, s[24:27], 0 offen offset:736
 buffer_load_dwordx4 v[96:99], v247, s[24:27], 0 offen offset:768
 buffer_load_dwordx4 v[100:103], v247, s[24:27], 0 offen offset:800
 buffer_load_dwordx4 v[104:107], v247, s[24:27], 0 offen offset:832
 buffer_load_dwordx4 v[108:111], v247, s[24:27], 0 offen offset:864
 buffer_load_dwordx4 v[112:115], v247, s[24:27], 0 offen offset:896
 buffer_load_dwordx4 v[116:119], v247, s[24:27], 0 offen offset:928
 buffer_load_dwordx4 v[120:123], v247, s[24:27], 0 offen offset:960
 buffer_load_dwordx4 v[124:127], v247, s[24:27], 0 offen offset:992
 buffer_load_dwordx4 v[128:131], v247, s[24:27], 0 offen offset:1024
 buffer_load_dwordx4 v[132:135], v247, s[24:27], 0 offen offset:1056
 buffer_load_dwordx4 v[136:139], v247, s[24:27], 0 offen offset:1088
 buffer_load_dwordx4 v[140:143], v247, s[24:27], 0 offen offset:1120
 s_mov_b32 s52, 0
 s_cmp_eq_u32 s89, 1
 s_cbranch_scc1 L_fs_278
 s_cmp_ge_u32 s52, s60
 s_cbranch_scc1 L_pq_280
 s_add_u32 s72, s59, s52
 s_cmp_ge_u32 s72, 64
 s_cbranch_scc1 L_pv_281
 s_mov_b32 s40, s12
 s_mov_b32 s41, s13
 s_mov_b32 s42, s14
 s_mov_b32 s43, s15
 s_mov_b32 s73, 0
 s_mov_b32 s66, 0
 s_branch L_pe_282
L_pv_281:
 s_sub_u32 s72, s72, 64
 s_mov_b32 s40, s16
 s_mov_b32 s41, s17
 s_mov_b32 s42, s18
 s_mov_b32 s43, s19
 s_mov_b32 s73, 16777216
 s_mov_b32 s66, 1
 s_branch L_pe_282
L_pq_280:
 s_sub_u32 s72, s52, s60
 s_add_u32 s72, s72, s61
 s_mov_b32 s40, s8
 s_mov_b32 s41, s9
 s_mov_b32 s42, s10
 s_mov_b32 s43, s11
 s_mov_b32 s73, 33554432
 s_mov_b32 s66, 0
L_pe_282:
 s_lshl_b32 s54, s72, 7
 s_lshl_b32 s3, s46, 16
 s_add_u32 s54, s54, s3
 s_lshl_b32 s74, s72, 12
 s_lshl_b32 s3, s58, 18
 s_add_u32 s74, s74, s3
 s_add_u32 s74, s74, s73
 s_mov_b32 s67, 262144
 v_mov_b32 v252, v244
 s_branch L_fs2_279
L_fs_278:
 s_mov_b32 s40, s28
 s_mov_b32 s41, s29
 s_mov_b32 s42, s30
 s_mov_b32 s43, s31
 s_lshl_b32 s54, s63, 7
 s_mul_i32 s3, s46, 73728
 s_add_u32 s54, s54, s3
 s_mov_b32 s67, 294912
 v_mov_b32 v252, v251
L_fs2_279:
 v_mov_b32 v144, 0
 v_mov_b32 v145, 0
 v_mov_b32 v146, 0
 v_mov_b32 v147, 0
 v_mov_b32 v148, 0
 v_mov_b32 v149, 0
 v_mov_b32 v150, 0
 v_mov_b32 v151, 0
 v_mov_b32 v152, 0x3f803f80
 s_waitcnt vmcnt(32)
 v_dot2c_f32_bf16 v144, v0, v152
 v_dot2c_f32_bf16 v148, v0, v0
 v_dot2c_f32_bf16 v145, v1, v152
 v_dot2c_f32_bf16 v149, v1, v1
 v_dot2c_f32_bf16 v146, v2, v152
 v_dot2c_f32_bf16 v150, v2, v2
 v_dot2c_f32_bf16 v147, v3, v152
 v_dot2c_f32_bf16 v151, v3, v3
 v_dot2c_f32_bf16 v144, v4, v152
 v_dot2c_f32_bf16 v148, v4, v4
 v_dot2c_f32_bf16 v145, v5, v152
 v_dot2c_f32_bf16 v149, v5, v5
 v_dot2c_f32_bf16 v146, v6, v152
 v_dot2c_f32_bf16 v150, v6, v6
 v_dot2c_f32_bf16 v147, v7, v152
 v_dot2c_f32_bf16 v151, v7, v7
 v_dot2c_f32_bf16 v144, v8, v152
 v_dot2c_f32_bf16 v148, v8, v8
 v_dot2c_f32_bf16 v145, v9, v152
 v_dot2c_f32_bf16 v149, v9, v9
 v_dot2c_f32_bf16 v146, v10, v152
 v_dot2c_f32_bf16 v150, v10, v10
 v_dot2c_f32_bf16 v147, v11, v152
 v_dot2c_f32_bf16 v151, v11, v11
 v_dot2c_f32_bf16 v144, v12, v152
 v_dot2c_f32_bf16 v148, v12, v12
 v_dot2c_f32_bf16 v145, v13, v152
 v_dot2c_f32_bf16 v149, v13, v13
 v_dot2c_f32_bf16 v146, v14, v152
 v_dot2c_f32_bf16 v150, v14, v14
 v_dot2c_f32_bf16 v147, v15, v152
 v_dot2c_f32_bf16 v151, v15, v15
 s_waitcnt vmcnt(28)
 v_dot2c_f32_bf16 v144, v16, v152
 v_dot2c_f32_bf16 v148, v16, v16
 v_dot2c_f32_bf16 v145, v17, v152
 v_dot2c_f32_bf16 v149, v17, v17
 v_dot2c_f32_bf16 v146, v18, v152
 v_dot2c_f32_bf16 v150, v18, v18
 v_dot2c_f32_bf16 v147, v19, v152
 v_dot2c_f32_bf16 v151, v19, v19
 v_dot2c_f32_bf16 v144, v20, v152
 v_dot2c_f32_bf16 v148, v20, v20
 v_dot2c_f32_bf16 v145, v21, v152
 v_dot2c_f32_bf16 v149, v21, v21
 v_dot2c_f32_bf16 v146, v22, v152
 v_dot2c_f32_bf16 v150, v22, v22
 v_dot2c_f32_bf16 v147, v23, v152
 v_dot2c_f32_bf16 v151, v23, v23
 v_dot2c_f32_bf16 v144, v24, v152
 v_dot2c_f32_bf16 v148, v24, v24
 v_dot2c_f32_bf16 v145, v25, v152
 v_dot2c_f32_bf16 v149, v25, v25
 v_dot2c_f32_bf16 v146, v26, v152
 v_dot2c_f32_bf16 v150, v26, v26
 v_dot2c_f32_bf16 v147, v27, v152
 v_dot2c_f32_bf16 v151, v27, v27
 v_dot2c_f32_bf16 v144, v28, v152
 v_dot2c_f32_bf16 v148, v28, v28
 v_dot2c_f32_bf16 v145, v29, v152
 v_dot2c_f32_bf16 v149, v29, v29
 v_dot2c_f32_bf16 v146, v30, v152
 v_dot2c_f32_bf16 v150, v30, v30
 v_dot2c_f32_bf16 v147, v31, v152
 v_dot2c_f32_bf16 v151, v31, v31
 s_waitcnt vmcnt(24)
 v_dot2c_f32_bf16 v144, v32, v152
 v_dot2c_f32_bf16 v148, v32, v32
 v_dot2c_f32_bf16 v145, v33, v152
 v_dot2c_f32_bf16 v149, v33, v33
 v_dot2c_f32_bf16 v146, v34, v152
 v_dot2c_f32_bf16 v150, v34, v34
 v_dot2c_f32_bf16 v147, v35, v152
 v_dot2c_f32_bf16 v151, v35, v35
 v_dot2c_f32_bf16 v144, v36, v152
 v_dot2c_f32_bf16 v148, v36, v36
 v_dot2c_f32_bf16 v145, v37, v152
 v_dot2c_f32_bf16 v149, v37, v37
 v_dot2c_f32_bf16 v146, v38, v152
 v_dot2c_f32_bf16 v150, v38, v38
 v_dot2c_f32_bf16 v147, v39, v152
 v_dot2c_f32_bf16 v151, v39, v39
 v_dot2c_f32_bf16 v144, v40, v152
 v_dot2c_f32_bf16 v148, v40, v40
 v_dot2c_f32_bf16 v145, v41, v152
 v_dot2c_f32_bf16 v149, v41, v41
 v_dot2c_f32_bf16 v146, v42, v152
 v_dot2c_f32_bf16 v150, v42, v42
 v_dot2c_f32_bf16 v147, v43, v152
 v_dot2c_f32_bf16 v151, v43, v43
 v_dot2c_f32_bf16 v144, v44, v152
 v_dot2c_f32_bf16 v148, v44, v44
 v_dot2c_f32_bf16 v145, v45, v152
 v_dot2c_f32_bf16 v149, v45, v45
 v_dot2c_f32_bf16 v146, v46, v152
 v_dot2c_f32_bf16 v150, v46, v46
 v_dot2c_f32_bf16 v147, v47, v152
 v_dot2c_f32_bf16 v151, v47, v47
 s_waitcnt vmcnt(20)
 v_dot2c_f32_bf16 v144, v48, v152
 v_dot2c_f32_bf16 v148, v48, v48
 v_dot2c_f32_bf16 v145, v49, v152
 v_dot2c_f32_bf16 v149, v49, v49
 v_dot2c_f32_bf16 v146, v50, v152
 v_dot2c_f32_bf16 v150, v50, v50
 v_dot2c_f32_bf16 v147, v51, v152
 v_dot2c_f32_bf16 v151, v51, v51
 v_dot2c_f32_bf16 v144, v52, v152
 v_dot2c_f32_bf16 v148, v52, v52
 v_dot2c_f32_bf16 v145, v53, v152
 v_dot2c_f32_bf16 v149, v53, v53
 v_dot2c_f32_bf16 v146, v54, v152
 v_dot2c_f32_bf16 v150, v54, v54
 v_dot2c_f32_bf16 v147, v55, v152
 v_dot2c_f32_bf16 v151, v55, v55
 v_dot2c_f32_bf16 v144, v56, v152
 v_dot2c_f32_bf16 v148, v56, v56
 v_dot2c_f32_bf16 v145, v57, v152
 v_dot2c_f32_bf16 v149, v57, v57
 v_dot2c_f32_bf16 v146, v58, v152
 v_dot2c_f32_bf16 v150, v58, v58
 v_dot2c_f32_bf16 v147, v59, v152
 v_dot2c_f32_bf16 v151, v59, v59
 v_dot2c_f32_bf16 v144, v60, v152
 v_dot2c_f32_bf16 v148, v60, v60
 v_dot2c_f32_bf16 v145, v61, v152
 v_dot2c_f32_bf16 v149, v61, v61
 v_dot2c_f32_bf16 v146, v62, v152
 v_dot2c_f32_bf16 v150, v62, v62
 v_dot2c_f32_bf16 v147, v63, v152
 v_dot2c_f32_bf16 v151, v63, v63
 s_waitcnt vmcnt(16)
 v_dot2c_f32_bf16 v144, v64, v152
 v_dot2c_f32_bf16 v148, v64, v64
 v_dot2c_f32_bf16 v145, v65, v152
 v_dot2c_f32_bf16 v149, v65, v65
 v_dot2c_f32_bf16 v146, v66, v152
 v_dot2c_f32_bf16 v150, v66, v66
 v_dot2c_f32_bf16 v147, v67, v152
 v_dot2c_f32_bf16 v151, v67, v67
 v_dot2c_f32_bf16 v144, v68, v152
 v_dot2c_f32_bf16 v148, v68, v68
 v_dot2c_f32_bf16 v145, v69, v152
 v_dot2c_f32_bf16 v149, v69, v69
 v_dot2c_f32_bf16 v146, v70, v152
 v_dot2c_f32_bf16 v150, v70, v70
 v_dot2c_f32_bf16 v147, v71, v152
 v_dot2c_f32_bf16 v151, v71, v71
 v_dot2c_f32_bf16 v144, v72, v152
 v_dot2c_f32_bf16 v148, v72, v72
 v_dot2c_f32_bf16 v145, v73, v152
 v_dot2c_f32_bf16 v149, v73, v73
 v_dot2c_f32_bf16 v146, v74, v152
 v_dot2c_f32_bf16 v150, v74, v74
 v_dot2c_f32_bf16 v147, v75, v152
 v_dot2c_f32_bf16 v151, v75, v75
 v_dot2c_f32_bf16 v144, v76, v152
 v_dot2c_f32_bf16 v148, v76, v76
 v_dot2c_f32_bf16 v145, v77, v152
 v_dot2c_f32_bf16 v149, v77, v77
 v_dot2c_f32_bf16 v146, v78, v152
 v_dot2c_f32_bf16 v150, v78, v78
 v_dot2c_f32_bf16 v147, v79, v152
 v_dot2c_f32_bf16 v151, v79, v79
 s_waitcnt vmcnt(12)
 v_dot2c_f32_bf16 v144, v80, v152
 v_dot2c_f32_bf16 v148, v80, v80
 v_dot2c_f32_bf16 v145, v81, v152
 v_dot2c_f32_bf16 v149, v81, v81
 v_dot2c_f32_bf16 v146, v82, v152
 v_dot2c_f32_bf16 v150, v82, v82
 v_dot2c_f32_bf16 v147, v83, v152
 v_dot2c_f32_bf16 v151, v83, v83
 v_dot2c_f32_bf16 v144, v84, v152
 v_dot2c_f32_bf16 v148, v84, v84
 v_dot2c_f32_bf16 v145, v85, v152
 v_dot2c_f32_bf16 v149, v85, v85
 v_dot2c_f32_bf16 v146, v86, v152
 v_dot2c_f32_bf16 v150, v86, v86
 v_dot2c_f32_bf16 v147, v87, v152
 v_dot2c_f32_bf16 v151, v87, v87
 v_dot2c_f32_bf16 v144, v88, v152
 v_dot2c_f32_bf16 v148, v88, v88
 v_dot2c_f32_bf16 v145, v89, v152
 v_dot2c_f32_bf16 v149, v89, v89
 v_dot2c_f32_bf16 v146, v90, v152
 v_dot2c_f32_bf16 v150, v90, v90
 v_dot2c_f32_bf16 v147, v91, v152
 v_dot2c_f32_bf16 v151, v91, v91
 v_dot2c_f32_bf16 v144, v92, v152
 v_dot2c_f32_bf16 v148, v92, v92
 v_dot2c_f32_bf16 v145, v93, v152
 v_dot2c_f32_bf16 v149, v93, v93
 v_dot2c_f32_bf16 v146, v94, v152
 v_dot2c_f32_bf16 v150, v94, v94
 v_dot2c_f32_bf16 v147, v95, v152
 v_dot2c_f32_bf16 v151, v95, v95
 s_waitcnt vmcnt(8)
 v_dot2c_f32_bf16 v144, v96, v152
 v_dot2c_f32_bf16 v148, v96, v96
 v_dot2c_f32_bf16 v145, v97, v152
 v_dot2c_f32_bf16 v149, v97, v97
 v_dot2c_f32_bf16 v146, v98, v152
 v_dot2c_f32_bf16 v150, v98, v98
 v_dot2c_f32_bf16 v147, v99, v152
 v_dot2c_f32_bf16 v151, v99, v99
 v_dot2c_f32_bf16 v144, v100, v152
 v_dot2c_f32_bf16 v148, v100, v100
 v_dot2c_f32_bf16 v145, v101, v152
 v_dot2c_f32_bf16 v149, v101, v101
 v_dot2c_f32_bf16 v146, v102, v152
 v_dot2c_f32_bf16 v150, v102, v102
 v_dot2c_f32_bf16 v147, v103, v152
 v_dot2c_f32_bf16 v151, v103, v103
 v_dot2c_f32_bf16 v144, v104, v152
 v_dot2c_f32_bf16 v148, v104, v104
 v_dot2c_f32_bf16 v145, v105, v152
 v_dot2c_f32_bf16 v149, v105, v105
 v_dot2c_f32_bf16 v146, v106, v152
 v_dot2c_f32_bf16 v150, v106, v106
 v_dot2c_f32_bf16 v147, v107, v152
 v_dot2c_f32_bf16 v151, v107, v107
 v_dot2c_f32_bf16 v144, v108, v152
 v_dot2c_f32_bf16 v148, v108, v108
 v_dot2c_f32_bf16 v145, v109, v152
 v_dot2c_f32_bf16 v149, v109, v109
 v_dot2c_f32_bf16 v146, v110, v152
 v_dot2c_f32_bf16 v150, v110, v110
 v_dot2c_f32_bf16 v147, v111, v152
 v_dot2c_f32_bf16 v151, v111, v111
 s_waitcnt vmcnt(4)
 v_dot2c_f32_bf16 v144, v112, v152
 v_dot2c_f32_bf16 v148, v112, v112
 v_dot2c_f32_bf16 v145, v113, v152
 v_dot2c_f32_bf16 v149, v113, v113
 v_dot2c_f32_bf16 v146, v114, v152
 v_dot2c_f32_bf16 v150, v114, v114
 v_dot2c_f32_bf16 v147, v115, v152
 v_dot2c_f32_bf16 v151, v115, v115
 v_dot2c_f32_bf16 v144, v116, v152
 v_dot2c_f32_bf16 v148, v116, v116
 v_dot2c_f32_bf16 v145, v117, v152
 v_dot2c_f32_bf16 v149, v117, v117
 v_dot2c_f32_bf16 v146, v118, v152
 v_dot2c_f32_bf16 v150, v118, v118
 v_dot2c_f32_bf16 v147, v119, v152
 v_dot2c_f32_bf16 v151, v119, v119
 v_dot2c_f32_bf16 v144, v120, v152
 v_dot2c_f32_bf16 v148, v120, v120
 v_dot2c_f32_bf16 v145, v121, v152
 v_dot2c_f32_bf16 v149, v121, v121
 v_dot2c_f32_bf16 v146, v122, v152
 v_dot2c_f32_bf16 v150, v122, v122
 v_dot2c_f32_bf16 v147, v123, v152
 v_dot2c_f32_bf16 v151, v123, v123
 v_dot2c_f32_bf16 v144, v124, v152
 v_dot2c_f32_bf16 v148, v124, v124
 v_dot2c_f32_bf16 v145, v125, v152
 v_dot2c_f32_bf16 v149, v125, v125
 v_dot2c_f32_bf16 v146, v126, v152
 v_dot2c_f32_bf16 v150, v126, v126
 v_dot2c_f32_bf16 v147, v127, v152
 v_dot2c_f32_bf16 v151, v127, v127
 s_waitcnt vmcnt(0)
 v_dot2c_f32_bf16 v144, v128, v152
 v_dot2c_f32_bf16 v148, v128, v128
 v_dot2c_f32_bf16 v145, v129, v152
 v_dot2c_f32_bf16 v149, v129, v129
 v_dot2c_f32_bf16 v146, v130, v152
 v_dot2c_f32_bf16 v150, v130, v130
 v_dot2c_f32_bf16 v147, v131, v152
 v_dot2c_f32_bf16 v151, v131, v131
 v_dot2c_f32_bf16 v144, v132, v152
 v_dot2c_f32_bf16 v148, v132, v132
 v_dot2c_f32_bf16 v145, v133, v152
 v_dot2c_f32_bf16 v149, v133, v133
 v_dot2c_f32_bf16 v146, v134, v152
 v_dot2c_f32_bf16 v150, v134, v134
 v_dot2c_f32_bf16 v147, v135, v152
 v_dot2c_f32_bf16 v151, v135, v135
 v_dot2c_f32_bf16 v144, v136, v152
 v_dot2c_f32_bf16 v148, v136, v136
 v_dot2c_f32_bf16 v145, v137, v152
 v_dot2c_f32_bf16 v149, v137, v137
 v_dot2c_f32_bf16 v146, v138, v152
 v_dot2c_f32_bf16 v150, v138, v138
 v_dot2c_f32_bf16 v147, v139, v152
 v_dot2c_f32_bf16 v151, v139, v139
 v_dot2c_f32_bf16 v144, v140, v152
 v_dot2c_f32_bf16 v148, v140, v140
 v_dot2c_f32_bf16 v145, v141, v152
 v_dot2c_f32_bf16 v149, v141, v141
 v_dot2c_f32_bf16 v146, v142, v152
 v_dot2c_f32_bf16 v150, v142, v142
 v_dot2c_f32_bf16 v147, v143, v152
 v_dot2c_f32_bf16 v151, v143, v143
 s_nop 2
 v_add_f32 v144, v144, v145
 v_add_f32 v146, v146, v147
 v_add_f32 v144, v144, v146
 v_mov_b32 v145, v144
 v_add_f32 v148, v148, v149
 v_add_f32 v150, v150, v151
 v_add_f32 v148, v148, v150
 v_mov_b32 v149, v148
 s_nop 1
 v_permlane32_swap_b32 v144, v145
 v_permlane32_swap_b32 v148, v149
 v_add_f32 v144, v144, v145
 v_add_f32 v148, v148, v149
 v_mul_f32 v144, 0x3ae38e39, v144
 v_mul_f32 v148, 0x3ae38e39, v148
 v_fma_f32 v148, -v144, v144, v148
 v_max_f32 v148, 0, v148
 v_cvt_pk_bf16_f32 v145, v148, v144
 v_lshlrev_b32 v148, 16, v145
 v_and_b32 v144, 0xffff0000, v145
 v_add_f32 v148, 0x3727c5ac, v148
 v_cvt_pk_bf16_f32 v148, v148, v148
 v_lshlrev_b32 v148, 16, v148
 v_sqrt_f32 v148, v148
 s_nop 0
 v_cvt_pk_bf16_f32 v148, v148, v148
 v_lshlrev_b32 v148, 16, v148
 v_rcp_f32 v148, v148
 s_nop 0
 v_mul_f32 v144, v144, v148
 s_mov_b32 s78, 0xffff0000
 v_lshlrev_b32 v160, 16, v0
 v_and_b32 v161, s78, v0
 v_pk_fma_f32 v[160:161], v[160:161], v[148:149], v[144:145] op_sel_hi:[1,0,0] neg_lo:[0,0,1] neg_hi:[0,0,1]
 v_cvt_pk_bf16_f32 v0, v160, v161
 s_add_u32 m0, s57, 0
 s_nop 0
 buffer_load_dwordx4 v252, s[40:43], s54 offen  lds
 s_add_u32 s54, s54, s67
 v_lshlrev_b32 v162, 16, v1
 v_and_b32 v163, s78, v1
 v_pk_fma_f32 v[162:163], v[162:163], v[148:149], v[144:145] op_sel_hi:[1,0,0] neg_lo:[0,0,1] neg_hi:[0,0,1]
 v_cvt_pk_bf16_f32 v1, v162, v163
 v_lshlrev_b32 v164, 16, v2
 v_and_b32 v165, s78, v2
 v_pk_fma_f32 v[164:165], v[164:165], v[148:149], v[144:145] op_sel_hi:[1,0,0] neg_lo:[0,0,1] neg_hi:[0,0,1]
 v_cvt_pk_bf16_f32 v2, v164, v165
 v_lshlrev_b32 v166, 16, v3
 v_and_b32 v167, s78, v3
 v_pk_fma_f32 v[166:167], v[166:167], v[148:149], v[144:145] op_sel_hi:[1,0,0] neg_lo:[0,0,1] neg_hi:[0,0,1]
 v_cvt_pk_bf16_f32 v3, v166, v167
 v_lshlrev_b32 v160, 16, v4
 v_and_b32 v161, s78, v4
 v_pk_fma_f32 v[160:161], v[160:161], v[148:149], v[144:145] op_sel_hi:[1,0,0] neg_lo:[0,0,1] neg_hi:[0,0,1]
 v_cvt_pk_bf16_f32 v4, v160, v161
 s_add_u32 m0, s57, 4096
 s_nop 0
 buffer_load_dwordx4 v252, s[40:43], s54 offen  lds
 s_add_u32 s54, s54, s67
 v_lshlrev_b32 v162, 16, v5
 v_and_b32 v163, s78, v5
 v_pk_fma_f32 v[162:163], v[162:163], v[148:149], v[144:145] op_sel_hi:[1,0,0] neg_lo:[0,0,1] neg_hi:[0,0,1]
 v_cvt_pk_bf16_f32 v5, v162, v163
 v_lshlrev_b32 v164, 16, v6
 v_and_b32 v165, s78, v6
 v_pk_fma_f32 v[164:165], v[164:165], v[148:149], v[144:145] op_sel_hi:[1,0,0] neg_lo:[0,0,1] neg_hi:[0,0,1]
 v_cvt_pk_bf16_f32 v6, v164, v165
 v_lshlrev_b32 v166, 16, v7
 v_and_b32 v167, s78, v7
 v_pk_fma_f32 v[166:167], v[166:167], v[148:149], v[144:145] op_sel_hi:[1,0,0] neg_lo:[0,0,1] neg_hi:[0,0,1]
 v_cvt_pk_bf16_f32 v7, v166, v167
 v_lshlrev_b32 v160, 16, v8
 v_and_b32 v161, s78, v8
 v_pk_fma_f32 v[160:161], v[160:161], v[148:149], v[144:145] op_sel_hi:[1,0,0] neg_lo:[0,0,1] neg_hi:[0,0,1]
 v_cvt_pk_bf16_f32 v8, v160, v161
 s_add_u32 m0, s57, 8192
 s_nop 0
 buffer_load_dwordx4 v252, s[40:43], s54 offen  lds
 s_add_u32 s54, s54, s67
 v_lshlrev_b32 v162, 16, v9
 v_and_b32 v163, s78, v9
 v_pk_fma_f32 v[162:163], v[162:163], v[148:149], v[144:145] op_sel_hi:[1,0,0] neg_lo:[0,0,1] neg_hi:[0,0,1]
 v_cvt_pk_bf16_f32 v9, v162, v163
 v_lshlrev_b32 v164, 16, v10
 v_and_b32 v165, s78, v10
 v_pk_fma_f32 v[164:165], v[164:165], v[148:149], v[144:145] op_sel_hi:[1,0,0] neg_lo:[0,0,1] neg_hi:[0,0,1]
 v_cvt_pk_bf16_f32 v10, v164, v165
 v_lshlrev_b32 v166, 16, v11
 v_and_b32 v167, s78, v11
 v_pk_fma_f32 v[166:167], v[166:167], v[148:149], v[144:145] op_sel_hi:[1,0,0] neg_lo:[0,0,1] neg_hi:[0,0,1]
 v_cvt_pk_bf16_f32 v11, v166, v167
 v_lshlrev_b32 v160, 16, v12
 v_and_b32 v161, s78, v12
 v_pk_fma_f32 v[160:161], v[160:161], v[148:149], v[144:145] op_sel_hi:[1,0,0] neg_lo:[0,0,1] neg_hi:[0,0,1]
 v_cvt_pk_bf16_f32 v12, v160, v161
 s_add_u32 m0, s57, 12288
 s_nop 0
 buffer_load_dwordx4 v252, s[40:43], s54 offen  lds
 s_add_u32 s54, s54, s67
 v_lshlrev_b32 v162, 16, v13
 v_and_b32 v163, s78, v13
 v_pk_fma_f32 v[162:163], v[162:163], v[148:149], v[144:145] op_sel_hi:[1,0,0] neg_lo:[0,0,1] neg_hi:[0,0,1]
 v_cvt_pk_bf16_f32 v13, v162, v163
 v_lshlrev_b32 v164, 16, v14
 v_and_b32 v165, s78, v14
 v_pk_fma_f32 v[164:165], v[164:165], v[148:149], v[144:145] op_sel_hi:[1,0,0] neg_lo:[0,0,1] neg_hi:[0,0,1]
 v_cvt_pk_bf16_f32 v14, v164, v165
 v_lshlrev_b32 v166, 16, v15
 v_and_b32 v167, s78, v15
 v_pk_fma_f32 v[166:167], v[166:167], v[148:149], v[144:145] op_sel_hi:[1,0,0] neg_lo:[0,0,1] neg_hi:[0,0,1]
 v_cvt_pk_bf16_f32 v15, v166, v167
 v_lshlrev_b32 v160, 16, v16
 v_and_b32 v161, s78, v16
 v_pk_fma_f32 v[160:161], v[160:161], v[148:149], v[144:145] op_sel_hi:[1,0,0] neg_lo:[0,0,1] neg_hi:[0,0,1]
 v_cvt_pk_bf16_f32 v16, v160, v161
 s_add_u32 m0, s57, 16384
 s_nop 0
 buffer_load_dwordx4 v252, s[40:43], s54 offen  lds
 s_add_u32 s54, s54, s67
 v_lshlrev_b32 v162, 16, v17
 v_and_b32 v163, s78, v17
 v_pk_fma_f32 v[162:163], v[162:163], v[148:149], v[144:145] op_sel_hi:[1,0,0] neg_lo:[0,0,1] neg_hi:[0,0,1]
 v_cvt_pk_bf16_f32 v17, v162, v163
 v_lshlrev_b32 v164, 16, v18
 v_and_b32 v165, s78, v18
 v_pk_fma_f32 v[164:165], v[164:165], v[148:149], v[144:145] op_sel_hi:[1,0,0] neg_lo:[0,0,1] neg_hi:[0,0,1]
 v_cvt_pk_bf16_f32 v18, v164, v165
 v_lshlrev_b32 v166, 16, v19
 v_and_b32 v167, s78, v19
 v_pk_fma_f32 v[166:167], v[166:167], v[148:149], v[144:145] op_sel_hi:[1,0,0] neg_lo:[0,0,1] neg_hi:[0,0,1]
 v_cvt_pk_bf16_f32 v19, v166, v167
 v_lshlrev_b32 v160, 16, v20
 v_and_b32 v161, s78, v20
 v_pk_fma_f32 v[160:161], v[160:161], v[148:149], v[144:145] op_sel_hi:[1,0,0] neg_lo:[0,0,1] neg_hi:[0,0,1]
 v_cvt_pk_bf16_f32 v20, v160, v161
 s_add_u32 m0, s57, 20480
 s_nop 0
 buffer_load_dwordx4 v252, s[40:43], s54 offen  lds
 s_add_u32 s54, s54, s67
 v_lshlrev_b32 v162, 16, v21
 v_and_b32 v163, s78, v21
 v_pk_fma_f32 v[162:163], v[162:163], v[148:149], v[144:145] op_sel_hi:[1,0,0] neg_lo:[0,0,1] neg_hi:[0,0,1]
 v_cvt_pk_bf16_f32 v21, v162, v163
 v_lshlrev_b32 v164, 16, v22
 v_and_b32 v165, s78, v22
 v_pk_fma_f32 v[164:165], v[164:165], v[148:149], v[144:145] op_sel_hi:[1,0,0] neg_lo:[0,0,1] neg_hi:[0,0,1]
 v_cvt_pk_bf16_f32 v22, v164, v165
 v_lshlrev_b32 v166, 16, v23
 v_and_b32 v167, s78, v23
 v_pk_fma_f32 v[166:167], v[166:167], v[148:149], v[144:145] op_sel_hi:[1,0,0] neg_lo:[0,0,1] neg_hi:[0,0,1]
 v_cvt_pk_bf16_f32 v23, v166, v167
 v_lshlrev_b32 v160, 16, v24
 v_and_b32 v161, s78, v24
 v_pk_fma_f32 v[160:161], v[160:161], v[148:149], v[144:145] op_sel_hi:[1,0,0] neg_lo:[0,0,1] neg_hi:[0,0,1]
 v_cvt_pk_bf16_f32 v24, v160, v161
 s_add_u32 m0, s57, 24576
 s_nop 0
 buffer_load_dwordx4 v252, s[40:43], s54 offen  lds
 s_add_u32 s54, s54, s67
 v_lshlrev_b32 v162, 16, v25
 v_and_b32 v163, s78, v25
 v_pk_fma_f32 v[162:163], v[162:163], v[148:149], v[144:145] op_sel_hi:[1,0,0] neg_lo:[0,0,1] neg_hi:[0,0,1]
 v_cvt_pk_bf16_f32 v25, v162, v163
 v_lshlrev_b32 v164, 16, v26
 v_and_b32 v165, s78, v26
 v_pk_fma_f32 v[164:165], v[164:165], v[148:149], v[144:145] op_sel_hi:[1,0,0] neg_lo:[0,0,1] neg_hi:[0,0,1]
 v_cvt_pk_bf16_f32 v26, v164, v165
 v_lshlrev_b32 v166, 16, v27
 v_and_b32 v167, s78, v27
 v_pk_fma_f32 v[166:167], v[166:167], v[148:149], v[144:145] op_sel_hi:[1,0,0] neg_lo:[0,0,1] neg_hi:[0,0,1]
 v_cvt_pk_bf16_f32 v27, v166, v167
 v_lshlrev_b32 v160, 16, v28
 v_and_b32 v161, s78, v28
 v_pk_fma_f32 v[160:161], v[160:161], v[148:149], v[144:145] op_sel_hi:[1,0,0] neg_lo:[0,0,1] neg_hi:[0,0,1]
 v_cvt_pk_bf16_f32 v28, v160, v161
 s_add_u32 m0, s57, 28672
 s_nop 0
 buffer_load_dwordx4 v252, s[40:43], s54 offen  lds
 s_add_u32 s54, s54, s67
 v_lshlrev_b32 v162, 16, v29
 v_and_b32 v163, s78, v29
 v_pk_fma_f32 v[162:163], v[162:163], v[148:149], v[144:145] op_sel_hi:[1,0,0] neg_lo:[0,0,1] neg_hi:[0,0,1]
 v_cvt_pk_bf16_f32 v29, v162, v163
 v_lshlrev_b32 v164, 16, v30
 v_and_b32 v165, s78, v30
 v_pk_fma_f32 v[164:165], v[164:165], v[148:149], v[144:145] op_sel_hi:[1,0,0] neg_lo:[0,0,1] neg_hi:[0,0,1]
 v_cvt_pk_bf16_f32 v30, v164, v165
 v_lshlrev_b32 v166, 16, v31
 v_and_b32 v167, s78, v31
 v_pk_fma_f32 v[166:167], v[166:167], v[148:149], v[144:145] op_sel_hi:[1,0,0] neg_lo:[0,0,1] neg_hi:[0,0,1]
 v_cvt_pk_bf16_f32 v31, v166, v167
 v_lshlrev_b32 v160, 16, v32
 v_and_b32 v161, s78, v32
 v_pk_fma_f32 v[160:161], v[160:161], v[148:149], v[144:145] op_sel_hi:[1,0,0] neg_lo:[0,0,1] neg_hi:[0,0,1]
 v_cvt_pk_bf16_f32 v32, v160, v161
 s_add_u32 m0, s57, 32768
 s_nop 0
 buffer_load_dwordx4 v252, s[40:43], s54 offen  lds
 s_add_u32 s54, s54, s67
 v_lshlrev_b32 v162, 16, v33
 v_and_b32 v163, s78, v33
 v_pk_fma_f32 v[162:163], v[162:163], v[148:149], v[144:145] op_sel_hi:[1,0,0] neg_lo:[0,0,1] neg_hi:[0,0,1]
 v_cvt_pk_bf16_f32 v33, v162, v163
 v_lshlrev_b32 v164, 16, v34
 v_and_b32 v165, s78, v34
 v_pk_fma_f32 v[164:165], v[164:165], v[148:149], v[144:145] op_sel_hi:[1,0,0] neg_lo:[0,0,1] neg_hi:[0,0,1]
 v_cvt_pk_bf16_f32 v34, v164, v165
 v_lshlrev_b32 v166, 16, v35
 v_and_b32 v167, s78, v35
 v_pk_fma_f32 v[166:167], v[166:167], v[148:149], v[144:145] op_sel_hi:[1,0,0] neg_lo:[0,0,1] neg_hi:[0,0,1]
 v_cvt_pk_bf16_f32 v35, v166, v167
 v_lshlrev_b32 v160, 16, v36
 v_and_b32 v161, s78, v36
 v_pk_fma_f32 v[160:161], v[160:161], v[148:149], v[144:145] op_sel_hi:[1,0,0] neg_lo:[0,0,1] neg_hi:[0,0,1]
 v_cvt_pk_bf16_f32 v36, v160, v161
 s_add_u32 m0, s57, 36864
 s_nop 0
 buffer_load_dwordx4 v252, s[40:43], s54 offen  lds
 s_add_u32 s54, s54, s67
 v_lshlrev_b32 v162, 16, v37
 v_and_b32 v163, s78, v37
 v_pk_fma_f32 v[162:163], v[162:163], v[148:149], v[144:145] op_sel_hi:[1,0,0] neg_lo:[0,0,1] neg_hi:[0,0,1]
 v_cvt_pk_bf16_f32 v37, v162, v163
 v_lshlrev_b32 v164, 16, v38
 v_and_b32 v165, s78, v38
 v_pk_fma_f32 v[164:165], v[164:165], v[148:149], v[144:145] op_sel_hi:[1,0,0] neg_lo:[0,0,1] neg_hi:[0,0,1]
 v_cvt_pk_bf16_f32 v38, v164, v165
 v_lshlrev_b32 v166, 16, v39
 v_and_b32 v167, s78, v39
 v_pk_fma_f32 v[166:167], v[166:167], v[148:149], v[144:145] op_sel_hi:[1,0,0] neg_lo:[0,0,1] neg_hi:[0,0,1]
 v_cvt_pk_bf16_f32 v39, v166, v167
 v_lshlrev_b32 v160, 16, v40
 v_and_b32 v161, s78, v40
 v_pk_fma_f32 v[160:161], v[160:161], v[148:149], v[144:145] op_sel_hi:[1,0,0] neg_lo:[0,0,1] neg_hi:[0,0,1]
 v_cvt_pk_bf16_f32 v40, v160, v161
 s_add_u32 m0, s57, 40960
 s_nop 0
 buffer_load_dwordx4 v252, s[40:43], s54 offen  lds
 s_add_u32 s54, s54, s67
 v_lshlrev_b32 v162, 16, v41
 v_and_b32 v163, s78, v41
 v_pk_fma_f32 v[162:163], v[162:163], v[148:149], v[144:145] op_sel_hi:[1,0,0] neg_lo:[0,0,1] neg_hi:[0,0,1]
 v_cvt_pk_bf16_f32 v41, v162, v163
 v_lshlrev_b32 v164, 16, v42
 v_and_b32 v165, s78, v42
 v_pk_fma_f32 v[164:165], v[164:165], v[148:149], v[144:145] op_sel_hi:[1,0,0] neg_lo:[0,0,1] neg_hi:[0,0,1]
 v_cvt_pk_bf16_f32 v42, v164, v165
 v_lshlrev_b32 v166, 16, v43
 v_and_b32 v167, s78, v43
 v_pk_fma_f32 v[166:167], v[166:167], v[148:149], v[144:145] op_sel_hi:[1,0,0] neg_lo:[0,0,1] neg_hi:[0,0,1]
 v_cvt_pk_bf16_f32 v43, v166, v167
 v_lshlrev_b32 v160, 16, v44
 v_and_b32 v161, s78, v44
 v_pk_fma_f32 v[160:161], v[160:161], v[148:149], v[144:145] op_sel_hi:[1,0,0] neg_lo:[0,0,1] neg_hi:[0,0,1]
 v_cvt_pk_bf16_f32 v44, v160, v161
 s_add_u32 m0, s57, 45056
 s_nop 0
 buffer_load_dwordx4 v252, s[40:43], s54 offen  lds
 s_add_u32 s54, s54, s67
 v_lshlrev_b32 v162, 16, v45
 v_and_b32 v163, s78, v45
 v_pk_fma_f32 v[162:163], v[162:163], v[148:149], v[144:145] op_sel_hi:[1,0,0] neg_lo:[0,0,1] neg_hi:[0,0,1]
 v_cvt_pk_bf16_f32 v45, v162, v163
 v_lshlrev_b32 v164, 16, v46
 v_and_b32 v165, s78, v46
 v_pk_fma_f32 v[164:165], v[164:165], v[148:149], v[144:145] op_sel_hi:[1,0,0] neg_lo:[0,0,1] neg_hi:[0,0,1]
 v_cvt_pk_bf16_f32 v46, v164, v165
 v_lshlrev_b32 v166, 16, v47
 v_and_b32 v167, s78, v47
 v_pk_fma_f32 v[166:167], v[166:167], v[148:149], v[144:145] op_sel_hi:[1,0,0] neg_lo:[0,0,1] neg_hi:[0,0,1]
 v_cvt_pk_bf16_f32 v47, v166, v167
 v_lshlrev_b32 v160, 16, v48
 v_and_b32 v161, s78, v48
 v_pk_fma_f32 v[160:161], v[160:161], v[148:149], v[144:145] op_sel_hi:[1,0,0] neg_lo:[0,0,1] neg_hi:[0,0,1]
 v_cvt_pk_bf16_f32 v48, v160, v161
 s_add_u32 m0, s57, 49152
 s_nop 0
 buffer_load_dwordx4 v252, s[40:43], s54 offen  lds
 s_add_u32 s54, s54, s67
 v_lshlrev_b32 v162, 16, v49
 v_and_b32 v163, s78, v49
 v_pk_fma_f32 v[162:163], v[162:163], v[148:149], v[144:145] op_sel_hi:[1,0,0] neg_lo:[0,0,1] neg_hi:[0,0,1]
 v_cvt_pk_bf16_f32 v49, v162, v163
 v_lshlrev_b32 v164, 16, v50
 v_and_b32 v165, s78, v50
 v_pk_fma_f32 v[164:165], v[164:165], v[148:149], v[144:145] op_sel_hi:[1,0,0] neg_lo:[0,0,1] neg_hi:[0,0,1]
 v_cvt_pk_bf16_f32 v50, v164, v165
 v_lshlrev_b32 v166, 16, v51
 v_and_b32 v167, s78, v51
 v_pk_fma_f32 v[166:167], v[166:167], v[148:149], v[144:145] op_sel_hi:[1,0,0] neg_lo:[0,0,1] neg_hi:[0,0,1]
 v_cvt_pk_bf16_f32 v51, v166, v167
 v_lshlrev_b32 v160, 16, v52
 v_and_b32 v161, s78, v52
 v_pk_fma_f32 v[160:161], v[160:161], v[148:149], v[144:145] op_sel_hi:[1,0,0] neg_lo:[0,0,1] neg_hi:[0,0,1]
 v_cvt_pk_bf16_f32 v52, v160, v161
 s_add_u32 m0, s57, 53248
 s_nop 0
 buffer_load_dwordx4 v252, s[40:43], s54 offen  lds
 s_add_u32 s54, s54, s67
 v_lshlrev_b32 v162, 16, v53
 v_and_b32 v163, s78, v53
 v_pk_fma_f32 v[162:163], v[162:163], v[148:149], v[144:145] op_sel_hi:[1,0,0] neg_lo:[0,0,1] neg_hi:[0,0,1]
 v_cvt_pk_bf16_f32 v53, v162, v163
 v_lshlrev_b32 v164, 16, v54
 v_and_b32 v165, s78, v54
 v_pk_fma_f32 v[164:165], v[164:165], v[148:149], v[144:145] op_sel_hi:[1,0,0] neg_lo:[0,0,1] neg_hi:[0,0,1]
 v_cvt_pk_bf16_f32 v54, v164, v165
 v_lshlrev_b32 v166, 16, v55
 v_and_b32 v167, s78, v55
 v_pk_fma_f32 v[166:167], v[166:167], v[148:149], v[144:145] op_sel_hi:[1,0,0] neg_lo:[0,0,1] neg_hi:[0,0,1]
 v_cvt_pk_bf16_f32 v55, v166, v167
 v_lshlrev_b32 v160, 16, v56
 v_and_b32 v161, s78, v56
 v_pk_fma_f32 v[160:161], v[160:161], v[148:149], v[144:145] op_sel_hi:[1,0,0] neg_lo:[0,0,1] neg_hi:[0,0,1]
 v_cvt_pk_bf16_f32 v56, v160, v161
 s_add_u32 m0, s57, 57344
 s_nop 0
 buffer_load_dwordx4 v252, s[40:43], s54 offen  lds
 s_add_u32 s54, s54, s67
 v_lshlrev_b32 v162, 16, v57
 v_and_b32 v163, s78, v57
 v_pk_fma_f32 v[162:163], v[162:163], v[148:149], v[144:145] op_sel_hi:[1,0,0] neg_lo:[0,0,1] neg_hi:[0,0,1]
 v_cvt_pk_bf16_f32 v57, v162, v163
 v_lshlrev_b32 v164, 16, v58
 v_and_b32 v165, s78, v58
 v_pk_fma_f32 v[164:165], v[164:165], v[148:149], v[144:145] op_sel_hi:[1,0,0] neg_lo:[0,0,1] neg_hi:[0,0,1]
 v_cvt_pk_bf16_f32 v58, v164, v165
 v_lshlrev_b32 v166, 16, v59
 v_and_b32 v167, s78, v59
 v_pk_fma_f32 v[166:167], v[166:167], v[148:149], v[144:145] op_sel_hi:[1,0,0] neg_lo:[0,0,1] neg_hi:[0,0,1]
 v_cvt_pk_bf16_f32 v59, v166, v167
 v_lshlrev_b32 v160, 16, v60
 v_and_b32 v161, s78, v60
 v_pk_fma_f32 v[160:161], v[160:161], v[148:149], v[144:145] op_sel_hi:[1,0,0] neg_lo:[0,0,1] neg_hi:[0,0,1]
 v_cvt_pk_bf16_f32 v60, v160, v161
 s_add_u32 m0, s57, 61440
 s_nop 0
 buffer_load_dwordx4 v252, s[40:43], s54 offen  lds
 s_add_u32 s54, s54, s67
 v_lshlrev_b32 v162, 16, v61
 v_and_b32 v163, s78, v61
 v_pk_fma_f32 v[162:163], v[162:163], v[148:149], v[144:145] op_sel_hi:[1,0,0] neg_lo:[0,0,1] neg_hi:[0,0,1]
 v_cvt_pk_bf16_f32 v61, v162, v163
 v_lshlrev_b32 v164, 16, v62
 v_and_b32 v165, s78, v62
 v_pk_fma_f32 v[164:165], v[164:165], v[148:149], v[144:145] op_sel_hi:[1,0,0] neg_lo:[0,0,1] neg_hi:[0,0,1]
 v_cvt_pk_bf16_f32 v62, v164, v165
 v_lshlrev_b32 v166, 16, v63
 v_and_b32 v167, s78, v63
 v_pk_fma_f32 v[166:167], v[166:167], v[148:149], v[144:145] op_sel_hi:[1,0,0] neg_lo:[0,0,1] neg_hi:[0,0,1]
 v_cvt_pk_bf16_f32 v63, v166, v167
 v_lshlrev_b32 v160, 16, v64
 v_and_b32 v161, s78, v64
 v_pk_fma_f32 v[160:161], v[160:161], v[148:149], v[144:145] op_sel_hi:[1,0,0] neg_lo:[0,0,1] neg_hi:[0,0,1]
 v_cvt_pk_bf16_f32 v64, v160, v161
 s_add_u32 m0, s57, 65536
 s_nop 0
 buffer_load_dwordx4 v252, s[40:43], s54 offen  lds
 s_add_u32 s54, s54, s67
 v_lshlrev_b32 v162, 16, v65
 v_and_b32 v163, s78, v65
 v_pk_fma_f32 v[162:163], v[162:163], v[148:149], v[144:145] op_sel_hi:[1,0,0] neg_lo:[0,0,1] neg_hi:[0,0,1]
 v_cvt_pk_bf16_f32 v65, v162, v163
 v_lshlrev_b32 v164, 16, v66
 v_and_b32 v165, s78, v66
 v_pk_fma_f32 v[164:165], v[164:165], v[148:149], v[144:145] op_sel_hi:[1,0,0] neg_lo:[0,0,1] neg_hi:[0,0,1]
 v_cvt_pk_bf16_f32 v66, v164, v165
 v_lshlrev_b32 v166, 16, v67
 v_and_b32 v167, s78, v67
 v_pk_fma_f32 v[166:167], v[166:167], v[148:149], v[144:145] op_sel_hi:[1,0,0] neg_lo:[0,0,1] neg_hi:[0,0,1]
 v_cvt_pk_bf16_f32 v67, v166, v167
 v_lshlrev_b32 v160, 16, v68
 v_and_b32 v161, s78, v68
 v_pk_fma_f32 v[160:161], v[160:161], v[148:149], v[144:145] op_sel_hi:[1,0,0] neg_lo:[0,0,1] neg_hi:[0,0,1]
 v_cvt_pk_bf16_f32 v68, v160, v161
 s_add_u32 m0, s57, 69632
 s_nop 0
 buffer_load_dwordx4 v252, s[40:43], s54 offen  lds
 s_add_u32 s54, s54, s67
 v_lshlrev_b32 v162, 16, v69
 v_and_b32 v163, s78, v69
 v_pk_fma_f32 v[162:163], v[162:163], v[148:149], v[144:145] op_sel_hi:[1,0,0] neg_lo:[0,0,1] neg_hi:[0,0,1]
 v_cvt_pk_bf16_f32 v69, v162, v163
 v_lshlrev_b32 v164, 16, v70
 v_and_b32 v165, s78, v70
 v_pk_fma_f32 v[164:165], v[164:165], v[148:149], v[144:145] op_sel_hi:[1,0,0] neg_lo:[0,0,1] neg_hi:[0,0,1]
 v_cvt_pk_bf16_f32 v70, v164, v165
 v_lshlrev_b32 v166, 16, v71
 v_and_b32 v167, s78, v71
 v_pk_fma_f32 v[166:167], v[166:167], v[148:149], v[144:145] op_sel_hi:[1,0,0] neg_lo:[0,0,1] neg_hi:[0,0,1]
 v_cvt_pk_bf16_f32 v71, v166, v167
 v_lshlrev_b32 v160, 16, v72
 v_and_b32 v161, s78, v72
 v_pk_fma_f32 v[160:161], v[160:161], v[148:149], v[144:145] op_sel_hi:[1,0,0] neg_lo:[0,0,1] neg_hi:[0,0,1]
 v_cvt_pk_bf16_f32 v72, v160, v161
 v_lshlrev_b32 v162, 16, v73
 v_and_b32 v163, s78, v73
 v_pk_fma_f32 v[162:163], v[162:163], v[148:149], v[144:145] op_sel_hi:[1,0,0] neg_lo:[0,0,1] neg_hi:[0,0,1]
 v_cvt_pk_bf16_f32 v73, v162, v163
 v_lshlrev_b32 v164, 16, v74
 v_and_b32 v165, s78, v74
 v_pk_fma_f32 v[164:165], v[164:165], v[148:149], v[144:145] op_sel_hi:[1,0,0] neg_lo:[0,0,1] neg_hi:[0,0,1]
 v_cvt_pk_bf16_f32 v74, v164, v165
 v_lshlrev_b32 v166, 16, v75
 v_and_b32 v167, s78, v75
 v_pk_fma_f32 v[166:167], v[166:167], v[148:149], v[144:145] op_sel_hi:[1,0,0] neg_lo:[0,0,1] neg_hi:[0,0,1]
 v_cvt_pk_bf16_f32 v75, v166, v167
 v_lshlrev_b32 v160, 16, v76
 v_and_b32 v161, s78, v76
 v_pk_fma_f32 v[160:161], v[160:161], v[148:149], v[144:145] op_sel_hi:[1,0,0] neg_lo:[0,0,1] neg_hi:[0,0,1]
 v_cvt_pk_bf16_f32 v76, v160, v161
 v_lshlrev_b32 v162, 16, v77
 v_and_b32 v163, s78, v77
 v_pk_fma_f32 v[162:163], v[162:163], v[148:149], v[144:145] op_sel_hi:[1,0,0] neg_lo:[0,0,1] neg_hi:[0,0,1]
 v_cvt_pk_bf16_f32 v77, v162, v163
 v_lshlrev_b32 v164, 16, v78
 v_and_b32 v165, s78, v78
 v_pk_fma_f32 v[164:165], v[164:165], v[148:149], v[144:145] op_sel_hi:[1,0,0] neg_lo:[0,0,1] neg_hi:[0,0,1]
 v_cvt_pk_bf16_f32 v78, v164, v165
 v_lshlrev_b32 v166, 16, v79
 v_and_b32 v167, s78, v79
 v_pk_fma_f32 v[166:167], v[166:167], v[148:149], v[144:145] op_sel_hi:[1,0,0] neg_lo:[0,0,1] neg_hi:[0,0,1]
 v_cvt_pk_bf16_f32 v79, v166, v167
 v_lshlrev_b32 v160, 16, v80
 v_and_b32 v161, s78, v80
 v_pk_fma_f32 v[160:161], v[160:161], v[148:149], v[144:145] op_sel_hi:[1,0,0] neg_lo:[0,0,1] neg_hi:[0,0,1]
 v_cvt_pk_bf16_f32 v80, v160, v161
 v_lshlrev_b32 v162, 16, v81
 v_and_b32 v163, s78, v81
 v_pk_fma_f32 v[162:163], v[162:163], v[148:149], v[144:145] op_sel_hi:[1,0,0] neg_lo:[0,0,1] neg_hi:[0,0,1]
 v_cvt_pk_bf16_f32 v81, v162, v163
 v_lshlrev_b32 v164, 16, v82
 v_and_b32 v165, s78, v82
 v_pk_fma_f32 v[164:165], v[164:165], v[148:149], v[144:145] op_sel_hi:[1,0,0] neg_lo:[0,0,1] neg_hi:[0,0,1]
 v_cvt_pk_bf16_f32 v82, v164, v165
 v_lshlrev_b32 v166, 16, v83
 v_and_b32 v167, s78, v83
 v_pk_fma_f32 v[166:167], v[166:167], v[148:149], v[144:145] op_sel_hi:[1,0,0] neg_lo:[0,0,1] neg_hi:[0,0,1]
 v_cvt_pk_bf16_f32 v83, v166, v167
 v_lshlrev_b32 v160, 16, v84
 v_and_b32 v161, s78, v84
 v_pk_fma_f32 v[160:161], v[160:161], v[148:149], v[144:145] op_sel_hi:[1,0,0] neg_lo:[0,0,1] neg_hi:[0,0,1]
 v_cvt_pk_bf16_f32 v84, v160, v161
 v_lshlrev_b32 v162, 16, v85
 v_and_b32 v163, s78, v85
 v_pk_fma_f32 v[162:163], v[162:163], v[148:149], v[144:145] op_sel_hi:[1,0,0] neg_lo:[0,0,1] neg_hi:[0,0,1]
 v_cvt_pk_bf16_f32 v85, v162, v163
 v_lshlrev_b32 v164, 16, v86
 v_and_b32 v165, s78, v86
 v_pk_fma_f32 v[164:165], v[164:165], v[148:149], v[144:145] op_sel_hi:[1,0,0] neg_lo:[0,0,1] neg_hi:[0,0,1]
 v_cvt_pk_bf16_f32 v86, v164, v165
 v_lshlrev_b32 v166, 16, v87
 v_and_b32 v167, s78, v87
 v_pk_fma_f32 v[166:167], v[166:167], v[148:149], v[144:145] op_sel_hi:[1,0,0] neg_lo:[0,0,1] neg_hi:[0,0,1]
 v_cvt_pk_bf16_f32 v87, v166, v167
 v_lshlrev_b32 v160, 16, v88
 v_and_b32 v161, s78, v88
 v_pk_fma_f32 v[160:161], v[160:161], v[148:149], v[144:145] op_sel_hi:[1,0,0] neg_lo:[0,0,1] neg_hi:[0,0,1]
 v_cvt_pk_bf16_f32 v88, v160, v161
 v_lshlrev_b32 v162, 16, v89
 v_and_b32 v163, s78, v89
 v_pk_fma_f32 v[162:163], v[162:163], v[148:149], v[144:145] op_sel_hi:[1,0,0] neg_lo:[0,0,1] neg_hi:[0,0,1]
 v_cvt_pk_bf16_f32 v89, v162, v163
 v_lshlrev_b32 v164, 16, v90
 v_and_b32 v165, s78, v90
 v_pk_fma_f32 v[164:165], v[164:165], v[148:149], v[144:145] op_sel_hi:[1,0,0] neg_lo:[0,0,1] neg_hi:[0,0,1]
 v_cvt_pk_bf16_f32 v90, v164, v165
 v_lshlrev_b32 v166, 16, v91
 v_and_b32 v167, s78, v91
 v_pk_fma_f32 v[166:167], v[166:167], v[148:149], v[144:145] op_sel_hi:[1,0,0] neg_lo:[0,0,1] neg_hi:[0,0,1]
 v_cvt_pk_bf16_f32 v91, v166, v167
 v_lshlrev_b32 v160, 16, v92
 v_and_b32 v161, s78, v92
 v_pk_fma_f32 v[160:161], v[160:161], v[148:149], v[144:145] op_sel_hi:[1,0,0] neg_lo:[0,0,1] neg_hi:[0,0,1]
 v_cvt_pk_bf16_f32 v92, v160, v161
 v_lshlrev_b32 v162, 16, v93
 v_and_b32 v163, s78, v93
 v_pk_fma_f32 v[162:163], v[162:163], v[148:149], v[144:145] op_sel_hi:[1,0,0] neg_lo:[0,0,1] neg_hi:[0,0,1]
 v_cvt_pk_bf16_f32 v93, v162, v163
 v_lshlrev_b32 v164, 16, v94
 v_and_b32 v165, s78, v94
 v_pk_fma_f32 v[164:165], v[164:165], v[148:149], v[144:145] op_sel_hi:[1,0,0] neg_lo:[0,0,1] neg_hi:[0,0,1]
 v_cvt_pk_bf16_f32 v94, v164, v165
 v_lshlrev_b32 v166, 16, v95
 v_and_b32 v167, s78, v95
 v_pk_fma_f32 v[166:167], v[166:167], v[148:149], v[144:145] op_sel_hi:[1,0,0] neg_lo:[0,0,1] neg_hi:[0,0,1]
 v_cvt_pk_bf16_f32 v95, v166, v167
 v_lshlrev_b32 v160, 16, v96
 v_and_b32 v161, s78, v96
 v_pk_fma_f32 v[160:161], v[160:161], v[148:149], v[144:145] op_sel_hi:[1,0,0] neg_lo:[0,0,1] neg_hi:[0,0,1]
 v_cvt_pk_bf16_f32 v96, v160, v161
 v_lshlrev_b32 v162, 16, v97
 v_and_b32 v163, s78, v97
 v_pk_fma_f32 v[162:163], v[162:163], v[148:149], v[144:145] op_sel_hi:[1,0,0] neg_lo:[0,0,1] neg_hi:[0,0,1]
 v_cvt_pk_bf16_f32 v97, v162, v163
 v_lshlrev_b32 v164, 16, v98
 v_and_b32 v165, s78, v98
 v_pk_fma_f32 v[164:165], v[164:165], v[148:149], v[144:145] op_sel_hi:[1,0,0] neg_lo:[0,0,1] neg_hi:[0,0,1]
 v_cvt_pk_bf16_f32 v98, v164, v165
 v_lshlrev_b32 v166, 16, v99
 v_and_b32 v167, s78, v99
 v_pk_fma_f32 v[166:167], v[166:167], v[148:149], v[144:145] op_sel_hi:[1,0,0] neg_lo:[0,0,1] neg_hi:[0,0,1]
 v_cvt_pk_bf16_f32 v99, v166, v167
 v_lshlrev_b32 v160, 16, v100
 v_and_b32 v161, s78, v100
 v_pk_fma_f32 v[160:161], v[160:161], v[148:149], v[144:145] op_sel_hi:[1,0,0] neg_lo:[0,0,1] neg_hi:[0,0,1]
 v_cvt_pk_bf16_f32 v100, v160, v161
 v_lshlrev_b32 v162, 16, v101
 v_and_b32 v163, s78, v101
 v_pk_fma_f32 v[162:163], v[162:163], v[148:149], v[144:145] op_sel_hi:[1,0,0] neg_lo:[0,0,1] neg_hi:[0,0,1]
 v_cvt_pk_bf16_f32 v101, v162, v163
 v_lshlrev_b32 v164, 16, v102
 v_and_b32 v165, s78, v102
 v_pk_fma_f32 v[164:165], v[164:165], v[148:149], v[144:145] op_sel_hi:[1,0,0] neg_lo:[0,0,1] neg_hi:[0,0,1]
 v_cvt_pk_bf16_f32 v102, v164, v165
 v_lshlrev_b32 v166, 16, v103
 v_and_b32 v167, s78, v103
 v_pk_fma_f32 v[166:167], v[166:167], v[148:149], v[144:145] op_sel_hi:[1,0,0] neg_lo:[0,0,1] neg_hi:[0,0,1]
 v_cvt_pk_bf16_f32 v103, v166, v167
 v_lshlrev_b32 v160, 16, v104
 v_and_b32 v161, s78, v104
 v_pk_fma_f32 v[160:161], v[160:161], v[148:149], v[144:145] op_sel_hi:[1,0,0] neg_lo:[0,0,1] neg_hi:[0,0,1]
 v_cvt_pk_bf16_f32 v104, v160, v161
 v_lshlrev_b32 v162, 16, v105
 v_and_b32 v163, s78, v105
 v_pk_fma_f32 v[162:163], v[162:163], v[148:149], v[144:145] op_sel_hi:[1,0,0] neg_lo:[0,0,1] neg_hi:[0,0,1]
 v_cvt_pk_bf16_f32 v105, v162, v163
 v_lshlrev_b32 v164, 16, v106
 v_and_b32 v165, s78, v106
 v_pk_fma_f32 v[164:165], v[164:165], v[148:149], v[144:145] op_sel_hi:[1,0,0] neg_lo:[0,0,1] neg_hi:[0,0,1]
 v_cvt_pk_bf16_f32 v106, v164, v165
 v_lshlrev_b32 v166, 16, v107
 v_and_b32 v167, s78, v107
 v_pk_fma_f32 v[166:167], v[166:167], v[148:149], v[144:145] op_sel_hi:[1,0,0] neg_lo:[0,0,1] neg_hi:[0,0,1]
 v_cvt_pk_bf16_f32 v107, v166, v167
 v_lshlrev_b32 v160, 16, v108
 v_and_b32 v161, s78, v108
 v_pk_fma_f32 v[160:161], v[160:161], v[148:149], v[144:145] op_sel_hi:[1,0,0] neg_lo:[0,0,1] neg_hi:[0,0,1]
 v_cvt_pk_bf16_f32 v108, v160, v161
 v_lshlrev_b32 v162, 16, v109
 v_and_b32 v163, s78, v109
 v_pk_fma_f32 v[162:163], v[162:163], v[148:149], v[144:145] op_sel_hi:[1,0,0] neg_lo:[0,0,1] neg_hi:[0,0,1]
 v_cvt_pk_bf16_f32 v109, v162, v163
 v_lshlrev_b32 v164, 16, v110
 v_and_b32 v165, s78, v110
 v_pk_fma_f32 v[164:165], v[164:165], v[148:149], v[144:145] op_sel_hi:[1,0,0] neg_lo:[0,0,1] neg_hi:[0,0,1]
 v_cvt_pk_bf16_f32 v110, v164, v165
 v_lshlrev_b32 v166, 16, v111
 v_and_b32 v167, s78, v111
 v_pk_fma_f32 v[166:167], v[166:167], v[148:149], v[144:145] op_sel_hi:[1,0,0] neg_lo:[0,0,1] neg_hi:[0,0,1]
 v_cvt_pk_bf16_f32 v111, v166, v167
 v_lshlrev_b32 v160, 16, v112
 v_and_b32 v161, s78, v112
 v_pk_fma_f32 v[160:161], v[160:161], v[148:149], v[144:145] op_sel_hi:[1,0,0] neg_lo:[0,0,1] neg_hi:[0,0,1]
 v_cvt_pk_bf16_f32 v112, v160, v161
 v_lshlrev_b32 v162, 16, v113
 v_and_b32 v163, s78, v113
 v_pk_fma_f32 v[162:163], v[162:163], v[148:149], v[144:145] op_sel_hi:[1,0,0] neg_lo:[0,0,1] neg_hi:[0,0,1]
 v_cvt_pk_bf16_f32 v113, v162, v163
 v_lshlrev_b32 v164, 16, v114
 v_and_b32 v165, s78, v114
 v_pk_fma_f32 v[164:165], v[164:165], v[148:149], v[144:145] op_sel_hi:[1,0,0] neg_lo:[0,0,1] neg_hi:[0,0,1]
 v_cvt_pk_bf16_f32 v114, v164, v165
 v_lshlrev_b32 v166, 16, v115
 v_and_b32 v167, s78, v115
 v_pk_fma_f32 v[166:167], v[166:167], v[148:149], v[144:145] op_sel_hi:[1,0,0] neg_lo:[0,0,1] neg_hi:[0,0,1]
 v_cvt_pk_bf16_f32 v115, v166, v167
 v_lshlrev_b32 v160, 16, v116
 v_and_b32 v161, s78, v116
 v_pk_fma_f32 v[160:161], v[160:161], v[148:149], v[144:145] op_sel_hi:[1,0,0] neg_lo:[0,0,1] neg_hi:[0,0,1]
 v_cvt_pk_bf16_f32 v116, v160, v161
 v_lshlrev_b32 v162, 16, v117
 v_and_b32 v163, s78, v117
 v_pk_fma_f32 v[162:163], v[162:163], v[148:149], v[144:145] op_sel_hi:[1,0,0] neg_lo:[0,0,1] neg_hi:[0,0,1]
 v_cvt_pk_bf16_f32 v117, v162, v163
 v_lshlrev_b32 v164, 16, v118
 v_and_b32 v165, s78, v118
 v_pk_fma_f32 v[164:165], v[164:165], v[148:149], v[144:145] op_sel_hi:[1,0,0] neg_lo:[0,0,1] neg_hi:[0,0,1]
 v_cvt_pk_bf16_f32 v118, v164, v165
 v_lshlrev_b32 v166, 16, v119
 v_and_b32 v167, s78, v119
 v_pk_fma_f32 v[166:167], v[166:167], v[148:149], v[144:145] op_sel_hi:[1,0,0] neg_lo:[0,0,1] neg_hi:[0,0,1]
 v_cvt_pk_bf16_f32 v119, v166, v167
 v_lshlrev_b32 v160, 16, v120
 v_and_b32 v161, s78, v120
 v_pk_fma_f32 v[160:161], v[160:161], v[148:149], v[144:145] op_sel_hi:[1,0,0] neg_lo:[0,0,1] neg_hi:[0,0,1]
 v_cvt_pk_bf16_f32 v120, v160, v161
 v_lshlrev_b32 v162, 16, v121
 v_and_b32 v163, s78, v121
 v_pk_fma_f32 v[162:163], v[162:163], v[148:149], v[144:145] op_sel_hi:[1,0,0] neg_lo:[0,0,1] neg_hi:[0,0,1]
 v_cvt_pk_bf16_f32 v121, v162, v163
 v_lshlrev_b32 v164, 16, v122
 v_and_b32 v165, s78, v122
 v_pk_fma_f32 v[164:165], v[164:165], v[148:149], v[144:145] op_sel_hi:[1,0,0] neg_lo:[0,0,1] neg_hi:[0,0,1]
 v_cvt_pk_bf16_f32 v122, v164, v165
 v_lshlrev_b32 v166, 16, v123
 v_and_b32 v167, s78, v123
 v_pk_fma_f32 v[166:167], v[166:167], v[148:149], v[144:145] op_sel_hi:[1,0,0] neg_lo:[0,0,1] neg_hi:[0,0,1]
 v_cvt_pk_bf16_f32 v123, v166, v167
 v_lshlrev_b32 v160, 16, v124
 v_and_b32 v161, s78, v124
 v_pk_fma_f32 v[160:161], v[160:161], v[148:149], v[144:145] op_sel_hi:[1,0,0] neg_lo:[0,0,1] neg_hi:[0,0,1]
 v_cvt_pk_bf16_f32 v124, v160, v161
 v_lshlrev_b32 v162, 16, v125
 v_and_b32 v163, s78, v125
 v_pk_fma_f32 v[162:163], v[162:163], v[148:149], v[144:145] op_sel_hi:[1,0,0] neg_lo:[0,0,1] neg_hi:[0,0,1]
 v_cvt_pk_bf16_f32 v125, v162, v163
 v_lshlrev_b32 v164, 16, v126
 v_and_b32 v165, s78, v126
 v_pk_fma_f32 v[164:165], v[164:165], v[148:149], v[144:145] op_sel_hi:[1,0,0] neg_lo:[0,0,1] neg_hi:[0,0,1]
 v_cvt_pk_bf16_f32 v126, v164, v165
 v_lshlrev_b32 v166, 16, v127
 v_and_b32 v167, s78, v127
 v_pk_fma_f32 v[166:167], v[166:167], v[148:149], v[144:145] op_sel_hi:[1,0,0] neg_lo:[0,0,1] neg_hi:[0,0,1]
 v_cvt_pk_bf16_f32 v127, v166, v167
 v_lshlrev_b32 v160, 16, v128
 v_and_b32 v161, s78, v128
 v_pk_fma_f32 v[160:161], v[160:161], v[148:149], v[144:145] op_sel_hi:[1,0,0] neg_lo:[0,0,1] neg_hi:[0,0,1]
 v_cvt_pk_bf16_f32 v128, v160, v161
 v_lshlrev_b32 v162, 16, v129
 v_and_b32 v163, s78, v129
 v_pk_fma_f32 v[162:163], v[162:163], v[148:149], v[144:145] op_sel_hi:[1,0,0] neg_lo:[0,0,1] neg_hi:[0,0,1]
 v_cvt_pk_bf16_f32 v129, v162, v163
 v_lshlrev_b32 v164, 16, v130
 v_and_b32 v165, s78, v130
 v_pk_fma_f32 v[164:165], v[164:165], v[148:149], v[144:145] op_sel_hi:[1,0,0] neg_lo:[0,0,1] neg_hi:[0,0,1]
 v_cvt_pk_bf16_f32 v130, v164, v165
 v_lshlrev_b32 v166, 16, v131
 v_and_b32 v167, s78, v131
 v_pk_fma_f32 v[166:167], v[166:167], v[148:149], v[144:145] op_sel_hi:[1,0,0] neg_lo:[0,0,1] neg_hi:[0,0,1]
 v_cvt_pk_bf16_f32 v131, v166, v167
 v_lshlrev_b32 v160, 16, v132
 v_and_b32 v161, s78, v132
 v_pk_fma_f32 v[160:161], v[160:161], v[148:149], v[144:145] op_sel_hi:[1,0,0] neg_lo:[0,0,1] neg_hi:[0,0,1]
 v_cvt_pk_bf16_f32 v132, v160, v161
 v_lshlrev_b32 v162, 16, v133
 v_and_b32 v163, s78, v133
 v_pk_fma_f32 v[162:163], v[162:163], v[148:149], v[144:145] op_sel_hi:[1,0,0] neg_lo:[0,0,1] neg_hi:[0,0,1]
 v_cvt_pk_bf16_f32 v133, v162, v163
 v_lshlrev_b32 v164, 16, v134
 v_and_b32 v165, s78, v134
 v_pk_fma_f32 v[164:165], v[164:165], v[148:149], v[144:145] op_sel_hi:[1,0,0] neg_lo:[0,0,1] neg_hi:[0,0,1]
 v_cvt_pk_bf16_f32 v134, v164, v165
 v_lshlrev_b32 v166, 16, v135
 v_and_b32 v167, s78, v135
 v_pk_fma_f32 v[166:167], v[166:167], v[148:149], v[144:145] op_sel_hi:[1,0,0] neg_lo:[0,0,1] neg_hi:[0,0,1]
 v_cvt_pk_bf16_f32 v135, v166, v167
 v_lshlrev_b32 v160, 16, v136
 v_and_b32 v161, s78, v136
 v_pk_fma_f32 v[160:161], v[160:161], v[148:149], v[144:145] op_sel_hi:[1,0,0] neg_lo:[0,0,1] neg_hi:[0,0,1]
 v_cvt_pk_bf16_f32 v136, v160, v161
 v_lshlrev_b32 v162, 16, v137
 v_and_b32 v163, s78, v137
 v_pk_fma_f32 v[162:163], v[162:163], v[148:149], v[144:145] op_sel_hi:[1,0,0] neg_lo:[0,0,1] neg_hi:[0,0,1]
 v_cvt_pk_bf16_f32 v137, v162, v163
 v_lshlrev_b32 v164, 16, v138
 v_and_b32 v165, s78, v138
 v_pk_fma_f32 v[164:165], v[164:165], v[148:149], v[144:145] op_sel_hi:[1,0,0] neg_lo:[0,0,1] neg_hi:[0,0,1]
 v_cvt_pk_bf16_f32 v138, v164, v165
 v_lshlrev_b32 v166, 16, v139
 v_and_b32 v167, s78, v139
 v_pk_fma_f32 v[166:167], v[166:167], v[148:149], v[144:145] op_sel_hi:[1,0,0] neg_lo:[0,0,1] neg_hi:[0,0,1]
 v_cvt_pk_bf16_f32 v139, v166, v167
 v_lshlrev_b32 v160, 16, v140
 v_and_b32 v161, s78, v140
 v_pk_fma_f32 v[160:161], v[160:161], v[148:149], v[144:145] op_sel_hi:[1,0,0] neg_lo:[0,0,1] neg_hi:[0,0,1]
 v_cvt_pk_bf16_f32 v140, v160, v161
 v_lshlrev_b32 v162, 16, v141
 v_and_b32 v163, s78, v141
 v_pk_fma_f32 v[162:163], v[162:163], v[148:149], v[144:145] op_sel_hi:[1,0,0] neg_lo:[0,0,1] neg_hi:[0,0,1]
 v_cvt_pk_bf16_f32 v141, v162, v163
 v_lshlrev_b32 v164, 16, v142
 v_and_b32 v165, s78, v142
 v_pk_fma_f32 v[164:165], v[164:165], v[148:149], v[144:145] op_sel_hi:[1,0,0] neg_lo:[0,0,1] neg_hi:[0,0,1]
 v_cvt_pk_bf16_f32 v142, v164, v165
 v_lshlrev_b32 v166, 16, v143
 v_and_b32 v167, s78, v143
 v_pk_fma_f32 v[166:167], v[166:167], v[148:149], v[144:145] op_sel_hi:[1,0,0] neg_lo:[0,0,1] neg_hi:[0,0,1]
 v_cvt_pk_bf16_f32 v143, v166, v167
 v_lshrrev_b32 v247, 2, v246
 s_mov_b32 s88, 0
L_cnt_283:
 global_load_dword v248, v247, s[44:45] sc1
 s_add_u32 s88, s88, 1
 s_cmp_gt_u32 s88, 100000
 s_cbranch_scc1 L_exit2
 s_waitcnt vmcnt(0)
 v_readlane_b32 s3, v248, 60
 s_cmp_lt_u32 s3, 32
 s_cbranch_scc1 L_cnt_283
 s_mov_b32 s3, 0
 v_readlane_b32 s80, v248, 0
 s_add_u32 s3, s3, s80
 v_readlane_b32 s81, v248, 1
 s_add_u32 s3, s3, s81
 v_readlane_b32 s82, v248, 18
 s_add_u32 s3, s3, s82
 v_readlane_b32 s83, v248, 19
 s_add_u32 s3, s3, s83
 v_readlane_b32 s84, v248, 36
 s_add_u32 s3, s3, s84
 v_readlane_b32 s85, v248, 37
 s_add_u32 s3, s3, s85
 v_readlane_b32 s86, v248, 54
 s_add_u32 s3, s3, s86
 v_readlane_b32 s87, v248, 55
 s_add_u32 s3, s3, s87
 s_cmp_lt_u32 s3, 256
 s_cbranch_scc1 L_cnt_283
 s_mov_b32 s49, 1
 s_cmp_eq_u32 s80, 32
 s_cselect_b32 s49, s49, 0
 s_cmp_eq_u32 s81, 32
 s_cselect_b32 s49, s49, 0
 s_cmp_eq_u32 s82, 32
 s_cselect_b32 s49, s49, 0
 s_cmp_eq_u32 s83, 32
 s_cselect_b32 s49, s49, 0
 s_cmp_eq_u32 s84, 32
 s_cselect_b32 s49, s49, 0
 s_cmp_eq_u32 s85, 32
 s_cselect_b32 s49, s49, 0
 s_cmp_eq_u32 s86, 32
 s_cselect_b32 s49, s49, 0
 s_cmp_eq_u32 s87, 32
 s_cselect_b32 s49, s49, 0
L_main_257:
 s_cmp_eq_u32 s89, 1
 s_cbranch_scc1 L_goffn_284
L_goproj_285:
 s_waitcnt vmcnt(0)
 s_add_u32 s53, s60, s62
 s_mov_b32 s56, 0x40000000
L_proj_287:
 s_waitcnt vmcnt(4) lgkmcnt(0)
 s_barrier
 s_lshl_b32 s3, s46, 10
 s_sub_u32 s76, s57, s3
 s_sub_u32 s77, 73728, s76
 s_add_u32 s57, s77, s3
 s_sub_u32 s76, s76, s77
 v_add_u32 v240, s76, v240
 v_add_u32 v241, s76, v241
 v_add_u32 v242, s76, v242
 v_add_u32 v243, s76, v243
 s_mov_b32 s55, s74
 s_mov_b32 s65, s66
 s_sub_u32 s3, s52, 1
 s_cmp_lg_u32 s3, s69
 s_cbranch_scc1 L_nosig_290
 s_waitcnt vmcnt(2)
 s_barrier
 s_lshl_b32 s72, s50, 7
 s_add_u32 s72, s72, 65015808
 s_cmp_lg_u32 s46, 0
 s_cbranch_scc1 L_sig_291
 v_mov_b32 v247, 32
 v_mov_b32 v248, 0
 s_mov_b64 exec, 1
 buffer_atomic_add v247, v248, s[4:7], s72 offen
 s_mov_b64 exec, -1
L_sig_291:
L_nosig_290:
 s_add_u32 s52, s52, 1
 s_cmp_eq_u32 s52, s53
 s_cbranch_scc1 L_nx_288
 s_cmp_ge_u32 s52, s60
 s_cbranch_scc1 L_pq_292
 s_add_u32 s72, s59, s52
 s_cmp_ge_u32 s72, 64
 s_cbranch_scc1 L_pv_293
 s_mov_b32 s40, s12
 s_mov_b32 s41, s13
 s_mov_b32 s42, s14
 s_mov_b32 s43, s15
 s_mov_b32 s73, 0
 s_mov_b32 s66, 0
 s_branch L_pe_294
L_pv_293:
 s_sub_u32 s72, s72, 64
 s_mov_b32 s40, s16
 s_mov_b32 s41, s17
 s_mov_b32 s42, s18
 s_mov_b32 s43, s19
 s_mov_b32 s73, 16777216
 s_mov_b32 s66, 1
 s_branch L_pe_294
L_pq_292:
 s_sub_u32 s72, s52, s60
 s_add_u32 s72, s72, s61
 s_mov_b32 s40, s8
 s_mov_b32 s41, s9
 s_mov_b32 s42, s10
 s_mov_b32 s43, s11
 s_mov_b32 s73, 33554432
 s_mov_b32 s66, 0
L_pe_294:
 s_lshl_b32 s54, s72, 7
 s_lshl_b32 s3, s46, 16
 s_add_u32 s54, s54, s3
 s_lshl_b32 s74, s72, 12
 s_lshl_b32 s3, s58, 18
 s_add_u32 s74, s74, s3
 s_add_u32 s74, s74, s73
 s_mov_b32 s67, 262144
 v_mov_b32 v252, v244
 s_branch L_nx2_289
L_nx_288:
 s_mov_b32 s40, s28
 s_mov_b32 s41, s29
 s_mov_b32 s42, s30
 s_mov_b32 s43, s31
 s_lshl_b32 s54, s63, 7
 s_mul_i32 s3, s46, 73728
 s_add_u32 s54, s54, s3
 s_mov_b32 s67, 294912
 v_mov_b32 v252, v251
L_nx2_289:
 s_cmp_eq_u32 s65, 1
 s_cbranch_scc1 L_projv_295
 ds_read_b64_tr_b16 v[176:177], v240 offset:0
 ds_read_b64_tr_b16 v[178:179], v240 offset:512
 ds_read_b64_tr_b16 v[180:181], v240 offset:2048
 ds_read_b64_tr_b16 v[182:183], v240 offset:2560
 ds_read_b64_tr_b16 v[184:185], v240 offset:4096
 ds_read_b64_tr_b16 v[186:187], v240 offset:4608
 s_waitcnt lgkmcnt(4)
 v_mfma_f32_32x32x16_bf16 v[144:159], v[176:179], v[0:3], 0
 ds_read_b64_tr_b16 v[188:189], v240 offset:6144
 ds_read_b64_tr_b16 v[190:191], v240 offset:6656
 s_add_u32 m0, s57, 0
 s_nop 0
 buffer_load_dwordx4 v252, s[40:43], s54 offen  lds
 s_add_u32 s54, s54, s67
 s_waitcnt lgkmcnt(4)
 v_mfma_f32_32x32x16_bf16 v[144:159], v[180:183], v[4:7], v[144:159]
 ds_read_b64_tr_b16 v[176:177], v240 offset:8192
 ds_read_b64_tr_b16 v[178:179], v240 offset:8704
 s_add_u32 m0, s57, 4096
 s_nop 0
 buffer_load_dwordx4 v252, s[40:43], s54 offen  lds
 s_add_u32 s54, s54, s67
 s_waitcnt lgkmcnt(4)
 v_mfma_f32_32x32x16_bf16 v[144:159], v[184:187], v[8:11], v[144:159]
 ds_read_b64_tr_b16 v[180:181], v240 offset:10240
 ds_read_b64_tr_b16 v[182:183], v240 offset:10752
 s_add_u32 m0, s57, 8192
 s_nop 0
 buffer_load_dwordx4 v252, s[40:43], s54 offen  lds
 s_add_u32 s54, s54, s67
 s_waitcnt lgkmcnt(4)
 v_mfma_f32_32x32x16_bf16 v[144:159], v[188:191], v[12:15], v[144:159]
 ds_read_b64_tr_b16 v[184:185], v240 offset:12288
 ds_read_b64_tr_b16 v[186:187], v240 offset:12800
 s_add_u32 m0, s57, 12288
 s_nop 0
 buffer_load_dwordx4 v252, s[40:43], s54 offen  lds
 s_add_u32 s54, s54, s67
 s_waitcnt lgkmcnt(4)
 v_mfma_f32_32x32x16_bf16 v[144:159], v[176:179], v[16:19], v[144:159]
 ds_read_b64_tr_b16 v[188:189], v240 offset:14336
 ds_read_b64_tr_b16 v[190:191], v240 offset:14848
 s_add_u32 m0, s57, 16384
 s_nop 0
 buffer_load_dwordx4 v252, s[40:43], s54 offen  lds
 s_add_u32 s54, s54, s67
 s_waitcnt lgkmcnt(4)
 v_mfma_f32_32x32x16_bf16 v[144:159], v[180:183], v[20:23], v[144:159]
 ds_read_b64_tr_b16 v[176:177], v240 offset:16384
 ds_read_b64_tr_b16 v[178:179], v240 offset:16896
 s_add_u32 m0, s57, 20480
 s_nop 0
 buffer_load_dwordx4 v252, s[40:43], s54 offen  lds
 s_add_u32 s54, s54, s67
 s_waitcnt lgkmcnt(4)
 v_mfma_f32_32x32x16_bf16 v[144:159], v[184:187], v[24:27], v[144:159]
 ds_read_b64_tr_b16 v[180:181], v240 offset:18432
 ds_read_b64_tr_b16 v[182:183], v240 offset:18944
 s_add_u32 m0, s57, 24576
 s_nop 0
 buffer_load_dwordx4 v252, s[40:43], s54 offen  lds
 s_add_u32 s54, s54, s67
 s_waitcnt lgkmcnt(4)
 v_mfma_f32_32x32x16_bf16 v[144:159], v[188:191], v[28:31], v[144:159]
 ds_read_b64_tr_b16 v[184:185], v240 offset:20480
 ds_read_b64_tr_b16 v[186:187], v240 offset:20992
 s_add_u32 m0, s57, 28672
 s_nop 0
 buffer_load_dwordx4 v252, s[40:43], s54 offen  lds
 s_add_u32 s54, s54, s67
 s_waitcnt lgkmcnt(4)
 v_mfma_f32_32x32x16_bf16 v[144:159], v[176:179], v[32:35], v[144:159]
 ds_read_b64_tr_b16 v[188:189], v240 offset:22528
 ds_read_b64_tr_b16 v[190:191], v240 offset:23040
 s_add_u32 m0, s57, 32768
 s_nop 0
 buffer_load_dwordx4 v252, s[40:43], s54 offen  lds
 s_add_u32 s54, s54, s67
 s_waitcnt lgkmcnt(4)
 v_mfma_f32_32x32x16_bf16 v[144:159], v[180:183], v[36:39], v[144:159]
 ds_read_b64_tr_b16 v[176:177], v240 offset:24576
 ds_read_b64_tr_b16 v[178:179], v240 offset:25088
 s_add_u32 m0, s57, 36864
 s_nop 0
 buffer_load_dwordx4 v252, s[40:43], s54 offen  lds
 s_add_u32 s54, s54, s67
 s_waitcnt lgkmcnt(4)
 v_mfma_f32_32x32x16_bf16 v[144:159], v[184:187], v[40:43], v[144:159]
 ds_read_b64_tr_b16 v[180:181], v240 offset:26624
 ds_read_b64_tr_b16 v[182:183], v240 offset:27136
 s_add_u32 m0, s57, 40960
 s_nop 0
 buffer_load_dwordx4 v252, s[40:43], s54 offen  lds
 s_add_u32 s54, s54, s67
 s_waitcnt lgkmcnt(4)
 v_mfma_f32_32x32x16_bf16 v[144:159], v[188:191], v[44:47], v[144:159]
 ds_read_b64_tr_b16 v[184:185], v240 offset:28672
 ds_read_b64_tr_b16 v[186:187], v240 offset:29184
 s_add_u32 m0, s57, 45056
 s_nop 0
 buffer_load_dwordx4 v252, s[40:43], s54 offen  lds
 s_add_u32 s54, s54, s67
 s_waitcnt lgkmcnt(4)
 v_mfma_f32_32x32x16_bf16 v[144:159], v[176:179], v[48:51], v[144:159]
 ds_read_b64_tr_b16 v[188:189], v240 offset:30720
 ds_read_b64_tr_b16 v[190:191], v240 offset:31232
 s_add_u32 m0, s57, 49152
 s_nop 0
 buffer_load_dwordx4 v252, s[40:43], s54 offen  lds
 s_add_u32 s54, s54, s67
 s_waitcnt lgkmcnt(4)
 v_mfma_f32_32x32x16_bf16 v[144:159], v[180:183], v[52:55], v[144:159]
 ds_read_b64_tr_b16 v[176:177], v240 offset:32768
 ds_read_b64_tr_b16 v[178:179], v240 offset:33280
 s_add_u32 m0, s57, 53248
 s_nop 0
 buffer_load_dwordx4 v252, s[40:43], s54 offen  lds
 s_add_u32 s54, s54, s67
 s_waitcnt lgkmcnt(4)
 v_mfma_f32_32x32x16_bf16 v[144:159], v[184:187], v[56:59], v[144:159]
 ds_read_b64_tr_b16 v[180:181], v240 offset:34816
 ds_read_b64_tr_b16 v[182:183], v240 offset:35328
 s_add_u32 m0, s57, 57344
 s_nop 0
 buffer_load_dwordx4 v252, s[40:43], s54 offen  lds
 s_add_u32 s54, s54, s67
 s_waitcnt lgkmcnt(4)
 v_mfma_f32_32x32x16_bf16 v[144:159], v[188:191], v[60:63], v[144:159]
 ds_read_b64_tr_b16 v[184:185], v241 offset:0
 ds_read_b64_tr_b16 v[186:187], v241 offset:512
 s_add_u32 m0, s57, 61440
 s_nop 0
 buffer_load_dwordx4 v252, s[40:43], s54 offen  lds
 s_add_u32 s54, s54, s67
 s_waitcnt lgkmcnt(4)
 v_mfma_f32_32x32x16_bf16 v[144:159], v[176:179], v[64:67], v[144:159]
 ds_read_b64_tr_b16 v[188:189], v241 offset:2048
 ds_read_b64_tr_b16 v[190:191], v241 offset:2560
 s_add_u32 m0, s57, 65536
 s_nop 0
 buffer_load_dwordx4 v252, s[40:43], s54 offen  lds
 s_add_u32 s54, s54, s67
 s_waitcnt lgkmcnt(4)
 v_mfma_f32_32x32x16_bf16 v[144:159], v[180:183], v[68:71], v[144:159]
 ds_read_b64_tr_b16 v[176:177], v241 offset:4096
 ds_read_b64_tr_b16 v[178:179], v241 offset:4608
 s_add_u32 m0, s57, 69632
 s_nop 0
 buffer_load_dwordx4 v252, s[40:43], s54 offen  lds
 s_add_u32 s54, s54, s67
 s_waitcnt lgkmcnt(4)
 v_mfma_f32_32x32x16_bf16 v[144:159], v[184:187], v[72:75], v[144:159]
 ds_read_b64_tr_b16 v[180:181], v241 offset:6144
 ds_read_b64_tr_b16 v[182:183], v241 offset:6656
 s_waitcnt lgkmcnt(4)
 v_mfma_f32_32x32x16_bf16 v[144:159], v[188:191], v[76:79], v[144:159]
 ds_read_b64_tr_b16 v[184:185], v241 offset:8192
 ds_read_b64_tr_b16 v[186:187], v241 offset:8704
 s_waitcnt lgkmcnt(4)
 v_mfma_f32_32x32x16_bf16 v[144:159], v[176:179], v[80:83], v[144:159]
 ds_read_b64_tr_b16 v[188:189], v241 offset:10240
 ds_read_b64_tr_b16 v[190:191], v241 offset:10752
 s_waitcnt lgkmcnt(4)
 v_mfma_f32_32x32x16_bf16 v[144:159], v[180:183], v[84:87], v[144:159]
 ds_read_b64_tr_b16 v[176:177], v241 offset:12288
 ds_read_b64_tr_b16 v[178:179], v241 offset:12800
 s_waitcnt lgkmcnt(4)
 v_mfma_f32_32x32x16_bf16 v[144:159], v[184:187], v[88:91], v[144:159]
 ds_read_b64_tr_b16 v[180:181], v241 offset:14336
 ds_read_b64_tr_b16 v[182:183], v241 offset:14848
 s_waitcnt lgkmcnt(4)
 v_mfma_f32_32x32x16_bf16 v[144:159], v[188:191], v[92:95], v[144:159]
 ds_read_b64_tr_b16 v[184:185], v241 offset:16384
 ds_read_b64_tr_b16 v[186:187], v241 offset:16896
 s_waitcnt lgkmcnt(4)
 v_mfma_f32_32x32x16_bf16 v[144:159], v[176:179], v[96:99], v[144:159]
 ds_read_b64_tr_b16 v[188:189], v241 offset:18432
 ds_read_b64_tr_b16 v[190:191], v241 offset:18944
 s_waitcnt lgkmcnt(4)
 v_mfma_f32_32x32x16_bf16 v[144:159], v[180:183], v[100:103], v[144:159]
 ds_read_b64_tr_b16 v[176:177], v241 offset:20480
 ds_read_b64_tr_b16 v[178:179], v241 offset:20992
 s_waitcnt lgkmcnt(4)
 v_mfma_f32_32x32x16_bf16 v[144:159], v[184:187], v[104:107], v[144:159]
 ds_read_b64_tr_b16 v[180:181], v241 offset:22528
 ds_read_b64_tr_b16 v[182:183], v241 offset:23040
 s_waitcnt lgkmcnt(4)
 v_mfma_f32_32x32x16_bf16 v[144:159], v[188:191], v[108:111], v[144:159]
 ds_read_b64_tr_b16 v[184:185], v241 offset:24576
 ds_read_b64_tr_b16 v[186:187], v241 offset:25088
 s_waitcnt lgkmcnt(4)
 v_mfma_f32_32x32x16_bf16 v[144:159], v[176:179], v[112:115], v[144:159]
 ds_read_b64_tr_b16 v[188:189], v241 offset:26624
 ds_read_b64_tr_b16 v[190:191], v241 offset:27136
 s_waitcnt lgkmcnt(4)
 v_mfma_f32_32x32x16_bf16 v[144:159], v[180:183], v[116:119], v[144:159]
 ds_read_b64_tr_b16 v[176:177], v241 offset:28672
 ds_read_b64_tr_b16 v[178:179], v241 offset:29184
 s_waitcnt lgkmcnt(4)
 v_mfma_f32_32x32x16_bf16 v[144:159], v[184:187], v[120:123], v[144:159]
 ds_read_b64_tr_b16 v[180:181], v241 offset:30720
 ds_read_b64_tr_b16 v[182:183], v241 offset:31232
 v_cvt_pk_bf16_f32 v192, v160, v161
 v_cvt_pk_bf16_f32 v193, v162, v163
 s_waitcnt lgkmcnt(4)
 v_mfma_f32_32x32x16_bf16 v[144:159], v[188:191], v[124:127], v[144:159]
 ds_read_b64_tr_b16 v[184:185], v241 offset:32768
 ds_read_b64_tr_b16 v[186:187], v241 offset:33280
 v_cvt_pk_bf16_f32 v194, v164, v165
 v_cvt_pk_bf16_f32 v195, v166, v167
 s_waitcnt lgkmcnt(4)
 v_mfma_f32_32x32x16_bf16 v[144:159], v[176:179], v[128:131], v[144:159]
 ds_read_b64_tr_b16 v[188:189], v241 offset:34816
 ds_read_b64_tr_b16 v[190:191], v241 offset:35328
 buffer_store_dwordx4 v[192:195], v246, s[4:7], s56 offen offset:2048 sc1
 v_cvt_pk_bf16_f32 v196, v168, v169
 s_waitcnt lgkmcnt(4)
 v_mfma_f32_32x32x16_bf16 v[144:159], v[180:183], v[132:135], v[144:159]
 ds_read_b64_tr_b16 v[176:177], v242 offset:0
 ds_read_b64_tr_b16 v[178:179], v242 offset:512
 v_cvt_pk_bf16_f32 v197, v170, v171
 v_cvt_pk_bf16_f32 v198, v172, v173
 s_waitcnt lgkmcnt(4)
 v_mfma_f32_32x32x16_bf16 v[144:159], v[184:187], v[136:139], v[144:159]
 ds_read_b64_tr_b16 v[180:181], v242 offset:2048
 ds_read_b64_tr_b16 v[182:183], v242 offset:2560
 v_cvt_pk_bf16_f32 v199, v174, v175
 buffer_store_dwordx4 v[196:199], v246, s[4:7], s56 offen offset:3072 sc1
 s_waitcnt lgkmcnt(4)
 v_mfma_f32_32x32x16_bf16 v[144:159], v[188:191], v[140:143], v[144:159]
 ds_read_b64_tr_b16 v[184:185], v242 offset:4096
 ds_read_b64_tr_b16 v[186:187], v242 offset:4608
 s_waitcnt lgkmcnt(4)
 v_mfma_f32_32x32x16_bf16 v[160:175], v[176:179], v[0:3], 0
 ds_read_b64_tr_b16 v[188:189], v242 offset:6144
 ds_read_b64_tr_b16 v[190:191], v242 offset:6656
 s_waitcnt lgkmcnt(4)
 v_mfma_f32_32x32x16_bf16 v[160:175], v[180:183], v[4:7], v[160:175]
 ds_read_b64_tr_b16 v[176:177], v242 offset:8192
 ds_read_b64_tr_b16 v[178:179], v242 offset:8704
 s_waitcnt lgkmcnt(4)
 v_mfma_f32_32x32x16_bf16 v[160:175], v[184:187], v[8:11], v[160:175]
 ds_read_b64_tr_b16 v[180:181], v242 offset:10240
 ds_read_b64_tr_b16 v[182:183], v242 offset:10752
 s_waitcnt lgkmcnt(4)
 v_mfma_f32_32x32x16_bf16 v[160:175], v[188:191], v[12:15], v[160:175]
 ds_read_b64_tr_b16 v[184:185], v242 offset:12288
 ds_read_b64_tr_b16 v[186:187], v242 offset:12800
 s_waitcnt lgkmcnt(4)
 v_mfma_f32_32x32x16_bf16 v[160:175], v[176:179], v[16:19], v[160:175]
 ds_read_b64_tr_b16 v[188:189], v242 offset:14336
 ds_read_b64_tr_b16 v[190:191], v242 offset:14848
 v_cvt_pk_bf16_f32 v200, v144, v145
 v_cvt_pk_bf16_f32 v201, v146, v147
 s_waitcnt lgkmcnt(4)
 v_mfma_f32_32x32x16_bf16 v[160:175], v[180:183], v[20:23], v[160:175]
 ds_read_b64_tr_b16 v[176:177], v242 offset:16384
 ds_read_b64_tr_b16 v[178:179], v242 offset:16896
 v_cvt_pk_bf16_f32 v202, v148, v149
 v_cvt_pk_bf16_f32 v203, v150, v151
 s_waitcnt lgkmcnt(4)
 v_mfma_f32_32x32x16_bf16 v[160:175], v[184:187], v[24:27], v[160:175]
 ds_read_b64_tr_b16 v[180:181], v242 offset:18432
 ds_read_b64_tr_b16 v[182:183], v242 offset:18944
 buffer_store_dwordx4 v[200:203], v246, s[4:7], s55 offen offset:0 sc1
 v_cvt_pk_bf16_f32 v204, v152, v153
 s_waitcnt lgkmcnt(4)
 v_mfma_f32_32x32x16_bf16 v[160:175], v[188:191], v[28:31], v[160:175]
 ds_read_b64_tr_b16 v[184:185], v242 offset:20480
 ds_read_b64_tr_b16 v[186:187], v242 offset:20992
 v_cvt_pk_bf16_f32 v205, v154, v155
 v_cvt_pk_bf16_f32 v206, v156, v157
 s_waitcnt lgkmcnt(4)
 v_mfma_f32_32x32x16_bf16 v[160:175], v[176:179], v[32:35], v[160:175]
 ds_read_b64_tr_b16 v[188:189], v242 offset:22528
 ds_read_b64_tr_b16 v[190:191], v242 offset:23040
 v_cvt_pk_bf16_f32 v207, v158, v159
 buffer_store_dwordx4 v[204:207], v246, s[4:7], s55 offen offset:1024 sc1
 s_waitcnt lgkmcnt(4)
 v_mfma_f32_32x32x16_bf16 v[160:175], v[180:183], v[36:39], v[160:175]
 ds_read_b64_tr_b16 v[176:177], v242 offset:24576
 ds_read_b64_tr_b16 v[178:179], v242 offset:25088
 s_waitcnt lgkmcnt(4)
 v_mfma_f32_32x32x16_bf16 v[160:175], v[184:187], v[40:43], v[160:175]
 ds_read_b64_tr_b16 v[180:181], v242 offset:26624
 ds_read_b64_tr_b16 v[182:183], v242 offset:27136
 s_waitcnt lgkmcnt(4)
 v_mfma_f32_32x32x16_bf16 v[160:175], v[188:191], v[44:47], v[160:175]
 ds_read_b64_tr_b16 v[184:185], v242 offset:28672
 ds_read_b64_tr_b16 v[186:187], v242 offset:29184
 s_waitcnt lgkmcnt(4)
 v_mfma_f32_32x32x16_bf16 v[160:175], v[176:179], v[48:51], v[160:175]
 ds_read_b64_tr_b16 v[188:189], v242 offset:30720
 ds_read_b64_tr_b16 v[190:191], v242 offset:31232
 s_waitcnt lgkmcnt(4)
 v_mfma_f32_32x32x16_bf16 v[160:175], v[180:183], v[52:55], v[160:175]
 ds_read_b64_tr_b16 v[176:177], v242 offset:32768
 ds_read_b64_tr_b16 v[178:179], v242 offset:33280
 s_waitcnt lgkmcnt(4)
 v_mfma_f32_32x32x16_bf16 v[160:175], v[184:187], v[56:59], v[160:175]
 ds_read_b64_tr_b16 v[180:181], v242 offset:34816
 ds_read_b64_tr_b16 v[182:183], v242 offset:35328
 s_waitcnt lgkmcnt(4)
 v_mfma_f32_32x32x16_bf16 v[160:175], v[188:191], v[60:63], v[160:175]
 ds_read_b64_tr_b16 v[184:185], v243 offset:0
 ds_read_b64_tr_b16 v[186:187], v243 offset:512
 s_waitcnt lgkmcnt(4)
 v_mfma_f32_32x32x16_bf16 v[160:175], v[176:179], v[64:67], v[160:175]
 ds_read_b64_tr_b16 v[188:189], v243 offset:2048
 ds_read_b64_tr_b16 v[190:191], v243 offset:2560
 s_waitcnt lgkmcnt(4)
 v_mfma_f32_32x32x16_bf16 v[160:175], v[180:183], v[68:71], v[160:175]
 ds_read_b64_tr_b16 v[176:177], v243 offset:4096
 ds_read_b64_tr_b16 v[178:179], v243 offset:4608
 s_waitcnt lgkmcnt(4)
 v_mfma_f32_32x32x16_bf16 v[160:175], v[184:187], v[72:75], v[160:175]
 ds_read_b64_tr_b16 v[180:181], v243 offset:6144
 ds_read_b64_tr_b16 v[182:183], v243 offset:6656
 s_waitcnt lgkmcnt(4)
 v_mfma_f32_32x32x16_bf16 v[160:175], v[188:191], v[76:79], v[160:175]
 ds_read_b64_tr_b16 v[184:185], v243 offset:8192
 ds_read_b64_tr_b16 v[186:187], v243 offset:8704
 s_waitcnt lgkmcnt(4)
 v_mfma_f32_32x32x16_bf16 v[160:175], v[176:179], v[80:83], v[160:175]
 ds_read_b64_tr_b16 v[188:189], v243 offset:10240
 ds_read_b64_tr_b16 v[190:191], v243 offset:10752
 s_waitcnt lgkmcnt(4)
 v_mfma_f32_32x32x16_bf16 v[160:175], v[180:183], v[84:87], v[160:175]
 ds_read_b64_tr_b16 v[176:177], v243 offset:12288
 ds_read_b64_tr_b16 v[178:179], v243 offset:12800
 s_waitcnt lgkmcnt(4)
 v_mfma_f32_32x32x16_bf16 v[160:175], v[184:187], v[88:91], v[160:175]
 ds_read_b64_tr_b16 v[180:181], v243 offset:14336
 ds_read_b64_tr_b16 v[182:183], v243 offset:14848
 s_waitcnt lgkmcnt(4)
 v_mfma_f32_32x32x16_bf16 v[160:175], v[188:191], v[92:95], v[160:175]
 ds_read_b64_tr_b16 v[184:185], v243 offset:16384
 ds_read_b64_tr_b16 v[186:187], v243 offset:16896
 s_waitcnt lgkmcnt(4)
 v_mfma_f32_32x32x16_bf16 v[160:175], v[176:179], v[96:99], v[160:175]
 ds_read_b64_tr_b16 v[188:189], v243 offset:18432
 ds_read_b64_tr_b16 v[190:191], v243 offset:18944
 s_waitcnt lgkmcnt(4)
 v_mfma_f32_32x32x16_bf16 v[160:175], v[180:183], v[100:103], v[160:175]
 ds_read_b64_tr_b16 v[176:177], v243 offset:20480
 ds_read_b64_tr_b16 v[178:179], v243 offset:20992
 s_waitcnt lgkmcnt(4)
 v_mfma_f32_32x32x16_bf16 v[160:175], v[184:187], v[104:107], v[160:175]
 ds_read_b64_tr_b16 v[180:181], v243 offset:22528
 ds_read_b64_tr_b16 v[182:183], v243 offset:23040
 s_waitcnt lgkmcnt(4)
 v_mfma_f32_32x32x16_bf16 v[160:175], v[188:191], v[108:111], v[160:175]
 ds_read_b64_tr_b16 v[184:185], v243 offset:24576
 ds_read_b64_tr_b16 v[186:187], v243 offset:25088
 s_waitcnt lgkmcnt(4)
 v_mfma_f32_32x32x16_bf16 v[160:175], v[176:179], v[112:115], v[160:175]
 ds_read_b64_tr_b16 v[188:189], v243 offset:26624
 ds_read_b64_tr_b16 v[190:191], v243 offset:27136
 s_waitcnt lgkmcnt(4)
 v_mfma_f32_32x32x16_bf16 v[160:175], v[180:183], v[116:119], v[160:175]
 ds_read_b64_tr_b16 v[176:177], v243 offset:28672
 ds_read_b64_tr_b16 v[178:179], v243 offset:29184
 s_waitcnt lgkmcnt(4)
 v_mfma_f32_32x32x16_bf16 v[160:175], v[184:187], v[120:123], v[160:175]
 ds_read_b64_tr_b16 v[180:181], v243 offset:30720
 ds_read_b64_tr_b16 v[182:183], v243 offset:31232
 s_waitcnt lgkmcnt(4)
 v_mfma_f32_32x32x16_bf16 v[160:175], v[188:191], v[124:127], v[160:175]
 ds_read_b64_tr_b16 v[184:185], v243 offset:32768
 ds_read_b64_tr_b16 v[186:187], v243 offset:33280
 s_waitcnt lgkmcnt(4)
 v_mfma_f32_32x32x16_bf16 v[160:175], v[176:179], v[128:131], v[160:175]
 ds_read_b64_tr_b16 v[188:189], v243 offset:34816
 ds_read_b64_tr_b16 v[190:191], v243 offset:35328
 s_waitcnt lgkmcnt(4)
 v_mfma_f32_32x32x16_bf16 v[160:175], v[180:183], v[132:135], v[160:175]
 s_waitcnt lgkmcnt(2)
 v_mfma_f32_32x32x16_bf16 v[160:175], v[184:187], v[136:139], v[160:175]
 s_waitcnt lgkmcnt(0)
 v_mfma_f32_32x32x16_bf16 v[160:175], v[188:191], v[140:143], v[160:175]
 s_branch L_projj_296
L_projv_295:
 ds_read_b64_tr_b16 v[176:177], v240 offset:0
 ds_read_b64_tr_b16 v[178:179], v240 offset:512
 ds_read_b64_tr_b16 v[180:181], v240 offset:2048
 ds_read_b64_tr_b16 v[182:183], v240 offset:2560
 ds_read_b64_tr_b16 v[184:185], v240 offset:4096
 ds_read_b64_tr_b16 v[186:187], v240 offset:4608
 s_waitcnt lgkmcnt(4)
 v_mfma_f32_32x32x16_bf16 v[144:159], v[0:3], v[176:179], 0
 ds_read_b64_tr_b16 v[188:189], v240 offset:6144
 ds_read_b64_tr_b16 v[190:191], v240 offset:6656
 s_add_u32 m0, s57, 0
 s_nop 0
 buffer_load_dwordx4 v252, s[40:43], s54 offen  lds
 s_add_u32 s54, s54, s67
 s_waitcnt lgkmcnt(4)
 v_mfma_f32_32x32x16_bf16 v[144:159], v[4:7], v[180:183], v[144:159]
 ds_read_b64_tr_b16 v[176:177], v240 offset:8192
 ds_read_b64_tr_b16 v[178:179], v240 offset:8704
 s_add_u32 m0, s57, 4096
 s_nop 0
 buffer_load_dwordx4 v252, s[40:43], s54 offen  lds
 s_add_u32 s54, s54, s67
 s_waitcnt lgkmcnt(4)
 v_mfma_f32_32x32x16_bf16 v[144:159], v[8:11], v[184:187], v[144:159]
 ds_read_b64_tr_b16 v[180:181], v240 offset:10240
 ds_read_b64_tr_b16 v[182:183], v240 offset:10752
 s_add_u32 m0, s57, 8192
 s_nop 0
 buffer_load_dwordx4 v252, s[40:43], s54 offen  lds
 s_add_u32 s54, s54, s67
 s_waitcnt lgkmcnt(4)
 v_mfma_f32_32x32x16_bf16 v[144:159], v[12:15], v[188:191], v[144:159]
 ds_read_b64_tr_b16 v[184:185], v240 offset:12288
 ds_read_b64_tr_b16 v[186:187], v240 offset:12800
 s_add_u32 m0, s57, 12288
 s_nop 0
 buffer_load_dwordx4 v252, s[40:43], s54 offen  lds
 s_add_u32 s54, s54, s67
 s_waitcnt lgkmcnt(4)
 v_mfma_f32_32x32x16_bf16 v[144:159], v[16:19], v[176:179], v[144:159]
 ds_read_b64_tr_b16 v[188:189], v240 offset:14336
 ds_read_b64_tr_b16 v[190:191], v240 offset:14848
 s_add_u32 m0, s57, 16384
 s_nop 0
 buffer_load_dwordx4 v252, s[40:43], s54 offen  lds
 s_add_u32 s54, s54, s67
 s_waitcnt lgkmcnt(4)
 v_mfma_f32_32x32x16_bf16 v[144:159], v[20:23], v[180:183], v[144:159]
 ds_read_b64_tr_b16 v[176:177], v240 offset:16384
 ds_read_b64_tr_b16 v[178:179], v240 offset:16896
 s_add_u32 m0, s57, 20480
 s_nop 0
 buffer_load_dwordx4 v252, s[40:43], s54 offen  lds
 s_add_u32 s54, s54, s67
 s_waitcnt lgkmcnt(4)
 v_mfma_f32_32x32x16_bf16 v[144:159], v[24:27], v[184:187], v[144:159]
 ds_read_b64_tr_b16 v[180:181], v240 offset:18432
 ds_read_b64_tr_b16 v[182:183], v240 offset:18944
 s_add_u32 m0, s57, 24576
 s_nop 0
 buffer_load_dwordx4 v252, s[40:43], s54 offen  lds
 s_add_u32 s54, s54, s67
 s_waitcnt lgkmcnt(4)
 v_mfma_f32_32x32x16_bf16 v[144:159], v[28:31], v[188:191], v[144:159]
 ds_read_b64_tr_b16 v[184:185], v240 offset:20480
 ds_read_b64_tr_b16 v[186:187], v240 offset:20992
 s_add_u32 m0, s57, 28672
 s_nop 0
 buffer_load_dwordx4 v252, s[40:43], s54 offen  lds
 s_add_u32 s54, s54, s67
 s_waitcnt lgkmcnt(4)
 v_mfma_f32_32x32x16_bf16 v[144:159], v[32:35], v[176:179], v[144:159]
 ds_read_b64_tr_b16 v[188:189], v240 offset:22528
 ds_read_b64_tr_b16 v[190:191], v240 offset:23040
 s_add_u32 m0, s57, 32768
 s_nop 0
 buffer_load_dwordx4 v252, s[40:43], s54 offen  lds
 s_add_u32 s54, s54, s67
 s_waitcnt lgkmcnt(4)
 v_mfma_f32_32x32x16_bf16 v[144:159], v[36:39], v[180:183], v[144:159]
 ds_read_b64_tr_b16 v[176:177], v240 offset:24576
 ds_read_b64_tr_b16 v[178:179], v240 offset:25088
 s_add_u32 m0, s57, 36864
 s_nop 0
 buffer_load_dwordx4 v252, s[40:43], s54 offen  lds
 s_add_u32 s54, s54, s67
 s_waitcnt lgkmcnt(4)
 v_mfma_f32_32x32x16_bf16 v[144:159], v[40:43], v[184:187], v[144:159]
 ds_read_b64_tr_b16 v[180:181], v240 offset:26624
 ds_read_b64_tr_b16 v[182:183], v240 offset:27136
 s_add_u32 m0, s57, 40960
 s_nop 0
 buffer_load_dwordx4 v252, s[40:43], s54 offen  lds
 s_add_u32 s54, s54, s67
 s_waitcnt lgkmcnt(4)
 v_mfma_f32_32x32x16_bf16 v[144:159], v[44:47], v[188:191], v[144:159]
 ds_read_b64_tr_b16 v[184:185], v240 offset:28672
 ds_read_b64_tr_b16 v[186:187], v240 offset:29184
 s_add_u32 m0, s57, 45056
 s_nop 0
 buffer_load_dwordx4 v252, s[40:43], s54 offen  lds
 s_add_u32 s54, s54, s67
 s_waitcnt lgkmcnt(4)
 v_mfma_f32_32x32x16_bf16 v[144:159], v[48:51], v[176:179], v[144:159]
 ds_read_b64_tr_b16 v[188:189], v240 offset:30720
 ds_read_b64_tr_b16 v[190:191], v240 offset:31232
 s_add_u32 m0, s57, 49152
 s_nop 0
 buffer_load_dwordx4 v252, s[40:43], s54 offen  lds
 s_add_u32 s54, s54, s67
 s_waitcnt lgkmcnt(4)
 v_mfma_f32_32x32x16_bf16 v[144:159], v[52:55], v[180:183], v[144:159]
 ds_read_b64_tr_b16 v[176:177], v240 offset:32768
 ds_read_b64_tr_b16 v[178:179], v240 offset:33280
 s_add_u32 m0, s57, 53248
 s_nop 0
 buffer_load_dwordx4 v252, s[40:43], s54 offen  lds
 s_add_u32 s54, s54, s67
 s_waitcnt lgkmcnt(4)
 v_mfma_f32_32x32x16_bf16 v[144:159], v[56:59], v[184:187], v[144:159]
 ds_read_b64_tr_b16 v[180:181], v240 offset:34816
 ds_read_b64_tr_b16 v[182:183], v240 offset:35328
 s_add_u32 m0, s57, 57344
 s_nop 0
 buffer_load_dwordx4 v252, s[40:43], s54 offen  lds
 s_add_u32 s54, s54, s67
 s_waitcnt lgkmcnt(4)
 v_mfma_f32_32x32x16_bf16 v[144:159], v[60:63], v[188:191], v[144:159]
 ds_read_b64_tr_b16 v[184:185], v241 offset:0
 ds_read_b64_tr_b16 v[186:187], v241 offset:512
 s_add_u32 m0, s57, 61440
 s_nop 0
 buffer_load_dwordx4 v252, s[40:43], s54 offen  lds
 s_add_u32 s54, s54, s67
 s_waitcnt lgkmcnt(4)
 v_mfma_f32_32x32x16_bf16 v[144:159], v[64:67], v[176:179], v[144:159]
 ds_read_b64_tr_b16 v[188:189], v241 offset:2048
 ds_read_b64_tr_b16 v[190:191], v241 offset:2560
 s_add_u32 m0, s57, 65536
 s_nop 0
 buffer_load_dwordx4 v252, s[40:43], s54 offen  lds
 s_add_u32 s54, s54, s67
 s_waitcnt lgkmcnt(4)
 v_mfma_f32_32x32x16_bf16 v[144:159], v[68:71], v[180:183], v[144:159]
 ds_read_b64_tr_b16 v[176:177], v241 offset:4096
 ds_read_b64_tr_b16 v[178:179], v241 offset:4608
 s_add_u32 m0, s57, 69632
 s_nop 0
 buffer_load_dwordx4 v252, s[40:43], s54 offen  lds
 s_add_u32 s54, s54, s67
 s_waitcnt lgkmcnt(4)
 v_mfma_f32_32x32x16_bf16 v[144:159], v[72:75], v[184:187], v[144:159]
 ds_read_b64_tr_b16 v[180:181], v241 offset:6144
 ds_read_b64_tr_b16 v[182:183], v241 offset:6656
 s_waitcnt lgkmcnt(4)
 v_mfma_f32_32x32x16_bf16 v[144:159], v[76:79], v[188:191], v[144:159]
 ds_read_b64_tr_b16 v[184:185], v241 offset:8192
 ds_read_b64_tr_b16 v[186:187], v241 offset:8704
 s_waitcnt lgkmcnt(4)
 v_mfma_f32_32x32x16_bf16 v[144:159], v[80:83], v[176:179], v[144:159]
 ds_read_b64_tr_b16 v[188:189], v241 offset:10240
 ds_read_b64_tr_b16 v[190:191], v241 offset:10752
 s_waitcnt lgkmcnt(4)
 v_mfma_f32_32x32x16_bf16 v[144:159], v[84:87], v[180:183], v[144:159]
 ds_read_b64_tr_b16 v[176:177], v241 offset:12288
 ds_read_b64_tr_b16 v[178:179], v241 offset:12800
 s_waitcnt lgkmcnt(4)
 v_mfma_f32_32x32x16_bf16 v[144:159], v[88:91], v[184:187], v[144:159]
 ds_read_b64_tr_b16 v[180:181], v241 offset:14336
 ds_read_b64_tr_b16 v[182:183], v241 offset:14848
 s_waitcnt lgkmcnt(4)
 v_mfma_f32_32x32x16_bf16 v[144:159], v[92:95], v[188:191], v[144:159]
 ds_read_b64_tr_b16 v[184:185], v241 offset:16384
 ds_read_b64_tr_b16 v[186:187], v241 offset:16896
 s_waitcnt lgkmcnt(4)
 v_mfma_f32_32x32x16_bf16 v[144:159], v[96:99], v[176:179], v[144:159]
 ds_read_b64_tr_b16 v[188:189], v241 offset:18432
 ds_read_b64_tr_b16 v[190:191], v241 offset:18944
 s_waitcnt lgkmcnt(4)
 v_mfma_f32_32x32x16_bf16 v[144:159], v[100:103], v[180:183], v[144:159]
 ds_read_b64_tr_b16 v[176:177], v241 offset:20480
 ds_read_b64_tr_b16 v[178:179], v241 offset:20992
 s_waitcnt lgkmcnt(4)
 v_mfma_f32_32x32x16_bf16 v[144:159], v[104:107], v[184:187], v[144:159]
 ds_read_b64_tr_b16 v[180:181], v241 offset:22528
 ds_read_b64_tr_b16 v[182:183], v241 offset:23040
 s_waitcnt lgkmcnt(4)
 v_mfma_f32_32x32x16_bf16 v[144:159], v[108:111], v[188:191], v[144:159]
 ds_read_b64_tr_b16 v[184:185], v241 offset:24576
 ds_read_b64_tr_b16 v[186:187], v241 offset:25088
 s_waitcnt lgkmcnt(4)
 v_mfma_f32_32x32x16_bf16 v[144:159], v[112:115], v[176:179], v[144:159]
 ds_read_b64_tr_b16 v[188:189], v241 offset:26624
 ds_read_b64_tr_b16 v[190:191], v241 offset:27136
 s_waitcnt lgkmcnt(4)
 v_mfma_f32_32x32x16_bf16 v[144:159], v[116:119], v[180:183], v[144:159]
 ds_read_b64_tr_b16 v[176:177], v241 offset:28672
 ds_read_b64_tr_b16 v[178:179], v241 offset:29184
 s_waitcnt lgkmcnt(4)
 v_mfma_f32_32x32x16_bf16 v[144:159], v[120:123], v[184:187], v[144:159]
 ds_read_b64_tr_b16 v[180:181], v241 offset:30720
 ds_read_b64_tr_b16 v[182:183], v241 offset:31232
 v_cvt_pk_bf16_f32 v192, v160, v161
 v_cvt_pk_bf16_f32 v193, v162, v163
 s_waitcnt lgkmcnt(4)
 v_mfma_f32_32x32x16_bf16 v[144:159], v[124:127], v[188:191], v[144:159]
 ds_read_b64_tr_b16 v[184:185], v241 offset:32768
 ds_read_b64_tr_b16 v[186:187], v241 offset:33280
 v_cvt_pk_bf16_f32 v194, v164, v165
 v_cvt_pk_bf16_f32 v195, v166, v167
 s_waitcnt lgkmcnt(4)
 v_mfma_f32_32x32x16_bf16 v[144:159], v[128:131], v[176:179], v[144:159]
 ds_read_b64_tr_b16 v[188:189], v241 offset:34816
 ds_read_b64_tr_b16 v[190:191], v241 offset:35328
 buffer_store_dwordx4 v[192:195], v246, s[4:7], s56 offen offset:2048 sc1
 v_cvt_pk_bf16_f32 v196, v168, v169
 s_waitcnt lgkmcnt(4)
 v_mfma_f32_32x32x16_bf16 v[144:159], v[132:135], v[180:183], v[144:159]
 ds_read_b64_tr_b16 v[176:177], v242 offset:0
 ds_read_b64_tr_b16 v[178:179], v242 offset:512
 v_cvt_pk_bf16_f32 v197, v170, v171
 v_cvt_pk_bf16_f32 v198, v172, v173
 s_waitcnt lgkmcnt(4)
 v_mfma_f32_32x32x16_bf16 v[144:159], v[136:139], v[184:187], v[144:159]
 ds_read_b64_tr_b16 v[180:181], v242 offset:2048
 ds_read_b64_tr_b16 v[182:183], v242 offset:2560
 v_cvt_pk_bf16_f32 v199, v174, v175
 buffer_store_dwordx4 v[196:199], v246, s[4:7], s56 offen offset:3072 sc1
 s_waitcnt lgkmcnt(4)
 v_mfma_f32_32x32x16_bf16 v[144:159], v[140:143], v[188:191], v[144:159]
 ds_read_b64_tr_b16 v[184:185], v242 offset:4096
 ds_read_b64_tr_b16 v[186:187], v242 offset:4608
 s_waitcnt lgkmcnt(4)
 v_mfma_f32_32x32x16_bf16 v[160:175], v[0:3], v[176:179], 0
 ds_read_b64_tr_b16 v[188:189], v242 offset:6144
 ds_read_b64_tr_b16 v[190:191], v242 offset:6656
 s_waitcnt lgkmcnt(4)
 v_mfma_f32_32x32x16_bf16 v[160:175], v[4:7], v[180:183], v[160:175]
 ds_read_b64_tr_b16 v[176:177], v242 offset:8192
 ds_read_b64_tr_b16 v[178:179], v242 offset:8704
 s_waitcnt lgkmcnt(4)
 v_mfma_f32_32x32x16_bf16 v[160:175], v[8:11], v[184:187], v[160:175]
 ds_read_b64_tr_b16 v[180:181], v242 offset:10240
 ds_read_b64_tr_b16 v[182:183], v242 offset:10752
 s_waitcnt lgkmcnt(4)
 v_mfma_f32_32x32x16_bf16 v[160:175], v[12:15], v[188:191], v[160:175]
 ds_read_b64_tr_b16 v[184:185], v242 offset:12288
 ds_read_b64_tr_b16 v[186:187], v242 offset:12800
 s_waitcnt lgkmcnt(4)
 v_mfma_f32_32x32x16_bf16 v[160:175], v[16:19], v[176:179], v[160:175]
 ds_read_b64_tr_b16 v[188:189], v242 offset:14336
 ds_read_b64_tr_b16 v[190:191], v242 offset:14848
 v_cvt_pk_bf16_f32 v200, v144, v145
 v_cvt_pk_bf16_f32 v201, v146, v147
 s_waitcnt lgkmcnt(4)
 v_mfma_f32_32x32x16_bf16 v[160:175], v[20:23], v[180:183], v[160:175]
 ds_read_b64_tr_b16 v[176:177], v242 offset:16384
 ds_read_b64_tr_b16 v[178:179], v242 offset:16896
 v_cvt_pk_bf16_f32 v202, v148, v149
 v_cvt_pk_bf16_f32 v203, v150, v151
 s_waitcnt lgkmcnt(4)
 v_mfma_f32_32x32x16_bf16 v[160:175], v[24:27], v[184:187], v[160:175]
 ds_read_b64_tr_b16 v[180:181], v242 offset:18432
 ds_read_b64_tr_b16 v[182:183], v242 offset:18944
 buffer_store_dwordx4 v[200:203], v246, s[4:7], s55 offen offset:0 sc1
 v_cvt_pk_bf16_f32 v204, v152, v153
 s_waitcnt lgkmcnt(4)
 v_mfma_f32_32x32x16_bf16 v[160:175], v[28:31], v[188:191], v[160:175]
 ds_read_b64_tr_b16 v[184:185], v242 offset:20480
 ds_read_b64_tr_b16 v[186:187], v242 offset:20992
 v_cvt_pk_bf16_f32 v205, v154, v155
 v_cvt_pk_bf16_f32 v206, v156, v157
 s_waitcnt lgkmcnt(4)
 v_mfma_f32_32x32x16_bf16 v[160:175], v[32:35], v[176:179], v[160:175]
 ds_read_b64_tr_b16 v[188:189], v242 offset:22528
 ds_read_b64_tr_b16 v[190:191], v242 offset:23040
 v_cvt_pk_bf16_f32 v207, v158, v159
 buffer_store_dwordx4 v[204:207], v246, s[4:7], s55 offen offset:1024 sc1
 s_waitcnt lgkmcnt(4)
 v_mfma_f32_32x32x16_bf16 v[160:175], v[36:39], v[180:183], v[160:175]
 ds_read_b64_tr_b16 v[176:177], v242 offset:24576
 ds_read_b64_tr_b16 v[178:179], v242 offset:25088
 s_waitcnt lgkmcnt(4)
 v_mfma_f32_32x32x16_bf16 v[160:175], v[40:43], v[184:187], v[160:175]
 ds_read_b64_tr_b16 v[180:181], v242 offset:26624
 ds_read_b64_tr_b16 v[182:183], v242 offset:27136
 s_waitcnt lgkmcnt(4)
 v_mfma_f32_32x32x16_bf16 v[160:175], v[44:47], v[188:191], v[160:175]
 ds_read_b64_tr_b16 v[184:185], v242 offset:28672
 ds_read_b64_tr_b16 v[186:187], v242 offset:29184
 s_waitcnt lgkmcnt(4)
 v_mfma_f32_32x32x16_bf16 v[160:175], v[48:51], v[176:179], v[160:175]
 ds_read_b64_tr_b16 v[188:189], v242 offset:30720
 ds_read_b64_tr_b16 v[190:191], v242 offset:31232
 s_waitcnt lgkmcnt(4)
 v_mfma_f32_32x32x16_bf16 v[160:175], v[52:55], v[180:183], v[160:175]
 ds_read_b64_tr_b16 v[176:177], v242 offset:32768
 ds_read_b64_tr_b16 v[178:179], v242 offset:33280
 s_waitcnt lgkmcnt(4)
 v_mfma_f32_32x32x16_bf16 v[160:175], v[56:59], v[184:187], v[160:175]
 ds_read_b64_tr_b16 v[180:181], v242 offset:34816
 ds_read_b64_tr_b16 v[182:183], v242 offset:35328
 s_waitcnt lgkmcnt(4)
 v_mfma_f32_32x32x16_bf16 v[160:175], v[60:63], v[188:191], v[160:175]
 ds_read_b64_tr_b16 v[184:185], v243 offset:0
 ds_read_b64_tr_b16 v[186:187], v243 offset:512
 s_waitcnt lgkmcnt(4)
 v_mfma_f32_32x32x16_bf16 v[160:175], v[64:67], v[176:179], v[160:175]
 ds_read_b64_tr_b16 v[188:189], v243 offset:2048
 ds_read_b64_tr_b16 v[190:191], v243 offset:2560
 s_waitcnt lgkmcnt(4)
 v_mfma_f32_32x32x16_bf16 v[160:175], v[68:71], v[180:183], v[160:175]
 ds_read_b64_tr_b16 v[176:177], v243 offset:4096
 ds_read_b64_tr_b16 v[178:179], v243 offset:4608
 s_waitcnt lgkmcnt(4)
 v_mfma_f32_32x32x16_bf16 v[160:175], v[72:75], v[184:187], v[160:175]
 ds_read_b64_tr_b16 v[180:181], v243 offset:6144
 ds_read_b64_tr_b16 v[182:183], v243 offset:6656
 s_waitcnt lgkmcnt(4)
 v_mfma_f32_32x32x16_bf16 v[160:175], v[76:79], v[188:191], v[160:175]
 ds_read_b64_tr_b16 v[184:185], v243 offset:8192
 ds_read_b64_tr_b16 v[186:187], v243 offset:8704
 s_waitcnt lgkmcnt(4)
 v_mfma_f32_32x32x16_bf16 v[160:175], v[80:83], v[176:179], v[160:175]
 ds_read_b64_tr_b16 v[188:189], v243 offset:10240
 ds_read_b64_tr_b16 v[190:191], v243 offset:10752
 s_waitcnt lgkmcnt(4)
 v_mfma_f32_32x32x16_bf16 v[160:175], v[84:87], v[180:183], v[160:175]
 ds_read_b64_tr_b16 v[176:177], v243 offset:12288
 ds_read_b64_tr_b16 v[178:179], v243 offset:12800
 s_waitcnt lgkmcnt(4)
 v_mfma_f32_32x32x16_bf16 v[160:175], v[88:91], v[184:187], v[160:175]
 ds_read_b64_tr_b16 v[180:181], v243 offset:14336
 ds_read_b64_tr_b16 v[182:183], v243 offset:14848
 s_waitcnt lgkmcnt(4)
 v_mfma_f32_32x32x16_bf16 v[160:175], v[92:95], v[188:191], v[160:175]
 ds_read_b64_tr_b16 v[184:185], v243 offset:16384
 ds_read_b64_tr_b16 v[186:187], v243 offset:16896
 s_waitcnt lgkmcnt(4)
 v_mfma_f32_32x32x16_bf16 v[160:175], v[96:99], v[176:179], v[160:175]
 ds_read_b64_tr_b16 v[188:189], v243 offset:18432
 ds_read_b64_tr_b16 v[190:191], v243 offset:18944
 s_waitcnt lgkmcnt(4)
 v_mfma_f32_32x32x16_bf16 v[160:175], v[100:103], v[180:183], v[160:175]
 ds_read_b64_tr_b16 v[176:177], v243 offset:20480
 ds_read_b64_tr_b16 v[178:179], v243 offset:20992
 s_waitcnt lgkmcnt(4)
 v_mfma_f32_32x32x16_bf16 v[160:175], v[104:107], v[184:187], v[160:175]
 ds_read_b64_tr_b16 v[180:181], v243 offset:22528
 ds_read_b64_tr_b16 v[182:183], v243 offset:23040
 s_waitcnt lgkmcnt(4)
 v_mfma_f32_32x32x16_bf16 v[160:175], v[108:111], v[188:191], v[160:175]
 ds_read_b64_tr_b16 v[184:185], v243 offset:24576
 ds_read_b64_tr_b16 v[186:187], v243 offset:25088
 s_waitcnt lgkmcnt(4)
 v_mfma_f32_32x32x16_bf16 v[160:175], v[112:115], v[176:179], v[160:175]
 ds_read_b64_tr_b16 v[188:189], v243 offset:26624
 ds_read_b64_tr_b16 v[190:191], v243 offset:27136
 s_waitcnt lgkmcnt(4)
 v_mfma_f32_32x32x16_bf16 v[160:175], v[116:119], v[180:183], v[160:175]
 ds_read_b64_tr_b16 v[176:177], v243 offset:28672
 ds_read_b64_tr_b16 v[178:179], v243 offset:29184
 s_waitcnt lgkmcnt(4)
 v_mfma_f32_32x32x16_bf16 v[160:175], v[120:123], v[184:187], v[160:175]
 ds_read_b64_tr_b16 v[180:181], v243 offset:30720
 ds_read_b64_tr_b16 v[182:183], v243 offset:31232
 s_waitcnt lgkmcnt(4)
 v_mfma_f32_32x32x16_bf16 v[160:175], v[124:127], v[188:191], v[160:175]
 ds_read_b64_tr_b16 v[184:185], v243 offset:32768
 ds_read_b64_tr_b16 v[186:187], v243 offset:33280
 s_waitcnt lgkmcnt(4)
 v_mfma_f32_32x32x16_bf16 v[160:175], v[128:131], v[176:179], v[160:175]
 ds_read_b64_tr_b16 v[188:189], v243 offset:34816
 ds_read_b64_tr_b16 v[190:191], v243 offset:35328
 s_waitcnt lgkmcnt(4)
 v_mfma_f32_32x32x16_bf16 v[160:175], v[132:135], v[180:183], v[160:175]
 s_waitcnt lgkmcnt(2)
 v_mfma_f32_32x32x16_bf16 v[160:175], v[136:139], v[184:187], v[160:175]
 s_waitcnt lgkmcnt(0)
 v_mfma_f32_32x32x16_bf16 v[160:175], v[140:143], v[188:191], v[160:175]
L_projj_296:
 s_mov_b32 s56, s55
 s_cmp_lt_u32 s52, s53
 s_cbranch_scc1 L_proj_287
 s_nop 7
 s_nop 3
 v_cvt_pk_bf16_f32 v192, v160, v161
 v_cvt_pk_bf16_f32 v193, v162, v163
 v_cvt_pk_bf16_f32 v194, v164, v165
 v_cvt_pk_bf16_f32 v195, v166, v167
 buffer_store_dwordx4 v[192:195], v246, s[4:7], s56 offen offset:2048 sc1
 v_cvt_pk_bf16_f32 v196, v168, v169
 v_cvt_pk_bf16_f32 v197, v170, v171
 v_cvt_pk_bf16_f32 v198, v172, v173
 v_cvt_pk_bf16_f32 v199, v174, v175
 buffer_store_dwordx4 v[196:199], v246, s[4:7], s56 offen offset:3072 sc1
 s_cmp_eq_u32 s89, 1
 s_cbranch_scc1 L_fin_286
 s_cmp_ge_u32 s48, 32
 s_cbranch_scc1 L_goffn_284
 s_waitcnt vmcnt(0)
 s_barrier
 s_mov_b32 s72, 65016064
 s_cmp_lg_u32 s46, 0
 s_cbranch_scc1 L_sig_297
 v_mov_b32 v247, 12
 v_mov_b32 v248, 0
 s_mov_b64 exec, 1
 buffer_atomic_add v247, v248, s[4:7], s72 offen
 s_mov_b64 exec, -1
L_sig_297:
 v_lshlrev_b32 v247, 3, v246
 s_lshl_b32 s72, s48, 2
 s_add_u32 s72, s72, s46
 s_lshl_b32 s72, s72, 13
 s_add_u32 s72, s72, 50462720
 buffer_load_dword v248, v247, s[4:7], s72 offen sc1
 s_add_u32 s72, s72, 1048576
 buffer_load_dword v248, v247, s[4:7], s72 offen sc1
 s_add_u32 s72, s72, 1048576
 buffer_load_dword v248, v247, s[4:7], s72 offen sc1
 s_add_u32 s72, s72, 1048576
 buffer_load_dword v248, v247, s[4:7], s72 offen sc1
 s_add_u32 s72, s72, 1048576
 buffer_load_dword v248, v247, s[4:7], s72 offen sc1
 s_add_u32 s72, s72, 1048576
 buffer_load_dword v248, v247, s[4:7], s72 offen sc1
 s_add_u32 s72, s72, 1048576
 buffer_load_dword v248, v247, s[4:7], s72 offen sc1
 s_add_u32 s72, s72, 1048576
 buffer_load_dword v248, v247, s[4:7], s72 offen sc1
 s_add_u32 s72, s72, 1048576
 s_waitcnt vmcnt(0)
 s_branch L_engine
L_goffn_284:
 v_accvgpr_write_b32 a0, 0
 v_accvgpr_write_b32 a1, 0
 v_accvgpr_write_b32 a2, 0
 v_accvgpr_write_b32 a3, 0
 v_accvgpr_write_b32 a4, 0
 v_accvgpr_write_b32 a5, 0
 v_accvgpr_write_b32 a6, 0
 v_accvgpr_write_b32 a7, 0
 v_accvgpr_write_b32 a8, 0
 v_accvgpr_write_b32 a9, 0
 v_accvgpr_write_b32 a10, 0
 v_accvgpr_write_b32 a11, 0
 v_accvgpr_write_b32 a12, 0
 v_accvgpr_write_b32 a13, 0
 v_accvgpr_write_b32 a14, 0
 v_accvgpr_write_b32 a15, 0
 v_accvgpr_write_b32 a16, 0
 v_accvgpr_write_b32 a17, 0
 v_accvgpr_write_b32 a18, 0
 v_accvgpr_write_b32 a19, 0
 v_accvgpr_write_b32 a20, 0
 v_accvgpr_write_b32 a21, 0
 v_accvgpr_write_b32 a22, 0
 v_accvgpr_write_b32 a23, 0
 v_accvgpr_write_b32 a24, 0
 v_accvgpr_write_b32 a25, 0
 v_accvgpr_write_b32 a26, 0
 v_accvgpr_write_b32 a27, 0
 v_accvgpr_write_b32 a28, 0
 v_accvgpr_write_b32 a29, 0
 v_accvgpr_write_b32 a30, 0
 v_accvgpr_write_b32 a31, 0
 v_accvgpr_write_b32 a32, 0
 v_accvgpr_write_b32 a33, 0
 v_accvgpr_write_b32 a34, 0
 v_accvgpr_write_b32 a35, 0
 v_accvgpr_write_b32 a36, 0
 v_accvgpr_write_b32 a37, 0
 v_accvgpr_write_b32 a38, 0
 v_accvgpr_write_b32 a39, 0
 v_accvgpr_write_b32 a40, 0
 v_accvgpr_write_b32 a41, 0
 v_accvgpr_write_b32 a42, 0
 v_accvgpr_write_b32 a43, 0
 v_accvgpr_write_b32 a44, 0
 v_accvgpr_write_b32 a45, 0
 v_accvgpr_write_b32 a46, 0
 v_accvgpr_write_b32 a47, 0
 v_accvgpr_write_b32 a48, 0
 v_accvgpr_write_b32 a49, 0
 v_accvgpr_write_b32 a50, 0
 v_accvgpr_write_b32 a51, 0
 v_accvgpr_write_b32 a52, 0
 v_accvgpr_write_b32 a53, 0
 v_accvgpr_write_b32 a54, 0
 v_accvgpr_write_b32 a55, 0
 v_accvgpr_write_b32 a56, 0
 v_accvgpr_write_b32 a57, 0
 v_accvgpr_write_b32 a58, 0
 v_accvgpr_write_b32 a59, 0
 v_accvgpr_write_b32 a60, 0
 v_accvgpr_write_b32 a61, 0
 v_accvgpr_write_b32 a62, 0
 v_accvgpr_write_b32 a63, 0
 v_accvgpr_write_b32 a64, 0
 v_accvgpr_write_b32 a65, 0
 v_accvgpr_write_b32 a66, 0
 v_accvgpr_write_b32 a67, 0
 v_accvgpr_write_b32 a68, 0
 v_accvgpr_write_b32 a69, 0
 v_accvgpr_write_b32 a70, 0
 v_accvgpr_write_b32 a71, 0
 v_accvgpr_write_b32 a72, 0
 v_accvgpr_write_b32 a73, 0
 v_accvgpr_write_b32 a74, 0
 v_accvgpr_write_b32 a75, 0
 v_accvgpr_write_b32 a76, 0
 v_accvgpr_write_b32 a77, 0
 v_accvgpr_write_b32 a78, 0
 v_accvgpr_write_b32 a79, 0
 v_accvgpr_write_b32 a80, 0
 v_accvgpr_write_b32 a81, 0
 v_accvgpr_write_b32 a82, 0
 v_accvgpr_write_b32 a83, 0
 v_accvgpr_write_b32 a84, 0
 v_accvgpr_write_b32 a85, 0
 v_accvgpr_write_b32 a86, 0
 v_accvgpr_write_b32 a87, 0
 v_accvgpr_write_b32 a88, 0
 v_accvgpr_write_b32 a89, 0
 v_accvgpr_write_b32 a90, 0
 v_accvgpr_write_b32 a91, 0
 v_accvgpr_write_b32 a92, 0
 v_accvgpr_write_b32 a93, 0
 v_accvgpr_write_b32 a94, 0
 v_accvgpr_write_b32 a95, 0
 v_accvgpr_write_b32 a96, 0
 v_accvgpr_write_b32 a97, 0
 v_accvgpr_write_b32 a98, 0
 v_accvgpr_write_b32 a99, 0
 v_accvgpr_write_b32 a100, 0
 v_accvgpr_write_b32 a101, 0
 v_accvgpr_write_b32 a102, 0
 v_accvgpr_write_b32 a103, 0
 v_accvgpr_write_b32 a104, 0
 v_accvgpr_write_b32 a105, 0
 v_accvgpr_write_b32 a106, 0
 v_accvgpr_write_b32 a107, 0
 v_accvgpr_write_b32 a108, 0
 v_accvgpr_write_b32 a109, 0
 v_accvgpr_write_b32 a110, 0
 v_accvgpr_write_b32 a111, 0
 v_accvgpr_write_b32 a112, 0
 v_accvgpr_write_b32 a113, 0
 v_accvgpr_write_b32 a114, 0
 v_accvgpr_write_b32 a115, 0
 v_accvgpr_write_b32 a116, 0
 v_accvgpr_write_b32 a117, 0
 v_accvgpr_write_b32 a118, 0
 v_accvgpr_write_b32 a119, 0
 v_accvgpr_write_b32 a120, 0
 v_accvgpr_write_b32 a121, 0
 v_accvgpr_write_b32 a122, 0
 v_accvgpr_write_b32 a123, 0
 v_accvgpr_write_b32 a124, 0
 v_accvgpr_write_b32 a125, 0
 v_accvgpr_write_b32 a126, 0
 v_accvgpr_write_b32 a127, 0
 v_accvgpr_write_b32 a128, 0
 v_accvgpr_write_b32 a129, 0
 v_accvgpr_write_b32 a130, 0
 v_accvgpr_write_b32 a131, 0
 v_accvgpr_write_b32 a132, 0
 v_accvgpr_write_b32 a133, 0
 v_accvgpr_write_b32 a134, 0
 v_accvgpr_write_b32 a135, 0
 v_accvgpr_write_b32 a136, 0
 v_accvgpr_write_b32 a137, 0
 v_accvgpr_write_b32 a138, 0
 v_accvgpr_write_b32 a139, 0
 v_accvgpr_write_b32 a140, 0
 v_accvgpr_write_b32 a141, 0
 v_accvgpr_write_b32 a142, 0
 v_accvgpr_write_b32 a143, 0
 v_accvgpr_write_b32 a144, 0
 v_accvgpr_write_b32 a145, 0
 v_accvgpr_write_b32 a146, 0
 v_accvgpr_write_b32 a147, 0
 v_accvgpr_write_b32 a148, 0
 v_accvgpr_write_b32 a149, 0
 v_accvgpr_write_b32 a150, 0
 v_accvgpr_write_b32 a151, 0
 v_accvgpr_write_b32 a152, 0
 v_accvgpr_write_b32 a153, 0
 v_accvgpr_write_b32 a154, 0
 v_accvgpr_write_b32 a155, 0
 v_accvgpr_write_b32 a156, 0
 v_accvgpr_write_b32 a157, 0
 v_accvgpr_write_b32 a158, 0
 v_accvgpr_write_b32 a159, 0
 v_accvgpr_write_b32 a160, 0
 v_accvgpr_write_b32 a161, 0
 v_accvgpr_write_b32 a162, 0
 v_accvgpr_write_b32 a163, 0
 v_accvgpr_write_b32 a164, 0
 v_accvgpr_write_b32 a165, 0
 v_accvgpr_write_b32 a166, 0
 v_accvgpr_write_b32 a167, 0
 v_accvgpr_write_b32 a168, 0
 v_accvgpr_write_b32 a169, 0
 v_accvgpr_write_b32 a170, 0
 v_accvgpr_write_b32 a171, 0
 v_accvgpr_write_b32 a172, 0
 v_accvgpr_write_b32 a173, 0
 v_accvgpr_write_b32 a174, 0
 v_accvgpr_write_b32 a175, 0
 v_accvgpr_write_b32 a176, 0
 v_accvgpr_write_b32 a177, 0
 v_accvgpr_write_b32 a178, 0
 v_accvgpr_write_b32 a179, 0
 v_accvgpr_write_b32 a180, 0
 v_accvgpr_write_b32 a181, 0
 v_accvgpr_write_b32 a182, 0
 v_accvgpr_write_b32 a183, 0
 v_accvgpr_write_b32 a184, 0
 v_accvgpr_write_b32 a185, 0
 v_accvgpr_write_b32 a186, 0
 v_accvgpr_write_b32 a187, 0
 v_accvgpr_write_b32 a188, 0
 v_accvgpr_write_b32 a189, 0
 v_accvgpr_write_b32 a190, 0
 v_accvgpr_write_b32 a191, 0
 v_accvgpr_write_b32 a192, 0
 v_accvgpr_write_b32 a193, 0
 v_accvgpr_write_b32 a194, 0
 v_accvgpr_write_b32 a195, 0
 v_accvgpr_write_b32 a196, 0
 v_accvgpr_write_b32 a197, 0
 v_accvgpr_write_b32 a198, 0
 v_accvgpr_write_b32 a199, 0
 v_accvgpr_write_b32 a200, 0
 v_accvgpr_write_b32 a201, 0
 v_accvgpr_write_b32 a202, 0
 v_accvgpr_write_b32 a203, 0
 v_accvgpr_write_b32 a204, 0
 v_accvgpr_write_b32 a205, 0
 v_accvgpr_write_b32 a206, 0
 v_accvgpr_write_b32 a207, 0
 v_accvgpr_write_b32 a208, 0
 v_accvgpr_write_b32 a209, 0
 v_accvgpr_write_b32 a210, 0
 v_accvgpr_write_b32 a211, 0
 v_accvgpr_write_b32 a212, 0
 v_accvgpr_write_b32 a213, 0
 v_accvgpr_write_b32 a214, 0
 v_accvgpr_write_b32 a215, 0
 v_accvgpr_write_b32 a216, 0
 v_accvgpr_write_b32 a217, 0
 v_accvgpr_write_b32 a218, 0
 v_accvgpr_write_b32 a219, 0
 v_accvgpr_write_b32 a220, 0
 v_accvgpr_write_b32 a221, 0
 v_accvgpr_write_b32 a222, 0
 v_accvgpr_write_b32 a223, 0
 v_accvgpr_write_b32 a224, 0
 v_accvgpr_write_b32 a225, 0
 v_accvgpr_write_b32 a226, 0
 v_accvgpr_write_b32 a227, 0
 v_accvgpr_write_b32 a228, 0
 v_accvgpr_write_b32 a229, 0
 v_accvgpr_write_b32 a230, 0
 v_accvgpr_write_b32 a231, 0
 v_accvgpr_write_b32 a232, 0
 v_accvgpr_write_b32 a233, 0
 v_accvgpr_write_b32 a234, 0
 v_accvgpr_write_b32 a235, 0
 v_accvgpr_write_b32 a236, 0
 v_accvgpr_write_b32 a237, 0
 v_accvgpr_write_b32 a238, 0
 v_accvgpr_write_b32 a239, 0
 v_accvgpr_write_b32 a240, 0
 v_accvgpr_write_b32 a241, 0
 v_accvgpr_write_b32 a242, 0
 v_accvgpr_write_b32 a243, 0
 v_accvgpr_write_b32 a244, 0
 v_accvgpr_write_b32 a245, 0
 v_accvgpr_write_b32 a246, 0
 v_accvgpr_write_b32 a247, 0
 v_accvgpr_write_b32 a248, 0
 v_accvgpr_write_b32 a249, 0
 v_accvgpr_write_b32 a250, 0
 v_accvgpr_write_b32 a251, 0
 v_accvgpr_write_b32 a252, 0
 v_accvgpr_write_b32 a253, 0
 v_accvgpr_write_b32 a254, 0
 v_accvgpr_write_b32 a255, 0
 v_mov_b64 v[208:209], 0
 v_mov_b64 v[210:211], 0
 v_mov_b64 v[212:213], 0
 v_mov_b64 v[214:215], 0
 v_mov_b64 v[216:217], 0
 v_mov_b64 v[218:219], 0
 v_mov_b64 v[220:221], 0
 v_mov_b64 v[222:223], 0
 v_mov_b64 v[224:225], 0
 v_mov_b64 v[226:227], 0
 v_mov_b64 v[228:229], 0
 v_mov_b64 v[230:231], 0
 v_mov_b64 v[232:233], 0
 v_mov_b64 v[234:235], 0
 v_mov_b64 v[236:237], 0
 v_mov_b64 v[238:239], 0
 s_mov_b32 s52, 0
L_ffn_298:
 s_waitcnt vmcnt(0) lgkmcnt(0)
 s_barrier
 s_lshl_b32 s3, s46, 10
 s_sub_u32 s76, s57, s3
 s_sub_u32 s77, 73728, s76
 s_add_u32 s57, s77, s3
 s_sub_u32 s76, s76, s77
 v_add_u32 v240, s76, v240
 v_add_u32 v241, s76, v241
 v_add_u32 v242, s76, v242
 v_add_u32 v243, s76, v243
 s_add_u32 s78, s63, s52
 s_mov_b32 s40, s32
 s_mov_b32 s41, s33
 s_mov_b32 s42, s34
 s_mov_b32 s43, s35
 s_mul_i32 s54, s78, 73728
 s_lshr_b32 s3, s46, 1
 s_mul_i32 s3, s3, 18432
 s_add_u32 s54, s54, s3
 s_and_b32 s3, s46, 1
 s_mul_i32 s3, s3, 4608
 s_add_u32 s54, s54, s3
 ds_read_b64_tr_b16 v[176:177], v240 offset:0
 ds_read_b64_tr_b16 v[178:179], v240 offset:512
 ds_read_b64_tr_b16 v[180:181], v240 offset:2048
 ds_read_b64_tr_b16 v[182:183], v240 offset:2560
 ds_read_b64_tr_b16 v[184:185], v240 offset:4096
 ds_read_b64_tr_b16 v[186:187], v240 offset:4608
 s_waitcnt lgkmcnt(4)
 v_mfma_f32_32x32x16_bf16 v[144:159], v[176:179], v[0:3], 0
 ds_read_b64_tr_b16 v[188:189], v240 offset:6144
 ds_read_b64_tr_b16 v[190:191], v240 offset:6656
 s_add_u32 m0, s57, 0
 s_add_u32 s75, s54, 0
 buffer_load_dwordx4 v245, s[40:43], s75 offen  lds
 s_waitcnt lgkmcnt(4)
 v_mfma_f32_32x32x16_bf16 v[144:159], v[180:183], v[4:7], v[144:159]
 ds_read_b64_tr_b16 v[176:177], v240 offset:8192
 ds_read_b64_tr_b16 v[178:179], v240 offset:8704
 s_add_u32 m0, s57, 4096
 s_add_u32 s75, s54, 36864
 buffer_load_dwordx4 v245, s[40:43], s75 offen  lds
 s_waitcnt lgkmcnt(4)
 v_mfma_f32_32x32x16_bf16 v[144:159], v[184:187], v[8:11], v[144:159]
 ds_read_b64_tr_b16 v[180:181], v240 offset:10240
 ds_read_b64_tr_b16 v[182:183], v240 offset:10752
 s_add_u32 m0, s57, 8192
 s_add_u32 s75, s54, 128
 buffer_load_dwordx4 v245, s[40:43], s75 offen  lds
 s_waitcnt lgkmcnt(4)
 v_mfma_f32_32x32x16_bf16 v[144:159], v[188:191], v[12:15], v[144:159]
 ds_read_b64_tr_b16 v[184:185], v240 offset:12288
 ds_read_b64_tr_b16 v[186:187], v240 offset:12800
 s_add_u32 m0, s57, 12288
 s_add_u32 s75, s54, 36992
 buffer_load_dwordx4 v245, s[40:43], s75 offen  lds
 s_waitcnt lgkmcnt(4)
 v_mfma_f32_32x32x16_bf16 v[144:159], v[176:179], v[16:19], v[144:159]
 ds_read_b64_tr_b16 v[188:189], v240 offset:14336
 ds_read_b64_tr_b16 v[190:191], v240 offset:14848
 s_add_u32 m0, s57, 16384
 s_add_u32 s75, s54, 256
 buffer_load_dwordx4 v245, s[40:43], s75 offen  lds
 s_waitcnt lgkmcnt(4)
 v_mfma_f32_32x32x16_bf16 v[144:159], v[180:183], v[20:23], v[144:159]
 ds_read_b64_tr_b16 v[176:177], v240 offset:16384
 ds_read_b64_tr_b16 v[178:179], v240 offset:16896
 s_add_u32 m0, s57, 20480
 s_add_u32 s75, s54, 37120
 buffer_load_dwordx4 v245, s[40:43], s75 offen  lds
 s_waitcnt lgkmcnt(4)
 v_mfma_f32_32x32x16_bf16 v[144:159], v[184:187], v[24:27], v[144:159]
 ds_read_b64_tr_b16 v[180:181], v240 offset:18432
 ds_read_b64_tr_b16 v[182:183], v240 offset:18944
 s_add_u32 m0, s57, 24576
 s_add_u32 s75, s54, 384
 buffer_load_dwordx4 v245, s[40:43], s75 offen  lds
 s_waitcnt lgkmcnt(4)
 v_mfma_f32_32x32x16_bf16 v[144:159], v[188:191], v[28:31], v[144:159]
 ds_read_b64_tr_b16 v[184:185], v240 offset:20480
 ds_read_b64_tr_b16 v[186:187], v240 offset:20992
 s_add_u32 m0, s57, 28672
 s_add_u32 s75, s54, 37248
 buffer_load_dwordx4 v245, s[40:43], s75 offen  lds
 s_waitcnt lgkmcnt(4)
 v_mfma_f32_32x32x16_bf16 v[144:159], v[176:179], v[32:35], v[144:159]
 ds_read_b64_tr_b16 v[188:189], v240 offset:22528
 ds_read_b64_tr_b16 v[190:191], v240 offset:23040
 s_add_u32 m0, s57, 32768
 s_add_u32 s75, s54, 512
 buffer_load_dwordx4 v245, s[40:43], s75 offen  lds
 s_waitcnt lgkmcnt(4)
 v_mfma_f32_32x32x16_bf16 v[144:159], v[180:183], v[36:39], v[144:159]
 ds_read_b64_tr_b16 v[176:177], v240 offset:24576
 ds_read_b64_tr_b16 v[178:179], v240 offset:25088
 s_add_u32 m0, s57, 36864
 s_add_u32 s75, s54, 37376
 buffer_load_dwordx4 v245, s[40:43], s75 offen  lds
 s_waitcnt lgkmcnt(4)
 v_mfma_f32_32x32x16_bf16 v[144:159], v[184:187], v[40:43], v[144:159]
 ds_read_b64_tr_b16 v[180:181], v240 offset:26624
 ds_read_b64_tr_b16 v[182:183], v240 offset:27136
 s_add_u32 m0, s57, 40960
 s_add_u32 s75, s54, 640
 buffer_load_dwordx4 v245, s[40:43], s75 offen  lds
 s_waitcnt lgkmcnt(4)
 v_mfma_f32_32x32x16_bf16 v[144:159], v[188:191], v[44:47], v[144:159]
 ds_read_b64_tr_b16 v[184:185], v240 offset:28672
 ds_read_b64_tr_b16 v[186:187], v240 offset:29184
 s_add_u32 m0, s57, 45056
 s_add_u32 s75, s54, 37504
 buffer_load_dwordx4 v245, s[40:43], s75 offen  lds
 s_waitcnt lgkmcnt(4)
 v_mfma_f32_32x32x16_bf16 v[144:159], v[176:179], v[48:51], v[144:159]
 ds_read_b64_tr_b16 v[188:189], v240 offset:30720
 ds_read_b64_tr_b16 v[190:191], v240 offset:31232
 s_add_u32 m0, s57, 49152
 s_add_u32 s75, s54, 768
 buffer_load_dwordx4 v245, s[40:43], s75 offen  lds
 s_waitcnt lgkmcnt(4)
 v_mfma_f32_32x32x16_bf16 v[144:159], v[180:183], v[52:55], v[144:159]
 ds_read_b64_tr_b16 v[176:177], v240 offset:32768
 ds_read_b64_tr_b16 v[178:179], v240 offset:33280
 s_add_u32 m0, s57, 53248
 s_add_u32 s75, s54, 37632
 buffer_load_dwordx4 v245, s[40:43], s75 offen  lds
 s_waitcnt lgkmcnt(4)
 v_mfma_f32_32x32x16_bf16 v[144:159], v[184:187], v[56:59], v[144:159]
 ds_read_b64_tr_b16 v[180:181], v240 offset:34816
 ds_read_b64_tr_b16 v[182:183], v240 offset:35328
 s_add_u32 m0, s57, 57344
 s_add_u32 s75, s54, 896
 buffer_load_dwordx4 v245, s[40:43], s75 offen  lds
 s_waitcnt lgkmcnt(4)
 v_mfma_f32_32x32x16_bf16 v[144:159], v[188:191], v[60:63], v[144:159]
 ds_read_b64_tr_b16 v[184:185], v241 offset:0
 ds_read_b64_tr_b16 v[186:187], v241 offset:512
 s_add_u32 m0, s57, 61440
 s_add_u32 s75, s54, 37760
 buffer_load_dwordx4 v245, s[40:43], s75 offen  lds
 s_waitcnt lgkmcnt(4)
 v_mfma_f32_32x32x16_bf16 v[144:159], v[176:179], v[64:67], v[144:159]
 ds_read_b64_tr_b16 v[188:189], v241 offset:2048
 ds_read_b64_tr_b16 v[190:191], v241 offset:2560
 s_add_u32 m0, s57, 65536
 s_add_u32 s75, s54, 1024
 buffer_load_dwordx4 v245, s[40:43], s75 offen  lds
 s_waitcnt lgkmcnt(4)
 v_mfma_f32_32x32x16_bf16 v[144:159], v[180:183], v[68:71], v[144:159]
 ds_read_b64_tr_b16 v[176:177], v241 offset:4096
 ds_read_b64_tr_b16 v[178:179], v241 offset:4608
 s_add_u32 m0, s57, 69632
 s_add_u32 s75, s54, 37888
 buffer_load_dwordx4 v245, s[40:43], s75 offen  lds
 s_waitcnt lgkmcnt(4)
 v_mfma_f32_32x32x16_bf16 v[144:159], v[184:187], v[72:75], v[144:159]
 ds_read_b64_tr_b16 v[180:181], v241 offset:6144
 ds_read_b64_tr_b16 v[182:183], v241 offset:6656
 s_waitcnt lgkmcnt(4)
 v_mfma_f32_32x32x16_bf16 v[144:159], v[188:191], v[76:79], v[144:159]
 ds_read_b64_tr_b16 v[184:185], v241 offset:8192
 ds_read_b64_tr_b16 v[186:187], v241 offset:8704
 s_waitcnt lgkmcnt(4)
 v_mfma_f32_32x32x16_bf16 v[144:159], v[176:179], v[80:83], v[144:159]
 ds_read_b64_tr_b16 v[188:189], v241 offset:10240
 ds_read_b64_tr_b16 v[190:191], v241 offset:10752
 s_waitcnt lgkmcnt(4)
 v_mfma_f32_32x32x16_bf16 v[144:159], v[180:183], v[84:87], v[144:159]
 ds_read_b64_tr_b16 v[176:177], v241 offset:12288
 ds_read_b64_tr_b16 v[178:179], v241 offset:12800
 s_waitcnt lgkmcnt(4)
 v_mfma_f32_32x32x16_bf16 v[144:159], v[184:187], v[88:91], v[144:159]
 ds_read_b64_tr_b16 v[180:181], v241 offset:14336
 ds_read_b64_tr_b16 v[182:183], v241 offset:14848
 s_waitcnt lgkmcnt(4)
 v_mfma_f32_32x32x16_bf16 v[144:159], v[188:191], v[92:95], v[144:159]
 ds_read_b64_tr_b16 v[184:185], v241 offset:16384
 ds_read_b64_tr_b16 v[186:187], v241 offset:16896
 s_waitcnt lgkmcnt(4)
 v_mfma_f32_32x32x16_bf16 v[144:159], v[176:179], v[96:99], v[144:159]
 ds_read_b64_tr_b16 v[188:189], v241 offset:18432
 ds_read_b64_tr_b16 v[190:191], v241 offset:18944
 s_waitcnt lgkmcnt(4)
 v_mfma_f32_32x32x16_bf16 v[144:159], v[180:183], v[100:103], v[144:159]
 ds_read_b64_tr_b16 v[176:177], v241 offset:20480
 ds_read_b64_tr_b16 v[178:179], v241 offset:20992
 s_waitcnt lgkmcnt(4)
 v_mfma_f32_32x32x16_bf16 v[144:159], v[184:187], v[104:107], v[144:159]
 ds_read_b64_tr_b16 v[180:181], v241 offset:22528
 ds_read_b64_tr_b16 v[182:183], v241 offset:23040
 s_waitcnt lgkmcnt(4)
 v_mfma_f32_32x32x16_bf16 v[144:159], v[188:191], v[108:111], v[144:159]
 ds_read_b64_tr_b16 v[184:185], v241 offset:24576
 ds_read_b64_tr_b16 v[186:187], v241 offset:25088
 s_waitcnt lgkmcnt(4)
 v_mfma_f32_32x32x16_bf16 v[144:159], v[176:179], v[112:115], v[144:159]
 ds_read_b64_tr_b16 v[188:189], v241 offset:26624
 ds_read_b64_tr_b16 v[190:191], v241 offset:27136
 s_waitcnt lgkmcnt(4)
 v_mfma_f32_32x32x16_bf16 v[144:159], v[180:183], v[116:119], v[144:159]
 ds_read_b64_tr_b16 v[176:177], v241 offset:28672
 ds_read_b64_tr_b16 v[178:179], v241 offset:29184
 s_waitcnt lgkmcnt(4)
 v_mfma_f32_32x32x16_bf16 v[144:159], v[184:187], v[120:123], v[144:159]
 ds_read_b64_tr_b16 v[180:181], v241 offset:30720
 ds_read_b64_tr_b16 v[182:183], v241 offset:31232
 s_waitcnt lgkmcnt(4)
 v_mfma_f32_32x32x16_bf16 v[144:159], v[188:191], v[124:127], v[144:159]
 ds_read_b64_tr_b16 v[184:185], v241 offset:32768
 ds_read_b64_tr_b16 v[186:187], v241 offset:33280
 s_waitcnt lgkmcnt(4)
 v_mfma_f32_32x32x16_bf16 v[144:159], v[176:179], v[128:131], v[144:159]
 ds_read_b64_tr_b16 v[188:189], v241 offset:34816
 ds_read_b64_tr_b16 v[190:191], v241 offset:35328
 s_waitcnt lgkmcnt(4)
 v_mfma_f32_32x32x16_bf16 v[144:159], v[180:183], v[132:135], v[144:159]
 ds_read_b64_tr_b16 v[176:177], v242 offset:0
 ds_read_b64_tr_b16 v[178:179], v242 offset:512
 s_waitcnt lgkmcnt(4)
 v_mfma_f32_32x32x16_bf16 v[144:159], v[184:187], v[136:139], v[144:159]
 ds_read_b64_tr_b16 v[180:181], v242 offset:2048
 ds_read_b64_tr_b16 v[182:183], v242 offset:2560
 s_waitcnt lgkmcnt(4)
 v_mfma_f32_32x32x16_bf16 v[144:159], v[188:191], v[140:143], v[144:159]
 ds_read_b64_tr_b16 v[184:185], v242 offset:4096
 ds_read_b64_tr_b16 v[186:187], v242 offset:4608
 s_waitcnt lgkmcnt(4)
 v_mfma_f32_32x32x16_bf16 v[160:175], v[176:179], v[0:3], 0
 ds_read_b64_tr_b16 v[188:189], v242 offset:6144
 ds_read_b64_tr_b16 v[190:191], v242 offset:6656
 s_waitcnt lgkmcnt(4)
 v_mfma_f32_32x32x16_bf16 v[160:175], v[180:183], v[4:7], v[160:175]
 ds_read_b64_tr_b16 v[176:177], v242 offset:8192
 ds_read_b64_tr_b16 v[178:179], v242 offset:8704
 s_waitcnt lgkmcnt(4)
 v_mfma_f32_32x32x16_bf16 v[160:175], v[184:187], v[8:11], v[160:175]
 ds_read_b64_tr_b16 v[180:181], v242 offset:10240
 ds_read_b64_tr_b16 v[182:183], v242 offset:10752
 s_waitcnt lgkmcnt(4)
 v_mfma_f32_32x32x16_bf16 v[160:175], v[188:191], v[12:15], v[160:175]
 ds_read_b64_tr_b16 v[184:185], v242 offset:12288
 ds_read_b64_tr_b16 v[186:187], v242 offset:12800
 s_waitcnt lgkmcnt(4)
 v_mfma_f32_32x32x16_bf16 v[160:175], v[176:179], v[16:19], v[160:175]
 ds_read_b64_tr_b16 v[188:189], v242 offset:14336
 ds_read_b64_tr_b16 v[190:191], v242 offset:14848
 v_mul_f32 v247, s68, v144
 v_mul_f32 v248, s68, v145
 v_exp_f32 v247, v247
 v_exp_f32 v248, v248
 s_waitcnt lgkmcnt(4)
 v_mfma_f32_32x32x16_bf16 v[160:175], v[180:183], v[20:23], v[160:175]
 ds_read_b64_tr_b16 v[176:177], v242 offset:16384
 ds_read_b64_tr_b16 v[178:179], v242 offset:16896
 v_add_f32 v247, 1.0, v247
 v_add_f32 v248, 1.0, v248
 v_rcp_f32 v247, v247
 v_rcp_f32 v248, v248
 s_waitcnt lgkmcnt(4)
 v_mfma_f32_32x32x16_bf16 v[160:175], v[184:187], v[24:27], v[160:175]
 ds_read_b64_tr_b16 v[180:181], v242 offset:18432
 ds_read_b64_tr_b16 v[182:183], v242 offset:18944
 v_mul_f32 v144, v144, v247
 v_mul_f32 v145, v145, v248
 v_cvt_pk_bf16_f32 v192, v144, v145
 v_mul_f32 v249, s68, v146
 s_waitcnt lgkmcnt(4)
 v_mfma_f32_32x32x16_bf16 v[160:175], v[188:191], v[28:31], v[160:175]
 ds_read_b64_tr_b16 v[184:185], v242 offset:20480
 ds_read_b64_tr_b16 v[186:187], v242 offset:20992
 v_mul_f32 v250, s68, v147
 v_exp_f32 v249, v249
 v_exp_f32 v250, v250
 v_add_f32 v249, 1.0, v249
 s_waitcnt lgkmcnt(4)
 v_mfma_f32_32x32x16_bf16 v[160:175], v[176:179], v[32:35], v[160:175]
 ds_read_b64_tr_b16 v[188:189], v242 offset:22528
 ds_read_b64_tr_b16 v[190:191], v242 offset:23040
 v_add_f32 v250, 1.0, v250
 v_rcp_f32 v249, v249
 v_rcp_f32 v250, v250
 v_mul_f32 v146, v146, v249
 s_waitcnt lgkmcnt(4)
 v_mfma_f32_32x32x16_bf16 v[160:175], v[180:183], v[36:39], v[160:175]
 ds_read_b64_tr_b16 v[176:177], v242 offset:24576
 ds_read_b64_tr_b16 v[178:179], v242 offset:25088
 v_mul_f32 v147, v147, v250
 v_cvt_pk_bf16_f32 v193, v146, v147
 v_mul_f32 v247, s68, v148
 v_mul_f32 v248, s68, v149
 s_waitcnt lgkmcnt(4)
 v_mfma_f32_32x32x16_bf16 v[160:175], v[184:187], v[40:43], v[160:175]
 ds_read_b64_tr_b16 v[180:181], v242 offset:26624
 ds_read_b64_tr_b16 v[182:183], v242 offset:27136
 v_exp_f32 v247, v247
 v_exp_f32 v248, v248
 v_add_f32 v247, 1.0, v247
 v_add_f32 v248, 1.0, v248
 s_waitcnt lgkmcnt(4)
 v_mfma_f32_32x32x16_bf16 v[160:175], v[188:191], v[44:47], v[160:175]
 ds_read_b64_tr_b16 v[184:185], v242 offset:28672
 ds_read_b64_tr_b16 v[186:187], v242 offset:29184
 v_rcp_f32 v247, v247
 v_rcp_f32 v248, v248
 v_mul_f32 v148, v148, v247
 v_mul_f32 v149, v149, v248
 s_waitcnt lgkmcnt(4)
 v_mfma_f32_32x32x16_bf16 v[160:175], v[176:179], v[48:51], v[160:175]
 ds_read_b64_tr_b16 v[188:189], v242 offset:30720
 ds_read_b64_tr_b16 v[190:191], v242 offset:31232
 v_cvt_pk_bf16_f32 v194, v148, v149
 v_mul_f32 v249, s68, v150
 v_mul_f32 v250, s68, v151
 v_exp_f32 v249, v249
 s_waitcnt lgkmcnt(4)
 v_mfma_f32_32x32x16_bf16 v[160:175], v[180:183], v[52:55], v[160:175]
 ds_read_b64_tr_b16 v[176:177], v242 offset:32768
 ds_read_b64_tr_b16 v[178:179], v242 offset:33280
 v_exp_f32 v250, v250
 v_add_f32 v249, 1.0, v249
 v_add_f32 v250, 1.0, v250
 v_rcp_f32 v249, v249
 s_waitcnt lgkmcnt(4)
 v_mfma_f32_32x32x16_bf16 v[160:175], v[184:187], v[56:59], v[160:175]
 ds_read_b64_tr_b16 v[180:181], v242 offset:34816
 ds_read_b64_tr_b16 v[182:183], v242 offset:35328
 v_rcp_f32 v250, v250
 v_mul_f32 v150, v150, v249
 v_mul_f32 v151, v151, v250
 v_cvt_pk_bf16_f32 v195, v150, v151
 s_waitcnt lgkmcnt(4)
 v_mfma_f32_32x32x16_bf16 v[160:175], v[188:191], v[60:63], v[160:175]
 ds_read_b64_tr_b16 v[184:185], v243 offset:0
 ds_read_b64_tr_b16 v[186:187], v243 offset:512
 v_mul_f32 v247, s68, v152
 v_mul_f32 v248, s68, v153
 v_exp_f32 v247, v247
 v_exp_f32 v248, v248
 s_waitcnt lgkmcnt(4)
 v_mfma_f32_32x32x16_bf16 v[160:175], v[176:179], v[64:67], v[160:175]
 ds_read_b64_tr_b16 v[188:189], v243 offset:2048
 ds_read_b64_tr_b16 v[190:191], v243 offset:2560
 v_add_f32 v247, 1.0, v247
 v_add_f32 v248, 1.0, v248
 v_rcp_f32 v247, v247
 v_rcp_f32 v248, v248
 s_waitcnt lgkmcnt(4)
 v_mfma_f32_32x32x16_bf16 v[160:175], v[180:183], v[68:71], v[160:175]
 ds_read_b64_tr_b16 v[176:177], v243 offset:4096
 ds_read_b64_tr_b16 v[178:179], v243 offset:4608
 v_mul_f32 v152, v152, v247
 v_mul_f32 v153, v153, v248
 v_cvt_pk_bf16_f32 v196, v152, v153
 v_mul_f32 v249, s68, v154
 s_waitcnt lgkmcnt(4)
 v_mfma_f32_32x32x16_bf16 v[160:175], v[184:187], v[72:75], v[160:175]
 ds_read_b64_tr_b16 v[180:181], v243 offset:6144
 ds_read_b64_tr_b16 v[182:183], v243 offset:6656
 v_mul_f32 v250, s68, v155
 v_exp_f32 v249, v249
 v_exp_f32 v250, v250
 v_add_f32 v249, 1.0, v249
 s_waitcnt lgkmcnt(4)
 v_mfma_f32_32x32x16_bf16 v[160:175], v[188:191], v[76:79], v[160:175]
 ds_read_b64_tr_b16 v[184:185], v243 offset:8192
 ds_read_b64_tr_b16 v[186:187], v243 offset:8704
 v_add_f32 v250, 1.0, v250
 v_rcp_f32 v249, v249
 v_rcp_f32 v250, v250
 v_mul_f32 v154, v154, v249
 s_waitcnt lgkmcnt(4)
 v_mfma_f32_32x32x16_bf16 v[160:175], v[176:179], v[80:83], v[160:175]
 ds_read_b64_tr_b16 v[188:189], v243 offset:10240
 ds_read_b64_tr_b16 v[190:191], v243 offset:10752
 v_mul_f32 v155, v155, v250
 v_cvt_pk_bf16_f32 v197, v154, v155
 v_mul_f32 v247, s68, v156
 v_mul_f32 v248, s68, v157
 s_waitcnt lgkmcnt(4)
 v_mfma_f32_32x32x16_bf16 v[160:175], v[180:183], v[84:87], v[160:175]
 ds_read_b64_tr_b16 v[176:177], v243 offset:12288
 ds_read_b64_tr_b16 v[178:179], v243 offset:12800
 v_exp_f32 v247, v247
 v_exp_f32 v248, v248
 v_add_f32 v247, 1.0, v247
 v_add_f32 v248, 1.0, v248
 s_waitcnt lgkmcnt(4)
 v_mfma_f32_32x32x16_bf16 v[160:175], v[184:187], v[88:91], v[160:175]
 ds_read_b64_tr_b16 v[180:181], v243 offset:14336
 ds_read_b64_tr_b16 v[182:183], v243 offset:14848
 v_rcp_f32 v247, v247
 v_rcp_f32 v248, v248
 v_mul_f32 v156, v156, v247
 v_mul_f32 v157, v157, v248
 s_waitcnt lgkmcnt(4)
 v_mfma_f32_32x32x16_bf16 v[160:175], v[188:191], v[92:95], v[160:175]
 ds_read_b64_tr_b16 v[184:185], v243 offset:16384
 ds_read_b64_tr_b16 v[186:187], v243 offset:16896
 v_cvt_pk_bf16_f32 v198, v156, v157
 v_mul_f32 v249, s68, v158
 v_mul_f32 v250, s68, v159
 v_exp_f32 v249, v249
 s_waitcnt lgkmcnt(4)
 v_mfma_f32_32x32x16_bf16 v[160:175], v[176:179], v[96:99], v[160:175]
 ds_read_b64_tr_b16 v[188:189], v243 offset:18432
 ds_read_b64_tr_b16 v[190:191], v243 offset:18944
 v_exp_f32 v250, v250
 v_add_f32 v249, 1.0, v249
 v_add_f32 v250, 1.0, v250
 v_rcp_f32 v249, v249
 s_waitcnt lgkmcnt(4)
 v_mfma_f32_32x32x16_bf16 v[160:175], v[180:183], v[100:103], v[160:175]
 ds_read_b64_tr_b16 v[176:177], v243 offset:20480
 ds_read_b64_tr_b16 v[178:179], v243 offset:20992
 v_rcp_f32 v250, v250
 v_mul_f32 v158, v158, v249
 v_mul_f32 v159, v159, v250
 v_cvt_pk_bf16_f32 v199, v158, v159
 s_waitcnt lgkmcnt(4)
 v_mfma_f32_32x32x16_bf16 v[160:175], v[184:187], v[104:107], v[160:175]
 ds_read_b64_tr_b16 v[180:181], v243 offset:22528
 ds_read_b64_tr_b16 v[182:183], v243 offset:23040
 s_waitcnt lgkmcnt(4)
 v_mfma_f32_32x32x16_bf16 v[160:175], v[188:191], v[108:111], v[160:175]
 ds_read_b64_tr_b16 v[184:185], v243 offset:24576
 ds_read_b64_tr_b16 v[186:187], v243 offset:25088
 s_waitcnt lgkmcnt(4)
 v_mfma_f32_32x32x16_bf16 v[160:175], v[176:179], v[112:115], v[160:175]
 ds_read_b64_tr_b16 v[188:189], v243 offset:26624
 ds_read_b64_tr_b16 v[190:191], v243 offset:27136
 s_waitcnt lgkmcnt(4)
 v_mfma_f32_32x32x16_bf16 v[160:175], v[180:183], v[116:119], v[160:175]
 ds_read_b64_tr_b16 v[176:177], v243 offset:28672
 ds_read_b64_tr_b16 v[178:179], v243 offset:29184
 s_waitcnt lgkmcnt(4)
 v_mfma_f32_32x32x16_bf16 v[160:175], v[184:187], v[120:123], v[160:175]
 ds_read_b64_tr_b16 v[180:181], v243 offset:30720
 ds_read_b64_tr_b16 v[182:183], v243 offset:31232
 s_waitcnt lgkmcnt(4)
 v_mfma_f32_32x32x16_bf16 v[160:175], v[188:191], v[124:127], v[160:175]
 ds_read_b64_tr_b16 v[184:185], v243 offset:32768
 ds_read_b64_tr_b16 v[186:187], v243 offset:33280
 s_waitcnt lgkmcnt(4)
 v_mfma_f32_32x32x16_bf16 v[160:175], v[176:179], v[128:131], v[160:175]
 ds_read_b64_tr_b16 v[188:189], v243 offset:34816
 ds_read_b64_tr_b16 v[190:191], v243 offset:35328
 s_waitcnt lgkmcnt(4)
 v_mfma_f32_32x32x16_bf16 v[160:175], v[180:183], v[132:135], v[160:175]
 s_waitcnt lgkmcnt(2)
 v_mfma_f32_32x32x16_bf16 v[160:175], v[184:187], v[136:139], v[160:175]
 s_waitcnt lgkmcnt(0)
 v_mfma_f32_32x32x16_bf16 v[160:175], v[188:191], v[140:143], v[160:175]
 s_waitcnt vmcnt(0) lgkmcnt(0)
 s_barrier
 s_lshl_b32 s3, s46, 10
 s_sub_u32 s76, s57, s3
 s_sub_u32 s77, 73728, s76
 s_add_u32 s57, s77, s3
 s_sub_u32 s76, s76, s77
 v_add_u32 v240, s76, v240
 v_add_u32 v241, s76, v241
 v_add_u32 v242, s76, v242
 v_add_u32 v243, s76, v243
 s_add_u32 s52, s52, 1
 s_add_u32 s78, s63, s52
 s_min_u32 s78, s78, 71
 s_cmp_eq_u32 s52, s64
 s_cbranch_scc1 L_ffnl_299
 s_mov_b32 s40, s28
 s_mov_b32 s41, s29
 s_mov_b32 s42, s30
 s_mov_b32 s43, s31
 s_lshl_b32 s54, s78, 7
 s_mul_i32 s3, s46, 73728
 s_add_u32 s54, s54, s3
 s_mov_b32 s67, 294912
 v_mov_b32 v252, v251
 s_branch L_ffnj_300
L_ffnl_299:
 s_mov_b32 s78, 0
 s_cmp_ge_u32 s78, s60
 s_cbranch_scc1 L_pq_301
 s_add_u32 s72, s59, s78
 s_cmp_ge_u32 s72, 64
 s_cbranch_scc1 L_pv_302
 s_mov_b32 s40, s12
 s_mov_b32 s41, s13
 s_mov_b32 s42, s14
 s_mov_b32 s43, s15
 s_mov_b32 s73, 0
 s_mov_b32 s66, 0
 s_branch L_pe_303
L_pv_302:
 s_sub_u32 s72, s72, 64
 s_mov_b32 s40, s16
 s_mov_b32 s41, s17
 s_mov_b32 s42, s18
 s_mov_b32 s43, s19
 s_mov_b32 s73, 16777216
 s_mov_b32 s66, 1
 s_branch L_pe_303
L_pq_301:
 s_sub_u32 s72, s78, s60
 s_add_u32 s72, s72, s61
 s_mov_b32 s40, s8
 s_mov_b32 s41, s9
 s_mov_b32 s42, s10
 s_mov_b32 s43, s11
 s_mov_b32 s73, 33554432
 s_mov_b32 s66, 0
L_pe_303:
 s_lshl_b32 s54, s72, 7
 s_lshl_b32 s3, s46, 16
 s_add_u32 s54, s54, s3
 s_lshl_b32 s74, s72, 12
 s_lshl_b32 s3, s58, 18
 s_add_u32 s74, s74, s3
 s_add_u32 s74, s74, s73
 s_mov_b32 s67, 262144
 v_mov_b32 v252, v244
L_ffnj_300:
 ds_read_b64_tr_b16 v[176:177], v240 offset:0
 ds_read_b64_tr_b16 v[178:179], v240 offset:512
 ds_read_b64_tr_b16 v[180:181], v242 offset:0
 ds_read_b64_tr_b16 v[182:183], v242 offset:512
 ds_read_b64_tr_b16 v[184:185], v240 offset:8192
 ds_read_b64_tr_b16 v[186:187], v240 offset:8704
 s_waitcnt lgkmcnt(4)
 v_mfma_f32_32x32x16_bf16 a[0:15], v[176:179], v[192:195], a[0:15]
 ds_read_b64_tr_b16 v[188:189], v242 offset:8192
 ds_read_b64_tr_b16 v[190:191], v242 offset:8704
 s_add_u32 m0, s57, 0
 s_nop 0
 buffer_load_dwordx4 v252, s[40:43], s54 offen  lds
 s_add_u32 s54, s54, s67
 s_waitcnt lgkmcnt(4)
 v_mfma_f32_32x32x16_bf16 a[16:31], v[180:183], v[192:195], a[16:31]
 ds_read_b64_tr_b16 v[176:177], v240 offset:16384
 ds_read_b64_tr_b16 v[178:179], v240 offset:16896
 s_add_u32 m0, s57, 4096
 s_nop 0
 buffer_load_dwordx4 v252, s[40:43], s54 offen  lds
 s_add_u32 s54, s54, s67
 s_waitcnt lgkmcnt(4)
 v_mfma_f32_32x32x16_bf16 a[32:47], v[184:187], v[192:195], a[32:47]
 ds_read_b64_tr_b16 v[180:181], v242 offset:16384
 ds_read_b64_tr_b16 v[182:183], v242 offset:16896
 s_add_u32 m0, s57, 8192
 s_nop 0
 buffer_load_dwordx4 v252, s[40:43], s54 offen  lds
 s_add_u32 s54, s54, s67
 s_waitcnt lgkmcnt(4)
 v_mfma_f32_32x32x16_bf16 a[48:63], v[188:191], v[192:195], a[48:63]
 ds_read_b64_tr_b16 v[184:185], v240 offset:24576
 ds_read_b64_tr_b16 v[186:187], v240 offset:25088
 s_add_u32 m0, s57, 12288
 s_nop 0
 buffer_load_dwordx4 v252, s[40:43], s54 offen  lds
 s_add_u32 s54, s54, s67
 s_waitcnt lgkmcnt(4)
 v_mfma_f32_32x32x16_bf16 a[64:79], v[176:179], v[192:195], a[64:79]
 ds_read_b64_tr_b16 v[188:189], v242 offset:24576
 ds_read_b64_tr_b16 v[190:191], v242 offset:25088
 s_add_u32 m0, s57, 16384
 s_nop 0
 buffer_load_dwordx4 v252, s[40:43], s54 offen  lds
 s_add_u32 s54, s54, s67
 v_mul_f32 v247, s68, v160
 v_mul_f32 v248, s68, v161
 v_exp_f32 v247, v247
 v_exp_f32 v248, v248
 s_waitcnt lgkmcnt(4)
 v_mfma_f32_32x32x16_bf16 a[80:95], v[180:183], v[192:195], a[80:95]
 ds_read_b64_tr_b16 v[176:177], v240 offset:32768
 ds_read_b64_tr_b16 v[178:179], v240 offset:33280
 s_add_u32 m0, s57, 20480
 s_nop 0
 buffer_load_dwordx4 v252, s[40:43], s54 offen  lds
 s_add_u32 s54, s54, s67
 v_add_f32 v247, 1.0, v247
 v_add_f32 v248, 1.0, v248
 v_rcp_f32 v247, v247
 v_rcp_f32 v248, v248
 s_waitcnt lgkmcnt(4)
 v_mfma_f32_32x32x16_bf16 a[96:111], v[184:187], v[192:195], a[96:111]
 ds_read_b64_tr_b16 v[180:181], v242 offset:32768
 ds_read_b64_tr_b16 v[182:183], v242 offset:33280
 s_add_u32 m0, s57, 24576
 s_nop 0
 buffer_load_dwordx4 v252, s[40:43], s54 offen  lds
 s_add_u32 s54, s54, s67
 v_mul_f32 v160, v160, v247
 v_mul_f32 v161, v161, v248
 v_cvt_pk_bf16_f32 v200, v160, v161
 v_mul_f32 v249, s68, v162
 s_waitcnt lgkmcnt(4)
 v_mfma_f32_32x32x16_bf16 a[112:127], v[188:191], v[192:195], a[112:127]
 ds_read_b64_tr_b16 v[184:185], v241 offset:4096
 ds_read_b64_tr_b16 v[186:187], v241 offset:4608
 s_add_u32 m0, s57, 28672
 s_nop 0
 buffer_load_dwordx4 v252, s[40:43], s54 offen  lds
 s_add_u32 s54, s54, s67
 v_mul_f32 v250, s68, v163
 v_exp_f32 v249, v249
 v_exp_f32 v250, v250
 v_add_f32 v249, 1.0, v249
 s_waitcnt lgkmcnt(4)
 v_mfma_f32_32x32x16_bf16 a[128:143], v[176:179], v[192:195], a[128:143]
 ds_read_b64_tr_b16 v[188:189], v243 offset:4096
 ds_read_b64_tr_b16 v[190:191], v243 offset:4608
 s_add_u32 m0, s57, 32768
 s_nop 0
 buffer_load_dwordx4 v252, s[40:43], s54 offen  lds
 s_add_u32 s54, s54, s67
 v_add_f32 v250, 1.0, v250
 v_rcp_f32 v249, v249
 v_rcp_f32 v250, v250
 v_mul_f32 v162, v162, v249
 s_waitcnt lgkmcnt(4)
 v_mfma_f32_32x32x16_bf16 a[144:159], v[180:183], v[192:195], a[144:159]
 ds_read_b64_tr_b16 v[176:177], v241 offset:12288
 ds_read_b64_tr_b16 v[178:179], v241 offset:12800
 s_add_u32 m0, s57, 36864
 s_nop 0
 buffer_load_dwordx4 v252, s[40:43], s54 offen  lds
 s_add_u32 s54, s54, s67
 v_mul_f32 v163, v163, v250
 v_cvt_pk_bf16_f32 v201, v162, v163
 v_mul_f32 v247, s68, v164
 v_mul_f32 v248, s68, v165
 s_waitcnt lgkmcnt(4)
 v_mfma_f32_32x32x16_bf16 a[160:175], v[184:187], v[192:195], a[160:175]
 ds_read_b64_tr_b16 v[180:181], v243 offset:12288
 ds_read_b64_tr_b16 v[182:183], v243 offset:12800
 s_add_u32 m0, s57, 40960
 s_nop 0
 buffer_load_dwordx4 v252, s[40:43], s54 offen  lds
 s_add_u32 s54, s54, s67
 v_exp_f32 v247, v247
 v_exp_f32 v248, v248
 v_add_f32 v247, 1.0, v247
 v_add_f32 v248, 1.0, v248
 s_waitcnt lgkmcnt(4)
 v_mfma_f32_32x32x16_bf16 a[176:191], v[188:191], v[192:195], a[176:191]
 ds_read_b64_tr_b16 v[184:185], v241 offset:20480
 ds_read_b64_tr_b16 v[186:187], v241 offset:20992
 s_add_u32 m0, s57, 45056
 s_nop 0
 buffer_load_dwordx4 v252, s[40:43], s54 offen  lds
 s_add_u32 s54, s54, s67
 v_rcp_f32 v247, v247
 v_rcp_f32 v248, v248
 v_mul_f32 v164, v164, v247
 v_mul_f32 v165, v165, v248
 s_waitcnt lgkmcnt(4)
 v_mfma_f32_32x32x16_bf16 a[192:207], v[176:179], v[192:195], a[192:207]
 ds_read_b64_tr_b16 v[188:189], v243 offset:20480
 ds_read_b64_tr_b16 v[190:191], v243 offset:20992
 s_add_u32 m0, s57, 49152
 s_nop 0
 buffer_load_dwordx4 v252, s[40:43], s54 offen  lds
 s_add_u32 s54, s54, s67
 v_cvt_pk_bf16_f32 v202, v164, v165
 v_mul_f32 v249, s68, v166
 v_mul_f32 v250, s68, v167
 v_exp_f32 v249, v249
 s_waitcnt lgkmcnt(4)
 v_mfma_f32_32x32x16_bf16 a[208:223], v[180:183], v[192:195], a[208:223]
 ds_read_b64_tr_b16 v[176:177], v241 offset:28672
 ds_read_b64_tr_b16 v[178:179], v241 offset:29184
 s_add_u32 m0, s57, 53248
 s_nop 0
 buffer_load_dwordx4 v252, s[40:43], s54 offen  lds
 s_add_u32 s54, s54, s67
 v_exp_f32 v250, v250
 v_add_f32 v249, 1.0, v249
 v_add_f32 v250, 1.0, v250
 v_rcp_f32 v249, v249
 s_waitcnt lgkmcnt(4)
 v_mfma_f32_32x32x16_bf16 a[224:239], v[184:187], v[192:195], a[224:239]
 ds_read_b64_tr_b16 v[180:181], v243 offset:28672
 ds_read_b64_tr_b16 v[182:183], v243 offset:29184
 s_add_u32 m0, s57, 57344
 s_nop 0
 buffer_load_dwordx4 v252, s[40:43], s54 offen  lds
 s_add_u32 s54, s54, s67
 v_rcp_f32 v250, v250
 v_mul_f32 v166, v166, v249
 v_mul_f32 v167, v167, v250
 v_cvt_pk_bf16_f32 v203, v166, v167
 s_waitcnt lgkmcnt(4)
 v_mfma_f32_32x32x16_bf16 a[240:255], v[188:191], v[192:195], a[240:255]
 ds_read_b64_tr_b16 v[184:185], v240 offset:2048
 ds_read_b64_tr_b16 v[186:187], v240 offset:2560
 s_add_u32 m0, s57, 61440
 s_nop 0
 buffer_load_dwordx4 v252, s[40:43], s54 offen  lds
 s_add_u32 s54, s54, s67
 v_mul_f32 v247, s68, v168
 v_mul_f32 v248, s68, v169
 v_exp_f32 v247, v247
 v_exp_f32 v248, v248
 s_waitcnt lgkmcnt(4)
 v_mfma_f32_32x32x16_bf16 v[208:223], v[176:179], v[192:195], v[208:223]
 ds_read_b64_tr_b16 v[188:189], v242 offset:2048
 ds_read_b64_tr_b16 v[190:191], v242 offset:2560
 s_add_u32 m0, s57, 65536
 s_nop 0
 buffer_load_dwordx4 v252, s[40:43], s54 offen  lds
 s_add_u32 s54, s54, s67
 v_add_f32 v247, 1.0, v247
 v_add_f32 v248, 1.0, v248
 v_rcp_f32 v247, v247
 v_rcp_f32 v248, v248
 s_waitcnt lgkmcnt(4)
 v_mfma_f32_32x32x16_bf16 v[224:239], v[180:183], v[192:195], v[224:239]
 ds_read_b64_tr_b16 v[176:177], v240 offset:10240
 ds_read_b64_tr_b16 v[178:179], v240 offset:10752
 s_add_u32 m0, s57, 69632
 s_nop 0
 buffer_load_dwordx4 v252, s[40:43], s54 offen  lds
 s_add_u32 s54, s54, s67
 v_mul_f32 v168, v168, v247
 v_mul_f32 v169, v169, v248
 v_cvt_pk_bf16_f32 v204, v168, v169
 v_mul_f32 v249, s68, v170
 s_waitcnt lgkmcnt(4)
 v_mfma_f32_32x32x16_bf16 a[0:15], v[184:187], v[196:199], a[0:15]
 ds_read_b64_tr_b16 v[180:181], v242 offset:10240
 ds_read_b64_tr_b16 v[182:183], v242 offset:10752
 v_mul_f32 v250, s68, v171
 v_exp_f32 v249, v249
 v_exp_f32 v250, v250
 v_add_f32 v249, 1.0, v249
 s_waitcnt lgkmcnt(4)
 v_mfma_f32_32x32x16_bf16 a[16:31], v[188:191], v[196:199], a[16:31]
 ds_read_b64_tr_b16 v[184:185], v240 offset:18432
 ds_read_b64_tr_b16 v[186:187], v240 offset:18944
 v_add_f32 v250, 1.0, v250
 v_rcp_f32 v249, v249
 v_rcp_f32 v250, v250
 v_mul_f32 v170, v170, v249
 s_waitcnt lgkmcnt(4)
 v_mfma_f32_32x32x16_bf16 a[32:47], v[176:179], v[196:199], a[32:47]
 ds_read_b64_tr_b16 v[188:189], v242 offset:18432
 ds_read_b64_tr_b16 v[190:191], v242 offset:18944
 v_mul_f32 v171, v171, v250
 v_cvt_pk_bf16_f32 v205, v170, v171
 v_mul_f32 v247, s68, v172
 v_mul_f32 v248, s68, v173
 s_waitcnt lgkmcnt(4)
 v_mfma_f32_32x32x16_bf16 a[48:63], v[180:183], v[196:199], a[48:63]
 ds_read_b64_tr_b16 v[176:177], v240 offset:26624
 ds_read_b64_tr_b16 v[178:179], v240 offset:27136
 v_exp_f32 v247, v247
 v_exp_f32 v248, v248
 v_add_f32 v247, 1.0, v247
 v_add_f32 v248, 1.0, v248
 s_waitcnt lgkmcnt(4)
 v_mfma_f32_32x32x16_bf16 a[64:79], v[184:187], v[196:199], a[64:79]
 ds_read_b64_tr_b16 v[180:181], v242 offset:26624
 ds_read_b64_tr_b16 v[182:183], v242 offset:27136
 v_rcp_f32 v247, v247
 v_rcp_f32 v248, v248
 v_mul_f32 v172, v172, v247
 v_mul_f32 v173, v173, v248
 s_waitcnt lgkmcnt(4)
 v_mfma_f32_32x32x16_bf16 a[80:95], v[188:191], v[196:199], a[80:95]
 ds_read_b64_tr_b16 v[184:185], v240 offset:34816
 ds_read_b64_tr_b16 v[186:187], v240 offset:35328
 v_cvt_pk_bf16_f32 v206, v172, v173
 v_mul_f32 v249, s68, v174
 v_mul_f32 v250, s68, v175
 v_exp_f32 v249, v249
 s_waitcnt lgkmcnt(4)
 v_mfma_f32_32x32x16_bf16 a[96:111], v[176:179], v[196:199], a[96:111]
 ds_read_b64_tr_b16 v[188:189], v242 offset:34816
 ds_read_b64_tr_b16 v[190:191], v242 offset:35328
 v_exp_f32 v250, v250
 v_add_f32 v249, 1.0, v249
 v_add_f32 v250, 1.0, v250
 v_rcp_f32 v249, v249
 s_waitcnt lgkmcnt(4)
 v_mfma_f32_32x32x16_bf16 a[112:127], v[180:183], v[196:199], a[112:127]
 ds_read_b64_tr_b16 v[176:177], v241 offset:6144
 ds_read_b64_tr_b16 v[178:179], v241 offset:6656
 v_rcp_f32 v250, v250
 v_mul_f32 v174, v174, v249
 v_mul_f32 v175, v175, v250
 v_cvt_pk_bf16_f32 v207, v174, v175
 s_waitcnt lgkmcnt(4)
 v_mfma_f32_32x32x16_bf16 a[128:143], v[184:187], v[196:199], a[128:143]
 ds_read_b64_tr_b16 v[180:181], v243 offset:6144
 ds_read_b64_tr_b16 v[182:183], v243 offset:6656
 s_waitcnt lgkmcnt(4)
 v_mfma_f32_32x32x16_bf16 a[144:159], v[188:191], v[196:199], a[144:159]
 ds_read_b64_tr_b16 v[184:185], v241 offset:14336
 ds_read_b64_tr_b16 v[186:187], v241 offset:14848
 s_waitcnt lgkmcnt(4)
 v_mfma_f32_32x32x16_bf16 a[160:175], v[176:179], v[196:199], a[160:175]
 ds_read_b64_tr_b16 v[188:189], v243 offset:14336
 ds_read_b64_tr_b16 v[190:191], v243 offset:14848
 s_waitcnt lgkmcnt(4)
 v_mfma_f32_32x32x16_bf16 a[176:191], v[180:183], v[196:199], a[176:191]
 ds_read_b64_tr_b16 v[176:177], v241 offset:22528
 ds_read_b64_tr_b16 v[178:179], v241 offset:23040
 s_waitcnt lgkmcnt(4)
 v_mfma_f32_32x32x16_bf16 a[192:207], v[184:187], v[196:199], a[192:207]
 ds_read_b64_tr_b16 v[180:181], v243 offset:22528
 ds_read_b64_tr_b16 v[182:183], v243 offset:23040
 s_waitcnt lgkmcnt(4)
 v_mfma_f32_32x32x16_bf16 a[208:223], v[188:191], v[196:199], a[208:223]
 ds_read_b64_tr_b16 v[184:185], v241 offset:30720
 ds_read_b64_tr_b16 v[186:187], v241 offset:31232
 s_waitcnt lgkmcnt(4)
 v_mfma_f32_32x32x16_bf16 a[224:239], v[176:179], v[196:199], a[224:239]
 ds_read_b64_tr_b16 v[188:189], v243 offset:30720
 ds_read_b64_tr_b16 v[190:191], v243 offset:31232
 s_waitcnt lgkmcnt(4)
 v_mfma_f32_32x32x16_bf16 a[240:255], v[180:183], v[196:199], a[240:255]
 ds_read_b64_tr_b16 v[176:177], v240 offset:4096
 ds_read_b64_tr_b16 v[178:179], v240 offset:4608
 s_waitcnt lgkmcnt(4)
 v_mfma_f32_32x32x16_bf16 v[208:223], v[184:187], v[196:199], v[208:223]
 ds_read_b64_tr_b16 v[180:181], v242 offset:4096
 ds_read_b64_tr_b16 v[182:183], v242 offset:4608
 s_waitcnt lgkmcnt(4)
 v_mfma_f32_32x32x16_bf16 v[224:239], v[188:191], v[196:199], v[224:239]
 ds_read_b64_tr_b16 v[184:185], v240 offset:12288
 ds_read_b64_tr_b16 v[186:187], v240 offset:12800
 s_waitcnt lgkmcnt(4)
 v_mfma_f32_32x32x16_bf16 a[0:15], v[176:179], v[200:203], a[0:15]
 ds_read_b64_tr_b16 v[188:189], v242 offset:12288
 ds_read_b64_tr_b16 v[190:191], v242 offset:12800
 s_waitcnt lgkmcnt(4)
 v_mfma_f32_32x32x16_bf16 a[16:31], v[180:183], v[200:203], a[16:31]
 ds_read_b64_tr_b16 v[176:177], v240 offset:20480
 ds_read_b64_tr_b16 v[178:179], v240 offset:20992
 s_waitcnt lgkmcnt(4)
 v_mfma_f32_32x32x16_bf16 a[32:47], v[184:187], v[200:203], a[32:47]
 ds_read_b64_tr_b16 v[180:181], v242 offset:20480
 ds_read_b64_tr_b16 v[182:183], v242 offset:20992
 s_waitcnt lgkmcnt(4)
 v_mfma_f32_32x32x16_bf16 a[48:63], v[188:191], v[200:203], a[48:63]
 ds_read_b64_tr_b16 v[184:185], v240 offset:28672
 ds_read_b64_tr_b16 v[186:187], v240 offset:29184
 s_waitcnt lgkmcnt(4)
 v_mfma_f32_32x32x16_bf16 a[64:79], v[176:179], v[200:203], a[64:79]
 ds_read_b64_tr_b16 v[188:189], v242 offset:28672
 ds_read_b64_tr_b16 v[190:191], v242 offset:29184
 s_waitcnt lgkmcnt(4)
 v_mfma_f32_32x32x16_bf16 a[80:95], v[180:183], v[200:203], a[80:95]
 ds_read_b64_tr_b16 v[176:177], v241 offset:0
 ds_read_b64_tr_b16 v[178:179], v241 offset:512
 s_waitcnt lgkmcnt(4)
 v_mfma_f32_32x32x16_bf16 a[96:111], v[184:187], v[200:203], a[96:111]
 ds_read_b64_tr_b16 v[180:181], v243 offset:0
 ds_read_b64_tr_b16 v[182:183], v243 offset:512
 s_waitcnt lgkmcnt(4)
 v_mfma_f32_32x32x16_bf16 a[112:127], v[188:191], v[200:203], a[112:127]
 ds_read_b64_tr_b16 v[184:185], v241 offset:8192
 ds_read_b64_tr_b16 v[186:187], v241 offset:8704
 s_waitcnt lgkmcnt(4)
 v_mfma_f32_32x32x16_bf16 a[128:143], v[176:179], v[200:203], a[128:143]
 ds_read_b64_tr_b16 v[188:189], v243 offset:8192
 ds_read_b64_tr_b16 v[190:191], v243 offset:8704
 s_waitcnt lgkmcnt(4)
 v_mfma_f32_32x32x16_bf16 a[144:159], v[180:183], v[200:203], a[144:159]
 ds_read_b64_tr_b16 v[176:177], v241 offset:16384
 ds_read_b64_tr_b16 v[178:179], v241 offset:16896
 s_waitcnt lgkmcnt(4)
 v_mfma_f32_32x32x16_bf16 a[160:175], v[184:187], v[200:203], a[160:175]
 ds_read_b64_tr_b16 v[180:181], v243 offset:16384
 ds_read_b64_tr_b16 v[182:183], v243 offset:16896
 s_waitcnt lgkmcnt(4)
 v_mfma_f32_32x32x16_bf16 a[176:191], v[188:191], v[200:203], a[176:191]
 ds_read_b64_tr_b16 v[184:185], v241 offset:24576
 ds_read_b64_tr_b16 v[186:187], v241 offset:25088
 s_waitcnt lgkmcnt(4)
 v_mfma_f32_32x32x16_bf16 a[192:207], v[176:179], v[200:203], a[192:207]
 ds_read_b64_tr_b16 v[188:189], v243 offset:24576
 ds_read_b64_tr_b16 v[190:191], v243 offset:25088
 s_waitcnt lgkmcnt(4)
 v_mfma_f32_32x32x16_bf16 a[208:223], v[180:183], v[200:203], a[208:223]
 ds_read_b64_tr_b16 v[176:177], v241 offset:32768
 ds_read_b64_tr_b16 v[178:179], v241 offset:33280
 s_waitcnt lgkmcnt(4)
 v_mfma_f32_32x32x16_bf16 a[224:239], v[184:187], v[200:203], a[224:239]
 ds_read_b64_tr_b16 v[180:181], v243 offset:32768
 ds_read_b64_tr_b16 v[182:183], v243 offset:33280
 s_waitcnt lgkmcnt(4)
 v_mfma_f32_32x32x16_bf16 a[240:255], v[188:191], v[200:203], a[240:255]
 ds_read_b64_tr_b16 v[184:185], v240 offset:6144
 ds_read_b64_tr_b16 v[186:187], v240 offset:6656
 s_waitcnt lgkmcnt(4)
 v_mfma_f32_32x32x16_bf16 v[208:223], v[176:179], v[200:203], v[208:223]
 ds_read_b64_tr_b16 v[188:189], v242 offset:6144
 ds_read_b64_tr_b16 v[190:191], v242 offset:6656
 s_waitcnt lgkmcnt(4)
 v_mfma_f32_32x32x16_bf16 v[224:239], v[180:183], v[200:203], v[224:239]
 ds_read_b64_tr_b16 v[176:177], v240 offset:14336
 ds_read_b64_tr_b16 v[178:179], v240 offset:14848
 s_waitcnt lgkmcnt(4)
 v_mfma_f32_32x32x16_bf16 a[0:15], v[184:187], v[204:207], a[0:15]
 ds_read_b64_tr_b16 v[180:181], v242 offset:14336
 ds_read_b64_tr_b16 v[182:183], v242 offset:14848
 s_waitcnt lgkmcnt(4)
 v_mfma_f32_32x32x16_bf16 a[16:31], v[188:191], v[204:207], a[16:31]
 ds_read_b64_tr_b16 v[184:185], v240 offset:22528
 ds_read_b64_tr_b16 v[186:187], v240 offset:23040
 s_waitcnt lgkmcnt(4)
 v_mfma_f32_32x32x16_bf16 a[32:47], v[176:179], v[204:207], a[32:47]
 ds_read_b64_tr_b16 v[188:189], v242 offset:22528
 ds_read_b64_tr_b16 v[190:191], v242 offset:23040
 s_waitcnt lgkmcnt(4)
 v_mfma_f32_32x32x16_bf16 a[48:63], v[180:183], v[204:207], a[48:63]
 ds_read_b64_tr_b16 v[176:177], v240 offset:30720
 ds_read_b64_tr_b16 v[178:179], v240 offset:31232
 s_waitcnt lgkmcnt(4)
 v_mfma_f32_32x32x16_bf16 a[64:79], v[184:187], v[204:207], a[64:79]
 ds_read_b64_tr_b16 v[180:181], v242 offset:30720
 ds_read_b64_tr_b16 v[182:183], v242 offset:31232
 s_waitcnt lgkmcnt(4)
 v_mfma_f32_32x32x16_bf16 a[80:95], v[188:191], v[204:207], a[80:95]
 ds_read_b64_tr_b16 v[184:185], v241 offset:2048
 ds_read_b64_tr_b16 v[186:187], v241 offset:2560
 s_waitcnt lgkmcnt(4)
 v_mfma_f32_32x32x16_bf16 a[96:111], v[176:179], v[204:207], a[96:111]
 ds_read_b64_tr_b16 v[188:189], v243 offset:2048
 ds_read_b64_tr_b16 v[190:191], v243 offset:2560
 s_waitcnt lgkmcnt(4)
 v_mfma_f32_32x32x16_bf16 a[112:127], v[180:183], v[204:207], a[112:127]
 ds_read_b64_tr_b16 v[176:177], v241 offset:10240
 ds_read_b64_tr_b16 v[178:179], v241 offset:10752
 s_waitcnt lgkmcnt(4)
 v_mfma_f32_32x32x16_bf16 a[128:143], v[184:187], v[204:207], a[128:143]
 ds_read_b64_tr_b16 v[180:181], v243 offset:10240
 ds_read_b64_tr_b16 v[182:183], v243 offset:10752
 s_waitcnt lgkmcnt(4)
 v_mfma_f32_32x32x16_bf16 a[144:159], v[188:191], v[204:207], a[144:159]
 ds_read_b64_tr_b16 v[184:185], v241 offset:18432
 ds_read_b64_tr_b16 v[186:187], v241 offset:18944
 s_waitcnt lgkmcnt(4)
 v_mfma_f32_32x32x16_bf16 a[160:175], v[176:179], v[204:207], a[160:175]
 ds_read_b64_tr_b16 v[188:189], v243 offset:18432
 ds_read_b64_tr_b16 v[190:191], v243 offset:18944
 s_waitcnt lgkmcnt(4)
 v_mfma_f32_32x32x16_bf16 a[176:191], v[180:183], v[204:207], a[176:191]
 ds_read_b64_tr_b16 v[176:177], v241 offset:26624
 ds_read_b64_tr_b16 v[178:179], v241 offset:27136
 s_waitcnt lgkmcnt(4)
 v_mfma_f32_32x32x16_bf16 a[192:207], v[184:187], v[204:207], a[192:207]
 ds_read_b64_tr_b16 v[180:181], v243 offset:26624
 ds_read_b64_tr_b16 v[182:183], v243 offset:27136
 s_waitcnt lgkmcnt(4)
 v_mfma_f32_32x32x16_bf16 a[208:223], v[188:191], v[204:207], a[208:223]
 ds_read_b64_tr_b16 v[184:185], v241 offset:34816
 ds_read_b64_tr_b16 v[186:187], v241 offset:35328
 s_waitcnt lgkmcnt(4)
 v_mfma_f32_32x32x16_bf16 a[224:239], v[176:179], v[204:207], a[224:239]
 ds_read_b64_tr_b16 v[188:189], v243 offset:34816
 ds_read_b64_tr_b16 v[190:191], v243 offset:35328
 s_waitcnt lgkmcnt(4)
 v_mfma_f32_32x32x16_bf16 a[240:255], v[180:183], v[204:207], a[240:255]
 s_waitcnt lgkmcnt(2)
 v_mfma_f32_32x32x16_bf16 v[208:223], v[184:187], v[204:207], v[208:223]
 s_waitcnt lgkmcnt(0)
 v_mfma_f32_32x32x16_bf16 v[224:239], v[188:191], v[204:207], v[224:239]
 s_cmp_lt_u32 s52, s64
 s_cbranch_scc1 L_ffn_298
 s_mul_i32 s55, s58, 589824
 s_lshl_b32 s3, s51, 10
 s_add_u32 s55, s55, s3
 s_add_u32 s55, s55, 67108864
 s_nop 7
 v_accvgpr_read_b32 v247, a0
 v_accvgpr_read_b32 v248, a1
 v_cvt_pk_bf16_f32 v192, v247, v248
 v_accvgpr_read_b32 v247, a2
 v_accvgpr_read_b32 v248, a3
 v_cvt_pk_bf16_f32 v193, v247, v248
 v_accvgpr_read_b32 v247, a4
 v_accvgpr_read_b32 v248, a5
 v_cvt_pk_bf16_f32 v194, v247, v248
 v_accvgpr_read_b32 v247, a6
 v_accvgpr_read_b32 v248, a7
 v_cvt_pk_bf16_f32 v195, v247, v248
 buffer_store_dwordx4 v[192:195], v246, s[4:7], s55 offen sc1
 s_add_u32 s55, s55, 16384
 v_accvgpr_read_b32 v247, a8
 v_accvgpr_read_b32 v248, a9
 v_cvt_pk_bf16_f32 v196, v247, v248
 v_accvgpr_read_b32 v247, a10
 v_accvgpr_read_b32 v248, a11
 v_cvt_pk_bf16_f32 v197, v247, v248
 v_accvgpr_read_b32 v247, a12
 v_accvgpr_read_b32 v248, a13
 v_cvt_pk_bf16_f32 v198, v247, v248
 v_accvgpr_read_b32 v247, a14
 v_accvgpr_read_b32 v248, a15
 v_cvt_pk_bf16_f32 v199, v247, v248
 buffer_store_dwordx4 v[196:199], v246, s[4:7], s55 offen sc1
 s_add_u32 s55, s55, 16384
 v_accvgpr_read_b32 v247, a16
 v_accvgpr_read_b32 v248, a17
 v_cvt_pk_bf16_f32 v200, v247, v248
 v_accvgpr_read_b32 v247, a18
 v_accvgpr_read_b32 v248, a19
 v_cvt_pk_bf16_f32 v201, v247, v248
 v_accvgpr_read_b32 v247, a20
 v_accvgpr_read_b32 v248, a21
 v_cvt_pk_bf16_f32 v202, v247, v248
 v_accvgpr_read_b32 v247, a22
 v_accvgpr_read_b32 v248, a23
 v_cvt_pk_bf16_f32 v203, v247, v248
 buffer_store_dwordx4 v[200:203], v246, s[4:7], s55 offen sc1
 s_add_u32 s55, s55, 16384
 v_accvgpr_read_b32 v247, a24
 v_accvgpr_read_b32 v248, a25
 v_cvt_pk_bf16_f32 v204, v247, v248
 v_accvgpr_read_b32 v247, a26
 v_accvgpr_read_b32 v248, a27
 v_cvt_pk_bf16_f32 v205, v247, v248
 v_accvgpr_read_b32 v247, a28
 v_accvgpr_read_b32 v248, a29
 v_cvt_pk_bf16_f32 v206, v247, v248
 v_accvgpr_read_b32 v247, a30
 v_accvgpr_read_b32 v248, a31
 v_cvt_pk_bf16_f32 v207, v247, v248
 buffer_store_dwordx4 v[204:207], v246, s[4:7], s55 offen sc1
 s_add_u32 s55, s55, 16384
 v_accvgpr_read_b32 v247, a32
 v_accvgpr_read_b32 v248, a33
 v_cvt_pk_bf16_f32 v192, v247, v248
 v_accvgpr_read_b32 v247, a34
 v_accvgpr_read_b32 v248, a35
 v_cvt_pk_bf16_f32 v193, v247, v248
 v_accvgpr_read_b32 v247, a36
 v_accvgpr_read_b32 v248, a37
 v_cvt_pk_bf16_f32 v194, v247, v248
 v_accvgpr_read_b32 v247, a38
 v_accvgpr_read_b32 v248, a39
 v_cvt_pk_bf16_f32 v195, v247, v248
 buffer_store_dwordx4 v[192:195], v246, s[4:7], s55 offen sc1
 s_add_u32 s55, s55, 16384
 v_accvgpr_read_b32 v247, a40
 v_accvgpr_read_b32 v248, a41
 v_cvt_pk_bf16_f32 v196, v247, v248
 v_accvgpr_read_b32 v247, a42
 v_accvgpr_read_b32 v248, a43
 v_cvt_pk_bf16_f32 v197, v247, v248
 v_accvgpr_read_b32 v247, a44
 v_accvgpr_read_b32 v248, a45
 v_cvt_pk_bf16_f32 v198, v247, v248
 v_accvgpr_read_b32 v247, a46
 v_accvgpr_read_b32 v248, a47
 v_cvt_pk_bf16_f32 v199, v247, v248
 buffer_store_dwordx4 v[196:199], v246, s[4:7], s55 offen sc1
 s_add_u32 s55, s55, 16384
 v_accvgpr_read_b32 v247, a48
 v_accvgpr_read_b32 v248, a49
 v_cvt_pk_bf16_f32 v200, v247, v248
 v_accvgpr_read_b32 v247, a50
 v_accvgpr_read_b32 v248, a51
 v_cvt_pk_bf16_f32 v201, v247, v248
 v_accvgpr_read_b32 v247, a52
 v_accvgpr_read_b32 v248, a53
 v_cvt_pk_bf16_f32 v202, v247, v248
 v_accvgpr_read_b32 v247, a54
 v_accvgpr_read_b32 v248, a55
 v_cvt_pk_bf16_f32 v203, v247, v248
 buffer_store_dwordx4 v[200:203], v246, s[4:7], s55 offen sc1
 s_add_u32 s55, s55, 16384
 v_accvgpr_read_b32 v247, a56
 v_accvgpr_read_b32 v248, a57
 v_cvt_pk_bf16_f32 v204, v247, v248
 v_accvgpr_read_b32 v247, a58
 v_accvgpr_read_b32 v248, a59
 v_cvt_pk_bf16_f32 v205, v247, v248
 v_accvgpr_read_b32 v247, a60
 v_accvgpr_read_b32 v248, a61
 v_cvt_pk_bf16_f32 v206, v247, v248
 v_accvgpr_read_b32 v247, a62
 v_accvgpr_read_b32 v248, a63
 v_cvt_pk_bf16_f32 v207, v247, v248
 buffer_store_dwordx4 v[204:207], v246, s[4:7], s55 offen sc1
 s_add_u32 s55, s55, 16384
 v_accvgpr_read_b32 v247, a64
 v_accvgpr_read_b32 v248, a65
 v_cvt_pk_bf16_f32 v192, v247, v248
 v_accvgpr_read_b32 v247, a66
 v_accvgpr_read_b32 v248, a67
 v_cvt_pk_bf16_f32 v193, v247, v248
 v_accvgpr_read_b32 v247, a68
 v_accvgpr_read_b32 v248, a69
 v_cvt_pk_bf16_f32 v194, v247, v248
 v_accvgpr_read_b32 v247, a70
 v_accvgpr_read_b32 v248, a71
 v_cvt_pk_bf16_f32 v195, v247, v248
 buffer_store_dwordx4 v[192:195], v246, s[4:7], s55 offen sc1
 s_add_u32 s55, s55, 16384
 v_accvgpr_read_b32 v247, a72
 v_accvgpr_read_b32 v248, a73
 v_cvt_pk_bf16_f32 v196, v247, v248
 v_accvgpr_read_b32 v247, a74
 v_accvgpr_read_b32 v248, a75
 v_cvt_pk_bf16_f32 v197, v247, v248
 v_accvgpr_read_b32 v247, a76
 v_accvgpr_read_b32 v248, a77
 v_cvt_pk_bf16_f32 v198, v247, v248
 v_accvgpr_read_b32 v247, a78
 v_accvgpr_read_b32 v248, a79
 v_cvt_pk_bf16_f32 v199, v247, v248
 buffer_store_dwordx4 v[196:199], v246, s[4:7], s55 offen sc1
 s_add_u32 s55, s55, 16384
 v_accvgpr_read_b32 v247, a80
 v_accvgpr_read_b32 v248, a81
 v_cvt_pk_bf16_f32 v200, v247, v248
 v_accvgpr_read_b32 v247, a82
 v_accvgpr_read_b32 v248, a83
 v_cvt_pk_bf16_f32 v201, v247, v248
 v_accvgpr_read_b32 v247, a84
 v_accvgpr_read_b32 v248, a85
 v_cvt_pk_bf16_f32 v202, v247, v248
 v_accvgpr_read_b32 v247, a86
 v_accvgpr_read_b32 v248, a87
 v_cvt_pk_bf16_f32 v203, v247, v248
 buffer_store_dwordx4 v[200:203], v246, s[4:7], s55 offen sc1
 s_add_u32 s55, s55, 16384
 v_accvgpr_read_b32 v247, a88
 v_accvgpr_read_b32 v248, a89
 v_cvt_pk_bf16_f32 v204, v247, v248
 v_accvgpr_read_b32 v247, a90
 v_accvgpr_read_b32 v248, a91
 v_cvt_pk_bf16_f32 v205, v247, v248
 v_accvgpr_read_b32 v247, a92
 v_accvgpr_read_b32 v248, a93
 v_cvt_pk_bf16_f32 v206, v247, v248
 v_accvgpr_read_b32 v247, a94
 v_accvgpr_read_b32 v248, a95
 v_cvt_pk_bf16_f32 v207, v247, v248
 buffer_store_dwordx4 v[204:207], v246, s[4:7], s55 offen sc1
 s_add_u32 s55, s55, 16384
 v_accvgpr_read_b32 v247, a96
 v_accvgpr_read_b32 v248, a97
 v_cvt_pk_bf16_f32 v192, v247, v248
 v_accvgpr_read_b32 v247, a98
 v_accvgpr_read_b32 v248, a99
 v_cvt_pk_bf16_f32 v193, v247, v248
 v_accvgpr_read_b32 v247, a100
 v_accvgpr_read_b32 v248, a101
 v_cvt_pk_bf16_f32 v194, v247, v248
 v_accvgpr_read_b32 v247, a102
 v_accvgpr_read_b32 v248, a103
 v_cvt_pk_bf16_f32 v195, v247, v248
 buffer_store_dwordx4 v[192:195], v246, s[4:7], s55 offen sc1
 s_add_u32 s55, s55, 16384
 v_accvgpr_read_b32 v247, a104
 v_accvgpr_read_b32 v248, a105
 v_cvt_pk_bf16_f32 v196, v247, v248
 v_accvgpr_read_b32 v247, a106
 v_accvgpr_read_b32 v248, a107
 v_cvt_pk_bf16_f32 v197, v247, v248
 v_accvgpr_read_b32 v247, a108
 v_accvgpr_read_b32 v248, a109
 v_cvt_pk_bf16_f32 v198, v247, v248
 v_accvgpr_read_b32 v247, a110
 v_accvgpr_read_b32 v248, a111
 v_cvt_pk_bf16_f32 v199, v247, v248
 buffer_store_dwordx4 v[196:199], v246, s[4:7], s55 offen sc1
 s_add_u32 s55, s55, 16384
 v_accvgpr_read_b32 v247, a112
 v_accvgpr_read_b32 v248, a113
 v_cvt_pk_bf16_f32 v200, v247, v248
 v_accvgpr_read_b32 v247, a114
 v_accvgpr_read_b32 v248, a115
 v_cvt_pk_bf16_f32 v201, v247, v248
 v_accvgpr_read_b32 v247, a116
 v_accvgpr_read_b32 v248, a117
 v_cvt_pk_bf16_f32 v202, v247, v248
 v_accvgpr_read_b32 v247, a118
 v_accvgpr_read_b32 v248, a119
 v_cvt_pk_bf16_f32 v203, v247, v248
 buffer_store_dwordx4 v[200:203], v246, s[4:7], s55 offen sc1
 s_add_u32 s55, s55, 16384
 v_accvgpr_read_b32 v247, a120
 v_accvgpr_read_b32 v248, a121
 v_cvt_pk_bf16_f32 v204, v247, v248
 v_accvgpr_read_b32 v247, a122
 v_accvgpr_read_b32 v248, a123
 v_cvt_pk_bf16_f32 v205, v247, v248
 v_accvgpr_read_b32 v247, a124
 v_accvgpr_read_b32 v248, a125
 v_cvt_pk_bf16_f32 v206, v247, v248
 v_accvgpr_read_b32 v247, a126
 v_accvgpr_read_b32 v248, a127
 v_cvt_pk_bf16_f32 v207, v247, v248
 buffer_store_dwordx4 v[204:207], v246, s[4:7], s55 offen sc1
 s_add_u32 s55, s55, 16384
 v_accvgpr_read_b32 v247, a128
 v_accvgpr_read_b32 v248, a129
 v_cvt_pk_bf16_f32 v192, v247, v248
 v_accvgpr_read_b32 v247, a130
 v_accvgpr_read_b32 v248, a131
 v_cvt_pk_bf16_f32 v193, v247, v248
 v_accvgpr_read_b32 v247, a132
 v_accvgpr_read_b32 v248, a133
 v_cvt_pk_bf16_f32 v194, v247, v248
 v_accvgpr_read_b32 v247, a134
 v_accvgpr_read_b32 v248, a135
 v_cvt_pk_bf16_f32 v195, v247, v248
 buffer_store_dwordx4 v[192:195], v246, s[4:7], s55 offen sc1
 s_add_u32 s55, s55, 16384
 v_accvgpr_read_b32 v247, a136
 v_accvgpr_read_b32 v248, a137
 v_cvt_pk_bf16_f32 v196, v247, v248
 v_accvgpr_read_b32 v247, a138
 v_accvgpr_read_b32 v248, a139
 v_cvt_pk_bf16_f32 v197, v247, v248
 v_accvgpr_read_b32 v247, a140
 v_accvgpr_read_b32 v248, a141
 v_cvt_pk_bf16_f32 v198, v247, v248
 v_accvgpr_read_b32 v247, a142
 v_accvgpr_read_b32 v248, a143
 v_cvt_pk_bf16_f32 v199, v247, v248
 buffer_store_dwordx4 v[196:199], v246, s[4:7], s55 offen sc1
 s_add_u32 s55, s55, 16384
 v_accvgpr_read_b32 v247, a144
 v_accvgpr_read_b32 v248, a145
 v_cvt_pk_bf16_f32 v200, v247, v248
 v_accvgpr_read_b32 v247, a146
 v_accvgpr_read_b32 v248, a147
 v_cvt_pk_bf16_f32 v201, v247, v248
 v_accvgpr_read_b32 v247, a148
 v_accvgpr_read_b32 v248, a149
 v_cvt_pk_bf16_f32 v202, v247, v248
 v_accvgpr_read_b32 v247, a150
 v_accvgpr_read_b32 v248, a151
 v_cvt_pk_bf16_f32 v203, v247, v248
 buffer_store_dwordx4 v[200:203], v246, s[4:7], s55 offen sc1
 s_add_u32 s55, s55, 16384
 v_accvgpr_read_b32 v247, a152
 v_accvgpr_read_b32 v248, a153
 v_cvt_pk_bf16_f32 v204, v247, v248
 v_accvgpr_read_b32 v247, a154
 v_accvgpr_read_b32 v248, a155
 v_cvt_pk_bf16_f32 v205, v247, v248
 v_accvgpr_read_b32 v247, a156
 v_accvgpr_read_b32 v248, a157
 v_cvt_pk_bf16_f32 v206, v247, v248
 v_accvgpr_read_b32 v247, a158
 v_accvgpr_read_b32 v248, a159
 v_cvt_pk_bf16_f32 v207, v247, v248
 buffer_store_dwordx4 v[204:207], v246, s[4:7], s55 offen sc1
 s_add_u32 s55, s55, 16384
 v_accvgpr_read_b32 v247, a160
 v_accvgpr_read_b32 v248, a161
 v_cvt_pk_bf16_f32 v192, v247, v248
 v_accvgpr_read_b32 v247, a162
 v_accvgpr_read_b32 v248, a163
 v_cvt_pk_bf16_f32 v193, v247, v248
 v_accvgpr_read_b32 v247, a164
 v_accvgpr_read_b32 v248, a165
 v_cvt_pk_bf16_f32 v194, v247, v248
 v_accvgpr_read_b32 v247, a166
 v_accvgpr_read_b32 v248, a167
 v_cvt_pk_bf16_f32 v195, v247, v248
 buffer_store_dwordx4 v[192:195], v246, s[4:7], s55 offen sc1
 s_add_u32 s55, s55, 16384
 v_accvgpr_read_b32 v247, a168
 v_accvgpr_read_b32 v248, a169
 v_cvt_pk_bf16_f32 v196, v247, v248
 v_accvgpr_read_b32 v247, a170
 v_accvgpr_read_b32 v248, a171
 v_cvt_pk_bf16_f32 v197, v247, v248
 v_accvgpr_read_b32 v247, a172
 v_accvgpr_read_b32 v248, a173
 v_cvt_pk_bf16_f32 v198, v247, v248
 v_accvgpr_read_b32 v247, a174
 v_accvgpr_read_b32 v248, a175
 v_cvt_pk_bf16_f32 v199, v247, v248
 buffer_store_dwordx4 v[196:199], v246, s[4:7], s55 offen sc1
 s_add_u32 s55, s55, 16384
 v_accvgpr_read_b32 v247, a176
 v_accvgpr_read_b32 v248, a177
 v_cvt_pk_bf16_f32 v200, v247, v248
 v_accvgpr_read_b32 v247, a178
 v_accvgpr_read_b32 v248, a179
 v_cvt_pk_bf16_f32 v201, v247, v248
 v_accvgpr_read_b32 v247, a180
 v_accvgpr_read_b32 v248, a181
 v_cvt_pk_bf16_f32 v202, v247, v248
 v_accvgpr_read_b32 v247, a182
 v_accvgpr_read_b32 v248, a183
 v_cvt_pk_bf16_f32 v203, v247, v248
 buffer_store_dwordx4 v[200:203], v246, s[4:7], s55 offen sc1
 s_add_u32 s55, s55, 16384
 v_accvgpr_read_b32 v247, a184
 v_accvgpr_read_b32 v248, a185
 v_cvt_pk_bf16_f32 v204, v247, v248
 v_accvgpr_read_b32 v247, a186
 v_accvgpr_read_b32 v248, a187
 v_cvt_pk_bf16_f32 v205, v247, v248
 v_accvgpr_read_b32 v247, a188
 v_accvgpr_read_b32 v248, a189
 v_cvt_pk_bf16_f32 v206, v247, v248
 v_accvgpr_read_b32 v247, a190
 v_accvgpr_read_b32 v248, a191
 v_cvt_pk_bf16_f32 v207, v247, v248
 buffer_store_dwordx4 v[204:207], v246, s[4:7], s55 offen sc1
 s_add_u32 s55, s55, 16384
 v_accvgpr_read_b32 v247, a192
 v_accvgpr_read_b32 v248, a193
 v_cvt_pk_bf16_f32 v192, v247, v248
 v_accvgpr_read_b32 v247, a194
 v_accvgpr_read_b32 v248, a195
 v_cvt_pk_bf16_f32 v193, v247, v248
 v_accvgpr_read_b32 v247, a196
 v_accvgpr_read_b32 v248, a197
 v_cvt_pk_bf16_f32 v194, v247, v248
 v_accvgpr_read_b32 v247, a198
 v_accvgpr_read_b32 v248, a199
 v_cvt_pk_bf16_f32 v195, v247, v248
 buffer_store_dwordx4 v[192:195], v246, s[4:7], s55 offen sc1
 s_add_u32 s55, s55, 16384
 v_accvgpr_read_b32 v247, a200
 v_accvgpr_read_b32 v248, a201
 v_cvt_pk_bf16_f32 v196, v247, v248
 v_accvgpr_read_b32 v247, a202
 v_accvgpr_read_b32 v248, a203
 v_cvt_pk_bf16_f32 v197, v247, v248
 v_accvgpr_read_b32 v247, a204
 v_accvgpr_read_b32 v248, a205
 v_cvt_pk_bf16_f32 v198, v247, v248
 v_accvgpr_read_b32 v247, a206
 v_accvgpr_read_b32 v248, a207
 v_cvt_pk_bf16_f32 v199, v247, v248
 buffer_store_dwordx4 v[196:199], v246, s[4:7], s55 offen sc1
 s_add_u32 s55, s55, 16384
 v_accvgpr_read_b32 v247, a208
 v_accvgpr_read_b32 v248, a209
 v_cvt_pk_bf16_f32 v200, v247, v248
 v_accvgpr_read_b32 v247, a210
 v_accvgpr_read_b32 v248, a211
 v_cvt_pk_bf16_f32 v201, v247, v248
 v_accvgpr_read_b32 v247, a212
 v_accvgpr_read_b32 v248, a213
 v_cvt_pk_bf16_f32 v202, v247, v248
 v_accvgpr_read_b32 v247, a214
 v_accvgpr_read_b32 v248, a215
 v_cvt_pk_bf16_f32 v203, v247, v248
 buffer_store_dwordx4 v[200:203], v246, s[4:7], s55 offen sc1
 s_add_u32 s55, s55, 16384
 v_accvgpr_read_b32 v247, a216
 v_accvgpr_read_b32 v248, a217
 v_cvt_pk_bf16_f32 v204, v247, v248
 v_accvgpr_read_b32 v247, a218
 v_accvgpr_read_b32 v248, a219
 v_cvt_pk_bf16_f32 v205, v247, v248
 v_accvgpr_read_b32 v247, a220
 v_accvgpr_read_b32 v248, a221
 v_cvt_pk_bf16_f32 v206, v247, v248
 v_accvgpr_read_b32 v247, a222
 v_accvgpr_read_b32 v248, a223
 v_cvt_pk_bf16_f32 v207, v247, v248
 buffer_store_dwordx4 v[204:207], v246, s[4:7], s55 offen sc1
 s_add_u32 s55, s55, 16384
 v_accvgpr_read_b32 v247, a224
 v_accvgpr_read_b32 v248, a225
 v_cvt_pk_bf16_f32 v192, v247, v248
 v_accvgpr_read_b32 v247, a226
 v_accvgpr_read_b32 v248, a227
 v_cvt_pk_bf16_f32 v193, v247, v248
 v_accvgpr_read_b32 v247, a228
 v_accvgpr_read_b32 v248, a229
 v_cvt_pk_bf16_f32 v194, v247, v248
 v_accvgpr_read_b32 v247, a230
 v_accvgpr_read_b32 v248, a231
 v_cvt_pk_bf16_f32 v195, v247, v248
 buffer_store_dwordx4 v[192:195], v246, s[4:7], s55 offen sc1
 s_add_u32 s55, s55, 16384
 v_accvgpr_read_b32 v247, a232
 v_accvgpr_read_b32 v248, a233
 v_cvt_pk_bf16_f32 v196, v247, v248
 v_accvgpr_read_b32 v247, a234
 v_accvgpr_read_b32 v248, a235
 v_cvt_pk_bf16_f32 v197, v247, v248
 v_accvgpr_read_b32 v247, a236
 v_accvgpr_read_b32 v248, a237
 v_cvt_pk_bf16_f32 v198, v247, v248
 v_accvgpr_read_b32 v247, a238
 v_accvgpr_read_b32 v248, a239
 v_cvt_pk_bf16_f32 v199, v247, v248
 buffer_store_dwordx4 v[196:199], v246, s[4:7], s55 offen sc1
 s_add_u32 s55, s55, 16384
 v_accvgpr_read_b32 v247, a240
 v_accvgpr_read_b32 v248, a241
 v_cvt_pk_bf16_f32 v200, v247, v248
 v_accvgpr_read_b32 v247, a242
 v_accvgpr_read_b32 v248, a243
 v_cvt_pk_bf16_f32 v201, v247, v248
 v_accvgpr_read_b32 v247, a244
 v_accvgpr_read_b32 v248, a245
 v_cvt_pk_bf16_f32 v202, v247, v248
 v_accvgpr_read_b32 v247, a246
 v_accvgpr_read_b32 v248, a247
 v_cvt_pk_bf16_f32 v203, v247, v248
 buffer_store_dwordx4 v[200:203], v246, s[4:7], s55 offen sc1
 s_add_u32 s55, s55, 16384
 v_accvgpr_read_b32 v247, a248
 v_accvgpr_read_b32 v248, a249
 v_cvt_pk_bf16_f32 v204, v247, v248
 v_accvgpr_read_b32 v247, a250
 v_accvgpr_read_b32 v248, a251
 v_cvt_pk_bf16_f32 v205, v247, v248
 v_accvgpr_read_b32 v247, a252
 v_accvgpr_read_b32 v248, a253
 v_cvt_pk_bf16_f32 v206, v247, v248
 v_accvgpr_read_b32 v247, a254
 v_accvgpr_read_b32 v248, a255
 v_cvt_pk_bf16_f32 v207, v247, v248
 buffer_store_dwordx4 v[204:207], v246, s[4:7], s55 offen sc1
 s_add_u32 s55, s55, 16384
 v_cvt_pk_bf16_f32 v192, v208, v209
 v_cvt_pk_bf16_f32 v193, v210, v211
 v_cvt_pk_bf16_f32 v194, v212, v213
 v_cvt_pk_bf16_f32 v195, v214, v215
 buffer_store_dwordx4 v[192:195], v246, s[4:7], s55 offen sc1
 s_add_u32 s55, s55, 16384
 v_cvt_pk_bf16_f32 v196, v216, v217
 v_cvt_pk_bf16_f32 v197, v218, v219
 v_cvt_pk_bf16_f32 v198, v220, v221
 v_cvt_pk_bf16_f32 v199, v222, v223
 buffer_store_dwordx4 v[196:199], v246, s[4:7], s55 offen sc1
 s_add_u32 s55, s55, 16384
 v_cvt_pk_bf16_f32 v200, v224, v225
 v_cvt_pk_bf16_f32 v201, v226, v227
 v_cvt_pk_bf16_f32 v202, v228, v229
 v_cvt_pk_bf16_f32 v203, v230, v231
 buffer_store_dwordx4 v[200:203], v246, s[4:7], s55 offen sc1
 s_add_u32 s55, s55, 16384
 v_cvt_pk_bf16_f32 v204, v232, v233
 v_cvt_pk_bf16_f32 v205, v234, v235
 v_cvt_pk_bf16_f32 v206, v236, v237
 v_cvt_pk_bf16_f32 v207, v238, v239
 buffer_store_dwordx4 v[204:207], v246, s[4:7], s55 offen sc1
 s_add_u32 s55, s55, 16384
 s_mov_b32 s52, 0
 s_cmp_eq_u32 s89, 1
 s_cbranch_scc1 L_goproj_285
L_fin_286:
 s_waitcnt vmcnt(0)
 s_barrier
 s_lshl_b32 s72, s50, 7
 s_add_u32 s72, s72, 65025024
 s_cmp_lg_u32 s46, 0
 s_cbranch_scc1 L_sig_304
 v_mov_b32 v247, 1
 v_mov_b32 v248, 0
 s_mov_b64 exec, 1
 buffer_atomic_add v247, v248, s[4:7], s72 offen
 s_mov_b64 exec, -1
L_sig_304:
L_engine:
 v_mov_b32 v240, v246
 s_and_b32 s50, s48, 31
 s_lshr_b32 s51, s48, 5
 s_mul_i32 s55, s51, 2359296
 s_lshl_b32 s3, s50, 10
 s_add_u32 s55, s55, s3
 s_add_u32 s55, s55, 117440512
 v_mov_b32 v0, 1
 v_mov_b32 v1, 1
 v_mov_b32 v2, 1
 v_mov_b32 v3, 1
 s_mul_i32 s72, s46, 589824
 s_add_u32 s72, s72, s55
 buffer_store_dwordx4 v[0:3], v240, s[4:7], s72 offen
 s_add_u32 s72, s72, 32768
 buffer_store_dwordx4 v[0:3], v240, s[4:7], s72 offen
 s_add_u32 s72, s72, 32768
 buffer_store_dwordx4 v[0:3], v240, s[4:7], s72 offen
 s_add_u32 s72, s72, 32768
 buffer_store_dwordx4 v[0:3], v240, s[4:7], s72 offen
 s_add_u32 s72, s72, 32768
 buffer_store_dwordx4 v[0:3], v240, s[4:7], s72 offen
 s_add_u32 s72, s72, 32768
 buffer_store_dwordx4 v[0:3], v240, s[4:7], s72 offen
 s_add_u32 s72, s72, 32768
 buffer_store_dwordx4 v[0:3], v240, s[4:7], s72 offen
 s_add_u32 s72, s72, 32768
 buffer_store_dwordx4 v[0:3], v240, s[4:7], s72 offen
 s_add_u32 s72, s72, 32768
 buffer_store_dwordx4 v[0:3], v240, s[4:7], s72 offen
 s_add_u32 s72, s72, 32768
 buffer_store_dwordx4 v[0:3], v240, s[4:7], s72 offen
 s_add_u32 s72, s72, 32768
 buffer_store_dwordx4 v[0:3], v240, s[4:7], s72 offen
 s_add_u32 s72, s72, 32768
 buffer_store_dwordx4 v[0:3], v240, s[4:7], s72 offen
 s_add_u32 s72, s72, 32768
 buffer_store_dwordx4 v[0:3], v240, s[4:7], s72 offen
 s_add_u32 s72, s72, 32768
 buffer_store_dwordx4 v[0:3], v240, s[4:7], s72 offen
 s_add_u32 s72, s72, 32768
 buffer_store_dwordx4 v[0:3], v240, s[4:7], s72 offen
 s_add_u32 s72, s72, 32768
 buffer_store_dwordx4 v[0:3], v240, s[4:7], s72 offen
 s_add_u32 s72, s72, 32768
 buffer_store_dwordx4 v[0:3], v240, s[4:7], s72 offen
 s_add_u32 s72, s72, 32768
 buffer_store_dwordx4 v[0:3], v240, s[4:7], s72 offen
 s_add_u32 s72, s72, 32768
 s_cmp_lg_u32 s51, 0
 s_cbranch_scc1 L_notlast_305
 v_mov_b32 v4, 0
 v_mov_b32 v5, 0
 v_mov_b32 v6, 0
 v_mov_b32 v7, 0
 s_lshl_b32 s72, s50, 2
 s_add_u32 s72, s72, s46
 s_lshl_b32 s72, s72, 10
 s_add_u32 s72, s72, 58720256
 buffer_store_dwordx4 v[4:7], v240, s[4:7], s72 offen sc1
L_notlast_305:
 v_lshrrev_b32 v249, 4, v240
 v_bfe_u32 v246, v249, 3, 2
 v_bfe_u32 v248, v249, 5, 1
 v_lshl_add_u32 v246, v248, 3, v246
 v_mul_u32_u24 v246, 1152, v246
 v_bfe_u32 v247, v249, 4, 1
 v_lshlrev_b32 v247, 2, v247
 v_xor_b32 v247, v247, v249
 v_and_b32 v247, 7, v247
 v_lshl_add_u32 v246, v247, 4, v246
 s_mul_i32 s65, s50, 147456
 s_lshr_b32 s3, s46, 1
 s_mul_i32 s3, s3, 18432
 s_add_u32 s65, s65, s3
 s_and_b32 s3, s46, 1
 s_mul_i32 s3, s3, 4608
 s_add_u32 s65, s65, s3
 s_lshl_b32 s73, s46, 10
 s_add_u32 m0, s73, 0
 s_add_u32 s72, s65, 0
 buffer_load_dwordx4 v246, s[20:23], s72 offen lds
 s_add_u32 m0, s73, 4096
 s_add_u32 s72, s65, 36864
 buffer_load_dwordx4 v246, s[20:23], s72 offen lds
 s_add_u32 m0, s73, 8192
 s_add_u32 s72, s65, 73728
 buffer_load_dwordx4 v246, s[20:23], s72 offen lds
 s_add_u32 m0, s73, 12288
 s_add_u32 s72, s65, 110592
 buffer_load_dwordx4 v246, s[20:23], s72 offen lds
 s_add_u32 m0, s73, 16384
 s_add_u32 s72, s65, 128
 buffer_load_dwordx4 v246, s[20:23], s72 offen lds
 s_add_u32 m0, s73, 20480
 s_add_u32 s72, s65, 36992
 buffer_load_dwordx4 v246, s[20:23], s72 offen lds
 s_add_u32 m0, s73, 24576
 s_add_u32 s72, s65, 73856
 buffer_load_dwordx4 v246, s[20:23], s72 offen lds
 s_add_u32 m0, s73, 28672
 s_add_u32 s72, s65, 110720
 buffer_load_dwordx4 v246, s[20:23], s72 offen lds
 s_add_u32 m0, s73, 32768
 s_add_u32 s72, s65, 256
 buffer_load_dwordx4 v246, s[20:23], s72 offen lds
 s_add_u32 m0, s73, 36864
 s_add_u32 s72, s65, 37120
 buffer_load_dwordx4 v246, s[20:23], s72 offen lds
 s_add_u32 m0, s73, 40960
 s_add_u32 s72, s65, 73984
 buffer_load_dwordx4 v246, s[20:23], s72 offen lds
 s_add_u32 m0, s73, 45056
 s_add_u32 s72, s65, 110848
 buffer_load_dwordx4 v246, s[20:23], s72 offen lds
 s_add_u32 m0, s73, 49152
 s_add_u32 s72, s65, 384
 buffer_load_dwordx4 v246, s[20:23], s72 offen lds
 s_add_u32 m0, s73, 53248
 s_add_u32 s72, s65, 37248
 buffer_load_dwordx4 v246, s[20:23], s72 offen lds
 s_add_u32 m0, s73, 57344
 s_add_u32 s72, s65, 74112
 buffer_load_dwordx4 v246, s[20:23], s72 offen lds
 s_add_u32 m0, s73, 61440
 s_add_u32 s72, s65, 110976
 buffer_load_dwordx4 v246, s[20:23], s72 offen lds
 s_add_u32 m0, s73, 65536
 s_add_u32 s72, s65, 512
 buffer_load_dwordx4 v246, s[20:23], s72 offen lds
 s_add_u32 m0, s73, 69632
 s_add_u32 s72, s65, 37376
 buffer_load_dwordx4 v246, s[20:23], s72 offen lds
 s_add_u32 m0, s73, 73728
 s_add_u32 s72, s65, 74240
 buffer_load_dwordx4 v246, s[20:23], s72 offen lds
 s_add_u32 m0, s73, 77824
 s_add_u32 s72, s65, 111104
 buffer_load_dwordx4 v246, s[20:23], s72 offen lds
 s_add_u32 m0, s73, 81920
 s_add_u32 s72, s65, 640
 buffer_load_dwordx4 v246, s[20:23], s72 offen lds
 s_add_u32 m0, s73, 86016
 s_add_u32 s72, s65, 37504
 buffer_load_dwordx4 v246, s[20:23], s72 offen lds
 s_add_u32 m0, s73, 90112
 s_add_u32 s72, s65, 74368
 buffer_load_dwordx4 v246, s[20:23], s72 offen lds
 s_add_u32 m0, s73, 94208
 s_add_u32 s72, s65, 111232
 buffer_load_dwordx4 v246, s[20:23], s72 offen lds
 s_add_u32 m0, s73, 98304
 s_add_u32 s72, s65, 768
 buffer_load_dwordx4 v246, s[20:23], s72 offen lds
 s_add_u32 m0, s73, 102400
 s_add_u32 s72, s65, 37632
 buffer_load_dwordx4 v246, s[20:23], s72 offen lds
 s_add_u32 m0, s73, 106496
 s_add_u32 s72, s65, 74496
 buffer_load_dwordx4 v246, s[20:23], s72 offen lds
 s_add_u32 m0, s73, 110592
 s_add_u32 s72, s65, 111360
 buffer_load_dwordx4 v246, s[20:23], s72 offen lds
 s_add_u32 m0, s73, 114688
 s_add_u32 s72, s65, 896
 buffer_load_dwordx4 v246, s[20:23], s72 offen lds
 s_add_u32 m0, s73, 118784
 s_add_u32 s72, s65, 37760
 buffer_load_dwordx4 v246, s[20:23], s72 offen lds
 s_add_u32 m0, s73, 122880
 s_add_u32 s72, s65, 74624
 buffer_load_dwordx4 v246, s[20:23], s72 offen lds
 s_add_u32 m0, s73, 126976
 s_add_u32 s72, s65, 111488
 buffer_load_dwordx4 v246, s[20:23], s72 offen lds
 s_add_u32 m0, s73, 131072
 s_add_u32 s72, s65, 1024
 buffer_load_dwordx4 v246, s[20:23], s72 offen lds
 s_add_u32 m0, s73, 135168
 s_add_u32 s72, s65, 37888
 buffer_load_dwordx4 v246, s[20:23], s72 offen lds
 s_add_u32 m0, s73, 139264
 s_add_u32 s72, s65, 74752
 buffer_load_dwordx4 v246, s[20:23], s72 offen lds
 s_add_u32 m0, s73, 143360
 s_add_u32 s72, s65, 111616
 buffer_load_dwordx4 v246, s[20:23], s72 offen lds
 v_bfe_u32 v246, v249, 2, 2
 v_bfe_u32 v247, v249, 5, 1
 v_lshl_add_u32 v246, v247, 3, v246
 v_lshlrev_b32 v243, 7, v246
 v_bfe_u32 v247, v249, 3, 1
 v_lshl_add_u32 v243, v247, 6, v243
 v_bfe_u32 v247, v249, 4, 1
 v_lshl_add_u32 v243, v247, 5, v243
 v_and_b32 v247, 3, v249
 v_lshl_add_u32 v243, v247, 3, v243
 s_mul_i32 s63, s46, 5
 s_cmp_eq_u32 s46, 3
 s_cselect_b32 s63, 14, s63
 s_waitcnt vmcnt(0)
 s_cmp_eq_u32 s49, 1
 s_cbranch_scc1 L_rel_306
 s_waitcnt vmcnt(0)
 buffer_wbl2 sc1
 s_waitcnt vmcnt(0)
L_rel_306:
 s_barrier
 s_lshl_b32 s72, s51, 7
 s_add_u32 s72, s72, 65024000
 s_cmp_lg_u32 s46, 0
 s_cbranch_scc1 L_gs_307
 v_mov_b32 v246, 1
 v_mov_b32 v247, 0
 s_mov_b64 exec, 1
 buffer_atomic_add v246, v247, s[4:7], s72 offen
 s_cmp_eq_u32 s51, 0
 s_cselect_b32 s3, 12, 0
 v_mov_b32 v246, s3
 s_mov_b32 s3, 65017856
 buffer_atomic_add v246, v247, s[4:7], s3 offen
 s_mov_b64 exec, -1
L_gs_307:
 s_add_u32 s3, s63, 0
 s_min_u32 s3, s3, 17
 s_lshr_b32 s73, s3, 1
 s_lshl_b32 s73, s73, 14
 s_and_b32 s3, s3, 1
 s_lshl_b32 s3, s3, 6
 v_xor_b32 v246, s3, v243
 v_add_u32 v246, s73, v246
 ds_read_b64_tr_b16 a[0:1], v246 offset:0
 ds_read_b64_tr_b16 a[2:3], v246 offset:512
 ds_read_b64_tr_b16 a[4:5], v246 offset:2048
 ds_read_b64_tr_b16 a[6:7], v246 offset:2560
 ds_read_b64_tr_b16 a[8:9], v246 offset:4096
 ds_read_b64_tr_b16 a[10:11], v246 offset:4608
 ds_read_b64_tr_b16 a[12:13], v246 offset:6144
 ds_read_b64_tr_b16 a[14:15], v246 offset:6656
 ds_read_b64_tr_b16 a[16:17], v246 offset:8192
 ds_read_b64_tr_b16 a[18:19], v246 offset:8704
 ds_read_b64_tr_b16 a[20:21], v246 offset:10240
 ds_read_b64_tr_b16 a[22:23], v246 offset:10752
 ds_read_b64_tr_b16 a[24:25], v246 offset:12288
 ds_read_b64_tr_b16 a[26:27], v246 offset:12800
 ds_read_b64_tr_b16 a[28:29], v246 offset:14336
 ds_read_b64_tr_b16 a[30:31], v246 offset:14848
 s_waitcnt lgkmcnt(0)
 s_add_u32 s3, s63, 1
 s_min_u32 s3, s3, 17
 s_lshr_b32 s73, s3, 1
 s_lshl_b32 s73, s73, 14
 s_and_b32 s3, s3, 1
 s_lshl_b32 s3, s3, 6
 v_xor_b32 v246, s3, v243
 v_add_u32 v246, s73, v246
 ds_read_b64_tr_b16 a[32:33], v246 offset:0
 ds_read_b64_tr_b16 a[34:35], v246 offset:512
 ds_read_b64_tr_b16 a[36:37], v246 offset:2048
 ds_read_b64_tr_b16 a[38:39], v246 offset:2560
 ds_read_b64_tr_b16 a[40:41], v246 offset:4096
 ds_read_b64_tr_b16 a[42:43], v246 offset:4608
 ds_read_b64_tr_b16 a[44:45], v246 offset:6144
 ds_read_b64_tr_b16 a[46:47], v246 offset:6656
 ds_read_b64_tr_b16 a[48:49], v246 offset:8192
 ds_read_b64_tr_b16 a[50:51], v246 offset:8704
 ds_read_b64_tr_b16 a[52:53], v246 offset:10240
 ds_read_b64_tr_b16 a[54:55], v246 offset:10752
 ds_read_b64_tr_b16 a[56:57], v246 offset:12288
 ds_read_b64_tr_b16 a[58:59], v246 offset:12800
 ds_read_b64_tr_b16 a[60:61], v246 offset:14336
 ds_read_b64_tr_b16 a[62:63], v246 offset:14848
 s_waitcnt lgkmcnt(0)
 s_add_u32 s3, s63, 2
 s_min_u32 s3, s3, 17
 s_lshr_b32 s73, s3, 1
 s_lshl_b32 s73, s73, 14
 s_and_b32 s3, s3, 1
 s_lshl_b32 s3, s3, 6
 v_xor_b32 v246, s3, v243
 v_add_u32 v246, s73, v246
 ds_read_b64_tr_b16 a[64:65], v246 offset:0
 ds_read_b64_tr_b16 a[66:67], v246 offset:512
 ds_read_b64_tr_b16 a[68:69], v246 offset:2048
 ds_read_b64_tr_b16 a[70:71], v246 offset:2560
 ds_read_b64_tr_b16 a[72:73], v246 offset:4096
 ds_read_b64_tr_b16 a[74:75], v246 offset:4608
 ds_read_b64_tr_b16 a[76:77], v246 offset:6144
 ds_read_b64_tr_b16 a[78:79], v246 offset:6656
 ds_read_b64_tr_b16 a[80:81], v246 offset:8192
 ds_read_b64_tr_b16 a[82:83], v246 offset:8704
 ds_read_b64_tr_b16 a[84:85], v246 offset:10240
 ds_read_b64_tr_b16 a[86:87], v246 offset:10752
 ds_read_b64_tr_b16 a[88:89], v246 offset:12288
 ds_read_b64_tr_b16 a[90:91], v246 offset:12800
 ds_read_b64_tr_b16 a[92:93], v246 offset:14336
 ds_read_b64_tr_b16 a[94:95], v246 offset:14848
 s_waitcnt lgkmcnt(0)
 s_add_u32 s3, s63, 3
 s_min_u32 s3, s3, 17
 s_lshr_b32 s73, s3, 1
 s_lshl_b32 s73, s73, 14
 s_and_b32 s3, s3, 1
 s_lshl_b32 s3, s3, 6
 v_xor_b32 v246, s3, v243
 v_add_u32 v246, s73, v246
 ds_read_b64_tr_b16 a[96:97], v246 offset:0
 ds_read_b64_tr_b16 a[98:99], v246 offset:512
 ds_read_b64_tr_b16 a[100:101], v246 offset:2048
 ds_read_b64_tr_b16 a[102:103], v246 offset:2560
 ds_read_b64_tr_b16 a[104:105], v246 offset:4096
 ds_read_b64_tr_b16 a[106:107], v246 offset:4608
 ds_read_b64_tr_b16 a[108:109], v246 offset:6144
 ds_read_b64_tr_b16 a[110:111], v246 offset:6656
 ds_read_b64_tr_b16 a[112:113], v246 offset:8192
 ds_read_b64_tr_b16 a[114:115], v246 offset:8704
 ds_read_b64_tr_b16 a[116:117], v246 offset:10240
 ds_read_b64_tr_b16 a[118:119], v246 offset:10752
 ds_read_b64_tr_b16 a[120:121], v246 offset:12288
 ds_read_b64_tr_b16 a[122:123], v246 offset:12800
 ds_read_b64_tr_b16 a[124:125], v246 offset:14336
 ds_read_b64_tr_b16 a[126:127], v246 offset:14848
 s_waitcnt lgkmcnt(0)
 s_add_u32 s3, s63, 4
 s_min_u32 s3, s3, 17
 s_lshr_b32 s73, s3, 1
 s_lshl_b32 s73, s73, 14
 s_and_b32 s3, s3, 1
 s_lshl_b32 s3, s3, 6
 v_xor_b32 v246, s3, v243
 v_add_u32 v246, s73, v246
 ds_read_b64_tr_b16 a[128:129], v246 offset:0
 ds_read_b64_tr_b16 a[130:131], v246 offset:512
 ds_read_b64_tr_b16 a[132:133], v246 offset:2048
 ds_read_b64_tr_b16 a[134:135], v246 offset:2560
 ds_read_b64_tr_b16 a[136:137], v246 offset:4096
 ds_read_b64_tr_b16 a[138:139], v246 offset:4608
 ds_read_b64_tr_b16 a[140:141], v246 offset:6144
 ds_read_b64_tr_b16 a[142:143], v246 offset:6656
 ds_read_b64_tr_b16 a[144:145], v246 offset:8192
 ds_read_b64_tr_b16 a[146:147], v246 offset:8704
 ds_read_b64_tr_b16 a[148:149], v246 offset:10240
 ds_read_b64_tr_b16 a[150:151], v246 offset:10752
 ds_read_b64_tr_b16 a[152:153], v246 offset:12288
 ds_read_b64_tr_b16 a[154:155], v246 offset:12800
 ds_read_b64_tr_b16 a[156:157], v246 offset:14336
 ds_read_b64_tr_b16 a[158:159], v246 offset:14848
 s_waitcnt lgkmcnt(0)
 v_and_b32 v246, 31, v249
 v_bfe_u32 v247, v249, 5, 1
 v_lshlrev_b32 v247, 2, v247
 v_sub_u32 v246, v246, v247
 v_mov_b32 v247, 0xff800000
 v_cmp_gt_i32 vcc, 0, v246
 s_nop 1
 v_cndmask_b32 v0, 0, v247, vcc
 v_cmp_gt_i32 vcc, 1, v246
 s_nop 1
 v_cndmask_b32 v1, 0, v247, vcc
 v_cmp_gt_i32 vcc, 2, v246
 s_nop 1
 v_cndmask_b32 v2, 0, v247, vcc
 v_cmp_gt_i32 vcc, 3, v246
 s_nop 1
 v_cndmask_b32 v3, 0, v247, vcc
 v_cmp_gt_i32 vcc, 8, v246
 s_nop 1
 v_cndmask_b32 v4, 0, v247, vcc
 v_cmp_gt_i32 vcc, 9, v246
 s_nop 1
 v_cndmask_b32 v5, 0, v247, vcc
 v_cmp_gt_i32 vcc, 10, v246
 s_nop 1
 v_cndmask_b32 v6, 0, v247, vcc
 v_cmp_gt_i32 vcc, 11, v246
 s_nop 1
 v_cndmask_b32 v7, 0, v247, vcc
 v_cmp_gt_i32 vcc, 16, v246
 s_nop 1
 v_cndmask_b32 v8, 0, v247, vcc
 v_cmp_gt_i32 vcc, 17, v246
 s_nop 1
 v_cndmask_b32 v9, 0, v247, vcc
 v_cmp_gt_i32 vcc, 18, v246
 s_nop 1
 v_cndmask_b32 v10, 0, v247, vcc
 v_cmp_gt_i32 vcc, 19, v246
 s_nop 1
 v_cndmask_b32 v11, 0, v247, vcc
 v_cmp_gt_i32 vcc, 24, v246
 s_nop 1
 v_cndmask_b32 v12, 0, v247, vcc
 v_cmp_gt_i32 vcc, 25, v246
 s_nop 1
 v_cndmask_b32 v13, 0, v247, vcc
 v_cmp_gt_i32 vcc, 26, v246
 s_nop 1
 v_cndmask_b32 v14, 0, v247, vcc
 v_cmp_gt_i32 vcc, 27, v246
 s_nop 1
 v_cndmask_b32 v15, 0, v247, vcc
 v_and_b32 v241, 0x70, v240
 v_bfe_u32 v246, v249, 5, 1
 v_lshl_add_u32 v241, v246, 8, v241
 v_and_b32 v242, 31, v249
 s_lshl_b32 s3, s46, 5
 v_add_u32 v242, s3, v242
 v_lshlrev_b32 v242, 3, v242
 v_lshl_add_u32 v242, v246, 10, v242
 s_lshl_b32 s64, s50, 1
 s_add_u32 s64, s64, s46
 s_add_u32 s3, s50, 64
 s_cmp_eq_u32 s46, 2
 s_cselect_b32 s64, s3, s64
 s_cmp_lt_u32 s64, 72
 s_cselect_b32 s57, 1, 0
 s_cmp_eq_u32 s46, 3
 s_cselect_b32 s57, 0, s57
 s_lshr_b32 s72, s64, 1
 s_lshl_b32 s56, s72, 15
 s_and_b32 s3, s64, 1
 s_lshl_b32 s3, s3, 8
 s_add_u32 s56, s56, s3
 s_mul_i32 s3, s51, 2359296
 s_add_u32 s56, s56, s3
 s_add_u32 s56, s56, 117440512
 v_and_b32 v243, 0xf0, v240
 v_lshrrev_b32 v246, 4, v249
 v_lshl_add_u32 v243, v246, 10, v243
 v_lshrrev_b32 v247, 1, v246
 v_and_b32 v245, 15, v249
 s_and_b32 s3, s64, 1
 s_lshl_b32 s3, s3, 4
 v_add_u32 v245, s3, v245
 v_mul_u32_u24 v245, 1152, v245
 v_lshl_add_u32 v245, v247, 3, v245
 v_and_b32 v247, 1, v246
 v_lshl_add_u32 v245, v247, 4, v245
 s_lshl_b32 s3, s72, 5
 v_add_u32 v245, s3, v245
 v_and_b32 v246, 1, v249
 v_lshlrev_b32 v246, 4, v246
 v_mov_b32 v247, 0x3f80
 v_lshlrev_b32 v247, v246, v247
 v_bfe_u32 v246, v249, 1, 3
 v_cmp_eq_u32 vcc, 0, v246
 s_nop 1
 v_cndmask_b32 v216, 0, v247, vcc
 v_cmp_eq_u32 vcc, 1, v246
 s_nop 1
 v_cndmask_b32 v217, 0, v247, vcc
 v_cmp_eq_u32 vcc, 2, v246
 s_nop 1
 v_cndmask_b32 v218, 0, v247, vcc
 v_cmp_eq_u32 vcc, 3, v246
 s_nop 1
 v_cndmask_b32 v219, 0, v247, vcc
 v_cmp_eq_u32 vcc, 4, v246
 s_nop 1
 v_cndmask_b32 v220, 0, v247, vcc
 v_cmp_eq_u32 vcc, 5, v246
 s_nop 1
 v_cndmask_b32 v221, 0, v247, vcc
 v_cmp_eq_u32 vcc, 6, v246
 s_nop 1
 v_cndmask_b32 v222, 0, v247, vcc
 v_cmp_eq_u32 vcc, 7, v246
 s_nop 1
 v_cndmask_b32 v223, 0, v247, vcc
 v_mov_b64 v[154:155], 0
 v_mov_b64 v[166:167], 0
 s_mov_b32 s58, 0x3e029413
 s_mov_b32 s59, 0x3e029413
 s_lshl_b32 s3, s63, 16
 s_add_u32 s55, s55, s3
 s_lshl_b32 s72, s51, 7
 s_add_u32 s72, s72, 65024000
 s_mov_b32 s60, 0
 v_mov_b32 v246, 0
L_pw_308:
 buffer_load_dword v247, v246, s[4:7], s72 offen sc1
 s_add_u32 s60, s60, 1
 s_cmp_gt_u32 s60, 400000
 s_cbranch_scc1 L_exit2
 s_waitcnt vmcnt(0)
 v_cmp_gt_i32 vcc, 32, v247
 s_cbranch_vccz L_pwok_309
 s_sleep 2
 s_branch L_pw_308
L_pwok_309:
 s_barrier
 s_sub_u32 s52, s51, 1
 s_cmp_eq_u32 s51, 0
 s_cselect_b32 s52, 63, s52
 s_mov_b32 s53, 0
 s_mov_b32 s54, 0
 s_mov_b32 s61, 0
 s_mov_b32 s67, -1
 s_lshr_b32 s72, s52, 2
 s_bitcmp1_b32 s61, s72
 s_cbranch_scc1 L_rbok_310
 v_and_b32 v246, 0xf0, v240
 v_lshlrev_b32 v246, 3, v246
 s_mov_b32 s73, 65025024
 s_mov_b32 s60, 0
L_rbp_311:
 buffer_load_dword v247, v246, s[4:7], s73 offen sc1
 s_add_u32 s60, s60, 1
 s_cmp_gt_u32 s60, 400000
 s_cbranch_scc1 L_exit2
 s_waitcnt vmcnt(0)
 v_cmp_le_u32 vcc, 12, v247
 s_and_b32 s61, vcc_lo, 0xffff
 s_bitcmp1_b32 s61, s72
 s_cbranch_scc1 L_rbok_310
 s_sleep 8
 s_branch L_rbp_311
L_rbok_310:
 s_lshl_b32 s72, s52, 5
 s_add_u32 s72, s72, s50
 s_lshl_b32 s72, s72, 13
 s_lshl_b32 s3, s46, 11
 s_add_u32 s72, s72, s3
 s_add_u32 s73, s54, s3
 s_add_u32 m0, s73, 0
 s_add_u32 s74, s72, 33554432
 buffer_load_dwordx4 v240, s[4:7], s74 offen sc1 lds
 buffer_load_dwordx4 v240, s[4:7], s74 offen offset:1024 sc1 lds
 s_add_u32 m0, s73, 8192
 s_add_u32 s74, s72, 0
 buffer_load_dwordx4 v240, s[4:7], s74 offen sc1 lds
 buffer_load_dwordx4 v240, s[4:7], s74 offen offset:1024 sc1 lds
 s_add_u32 m0, s73, 16384
 s_add_u32 s74, s72, 16777216
 buffer_load_dwordx4 v240, s[4:7], s74 offen sc1 lds
 buffer_load_dwordx4 v240, s[4:7], s74 offen offset:1024 sc1 lds
L_seg_312:
 s_add_u32 s78, s52, 6
 s_xor_b32 s79, s54, 24576
 s_cmp_gt_u32 s78, 62
 s_cbranch_scc1 L_nonext_313
 s_lshr_b32 s72, s78, 2
 s_bitcmp1_b32 s61, s72
 s_cbranch_scc1 L_rbok_315
 v_and_b32 v246, 0xf0, v240
 v_lshlrev_b32 v246, 3, v246
 s_mov_b32 s73, 65025024
 s_mov_b32 s60, 0
L_rbp_316:
 buffer_load_dword v247, v246, s[4:7], s73 offen sc1
 s_add_u32 s60, s60, 1
 s_cmp_gt_u32 s60, 400000
 s_cbranch_scc1 L_exit2
 s_waitcnt vmcnt(0)
 v_cmp_le_u32 vcc, 12, v247
 s_and_b32 s61, vcc_lo, 0xffff
 s_bitcmp1_b32 s61, s72
 s_cbranch_scc1 L_rbok_315
 s_sleep 8
 s_branch L_rbp_316
L_rbok_315:
 s_branch L_next_314
L_nonext_313:
 s_mov_b32 s78, 4096
L_next_314:
 s_waitcnt vmcnt(0)
 s_barrier
 v_add_u32 v248, s54, v240
 ds_read_b128 v[16:19], v248 offset:0
 ds_read_b128 v[48:51], v248 offset:8192
 ds_read_b128 v[20:23], v248 offset:1024
 ds_read_b128 v[52:55], v248 offset:9216
 ds_read_b128 v[24:27], v248 offset:2048
 ds_read_b128 v[56:59], v248 offset:10240
 ds_read_b128 v[28:31], v248 offset:3072
 ds_read_b128 v[60:63], v248 offset:11264
 ds_read_b128 v[32:35], v248 offset:4096
 ds_read_b128 v[64:67], v248 offset:12288
 ds_read_b128 v[36:39], v248 offset:5120
 ds_read_b128 v[68:71], v248 offset:13312
 s_waitcnt lgkmcnt(10)
 ds_read_b128 v[40:43], v248 offset:6144
 ds_read_b128 v[72:75], v248 offset:14336
 ds_read_b128 v[44:47], v248 offset:7168
 ds_read_b128 v[76:79], v248 offset:15360
 s_lshl_b32 s66, s52, 5
 s_add_u32 s66, s66, s50
 s_lshl_b32 s66, s66, 2
 s_add_u32 s66, s66, s46
 s_lshl_b32 s66, s66, 10
 s_add_u32 s66, s66, 50462720
 s_cmp_gt_i32 s67, s52
 s_cselect_b32 s3, s66, 0x40000000
 buffer_load_dwordx4 v[232:235], v240, s[4:7], s3 offen sc1
 s_mul_i32 s72, s52, 589824
 s_lshr_b32 s3, s64, 1
 s_lshl_b32 s3, s3, 14
 s_add_u32 s72, s72, s3
 s_and_b32 s3, s64, 1
 s_lshl_b32 s3, s3, 8
 s_add_u32 s72, s72, s3
 s_add_u32 s72, s72, 67108864
 s_mul_i32 s73, s52, 36864
 s_cmp_eq_u32 s57, 1
 s_cselect_b32 s72, s72, 0x40000000
 s_cselect_b32 s73, s73, 0x40000000
 buffer_load_dwordx4 a[160:163], v243, s[4:7], s72 offen offset:0 sc1
 buffer_load_dwordx4 a[164:167], v243, s[4:7], s72 offen offset:512 sc1
 s_add_u32 s72, s72, 4096
 buffer_load_dwordx4 a[168:171], v243, s[4:7], s72 offen offset:0 sc1
 buffer_load_dwordx4 a[172:175], v243, s[4:7], s72 offen offset:512 sc1
 s_add_u32 s72, s72, 4096
 buffer_load_dwordx4 a[176:179], v243, s[4:7], s72 offen offset:0 sc1
 buffer_load_dwordx4 a[180:183], v243, s[4:7], s72 offen offset:512 sc1
 s_add_u32 s72, s72, 4096
 buffer_load_dwordx2 v[228:229], v245, s[24:27], s73 offen
 s_lshl_b32 s72, s78, 5
 s_add_u32 s72, s72, s50
 s_lshl_b32 s72, s72, 13
 s_lshl_b32 s3, s46, 11
 s_add_u32 s72, s72, s3
 s_add_u32 s73, s79, s3
 s_add_u32 m0, s73, 0
 s_add_u32 s74, s72, 33554432
 buffer_load_dwordx4 v240, s[4:7], s74 offen sc1 lds
 buffer_load_dwordx4 v240, s[4:7], s74 offen offset:1024 sc1 lds
 s_add_u32 m0, s73, 8192
 s_add_u32 s74, s72, 0
 buffer_load_dwordx4 v240, s[4:7], s74 offen sc1 lds
 buffer_load_dwordx4 v240, s[4:7], s74 offen offset:1024 sc1 lds
 s_add_u32 m0, s73, 16384
 s_add_u32 s74, s72, 16777216
 buffer_load_dwordx4 v240, s[4:7], s74 offen sc1 lds
 buffer_load_dwordx4 v240, s[4:7], s74 offen offset:1024 sc1 lds
 s_lshl_b32 s3, s46, 11
 v_add_u32 v248, s3, v248
 v_mfma_f32_32x32x16_bf16 v[112:127], v[48:51], v[16:19], v[0:15]
 s_waitcnt lgkmcnt(12)
 v_mfma_f32_32x32x16_bf16 v[112:127], v[52:55], v[20:23], v[112:127]
 s_waitcnt lgkmcnt(10)
 v_mfma_f32_32x32x16_bf16 v[112:127], v[56:59], v[24:27], v[112:127]
 s_waitcnt lgkmcnt(8)
 v_mfma_f32_32x32x16_bf16 v[112:127], v[60:63], v[28:31], v[112:127]
 s_waitcnt lgkmcnt(6)
 v_mfma_f32_32x32x16_bf16 v[112:127], v[64:67], v[32:35], v[112:127]
 s_waitcnt lgkmcnt(4)
 v_mfma_f32_32x32x16_bf16 v[112:127], v[68:71], v[36:39], v[112:127]
 s_waitcnt lgkmcnt(2)
 v_mfma_f32_32x32x16_bf16 v[112:127], v[72:75], v[40:43], v[112:127]
 s_waitcnt lgkmcnt(0)
 v_mfma_f32_32x32x16_bf16 v[112:127], v[76:79], v[44:47], v[112:127]
 ds_read_b128 v[156:159], v248 offset:16384
 ds_read_b128 v[160:163], v248 offset:17408
 s_lshl_b32 s3, s46, 10
 v_add_u32 v248, s3, v240
 s_cmp_gt_i32 s67, s52
 s_waitcnt vmcnt(13)
 s_cbranch_scc1 L_kvmok_317
 s_lshl_b32 s75, s50, 7
 s_add_u32 s75, s75, 65011712
 s_add_u32 s76, s52, 1
 s_cmp_eq_u32 s52, 63
 s_cselect_b32 s76, 62, s76
 s_mov_b32 s60, 0
 v_mov_b32 v246, 0
L_pw_319:
 buffer_load_dword v247, v246, s[4:7], s75 offen sc1
 s_add_u32 s60, s60, 1
 s_cmp_gt_u32 s60, 400000
 s_cbranch_scc1 L_exit2
 s_waitcnt vmcnt(0)
 v_cmp_gt_i32 vcc, s76, v247
 s_cbranch_vccz L_pwok_320
 v_readfirstlane_b32 s3, v247
 s_add_u32 s3, s3, 2
 s_cmp_ge_i32 s3, s76
 s_cbranch_scc1 L_pw_319
 s_sleep 16
 s_branch L_pw_319
L_pwok_320:
 v_readfirstlane_b32 s67, v247
 s_mov_b32 s60, 0
L_kvmp_318:
 buffer_load_dwordx4 v[232:235], v240, s[4:7], s66 offen sc1
 s_add_u32 s60, s60, 1
 s_cmp_gt_u32 s60, 400000
 s_cbranch_scc1 L_exit2
 s_cmp_lg_u32 s52, 63
 s_waitcnt vmcnt(0)
 s_cbranch_scc1 L_kvmok_317
 v_bitop3_b32 v246, v232, v233, v234 bitop3:0x80
 v_bitop3_b32 v246, v246, v235, 1 bitop3:0x80
 v_cmp_ne_u32 vcc, 1, v246
 s_cbranch_vccnz L_kvmp_318
L_kvmok_317:
 ds_write_b128 v248, v[232:235] offset:49152
 s_waitcnt lgkmcnt(0)
 s_barrier
 ds_read_b128 v[80:83], v241 offset:49152
 ds_read_b128 v[84:87], v241 offset:49664
 ds_read_b128 v[88:91], v241 offset:49280
 ds_read_b128 v[92:95], v241 offset:49792
 ds_read_b128 v[96:99], v241 offset:50176
 ds_read_b128 v[100:103], v241 offset:50688
 ds_read_b128 v[104:107], v241 offset:50304
 ds_read_b128 v[108:111], v241 offset:50816
 ds_read_b64 v[164:165], v242 offset:51200
 s_waitcnt lgkmcnt(8)
 v_mfma_f32_32x32x16_bf16 v[128:143], v[80:83], v[16:19], 0
 s_waitcnt lgkmcnt(7)
 v_mfma_f32_32x32x16_bf16 v[128:143], v[84:87], v[20:23], v[128:143]
 s_waitcnt lgkmcnt(6)
 v_mfma_f32_32x32x16_bf16 v[128:143], v[88:91], v[24:27], v[128:143]
 s_waitcnt lgkmcnt(5)
 v_mfma_f32_32x32x16_bf16 v[128:143], v[92:95], v[28:31], v[128:143]
 s_waitcnt lgkmcnt(4)
 v_mfma_f32_32x32x16_bf16 v[128:143], v[96:99], v[32:35], v[128:143]
 s_waitcnt lgkmcnt(3)
 v_mfma_f32_32x32x16_bf16 v[128:143], v[100:103], v[36:39], v[128:143]
 s_waitcnt lgkmcnt(2)
 v_mfma_f32_32x32x16_bf16 v[128:143], v[104:107], v[40:43], v[128:143]
 s_waitcnt lgkmcnt(1)
 v_mfma_f32_32x32x16_bf16 v[128:143], v[108:111], v[44:47], v[128:143]
 v_max3_f32 v246, v112, v113, v114
 v_max3_f32 v246, v246, v115, v116
 v_max3_f32 v246, v246, v117, v118
 v_max3_f32 v246, v246, v119, v120
 v_max3_f32 v246, v246, v121, v122
 v_max3_f32 v246, v246, v123, v124
 v_max3_f32 v246, v246, v125, v126
 v_max_f32 v246, v246, v127
 s_nop 3
 v_max3_f32 v246, v246, v128, v129
 v_max3_f32 v247, v246, v130, v131
 v_max3_f32 v246, v246, v130, v131
 s_nop 1
 v_permlane32_swap_b32 v246, v247
 v_max_f32 v246, v246, v247
 v_pk_add_f32 v[112:113], v[112:113], v[246:247] op_sel_hi:[1,0] neg_lo:[0,1] neg_hi:[0,1]
 v_pk_add_f32 v[114:115], v[114:115], v[246:247] op_sel_hi:[1,0] neg_lo:[0,1] neg_hi:[0,1]
 v_pk_add_f32 v[116:117], v[116:117], v[246:247] op_sel_hi:[1,0] neg_lo:[0,1] neg_hi:[0,1]
 v_pk_add_f32 v[118:119], v[118:119], v[246:247] op_sel_hi:[1,0] neg_lo:[0,1] neg_hi:[0,1]
 v_pk_add_f32 v[120:121], v[120:121], v[246:247] op_sel_hi:[1,0] neg_lo:[0,1] neg_hi:[0,1]
 v_pk_add_f32 v[122:123], v[122:123], v[246:247] op_sel_hi:[1,0] neg_lo:[0,1] neg_hi:[0,1]
 v_pk_add_f32 v[124:125], v[124:125], v[246:247] op_sel_hi:[1,0] neg_lo:[0,1] neg_hi:[0,1]
 v_pk_add_f32 v[126:127], v[126:127], v[246:247] op_sel_hi:[1,0] neg_lo:[0,1] neg_hi:[0,1]
 v_pk_add_f32 v[128:129], v[128:129], v[246:247] op_sel_hi:[1,0] neg_lo:[0,1] neg_hi:[0,1]
 v_pk_add_f32 v[130:131], v[130:131], v[246:247] op_sel_hi:[1,0] neg_lo:[0,1] neg_hi:[0,1]
 v_pk_mul_f32 v[112:113], v[112:113], s[58:59]
 v_pk_mul_f32 v[114:115], v[114:115], s[58:59]
 v_pk_mul_f32 v[116:117], v[116:117], s[58:59]
 v_pk_mul_f32 v[118:119], v[118:119], s[58:59]
 v_pk_mul_f32 v[120:121], v[120:121], s[58:59]
 v_pk_mul_f32 v[122:123], v[122:123], s[58:59]
 v_pk_mul_f32 v[124:125], v[124:125], s[58:59]
 v_pk_mul_f32 v[126:127], v[126:127], s[58:59]
 v_pk_mul_f32 v[128:129], v[128:129], s[58:59]
 v_pk_mul_f32 v[130:131], v[130:131], s[58:59]
 v_exp_f32 v112, v112
 v_exp_f32 v113, v113
 v_exp_f32 v114, v114
 v_exp_f32 v115, v115
 v_exp_f32 v116, v116
 v_exp_f32 v117, v117
 v_exp_f32 v118, v118
 v_exp_f32 v119, v119
 v_exp_f32 v120, v120
 v_exp_f32 v121, v121
 v_exp_f32 v122, v122
 v_exp_f32 v123, v123
 v_exp_f32 v124, v124
 v_exp_f32 v125, v125
 v_exp_f32 v126, v126
 v_exp_f32 v127, v127
 v_exp_f32 v128, v128
 v_exp_f32 v129, v129
 v_exp_f32 v130, v130
 v_exp_f32 v131, v131
 v_cvt_pk_bf16_f32 v144, v112, v113
 v_cvt_pk_bf16_f32 v145, v114, v115
 v_cvt_pk_bf16_f32 v146, v116, v117
 v_cvt_pk_bf16_f32 v147, v118, v119
 v_cvt_pk_bf16_f32 v148, v120, v121
 v_cvt_pk_bf16_f32 v149, v122, v123
 v_cvt_pk_bf16_f32 v150, v124, v125
 v_cvt_pk_bf16_f32 v151, v126, v127
 v_cvt_pk_bf16_f32 v152, v128, v129
 v_cvt_pk_bf16_f32 v153, v130, v131
 s_waitcnt lgkmcnt(0)
 s_nop 0
 v_mfma_f32_32x32x16_bf16 v[168:183], v[156:159], v[144:147], 0
 v_pk_add_f32 v[112:113], v[112:113], v[114:115]
 v_mfma_f32_32x32x16_bf16 v[168:183], v[160:163], v[148:151], v[168:183]
 v_mfma_f32_32x32x16_bf16 v[168:183], v[164:167], v[152:155], v[168:183]
 v_pk_add_f32 v[112:113], v[112:113], v[116:117]
 v_pk_add_f32 v[112:113], v[112:113], v[118:119]
 v_pk_add_f32 v[112:113], v[112:113], v[120:121]
 v_pk_add_f32 v[112:113], v[112:113], v[122:123]
 v_pk_add_f32 v[112:113], v[112:113], v[124:125]
 v_pk_add_f32 v[112:113], v[112:113], v[126:127]
 v_pk_add_f32 v[112:113], v[112:113], v[128:129]
 v_pk_add_f32 v[112:113], v[112:113], v[130:131]
 v_add_f32 v246, v112, v113
 v_add_f32 v247, v112, v113
 s_nop 1
 v_permlane32_swap_b32 v246, v247
 v_add_f32 v246, v246, v247
 v_rcp_f32 v246, v246
 s_nop 0
 v_pk_mul_f32 v[168:169], v[168:169], v[246:247] op_sel_hi:[1,0]
 v_pk_mul_f32 v[170:171], v[170:171], v[246:247] op_sel_hi:[1,0]
 v_pk_mul_f32 v[172:173], v[172:173], v[246:247] op_sel_hi:[1,0]
 v_pk_mul_f32 v[174:175], v[174:175], v[246:247] op_sel_hi:[1,0]
 v_pk_mul_f32 v[176:177], v[176:177], v[246:247] op_sel_hi:[1,0]
 v_pk_mul_f32 v[178:179], v[178:179], v[246:247] op_sel_hi:[1,0]
 v_pk_mul_f32 v[180:181], v[180:181], v[246:247] op_sel_hi:[1,0]
 v_pk_mul_f32 v[182:183], v[182:183], v[246:247] op_sel_hi:[1,0]
 v_cvt_pk_bf16_f32 v144, v168, v169
 v_cvt_pk_bf16_f32 v145, v170, v171
 v_cvt_pk_bf16_f32 v146, v172, v173
 v_cvt_pk_bf16_f32 v147, v174, v175
 v_cvt_pk_bf16_f32 v148, v176, v177
 v_cvt_pk_bf16_f32 v149, v178, v179
 v_cvt_pk_bf16_f32 v150, v180, v181
 v_cvt_pk_bf16_f32 v151, v182, v183
 s_lshl_b32 s3, s46, 11
 v_add_u32 v248, s3, v240
 ds_write_b128 v248, v[144:147] offset:53248
 ds_write_b128 v248, v[148:151] offset:54272
 s_waitcnt lgkmcnt(0)
 s_barrier
 ds_read_b128 v[16:19], v240 offset:53248
 ds_read_b128 v[20:23], v240 offset:54272
 ds_read_b128 v[24:27], v240 offset:55296
 ds_read_b128 v[28:31], v240 offset:56320
 ds_read_b128 v[32:35], v240 offset:57344
 ds_read_b128 v[36:39], v240 offset:58368
 ds_read_b128 v[40:43], v240 offset:59392
 ds_read_b128 v[44:47], v240 offset:60416
 s_and_b32 s3, s53, 1
 s_mul_i32 s77, s3, 1179648
 s_add_u32 s72, s55, s77
 s_lshr_b32 s62, s53, 1
 s_and_b32 s62, s62, 1
 s_waitcnt lgkmcnt(7)
 v_mfma_f32_32x32x16_bf16 v[184:199], a[0:3], v[16:19], 0
 s_waitcnt lgkmcnt(6)
 v_mfma_f32_32x32x16_bf16 v[184:199], a[4:7], v[20:23], v[184:199]
 s_waitcnt lgkmcnt(5)
 v_mfma_f32_32x32x16_bf16 v[184:199], a[8:11], v[24:27], v[184:199]
 s_waitcnt lgkmcnt(4)
 v_mfma_f32_32x32x16_bf16 v[184:199], a[12:15], v[28:31], v[184:199]
 s_waitcnt lgkmcnt(3)
 v_mfma_f32_32x32x16_bf16 v[184:199], a[16:19], v[32:35], v[184:199]
 s_waitcnt lgkmcnt(2)
 v_mfma_f32_32x32x16_bf16 v[184:199], a[20:23], v[36:39], v[184:199]
 s_waitcnt lgkmcnt(1)
 v_mfma_f32_32x32x16_bf16 v[184:199], a[24:27], v[40:43], v[184:199]
 s_waitcnt lgkmcnt(0)
 v_mfma_f32_32x32x16_bf16 v[184:199], a[28:31], v[44:47], v[184:199]
 v_mfma_f32_32x32x16_bf16 v[200:215], a[32:35], v[16:19], 0
 s_nop 3
 v_mfma_f32_32x32x16_bf16 v[200:215], a[36:39], v[20:23], v[200:215]
 s_nop 3
 v_mfma_f32_32x32x16_bf16 v[200:215], a[40:43], v[24:27], v[200:215]
 s_nop 3
 v_mfma_f32_32x32x16_bf16 v[200:215], a[44:47], v[28:31], v[200:215]
 v_cvt_pk_bf16_f32 v184, v184, v185
 v_cvt_pk_bf16_f32 v185, v186, v187
 v_cvt_pk_bf16_f32 v186, v188, v189
 v_cvt_pk_bf16_f32 v187, v190, v191
 v_mfma_f32_32x32x16_bf16 v[200:215], a[48:51], v[32:35], v[200:215]
 v_and_or_b32 v184, v184, -2, s62
 v_and_or_b32 v185, v185, -2, s62
 v_and_or_b32 v186, v186, -2, s62
 v_and_or_b32 v187, v187, -2, s62
 v_mfma_f32_32x32x16_bf16 v[200:215], a[52:55], v[36:39], v[200:215]
 buffer_store_dwordx4 v[184:187], v240, s[4:7], s72 offen
 s_add_u32 s72, s72, 32768
 v_cvt_pk_bf16_f32 v192, v192, v193
 v_cvt_pk_bf16_f32 v193, v194, v195
 v_mfma_f32_32x32x16_bf16 v[200:215], a[56:59], v[40:43], v[200:215]
 v_cvt_pk_bf16_f32 v194, v196, v197
 v_cvt_pk_bf16_f32 v195, v198, v199
 v_and_or_b32 v192, v192, -2, s62
 v_and_or_b32 v193, v193, -2, s62
 v_mfma_f32_32x32x16_bf16 v[200:215], a[60:63], v[44:47], v[200:215]
 v_and_or_b32 v194, v194, -2, s62
 v_and_or_b32 v195, v195, -2, s62
 buffer_store_dwordx4 v[192:195], v240, s[4:7], s72 offen
 s_add_u32 s72, s72, 32768
 v_mfma_f32_32x32x16_bf16 v[184:199], a[64:67], v[16:19], 0
 s_nop 3
 v_mfma_f32_32x32x16_bf16 v[184:199], a[68:71], v[20:23], v[184:199]
 s_nop 3
 v_mfma_f32_32x32x16_bf16 v[184:199], a[72:75], v[24:27], v[184:199]
 s_nop 3
 v_mfma_f32_32x32x16_bf16 v[184:199], a[76:79], v[28:31], v[184:199]
 v_cvt_pk_bf16_f32 v200, v200, v201
 v_cvt_pk_bf16_f32 v201, v202, v203
 v_cvt_pk_bf16_f32 v202, v204, v205
 v_cvt_pk_bf16_f32 v203, v206, v207
 v_mfma_f32_32x32x16_bf16 v[184:199], a[80:83], v[32:35], v[184:199]
 v_and_or_b32 v200, v200, -2, s62
 v_and_or_b32 v201, v201, -2, s62
 v_and_or_b32 v202, v202, -2, s62
 v_and_or_b32 v203, v203, -2, s62
 v_mfma_f32_32x32x16_bf16 v[184:199], a[84:87], v[36:39], v[184:199]
 buffer_store_dwordx4 v[200:203], v240, s[4:7], s72 offen
 s_add_u32 s72, s72, 32768
 v_cvt_pk_bf16_f32 v208, v208, v209
 v_cvt_pk_bf16_f32 v209, v210, v211
 v_mfma_f32_32x32x16_bf16 v[184:199], a[88:91], v[40:43], v[184:199]
 v_cvt_pk_bf16_f32 v210, v212, v213
 v_cvt_pk_bf16_f32 v211, v214, v215
 v_and_or_b32 v208, v208, -2, s62
 v_and_or_b32 v209, v209, -2, s62
 v_mfma_f32_32x32x16_bf16 v[184:199], a[92:95], v[44:47], v[184:199]
 v_and_or_b32 v210, v210, -2, s62
 v_and_or_b32 v211, v211, -2, s62
 buffer_store_dwordx4 v[208:211], v240, s[4:7], s72 offen
 s_add_u32 s72, s72, 32768
 v_mfma_f32_32x32x16_bf16 v[200:215], a[96:99], v[16:19], 0
 s_nop 3
 v_mfma_f32_32x32x16_bf16 v[200:215], a[100:103], v[20:23], v[200:215]
 s_nop 3
 v_mfma_f32_32x32x16_bf16 v[200:215], a[104:107], v[24:27], v[200:215]
 s_nop 3
 v_mfma_f32_32x32x16_bf16 v[200:215], a[108:111], v[28:31], v[200:215]
 v_cvt_pk_bf16_f32 v184, v184, v185
 v_cvt_pk_bf16_f32 v185, v186, v187
 v_cvt_pk_bf16_f32 v186, v188, v189
 v_cvt_pk_bf16_f32 v187, v190, v191
 v_mfma_f32_32x32x16_bf16 v[200:215], a[112:115], v[32:35], v[200:215]
 v_and_or_b32 v184, v184, -2, s62
 v_and_or_b32 v185, v185, -2, s62
 v_and_or_b32 v186, v186, -2, s62
 v_and_or_b32 v187, v187, -2, s62
 v_mfma_f32_32x32x16_bf16 v[200:215], a[116:119], v[36:39], v[200:215]
 buffer_store_dwordx4 v[184:187], v240, s[4:7], s72 offen
 s_add_u32 s72, s72, 32768
 v_cvt_pk_bf16_f32 v192, v192, v193
 v_cvt_pk_bf16_f32 v193, v194, v195
 v_mfma_f32_32x32x16_bf16 v[200:215], a[120:123], v[40:43], v[200:215]
 v_cvt_pk_bf16_f32 v194, v196, v197
 v_cvt_pk_bf16_f32 v195, v198, v199
 v_and_or_b32 v192, v192, -2, s62
 v_and_or_b32 v193, v193, -2, s62
 v_mfma_f32_32x32x16_bf16 v[200:215], a[124:127], v[44:47], v[200:215]
 v_and_or_b32 v194, v194, -2, s62
 v_and_or_b32 v195, v195, -2, s62
 buffer_store_dwordx4 v[192:195], v240, s[4:7], s72 offen
 s_add_u32 s72, s72, 32768
 s_cmp_ge_u32 s46, 2
 s_cbranch_scc1 L_t4_321
 v_mfma_f32_32x32x16_bf16 v[184:199], a[128:131], v[16:19], 0
 s_nop 3
 v_mfma_f32_32x32x16_bf16 v[184:199], a[132:135], v[20:23], v[184:199]
 s_nop 3
 v_mfma_f32_32x32x16_bf16 v[184:199], a[136:139], v[24:27], v[184:199]
 s_nop 3
 v_mfma_f32_32x32x16_bf16 v[184:199], a[140:143], v[28:31], v[184:199]
 v_cvt_pk_bf16_f32 v200, v200, v201
 v_cvt_pk_bf16_f32 v201, v202, v203
 v_cvt_pk_bf16_f32 v202, v204, v205
 v_cvt_pk_bf16_f32 v203, v206, v207
 v_mfma_f32_32x32x16_bf16 v[184:199], a[144:147], v[32:35], v[184:199]
 v_and_or_b32 v200, v200, -2, s62
 v_and_or_b32 v201, v201, -2, s62
 v_and_or_b32 v202, v202, -2, s62
 v_and_or_b32 v203, v203, -2, s62
 v_mfma_f32_32x32x16_bf16 v[184:199], a[148:151], v[36:39], v[184:199]
 buffer_store_dwordx4 v[200:203], v240, s[4:7], s72 offen
 s_add_u32 s72, s72, 32768
 v_cvt_pk_bf16_f32 v208, v208, v209
 v_cvt_pk_bf16_f32 v209, v210, v211
 v_mfma_f32_32x32x16_bf16 v[184:199], a[152:155], v[40:43], v[184:199]
 v_cvt_pk_bf16_f32 v210, v212, v213
 v_cvt_pk_bf16_f32 v211, v214, v215
 v_and_or_b32 v208, v208, -2, s62
 v_and_or_b32 v209, v209, -2, s62
 v_mfma_f32_32x32x16_bf16 v[184:199], a[156:159], v[44:47], v[184:199]
 v_and_or_b32 v210, v210, -2, s62
 v_and_or_b32 v211, v211, -2, s62
 buffer_store_dwordx4 v[208:211], v240, s[4:7], s72 offen
 s_add_u32 s72, s72, 32768
 s_nop 11
 v_cvt_pk_bf16_f32 v184, v184, v185
 v_cvt_pk_bf16_f32 v185, v186, v187
 v_cvt_pk_bf16_f32 v186, v188, v189
 v_cvt_pk_bf16_f32 v187, v190, v191
 v_and_or_b32 v184, v184, -2, s62
 v_and_or_b32 v185, v185, -2, s62
 v_and_or_b32 v186, v186, -2, s62
 v_and_or_b32 v187, v187, -2, s62
 buffer_store_dwordx4 v[184:187], v240, s[4:7], s72 offen
 s_add_u32 s72, s72, 32768
 v_cvt_pk_bf16_f32 v192, v192, v193
 v_cvt_pk_bf16_f32 v193, v194, v195
 v_cvt_pk_bf16_f32 v194, v196, v197
 v_cvt_pk_bf16_f32 v195, v198, v199
 v_and_or_b32 v192, v192, -2, s62
 v_and_or_b32 v193, v193, -2, s62
 v_and_or_b32 v194, v194, -2, s62
 v_and_or_b32 v195, v195, -2, s62
 buffer_store_dwordx4 v[192:195], v240, s[4:7], s72 offen
 s_add_u32 s72, s72, 32768
 s_branch L_tj_322
L_t4_321:
 s_nop 11
 v_cvt_pk_bf16_f32 v200, v200, v201
 v_cvt_pk_bf16_f32 v201, v202, v203
 v_cvt_pk_bf16_f32 v202, v204, v205
 v_cvt_pk_bf16_f32 v203, v206, v207
 v_and_or_b32 v200, v200, -2, s62
 v_and_or_b32 v201, v201, -2, s62
 v_and_or_b32 v202, v202, -2, s62
 v_and_or_b32 v203, v203, -2, s62
 buffer_store_dwordx4 v[200:203], v240, s[4:7], s72 offen
 s_add_u32 s72, s72, 32768
 v_cvt_pk_bf16_f32 v208, v208, v209
 v_cvt_pk_bf16_f32 v209, v210, v211
 v_cvt_pk_bf16_f32 v210, v212, v213
 v_cvt_pk_bf16_f32 v211, v214, v215
 v_and_or_b32 v208, v208, -2, s62
 v_and_or_b32 v209, v209, -2, s62
 v_and_or_b32 v210, v210, -2, s62
 v_and_or_b32 v211, v211, -2, s62
 buffer_store_dwordx4 v[208:211], v240, s[4:7], s72 offen
 s_add_u32 s72, s72, 32768
L_tj_322:
 s_cmp_eq_u32 s49, 1
 s_cbranch_scc1 L_rel_323
 s_waitcnt vmcnt(0)
 buffer_wbl2 sc1
 s_waitcnt vmcnt(0)
L_rel_323:
 s_cmp_eq_u32 s57, 0
 s_cbranch_scc1 L_segend_324
 s_mov_b32 s60, 0
 s_waitcnt vmcnt(14)
 v_mfma_f32_16x16x32_bf16 v[224:227], v[216:219], a[160:163], 0
 v_mfma_f32_16x16x32_bf16 v[224:227], v[220:223], a[164:167], v[224:227]
 v_mfma_f32_16x16x32_bf16 v[224:227], v[216:219], a[168:171], v[224:227]
 v_mfma_f32_16x16x32_bf16 v[224:227], v[220:223], a[172:175], v[224:227]
 v_mfma_f32_16x16x32_bf16 v[224:227], v[216:219], a[176:179], v[224:227]
 v_mfma_f32_16x16x32_bf16 v[224:227], v[220:223], a[180:183], v[224:227]
 s_nop 15
 s_nop 15
 s_nop 15
 s_nop 15
L_epoll_325:
 s_add_u32 s72, s56, s77
 buffer_load_dwordx4 v[48:51], v243, s[4:7], s72 offen offset:0 sc1
 buffer_load_dwordx4 v[52:55], v243, s[4:7], s72 offen offset:512 sc1
 s_add_u32 s72, s72, 4096
 buffer_load_dwordx4 v[56:59], v243, s[4:7], s72 offen offset:0 sc1
 buffer_load_dwordx4 v[60:63], v243, s[4:7], s72 offen offset:512 sc1
 s_add_u32 s72, s72, 4096
 buffer_load_dwordx4 v[64:67], v243, s[4:7], s72 offen offset:0 sc1
 buffer_load_dwordx4 v[68:71], v243, s[4:7], s72 offen offset:512 sc1
 s_add_u32 s72, s72, 4096
 buffer_load_dwordx4 v[72:75], v243, s[4:7], s72 offen offset:0 sc1
 buffer_load_dwordx4 v[76:79], v243, s[4:7], s72 offen offset:512 sc1
 s_add_u32 s72, s72, 4096
 buffer_load_dwordx4 v[80:83], v243, s[4:7], s72 offen offset:0 sc1
 buffer_load_dwordx4 v[84:87], v243, s[4:7], s72 offen offset:512 sc1
 s_add_u32 s72, s72, 4096
 buffer_load_dwordx4 v[88:91], v243, s[4:7], s72 offen offset:0 sc1
 buffer_load_dwordx4 v[92:95], v243, s[4:7], s72 offen offset:512 sc1
 s_add_u32 s72, s72, 4096
 buffer_load_dwordx4 v[96:99], v243, s[4:7], s72 offen offset:0 sc1
 buffer_load_dwordx4 v[100:103], v243, s[4:7], s72 offen offset:512 sc1
 s_add_u32 s72, s72, 4096
 buffer_load_dwordx4 v[104:107], v243, s[4:7], s72 offen offset:0 sc1
 buffer_load_dwordx4 v[108:111], v243, s[4:7], s72 offen offset:512 sc1
 s_add_u32 s72, s72, 4096
 s_add_u32 s60, s60, 1
 s_cmp_gt_u32 s60, 400000
 s_cbranch_scc1 L_exit2
 s_waitcnt vmcnt(15)
 v_mfma_f32_16x16x32_bf16 v[168:171], v[216:219], v[48:51], v[224:227]
 v_bitop3_b32 v246, v48, v49, v50 bitop3:0x80
 v_bitop3_b32 v247, v48, v49, v50 bitop3:0xfe
 v_and_b32 v246, v246, v51
 v_or_b32 v247, v247, v51
 s_waitcnt vmcnt(14)
 v_mfma_f32_16x16x32_bf16 v[168:171], v[220:223], v[52:55], v[168:171]
 v_bitop3_b32 v246, v246, v52, v53 bitop3:0x80
 v_bitop3_b32 v247, v247, v52, v53 bitop3:0xfe
 v_bitop3_b32 v246, v246, v54, v55 bitop3:0x80
 v_bitop3_b32 v247, v247, v54, v55 bitop3:0xfe
 s_waitcnt vmcnt(13)
 v_mfma_f32_16x16x32_bf16 v[168:171], v[216:219], v[56:59], v[168:171]
 v_bitop3_b32 v246, v246, v56, v57 bitop3:0x80
 v_bitop3_b32 v247, v247, v56, v57 bitop3:0xfe
 v_bitop3_b32 v246, v246, v58, v59 bitop3:0x80
 v_bitop3_b32 v247, v247, v58, v59 bitop3:0xfe
 s_waitcnt vmcnt(12)
 v_mfma_f32_16x16x32_bf16 v[168:171], v[220:223], v[60:63], v[168:171]
 v_bitop3_b32 v246, v246, v60, v61 bitop3:0x80
 v_bitop3_b32 v247, v247, v60, v61 bitop3:0xfe
 v_bitop3_b32 v246, v246, v62, v63 bitop3:0x80
 v_bitop3_b32 v247, v247, v62, v63 bitop3:0xfe
 s_waitcnt vmcnt(11)
 v_mfma_f32_16x16x32_bf16 v[168:171], v[216:219], v[64:67], v[168:171]
 v_bitop3_b32 v246, v246, v64, v65 bitop3:0x80
 v_bitop3_b32 v247, v247, v64, v65 bitop3:0xfe
 v_bitop3_b32 v246, v246, v66, v67 bitop3:0x80
 v_bitop3_b32 v247, v247, v66, v67 bitop3:0xfe
 s_waitcnt vmcnt(10)
 v_mfma_f32_16x16x32_bf16 v[168:171], v[220:223], v[68:71], v[168:171]
 v_bitop3_b32 v246, v246, v68, v69 bitop3:0x80
 v_bitop3_b32 v247, v247, v68, v69 bitop3:0xfe
 v_bitop3_b32 v246, v246, v70, v71 bitop3:0x80
 v_bitop3_b32 v247, v247, v70, v71 bitop3:0xfe
 s_waitcnt vmcnt(9)
 v_mfma_f32_16x16x32_bf16 v[168:171], v[216:219], v[72:75], v[168:171]
 v_bitop3_b32 v246, v246, v72, v73 bitop3:0x80
 v_bitop3_b32 v247, v247, v72, v73 bitop3:0xfe
 v_bitop3_b32 v246, v246, v74, v75 bitop3:0x80
 v_bitop3_b32 v247, v247, v74, v75 bitop3:0xfe
 s_waitcnt vmcnt(8)
 v_mfma_f32_16x16x32_bf16 v[168:171], v[220:223], v[76:79], v[168:171]
 v_bitop3_b32 v246, v246, v76, v77 bitop3:0x80
 v_bitop3_b32 v247, v247, v76, v77 bitop3:0xfe
 v_bitop3_b32 v246, v246, v78, v79 bitop3:0x80
 v_bitop3_b32 v247, v247, v78, v79 bitop3:0xfe
 s_waitcnt vmcnt(7)
 v_mfma_f32_16x16x32_bf16 v[168:171], v[216:219], v[80:83], v[168:171]
 v_bitop3_b32 v246, v246, v80, v81 bitop3:0x80
 v_bitop3_b32 v247, v247, v80, v81 bitop3:0xfe
 v_bitop3_b32 v246, v246, v82, v83 bitop3:0x80
 v_bitop3_b32 v247, v247, v82, v83 bitop3:0xfe
 s_waitcnt vmcnt(6)
 v_mfma_f32_16x16x32_bf16 v[168:171], v[220:223], v[84:87], v[168:171]
 v_bitop3_b32 v246, v246, v84, v85 bitop3:0x80
 v_bitop3_b32 v247, v247, v84, v85 bitop3:0xfe
 v_bitop3_b32 v246, v246, v86, v87 bitop3:0x80
 v_bitop3_b32 v247, v247, v86, v87 bitop3:0xfe
 s_waitcnt vmcnt(5)
 v_mfma_f32_16x16x32_bf16 v[168:171], v[216:219], v[88:91], v[168:171]
 v_bitop3_b32 v246, v246, v88, v89 bitop3:0x80
 v_bitop3_b32 v247, v247, v88, v89 bitop3:0xfe
 v_bitop3_b32 v246, v246, v90, v91 bitop3:0x80
 v_bitop3_b32 v247, v247, v90, v91 bitop3:0xfe
 s_waitcnt vmcnt(4)
 v_mfma_f32_16x16x32_bf16 v[168:171], v[220:223], v[92:95], v[168:171]
 v_bitop3_b32 v246, v246, v92, v93 bitop3:0x80
 v_bitop3_b32 v247, v247, v92, v93 bitop3:0xfe
 v_bitop3_b32 v246, v246, v94, v95 bitop3:0x80
 v_bitop3_b32 v247, v247, v94, v95 bitop3:0xfe
 s_waitcnt vmcnt(3)
 v_mfma_f32_16x16x32_bf16 v[168:171], v[216:219], v[96:99], v[168:171]
 v_bitop3_b32 v246, v246, v96, v97 bitop3:0x80
 v_bitop3_b32 v247, v247, v96, v97 bitop3:0xfe
 v_bitop3_b32 v246, v246, v98, v99 bitop3:0x80
 v_bitop3_b32 v247, v247, v98, v99 bitop3:0xfe
 s_waitcnt vmcnt(2)
 v_mfma_f32_16x16x32_bf16 v[168:171], v[220:223], v[100:103], v[168:171]
 v_bitop3_b32 v246, v246, v100, v101 bitop3:0x80
 v_bitop3_b32 v247, v247, v100, v101 bitop3:0xfe
 v_bitop3_b32 v246, v246, v102, v103 bitop3:0x80
 v_bitop3_b32 v247, v247, v102, v103 bitop3:0xfe
 s_waitcnt vmcnt(1)
 v_mfma_f32_16x16x32_bf16 v[168:171], v[216:219], v[104:107], v[168:171]
 v_bitop3_b32 v246, v246, v104, v105 bitop3:0x80
 v_bitop3_b32 v247, v247, v104, v105 bitop3:0xfe
 v_bitop3_b32 v246, v246, v106, v107 bitop3:0x80
 v_bitop3_b32 v247, v247, v106, v107 bitop3:0xfe
 s_waitcnt vmcnt(0)
 v_mfma_f32_16x16x32_bf16 v[168:171], v[220:223], v[108:111], v[168:171]
 v_bitop3_b32 v246, v246, v108, v109 bitop3:0x80
 v_bitop3_b32 v247, v247, v108, v109 bitop3:0xfe
 v_bitop3_b32 v246, v246, v110, v111 bitop3:0x80
 v_bitop3_b32 v247, v247, v110, v111 bitop3:0xfe
 v_xor_b32 v246, s62, v246
 v_xor_b32 v247, s62, v247
 v_or_b32 v246, v246, v247
 v_and_b32 v246, 1, v246
 v_cmp_ne_u32 vcc, 0, v246
 s_cbranch_vccnz L_epoll_325
 v_lshlrev_b32 v246, 16, v228
 v_and_b32 v247, 0xffff0000, v228
 v_lshlrev_b32 v248, 16, v229
 v_and_b32 v249, 0xffff0000, v229
 v_add_f32 v168, v168, v246
 v_add_f32 v169, v169, v247
 v_add_f32 v170, v170, v248
 v_add_f32 v171, v171, v249
 v_cvt_pk_bf16_f32 v168, v168, v169
 v_cvt_pk_bf16_f32 v169, v170, v171
 s_mul_i32 s72, s52, 36864
 buffer_store_dwordx2 v[168:169], v245, s[36:39], s72 offen
L_segend_324:
 s_add_u32 s52, s52, 6
 s_add_u32 s53, s53, 1
 s_xor_b32 s54, s54, 24576
 s_cmp_lt_u32 s52, 63
 s_cbranch_scc1 L_seg_312
 s_branch L_done2
L_done2:
 s_add_u32 s48, s48, 32
L_done:
L_exit2:
 s_endpgm
L_codeend:

.section .rodata,"a"
.p2align 6
.amdhsa_kernel parallel_sum__memory_aug_recurrent_mem_tr__dense_activation_silu__prompt_kernel
  .amdhsa_next_free_vgpr 512
  .amdhsa_next_free_sgpr 102
  .amdhsa_accum_offset 256
  .amdhsa_group_segment_fixed_size 0
  .amdhsa_kernarg_size 104
  .amdhsa_user_sgpr_count 2
  .amdhsa_user_sgpr_kernarg_segment_ptr 1
  .amdhsa_system_sgpr_workgroup_id_x 1
.end_amdhsa_kernel
```
